```python
import torch

def _softmax(x, axis=-1):
    return torch.softmax(x, dim=axis)
def _gelu(x):
    return torch.nn.functional.gelu(x, approximate="tanh")
def _silu(x):
    return torch.nn.functional.silu(x)
def _sigmoid(x):
    return torch.sigmoid(x)
def _layernorm(x, axis=-1, eps=1e-5):
    m = x.mean(dim=axis, keepdim=True)
    v = x.var(dim=axis, keepdim=True, unbiased=False)
    return (x - m) / torch.sqrt(v + eps)
def _scatter_add(tgt, idx, src, axis=0):
    return tgt.clone().index_add_(axis, idx, src)
def _segment_sum(src, seg, n):
    out = torch.zeros((n,) + src.shape[1:], dtype=src.dtype)
    return out.index_add_(0, seg, src)
def _pad(x, pw):
    flat = tuple(v for pair in reversed(pw) for v in pair)
    return torch.nn.functional.pad(x, flat)

kernel_name = 'sequential_preLN__linear_kernel_hedgehog__moe_arch_mod__prompt'

def setup_inputs():

    _w = (lambda a: (lambda t: t.to(torch.bfloat16) if t.is_floating_point() else t)(torch.as_tensor(a)))
    def _A_setup():
        B, S, D, H = 1, 2048, 1024, 32
        Dh = D // H
        return {
            "x": _w((lambda *s: torch.randn(*s, dtype=torch.bfloat16) * 0.05)(B, S, D)),
            "wqkv": _w((lambda *s: torch.randn(*s, dtype=torch.bfloat16) * 0.2)(D, 3 * D)),
            "w_phi": _w((lambda *s: torch.randn(*s, dtype=torch.bfloat16) * 0.2)(H, Dh, Dh) * (Dh ** -0.5)),
            "wo": _w((lambda *s: torch.randn(*s, dtype=torch.bfloat16) * 0.05)(D, D)),
        }
    _A_in = _A_setup()

    def _B_setup():
        B, S, D, F, C = 1, 2048, 1024, 3584, 1
        return {
            "x": _w((lambda *s: torch.randn(*s, dtype=torch.bfloat16) * 0.05)(B, S, D)),
            "w_r": _w((lambda *s: torch.randn(*s, dtype=torch.bfloat16) * 0.1)(D)),
            "w_gate": _w((lambda *s: torch.randn(*s, dtype=torch.bfloat16) * 0.05)(D, F)),
            "w_up": _w((lambda *s: torch.randn(*s, dtype=torch.bfloat16) * 0.05)(D, F)),
            "w_down": _w((lambda *s: torch.randn(*s, dtype=torch.bfloat16) * 0.05)(F, D)),
        }
    _B_in = _B_setup()

    return {
        "A_x": _A_in["x"],
        "A_wqkv": _A_in["wqkv"],
        "A_w_phi": _A_in["w_phi"],
        "A_wo": _A_in["wo"],
        "B_x": _B_in["x"],
        "B_w_r": _B_in["w_r"],
        "B_w_gate": _B_in["w_gate"],
        "B_w_up": _B_in["w_up"],
        "B_w_down": _B_in["w_down"],
    }

def reference(A_x, A_wqkv, A_w_phi, A_wo, B_x, B_w_r, B_w_gate, B_w_up, B_w_down):
    def _A_ref(x, wqkv, w_phi, wo):
        B, S, D = x.shape
        H = 32; Dh = D // H
        qkv = (lambda x, *d: x.permute(*d))((x @ wqkv).reshape(B, S, 3, H, Dh), 2, 0, 3, 1, 4)
        q, k, v = qkv[0], qkv[1], qkv[2]
        pq = torch.einsum("bhsd,hdf->bhsf", q, w_phi)
        pk = torch.einsum("bhsd,hdf->bhsf", k, w_phi)
        phi_q = torch.concatenate([_softmax(pq, axis=-1), _softmax(-pq, axis=-1)], axis=-1)
        phi_k = torch.concatenate([_softmax(pk, axis=-1), _softmax(-pk, axis=-1)], axis=-1)
        kv = torch.einsum("bhsf,bhsd->bhfd", phi_k, v)
        z  = torch.einsum("bhsf->bhf", phi_k)
        num = torch.einsum("bhqf,bhfd->bhqd", phi_q, kv)
        den = torch.einsum("bhqf,bhf->bhq", phi_q, z)[..., None] + 1e-6
        o = num / den
        return (lambda x, *d: x.permute(*d))(o, 0, 2, 1, 3).reshape(B, S, D) @ wo

    def _B_ref(x, w_r, w_gate, w_up, w_down):
        B, S, D = x.shape
        C = 1
        r = x @ w_r
        idx = torch.argsort(-r, axis=-1)[:, :C]
        idx_e = (lambda x, n, axis: torch.repeat_interleave(x, n, dim=axis))(idx.reshape(B, C, 1), D, axis=2)
        x_sel = (lambda x, i, axis: torch.take_along_dim(x, i, dim=axis))(x, idx_e, axis=1)
        g = _silu(x_sel @ w_gate)
        u = x_sel @ w_up
        y = (g * u) @ w_down
        r_sel = _sigmoid((lambda x, i, axis: torch.take_along_dim(x, i, dim=axis))(r, idx, axis=1))
        y = y * r_sel.reshape(B, C, 1)
        b_off = (torch.arange(B) * S).reshape(B, 1)
        flat_idx = (idx + b_off).reshape(B * C)
        zero = (x * 0.0).reshape(B * S, D)
        upd = _scatter_add(zero, flat_idx, y.reshape(B * C, D), axis=0)
        return x + upd.reshape(B, S, D)

    x = A_x
    h = x + _A_ref(_layernorm(x, axis=-1), A_wqkv, A_w_phi, A_wo)
    h2 = h + _B_ref(_layernorm(h, axis=-1), B_w_r, B_w_gate, B_w_up, B_w_down)
    return h2
```

```asm
; @launch grid=(256,1,1) block=(512,1,1) lds=163840
.amdgcn_target "amdgcn-amd-amdhsa--gfx950"
.text
.globl sequential_preLN__linear_kernel_hedgehog__moe_arch_mod__prompt_kernel
.p2align 8
.type sequential_preLN__linear_kernel_hedgehog__moe_arch_mod__prompt_kernel,@function
sequential_preLN__linear_kernel_hedgehog__moe_arch_mod__prompt_kernel:
    s_cmp_ge_u32 s2, 256
    s_cbranch_scc1 L_end
    s_load_dwordx16 s[4:19], s[0:1], 0
    s_load_dwordx8 s[20:27], s[0:1], 64
    v_lshrrev_b32 v1, 6, v0
    v_and_b32 v2, 63, v0
    v_readfirstlane_b32 s68, v1
    s_and_b32 s78, s2, 7
    s_lshr_b32 s79, s2, 3
    s_and_b32 s69, s78, 1
    s_lshl_b32 s69, s69, 3
    s_and_b32 s80, s79, 7
    s_add_u32 s69, s69, s80
    s_lshr_b32 s70, s78, 1
    s_lshl_b32 s70, s70, 2
    s_lshr_b32 s80, s79, 3
    s_add_u32 s70, s70, s80
    s_and_b32 s71, s78, 3
    s_lshl_b32 s71, s71, 2
    s_and_b32 s80, s79, 3
    s_add_u32 s71, s71, s80
    s_lshr_b32 s72, s78, 2
    s_lshl_b32 s72, s72, 3
    s_lshr_b32 s80, s79, 2
    s_add_u32 s72, s72, s80
    s_lshr_b32 s73, s2, 2
    s_and_b32 s74, s2, 3
    s_lshl_b32 s77, s70, 4
    s_add_u32 s77, s77, s69
    s_and_b32 s76, s68, 3
    s_cmp_ge_u32 s68, 4
    s_cbranch_scc1 L_H
    s_and_b32 s80, s68, 1
    s_lshr_b32 s81, s68, 1
    v_and_b32 v8, 15, v2
    v_lshrrev_b32 v9, 4, v2
    v_lshrrev_b32 v10, 1, v8
    s_lshl_b32 s78, s80, 13
    s_add_u32 s78, s78, 118784
    v_lshlrev_b32 v11, 7, v8
    v_add_u32 v11, s78, v11
    v_add_u32 v12, 0, v9
    v_xor_b32 v12, v12, v10
    v_lshl_add_u32 v4, v12, 4, v11
    v_add_u32 v12, 4, v9
    v_xor_b32 v12, v12, v10
    v_lshl_add_u32 v5, v12, 4, v11
    v_bfe_u32 v10, v2, 2, 2
    v_and_b32 v11, 3, v2
    v_lshl_add_u32 v12, v9, 3, v10
    v_lshlrev_b32 v12, 7, v12
    v_lshl_add_u32 v12, v11, 3, v12
    v_add_u32 v12, 135168, v12
    v_lshrrev_b32 v13, 1, v10
    v_and_b32 v14, 1, v9
    v_lshl_add_u32 v13, v14, 1, v13
    s_lshl_b32 s78, s81, 1
    s_add_u32 s79, s78, 0
    v_xor_b32 v14, s79, v13
    v_lshl_add_u32 v6, v14, 5, v12
    s_add_u32 s79, s78, 1
    v_xor_b32 v14, s79, v13
    v_lshl_add_u32 v7, v14, 5, v12
    v_lshrrev_b32 v13, 5, v2
    v_lshl_add_u32 v13, v13, 3, v10
    v_lshlrev_b32 v13, 6, v13
    v_and_b32 v14, 1, v9
    v_lshl_add_u32 v13, v14, 5, v13
    v_lshl_add_u32 v13, v11, 3, v13
    s_lshl_b32 s78, s81, 11
    s_add_u32 s78, s78, 159744
    v_add_u32 v15, s78, v13
    v_mov_b64 v[128:129], 0
    v_mov_b64 v[130:131], 0
    v_mov_b64 v[132:133], 0
    v_mov_b64 v[134:135], 0
    v_mov_b64 v[136:137], 0
    v_mov_b64 v[138:139], 0
    v_mov_b64 v[140:141], 0
    v_mov_b64 v[142:143], 0
    v_mov_b64 v[144:145], 0
    v_mov_b64 v[146:147], 0
    v_mov_b64 v[148:149], 0
    v_mov_b64 v[150:151], 0
    v_mov_b64 v[152:153], 0
    v_mov_b64 v[154:155], 0
    v_mov_b64 v[156:157], 0
    v_mov_b64 v[158:159], 0
    v_mov_b64 v[160:161], 0
    v_mov_b64 v[162:163], 0
    v_mov_b64 v[164:165], 0
    v_mov_b64 v[166:167], 0
    v_mov_b64 v[168:169], 0
    v_mov_b64 v[170:171], 0
    v_mov_b64 v[172:173], 0
    v_mov_b64 v[174:175], 0
    v_mov_b64 v[176:177], 0
    v_mov_b64 v[178:179], 0
    v_mov_b64 v[180:181], 0
    v_mov_b64 v[182:183], 0
    v_mov_b64 v[184:185], 0
    v_mov_b64 v[186:187], 0
    v_mov_b64 v[188:189], 0
    v_mov_b64 v[190:191], 0
    v_mov_b64 v[192:193], 0
    v_mov_b64 v[194:195], 0
    v_mov_b64 v[196:197], 0
    v_mov_b64 v[198:199], 0
    v_mov_b64 v[200:201], 0
    v_mov_b64 v[202:203], 0
    v_mov_b64 v[204:205], 0
    v_mov_b64 v[206:207], 0
    v_mov_b64 v[208:209], 0
    v_mov_b64 v[210:211], 0
    v_mov_b64 v[212:213], 0
    v_mov_b64 v[214:215], 0
    v_mov_b64 v[216:217], 0
    v_mov_b64 v[218:219], 0
    v_mov_b64 v[220:221], 0
    v_mov_b64 v[222:223], 0
    s_waitcnt lgkmcnt(0)
    s_mov_b32 s36, s26
    s_and_b32 s37, s27, 0xffff
    s_mov_b32 s38, 0x10000000
    s_mov_b32 s39, 0x20000
    s_mov_b32 s64, s14
    s_and_b32 s65, s15, 0xffff
    s_mov_b32 s66, 0x800
    s_mov_b32 s67, 0x20000
    s_mov_b32 s44, s22
    s_and_b32 s45, s23, 0xffff
    s_mov_b32 s46, 0x400000
    s_mov_b32 s47, 0x20000
    s_mov_b32 s84, 0
    s_mov_b32 s82, 2
    s_mov_b32 s83, 0xfffec000
    s_barrier
    ds_read_b128 v[16:19], v4 offset:0
    ds_read_b64_tr_b16 v[32:33], v6 offset:0
    ds_read_b64_tr_b16 v[34:35], v6 offset:512
    ds_read_b128 v[20:23], v4 offset:2048
    ds_read_b128 v[24:27], v4 offset:4096
    ds_read_b128 v[28:31], v4 offset:6144
    ds_read_b64_tr_b16 v[36:37], v7 offset:0
    ds_read_b64_tr_b16 v[38:39], v7 offset:512
    ds_read_b64_tr_b16 v[40:41], v6 offset:8192
    ds_read_b64_tr_b16 v[42:43], v6 offset:8704
    ds_read_b64_tr_b16 v[44:45], v7 offset:8192
    ds_read_b64_tr_b16 v[46:47], v7 offset:8704
    ds_read_b64_tr_b16 v[48:49], v6 offset:16384
    ds_read_b64_tr_b16 v[50:51], v6 offset:16896
    ds_read_b64_tr_b16 v[52:53], v7 offset:16384
    ds_read_b64_tr_b16 v[54:55], v7 offset:16896
    ds_read_b64_tr_b16 v[96:97], v15 offset:0
    ds_read_b64_tr_b16 v[98:99], v15 offset:1024
    ds_read_b64_tr_b16 v[100:101], v15 offset:256
    ds_read_b64_tr_b16 v[102:103], v15 offset:1280
    .p2align 3
L_Mloop:
    s_waitcnt lgkmcnt(0)
    v_mfma_f32_16x16x32_bf16 v[128:131], v[32:35], v[16:19], v[128:131]
    ds_read_b128 v[56:59], v5 offset:0
    v_mfma_f32_16x16x32_bf16 v[132:135], v[32:35], v[20:23], v[132:135]
    ds_read_b64_tr_b16 v[72:73], v6 offset:4096
    v_mfma_f32_16x16x32_bf16 v[136:139], v[32:35], v[24:27], v[136:139]
    ds_read_b64_tr_b16 v[74:75], v6 offset:4608
    v_mfma_f32_16x16x32_bf16 v[140:143], v[32:35], v[28:31], v[140:143]
    ds_read_b128 v[60:63], v5 offset:2048
    v_mfma_f32_16x16x32_bf16 v[156:159], v[36:39], v[28:31], v[156:159]
    ds_read_b128 v[64:67], v5 offset:4096
    v_mfma_f32_16x16x32_bf16 v[152:155], v[36:39], v[24:27], v[152:155]
    ds_read_b128 v[68:71], v5 offset:6144
    v_mfma_f32_16x16x32_bf16 v[148:151], v[36:39], v[20:23], v[148:151]
    ds_read_b64_tr_b16 v[76:77], v7 offset:4096
    v_mfma_f32_16x16x32_bf16 v[144:147], v[36:39], v[16:19], v[144:147]
    ds_read_b64_tr_b16 v[78:79], v7 offset:4608
    v_mfma_f32_16x16x32_bf16 v[160:163], v[40:43], v[16:19], v[160:163]
    ds_read_b64_tr_b16 v[80:81], v6 offset:12288
    v_mfma_f32_16x16x32_bf16 v[164:167], v[40:43], v[20:23], v[164:167]
    ds_read_b64_tr_b16 v[82:83], v6 offset:12800
    v_mfma_f32_16x16x32_bf16 v[168:171], v[40:43], v[24:27], v[168:171]
    ds_read_b64_tr_b16 v[84:85], v7 offset:12288
    v_mfma_f32_16x16x32_bf16 v[172:175], v[40:43], v[28:31], v[172:175]
    ds_read_b64_tr_b16 v[86:87], v7 offset:12800
    v_mfma_f32_16x16x32_bf16 v[188:191], v[44:47], v[28:31], v[188:191]
    ds_read_b64_tr_b16 v[88:89], v6 offset:20480
    v_mfma_f32_16x16x32_bf16 v[184:187], v[44:47], v[24:27], v[184:187]
    ds_read_b64_tr_b16 v[90:91], v6 offset:20992
    v_mfma_f32_16x16x32_bf16 v[180:183], v[44:47], v[20:23], v[180:183]
    ds_read_b64_tr_b16 v[92:93], v7 offset:20480
    v_mfma_f32_16x16x32_bf16 v[176:179], v[44:47], v[16:19], v[176:179]
    ds_read_b64_tr_b16 v[94:95], v7 offset:20992
    v_mfma_f32_16x16x32_bf16 v[192:195], v[48:51], v[16:19], v[192:195]
    s_add_u32 s84, s84, 1
    s_cmp_eq_u32 s82, 2
    s_cselect_b32 s78, s83, 40960
    s_cselect_b32 s82, -1, s82
    s_add_u32 s82, s82, 1
    v_mfma_f32_16x16x32_bf16 v[196:199], v[48:51], v[20:23], v[196:199]
    v_add_u32 v4, s78, v4
    v_add_u32 v5, s78, v5
    v_mfma_f32_16x16x32_bf16 v[200:203], v[48:51], v[24:27], v[200:203]
    v_add_u32 v6, s78, v6
    v_add_u32 v7, s78, v7
    v_mfma_f32_16x16x32_bf16 v[204:207], v[48:51], v[28:31], v[204:207]
    v_mfma_f32_16x16x32_bf16 v[220:223], v[52:55], v[28:31], v[220:223]
    v_mfma_f32_16x16x32_bf16 v[216:219], v[52:55], v[24:27], v[216:219]
    v_mfma_f32_16x16x32_bf16 v[212:215], v[52:55], v[20:23], v[212:215]
    v_mfma_f32_16x16x32_bf16 v[208:211], v[52:55], v[16:19], v[208:211]
    s_waitcnt lgkmcnt(0)
    v_mfma_f32_16x16x32_bf16 v[128:131], v[72:75], v[56:59], v[128:131]
    v_mfma_f32_16x16x32_bf16 v[132:135], v[72:75], v[60:63], v[132:135]
    s_barrier
    s_cmp_eq_u32 s84, 16
    s_cbranch_scc1 L_Mtail
    v_mfma_f32_16x16x32_bf16 v[136:139], v[72:75], v[64:67], v[136:139]
    ds_read_b128 v[16:19], v4 offset:0
    v_mfma_f32_16x16x32_bf16 v[140:143], v[72:75], v[68:71], v[140:143]
    ds_read_b64_tr_b16 v[32:33], v6 offset:0
    v_mfma_f32_16x16x32_bf16 v[156:159], v[76:79], v[68:71], v[156:159]
    ds_read_b64_tr_b16 v[34:35], v6 offset:512
    v_mfma_f32_16x16x32_bf16 v[152:155], v[76:79], v[64:67], v[152:155]
    ds_read_b128 v[20:23], v4 offset:2048
    v_mfma_f32_16x16x32_bf16 v[148:151], v[76:79], v[60:63], v[148:151]
    ds_read_b128 v[24:27], v4 offset:4096
    v_mfma_f32_16x16x32_bf16 v[144:147], v[76:79], v[56:59], v[144:147]
    ds_read_b128 v[28:31], v4 offset:6144
    v_mfma_f32_16x16x32_bf16 v[160:163], v[80:83], v[56:59], v[160:163]
    ds_read_b64_tr_b16 v[36:37], v7 offset:0
    v_mfma_f32_16x16x32_bf16 v[164:167], v[80:83], v[60:63], v[164:167]
    ds_read_b64_tr_b16 v[38:39], v7 offset:512
    v_mfma_f32_16x16x32_bf16 v[168:171], v[80:83], v[64:67], v[168:171]
    ds_read_b64_tr_b16 v[40:41], v6 offset:8192
    v_mfma_f32_16x16x32_bf16 v[172:175], v[80:83], v[68:71], v[172:175]
    ds_read_b64_tr_b16 v[42:43], v6 offset:8704
    v_mfma_f32_16x16x32_bf16 v[188:191], v[84:87], v[68:71], v[188:191]
    ds_read_b64_tr_b16 v[44:45], v7 offset:8192
    v_mfma_f32_16x16x32_bf16 v[184:187], v[84:87], v[64:67], v[184:187]
    ds_read_b64_tr_b16 v[46:47], v7 offset:8704
    v_mfma_f32_16x16x32_bf16 v[180:183], v[84:87], v[60:63], v[180:183]
    ds_read_b64_tr_b16 v[48:49], v6 offset:16384
    v_mfma_f32_16x16x32_bf16 v[176:179], v[84:87], v[56:59], v[176:179]
    ds_read_b64_tr_b16 v[50:51], v6 offset:16896
    v_mfma_f32_16x16x32_bf16 v[192:195], v[88:91], v[56:59], v[192:195]
    ds_read_b64_tr_b16 v[52:53], v7 offset:16384
    v_mfma_f32_16x16x32_bf16 v[196:199], v[88:91], v[60:63], v[196:199]
    ds_read_b64_tr_b16 v[54:55], v7 offset:16896
    v_mfma_f32_16x16x32_bf16 v[200:203], v[88:91], v[64:67], v[200:203]
    v_mfma_f32_16x16x32_bf16 v[204:207], v[88:91], v[68:71], v[204:207]
    v_mfma_f32_16x16x32_bf16 v[220:223], v[92:95], v[68:71], v[220:223]
    v_mfma_f32_16x16x32_bf16 v[216:219], v[92:95], v[64:67], v[216:219]
    v_mfma_f32_16x16x32_bf16 v[212:215], v[92:95], v[60:63], v[212:215]
    v_mfma_f32_16x16x32_bf16 v[208:211], v[92:95], v[56:59], v[208:211]
    s_branch L_Mloop
    .p2align 3
L_Mtail:
    v_mfma_f32_16x16x32_bf16 v[136:139], v[72:75], v[64:67], v[136:139]
    s_lshl_b32 s78, s80, 6
    v_add_u32 v10, s78, v8
    v_mfma_f32_16x16x32_bf16 v[140:143], v[72:75], v[68:71], v[140:143]
    v_lshlrev_b32 v11, 3, v10
    v_add_u32 v11, 159744, v11
    v_mfma_f32_16x16x32_bf16 v[156:159], v[76:79], v[68:71], v[156:159]
    s_lshl_b32 s79, s81, 5
    v_add_u32 v12, s79, v8
    v_mfma_f32_16x16x32_bf16 v[152:155], v[76:79], v[64:67], v[152:155]
    v_lshlrev_b32 v12, 3, v12
    v_add_u32 v12, 160768, v12
    v_mfma_f32_16x16x32_bf16 v[148:151], v[76:79], v[60:63], v[148:151]
    v_lshlrev_b32 v13, 2, v10
    v_add_u32 v13, 162304, v13
    v_mfma_f32_16x16x32_bf16 v[144:147], v[76:79], v[56:59], v[144:147]
    v_and_b32 v14, 31, v2
    v_add_u32 v14, s78, v14
    v_mfma_f32_16x16x32_bf16 v[160:163], v[80:83], v[56:59], v[160:163]
    v_lshlrev_b32 v14, 2, v14
    v_add_u32 v14, 162304, v14
    v_mfma_f32_16x16x32_bf16 v[164:167], v[80:83], v[60:63], v[164:167]
    ds_read_b64 v[16:17], v11 offset:0
    v_mfma_f32_16x16x32_bf16 v[168:171], v[80:83], v[64:67], v[168:171]
    ds_read_b64 v[18:19], v11 offset:128
    v_mfma_f32_16x16x32_bf16 v[172:175], v[80:83], v[68:71], v[172:175]
    ds_read_b64 v[20:21], v11 offset:256
    v_mfma_f32_16x16x32_bf16 v[188:191], v[84:87], v[68:71], v[188:191]
    ds_read_b64 v[22:23], v11 offset:384
    v_mfma_f32_16x16x32_bf16 v[184:187], v[84:87], v[64:67], v[184:187]
    ds_read_b64 v[24:25], v12 offset:0
    v_mfma_f32_16x16x32_bf16 v[180:183], v[84:87], v[60:63], v[180:183]
    ds_read_b64 v[26:27], v12 offset:128
    v_mfma_f32_16x16x32_bf16 v[176:179], v[84:87], v[56:59], v[176:179]
    ds_read_b64 v[28:29], v12 offset:512
    v_mfma_f32_16x16x32_bf16 v[192:195], v[88:91], v[56:59], v[192:195]
    ds_read_b64 v[30:31], v12 offset:640
    v_mfma_f32_16x16x32_bf16 v[196:199], v[88:91], v[60:63], v[196:199]
    ds_read_b64 v[32:33], v12 offset:1024
    v_mfma_f32_16x16x32_bf16 v[200:203], v[88:91], v[64:67], v[200:203]
    ds_read_b64 v[34:35], v12 offset:1152
    v_mfma_f32_16x16x32_bf16 v[204:207], v[88:91], v[68:71], v[204:207]
    ds_read2_b32 v[36:37], v13 offset0:0 offset1:16
    v_mfma_f32_16x16x32_bf16 v[220:223], v[92:95], v[68:71], v[220:223]
    ds_read2_b32 v[38:39], v13 offset0:32 offset1:48
    v_mfma_f32_16x16x32_bf16 v[216:219], v[92:95], v[64:67], v[216:219]
    ds_read2_b32 v[40:41], v14 offset0:0 offset1:32
    v_mfma_f32_16x16x32_bf16 v[212:215], v[92:95], v[60:63], v[212:215]
    v_mfma_f32_16x16x32_bf16 v[208:211], v[92:95], v[56:59], v[208:211]
    v_cmp_gt_u32 vcc, 16, v2
    s_waitcnt lgkmcnt(0)
    s_nop 0
    v_cndmask_b32 v16, 0, v16, vcc
    v_cndmask_b32 v17, 0, v17, vcc
    v_cndmask_b32 v18, 0, v18, vcc
    v_cndmask_b32 v19, 0, v19, vcc
    v_cndmask_b32 v20, 0, v20, vcc
    v_cndmask_b32 v21, 0, v21, vcc
    v_cndmask_b32 v22, 0, v22, vcc
    v_cndmask_b32 v23, 0, v23, vcc
    v_mfma_f32_16x16x16_bf16 v[160:163], v[28:29], v[16:17], v[160:163]
    v_mfma_f32_16x16x16_bf16 v[164:167], v[28:29], v[18:19], v[164:167]
    v_mfma_f32_16x16x16_bf16 v[168:171], v[28:29], v[20:21], v[168:171]
    v_mfma_f32_16x16x16_bf16 v[172:175], v[28:29], v[22:23], v[172:175]
    v_mfma_f32_16x16x16_bf16 v[176:179], v[30:31], v[16:17], v[176:179]
    v_mfma_f32_16x16x16_bf16 v[180:183], v[30:31], v[18:19], v[180:183]
    v_mfma_f32_16x16x16_bf16 v[184:187], v[30:31], v[20:21], v[184:187]
    v_mfma_f32_16x16x16_bf16 v[188:191], v[30:31], v[22:23], v[188:191]
    v_mfma_f32_16x16x16_bf16 v[192:195], v[32:33], v[16:17], v[192:195]
    v_mfma_f32_16x16x16_bf16 v[196:199], v[32:33], v[18:19], v[196:199]
    v_mfma_f32_16x16x16_bf16 v[200:203], v[32:33], v[20:21], v[200:203]
    v_mfma_f32_16x16x16_bf16 v[204:207], v[32:33], v[22:23], v[204:207]
    v_mfma_f32_16x16x16_bf16 v[208:211], v[34:35], v[16:17], v[208:211]
    v_mfma_f32_16x16x16_bf16 v[212:215], v[34:35], v[18:19], v[212:215]
    v_mfma_f32_16x16x16_bf16 v[216:219], v[34:35], v[20:21], v[216:219]
    v_mfma_f32_16x16x16_bf16 v[220:223], v[34:35], v[22:23], v[220:223]
    v_mfma_f32_16x16x16_bf16 v[128:131], v[24:25], v[16:17], v[128:131]
    v_mfma_f32_16x16x16_bf16 v[132:135], v[24:25], v[18:19], v[132:135]
    v_mfma_f32_16x16x16_bf16 v[136:139], v[24:25], v[20:21], v[136:139]
    v_mfma_f32_16x16x16_bf16 v[140:143], v[24:25], v[22:23], v[140:143]
    v_mfma_f32_16x16x16_bf16 v[144:147], v[26:27], v[16:17], v[144:147]
    v_mfma_f32_16x16x16_bf16 v[148:151], v[26:27], v[18:19], v[148:151]
    v_mfma_f32_16x16x16_bf16 v[152:155], v[26:27], v[20:21], v[152:155]
    v_mfma_f32_16x16x16_bf16 v[156:159], v[26:27], v[22:23], v[156:159]
    v_mul_f32 v104, 0x3fb8aa3b, v40
    v_mul_f32 v106, 0x3fb8aa3b, v41
    v_mov_b32 v108, v36
    v_mov_b32 v110, v37
    v_mov_b32 v112, v38
    v_mov_b32 v114, v39
    v_lshlrev_b32 v116, 3, v9
    s_lshl_b32 s78, s72, 7
    buffer_load_dwordx2 v[32:33], v116, s[64:67], s78 offen offset:0
    buffer_load_dwordx2 v[34:35], v116, s[64:67], s78 offen offset:32
    buffer_load_dwordx2 v[36:37], v116, s[64:67], s78 offen offset:64
    buffer_load_dwordx2 v[38:39], v116, s[64:67], s78 offen offset:96
    v_and_b32 v14, 31, v2
    v_lshrrev_b32 v15, 5, v2
    s_lshl_b32 s78, s81, 14
    s_lshl_b32 s79, s80, 13
    s_add_u32 s78, s78, s79
    s_add_u32 s78, s78, 110592
    v_lshl_add_u32 v116, v14, 7, s78
    v_and_b32 v14, 7, v14
    v_xor_b32 v14, v14, v15
    v_xor_b32 v15, 0, v14
    v_lshl_add_u32 v10, v15, 4, v116
    v_xor_b32 v15, 2, v14
    v_lshl_add_u32 v11, v15, 4, v116
    v_xor_b32 v15, 4, v14
    v_lshl_add_u32 v12, v15, 4, v116
    v_xor_b32 v15, 6, v14
    v_lshl_add_u32 v13, v15, 4, v116
    s_add_u32 s79, s79, 143360
    v_lshl_add_u32 v116, v8, 7, s79
    s_lshl_b32 s78, s81, 2
    v_add_u32 v14, s78, v9
    v_and_b32 v15, 7, v8
    v_xor_b32 v14, v14, v15
    v_lshl_add_u32 v14, v14, 4, v116
    v_cvt_pk_bf16_f32 v44, v160, v161
    v_cvt_pk_bf16_f32 v45, v162, v163
    v_cvt_pk_bf16_f32 v46, v176, v177
    v_cvt_pk_bf16_f32 v47, v178, v179
    v_cvt_pk_bf16_f32 v48, v164, v165
    v_cvt_pk_bf16_f32 v49, v166, v167
    v_cvt_pk_bf16_f32 v50, v180, v181
    v_cvt_pk_bf16_f32 v51, v182, v183
    v_cvt_pk_bf16_f32 v52, v168, v169
    v_cvt_pk_bf16_f32 v53, v170, v171
    v_cvt_pk_bf16_f32 v54, v184, v185
    v_cvt_pk_bf16_f32 v55, v186, v187
    v_cvt_pk_bf16_f32 v56, v172, v173
    v_cvt_pk_bf16_f32 v57, v174, v175
    v_cvt_pk_bf16_f32 v58, v188, v189
    v_cvt_pk_bf16_f32 v59, v190, v191
    v_permlane16_swap_b32 v44, v48
    v_permlane16_swap_b32 v45, v49
    v_permlane16_swap_b32 v46, v50
    v_permlane16_swap_b32 v47, v51
    v_permlane16_swap_b32 v52, v56
    v_permlane16_swap_b32 v53, v57
    v_permlane16_swap_b32 v54, v58
    v_permlane16_swap_b32 v55, v59
    v_mfma_f32_32x32x16_bf16 v[60:75], v[96:99], v[44:47], 0
    v_mfma_f32_32x32x16_bf16 v[60:75], v[100:103], v[48:51], v[60:75]
    v_mfma_f32_32x32x16_bf16 v[76:91], v[96:99], v[52:55], 0
    v_mfma_f32_32x32x16_bf16 v[76:91], v[100:103], v[56:59], v[76:91]
    v_pk_mul_f32 v[192:193], v[192:193], v[108:109] op_sel_hi:[1,0]
    v_pk_mul_f32 v[194:195], v[194:195], v[108:109] op_sel_hi:[1,0]
    v_pk_mul_f32 v[208:209], v[208:209], v[108:109] op_sel_hi:[1,0]
    v_pk_mul_f32 v[210:211], v[210:211], v[108:109] op_sel_hi:[1,0]
    v_cvt_pk_bf16_f32 v16, v192, v193
    v_cvt_pk_bf16_f32 v17, v194, v195
    v_cvt_pk_bf16_f32 v18, v208, v209
    v_cvt_pk_bf16_f32 v19, v210, v211
    ds_write_b128 v14, v[16:19] offset:0
    v_pk_mul_f32 v[196:197], v[196:197], v[110:111] op_sel_hi:[1,0]
    v_pk_mul_f32 v[198:199], v[198:199], v[110:111] op_sel_hi:[1,0]
    v_pk_mul_f32 v[212:213], v[212:213], v[110:111] op_sel_hi:[1,0]
    v_pk_mul_f32 v[214:215], v[214:215], v[110:111] op_sel_hi:[1,0]
    v_cvt_pk_bf16_f32 v20, v196, v197
    v_cvt_pk_bf16_f32 v21, v198, v199
    v_cvt_pk_bf16_f32 v22, v212, v213
    v_cvt_pk_bf16_f32 v23, v214, v215
    ds_write_b128 v14, v[20:23] offset:2048
    v_pk_mul_f32 v[200:201], v[200:201], v[112:113] op_sel_hi:[1,0]
    v_pk_mul_f32 v[202:203], v[202:203], v[112:113] op_sel_hi:[1,0]
    v_pk_mul_f32 v[216:217], v[216:217], v[112:113] op_sel_hi:[1,0]
    v_pk_mul_f32 v[218:219], v[218:219], v[112:113] op_sel_hi:[1,0]
    v_cvt_pk_bf16_f32 v24, v200, v201
    v_cvt_pk_bf16_f32 v25, v202, v203
    v_cvt_pk_bf16_f32 v26, v216, v217
    v_cvt_pk_bf16_f32 v27, v218, v219
    ds_write_b128 v14, v[24:27] offset:4096
    v_pk_mul_f32 v[204:205], v[204:205], v[114:115] op_sel_hi:[1,0]
    v_pk_mul_f32 v[206:207], v[206:207], v[114:115] op_sel_hi:[1,0]
    v_pk_mul_f32 v[220:221], v[220:221], v[114:115] op_sel_hi:[1,0]
    v_pk_mul_f32 v[222:223], v[222:223], v[114:115] op_sel_hi:[1,0]
    v_cvt_pk_bf16_f32 v28, v204, v205
    v_cvt_pk_bf16_f32 v29, v206, v207
    v_cvt_pk_bf16_f32 v30, v220, v221
    v_cvt_pk_bf16_f32 v31, v222, v223
    ds_write_b128 v14, v[28:31] offset:6144
    v_max3_f32 v116, v60, v61, v62
    v_max3_f32 v118, -v60, -v61, -v62
    v_max3_f32 v116, v116, v63, v64
    v_max3_f32 v118, v118, -v63, -v64
    v_max3_f32 v116, v116, v65, v66
    v_max3_f32 v118, v118, -v65, -v66
    v_max3_f32 v116, v116, v67, v68
    v_max3_f32 v118, v118, -v67, -v68
    v_max3_f32 v116, v116, v69, v70
    v_max3_f32 v118, v118, -v69, -v70
    v_max3_f32 v116, v116, v71, v72
    v_max3_f32 v118, v118, -v71, -v72
    v_max3_f32 v116, v116, v73, v74
    v_max3_f32 v118, v118, -v73, -v74
    v_max_f32 v116, v116, v75
    v_max_f32 v118, v118, -v75
    s_nop 1
    v_permlane32_swap_b32 v116, v118
    v_max_f32 v116, v116, v118
    v_mul_f32 v116, -v116, v104
    v_mov_b32 v118, v116
    s_nop 1
    v_permlane32_swap_b32 v116, v118
    v_pk_fma_f32 v[224:225], v[60:61], v[104:105], v[116:117] op_sel_hi:[1,0,0]
    v_pk_fma_f32 v[226:227], v[62:63], v[104:105], v[116:117] op_sel_hi:[1,0,0]
    v_pk_fma_f32 v[228:229], v[64:65], v[104:105], v[116:117] op_sel_hi:[1,0,0]
    v_pk_fma_f32 v[230:231], v[66:67], v[104:105], v[116:117] op_sel_hi:[1,0,0]
    v_pk_fma_f32 v[232:233], v[68:69], v[104:105], v[116:117] op_sel_hi:[1,0,0]
    v_pk_fma_f32 v[234:235], v[70:71], v[104:105], v[116:117] op_sel_hi:[1,0,0]
    v_pk_fma_f32 v[236:237], v[72:73], v[104:105], v[116:117] op_sel_hi:[1,0,0]
    v_pk_fma_f32 v[238:239], v[74:75], v[104:105], v[116:117] op_sel_hi:[1,0,0]
    v_pk_fma_f32 v[240:241], v[60:61], v[104:105], v[118:119] op_sel_hi:[1,0,0] neg_lo:[1,0,0] neg_hi:[1,0,0]
    v_pk_fma_f32 v[242:243], v[62:63], v[104:105], v[118:119] op_sel_hi:[1,0,0] neg_lo:[1,0,0] neg_hi:[1,0,0]
    v_pk_fma_f32 v[244:245], v[64:65], v[104:105], v[118:119] op_sel_hi:[1,0,0] neg_lo:[1,0,0] neg_hi:[1,0,0]
    v_pk_fma_f32 v[246:247], v[66:67], v[104:105], v[118:119] op_sel_hi:[1,0,0] neg_lo:[1,0,0] neg_hi:[1,0,0]
    v_pk_fma_f32 v[248:249], v[68:69], v[104:105], v[118:119] op_sel_hi:[1,0,0] neg_lo:[1,0,0] neg_hi:[1,0,0]
    v_pk_fma_f32 v[250:251], v[70:71], v[104:105], v[118:119] op_sel_hi:[1,0,0] neg_lo:[1,0,0] neg_hi:[1,0,0]
    v_pk_fma_f32 v[252:253], v[72:73], v[104:105], v[118:119] op_sel_hi:[1,0,0] neg_lo:[1,0,0] neg_hi:[1,0,0]
    v_pk_fma_f32 v[254:255], v[74:75], v[104:105], v[118:119] op_sel_hi:[1,0,0] neg_lo:[1,0,0] neg_hi:[1,0,0]
    v_exp_f32 v224, v224
    v_exp_f32 v225, v225
    v_exp_f32 v226, v226
    v_exp_f32 v227, v227
    v_exp_f32 v228, v228
    v_exp_f32 v229, v229
    v_exp_f32 v230, v230
    v_exp_f32 v231, v231
    v_exp_f32 v232, v232
    v_exp_f32 v233, v233
    v_exp_f32 v234, v234
    v_exp_f32 v235, v235
    v_exp_f32 v236, v236
    v_exp_f32 v237, v237
    v_exp_f32 v238, v238
    v_exp_f32 v239, v239
    v_exp_f32 v240, v240
    v_exp_f32 v241, v241
    v_exp_f32 v242, v242
    v_exp_f32 v243, v243
    v_exp_f32 v244, v244
    v_exp_f32 v245, v245
    v_exp_f32 v246, v246
    v_exp_f32 v247, v247
    v_exp_f32 v248, v248
    v_exp_f32 v249, v249
    v_exp_f32 v250, v250
    v_exp_f32 v251, v251
    v_exp_f32 v252, v252
    v_exp_f32 v253, v253
    v_exp_f32 v254, v254
    v_exp_f32 v255, v255
    v_pk_add_f32 v[120:121], v[224:225], v[226:227]
    v_pk_add_f32 v[120:121], v[120:121], v[228:229]
    v_pk_add_f32 v[120:121], v[120:121], v[230:231]
    v_pk_add_f32 v[120:121], v[120:121], v[232:233]
    v_pk_add_f32 v[120:121], v[120:121], v[234:235]
    v_pk_add_f32 v[120:121], v[120:121], v[236:237]
    v_pk_add_f32 v[120:121], v[120:121], v[238:239]
    v_pk_add_f32 v[122:123], v[240:241], v[242:243]
    v_pk_add_f32 v[122:123], v[122:123], v[244:245]
    v_pk_add_f32 v[122:123], v[122:123], v[246:247]
    v_pk_add_f32 v[122:123], v[122:123], v[248:249]
    v_pk_add_f32 v[122:123], v[122:123], v[250:251]
    v_pk_add_f32 v[122:123], v[122:123], v[252:253]
    v_pk_add_f32 v[122:123], v[122:123], v[254:255]
    v_add_f32 v120, v120, v121
    v_add_f32 v122, v122, v123
    s_nop 1
    v_permlane32_swap_b32 v120, v122
    v_add_f32 v120, v120, v122
    v_rcp_f32 v120, v120
    s_nop 0
    v_mov_b32 v122, v120
    s_nop 1
    v_permlane32_swap_b32 v120, v122
    v_pk_mul_f32 v[224:225], v[224:225], v[120:121] op_sel_hi:[1,0]
    v_pk_mul_f32 v[226:227], v[226:227], v[120:121] op_sel_hi:[1,0]
    v_pk_mul_f32 v[228:229], v[228:229], v[120:121] op_sel_hi:[1,0]
    v_pk_mul_f32 v[230:231], v[230:231], v[120:121] op_sel_hi:[1,0]
    v_cvt_pk_bf16_f32 v192, v224, v225
    v_cvt_pk_bf16_f32 v193, v226, v227
    v_cvt_pk_bf16_f32 v194, v228, v229
    v_cvt_pk_bf16_f32 v195, v230, v231
    ds_write_b128 v10, v[192:195] offset:0
    v_pk_mul_f32 v[232:233], v[232:233], v[120:121] op_sel_hi:[1,0]
    v_pk_mul_f32 v[234:235], v[234:235], v[120:121] op_sel_hi:[1,0]
    v_pk_mul_f32 v[236:237], v[236:237], v[120:121] op_sel_hi:[1,0]
    v_pk_mul_f32 v[238:239], v[238:239], v[120:121] op_sel_hi:[1,0]
    v_cvt_pk_bf16_f32 v196, v232, v233
    v_cvt_pk_bf16_f32 v197, v234, v235
    v_cvt_pk_bf16_f32 v198, v236, v237
    v_cvt_pk_bf16_f32 v199, v238, v239
    ds_write_b128 v11, v[196:199] offset:0
    v_pk_mul_f32 v[240:241], v[240:241], v[122:123] op_sel_hi:[1,0]
    v_pk_mul_f32 v[242:243], v[242:243], v[122:123] op_sel_hi:[1,0]
    v_pk_mul_f32 v[244:245], v[244:245], v[122:123] op_sel_hi:[1,0]
    v_pk_mul_f32 v[246:247], v[246:247], v[122:123] op_sel_hi:[1,0]
    v_cvt_pk_bf16_f32 v200, v240, v241
    v_cvt_pk_bf16_f32 v201, v242, v243
    v_cvt_pk_bf16_f32 v202, v244, v245
    v_cvt_pk_bf16_f32 v203, v246, v247
    ds_write_b128 v12, v[200:203] offset:0
    v_pk_mul_f32 v[248:249], v[248:249], v[122:123] op_sel_hi:[1,0]
    v_pk_mul_f32 v[250:251], v[250:251], v[122:123] op_sel_hi:[1,0]
    v_pk_mul_f32 v[252:253], v[252:253], v[122:123] op_sel_hi:[1,0]
    v_pk_mul_f32 v[254:255], v[254:255], v[122:123] op_sel_hi:[1,0]
    v_cvt_pk_bf16_f32 v204, v248, v249
    v_cvt_pk_bf16_f32 v205, v250, v251
    v_cvt_pk_bf16_f32 v206, v252, v253
    v_cvt_pk_bf16_f32 v207, v254, v255
    ds_write_b128 v13, v[204:207] offset:0
    v_max3_f32 v116, v76, v77, v78
    v_max3_f32 v118, -v76, -v77, -v78
    v_max3_f32 v116, v116, v79, v80
    v_max3_f32 v118, v118, -v79, -v80
    v_max3_f32 v116, v116, v81, v82
    v_max3_f32 v118, v118, -v81, -v82
    v_max3_f32 v116, v116, v83, v84
    v_max3_f32 v118, v118, -v83, -v84
    v_max3_f32 v116, v116, v85, v86
    v_max3_f32 v118, v118, -v85, -v86
    v_max3_f32 v116, v116, v87, v88
    v_max3_f32 v118, v118, -v87, -v88
    v_max3_f32 v116, v116, v89, v90
    v_max3_f32 v118, v118, -v89, -v90
    v_max_f32 v116, v116, v91
    v_max_f32 v118, v118, -v91
    s_nop 1
    v_permlane32_swap_b32 v116, v118
    v_max_f32 v116, v116, v118
    v_mul_f32 v116, -v116, v106
    v_mov_b32 v118, v116
    s_nop 1
    v_permlane32_swap_b32 v116, v118
    v_pk_fma_f32 v[224:225], v[76:77], v[106:107], v[116:117] op_sel_hi:[1,0,0]
    v_pk_fma_f32 v[226:227], v[78:79], v[106:107], v[116:117] op_sel_hi:[1,0,0]
    v_pk_fma_f32 v[228:229], v[80:81], v[106:107], v[116:117] op_sel_hi:[1,0,0]
    v_pk_fma_f32 v[230:231], v[82:83], v[106:107], v[116:117] op_sel_hi:[1,0,0]
    v_pk_fma_f32 v[232:233], v[84:85], v[106:107], v[116:117] op_sel_hi:[1,0,0]
    v_pk_fma_f32 v[234:235], v[86:87], v[106:107], v[116:117] op_sel_hi:[1,0,0]
    v_pk_fma_f32 v[236:237], v[88:89], v[106:107], v[116:117] op_sel_hi:[1,0,0]
    v_pk_fma_f32 v[238:239], v[90:91], v[106:107], v[116:117] op_sel_hi:[1,0,0]
    v_pk_fma_f32 v[240:241], v[76:77], v[106:107], v[118:119] op_sel_hi:[1,0,0] neg_lo:[1,0,0] neg_hi:[1,0,0]
    v_pk_fma_f32 v[242:243], v[78:79], v[106:107], v[118:119] op_sel_hi:[1,0,0] neg_lo:[1,0,0] neg_hi:[1,0,0]
    v_pk_fma_f32 v[244:245], v[80:81], v[106:107], v[118:119] op_sel_hi:[1,0,0] neg_lo:[1,0,0] neg_hi:[1,0,0]
    v_pk_fma_f32 v[246:247], v[82:83], v[106:107], v[118:119] op_sel_hi:[1,0,0] neg_lo:[1,0,0] neg_hi:[1,0,0]
    v_pk_fma_f32 v[248:249], v[84:85], v[106:107], v[118:119] op_sel_hi:[1,0,0] neg_lo:[1,0,0] neg_hi:[1,0,0]
    v_pk_fma_f32 v[250:251], v[86:87], v[106:107], v[118:119] op_sel_hi:[1,0,0] neg_lo:[1,0,0] neg_hi:[1,0,0]
    v_pk_fma_f32 v[252:253], v[88:89], v[106:107], v[118:119] op_sel_hi:[1,0,0] neg_lo:[1,0,0] neg_hi:[1,0,0]
    v_pk_fma_f32 v[254:255], v[90:91], v[106:107], v[118:119] op_sel_hi:[1,0,0] neg_lo:[1,0,0] neg_hi:[1,0,0]
    v_exp_f32 v224, v224
    v_exp_f32 v225, v225
    v_exp_f32 v226, v226
    v_exp_f32 v227, v227
    v_exp_f32 v228, v228
    v_exp_f32 v229, v229
    v_exp_f32 v230, v230
    v_exp_f32 v231, v231
    v_exp_f32 v232, v232
    v_exp_f32 v233, v233
    v_exp_f32 v234, v234
    v_exp_f32 v235, v235
    v_exp_f32 v236, v236
    v_exp_f32 v237, v237
    v_exp_f32 v238, v238
    v_exp_f32 v239, v239
    v_exp_f32 v240, v240
    v_exp_f32 v241, v241
    v_exp_f32 v242, v242
    v_exp_f32 v243, v243
    v_exp_f32 v244, v244
    v_exp_f32 v245, v245
    v_exp_f32 v246, v246
    v_exp_f32 v247, v247
    v_exp_f32 v248, v248
    v_exp_f32 v249, v249
    v_exp_f32 v250, v250
    v_exp_f32 v251, v251
    v_exp_f32 v252, v252
    v_exp_f32 v253, v253
    v_exp_f32 v254, v254
    v_exp_f32 v255, v255
    v_pk_add_f32 v[120:121], v[224:225], v[226:227]
    v_pk_add_f32 v[120:121], v[120:121], v[228:229]
    v_pk_add_f32 v[120:121], v[120:121], v[230:231]
    v_pk_add_f32 v[120:121], v[120:121], v[232:233]
    v_pk_add_f32 v[120:121], v[120:121], v[234:235]
    v_pk_add_f32 v[120:121], v[120:121], v[236:237]
    v_pk_add_f32 v[120:121], v[120:121], v[238:239]
    v_pk_add_f32 v[122:123], v[240:241], v[242:243]
    v_pk_add_f32 v[122:123], v[122:123], v[244:245]
    v_pk_add_f32 v[122:123], v[122:123], v[246:247]
    v_pk_add_f32 v[122:123], v[122:123], v[248:249]
    v_pk_add_f32 v[122:123], v[122:123], v[250:251]
    v_pk_add_f32 v[122:123], v[122:123], v[252:253]
    v_pk_add_f32 v[122:123], v[122:123], v[254:255]
    v_add_f32 v120, v120, v121
    v_add_f32 v122, v122, v123
    s_nop 1
    v_permlane32_swap_b32 v120, v122
    v_add_f32 v120, v120, v122
    v_rcp_f32 v120, v120
    s_nop 0
    v_mov_b32 v122, v120
    s_nop 1
    v_permlane32_swap_b32 v120, v122
    v_pk_mul_f32 v[224:225], v[224:225], v[120:121] op_sel_hi:[1,0]
    v_pk_mul_f32 v[226:227], v[226:227], v[120:121] op_sel_hi:[1,0]
    v_pk_mul_f32 v[228:229], v[228:229], v[120:121] op_sel_hi:[1,0]
    v_pk_mul_f32 v[230:231], v[230:231], v[120:121] op_sel_hi:[1,0]
    v_cvt_pk_bf16_f32 v208, v224, v225
    v_cvt_pk_bf16_f32 v209, v226, v227
    v_cvt_pk_bf16_f32 v210, v228, v229
    v_cvt_pk_bf16_f32 v211, v230, v231
    ds_write_b128 v10, v[208:211] offset:4096
    v_pk_mul_f32 v[232:233], v[232:233], v[120:121] op_sel_hi:[1,0]
    v_pk_mul_f32 v[234:235], v[234:235], v[120:121] op_sel_hi:[1,0]
    v_pk_mul_f32 v[236:237], v[236:237], v[120:121] op_sel_hi:[1,0]
    v_pk_mul_f32 v[238:239], v[238:239], v[120:121] op_sel_hi:[1,0]
    v_cvt_pk_bf16_f32 v212, v232, v233
    v_cvt_pk_bf16_f32 v213, v234, v235
    v_cvt_pk_bf16_f32 v214, v236, v237
    v_cvt_pk_bf16_f32 v215, v238, v239
    ds_write_b128 v11, v[212:215] offset:4096
    v_pk_mul_f32 v[240:241], v[240:241], v[122:123] op_sel_hi:[1,0]
    v_pk_mul_f32 v[242:243], v[242:243], v[122:123] op_sel_hi:[1,0]
    v_pk_mul_f32 v[244:245], v[244:245], v[122:123] op_sel_hi:[1,0]
    v_pk_mul_f32 v[246:247], v[246:247], v[122:123] op_sel_hi:[1,0]
    v_cvt_pk_bf16_f32 v216, v240, v241
    v_cvt_pk_bf16_f32 v217, v242, v243
    v_cvt_pk_bf16_f32 v218, v244, v245
    v_cvt_pk_bf16_f32 v219, v246, v247
    ds_write_b128 v12, v[216:219] offset:4096
    v_pk_mul_f32 v[248:249], v[248:249], v[122:123] op_sel_hi:[1,0]
    v_pk_mul_f32 v[250:251], v[250:251], v[122:123] op_sel_hi:[1,0]
    v_pk_mul_f32 v[252:253], v[252:253], v[122:123] op_sel_hi:[1,0]
    v_pk_mul_f32 v[254:255], v[254:255], v[122:123] op_sel_hi:[1,0]
    v_cvt_pk_bf16_f32 v220, v248, v249
    v_cvt_pk_bf16_f32 v221, v250, v251
    v_cvt_pk_bf16_f32 v222, v252, v253
    v_cvt_pk_bf16_f32 v223, v254, v255
    ds_write_b128 v13, v[220:223] offset:4096
    s_waitcnt lgkmcnt(0)
    s_barrier
    v_cvt_pk_bf16_f32 v44, v128, v129
    v_cvt_pk_bf16_f32 v45, v130, v131
    v_cvt_pk_bf16_f32 v46, v144, v145
    v_cvt_pk_bf16_f32 v47, v146, v147
    v_cvt_pk_bf16_f32 v48, v132, v133
    v_cvt_pk_bf16_f32 v49, v134, v135
    v_cvt_pk_bf16_f32 v50, v148, v149
    v_cvt_pk_bf16_f32 v51, v150, v151
    v_cvt_pk_bf16_f32 v52, v136, v137
    v_cvt_pk_bf16_f32 v53, v138, v139
    v_cvt_pk_bf16_f32 v54, v152, v153
    v_cvt_pk_bf16_f32 v55, v154, v155
    v_cvt_pk_bf16_f32 v56, v140, v141
    v_cvt_pk_bf16_f32 v57, v142, v143
    v_cvt_pk_bf16_f32 v58, v156, v157
    v_cvt_pk_bf16_f32 v59, v158, v159
    v_permlane16_swap_b32 v44, v48
    v_permlane16_swap_b32 v45, v49
    v_permlane16_swap_b32 v46, v50
    v_permlane16_swap_b32 v47, v51
    v_permlane16_swap_b32 v52, v56
    v_permlane16_swap_b32 v53, v57
    v_permlane16_swap_b32 v54, v58
    v_permlane16_swap_b32 v55, v59
    v_mfma_f32_32x32x16_bf16 v[60:75], v[96:99], v[44:47], 0
    v_mfma_f32_32x32x16_bf16 v[60:75], v[100:103], v[48:51], v[60:75]
    v_mfma_f32_32x32x16_bf16 v[76:91], v[96:99], v[52:55], 0
    v_mfma_f32_32x32x16_bf16 v[76:91], v[100:103], v[56:59], v[76:91]
    v_lshrrev_b32 v10, 5, v2
    s_lshl_b32 s78, s81, 7
    s_add_u32 s78, s78, 162944
    v_lshl_add_u32 v10, v10, 4, s78
    v_lshrrev_b32 v11, 5, v2
    v_and_b32 v12, 31, v2
    v_lshlrev_b32 v12, 4, v12
    v_lshl_add_u32 v11, v11, 10, v12
    v_bfe_u32 v12, v2, 4, 1
    v_lshlrev_b32 v12, 15, v12
    v_lshrrev_b32 v13, 5, v2
    v_lshl_add_u32 v12, v13, 8, v12
    v_lshl_add_u32 v12, v8, 4, v12
    v_max3_f32 v116, v60, v61, v62
    v_max3_f32 v118, -v60, -v61, -v62
    v_max3_f32 v116, v116, v63, v64
    v_max3_f32 v118, v118, -v63, -v64
    v_max3_f32 v116, v116, v65, v66
    v_max3_f32 v118, v118, -v65, -v66
    v_max3_f32 v116, v116, v67, v68
    v_max3_f32 v118, v118, -v67, -v68
    v_max3_f32 v116, v116, v69, v70
    v_max3_f32 v118, v118, -v69, -v70
    v_max3_f32 v116, v116, v71, v72
    v_max3_f32 v118, v118, -v71, -v72
    v_max3_f32 v116, v116, v73, v74
    v_max3_f32 v118, v118, -v73, -v74
    v_max_f32 v116, v116, v75
    v_max_f32 v118, v118, -v75
    s_nop 1
    v_permlane32_swap_b32 v116, v118
    v_max_f32 v116, v116, v118
    v_mul_f32 v116, -v116, v104
    v_mov_b32 v118, v116
    s_nop 1
    v_permlane32_swap_b32 v116, v118
    v_pk_fma_f32 v[160:161], v[60:61], v[104:105], v[116:117] op_sel_hi:[1,0,0]
    v_pk_fma_f32 v[162:163], v[62:63], v[104:105], v[116:117] op_sel_hi:[1,0,0]
    v_pk_fma_f32 v[164:165], v[64:65], v[104:105], v[116:117] op_sel_hi:[1,0,0]
    v_pk_fma_f32 v[166:167], v[66:67], v[104:105], v[116:117] op_sel_hi:[1,0,0]
    v_pk_fma_f32 v[168:169], v[68:69], v[104:105], v[116:117] op_sel_hi:[1,0,0]
    v_pk_fma_f32 v[170:171], v[70:71], v[104:105], v[116:117] op_sel_hi:[1,0,0]
    v_pk_fma_f32 v[172:173], v[72:73], v[104:105], v[116:117] op_sel_hi:[1,0,0]
    v_pk_fma_f32 v[174:175], v[74:75], v[104:105], v[116:117] op_sel_hi:[1,0,0]
    v_pk_fma_f32 v[176:177], v[60:61], v[104:105], v[118:119] op_sel_hi:[1,0,0] neg_lo:[1,0,0] neg_hi:[1,0,0]
    v_pk_fma_f32 v[178:179], v[62:63], v[104:105], v[118:119] op_sel_hi:[1,0,0] neg_lo:[1,0,0] neg_hi:[1,0,0]
    v_pk_fma_f32 v[180:181], v[64:65], v[104:105], v[118:119] op_sel_hi:[1,0,0] neg_lo:[1,0,0] neg_hi:[1,0,0]
    v_pk_fma_f32 v[182:183], v[66:67], v[104:105], v[118:119] op_sel_hi:[1,0,0] neg_lo:[1,0,0] neg_hi:[1,0,0]
    v_pk_fma_f32 v[184:185], v[68:69], v[104:105], v[118:119] op_sel_hi:[1,0,0] neg_lo:[1,0,0] neg_hi:[1,0,0]
    v_pk_fma_f32 v[186:187], v[70:71], v[104:105], v[118:119] op_sel_hi:[1,0,0] neg_lo:[1,0,0] neg_hi:[1,0,0]
    v_pk_fma_f32 v[188:189], v[72:73], v[104:105], v[118:119] op_sel_hi:[1,0,0] neg_lo:[1,0,0] neg_hi:[1,0,0]
    v_pk_fma_f32 v[190:191], v[74:75], v[104:105], v[118:119] op_sel_hi:[1,0,0] neg_lo:[1,0,0] neg_hi:[1,0,0]
    v_exp_f32 v160, v160
    v_exp_f32 v161, v161
    v_exp_f32 v162, v162
    v_exp_f32 v163, v163
    v_exp_f32 v164, v164
    v_exp_f32 v165, v165
    v_exp_f32 v166, v166
    v_exp_f32 v167, v167
    v_exp_f32 v168, v168
    v_exp_f32 v169, v169
    v_exp_f32 v170, v170
    v_exp_f32 v171, v171
    v_exp_f32 v172, v172
    v_exp_f32 v173, v173
    v_exp_f32 v174, v174
    v_exp_f32 v175, v175
    v_exp_f32 v176, v176
    v_exp_f32 v177, v177
    v_exp_f32 v178, v178
    v_exp_f32 v179, v179
    v_exp_f32 v180, v180
    v_exp_f32 v181, v181
    v_exp_f32 v182, v182
    v_exp_f32 v183, v183
    v_exp_f32 v184, v184
    v_exp_f32 v185, v185
    v_exp_f32 v186, v186
    v_exp_f32 v187, v187
    v_exp_f32 v188, v188
    v_exp_f32 v189, v189
    v_exp_f32 v190, v190
    v_exp_f32 v191, v191
    v_cvt_pk_bf16_f32 v128, v160, v161
    v_cvt_pk_bf16_f32 v129, v162, v163
    v_cvt_pk_bf16_f32 v130, v164, v165
    v_cvt_pk_bf16_f32 v131, v166, v167
    v_cvt_pk_bf16_f32 v132, v168, v169
    v_cvt_pk_bf16_f32 v133, v170, v171
    v_cvt_pk_bf16_f32 v134, v172, v173
    v_cvt_pk_bf16_f32 v135, v174, v175
    v_cvt_pk_bf16_f32 v136, v176, v177
    v_cvt_pk_bf16_f32 v137, v178, v179
    v_cvt_pk_bf16_f32 v138, v180, v181
    v_cvt_pk_bf16_f32 v139, v182, v183
    v_cvt_pk_bf16_f32 v140, v184, v185
    v_cvt_pk_bf16_f32 v141, v186, v187
    v_cvt_pk_bf16_f32 v142, v188, v189
    v_cvt_pk_bf16_f32 v143, v190, v191
    v_max3_f32 v116, v76, v77, v78
    v_max3_f32 v118, -v76, -v77, -v78
    v_max3_f32 v116, v116, v79, v80
    v_max3_f32 v118, v118, -v79, -v80
    v_max3_f32 v116, v116, v81, v82
    v_max3_f32 v118, v118, -v81, -v82
    v_max3_f32 v116, v116, v83, v84
    v_max3_f32 v118, v118, -v83, -v84
    v_max3_f32 v116, v116, v85, v86
    v_max3_f32 v118, v118, -v85, -v86
    v_max3_f32 v116, v116, v87, v88
    v_max3_f32 v118, v118, -v87, -v88
    v_max3_f32 v116, v116, v89, v90
    v_max3_f32 v118, v118, -v89, -v90
    v_max_f32 v116, v116, v91
    v_max_f32 v118, v118, -v91
    s_nop 1
    v_permlane32_swap_b32 v116, v118
    v_max_f32 v116, v116, v118
    v_mul_f32 v116, -v116, v106
    v_mov_b32 v118, v116
    s_nop 1
    v_permlane32_swap_b32 v116, v118
    v_pk_fma_f32 v[192:193], v[76:77], v[106:107], v[116:117] op_sel_hi:[1,0,0]
    v_pk_fma_f32 v[194:195], v[78:79], v[106:107], v[116:117] op_sel_hi:[1,0,0]
    v_pk_fma_f32 v[196:197], v[80:81], v[106:107], v[116:117] op_sel_hi:[1,0,0]
    v_pk_fma_f32 v[198:199], v[82:83], v[106:107], v[116:117] op_sel_hi:[1,0,0]
    v_pk_fma_f32 v[200:201], v[84:85], v[106:107], v[116:117] op_sel_hi:[1,0,0]
    v_pk_fma_f32 v[202:203], v[86:87], v[106:107], v[116:117] op_sel_hi:[1,0,0]
    v_pk_fma_f32 v[204:205], v[88:89], v[106:107], v[116:117] op_sel_hi:[1,0,0]
    v_pk_fma_f32 v[206:207], v[90:91], v[106:107], v[116:117] op_sel_hi:[1,0,0]
    v_pk_fma_f32 v[208:209], v[76:77], v[106:107], v[118:119] op_sel_hi:[1,0,0] neg_lo:[1,0,0] neg_hi:[1,0,0]
    v_pk_fma_f32 v[210:211], v[78:79], v[106:107], v[118:119] op_sel_hi:[1,0,0] neg_lo:[1,0,0] neg_hi:[1,0,0]
    v_pk_fma_f32 v[212:213], v[80:81], v[106:107], v[118:119] op_sel_hi:[1,0,0] neg_lo:[1,0,0] neg_hi:[1,0,0]
    v_pk_fma_f32 v[214:215], v[82:83], v[106:107], v[118:119] op_sel_hi:[1,0,0] neg_lo:[1,0,0] neg_hi:[1,0,0]
    v_pk_fma_f32 v[216:217], v[84:85], v[106:107], v[118:119] op_sel_hi:[1,0,0] neg_lo:[1,0,0] neg_hi:[1,0,0]
    v_pk_fma_f32 v[218:219], v[86:87], v[106:107], v[118:119] op_sel_hi:[1,0,0] neg_lo:[1,0,0] neg_hi:[1,0,0]
    v_pk_fma_f32 v[220:221], v[88:89], v[106:107], v[118:119] op_sel_hi:[1,0,0] neg_lo:[1,0,0] neg_hi:[1,0,0]
    v_pk_fma_f32 v[222:223], v[90:91], v[106:107], v[118:119] op_sel_hi:[1,0,0] neg_lo:[1,0,0] neg_hi:[1,0,0]
    v_exp_f32 v192, v192
    v_exp_f32 v193, v193
    v_exp_f32 v194, v194
    v_exp_f32 v195, v195
    v_exp_f32 v196, v196
    v_exp_f32 v197, v197
    v_exp_f32 v198, v198
    v_exp_f32 v199, v199
    v_exp_f32 v200, v200
    v_exp_f32 v201, v201
    v_exp_f32 v202, v202
    v_exp_f32 v203, v203
    v_exp_f32 v204, v204
    v_exp_f32 v205, v205
    v_exp_f32 v206, v206
    v_exp_f32 v207, v207
    v_exp_f32 v208, v208
    v_exp_f32 v209, v209
    v_exp_f32 v210, v210
    v_exp_f32 v211, v211
    v_exp_f32 v212, v212
    v_exp_f32 v213, v213
    v_exp_f32 v214, v214
    v_exp_f32 v215, v215
    v_exp_f32 v216, v216
    v_exp_f32 v217, v217
    v_exp_f32 v218, v218
    v_exp_f32 v219, v219
    v_exp_f32 v220, v220
    v_exp_f32 v221, v221
    v_exp_f32 v222, v222
    v_exp_f32 v223, v223
    v_cvt_pk_bf16_f32 v144, v192, v193
    v_cvt_pk_bf16_f32 v145, v194, v195
    v_cvt_pk_bf16_f32 v146, v196, v197
    v_cvt_pk_bf16_f32 v147, v198, v199
    v_cvt_pk_bf16_f32 v148, v200, v201
    v_cvt_pk_bf16_f32 v149, v202, v203
    v_cvt_pk_bf16_f32 v150, v204, v205
    v_cvt_pk_bf16_f32 v151, v206, v207
    v_cvt_pk_bf16_f32 v152, v208, v209
    v_cvt_pk_bf16_f32 v153, v210, v211
    v_cvt_pk_bf16_f32 v154, v212, v213
    v_cvt_pk_bf16_f32 v155, v214, v215
    v_cvt_pk_bf16_f32 v156, v216, v217
    v_cvt_pk_bf16_f32 v157, v218, v219
    v_cvt_pk_bf16_f32 v158, v220, v221
    v_cvt_pk_bf16_f32 v159, v222, v223
    s_barrier
    ds_read_b128 v[16:19], v10 offset:0
    ds_read_b128 v[20:23], v10 offset:32
    ds_read_b128 v[24:27], v10 offset:64
    ds_read_b128 v[28:31], v10 offset:96
    v_and_b32 v13, 1, v2
    v_cmp_eq_u32 vcc, 1, v13
    v_mov_b32 v13, 0x3f803f80
    s_waitcnt lgkmcnt(0)
    v_cndmask_b32 v16, v16, v13, vcc
    v_cndmask_b32 v17, v17, v13, vcc
    v_cndmask_b32 v18, v18, v13, vcc
    v_cndmask_b32 v19, v19, v13, vcc
    v_cndmask_b32 v20, v20, v13, vcc
    v_cndmask_b32 v21, v21, v13, vcc
    v_cndmask_b32 v22, v22, v13, vcc
    v_cndmask_b32 v23, v23, v13, vcc
    v_cndmask_b32 v24, v24, v13, vcc
    v_cndmask_b32 v25, v25, v13, vcc
    v_cndmask_b32 v26, v26, v13, vcc
    v_cndmask_b32 v27, v27, v13, vcc
    v_cndmask_b32 v28, v28, v13, vcc
    v_cndmask_b32 v29, v29, v13, vcc
    v_cndmask_b32 v30, v30, v13, vcc
    v_cndmask_b32 v31, v31, v13, vcc
    v_mfma_f32_32x32x16_bf16 v[60:75], v[16:19], v[128:131], 0
    v_mfma_f32_32x32x16_bf16 v[60:75], v[20:23], v[132:135], v[60:75]
    v_mfma_f32_32x32x16_bf16 v[76:91], v[24:27], v[136:139], 0
    v_mfma_f32_32x32x16_bf16 v[76:91], v[28:31], v[140:143], v[76:91]
    v_mfma_f32_32x32x16_bf16 v[224:239], v[16:19], v[144:147], 0
    v_mfma_f32_32x32x16_bf16 v[224:239], v[20:23], v[148:151], v[224:239]
    v_mfma_f32_32x32x16_bf16 v[240:255], v[24:27], v[152:155], 0
    v_mfma_f32_32x32x16_bf16 v[240:255], v[28:31], v[156:159], v[240:255]
    s_nop 5
    v_rcp_f32 v116, v61
    s_nop 0
    v_rcp_f32 v118, v77
    v_mov_b32 v120, 0x358637bd
    v_fmac_f32 v120, v60, v116
    v_fmac_f32 v120, v76, v118
    v_rcp_f32 v120, v120
    s_nop 0
    v_mul_f32 v116, v116, v120
    v_mul_f32 v118, v118, v120
    v_pk_mul_f32 v[160:161], v[160:161], v[116:117] op_sel_hi:[1,0]
    v_pk_mul_f32 v[162:163], v[162:163], v[116:117] op_sel_hi:[1,0]
    v_pk_mul_f32 v[164:165], v[164:165], v[116:117] op_sel_hi:[1,0]
    v_pk_mul_f32 v[166:167], v[166:167], v[116:117] op_sel_hi:[1,0]
    v_pk_mul_f32 v[168:169], v[168:169], v[116:117] op_sel_hi:[1,0]
    v_pk_mul_f32 v[170:171], v[170:171], v[116:117] op_sel_hi:[1,0]
    v_pk_mul_f32 v[172:173], v[172:173], v[116:117] op_sel_hi:[1,0]
    v_pk_mul_f32 v[174:175], v[174:175], v[116:117] op_sel_hi:[1,0]
    v_pk_mul_f32 v[176:177], v[176:177], v[118:119] op_sel_hi:[1,0]
    v_pk_mul_f32 v[178:179], v[178:179], v[118:119] op_sel_hi:[1,0]
    v_pk_mul_f32 v[180:181], v[180:181], v[118:119] op_sel_hi:[1,0]
    v_pk_mul_f32 v[182:183], v[182:183], v[118:119] op_sel_hi:[1,0]
    v_pk_mul_f32 v[184:185], v[184:185], v[118:119] op_sel_hi:[1,0]
    v_pk_mul_f32 v[186:187], v[186:187], v[118:119] op_sel_hi:[1,0]
    v_pk_mul_f32 v[188:189], v[188:189], v[118:119] op_sel_hi:[1,0]
    v_pk_mul_f32 v[190:191], v[190:191], v[118:119] op_sel_hi:[1,0]
    v_cvt_pk_bf16_f32 v128, v160, v161
    v_cvt_pk_bf16_f32 v129, v162, v163
    v_cvt_pk_bf16_f32 v130, v164, v165
    v_cvt_pk_bf16_f32 v131, v166, v167
    v_cvt_pk_bf16_f32 v132, v168, v169
    v_cvt_pk_bf16_f32 v133, v170, v171
    v_cvt_pk_bf16_f32 v134, v172, v173
    v_cvt_pk_bf16_f32 v135, v174, v175
    v_cvt_pk_bf16_f32 v136, v176, v177
    v_cvt_pk_bf16_f32 v137, v178, v179
    v_cvt_pk_bf16_f32 v138, v180, v181
    v_cvt_pk_bf16_f32 v139, v182, v183
    v_cvt_pk_bf16_f32 v140, v184, v185
    v_cvt_pk_bf16_f32 v141, v186, v187
    v_cvt_pk_bf16_f32 v142, v188, v189
    v_cvt_pk_bf16_f32 v143, v190, v191
    v_rcp_f32 v116, v225
    v_rcp_f32 v118, v241
    v_mov_b32 v120, 0x358637bd
    v_fmac_f32 v120, v224, v116
    v_fmac_f32 v120, v240, v118
    v_rcp_f32 v120, v120
    s_nop 0
    v_mul_f32 v116, v116, v120
    v_mul_f32 v118, v118, v120
    v_pk_mul_f32 v[192:193], v[192:193], v[116:117] op_sel_hi:[1,0]
    v_pk_mul_f32 v[194:195], v[194:195], v[116:117] op_sel_hi:[1,0]
    v_pk_mul_f32 v[196:197], v[196:197], v[116:117] op_sel_hi:[1,0]
    v_pk_mul_f32 v[198:199], v[198:199], v[116:117] op_sel_hi:[1,0]
    v_pk_mul_f32 v[200:201], v[200:201], v[116:117] op_sel_hi:[1,0]
    v_pk_mul_f32 v[202:203], v[202:203], v[116:117] op_sel_hi:[1,0]
    v_pk_mul_f32 v[204:205], v[204:205], v[116:117] op_sel_hi:[1,0]
    v_pk_mul_f32 v[206:207], v[206:207], v[116:117] op_sel_hi:[1,0]
    v_pk_mul_f32 v[208:209], v[208:209], v[118:119] op_sel_hi:[1,0]
    v_pk_mul_f32 v[210:211], v[210:211], v[118:119] op_sel_hi:[1,0]
    v_pk_mul_f32 v[212:213], v[212:213], v[118:119] op_sel_hi:[1,0]
    v_pk_mul_f32 v[214:215], v[214:215], v[118:119] op_sel_hi:[1,0]
    v_pk_mul_f32 v[216:217], v[216:217], v[118:119] op_sel_hi:[1,0]
    v_pk_mul_f32 v[218:219], v[218:219], v[118:119] op_sel_hi:[1,0]
    v_pk_mul_f32 v[220:221], v[220:221], v[118:119] op_sel_hi:[1,0]
    v_pk_mul_f32 v[222:223], v[222:223], v[118:119] op_sel_hi:[1,0]
    v_cvt_pk_bf16_f32 v144, v192, v193
    v_cvt_pk_bf16_f32 v145, v194, v195
    v_cvt_pk_bf16_f32 v146, v196, v197
    v_cvt_pk_bf16_f32 v147, v198, v199
    v_cvt_pk_bf16_f32 v148, v200, v201
    v_cvt_pk_bf16_f32 v149, v202, v203
    v_cvt_pk_bf16_f32 v150, v204, v205
    v_cvt_pk_bf16_f32 v151, v206, v207
    v_cvt_pk_bf16_f32 v152, v208, v209
    v_cvt_pk_bf16_f32 v153, v210, v211
    v_cvt_pk_bf16_f32 v154, v212, v213
    v_cvt_pk_bf16_f32 v155, v214, v215
    v_cvt_pk_bf16_f32 v156, v216, v217
    v_cvt_pk_bf16_f32 v157, v218, v219
    v_cvt_pk_bf16_f32 v158, v220, v221
    v_cvt_pk_bf16_f32 v159, v222, v223
    s_lshl_b32 s78, s70, 14
    s_lshl_b32 s79, s81, 13
    s_add_u32 s78, s78, s79
    s_add_u32 s78, s78, 8388608
    s_add_u32 s79, s78, 4096
    s_mov_b32 s85, 0
Lspin_1:
    s_add_u32 s85, s85, 1
    s_cmp_gt_u32 s85, 400000
    s_cbranch_scc1 L_end
    buffer_load_dwordx4 v[16:19], v11, s[36:39], s78 offen offset:0 sc1
    buffer_load_dwordx4 v[20:23], v11, s[36:39], s78 offen offset:2048 sc1
    buffer_load_dwordx4 v[24:27], v11, s[36:39], s79 offen offset:0 sc1
    buffer_load_dwordx4 v[28:31], v11, s[36:39], s79 offen offset:2048 sc1
    s_waitcnt vmcnt(0)
    v_max3_u32 v13, v16, v20, v24
    v_max3_u32 v13, v13, v28, v19
    v_max3_u32 v13, v13, v23, v27
    v_max_u32 v13, v13, v31
    v_cmp_eq_u32 vcc, -1, v13
    s_cbranch_vccnz Lspin_1
    v_mfma_f32_32x32x16_bf16 v[60:75], v[16:19], v[128:131], 0
    v_mfma_f32_32x32x16_bf16 v[76:91], v[16:19], v[144:147], 0
    v_mfma_f32_32x32x16_bf16 v[60:75], v[20:23], v[132:135], v[60:75]
    v_mfma_f32_32x32x16_bf16 v[76:91], v[20:23], v[148:151], v[76:91]
    v_mfma_f32_32x32x16_bf16 v[60:75], v[24:27], v[136:139], v[60:75]
    v_mfma_f32_32x32x16_bf16 v[76:91], v[24:27], v[152:155], v[76:91]
    v_mfma_f32_32x32x16_bf16 v[60:75], v[28:31], v[140:143], v[60:75]
    v_mfma_f32_32x32x16_bf16 v[76:91], v[28:31], v[156:159], v[76:91]
    s_lshl_b32 s78, s69, 3
    s_lshl_b32 s79, s80, 2
    s_add_u32 s78, s78, s79
    s_lshl_b32 s78, s78, 5
    s_lshl_b32 s79, s70, 1
    s_add_u32 s78, s78, s79
    s_add_u32 s78, s78, s81
    s_lshl_b32 s78, s78, 10
    s_add_u32 s78, s78, 4194304
    s_add_u32 s79, s78, 65536
    s_nop 0
    v_cvt_pk_bf16_f32 v44, v60, v61
    v_cvt_pk_bf16_f32 v45, v62, v63
    v_cvt_pk_bf16_f32 v46, v64, v65
    v_cvt_pk_bf16_f32 v47, v66, v67
    buffer_store_dwordx4 v[44:47], v12, s[36:39], s78 offen offset:0 sc1
    v_cvt_pk_bf16_f32 v48, v68, v69
    v_cvt_pk_bf16_f32 v49, v70, v71
    v_cvt_pk_bf16_f32 v50, v72, v73
    v_cvt_pk_bf16_f32 v51, v74, v75
    buffer_store_dwordx4 v[48:51], v12, s[36:39], s78 offen offset:512 sc1
    v_cvt_pk_bf16_f32 v52, v76, v77
    v_cvt_pk_bf16_f32 v53, v78, v79
    v_cvt_pk_bf16_f32 v54, v80, v81
    v_cvt_pk_bf16_f32 v55, v82, v83
    buffer_store_dwordx4 v[52:55], v12, s[36:39], s79 offen offset:0 sc1
    v_cvt_pk_bf16_f32 v56, v84, v85
    v_cvt_pk_bf16_f32 v57, v86, v87
    v_cvt_pk_bf16_f32 v58, v88, v89
    v_cvt_pk_bf16_f32 v59, v90, v91
    buffer_store_dwordx4 v[56:59], v12, s[36:39], s79 offen offset:512 sc1
    v_bfe_u32 v16, v2, 2, 2
    v_and_b32 v17, 3, v2
    v_and_b32 v18, 1, v9
    v_lshrrev_b32 v19, 1, v9
    v_lshl_add_u32 v20, v18, 2, v16
    v_lshrrev_b32 v21, 1, v20
    v_lshl_add_u32 v20, v19, 4, v20
    v_lshlrev_b32 v20, 7, v20
    v_lshl_add_u32 v20, v17, 3, v20
    s_and_b32 s82, s72, 3
    s_lshl_b32 s78, s82, 15
    v_add_u32 v20, s78, v20
    v_xor_b32 v22, 0, v21
    v_lshl_add_u32 v4, v22, 5, v20
    v_xor_b32 v22, 1, v21
    v_lshl_add_u32 v5, v22, 5, v20
    v_xor_b32 v22, 2, v21
    v_lshl_add_u32 v6, v22, 5, v20
    v_xor_b32 v22, 3, v21
    v_lshl_add_u32 v7, v22, 5, v20
    s_lshl_b32 s78, s76, 12
    s_add_u32 s78, s78, 131072
    v_lshl_add_u32 v20, v8, 7, s78
    v_lshl_add_u32 v20, v18, 3, v20
    v_lshrrev_b32 v21, 1, v8
    v_xor_b32 v21, v21, v19
    v_xor_b32 v22, 0, v21
    v_lshl_add_u32 v96, v22, 4, v20
    v_xor_b32 v22, 2, v21
    v_lshl_add_u32 v97, v22, 4, v20
    v_xor_b32 v22, 4, v21
    v_lshl_add_u32 v98, v22, 4, v20
    v_xor_b32 v22, 6, v21
    v_lshl_add_u32 v99, v22, 4, v20
    v_lshlrev_b32 v10, 4, v2
    v_add_u32 v11, 32768, v10
    s_lshl_b32 s83, s71, 2
    s_add_u32 s83, s83, s76
    s_lshl_b32 s83, s83, 16
    s_add_u32 s83, s83, 4194304
    s_lshl_b32 s88, s82, 13
    s_add_u32 s88, s88, s83
    s_add_u32 s89, s88, 4096
    v_lshlrev_b32 v104, 16, v32
    v_and_b32 v105, 0xffff0000, v32
    v_lshlrev_b32 v106, 16, v33
    v_and_b32 v107, 0xffff0000, v33
    v_lshlrev_b32 v108, 16, v34
    v_and_b32 v109, 0xffff0000, v34
    v_lshlrev_b32 v110, 16, v35
    v_and_b32 v111, 0xffff0000, v35
    v_lshlrev_b32 v112, 16, v36
    v_and_b32 v113, 0xffff0000, v36
    v_lshlrev_b32 v114, 16, v37
    v_and_b32 v115, 0xffff0000, v37
    v_lshlrev_b32 v116, 16, v38
    v_and_b32 v117, 0xffff0000, v38
    v_lshlrev_b32 v118, 16, v39
    v_and_b32 v119, 0xffff0000, v39
    v_pk_add_f32 v[120:121], v[104:105], v[106:107]
    v_pk_add_f32 v[120:121], v[120:121], v[108:109]
    v_pk_add_f32 v[120:121], v[120:121], v[110:111]
    v_pk_add_f32 v[120:121], v[120:121], v[112:113]
    v_pk_add_f32 v[120:121], v[120:121], v[114:115]
    v_pk_add_f32 v[120:121], v[120:121], v[116:117]
    v_pk_add_f32 v[120:121], v[120:121], v[118:119]
    v_add_f32 v120, v120, v121
    v_mov_b32 v121, v120
    s_nop 1
    v_permlane32_swap_b32 v120, v121
    v_add_f32 v120, v120, v121
    v_mov_b32 v121, v120
    s_nop 1
    v_permlane16_swap_b32 v120, v121
    v_add_f32 v120, v120, v121
    s_barrier
    ds_read_b64 v[16:17], v96 offset:0
    ds_read_b64 v[18:19], v96 offset:2048
    ds_read_b64 v[20:21], v97 offset:0
    ds_read_b64 v[22:23], v97 offset:2048
    ds_read_b64 v[24:25], v98 offset:0
    ds_read_b64 v[26:27], v98 offset:2048
    ds_read_b64 v[28:29], v99 offset:0
    ds_read_b64 v[30:31], v99 offset:2048
    buffer_load_dwordx4 v[160:163], v10, s[36:39], s88 offen offset:0 sc1
    buffer_load_dwordx4 v[164:167], v11, s[36:39], s88 offen offset:0 sc1
    buffer_load_dwordx4 v[168:171], v10, s[36:39], s88 offen offset:1024 sc1
    buffer_load_dwordx4 v[172:175], v11, s[36:39], s88 offen offset:1024 sc1
    buffer_load_dwordx4 v[176:179], v10, s[36:39], s88 offen offset:2048 sc1
    buffer_load_dwordx4 v[180:183], v11, s[36:39], s88 offen offset:2048 sc1
    buffer_load_dwordx4 v[184:187], v10, s[36:39], s88 offen offset:3072 sc1
    buffer_load_dwordx4 v[188:191], v11, s[36:39], s88 offen offset:3072 sc1
    buffer_load_dwordx4 v[192:195], v10, s[36:39], s89 offen offset:0 sc1
    buffer_load_dwordx4 v[196:199], v11, s[36:39], s89 offen offset:0 sc1
    buffer_load_dwordx4 v[200:203], v10, s[36:39], s89 offen offset:1024 sc1
    buffer_load_dwordx4 v[204:207], v11, s[36:39], s89 offen offset:1024 sc1
    buffer_load_dwordx4 v[208:211], v10, s[36:39], s89 offen offset:2048 sc1
    buffer_load_dwordx4 v[212:215], v11, s[36:39], s89 offen offset:2048 sc1
    buffer_load_dwordx4 v[216:219], v10, s[36:39], s89 offen offset:3072 sc1
    buffer_load_dwordx4 v[220:223], v11, s[36:39], s89 offen offset:3072 sc1
    s_waitcnt lgkmcnt(0)
    ds_read_b64_tr_b16 v[64:65], v4 offset:0
    ds_read_b64_tr_b16 v[66:67], v4 offset:1024
    ds_read_b64_tr_b16 v[68:69], v5 offset:0
    ds_read_b64_tr_b16 v[70:71], v5 offset:1024
    ds_read_b64_tr_b16 v[72:73], v6 offset:0
    ds_read_b64_tr_b16 v[74:75], v6 offset:1024
    ds_read_b64_tr_b16 v[76:77], v7 offset:0
    ds_read_b64_tr_b16 v[78:79], v7 offset:1024
    v_lshlrev_b32 v128, 16, v16
    v_and_b32 v129, 0xffff0000, v16
    v_lshlrev_b32 v130, 16, v17
    v_and_b32 v131, 0xffff0000, v17
    v_lshlrev_b32 v132, 16, v18
    v_and_b32 v133, 0xffff0000, v18
    v_lshlrev_b32 v134, 16, v19
    v_and_b32 v135, 0xffff0000, v19
    v_lshlrev_b32 v136, 16, v20
    v_and_b32 v137, 0xffff0000, v20
    v_lshlrev_b32 v138, 16, v21
    v_and_b32 v139, 0xffff0000, v21
    v_lshlrev_b32 v140, 16, v22
    v_and_b32 v141, 0xffff0000, v22
    v_lshlrev_b32 v142, 16, v23
    v_and_b32 v143, 0xffff0000, v23
    v_lshlrev_b32 v144, 16, v24
    v_and_b32 v145, 0xffff0000, v24
    v_lshlrev_b32 v146, 16, v25
    v_and_b32 v147, 0xffff0000, v25
    v_lshlrev_b32 v148, 16, v26
    v_and_b32 v149, 0xffff0000, v26
    v_lshlrev_b32 v150, 16, v27
    v_and_b32 v151, 0xffff0000, v27
    v_lshlrev_b32 v152, 16, v28
    v_and_b32 v153, 0xffff0000, v28
    v_lshlrev_b32 v154, 16, v29
    v_and_b32 v155, 0xffff0000, v29
    v_lshlrev_b32 v156, 16, v30
    v_and_b32 v157, 0xffff0000, v30
    v_lshlrev_b32 v158, 16, v31
    v_and_b32 v159, 0xffff0000, v31
    s_mov_b32 s84, 0
    s_mov_b32 s85, 0
    .p2align 3
L_G2:
    s_mov_b32 s86, s88
    s_mov_b32 s87, s89
    s_add_u32 s82, s82, 1
    s_and_b32 s82, s82, 3
    s_lshl_b32 s88, s82, 13
    s_add_u32 s88, s88, s83
    s_add_u32 s84, s84, 1
    s_cmp_eq_u32 s84, 4
    s_cselect_b32 s88, 0x10000000, s88
    s_add_u32 s89, s88, 4096
    s_waitcnt vmcnt(12)
L_G2c0:
    v_max3_u32 v16, v160, v164, v168
    v_max_u32 v16, v16, v172
    v_cmp_eq_u32 vcc, -1, v16
    s_cbranch_vccnz L_G2s0
    s_waitcnt lgkmcnt(0)
    v_mfma_f32_16x16x32_bf16 v[128:131], v[64:67], v[160:163], v[128:131]
    ds_read_b64_tr_b16 v[80:81], v4 offset:4096
    v_mfma_f32_16x16x32_bf16 v[132:135], v[64:67], v[164:167], v[132:135]
    ds_read_b64_tr_b16 v[82:83], v4 offset:5120
    v_mfma_f32_16x16x32_bf16 v[140:143], v[68:71], v[164:167], v[140:143]
    ds_read_b64_tr_b16 v[84:85], v5 offset:4096
    v_mfma_f32_16x16x32_bf16 v[136:139], v[68:71], v[160:163], v[136:139]
    ds_read_b64_tr_b16 v[86:87], v5 offset:5120
    v_mfma_f32_16x16x32_bf16 v[144:147], v[72:75], v[160:163], v[144:147]
    ds_read_b64_tr_b16 v[88:89], v6 offset:4096
    v_mfma_f32_16x16x32_bf16 v[148:151], v[72:75], v[164:167], v[148:151]
    ds_read_b64_tr_b16 v[90:91], v6 offset:5120
    v_mfma_f32_16x16x32_bf16 v[156:159], v[76:79], v[164:167], v[156:159]
    ds_read_b64_tr_b16 v[92:93], v7 offset:4096
    v_mfma_f32_16x16x32_bf16 v[152:155], v[76:79], v[160:163], v[152:155]
    ds_read_b64_tr_b16 v[94:95], v7 offset:5120
    s_waitcnt lgkmcnt(0)
    v_mfma_f32_16x16x32_bf16 v[128:131], v[80:83], v[168:171], v[128:131]
    ds_read_b64_tr_b16 v[64:65], v4 offset:8192
    v_mfma_f32_16x16x32_bf16 v[132:135], v[80:83], v[172:175], v[132:135]
    ds_read_b64_tr_b16 v[66:67], v4 offset:9216
    v_mfma_f32_16x16x32_bf16 v[140:143], v[84:87], v[172:175], v[140:143]
    ds_read_b64_tr_b16 v[68:69], v5 offset:8192
    v_mfma_f32_16x16x32_bf16 v[136:139], v[84:87], v[168:171], v[136:139]
    ds_read_b64_tr_b16 v[70:71], v5 offset:9216
    v_mfma_f32_16x16x32_bf16 v[144:147], v[88:91], v[168:171], v[144:147]
    ds_read_b64_tr_b16 v[72:73], v6 offset:8192
    v_mfma_f32_16x16x32_bf16 v[148:151], v[88:91], v[172:175], v[148:151]
    ds_read_b64_tr_b16 v[74:75], v6 offset:9216
    v_mfma_f32_16x16x32_bf16 v[156:159], v[92:95], v[172:175], v[156:159]
    ds_read_b64_tr_b16 v[76:77], v7 offset:8192
    v_mfma_f32_16x16x32_bf16 v[152:155], v[92:95], v[168:171], v[152:155]
    ds_read_b64_tr_b16 v[78:79], v7 offset:9216
    buffer_load_dwordx4 v[160:163], v10, s[36:39], s88 offen offset:0 sc1
    buffer_load_dwordx4 v[164:167], v11, s[36:39], s88 offen offset:0 sc1
    buffer_load_dwordx4 v[168:171], v10, s[36:39], s88 offen offset:1024 sc1
    buffer_load_dwordx4 v[172:175], v11, s[36:39], s88 offen offset:1024 sc1
    s_waitcnt vmcnt(12)
L_G2c2:
    v_max3_u32 v16, v176, v180, v184
    v_max_u32 v16, v16, v188
    v_cmp_eq_u32 vcc, -1, v16
    s_cbranch_vccnz L_G2s2
    s_waitcnt lgkmcnt(0)
    v_mfma_f32_16x16x32_bf16 v[128:131], v[64:67], v[176:179], v[128:131]
    ds_read_b64_tr_b16 v[80:81], v4 offset:12288
    v_mfma_f32_16x16x32_bf16 v[132:135], v[64:67], v[180:183], v[132:135]
    ds_read_b64_tr_b16 v[82:83], v4 offset:13312
    v_mfma_f32_16x16x32_bf16 v[140:143], v[68:71], v[180:183], v[140:143]
    ds_read_b64_tr_b16 v[84:85], v5 offset:12288
    v_mfma_f32_16x16x32_bf16 v[136:139], v[68:71], v[176:179], v[136:139]
    ds_read_b64_tr_b16 v[86:87], v5 offset:13312
    v_mfma_f32_16x16x32_bf16 v[144:147], v[72:75], v[176:179], v[144:147]
    ds_read_b64_tr_b16 v[88:89], v6 offset:12288
    v_mfma_f32_16x16x32_bf16 v[148:151], v[72:75], v[180:183], v[148:151]
    ds_read_b64_tr_b16 v[90:91], v6 offset:13312
    v_mfma_f32_16x16x32_bf16 v[156:159], v[76:79], v[180:183], v[156:159]
    ds_read_b64_tr_b16 v[92:93], v7 offset:12288
    v_mfma_f32_16x16x32_bf16 v[152:155], v[76:79], v[176:179], v[152:155]
    ds_read_b64_tr_b16 v[94:95], v7 offset:13312
    s_waitcnt lgkmcnt(0)
    v_mfma_f32_16x16x32_bf16 v[128:131], v[80:83], v[184:187], v[128:131]
    ds_read_b64_tr_b16 v[64:65], v4 offset:16384
    v_mfma_f32_16x16x32_bf16 v[132:135], v[80:83], v[188:191], v[132:135]
    ds_read_b64_tr_b16 v[66:67], v4 offset:17408
    v_mfma_f32_16x16x32_bf16 v[140:143], v[84:87], v[188:191], v[140:143]
    ds_read_b64_tr_b16 v[68:69], v5 offset:16384
    v_mfma_f32_16x16x32_bf16 v[136:139], v[84:87], v[184:187], v[136:139]
    ds_read_b64_tr_b16 v[70:71], v5 offset:17408
    v_mfma_f32_16x16x32_bf16 v[144:147], v[88:91], v[184:187], v[144:147]
    ds_read_b64_tr_b16 v[72:73], v6 offset:16384
    v_mfma_f32_16x16x32_bf16 v[148:151], v[88:91], v[188:191], v[148:151]
    ds_read_b64_tr_b16 v[74:75], v6 offset:17408
    v_mfma_f32_16x16x32_bf16 v[156:159], v[92:95], v[188:191], v[156:159]
    ds_read_b64_tr_b16 v[76:77], v7 offset:16384
    v_mfma_f32_16x16x32_bf16 v[152:155], v[92:95], v[184:187], v[152:155]
    ds_read_b64_tr_b16 v[78:79], v7 offset:17408
    buffer_load_dwordx4 v[176:179], v10, s[36:39], s88 offen offset:2048 sc1
    buffer_load_dwordx4 v[180:183], v11, s[36:39], s88 offen offset:2048 sc1
    buffer_load_dwordx4 v[184:187], v10, s[36:39], s88 offen offset:3072 sc1
    buffer_load_dwordx4 v[188:191], v11, s[36:39], s88 offen offset:3072 sc1
    s_waitcnt vmcnt(12)
L_G2c4:
    v_max3_u32 v16, v192, v196, v200
    v_max_u32 v16, v16, v204
    v_cmp_eq_u32 vcc, -1, v16
    s_cbranch_vccnz L_G2s4
    s_waitcnt lgkmcnt(0)
    v_mfma_f32_16x16x32_bf16 v[128:131], v[64:67], v[192:195], v[128:131]
    ds_read_b64_tr_b16 v[80:81], v4 offset:20480
    v_mfma_f32_16x16x32_bf16 v[132:135], v[64:67], v[196:199], v[132:135]
    ds_read_b64_tr_b16 v[82:83], v4 offset:21504
    v_mfma_f32_16x16x32_bf16 v[140:143], v[68:71], v[196:199], v[140:143]
    ds_read_b64_tr_b16 v[84:85], v5 offset:20480
    v_mfma_f32_16x16x32_bf16 v[136:139], v[68:71], v[192:195], v[136:139]
    ds_read_b64_tr_b16 v[86:87], v5 offset:21504
    v_mfma_f32_16x16x32_bf16 v[144:147], v[72:75], v[192:195], v[144:147]
    ds_read_b64_tr_b16 v[88:89], v6 offset:20480
    v_mfma_f32_16x16x32_bf16 v[148:151], v[72:75], v[196:199], v[148:151]
    ds_read_b64_tr_b16 v[90:91], v6 offset:21504
    v_mfma_f32_16x16x32_bf16 v[156:159], v[76:79], v[196:199], v[156:159]
    ds_read_b64_tr_b16 v[92:93], v7 offset:20480
    v_mfma_f32_16x16x32_bf16 v[152:155], v[76:79], v[192:195], v[152:155]
    ds_read_b64_tr_b16 v[94:95], v7 offset:21504
    s_waitcnt lgkmcnt(0)
    v_mfma_f32_16x16x32_bf16 v[128:131], v[80:83], v[200:203], v[128:131]
    ds_read_b64_tr_b16 v[64:65], v4 offset:24576
    v_mfma_f32_16x16x32_bf16 v[132:135], v[80:83], v[204:207], v[132:135]
    ds_read_b64_tr_b16 v[66:67], v4 offset:25600
    v_mfma_f32_16x16x32_bf16 v[140:143], v[84:87], v[204:207], v[140:143]
    ds_read_b64_tr_b16 v[68:69], v5 offset:24576
    v_mfma_f32_16x16x32_bf16 v[136:139], v[84:87], v[200:203], v[136:139]
    ds_read_b64_tr_b16 v[70:71], v5 offset:25600
    v_mfma_f32_16x16x32_bf16 v[144:147], v[88:91], v[200:203], v[144:147]
    ds_read_b64_tr_b16 v[72:73], v6 offset:24576
    v_mfma_f32_16x16x32_bf16 v[148:151], v[88:91], v[204:207], v[148:151]
    ds_read_b64_tr_b16 v[74:75], v6 offset:25600
    v_mfma_f32_16x16x32_bf16 v[156:159], v[92:95], v[204:207], v[156:159]
    ds_read_b64_tr_b16 v[76:77], v7 offset:24576
    v_mfma_f32_16x16x32_bf16 v[152:155], v[92:95], v[200:203], v[152:155]
    ds_read_b64_tr_b16 v[78:79], v7 offset:25600
    buffer_load_dwordx4 v[192:195], v10, s[36:39], s89 offen offset:0 sc1
    buffer_load_dwordx4 v[196:199], v11, s[36:39], s89 offen offset:0 sc1
    buffer_load_dwordx4 v[200:203], v10, s[36:39], s89 offen offset:1024 sc1
    buffer_load_dwordx4 v[204:207], v11, s[36:39], s89 offen offset:1024 sc1
    s_waitcnt vmcnt(12)
L_G2c6:
    v_max3_u32 v16, v208, v212, v216
    v_max_u32 v16, v16, v220
    v_cmp_eq_u32 vcc, -1, v16
    s_cbranch_vccnz L_G2s6
    s_waitcnt lgkmcnt(0)
    v_mfma_f32_16x16x32_bf16 v[128:131], v[64:67], v[208:211], v[128:131]
    ds_read_b64_tr_b16 v[80:81], v4 offset:28672
    v_mfma_f32_16x16x32_bf16 v[132:135], v[64:67], v[212:215], v[132:135]
    ds_read_b64_tr_b16 v[82:83], v4 offset:29696
    v_mfma_f32_16x16x32_bf16 v[140:143], v[68:71], v[212:215], v[140:143]
    ds_read_b64_tr_b16 v[84:85], v5 offset:28672
    v_mfma_f32_16x16x32_bf16 v[136:139], v[68:71], v[208:211], v[136:139]
    ds_read_b64_tr_b16 v[86:87], v5 offset:29696
    v_mfma_f32_16x16x32_bf16 v[144:147], v[72:75], v[208:211], v[144:147]
    ds_read_b64_tr_b16 v[88:89], v6 offset:28672
    v_mfma_f32_16x16x32_bf16 v[148:151], v[72:75], v[212:215], v[148:151]
    ds_read_b64_tr_b16 v[90:91], v6 offset:29696
    v_mfma_f32_16x16x32_bf16 v[156:159], v[76:79], v[212:215], v[156:159]
    ds_read_b64_tr_b16 v[92:93], v7 offset:28672
    v_mfma_f32_16x16x32_bf16 v[152:155], v[76:79], v[208:211], v[152:155]
    ds_read_b64_tr_b16 v[94:95], v7 offset:29696
    v_add_u32 v4, 0x8000, v4
    v_and_b32 v4, 0x1ffff, v4
    v_add_u32 v5, 0x8000, v5
    v_and_b32 v5, 0x1ffff, v5
    v_add_u32 v6, 0x8000, v6
    v_and_b32 v6, 0x1ffff, v6
    v_add_u32 v7, 0x8000, v7
    v_and_b32 v7, 0x1ffff, v7
    s_waitcnt lgkmcnt(0)
    v_mfma_f32_16x16x32_bf16 v[128:131], v[80:83], v[216:219], v[128:131]
    ds_read_b64_tr_b16 v[64:65], v4 offset:0
    v_mfma_f32_16x16x32_bf16 v[132:135], v[80:83], v[220:223], v[132:135]
    ds_read_b64_tr_b16 v[66:67], v4 offset:1024
    v_mfma_f32_16x16x32_bf16 v[140:143], v[84:87], v[220:223], v[140:143]
    ds_read_b64_tr_b16 v[68:69], v5 offset:0
    v_mfma_f32_16x16x32_bf16 v[136:139], v[84:87], v[216:219], v[136:139]
    ds_read_b64_tr_b16 v[70:71], v5 offset:1024
    v_mfma_f32_16x16x32_bf16 v[144:147], v[88:91], v[216:219], v[144:147]
    ds_read_b64_tr_b16 v[72:73], v6 offset:0
    v_mfma_f32_16x16x32_bf16 v[148:151], v[88:91], v[220:223], v[148:151]
    ds_read_b64_tr_b16 v[74:75], v6 offset:1024
    v_mfma_f32_16x16x32_bf16 v[156:159], v[92:95], v[220:223], v[156:159]
    ds_read_b64_tr_b16 v[76:77], v7 offset:0
    v_mfma_f32_16x16x32_bf16 v[152:155], v[92:95], v[216:219], v[152:155]
    ds_read_b64_tr_b16 v[78:79], v7 offset:1024
    buffer_load_dwordx4 v[208:211], v10, s[36:39], s89 offen offset:2048 sc1
    buffer_load_dwordx4 v[212:215], v11, s[36:39], s89 offen offset:2048 sc1
    buffer_load_dwordx4 v[216:219], v10, s[36:39], s89 offen offset:3072 sc1
    buffer_load_dwordx4 v[220:223], v11, s[36:39], s89 offen offset:3072 sc1
    s_cmp_lt_u32 s84, 4
    s_cbranch_scc1 L_G2
    s_branch L_G2done
L_G2s0:
    s_add_u32 s85, s85, 1
    s_cmp_gt_u32 s85, 400000
    s_cbranch_scc1 L_end
    buffer_load_dwordx4 v[160:163], v10, s[36:39], s86 offen offset:0 sc1
    buffer_load_dwordx4 v[164:167], v11, s[36:39], s86 offen offset:0 sc1
    buffer_load_dwordx4 v[168:171], v10, s[36:39], s86 offen offset:1024 sc1
    buffer_load_dwordx4 v[172:175], v11, s[36:39], s86 offen offset:1024 sc1
    s_waitcnt vmcnt(0)
    s_branch L_G2c0
L_G2s2:
    s_add_u32 s85, s85, 1
    s_cmp_gt_u32 s85, 400000
    s_cbranch_scc1 L_end
    buffer_load_dwordx4 v[176:179], v10, s[36:39], s86 offen offset:2048 sc1
    buffer_load_dwordx4 v[180:183], v11, s[36:39], s86 offen offset:2048 sc1
    buffer_load_dwordx4 v[184:187], v10, s[36:39], s86 offen offset:3072 sc1
    buffer_load_dwordx4 v[188:191], v11, s[36:39], s86 offen offset:3072 sc1
    s_waitcnt vmcnt(0)
    s_branch L_G2c2
L_G2s4:
    s_add_u32 s85, s85, 1
    s_cmp_gt_u32 s85, 400000
    s_cbranch_scc1 L_end
    buffer_load_dwordx4 v[192:195], v10, s[36:39], s87 offen offset:0 sc1
    buffer_load_dwordx4 v[196:199], v11, s[36:39], s87 offen offset:0 sc1
    buffer_load_dwordx4 v[200:203], v10, s[36:39], s87 offen offset:1024 sc1
    buffer_load_dwordx4 v[204:207], v11, s[36:39], s87 offen offset:1024 sc1
    s_waitcnt vmcnt(0)
    s_branch L_G2c4
L_G2s6:
    s_add_u32 s85, s85, 1
    s_cmp_gt_u32 s85, 400000
    s_cbranch_scc1 L_end
    buffer_load_dwordx4 v[208:211], v10, s[36:39], s87 offen offset:2048 sc1
    buffer_load_dwordx4 v[212:215], v11, s[36:39], s87 offen offset:2048 sc1
    buffer_load_dwordx4 v[216:219], v10, s[36:39], s87 offen offset:3072 sc1
    buffer_load_dwordx4 v[220:223], v11, s[36:39], s87 offen offset:3072 sc1
    s_waitcnt vmcnt(0)
    s_branch L_G2c6
L_G2done:
    v_lshrrev_b32 v12, 5, v2
    v_lshlrev_b32 v13, 4, v8
    v_lshl_add_u32 v12, v12, 8, v13
    v_lshl_add_u32 v13, v9, 13, v13
    s_lshl_b32 s78, s71, 15
    s_lshl_b32 s79, s76, 9
    s_add_u32 s78, s78, s79
    s_add_u32 s78, s78, 1572864
    s_add_u32 s79, s78, 4096
    s_lshl_b32 s80, s72, 11
    s_add_u32 s80, s80, s78
    s_waitcnt lgkmcnt(0)
    s_nop 2
    v_pk_mul_f32 v[18:19], v[128:129], v[128:129]
    v_pk_mul_f32 v[20:21], v[128:129], v[104:105]
    v_pk_add_f32 v[16:17], v[128:129], v[130:131]
    v_pk_fma_f32 v[18:19], v[130:131], v[130:131], v[18:19]
    v_pk_fma_f32 v[20:21], v[130:131], v[106:107], v[20:21]
    v_pk_add_f32 v[16:17], v[16:17], v[136:137]
    v_pk_fma_f32 v[18:19], v[136:137], v[136:137], v[18:19]
    v_pk_fma_f32 v[20:21], v[136:137], v[108:109], v[20:21]
    v_pk_add_f32 v[16:17], v[16:17], v[138:139]
    v_pk_fma_f32 v[18:19], v[138:139], v[138:139], v[18:19]
    v_pk_fma_f32 v[20:21], v[138:139], v[110:111], v[20:21]
    v_pk_add_f32 v[16:17], v[16:17], v[144:145]
    v_pk_fma_f32 v[18:19], v[144:145], v[144:145], v[18:19]
    v_pk_fma_f32 v[20:21], v[144:145], v[112:113], v[20:21]
    v_pk_add_f32 v[16:17], v[16:17], v[146:147]
    v_pk_fma_f32 v[18:19], v[146:147], v[146:147], v[18:19]
    v_pk_fma_f32 v[20:21], v[146:147], v[114:115], v[20:21]
    v_pk_add_f32 v[16:17], v[16:17], v[152:153]
    v_pk_fma_f32 v[18:19], v[152:153], v[152:153], v[18:19]
    v_pk_fma_f32 v[20:21], v[152:153], v[116:117], v[20:21]
    v_pk_add_f32 v[16:17], v[16:17], v[154:155]
    v_pk_fma_f32 v[18:19], v[154:155], v[154:155], v[18:19]
    v_pk_fma_f32 v[20:21], v[154:155], v[118:119], v[20:21]
    v_pk_mul_f32 v[24:25], v[132:133], v[132:133]
    v_pk_mul_f32 v[26:27], v[132:133], v[104:105]
    v_pk_add_f32 v[22:23], v[132:133], v[134:135]
    v_pk_fma_f32 v[24:25], v[134:135], v[134:135], v[24:25]
    v_pk_fma_f32 v[26:27], v[134:135], v[106:107], v[26:27]
    v_pk_add_f32 v[22:23], v[22:23], v[140:141]
    v_pk_fma_f32 v[24:25], v[140:141], v[140:141], v[24:25]
    v_pk_fma_f32 v[26:27], v[140:141], v[108:109], v[26:27]
    v_pk_add_f32 v[22:23], v[22:23], v[142:143]
    v_pk_fma_f32 v[24:25], v[142:143], v[142:143], v[24:25]
    v_pk_fma_f32 v[26:27], v[142:143], v[110:111], v[26:27]
    v_pk_add_f32 v[22:23], v[22:23], v[148:149]
    v_pk_fma_f32 v[24:25], v[148:149], v[148:149], v[24:25]
    v_pk_fma_f32 v[26:27], v[148:149], v[112:113], v[26:27]
    v_pk_add_f32 v[22:23], v[22:23], v[150:151]
    v_pk_fma_f32 v[24:25], v[150:151], v[150:151], v[24:25]
    v_pk_fma_f32 v[26:27], v[150:151], v[114:115], v[26:27]
    v_pk_add_f32 v[22:23], v[22:23], v[156:157]
    v_pk_fma_f32 v[24:25], v[156:157], v[156:157], v[24:25]
    v_pk_fma_f32 v[26:27], v[156:157], v[116:117], v[26:27]
    v_pk_add_f32 v[22:23], v[22:23], v[158:159]
    v_pk_fma_f32 v[24:25], v[158:159], v[158:159], v[24:25]
    v_pk_fma_f32 v[26:27], v[158:159], v[118:119], v[26:27]
    v_add_f32 v28, v16, v17
    v_add_f32 v29, v18, v19
    v_add_f32 v30, v20, v21
    v_add_f32 v32, v22, v23
    v_add_f32 v33, v24, v25
    v_add_f32 v34, v26, v27
    v_permlane32_swap_b32 v28, v32
    v_permlane32_swap_b32 v29, v33
    v_permlane32_swap_b32 v30, v34
    v_add_f32 v28, v28, v32
    v_add_f32 v29, v29, v33
    v_add_f32 v30, v30, v34
    v_mov_b32 v32, v28
    v_mov_b32 v33, v29
    v_mov_b32 v34, v30
    v_permlane16_swap_b32 v28, v32
    v_permlane16_swap_b32 v29, v33
    v_permlane16_swap_b32 v30, v34
    v_add_f32 v28, v28, v32
    v_add_f32 v29, v29, v33
    v_add_f32 v30, v30, v34
    v_mov_b32 v31, v120
    s_mov_b32 exec_lo, 0xffff
    s_mov_b32 exec_hi, 0xffff
    buffer_store_dwordx4 v[28:31], v12, s[36:39], s80 offen sc1
    s_mov_b64 exec, -1
    s_mov_b32 s85, 0
Lspin_2:
    s_add_u32 s85, s85, 1
    s_cmp_gt_u32 s85, 400000
    s_cbranch_scc1 L_end
    buffer_load_dwordx4 v[64:67], v13, s[36:39], s78 offen offset:0 sc1
    buffer_load_dwordx4 v[68:71], v13, s[36:39], s78 offen offset:2048 sc1
    buffer_load_dwordx4 v[72:75], v13, s[36:39], s79 offen offset:0 sc1
    buffer_load_dwordx4 v[76:79], v13, s[36:39], s79 offen offset:2048 sc1
    buffer_load_dwordx4 v[80:83], v13, s[36:39], s78 offen offset:256 sc1
    buffer_load_dwordx4 v[84:87], v13, s[36:39], s78 offen offset:2304 sc1
    buffer_load_dwordx4 v[88:91], v13, s[36:39], s79 offen offset:256 sc1
    buffer_load_dwordx4 v[92:95], v13, s[36:39], s79 offen offset:2304 sc1
    s_waitcnt vmcnt(0)
    v_max3_u32 v14, v64, v68, v72
    v_max3_u32 v14, v14, v76, v80
    v_max3_u32 v14, v14, v84, v88
    v_max_u32 v14, v14, v92
    v_cmp_eq_u32 vcc, -1, v14
    s_cbranch_vccnz Lspin_2
    v_pk_add_f32 v[64:65], v[64:65], v[68:69]
    v_pk_add_f32 v[72:73], v[72:73], v[76:77]
    v_pk_add_f32 v[66:67], v[66:67], v[70:71]
    v_pk_add_f32 v[74:75], v[74:75], v[78:79]
    v_pk_add_f32 v[28:29], v[64:65], v[72:73]
    v_pk_add_f32 v[30:31], v[66:67], v[74:75]
    v_pk_add_f32 v[80:81], v[80:81], v[84:85]
    v_pk_add_f32 v[88:89], v[88:89], v[92:93]
    v_pk_add_f32 v[82:83], v[82:83], v[86:87]
    v_pk_add_f32 v[90:91], v[90:91], v[94:95]
    v_pk_add_f32 v[32:33], v[80:81], v[88:89]
    v_pk_add_f32 v[34:35], v[82:83], v[90:91]
    s_nop 0
    v_permlane32_swap_b32 v28, v32
    v_permlane32_swap_b32 v29, v33
    v_permlane32_swap_b32 v30, v34
    v_permlane32_swap_b32 v31, v35
    v_add_f32 v28, v28, v32
    v_add_f32 v29, v29, v33
    v_add_f32 v30, v30, v34
    v_add_f32 v31, v31, v35
    v_mov_b32 v32, v28
    v_mov_b32 v33, v29
    v_mov_b32 v34, v30
    v_mov_b32 v35, v31
    v_permlane16_swap_b32 v28, v32
    v_permlane16_swap_b32 v29, v33
    v_permlane16_swap_b32 v30, v34
    v_permlane16_swap_b32 v31, v35
    v_add_f32 v28, v28, v32
    v_add_f32 v29, v29, v33
    v_add_f32 v30, v30, v34
    v_add_f32 v31, v31, v35
    v_mul_f32 v36, 0x3a800000, v28
    v_mul_f32 v40, 0x3a800000, v29
    v_fma_f32 v40, -v36, v36, v40
    v_max_f32 v40, 0, v40
    v_cvt_pk_bf16_f32 v36, v36, v36
    v_and_b32 v36, 0xffff0000, v36
    v_cvt_pk_bf16_f32 v40, v40, v40
    v_and_b32 v40, 0xffff0000, v40
    v_add_f32 v40, 0x3727c5ac, v40
    v_cvt_pk_bf16_f32 v40, v40, v40
    v_and_b32 v40, 0xffff0000, v40
    v_sqrt_f32 v40, v40
    s_nop 0
    v_cvt_pk_bf16_f32 v40, v40, v40
    v_and_b32 v40, 0xffff0000, v40
    v_rcp_f32 v38, v40
    v_fma_f32 v42, -v36, v31, v30
    v_mul_f32 v42, v42, v38
    s_lshl_b32 s78, s71, 2
    s_add_u32 s78, s78, s76
    s_lshl_b32 s78, s78, 5
    v_lshrrev_b32 v14, 4, v12
    v_add_u32 v14, s78, v14
    s_mov_b32 s79, 0xfffff800
    v_and_or_b32 v42, v42, s79, v14
    s_nop 1
    v_max_f32_dpp v42, v42, v42 row_ror:8 row_mask:0xf bank_mask:0xf
    s_nop 1
    v_max_f32_dpp v42, v42, v42 row_ror:4 row_mask:0xf bank_mask:0xf
    s_nop 1
    v_max_f32_dpp v42, v42, v42 row_ror:2 row_mask:0xf bank_mask:0xf
    s_nop 1
    v_max_f32_dpp v42, v42, v42 row_ror:1 row_mask:0xf bank_mask:0xf
    v_mov_b32 v14, v42
    s_nop 1
    v_permlane32_swap_b32 v42, v14
    v_max_f32 v42, v42, v14
    s_lshl_b32 s78, s76, 2
    s_add_u32 s78, s78, 163328
    v_mov_b32 v14, s78
    ds_write_b32 v14, v42
    v_mul_f32 v48, -v36, v38
    v_mov_b32 v44, v38
    v_mov_b32 v46, v38
    v_mov_b32 v50, v48
    s_nop 0
    v_permlane32_swap_b32 v44, v46
    v_permlane32_swap_b32 v48, v50
    v_add_f32 v52, 1.0, v44
    v_add_f32 v54, 1.0, v46
    v_mov_b32 v14, 163328
    s_waitcnt lgkmcnt(0)
    s_barrier
    ds_read_b128 v[56:59], v14
    v_pk_fma_f32 v[160:161], v[128:129], v[52:53], v[48:49] op_sel_hi:[1,0,0]
    v_pk_fma_f32 v[162:163], v[130:131], v[52:53], v[48:49] op_sel_hi:[1,0,0]
    v_pk_fma_f32 v[164:165], v[132:133], v[54:55], v[50:51] op_sel_hi:[1,0,0]
    v_pk_fma_f32 v[166:167], v[134:135], v[54:55], v[50:51] op_sel_hi:[1,0,0]
    v_pk_fma_f32 v[168:169], v[136:137], v[52:53], v[48:49] op_sel_hi:[1,0,0]
    v_pk_fma_f32 v[170:171], v[138:139], v[52:53], v[48:49] op_sel_hi:[1,0,0]
    v_pk_fma_f32 v[172:173], v[140:141], v[54:55], v[50:51] op_sel_hi:[1,0,0]
    v_pk_fma_f32 v[174:175], v[142:143], v[54:55], v[50:51] op_sel_hi:[1,0,0]
    v_pk_fma_f32 v[176:177], v[144:145], v[52:53], v[48:49] op_sel_hi:[1,0,0]
    v_pk_fma_f32 v[178:179], v[146:147], v[52:53], v[48:49] op_sel_hi:[1,0,0]
    v_pk_fma_f32 v[180:181], v[148:149], v[54:55], v[50:51] op_sel_hi:[1,0,0]
    v_pk_fma_f32 v[182:183], v[150:151], v[54:55], v[50:51] op_sel_hi:[1,0,0]
    v_pk_fma_f32 v[184:185], v[152:153], v[52:53], v[48:49] op_sel_hi:[1,0,0]
    v_pk_fma_f32 v[186:187], v[154:155], v[52:53], v[48:49] op_sel_hi:[1,0,0]
    v_pk_fma_f32 v[188:189], v[156:157], v[54:55], v[50:51] op_sel_hi:[1,0,0]
    v_pk_fma_f32 v[190:191], v[158:159], v[54:55], v[50:51] op_sel_hi:[1,0,0]
    s_waitcnt lgkmcnt(0)
    v_max3_f32 v56, v56, v57, v58
    v_max_f32 v56, v56, v59
    s_nop 0
    v_readfirstlane_b32 s97, v56
    s_bfe_u32 s78, s97, 0x20005
    s_cmp_lg_u32 s78, s76
    s_cbranch_scc1 L_nocand
    s_and_b32 s78, s97, 15
    s_lshl_b32 s90, 0x00010001, s78
    s_lshl_b32 s79, s71, 4
    s_add_u32 s79, s79, s72
    s_lshl_b32 s79, s79, 9
    s_add_u32 s79, s79, 524288
    v_lshlrev_b32 v14, 3, v9
    v_lshlrev_b32 v15, 4, v9
    s_mov_b32 exec_lo, s90
    s_mov_b32 exec_hi, s90
    s_bitcmp1_b32 s97, 4
    s_cbranch_scc1 L_cand1
    v_pk_fma_f32 v[64:65], v[128:129], v[44:45], v[48:49] op_sel_hi:[1,0,0]
    v_pk_fma_f32 v[66:67], v[130:131], v[44:45], v[48:49] op_sel_hi:[1,0,0]
    v_cvt_pk_bf16_f32 v80, v64, v65
    v_cvt_pk_bf16_f32 v81, v66, v67
    buffer_store_dwordx2 v[80:81], v14, s[36:39], s79 offen offset:0 sc1
    v_pk_fma_f32 v[68:69], v[136:137], v[44:45], v[48:49] op_sel_hi:[1,0,0]
    v_pk_fma_f32 v[70:71], v[138:139], v[44:45], v[48:49] op_sel_hi:[1,0,0]
    v_cvt_pk_bf16_f32 v82, v68, v69
    v_cvt_pk_bf16_f32 v83, v70, v71
    buffer_store_dwordx2 v[82:83], v14, s[36:39], s79 offen offset:32 sc1
    v_pk_fma_f32 v[72:73], v[144:145], v[44:45], v[48:49] op_sel_hi:[1,0,0]
    v_pk_fma_f32 v[74:75], v[146:147], v[44:45], v[48:49] op_sel_hi:[1,0,0]
    v_cvt_pk_bf16_f32 v84, v72, v73
    v_cvt_pk_bf16_f32 v85, v74, v75
    buffer_store_dwordx2 v[84:85], v14, s[36:39], s79 offen offset:64 sc1
    v_pk_fma_f32 v[76:77], v[152:153], v[44:45], v[48:49] op_sel_hi:[1,0,0]
    v_pk_fma_f32 v[78:79], v[154:155], v[44:45], v[48:49] op_sel_hi:[1,0,0]
    v_cvt_pk_bf16_f32 v86, v76, v77
    v_cvt_pk_bf16_f32 v87, v78, v79
    buffer_store_dwordx2 v[86:87], v14, s[36:39], s79 offen offset:96 sc1
    buffer_store_dword v56, v14, s[36:39], s79 offen offset:128 sc1
    buffer_store_dwordx4 v[160:163], v15, s[36:39], s79 offen offset:256 sc1
    buffer_store_dwordx4 v[168:171], v15, s[36:39], s79 offen offset:320 sc1
    buffer_store_dwordx4 v[176:179], v15, s[36:39], s79 offen offset:384 sc1
    buffer_store_dwordx4 v[184:187], v15, s[36:39], s79 offen offset:448 sc1
    s_branch L_cand2
L_cand1:
    v_pk_fma_f32 v[64:65], v[132:133], v[46:47], v[50:51] op_sel_hi:[1,0,0]
    v_pk_fma_f32 v[66:67], v[134:135], v[46:47], v[50:51] op_sel_hi:[1,0,0]
    v_cvt_pk_bf16_f32 v80, v64, v65
    v_cvt_pk_bf16_f32 v81, v66, v67
    buffer_store_dwordx2 v[80:81], v14, s[36:39], s79 offen offset:0 sc1
    v_pk_fma_f32 v[68:69], v[140:141], v[46:47], v[50:51] op_sel_hi:[1,0,0]
    v_pk_fma_f32 v[70:71], v[142:143], v[46:47], v[50:51] op_sel_hi:[1,0,0]
    v_cvt_pk_bf16_f32 v82, v68, v69
    v_cvt_pk_bf16_f32 v83, v70, v71
    buffer_store_dwordx2 v[82:83], v14, s[36:39], s79 offen offset:32 sc1
    v_pk_fma_f32 v[72:73], v[148:149], v[46:47], v[50:51] op_sel_hi:[1,0,0]
    v_pk_fma_f32 v[74:75], v[150:151], v[46:47], v[50:51] op_sel_hi:[1,0,0]
    v_cvt_pk_bf16_f32 v84, v72, v73
    v_cvt_pk_bf16_f32 v85, v74, v75
    buffer_store_dwordx2 v[84:85], v14, s[36:39], s79 offen offset:64 sc1
    v_pk_fma_f32 v[76:77], v[156:157], v[46:47], v[50:51] op_sel_hi:[1,0,0]
    v_pk_fma_f32 v[78:79], v[158:159], v[46:47], v[50:51] op_sel_hi:[1,0,0]
    v_cvt_pk_bf16_f32 v86, v76, v77
    v_cvt_pk_bf16_f32 v87, v78, v79
    buffer_store_dwordx2 v[86:87], v14, s[36:39], s79 offen offset:96 sc1
    buffer_store_dword v56, v14, s[36:39], s79 offen offset:128 sc1
    buffer_store_dwordx4 v[164:167], v15, s[36:39], s79 offen offset:256 sc1
    buffer_store_dwordx4 v[172:175], v15, s[36:39], s79 offen offset:320 sc1
    buffer_store_dwordx4 v[180:183], v15, s[36:39], s79 offen offset:384 sc1
    buffer_store_dwordx4 v[188:191], v15, s[36:39], s79 offen offset:448 sc1
L_cand2:
    s_mov_b64 exec, -1
L_nocand:
    v_cvt_pk_bf16_f32 v192, v160, v161
    v_cvt_pk_bf16_f32 v193, v162, v163
    ds_write_b64 v96, v[192:193] offset:0
    v_cvt_pk_bf16_f32 v194, v164, v165
    v_cvt_pk_bf16_f32 v195, v166, v167
    ds_write_b64 v96, v[194:195] offset:2048
    v_cvt_pk_bf16_f32 v196, v168, v169
    v_cvt_pk_bf16_f32 v197, v170, v171
    ds_write_b64 v97, v[196:197] offset:0
    v_cvt_pk_bf16_f32 v198, v172, v173
    v_cvt_pk_bf16_f32 v199, v174, v175
    ds_write_b64 v97, v[198:199] offset:2048
    v_cvt_pk_bf16_f32 v200, v176, v177
    v_cvt_pk_bf16_f32 v201, v178, v179
    ds_write_b64 v98, v[200:201] offset:0
    v_cvt_pk_bf16_f32 v202, v180, v181
    v_cvt_pk_bf16_f32 v203, v182, v183
    ds_write_b64 v98, v[202:203] offset:2048
    v_cvt_pk_bf16_f32 v204, v184, v185
    v_cvt_pk_bf16_f32 v205, v186, v187
    ds_write_b64 v99, v[204:205] offset:0
    v_cvt_pk_bf16_f32 v206, v188, v189
    v_cvt_pk_bf16_f32 v207, v190, v191
    ds_write_b64 v99, v[206:207] offset:2048
    s_lshl_b32 s78, s76, 12
    s_add_u32 s78, s78, 131072
    v_add_u32 v14, s78, v10
    s_waitcnt lgkmcnt(0)
    ds_read_b128 v[208:211], v14 offset:0
    ds_read_b128 v[212:215], v14 offset:1024
    ds_read_b128 v[216:219], v14 offset:2048
    ds_read_b128 v[220:223], v14 offset:3072
    v_lshrrev_b32 v16, 3, v2
    v_and_b32 v17, 7, v2
    v_xor_b32 v17, v17, v9
    v_xor_b32 v18, 4, v17
    s_lshl_b32 s78, s71, 2
    s_add_u32 s78, s78, s76
    s_lshl_b32 s78, s78, 5
    v_add_u32 v16, s78, v16
    s_lshl_b32 s79, s72, 7
    v_lshl_add_u32 v19, v16, 11, s79
    v_lshl_add_u32 v17, v17, 4, v19
    v_lshl_add_u32 v18, v18, 4, v19
    v_mov_b32 v14, 163344
    s_barrier
    ds_read_b32 v15, v14
    s_waitcnt lgkmcnt(0)
    v_and_b32 v15, 0x7ff, v15
    v_sub_u32 v15, v15, v16
    s_mov_b32 s78, 0
    v_cmp_ne_u32 vcc, 0, v15
    s_mov_b64 exec, vcc
    buffer_store_dwordx4 v[208:211], v17, s[44:47], s78 offen
    s_mov_b64 exec, -1
    s_mov_b32 s78, 16384
    v_cmp_ne_u32 vcc, 8, v15
    s_mov_b64 exec, vcc
    buffer_store_dwordx4 v[212:215], v18, s[44:47], s78 offen
    s_mov_b64 exec, -1
    s_mov_b32 s78, 32768
    v_cmp_ne_u32 vcc, 16, v15
    s_mov_b64 exec, vcc
    buffer_store_dwordx4 v[216:219], v17, s[44:47], s78 offen
    s_mov_b64 exec, -1
    s_mov_b32 s78, 49152
    v_cmp_ne_u32 vcc, 24, v15
    s_mov_b64 exec, vcc
    buffer_store_dwordx4 v[220:223], v18, s[44:47], s78 offen
    s_mov_b64 exec, -1
    s_barrier
    s_branch L_fin
L_H:
    v_lshrrev_b32 v196, 3, v2
    v_and_b32 v197, 7, v2
    v_lshrrev_b32 v198, 4, v2
    s_lshl_b32 s78, s69, 7
    s_lshl_b32 s79, s76, 5
    s_add_u32 s78, s78, s79
    s_lshl_b32 s78, s78, 11
    v_lshlrev_b32 v199, 11, v196
    v_add_u32 v199, s78, v199
    v_add_u32 v200, 0, v198
    v_xor_b32 v200, v200, v197
    v_lshl_add_u32 v200, v200, 4, v199
    v_add_u32 v4, 0, v200
    v_add_u32 v200, 4, v198
    v_xor_b32 v200, v200, v197
    v_lshl_add_u32 v200, v200, 4, v199
    v_add_u32 v5, 15360, v200
    v_add_u32 v200, 0, v198
    v_xor_b32 v200, v200, v197
    v_lshl_add_u32 v200, v200, 4, v199
    v_add_u32 v6, 30720, v200
    v_add_u32 v200, 4, v198
    v_xor_b32 v200, v200, v197
    v_lshl_add_u32 v200, v200, 4, v199
    v_add_u32 v7, 46080, v200
    v_mul_u32_u24 v199, 6144, v196
    s_lshl_b32 s78, s70, 7
    v_add_u32 v199, s78, v199
    v_and_b32 v200, 1, v198
    v_lshlrev_b32 v200, 1, v200
    v_xor_b32 v200, v200, v197
    v_xor_b32 v201, 4, v200
    v_lshl_add_u32 v200, v200, 4, v199
    v_lshl_add_u32 v201, v201, 4, v199
    s_mul_i32 s80, s76, 6
    s_add_u32 s78, s80, 0
    s_and_b32 s79, s78, 7
    s_mul_i32 s79, s79, 49152
    s_lshr_b32 s78, s78, 3
    s_lshl_b32 s78, s78, 11
    s_add_u32 s78, s78, s79
    v_add_u32 v8, s78, v200
    s_add_u32 s78, s80, 1
    s_and_b32 s79, s78, 7
    s_mul_i32 s79, s79, 49152
    s_lshr_b32 s78, s78, 3
    s_lshl_b32 s78, s78, 11
    s_add_u32 s78, s78, s79
    s_sub_u32 s78, s78, 1024
    v_add_u32 v9, s78, v201
    s_add_u32 s78, s80, 2
    s_and_b32 s79, s78, 7
    s_mul_i32 s79, s79, 49152
    s_lshr_b32 s78, s78, 3
    s_lshl_b32 s78, s78, 11
    s_add_u32 s78, s78, s79
    s_sub_u32 s78, s78, 2048
    v_add_u32 v10, s78, v200
    s_add_u32 s78, s80, 3
    s_and_b32 s79, s78, 7
    s_mul_i32 s79, s79, 49152
    s_lshr_b32 s78, s78, 3
    s_lshl_b32 s78, s78, 11
    s_add_u32 s78, s78, s79
    s_sub_u32 s78, s78, 3072
    v_add_u32 v11, s78, v201
    s_add_u32 s78, s80, 4
    s_and_b32 s79, s78, 7
    s_mul_i32 s79, s79, 49152
    s_lshr_b32 s78, s78, 3
    s_lshl_b32 s78, s78, 11
    s_add_u32 s78, s78, s79
    v_add_u32 v12, s78, v200
    s_add_u32 s78, s80, 5
    s_and_b32 s79, s78, 7
    s_mul_i32 s79, s79, 49152
    s_lshr_b32 s78, s78, 3
    s_lshl_b32 s78, s78, 11
    s_add_u32 s78, s78, s79
    s_sub_u32 s78, s78, 1024
    v_add_u32 v13, s78, v201
    v_lshlrev_b32 v14, 4, v2
    s_lshl_b32 s88, s76, 12
    s_mul_i32 s89, s76, 6144
    s_add_u32 s89, s89, 16384
    s_and_b32 s78, s70, 12
    s_and_b32 s79, s69, 8
    s_add_u32 s78, s78, s79
    s_and_b32 s78, s78, 15
    s_lshl_b32 s86, s78, 7
    s_mul_i32 s87, s78, 393216
    s_waitcnt lgkmcnt(0)
    s_mov_b32 s28, s4
    s_and_b32 s29, s5, 0xffff
    s_mov_b32 s30, 0x400000
    s_mov_b32 s31, 0x20000
    s_mov_b32 s32, s6
    s_and_b32 s33, s7, 0xffff
    s_mov_b32 s34, 0x600000
    s_mov_b32 s35, 0x20000
    s_add_u32 m0, s89, 118784
    s_nop 0
    buffer_load_dwordx4 v8, s[32:35], s87 offen offset:0  lds
    buffer_load_dwordx4 v9, s[32:35], s87 offen offset:1024  lds
    buffer_load_dwordx4 v10, s[32:35], s87 offen offset:2048  lds
    buffer_load_dwordx4 v11, s[32:35], s87 offen offset:3072  lds
    s_add_u32 m0, s88, 118784
    s_nop 0
    buffer_load_dwordx4 v4, s[28:31], s86 offen offset:0  lds
    buffer_load_dwordx4 v5, s[28:31], s86 offen offset:1024  lds
    buffer_load_dwordx4 v6, s[28:31], s86 offen offset:2048  lds
    buffer_load_dwordx4 v7, s[28:31], s86 offen offset:3072  lds
    s_add_u32 m0, s89, 122880
    s_add_u32 s86, s86, 128
    buffer_load_dwordx4 v12, s[32:35], s87 offen offset:0  lds
    buffer_load_dwordx4 v13, s[32:35], s87 offen offset:1024  lds
    s_add_u32 s87, s87, 393216
    s_and_b32 s86, s86, 2047
    s_cselect_b32 s87, s87, 0
    s_mov_b32 s60, s8
    s_and_b32 s61, s9, 0xffff
    s_mov_b32 s62, 0x10000
    s_mov_b32 s63, 0x20000
    s_mov_b32 s36, s26
    s_and_b32 s37, s27, 0xffff
    s_mov_b32 s38, 0x10000000
    s_mov_b32 s39, 0x20000
    s_load_dword s75, s[26:27], 0
    s_lshl_b32 s78, s70, 12
    s_lshl_b32 s79, s76, 10
    s_add_u32 s78, s78, s79
    s_add_u32 m0, s79, 159744
    s_nop 0
    buffer_load_dwordx4 v14, s[60:63], s78 offen lds
    s_cmp_lg_u32 s76, 0
    s_cbranch_scc1 Lpf_3
    s_getpc_b64 s[90:91]
Lpc:
    s_sub_u32 s90, s90, Lpc-sequential_preLN__linear_kernel_hedgehog__moe_arch_mod__prompt_kernel
    s_subb_u32 s91, s91, 0
    s_lshr_b32 s78, s2, 3
    s_lshl_b32 s78, s78, 10
    s_min_u32 s78, s78, (L_end-sequential_preLN__linear_kernel_hedgehog__moe_arch_mod__prompt_kernel-768)
    v_add_u32 v196, s78, v14
    global_load_dword v236, v196, s[90:91]
Lpf_3:
    s_add_u32 m0, s89, 36864
    s_nop 0
    buffer_load_dwordx4 v8, s[32:35], s87 offen offset:0  lds
    buffer_load_dwordx4 v9, s[32:35], s87 offen offset:1024  lds
    buffer_load_dwordx4 v10, s[32:35], s87 offen offset:2048  lds
    buffer_load_dwordx4 v11, s[32:35], s87 offen offset:3072  lds
    s_add_u32 m0, s88, 36864
    s_nop 0
    buffer_load_dwordx4 v4, s[28:31], s86 offen offset:0  lds
    buffer_load_dwordx4 v5, s[28:31], s86 offen offset:1024  lds
    buffer_load_dwordx4 v6, s[28:31], s86 offen offset:2048  lds
    buffer_load_dwordx4 v7, s[28:31], s86 offen offset:3072  lds
    s_add_u32 m0, s89, 40960
    s_add_u32 s86, s86, 128
    buffer_load_dwordx4 v12, s[32:35], s87 offen offset:0  lds
    buffer_load_dwordx4 v13, s[32:35], s87 offen offset:1024  lds
    s_add_u32 s87, s87, 393216
    s_and_b32 s86, s86, 2047
    s_cselect_b32 s87, s87, 0
    s_mov_b32 s40, s10
    s_and_b32 s41, s11, 0xffff
    s_mov_b32 s42, 0x200000
    s_mov_b32 s43, 0x20000
    s_mov_b32 s44, s22
    s_and_b32 s45, s23, 0xffff
    s_mov_b32 s46, 0x400000
    s_mov_b32 s47, 0x20000
    s_mov_b32 s48, s16
    s_and_b32 s49, s17, 0xffff
    s_mov_b32 s50, 0x700000
    s_mov_b32 s51, 0x20000
    s_mov_b32 s52, s18
    s_and_b32 s53, s19, 0xffff
    s_mov_b32 s54, 0x700000
    s_mov_b32 s55, 0x20000
    s_mov_b32 s56, s20
    s_and_b32 s57, s21, 0xffff
    s_mov_b32 s58, 0x700000
    s_mov_b32 s59, 0x20000
    v_mov_b32 v16, -1
    v_mov_b32 v17, -1
    v_mov_b32 v18, -1
    v_mov_b32 v19, -1
    s_lshl_b32 s94, s77, 14
    s_lshl_b32 s78, s76, 12
    s_add_u32 s94, s94, s78
    s_add_u32 s94, s94, 4194304
    s_lshl_b32 s95, s77, 13
    s_lshl_b32 s78, s76, 11
    s_add_u32 s95, s95, s78
    s_add_u32 s95, s95, 2097152
    s_mul_i32 s96, s77, 6144
    s_add_u32 s96, s96, s78
    s_add_u32 s96, s96, 524288
    s_lshl_b32 s79, s77, 10
    s_add_u32 s79, s79, 8388608
    s_add_u32 s81, s96, 1024
    s_cmp_eq_u32 s76, 3
    s_cselect_b32 s96, s79, s96
    s_cselect_b32 s81, s79, s81
    v_and_b32 v196, 15, v2
    v_lshrrev_b32 v197, 1, v196
    s_lshl_b32 s78, s76, 12
    v_lshlrev_b32 v199, 7, v196
    v_add_u32 v199, s78, v199
    v_add_u32 v200, 0, v198
    v_xor_b32 v200, v200, v197
    v_lshl_add_u32 v60, v200, 4, v199
    v_add_u32 v200, 4, v198
    v_xor_b32 v200, v200, v197
    v_lshl_add_u32 v61, v200, 4, v199
    v_bfe_u32 v196, v2, 2, 2
    v_and_b32 v197, 3, v2
    v_lshl_add_u32 v199, v198, 3, v196
    v_lshlrev_b32 v199, 7, v199
    v_lshl_add_u32 v199, v197, 3, v199
    v_lshrrev_b32 v196, 1, v196
    v_and_b32 v197, 1, v198
    v_lshl_add_u32 v196, v197, 1, v196
    s_mul_i32 s80, s76, 3
    s_add_u32 s78, s80, 0
    s_and_b32 s79, s78, 3
    s_lshr_b32 s78, s78, 2
    s_lshl_b32 s78, s78, 13
    s_add_u32 s78, s78, 16384
    v_xor_b32 v197, s79, v196
    v_lshl_add_u32 v197, v197, 5, v199
    v_add_u32 v240, s78, v197
    s_add_u32 s78, s80, 1
    s_and_b32 s79, s78, 3
    s_lshr_b32 s78, s78, 2
    s_lshl_b32 s78, s78, 13
    s_add_u32 s78, s78, 16384
    v_xor_b32 v197, s79, v196
    v_lshl_add_u32 v197, v197, 5, v199
    v_add_u32 v241, s78, v197
    s_add_u32 s78, s80, 2
    s_and_b32 s79, s78, 3
    s_lshr_b32 s78, s78, 2
    s_lshl_b32 s78, s78, 13
    s_add_u32 s78, s78, 16384
    v_xor_b32 v197, s79, v196
    v_lshl_add_u32 v197, v197, 5, v199
    v_add_u32 v242, s78, v197
    v_lshrrev_b32 v196, 3, v2
    v_and_b32 v197, 7, v2
    v_lshlrev_b32 v197, 4, v197
    v_mul_u32_u24 v243, 57344, v196
    v_add_u32 v243, v243, v197
    v_lshl_add_u32 v244, v196, 14, v197
    s_lshl_b32 s78, s74, 2
    s_add_u32 s78, s78, s76
    s_mul_i32 s79, s78, 458752
    s_lshl_b32 s80, s73, 7
    s_add_u32 s79, s79, s80
    s_cmp_ge_u32 s73, 56
    s_cselect_b32 s79, 0x8000000, s79
    v_add_u32 v243, s79, v243
    s_lshl_b32 s78, s78, 7
    s_lshl_b32 s80, s73, 17
    s_add_u32 s78, s78, s80
    v_add_u32 v244, s78, v244
    s_and_b32 s82, s70, 3
    s_and_b32 s83, s69, 7
    v_lshrrev_b32 v196, 3, v2
    v_and_b32 v197, 7, v2
    v_lshrrev_b32 v198, 4, v2
    s_lshl_b32 s78, s72, 7
    v_lshl_add_u32 v196, v196, 11, s78
    v_lshlrev_b32 v199, 1, v198
    v_xor_b32 v199, v199, v197
    v_lshl_add_u32 v245, v199, 4, v196
    s_lshl_b32 s78, s71, 2
    s_add_u32 s78, s78, s76
    s_lshl_b32 s78, s78, 16
    v_add_u32 v196, s78, v196
    v_xor_b32 v199, v198, v197
    v_lshl_add_u32 v246, v199, 4, v196
    v_xor_b32 v199, 4, v199
    v_lshl_add_u32 v247, v199, 4, v196
    s_waitcnt vmcnt(10)
    s_barrier
    s_cmp_lg_u32 s82, 0
    s_cbranch_scc1 Lsx_4
    v_add_u32 v196, 118784, v60
    v_add_u32 v197, 118784, v61
    ds_read_b128 v[20:23], v196 offset:0
    ds_read_b128 v[24:27], v196 offset:2048
    ds_read_b128 v[28:31], v197 offset:0
    ds_read_b128 v[32:35], v197 offset:2048
Lsx_4:
    s_cmp_lg_u32 s83, 0
    s_cbranch_scc1 Lsw_5
    v_add_u32 v198, 118784, v240
    v_add_u32 v199, 118784, v241
    v_add_u32 v200, 118784, v242
    ds_read_b64_tr_b16 v[36:37], v198 offset:0
    ds_read_b64_tr_b16 v[38:39], v198 offset:512
    ds_read_b64_tr_b16 v[40:41], v198 offset:4096
    ds_read_b64_tr_b16 v[42:43], v198 offset:4608
    ds_read_b64_tr_b16 v[44:45], v199 offset:0
    ds_read_b64_tr_b16 v[46:47], v199 offset:512
    ds_read_b64_tr_b16 v[48:49], v199 offset:4096
    ds_read_b64_tr_b16 v[50:51], v199 offset:4608
    ds_read_b64_tr_b16 v[52:53], v200 offset:0
    ds_read_b64_tr_b16 v[54:55], v200 offset:512
    ds_read_b64_tr_b16 v[56:57], v200 offset:4096
    ds_read_b64_tr_b16 v[58:59], v200 offset:4608
Lsw_5:
    s_add_u32 m0, s89, 77824
    s_nop 0
    buffer_load_dwordx4 v8, s[32:35], s87 offen offset:0  lds
    buffer_load_dwordx4 v9, s[32:35], s87 offen offset:1024  lds
    buffer_load_dwordx4 v10, s[32:35], s87 offen offset:2048  lds
    buffer_load_dwordx4 v11, s[32:35], s87 offen offset:3072  lds
    s_add_u32 m0, s88, 77824
    s_nop 0
    buffer_load_dwordx4 v4, s[28:31], s86 offen offset:0  lds
    buffer_load_dwordx4 v5, s[28:31], s86 offen offset:1024  lds
    buffer_load_dwordx4 v6, s[28:31], s86 offen offset:2048  lds
    buffer_load_dwordx4 v7, s[28:31], s86 offen offset:3072  lds
    s_add_u32 m0, s89, 81920
    s_add_u32 s86, s86, 128
    buffer_load_dwordx4 v12, s[32:35], s87 offen offset:0  lds
    buffer_load_dwordx4 v13, s[32:35], s87 offen offset:1024  lds
    s_add_u32 s87, s87, 393216
    s_and_b32 s86, s86, 2047
    s_cselect_b32 s87, s87, 0
    buffer_store_dwordx4 v[16:19], v14, s[36:39], s95 offen offset:0 sc1
    s_waitcnt lgkmcnt(0)
    s_mul_i32 s75, s75, 0x9E3779B1
    s_add_u32 s75, s75, 0x7F4A7C15
    s_waitcnt vmcnt(11)
    s_waitcnt lgkmcnt(0)
    s_barrier
    s_cmp_lg_u32 s82, 1
    s_cbranch_scc1 Lsx_6
    v_add_u32 v196, 36864, v60
    v_add_u32 v197, 36864, v61
    ds_read_b128 v[20:23], v196 offset:0
    ds_read_b128 v[24:27], v196 offset:2048
    ds_read_b128 v[28:31], v197 offset:0
    ds_read_b128 v[32:35], v197 offset:2048
Lsx_6:
    s_cmp_lg_u32 s83, 1
    s_cbranch_scc1 Lsw_7
    v_add_u32 v198, 36864, v240
    v_add_u32 v199, 36864, v241
    v_add_u32 v200, 36864, v242
    ds_read_b64_tr_b16 v[36:37], v198 offset:0
    ds_read_b64_tr_b16 v[38:39], v198 offset:512
    ds_read_b64_tr_b16 v[40:41], v198 offset:4096
    ds_read_b64_tr_b16 v[42:43], v198 offset:4608
    ds_read_b64_tr_b16 v[44:45], v199 offset:0
    ds_read_b64_tr_b16 v[46:47], v199 offset:512
    ds_read_b64_tr_b16 v[48:49], v199 offset:4096
    ds_read_b64_tr_b16 v[50:51], v199 offset:4608
    ds_read_b64_tr_b16 v[52:53], v200 offset:0
    ds_read_b64_tr_b16 v[54:55], v200 offset:512
    ds_read_b64_tr_b16 v[56:57], v200 offset:4096
    ds_read_b64_tr_b16 v[58:59], v200 offset:4608
Lsw_7:
    s_add_u32 m0, s89, 118784
    s_nop 0
    buffer_load_dwordx4 v8, s[32:35], s87 offen offset:0  lds
    buffer_load_dwordx4 v9, s[32:35], s87 offen offset:1024  lds
    buffer_load_dwordx4 v10, s[32:35], s87 offen offset:2048  lds
    buffer_load_dwordx4 v11, s[32:35], s87 offen offset:3072  lds
    s_add_u32 m0, s88, 118784
    s_nop 0
    buffer_load_dwordx4 v4, s[28:31], s86 offen offset:0  lds
    buffer_load_dwordx4 v5, s[28:31], s86 offen offset:1024  lds
    buffer_load_dwordx4 v6, s[28:31], s86 offen offset:2048  lds
    buffer_load_dwordx4 v7, s[28:31], s86 offen offset:3072  lds
    s_add_u32 m0, s89, 122880
    s_add_u32 s86, s86, 128
    buffer_load_dwordx4 v12, s[32:35], s87 offen offset:0  lds
    buffer_load_dwordx4 v13, s[32:35], s87 offen offset:1024  lds
    s_add_u32 s87, s87, 393216
    s_and_b32 s86, s86, 2047
    s_cselect_b32 s87, s87, 0
    buffer_store_dwordx4 v[16:19], v14, s[36:39], s95 offen offset:1024 sc1
    s_waitcnt vmcnt(12)
    s_waitcnt lgkmcnt(0)
    s_barrier
    s_cmp_lg_u32 s82, 2
    s_cbranch_scc1 Lsx_8
    v_add_u32 v196, 77824, v60
    v_add_u32 v197, 77824, v61
    ds_read_b128 v[20:23], v196 offset:0
    ds_read_b128 v[24:27], v196 offset:2048
    ds_read_b128 v[28:31], v197 offset:0
    ds_read_b128 v[32:35], v197 offset:2048
Lsx_8:
    s_cmp_lg_u32 s83, 2
    s_cbranch_scc1 Lsw_9
    v_add_u32 v198, 77824, v240
    v_add_u32 v199, 77824, v241
    v_add_u32 v200, 77824, v242
    ds_read_b64_tr_b16 v[36:37], v198 offset:0
    ds_read_b64_tr_b16 v[38:39], v198 offset:512
    ds_read_b64_tr_b16 v[40:41], v198 offset:4096
    ds_read_b64_tr_b16 v[42:43], v198 offset:4608
    ds_read_b64_tr_b16 v[44:45], v199 offset:0
    ds_read_b64_tr_b16 v[46:47], v199 offset:512
    ds_read_b64_tr_b16 v[48:49], v199 offset:4096
    ds_read_b64_tr_b16 v[50:51], v199 offset:4608
    ds_read_b64_tr_b16 v[52:53], v200 offset:0
    ds_read_b64_tr_b16 v[54:55], v200 offset:512
    ds_read_b64_tr_b16 v[56:57], v200 offset:4096
    ds_read_b64_tr_b16 v[58:59], v200 offset:4608
Lsw_9:
    s_add_u32 m0, s89, 36864
    s_nop 0
    buffer_load_dwordx4 v8, s[32:35], s87 offen offset:0  lds
    buffer_load_dwordx4 v9, s[32:35], s87 offen offset:1024  lds
    buffer_load_dwordx4 v10, s[32:35], s87 offen offset:2048  lds
    buffer_load_dwordx4 v11, s[32:35], s87 offen offset:3072  lds
    s_add_u32 m0, s88, 36864
    s_nop 0
    buffer_load_dwordx4 v4, s[28:31], s86 offen offset:0  lds
    buffer_load_dwordx4 v5, s[28:31], s86 offen offset:1024  lds
    buffer_load_dwordx4 v6, s[28:31], s86 offen offset:2048  lds
    buffer_load_dwordx4 v7, s[28:31], s86 offen offset:3072  lds
    s_add_u32 m0, s89, 40960
    s_add_u32 s86, s86, 128
    buffer_load_dwordx4 v12, s[32:35], s87 offen offset:0  lds
    buffer_load_dwordx4 v13, s[32:35], s87 offen offset:1024  lds
    s_add_u32 s87, s87, 393216
    s_and_b32 s86, s86, 2047
    s_cselect_b32 s87, s87, 0
    buffer_store_dwordx4 v[16:19], v14, s[36:39], s96 offen offset:0 sc1
    s_waitcnt vmcnt(12)
    s_waitcnt lgkmcnt(0)
    s_barrier
    s_cmp_lg_u32 s82, 3
    s_cbranch_scc1 Lsx_10
    v_add_u32 v196, 118784, v60
    v_add_u32 v197, 118784, v61
    ds_read_b128 v[20:23], v196 offset:0
    ds_read_b128 v[24:27], v196 offset:2048
    ds_read_b128 v[28:31], v197 offset:0
    ds_read_b128 v[32:35], v197 offset:2048
Lsx_10:
    s_cmp_lg_u32 s83, 3
    s_cbranch_scc1 Lsw_11
    v_add_u32 v198, 118784, v240
    v_add_u32 v199, 118784, v241
    v_add_u32 v200, 118784, v242
    ds_read_b64_tr_b16 v[36:37], v198 offset:0
    ds_read_b64_tr_b16 v[38:39], v198 offset:512
    ds_read_b64_tr_b16 v[40:41], v198 offset:4096
    ds_read_b64_tr_b16 v[42:43], v198 offset:4608
    ds_read_b64_tr_b16 v[44:45], v199 offset:0
    ds_read_b64_tr_b16 v[46:47], v199 offset:512
    ds_read_b64_tr_b16 v[48:49], v199 offset:4096
    ds_read_b64_tr_b16 v[50:51], v199 offset:4608
    ds_read_b64_tr_b16 v[52:53], v200 offset:0
    ds_read_b64_tr_b16 v[54:55], v200 offset:512
    ds_read_b64_tr_b16 v[56:57], v200 offset:4096
    ds_read_b64_tr_b16 v[58:59], v200 offset:4608
Lsw_11:
    s_add_u32 m0, s89, 77824
    s_nop 0
    buffer_load_dwordx4 v8, s[32:35], s87 offen offset:0  lds
    buffer_load_dwordx4 v9, s[32:35], s87 offen offset:1024  lds
    buffer_load_dwordx4 v10, s[32:35], s87 offen offset:2048  lds
    buffer_load_dwordx4 v11, s[32:35], s87 offen offset:3072  lds
    s_add_u32 m0, s88, 77824
    s_nop 0
    buffer_load_dwordx4 v4, s[28:31], s86 offen offset:0  lds
    buffer_load_dwordx4 v5, s[28:31], s86 offen offset:1024  lds
    buffer_load_dwordx4 v6, s[28:31], s86 offen offset:2048  lds
    buffer_load_dwordx4 v7, s[28:31], s86 offen offset:3072  lds
    s_add_u32 m0, s89, 81920
    s_add_u32 s86, s86, 128
    buffer_load_dwordx4 v12, s[32:35], s87 offen offset:0  lds
    buffer_load_dwordx4 v13, s[32:35], s87 offen offset:1024  lds
    s_add_u32 s87, s87, 393216
    s_and_b32 s86, s86, 2047
    s_cselect_b32 s87, s87, 0
    buffer_store_dwordx4 v[16:19], v14, s[36:39], s81 offen offset:0 sc1
    s_waitcnt vmcnt(12)
    s_waitcnt lgkmcnt(0)
    s_barrier
    s_cmp_lg_u32 s83, 4
    s_cbranch_scc1 Lsw_12
    v_add_u32 v198, 36864, v240
    v_add_u32 v199, 36864, v241
    v_add_u32 v200, 36864, v242
    ds_read_b64_tr_b16 v[36:37], v198 offset:0
    ds_read_b64_tr_b16 v[38:39], v198 offset:512
    ds_read_b64_tr_b16 v[40:41], v198 offset:4096
    ds_read_b64_tr_b16 v[42:43], v198 offset:4608
    ds_read_b64_tr_b16 v[44:45], v199 offset:0
    ds_read_b64_tr_b16 v[46:47], v199 offset:512
    ds_read_b64_tr_b16 v[48:49], v199 offset:4096
    ds_read_b64_tr_b16 v[50:51], v199 offset:4608
    ds_read_b64_tr_b16 v[52:53], v200 offset:0
    ds_read_b64_tr_b16 v[54:55], v200 offset:512
    ds_read_b64_tr_b16 v[56:57], v200 offset:4096
    ds_read_b64_tr_b16 v[58:59], v200 offset:4608
Lsw_12:
    s_add_u32 m0, s89, 118784
    s_nop 0
    buffer_load_dwordx4 v8, s[32:35], s87 offen offset:0  lds
    buffer_load_dwordx4 v9, s[32:35], s87 offen offset:1024  lds
    buffer_load_dwordx4 v10, s[32:35], s87 offen offset:2048  lds
    buffer_load_dwordx4 v11, s[32:35], s87 offen offset:3072  lds
    s_add_u32 m0, s88, 118784
    s_nop 0
    buffer_load_dwordx4 v4, s[28:31], s86 offen offset:0  lds
    buffer_load_dwordx4 v5, s[28:31], s86 offen offset:1024  lds
    buffer_load_dwordx4 v6, s[28:31], s86 offen offset:2048  lds
    buffer_load_dwordx4 v7, s[28:31], s86 offen offset:3072  lds
    s_add_u32 m0, s89, 122880
    s_add_u32 s86, s86, 128
    buffer_load_dwordx4 v12, s[32:35], s87 offen offset:0  lds
    buffer_load_dwordx4 v13, s[32:35], s87 offen offset:1024  lds
    s_add_u32 s87, s87, 393216
    s_and_b32 s86, s86, 2047
    s_cselect_b32 s87, s87, 0
    buffer_store_dwordx4 v[16:19], v14, s[36:39], s94 offen offset:0 sc1
    s_mov_b32 s78, 0
    buffer_load_dwordx4 v[64:67], v243, s[48:51], s78 offen nt
    s_mov_b32 s78, 0
    buffer_load_dwordx4 v[96:99], v243, s[52:55], s78 offen nt
    s_waitcnt vmcnt(14)
    s_waitcnt lgkmcnt(0)
    s_barrier
    s_cmp_lg_u32 s83, 5
    s_cbranch_scc1 Lsw_13
    v_add_u32 v198, 77824, v240
    v_add_u32 v199, 77824, v241
    v_add_u32 v200, 77824, v242
    ds_read_b64_tr_b16 v[36:37], v198 offset:0
    ds_read_b64_tr_b16 v[38:39], v198 offset:512
    ds_read_b64_tr_b16 v[40:41], v198 offset:4096
    ds_read_b64_tr_b16 v[42:43], v198 offset:4608
    ds_read_b64_tr_b16 v[44:45], v199 offset:0
    ds_read_b64_tr_b16 v[46:47], v199 offset:512
    ds_read_b64_tr_b16 v[48:49], v199 offset:4096
    ds_read_b64_tr_b16 v[50:51], v199 offset:4608
    ds_read_b64_tr_b16 v[52:53], v200 offset:0
    ds_read_b64_tr_b16 v[54:55], v200 offset:512
    ds_read_b64_tr_b16 v[56:57], v200 offset:4096
    ds_read_b64_tr_b16 v[58:59], v200 offset:4608
Lsw_13:
    s_add_u32 m0, s89, 36864
    s_nop 0
    buffer_load_dwordx4 v8, s[32:35], s87 offen offset:0  lds
    buffer_load_dwordx4 v9, s[32:35], s87 offen offset:1024  lds
    buffer_load_dwordx4 v10, s[32:35], s87 offen offset:2048  lds
    buffer_load_dwordx4 v11, s[32:35], s87 offen offset:3072  lds
    s_add_u32 m0, s88, 36864
    s_nop 0
    buffer_load_dwordx4 v4, s[28:31], s86 offen offset:0  lds
    buffer_load_dwordx4 v5, s[28:31], s86 offen offset:1024  lds
    buffer_load_dwordx4 v6, s[28:31], s86 offen offset:2048  lds
    buffer_load_dwordx4 v7, s[28:31], s86 offen offset:3072  lds
    s_add_u32 m0, s89, 40960
    s_add_u32 s86, s86, 128
    buffer_load_dwordx4 v12, s[32:35], s87 offen offset:0  lds
    buffer_load_dwordx4 v13, s[32:35], s87 offen offset:1024  lds
    s_add_u32 s87, s87, 393216
    s_and_b32 s86, s86, 2047
    s_cselect_b32 s87, s87, 0
    buffer_store_dwordx4 v[16:19], v14, s[36:39], s94 offen offset:1024 sc1
    s_mov_b32 s78, 7168
    buffer_load_dwordx4 v[68:71], v243, s[48:51], s78 offen nt
    s_mov_b32 s78, 7168
    buffer_load_dwordx4 v[100:103], v243, s[52:55], s78 offen nt
    s_waitcnt vmcnt(16)
    s_waitcnt lgkmcnt(0)
    s_barrier
    s_cmp_lg_u32 s83, 6
    s_cbranch_scc1 Lsw_14
    v_add_u32 v198, 118784, v240
    v_add_u32 v199, 118784, v241
    v_add_u32 v200, 118784, v242
    ds_read_b64_tr_b16 v[36:37], v198 offset:0
    ds_read_b64_tr_b16 v[38:39], v198 offset:512
    ds_read_b64_tr_b16 v[40:41], v198 offset:4096
    ds_read_b64_tr_b16 v[42:43], v198 offset:4608
    ds_read_b64_tr_b16 v[44:45], v199 offset:0
    ds_read_b64_tr_b16 v[46:47], v199 offset:512
    ds_read_b64_tr_b16 v[48:49], v199 offset:4096
    ds_read_b64_tr_b16 v[50:51], v199 offset:4608
    ds_read_b64_tr_b16 v[52:53], v200 offset:0
    ds_read_b64_tr_b16 v[54:55], v200 offset:512
    ds_read_b64_tr_b16 v[56:57], v200 offset:4096
    ds_read_b64_tr_b16 v[58:59], v200 offset:4608
Lsw_14:
    s_add_u32 m0, s89, 77824
    s_nop 0
    buffer_load_dwordx4 v8, s[32:35], s87 offen offset:0  lds
    buffer_load_dwordx4 v9, s[32:35], s87 offen offset:1024  lds
    buffer_load_dwordx4 v10, s[32:35], s87 offen offset:2048  lds
    buffer_load_dwordx4 v11, s[32:35], s87 offen offset:3072  lds
    s_add_u32 m0, s88, 77824
    s_nop 0
    buffer_load_dwordx4 v4, s[28:31], s86 offen offset:0  lds
    buffer_load_dwordx4 v5, s[28:31], s86 offen offset:1024  lds
    buffer_load_dwordx4 v6, s[28:31], s86 offen offset:2048  lds
    buffer_load_dwordx4 v7, s[28:31], s86 offen offset:3072  lds
    s_add_u32 m0, s89, 81920
    s_add_u32 s86, s86, 128
    buffer_load_dwordx4 v12, s[32:35], s87 offen offset:0  lds
    buffer_load_dwordx4 v13, s[32:35], s87 offen offset:1024  lds
    s_add_u32 s87, s87, 393216
    s_and_b32 s86, s86, 2047
    s_cselect_b32 s87, s87, 0
    buffer_store_dwordx4 v[16:19], v14, s[36:39], s94 offen offset:2048 sc1
    s_mov_b32 s78, 14336
    buffer_load_dwordx4 v[72:75], v243, s[48:51], s78 offen nt
    s_mov_b32 s78, 14336
    buffer_load_dwordx4 v[104:107], v243, s[52:55], s78 offen nt
    s_waitcnt vmcnt(16)
    s_waitcnt lgkmcnt(0)
    s_barrier
    s_cmp_lg_u32 s83, 7
    s_cbranch_scc1 Lsw_15
    v_add_u32 v198, 36864, v240
    v_add_u32 v199, 36864, v241
    v_add_u32 v200, 36864, v242
    ds_read_b64_tr_b16 v[36:37], v198 offset:0
    ds_read_b64_tr_b16 v[38:39], v198 offset:512
    ds_read_b64_tr_b16 v[40:41], v198 offset:4096
    ds_read_b64_tr_b16 v[42:43], v198 offset:4608
    ds_read_b64_tr_b16 v[44:45], v199 offset:0
    ds_read_b64_tr_b16 v[46:47], v199 offset:512
    ds_read_b64_tr_b16 v[48:49], v199 offset:4096
    ds_read_b64_tr_b16 v[50:51], v199 offset:4608
    ds_read_b64_tr_b16 v[52:53], v200 offset:0
    ds_read_b64_tr_b16 v[54:55], v200 offset:512
    ds_read_b64_tr_b16 v[56:57], v200 offset:4096
    ds_read_b64_tr_b16 v[58:59], v200 offset:4608
Lsw_15:
    s_add_u32 m0, s89, 118784
    s_nop 0
    buffer_load_dwordx4 v8, s[32:35], s87 offen offset:0  lds
    buffer_load_dwordx4 v9, s[32:35], s87 offen offset:1024  lds
    buffer_load_dwordx4 v10, s[32:35], s87 offen offset:2048  lds
    buffer_load_dwordx4 v11, s[32:35], s87 offen offset:3072  lds
    s_add_u32 m0, s88, 118784
    s_nop 0
    buffer_load_dwordx4 v4, s[28:31], s86 offen offset:0  lds
    buffer_load_dwordx4 v5, s[28:31], s86 offen offset:1024  lds
    buffer_load_dwordx4 v6, s[28:31], s86 offen offset:2048  lds
    buffer_load_dwordx4 v7, s[28:31], s86 offen offset:3072  lds
    s_add_u32 m0, s89, 122880
    s_add_u32 s86, s86, 128
    buffer_load_dwordx4 v12, s[32:35], s87 offen offset:0  lds
    buffer_load_dwordx4 v13, s[32:35], s87 offen offset:1024  lds
    s_add_u32 s87, s87, 393216
    s_and_b32 s86, s86, 2047
    s_cselect_b32 s87, s87, 0
    buffer_store_dwordx4 v[16:19], v14, s[36:39], s94 offen offset:3072 sc1
    s_mov_b32 s78, 21504
    buffer_load_dwordx4 v[76:79], v243, s[48:51], s78 offen nt
    s_mov_b32 s78, 21504
    buffer_load_dwordx4 v[108:111], v243, s[52:55], s78 offen nt
    s_waitcnt vmcnt(16)
    s_waitcnt lgkmcnt(0)
    s_barrier
    s_add_u32 m0, s89, 36864
    s_nop 0
    buffer_load_dwordx4 v8, s[32:35], s87 offen offset:0  lds
    buffer_load_dwordx4 v9, s[32:35], s87 offen offset:1024  lds
    buffer_load_dwordx4 v10, s[32:35], s87 offen offset:2048  lds
    buffer_load_dwordx4 v11, s[32:35], s87 offen offset:3072  lds
    s_add_u32 m0, s88, 36864
    s_nop 0
    buffer_load_dwordx4 v4, s[28:31], s86 offen offset:0  lds
    buffer_load_dwordx4 v5, s[28:31], s86 offen offset:1024  lds
    buffer_load_dwordx4 v6, s[28:31], s86 offen offset:2048  lds
    buffer_load_dwordx4 v7, s[28:31], s86 offen offset:3072  lds
    s_add_u32 m0, s89, 40960
    s_add_u32 s86, s86, 128
    buffer_load_dwordx4 v12, s[32:35], s87 offen offset:0  lds
    buffer_load_dwordx4 v13, s[32:35], s87 offen offset:1024  lds
    s_add_u32 s87, s87, 393216
    s_and_b32 s86, s86, 2047
    s_cselect_b32 s87, s87, 0
    s_mov_b32 s78, 28672
    buffer_load_dwordx4 v[80:83], v243, s[48:51], s78 offen nt
    s_mov_b32 s78, 28672
    buffer_load_dwordx4 v[112:115], v243, s[52:55], s78 offen nt
    v_mov_b32 v200, 0x3f803f80
    v_mov_b32 v201, 0x3f803f80
    v_mov_b32 v202, 0x3f803f80
    v_mov_b32 v203, 0x3f803f80
    s_nop 1
    v_mfma_f32_16x16x32_bf16 v[204:207], v[200:203], v[20:23], 0
    v_mfma_f32_16x16x32_bf16 v[212:215], v[20:23], v[20:23], 0
    v_mfma_f32_16x16x32_bf16 v[208:211], v[200:203], v[24:27], 0
    v_mfma_f32_16x16x32_bf16 v[216:219], v[24:27], v[24:27], 0
    v_mfma_f32_16x16x32_bf16 v[220:223], v[200:203], v[36:39], 0
    v_mfma_f32_16x16x32_bf16 v[224:227], v[200:203], v[44:47], 0
    v_mfma_f32_16x16x32_bf16 v[228:231], v[200:203], v[52:55], 0
    v_mfma_f32_16x16x32_bf16 v[204:207], v[200:203], v[28:31], v[204:207]
    v_mfma_f32_16x16x32_bf16 v[212:215], v[28:31], v[28:31], v[212:215]
    v_mfma_f32_16x16x32_bf16 v[208:211], v[200:203], v[32:35], v[208:211]
    v_mfma_f32_16x16x32_bf16 v[216:219], v[32:35], v[32:35], v[216:219]
    v_mfma_f32_16x16x32_bf16 v[220:223], v[200:203], v[40:43], v[220:223]
    v_mfma_f32_16x16x32_bf16 v[224:227], v[200:203], v[48:51], v[224:227]
    v_mfma_f32_16x16x32_bf16 v[228:231], v[200:203], v[56:59], v[228:231]
    v_and_b32 v196, 3, v2
    v_cmp_eq_u32 s[90:91], 1, v196
    v_cmp_eq_u32 s[92:93], 2, v196
    v_cmp_eq_u32 vcc, 3, v196
    v_cndmask_b32 v212, v212, v213, s[90:91]
    v_cndmask_b32 v212, v212, v214, s[92:93]
    v_cndmask_b32 v205, v212, v215, vcc
    v_cndmask_b32 v216, v216, v217, s[90:91]
    v_cndmask_b32 v216, v216, v218, s[92:93]
    v_cndmask_b32 v209, v216, v219, vcc
    v_lshrrev_b32 v196, 4, v2
    v_cmp_eq_u32 s[90:91], 1, v196
    v_cmp_eq_u32 vcc, 2, v196
    s_nop 0
    v_cndmask_b32 v220, v220, v224, s[90:91]
    v_cndmask_b32 v220, v220, v228, vcc
    s_mul_i32 s78, s77, 768
    s_mul_i32 s79, s76, 192
    s_add_u32 s78, s78, s79
    s_add_u32 s78, s78, 327680
    v_lshlrev_b32 v197, 2, v2
    s_mov_b32 exec_hi, 0xffff
    buffer_store_dword v220, v197, s[36:39], s78 offen sc1
    s_lshl_b32 s78, s69, 4
    s_add_u32 s78, s78, s70
    s_lshl_b32 s78, s78, 10
    s_lshl_b32 s79, s76, 8
    s_add_u32 s78, s78, s79
    s_add_u32 s78, s78, 65536
    s_mov_b64 exec, -1
    v_and_b32 v197, 15, v2
    v_lshlrev_b32 v197, 3, v197
    s_mov_b32 exec_lo, 0x00f0000f
    s_mov_b32 exec_hi, 0xf0000f00
    buffer_store_dwordx2 v[204:205], v197, s[36:39], s78 offen offset:0 sc1
    buffer_store_dwordx2 v[208:209], v197, s[36:39], s78 offen offset:128 sc1
    s_mov_b64 exec, -1
    s_waitcnt vmcnt(18)
    s_barrier
    s_add_u32 m0, s89, 77824
    s_nop 0
    buffer_load_dwordx4 v8, s[32:35], s87 offen offset:0  lds
    buffer_load_dwordx4 v9, s[32:35], s87 offen offset:1024  lds
    buffer_load_dwordx4 v10, s[32:35], s87 offen offset:2048  lds
    buffer_load_dwordx4 v11, s[32:35], s87 offen offset:3072  lds
    s_add_u32 m0, s88, 77824
    s_nop 0
    buffer_load_dwordx4 v4, s[28:31], s86 offen offset:0  lds
    buffer_load_dwordx4 v5, s[28:31], s86 offen offset:1024  lds
    buffer_load_dwordx4 v6, s[28:31], s86 offen offset:2048  lds
    buffer_load_dwordx4 v7, s[28:31], s86 offen offset:3072  lds
    s_add_u32 m0, s89, 81920
    s_add_u32 s86, s86, 128
    buffer_load_dwordx4 v12, s[32:35], s87 offen offset:0  lds
    buffer_load_dwordx4 v13, s[32:35], s87 offen offset:1024  lds
    s_add_u32 s87, s87, 393216
    s_and_b32 s86, s86, 2047
    s_cselect_b32 s87, s87, 0
    s_mov_b32 s78, 35840
    buffer_load_dwordx4 v[84:87], v243, s[48:51], s78 offen nt
    s_mov_b32 s78, 35840
    buffer_load_dwordx4 v[116:119], v243, s[52:55], s78 offen nt
    s_waitcnt vmcnt(12)
    s_barrier
    s_add_u32 m0, s89, 118784
    s_nop 0
    buffer_load_dwordx4 v8, s[32:35], s87 offen offset:0  lds
    buffer_load_dwordx4 v9, s[32:35], s87 offen offset:1024  lds
    buffer_load_dwordx4 v10, s[32:35], s87 offen offset:2048  lds
    buffer_load_dwordx4 v11, s[32:35], s87 offen offset:3072  lds
    s_add_u32 m0, s88, 118784
    s_nop 0
    buffer_load_dwordx4 v4, s[28:31], s86 offen offset:0  lds
    buffer_load_dwordx4 v5, s[28:31], s86 offen offset:1024  lds
    buffer_load_dwordx4 v6, s[28:31], s86 offen offset:2048  lds
    buffer_load_dwordx4 v7, s[28:31], s86 offen offset:3072  lds
    s_add_u32 m0, s89, 122880
    s_add_u32 s86, s86, 128
    buffer_load_dwordx4 v12, s[32:35], s87 offen offset:0  lds
    buffer_load_dwordx4 v13, s[32:35], s87 offen offset:1024  lds
    s_add_u32 s87, s87, 393216
    s_and_b32 s86, s86, 2047
    s_cselect_b32 s87, s87, 0
    s_mov_b32 s78, 43008
    buffer_load_dwordx4 v[88:91], v243, s[48:51], s78 offen nt
    s_mov_b32 s78, 43008
    buffer_load_dwordx4 v[120:123], v243, s[52:55], s78 offen nt
    s_cmp_lg_u32 s76, 0
    s_cbranch_scc1 Lfl_16
    s_lshl_b32 s78, s77, 7
    s_add_u32 s78, s78, 4096
    v_mov_b32 v196, s75
    v_lshlrev_b32 v197, 2, v2
    s_mov_b64 exec, 0xffffffff
    buffer_store_dword v196, v197, s[36:39], s78 offen sc1
    s_mov_b64 exec, -1
Lfl_16:
    s_waitcnt vmcnt(14)
    s_barrier
    s_add_u32 m0, s89, 36864
    s_nop 0
    buffer_load_dwordx4 v8, s[32:35], s87 offen offset:0  lds
    buffer_load_dwordx4 v9, s[32:35], s87 offen offset:1024  lds
    buffer_load_dwordx4 v10, s[32:35], s87 offen offset:2048  lds
    buffer_load_dwordx4 v11, s[32:35], s87 offen offset:3072  lds
    s_add_u32 m0, s88, 36864
    s_nop 0
    buffer_load_dwordx4 v4, s[28:31], s86 offen offset:0  lds
    buffer_load_dwordx4 v5, s[28:31], s86 offen offset:1024  lds
    buffer_load_dwordx4 v6, s[28:31], s86 offen offset:2048  lds
    buffer_load_dwordx4 v7, s[28:31], s86 offen offset:3072  lds
    s_add_u32 m0, s89, 40960
    s_add_u32 s86, s86, 128
    buffer_load_dwordx4 v12, s[32:35], s87 offen offset:0  lds
    buffer_load_dwordx4 v13, s[32:35], s87 offen offset:1024  lds
    s_add_u32 s87, s87, 393216
    s_and_b32 s86, s86, 2047
    s_cselect_b32 s87, s87, 0
    s_mov_b32 s78, 50176
    buffer_load_dwordx4 v[92:95], v243, s[48:51], s78 offen nt
    s_mov_b32 s78, 50176
    buffer_load_dwordx4 v[124:127], v243, s[52:55], s78 offen nt
    s_waitcnt vmcnt(14)
    s_barrier
    s_add_u32 m0, s89, 77824
    s_nop 0
    buffer_load_dwordx4 v8, s[32:35], s87 offen offset:0  lds
    buffer_load_dwordx4 v9, s[32:35], s87 offen offset:1024  lds
    buffer_load_dwordx4 v10, s[32:35], s87 offen offset:2048  lds
    buffer_load_dwordx4 v11, s[32:35], s87 offen offset:3072  lds
    s_add_u32 m0, s88, 77824
    s_nop 0
    buffer_load_dwordx4 v4, s[28:31], s86 offen offset:0  lds
    buffer_load_dwordx4 v5, s[28:31], s86 offen offset:1024  lds
    buffer_load_dwordx4 v6, s[28:31], s86 offen offset:2048  lds
    buffer_load_dwordx4 v7, s[28:31], s86 offen offset:3072  lds
    s_add_u32 m0, s89, 81920
    s_add_u32 s86, s86, 128
    buffer_load_dwordx4 v12, s[32:35], s87 offen offset:0  lds
    buffer_load_dwordx4 v13, s[32:35], s87 offen offset:1024  lds
    s_add_u32 s87, s87, 393216
    s_and_b32 s86, s86, 2047
    s_cselect_b32 s87, s87, 0
    s_waitcnt vmcnt(12)
    s_barrier
    s_add_u32 m0, s89, 118784
    s_nop 0
    buffer_load_dwordx4 v8, s[32:35], s87 offen offset:0  lds
    buffer_load_dwordx4 v9, s[32:35], s87 offen offset:1024  lds
    buffer_load_dwordx4 v10, s[32:35], s87 offen offset:2048  lds
    buffer_load_dwordx4 v11, s[32:35], s87 offen offset:3072  lds
    s_add_u32 m0, s88, 118784
    s_nop 0
    buffer_load_dwordx4 v4, s[28:31], s86 offen offset:0  lds
    buffer_load_dwordx4 v5, s[28:31], s86 offen offset:1024  lds
    buffer_load_dwordx4 v6, s[28:31], s86 offen offset:2048  lds
    buffer_load_dwordx4 v7, s[28:31], s86 offen offset:3072  lds
    s_add_u32 m0, s89, 122880
    s_add_u32 s86, s86, 128
    buffer_load_dwordx4 v12, s[32:35], s87 offen offset:0  lds
    buffer_load_dwordx4 v13, s[32:35], s87 offen offset:1024  lds
    s_add_u32 s87, s87, 393216
    s_and_b32 s86, s86, 2047
    s_cselect_b32 s87, s87, 0
    s_cmp_lg_u32 s76, 0
    s_cbranch_scc1 Lpo_17
    v_and_b32 v196, 15, v2
    v_lshlrev_b32 v197, 4, v196
    v_add_u32 v197, s69, v197
    s_lshl_b32 s78, s70, 4
    v_add_u32 v196, s78, v196
    v_and_b32 v198, 16, v2
    v_cmp_eq_u32 vcc, 0, v198
    s_nop 1
    v_cndmask_b32 v196, v196, v197, vcc
    v_lshlrev_b32 v196, 7, v196
    s_mov_b32 s78, 4096
    s_mov_b64 exec, 0xffffffff
    s_mov_b32 s85, 0
Lspin_18:
    s_add_u32 s85, s85, 1
    s_cmp_gt_u32 s85, 400000
    s_cbranch_scc1 L_end
    buffer_load_dword v197, v196, s[36:39], s78 offen sc1
    s_waitcnt vmcnt(0)
    v_cmp_ne_u32 vcc, s75, v197
    s_cbranch_vccnz Lspin_18
    s_mov_b64 exec, -1
Lpo_17:
    s_waitcnt vmcnt(10)
    s_barrier
    v_lshrrev_b32 v196, 4, v2
    v_and_b32 v197, 15, v2
    v_lshlrev_b32 v197, 4, v197
    v_lshl_add_u32 v198, v196, 10, v197
    s_lshl_b32 s78, s69, 14
    s_lshl_b32 s79, s76, 8
    s_add_u32 s78, s78, s79
    s_add_u32 s78, s78, 65536
    buffer_load_dwordx4 v[20:23], v198, s[36:39], s78 offen sc1
    s_add_u32 s78, s78, 4096
    buffer_load_dwordx4 v[24:27], v198, s[36:39], s78 offen sc1
    s_add_u32 s78, s78, 4096
    buffer_load_dwordx4 v[28:31], v198, s[36:39], s78 offen sc1
    s_add_u32 s78, s78, 4096
    buffer_load_dwordx4 v[32:35], v198, s[36:39], s78 offen sc1
    v_mul_u32_u24 v198, 768, v196
    v_add_u32 v198, v198, v197
    s_mul_i32 s78, s70, 12288
    s_min_u32 s79, s76, 2
    s_lshl_b32 s79, s79, 8
    s_add_u32 s78, s78, s79
    s_add_u32 s78, s78, 327680
    buffer_load_dwordx4 v[36:39], v198, s[36:39], s78 offen sc1
    s_add_u32 s78, s78, 3072
    buffer_load_dwordx4 v[40:43], v198, s[36:39], s78 offen sc1
    s_add_u32 s78, s78, 3072
    buffer_load_dwordx4 v[44:47], v198, s[36:39], s78 offen sc1
    s_add_u32 s78, s78, 3072
    buffer_load_dwordx4 v[48:51], v198, s[36:39], s78 offen sc1
    s_waitcnt vmcnt(8)
    s_waitcnt lgkmcnt(0)
    s_barrier
    s_waitcnt vmcnt(4)
    v_add_f32 v20, v20, v24
    v_add_f32 v21, v21, v25
    v_add_f32 v22, v22, v26
    v_add_f32 v23, v23, v27
    v_add_f32 v20, v20, v28
    v_add_f32 v21, v21, v29
    v_add_f32 v22, v22, v30
    v_add_f32 v23, v23, v31
    v_add_f32 v20, v20, v32
    v_add_f32 v21, v21, v33
    v_add_f32 v22, v22, v34
    v_add_f32 v23, v23, v35
    s_nop 0
    v_permlane32_swap_b32 v20, v22
    v_permlane32_swap_b32 v21, v23
    v_add_f32 v20, v20, v22
    v_add_f32 v21, v21, v23
    v_mov_b32 v22, v20
    v_mov_b32 v23, v21
    s_nop 0
    v_permlane16_swap_b32 v20, v22
    v_permlane16_swap_b32 v21, v23
    v_add_f32 v20, v20, v22
    v_add_f32 v21, v21, v23
    v_mul_f32 v24, 0x3a800000, v20
    v_mul_f32 v26, 0x3a800000, v21
    v_fma_f32 v26, -v24, v24, v26
    v_max_f32 v26, 0, v26
    v_cvt_pk_bf16_f32 v24, v24, v24
    v_and_b32 v24, 0xffff0000, v24
    v_cvt_pk_bf16_f32 v26, v26, v26
    v_and_b32 v26, 0xffff0000, v26
    v_add_f32 v26, 0x3727c5ac, v26
    v_cvt_pk_bf16_f32 v26, v26, v26
    v_and_b32 v26, 0xffff0000, v26
    v_sqrt_f32 v26, v26
    s_nop 0
    v_cvt_pk_bf16_f32 v26, v26, v26
    v_and_b32 v26, 0xffff0000, v26
    v_rcp_f32 v25, v26
    v_xor_b32 v26, 0x80000000, v24
    v_lshrrev_b32 v27, 16, v26
    v_or_b32 v26, v26, v27
    v_mov_b32 v27, 0
    v_and_b32 v196, 15, v2
    v_lshrrev_b32 v197, 5, v2
    v_lshl_add_u32 v196, v196, 1, v197
    s_lshl_b32 s78, s76, 5
    v_add_u32 v196, s78, v196
    v_lshlrev_b32 v197, 3, v196
    v_add_u32 v197, 159744, v197
    v_lshlrev_b32 v196, 2, v196
    v_add_u32 v196, 162304, v196
    ds_write_b64 v197, v[26:27]
    ds_write_b32 v196, v25
    s_waitcnt vmcnt(0)
    v_add_f32 v36, v36, v40
    v_add_f32 v37, v37, v41
    v_add_f32 v38, v38, v42
    v_add_f32 v39, v39, v43
    v_add_f32 v36, v36, v44
    v_add_f32 v37, v37, v45
    v_add_f32 v38, v38, v46
    v_add_f32 v39, v39, v47
    v_add_f32 v36, v36, v48
    v_add_f32 v37, v37, v49
    v_add_f32 v38, v38, v50
    v_add_f32 v39, v39, v51
    s_nop 0
    v_permlane32_swap_b32 v36, v38
    v_permlane32_swap_b32 v37, v39
    v_add_f32 v36, v36, v38
    v_add_f32 v37, v37, v39
    s_nop 1
    v_permlane16_swap_b32 v36, v37
    v_add_f32 v36, v36, v37
    v_cvt_pk_bf16_f32 v37, v36, v36
    v_and_b32 v37, 0xffff0000, v37
    v_sub_f32 v38, v36, v37
    v_cvt_pk_bf16_f32 v38, v37, v38
    v_mov_b32 v39, 0
    v_and_b32 v196, 15, v2
    v_lshrrev_b32 v197, 4, v2
    v_lshl_add_u32 v196, v196, 2, v197
    s_min_u32 s78, s76, 2
    s_lshl_b32 s78, s78, 9
    s_add_u32 s78, s78, 160768
    v_lshl_add_u32 v196, v196, 3, s78
    ds_write_b64 v196, v[38:39]
    s_mul_i32 s78, s76, 8
    s_add_u32 s78, s78, 76
    s_lshl_b32 s79, s78, 10
    s_lshl_b32 s78, s78, 14
    s_add_u32 m0, s79, 0
    s_add_u32 s80, s78, 0
    buffer_load_dwordx4 v245, s[40:43], s80 offen  lds
    s_add_u32 m0, s79, 1024
    s_add_u32 s80, s78, 16384
    buffer_load_dwordx4 v245, s[40:43], s80 offen  lds
    s_add_u32 m0, s79, 2048
    s_add_u32 s80, s78, 32768
    buffer_load_dwordx4 v245, s[40:43], s80 offen  lds
    s_add_u32 m0, s79, 3072
    s_add_u32 s80, s78, 49152
    buffer_load_dwordx4 v245, s[40:43], s80 offen  lds
    s_add_u32 m0, s79, 4096
    s_add_u32 s80, s78, 65536
    buffer_load_dwordx4 v245, s[40:43], s80 offen  lds
    s_add_u32 m0, s79, 5120
    s_add_u32 s80, s78, 81920
    buffer_load_dwordx4 v245, s[40:43], s80 offen  lds
    s_add_u32 m0, s79, 6144
    s_add_u32 s80, s78, 98304
    buffer_load_dwordx4 v245, s[40:43], s80 offen  lds
    s_add_u32 m0, s79, 7168
    s_add_u32 s80, s78, 114688
    buffer_load_dwordx4 v245, s[40:43], s80 offen  lds
    s_waitcnt lgkmcnt(0)
    s_barrier
    s_mul_i32 s78, s76, 10
    s_add_u32 s78, s78, 36
    s_lshl_b32 s79, s78, 10
    s_lshl_b32 s78, s78, 14
    s_add_u32 m0, s79, 0
    s_add_u32 s80, s78, 0
    buffer_load_dwordx4 v245, s[40:43], s80 offen  lds
    s_add_u32 m0, s79, 1024
    s_add_u32 s80, s78, 16384
    buffer_load_dwordx4 v245, s[40:43], s80 offen  lds
    s_add_u32 m0, s79, 2048
    s_add_u32 s80, s78, 32768
    buffer_load_dwordx4 v245, s[40:43], s80 offen  lds
    s_add_u32 m0, s79, 3072
    s_add_u32 s80, s78, 49152
    buffer_load_dwordx4 v245, s[40:43], s80 offen  lds
    s_add_u32 m0, s79, 4096
    s_add_u32 s80, s78, 65536
    buffer_load_dwordx4 v245, s[40:43], s80 offen  lds
    s_add_u32 m0, s79, 5120
    s_add_u32 s80, s78, 81920
    buffer_load_dwordx4 v245, s[40:43], s80 offen  lds
    s_add_u32 m0, s79, 6144
    s_add_u32 s80, s78, 98304
    buffer_load_dwordx4 v245, s[40:43], s80 offen  lds
    s_add_u32 m0, s79, 7168
    s_add_u32 s80, s78, 114688
    buffer_load_dwordx4 v245, s[40:43], s80 offen  lds
    s_add_u32 m0, s79, 8192
    s_add_u32 s80, s78, 131072
    buffer_load_dwordx4 v245, s[40:43], s80 offen  lds
    s_add_u32 m0, s79, 9216
    s_add_u32 s80, s78, 147456
    buffer_load_dwordx4 v245, s[40:43], s80 offen  lds
    s_mul_i32 s78, s76, 9
    s_add_u32 s78, s78, 0
    s_lshl_b32 s79, s78, 10
    s_lshl_b32 s78, s78, 14
    s_add_u32 m0, s79, 0
    s_add_u32 s80, s78, 0
    buffer_load_dwordx4 v245, s[40:43], s80 offen  lds
    s_add_u32 m0, s79, 1024
    s_add_u32 s80, s78, 16384
    buffer_load_dwordx4 v245, s[40:43], s80 offen  lds
    s_add_u32 m0, s79, 2048
    s_add_u32 s80, s78, 32768
    buffer_load_dwordx4 v245, s[40:43], s80 offen  lds
    s_add_u32 m0, s79, 3072
    s_add_u32 s80, s78, 49152
    buffer_load_dwordx4 v245, s[40:43], s80 offen  lds
    s_add_u32 m0, s79, 4096
    s_add_u32 s80, s78, 65536
    buffer_load_dwordx4 v245, s[40:43], s80 offen  lds
    s_add_u32 m0, s79, 5120
    s_add_u32 s80, s78, 81920
    buffer_load_dwordx4 v245, s[40:43], s80 offen  lds
    s_add_u32 m0, s79, 6144
    s_add_u32 s80, s78, 98304
    buffer_load_dwordx4 v245, s[40:43], s80 offen  lds
    s_add_u32 m0, s79, 7168
    s_add_u32 s80, s78, 114688
    buffer_load_dwordx4 v245, s[40:43], s80 offen  lds
    s_add_u32 m0, s79, 8192
    s_add_u32 s80, s78, 131072
    buffer_load_dwordx4 v245, s[40:43], s80 offen  lds
    s_mul_i32 s78, s76, 5
    s_add_u32 s78, s78, 108
    s_lshl_b32 s78, s78, 14
    s_add_u32 s80, s78, 0
    buffer_load_dwordx4 v[160:163], v245, s[40:43], s80 offen
    s_add_u32 s80, s78, 16384
    buffer_load_dwordx4 v[164:167], v245, s[40:43], s80 offen
    s_add_u32 s80, s78, 32768
    buffer_load_dwordx4 v[168:171], v245, s[40:43], s80 offen
    s_add_u32 s80, s78, 49152
    buffer_load_dwordx4 v[172:175], v245, s[40:43], s80 offen
    s_add_u32 s80, s78, 65536
    buffer_load_dwordx4 v[176:179], v245, s[40:43], s80 offen
    s_mov_b32 s80, 0
    buffer_load_dwordx4 v[180:183], v246, s[28:31], s80 offen
    s_mov_b32 s80, 16384
    buffer_load_dwordx4 v[184:187], v247, s[28:31], s80 offen
    s_mov_b32 s80, 32768
    buffer_load_dwordx4 v[188:191], v246, s[28:31], s80 offen
    s_mov_b32 s80, 49152
    buffer_load_dwordx4 v[192:195], v247, s[28:31], s80 offen
    s_mov_b32 s78, 0
    buffer_load_dwordx4 v[128:131], v244, s[56:59], s78 offen nt
    s_mov_b32 s78, 2048
    buffer_load_dwordx4 v[132:135], v244, s[56:59], s78 offen nt
    s_mov_b32 s78, 4096
    buffer_load_dwordx4 v[136:139], v244, s[56:59], s78 offen nt
    s_mov_b32 s78, 6144
    buffer_load_dwordx4 v[140:143], v244, s[56:59], s78 offen nt
    s_mov_b32 s78, 8192
    buffer_load_dwordx4 v[144:147], v244, s[56:59], s78 offen nt
    s_mov_b32 s78, 10240
    buffer_load_dwordx4 v[148:151], v244, s[56:59], s78 offen nt
    s_mov_b32 s78, 12288
    buffer_load_dwordx4 v[152:155], v244, s[56:59], s78 offen nt
    s_mov_b32 s78, 14336
    buffer_load_dwordx4 v[156:159], v244, s[56:59], s78 offen nt
    v_lshrrev_b32 v198, 2, v2
    v_and_b32 v199, 7, v198
    v_and_b32 v200, 3, v2
    v_xor_b32 v199, v199, v200
    s_lshr_b32 s78, s76, 1
    s_and_b32 s79, s76, 1
    s_lshl_b32 s80, s79, 2
    s_lshl_b32 s81, s78, 2
    v_xor_b32 v200, s80, v199
    v_xor_b32 v201, s81, v199
    v_lshlrev_b32 v198, 7, v198
    s_lshl_b32 s80, s78, 14
    s_add_u32 s80, s80, 110592
    v_lshl_add_u32 v196, v200, 4, v198
    v_add_u32 v196, s80, v196
    v_lshl_add_u32 v197, v201, 4, v198
    v_add_u32 v197, 143360, v197
    v_mov_b32 v200, 0x3f803f80
    v_mov_b32 v201, 0x3f803f80
    v_mov_b32 v202, 0x3f803f80
    v_mov_b32 v203, 0x3f803f80
    v_lshrrev_b32 v198, 4, v2
    v_and_b32 v199, 15, v2
    v_lshlrev_b32 v199, 4, v199
    v_lshl_add_u32 v198, v198, 13, v199
    s_lshl_b32 s78, s70, 2
    s_add_u32 s78, s78, s76
    s_lshl_b32 s78, s78, 15
    s_lshl_b32 s79, s69, 9
    s_add_u32 s78, s78, s79
    s_add_u32 s78, s78, 2097152
    s_lshl_b32 s79, s77, 10
    s_lshl_b32 s80, s76, 6
    s_add_u32 s79, s79, s80
    s_add_u32 s79, s79, 8389120
    s_barrier
    ds_read_b64_tr_b16 v[4:5], v196 offset:0
    ds_read_b64_tr_b16 v[6:7], v196 offset:2048
    ds_read_b64_tr_b16 v[8:9], v196 offset:8
    ds_read_b64_tr_b16 v[10:11], v196 offset:2056
    ds_read_b64_tr_b16 v[12:13], v197 offset:0
    ds_read_b64_tr_b16 v[14:15], v197 offset:2048
    ds_read_b64_tr_b16 v[16:17], v197 offset:8
    ds_read_b64_tr_b16 v[18:19], v197 offset:2056
    ds_read_b64_tr_b16 v[20:21], v196 offset:4096
    ds_read_b64_tr_b16 v[22:23], v196 offset:6144
    ds_read_b64_tr_b16 v[24:25], v196 offset:4104
    ds_read_b64_tr_b16 v[26:27], v196 offset:6152
    ds_read_b64_tr_b16 v[28:29], v197 offset:4096
    ds_read_b64_tr_b16 v[30:31], v197 offset:6144
    ds_read_b64_tr_b16 v[32:33], v197 offset:4104
    ds_read_b64_tr_b16 v[34:35], v197 offset:6152
    s_waitcnt lgkmcnt(8)
    v_mfma_f32_16x16x32_bf16 v[204:207], v[4:7], v[12:15], 0
    v_mfma_f32_16x16x32_bf16 v[208:211], v[8:11], v[12:15], 0
    v_mfma_f32_16x16x32_bf16 v[212:215], v[4:7], v[16:19], 0
    v_mfma_f32_16x16x32_bf16 v[216:219], v[8:11], v[16:19], 0
    v_mfma_f32_16x16x32_bf16 v[220:223], v[4:7], v[200:203], 0
    v_mfma_f32_16x16x32_bf16 v[224:227], v[8:11], v[200:203], 0
    ds_read_b64_tr_b16 v[36:37], v196 offset:8192
    ds_read_b64_tr_b16 v[38:39], v196 offset:10240
    ds_read_b64_tr_b16 v[40:41], v196 offset:8200
    ds_read_b64_tr_b16 v[42:43], v196 offset:10248
    ds_read_b64_tr_b16 v[44:45], v197 offset:8192
    ds_read_b64_tr_b16 v[46:47], v197 offset:10240
    ds_read_b64_tr_b16 v[48:49], v197 offset:8200
    ds_read_b64_tr_b16 v[50:51], v197 offset:10248
    s_waitcnt lgkmcnt(8)
    v_mfma_f32_16x16x32_bf16 v[204:207], v[20:23], v[28:31], v[204:207]
    v_mfma_f32_16x16x32_bf16 v[208:211], v[24:27], v[28:31], v[208:211]
    v_mfma_f32_16x16x32_bf16 v[212:215], v[20:23], v[32:35], v[212:215]
    v_mfma_f32_16x16x32_bf16 v[216:219], v[24:27], v[32:35], v[216:219]
    v_mfma_f32_16x16x32_bf16 v[220:223], v[20:23], v[200:203], v[220:223]
    v_mfma_f32_16x16x32_bf16 v[224:227], v[24:27], v[200:203], v[224:227]
    ds_read_b64_tr_b16 v[228:229], v196 offset:12288
    ds_read_b64_tr_b16 v[230:231], v196 offset:14336
    ds_read_b64_tr_b16 v[232:233], v196 offset:12296
    ds_read_b64_tr_b16 v[234:235], v196 offset:14344
    ds_read_b64_tr_b16 v[236:237], v197 offset:12288
    ds_read_b64_tr_b16 v[238:239], v197 offset:14336
    ds_read_b64_tr_b16 v[240:241], v197 offset:12296
    ds_read_b64_tr_b16 v[242:243], v197 offset:14344
    s_waitcnt lgkmcnt(8)
    v_mfma_f32_16x16x32_bf16 v[204:207], v[36:39], v[44:47], v[204:207]
    v_mfma_f32_16x16x32_bf16 v[208:211], v[40:43], v[44:47], v[208:211]
    v_mfma_f32_16x16x32_bf16 v[212:215], v[36:39], v[48:51], v[212:215]
    v_mfma_f32_16x16x32_bf16 v[216:219], v[40:43], v[48:51], v[216:219]
    v_mfma_f32_16x16x32_bf16 v[220:223], v[36:39], v[200:203], v[220:223]
    v_mfma_f32_16x16x32_bf16 v[224:227], v[40:43], v[200:203], v[224:227]
    s_waitcnt lgkmcnt(0)
    v_mfma_f32_16x16x32_bf16 v[204:207], v[228:231], v[236:239], v[204:207]
    v_mfma_f32_16x16x32_bf16 v[208:211], v[232:235], v[236:239], v[208:211]
    v_mfma_f32_16x16x32_bf16 v[212:215], v[228:231], v[240:243], v[212:215]
    v_mfma_f32_16x16x32_bf16 v[216:219], v[232:235], v[240:243], v[216:219]
    v_mfma_f32_16x16x32_bf16 v[220:223], v[228:231], v[200:203], v[220:223]
    v_mfma_f32_16x16x32_bf16 v[224:227], v[232:235], v[200:203], v[224:227]
    s_nop 2
    v_cvt_pk_bf16_f32 v4, v204, v205
    v_cvt_pk_bf16_f32 v5, v206, v207
    v_cvt_pk_bf16_f32 v6, v208, v209
    v_cvt_pk_bf16_f32 v7, v210, v211
    buffer_store_dwordx4 v[4:7], v198, s[36:39], s78 offen offset:0 sc1
    v_cvt_pk_bf16_f32 v8, v212, v213
    v_cvt_pk_bf16_f32 v9, v214, v215
    v_cvt_pk_bf16_f32 v10, v216, v217
    v_cvt_pk_bf16_f32 v11, v218, v219
    buffer_store_dwordx4 v[8:11], v198, s[36:39], s78 offen offset:256 sc1
    v_cvt_pk_bf16_f32 v12, v220, v221
    v_cvt_pk_bf16_f32 v13, v222, v223
    v_cvt_pk_bf16_f32 v14, v224, v225
    v_cvt_pk_bf16_f32 v15, v226, v227
    s_mov_b32 exec_lo, 0x00010001
    s_mov_b32 exec_hi, 0x00010001
    buffer_store_dwordx4 v[12:15], v2, s[36:39], s79 offen sc1
    s_mov_b64 exec, -1
    v_lshrrev_b32 v196, 3, v2
    v_and_b32 v197, 7, v2
    v_lshlrev_b32 v197, 4, v197
    v_lshl_add_u32 v198, v196, 9, v197
    v_lshl_add_u32 v199, v196, 1, v197
    s_lshl_b32 s78, s77, 13
    s_lshl_b32 s80, s76, 7
    s_add_u32 s78, s78, s80
    s_add_u32 s78, s78, 2097152
    s_add_u32 s79, s78, 4096
    s_lshl_b32 s81, s77, 10
    s_add_u32 s81, s81, s80
    s_add_u32 s81, s81, 8388608
    s_mov_b32 s85, 0
Lspin_19:
    s_add_u32 s85, s85, 1
    s_cmp_gt_u32 s85, 400000
    s_cbranch_scc1 L_end
    buffer_load_dwordx4 v[20:23], v198, s[36:39], s78 offen sc1
    buffer_load_dwordx4 v[24:27], v198, s[36:39], s79 offen sc1
    s_waitcnt vmcnt(0)
    v_max_u32 v28, v20, v24
    v_cmp_eq_u32 vcc, -1, v28
    s_cbranch_vccnz Lspin_19
    v_lshlrev_b32 v28, 16, v20
    v_and_b32 v29, 0xffff0000, v20
    v_lshlrev_b32 v36, 16, v24
    v_and_b32 v37, 0xffff0000, v24
    v_pk_add_f32 v[28:29], v[28:29], v[36:37]
    v_lshlrev_b32 v30, 16, v21
    v_and_b32 v31, 0xffff0000, v21
    v_lshlrev_b32 v38, 16, v25
    v_and_b32 v39, 0xffff0000, v25
    v_pk_add_f32 v[30:31], v[30:31], v[38:39]
    v_lshlrev_b32 v32, 16, v22
    v_and_b32 v33, 0xffff0000, v22
    v_lshlrev_b32 v40, 16, v26
    v_and_b32 v41, 0xffff0000, v26
    v_pk_add_f32 v[32:33], v[32:33], v[40:41]
    v_lshlrev_b32 v34, 16, v23
    v_and_b32 v35, 0xffff0000, v23
    v_lshlrev_b32 v42, 16, v27
    v_and_b32 v43, 0xffff0000, v27
    v_pk_add_f32 v[34:35], v[34:35], v[42:43]
    v_permlane32_swap_b32 v28, v32
    v_permlane32_swap_b32 v29, v33
    v_permlane32_swap_b32 v30, v34
    v_permlane32_swap_b32 v31, v35
    v_pk_add_f32 v[28:29], v[28:29], v[32:33]
    v_pk_add_f32 v[30:31], v[30:31], v[34:35]
    s_nop 1
    v_permlane16_swap_b32 v28, v30
    v_permlane16_swap_b32 v29, v31
    v_pk_add_f32 v[28:29], v[28:29], v[30:31]
    s_nop 1
    v_add_f32_dpp v36, v28, v28 row_ror:8 row_mask:0xf bank_mask:0x3
    s_nop 1
    v_add_f32_dpp v36, v29, v29 row_ror:8 row_mask:0xf bank_mask:0xc
    v_cvt_pk_bf16_f32 v36, v36, v36
    buffer_store_short v36, v199, s[36:39], s81 offen sc1
    v_lshrrev_b32 v196, 2, v2
    v_and_b32 v197, 3, v2
    v_lshlrev_b32 v197, 4, v197
    v_lshl_add_u32 v198, v196, 10, v197
    s_lshl_b32 s78, s70, 14
    s_lshl_b32 s80, s76, 6
    s_add_u32 s78, s78, s80
    s_add_u32 s78, s78, 8389120
    v_lshrrev_b32 v196, 3, v2
    v_lshl_add_u32 v199, v196, 1, v197
    s_add_u32 s80, s80, 162944
    v_add_u32 v199, s80, v199
    s_mov_b32 s85, 0
Lspin_20:
    s_add_u32 s85, s85, 1
    s_cmp_gt_u32 s85, 400000
    s_cbranch_scc1 L_end
    buffer_load_dwordx4 v[20:23], v198, s[36:39], s78 offen sc1
    s_waitcnt vmcnt(0)
    v_cmp_eq_u32 vcc, -1, v20
    s_cbranch_vccnz Lspin_20
    v_lshlrev_b32 v28, 16, v20
    v_and_b32 v29, 0xffff0000, v20
    v_lshlrev_b32 v30, 16, v21
    v_and_b32 v31, 0xffff0000, v21
    v_lshlrev_b32 v32, 16, v22
    v_and_b32 v33, 0xffff0000, v22
    v_lshlrev_b32 v34, 16, v23
    v_and_b32 v35, 0xffff0000, v23
    v_permlane32_swap_b32 v28, v32
    v_permlane32_swap_b32 v29, v33
    v_permlane32_swap_b32 v30, v34
    v_permlane32_swap_b32 v31, v35
    v_pk_add_f32 v[28:29], v[28:29], v[32:33]
    v_pk_add_f32 v[30:31], v[30:31], v[34:35]
    s_nop 1
    v_permlane16_swap_b32 v28, v30
    v_permlane16_swap_b32 v29, v31
    v_pk_add_f32 v[28:29], v[28:29], v[30:31]
    s_nop 1
    v_add_f32_dpp v36, v28, v28 row_ror:8 row_mask:0xf bank_mask:0x3
    s_nop 1
    v_add_f32_dpp v36, v29, v29 row_ror:8 row_mask:0xf bank_mask:0xc
    s_nop 1
    v_add_f32_dpp v37, v36, v36 row_shr:4 row_mask:0xf bank_mask:0xf
    v_cvt_pk_bf16_f32 v37, v37, v37
    s_mov_b32 exec_lo, 0xf0f0f0f0
    s_mov_b32 exec_hi, 0xf0f0f0f0
    ds_write_b16 v199, v37
    s_mov_b64 exec, -1
    s_waitcnt lgkmcnt(0)
    s_barrier
    v_lshlrev_b32 v4, 4, v2
    s_mul_i32 s78, s76, 5120
    s_add_u32 s78, s78, 110592
    v_add_u32 v5, s78, v4
    s_lshl_b32 s78, s76, 12
    s_add_u32 s78, s78, 131072
    v_add_u32 v6, s78, v4
    ds_write_b128 v5, v[160:163] offset:0
    ds_write_b128 v5, v[164:167] offset:1024
    ds_write_b128 v5, v[168:171] offset:2048
    ds_write_b128 v5, v[172:175] offset:3072
    ds_write_b128 v5, v[176:179] offset:4096
    ds_write_b128 v6, v[180:183] offset:0
    ds_write_b128 v6, v[184:187] offset:1024
    ds_write_b128 v6, v[188:191] offset:2048
    ds_write_b128 v6, v[192:195] offset:3072
    s_waitcnt lgkmcnt(0)
    s_barrier
    s_mov_b32 s78, 0x05040100
    s_mov_b32 s79, 0x07060302
    v_perm_b32 v7, v68, v64, s78
    v_perm_b32 v68, v68, v64, s79
    v_mov_b32 v64, v7
    v_perm_b32 v7, v69, v65, s78
    v_perm_b32 v69, v69, v65, s79
    v_mov_b32 v65, v7
    v_perm_b32 v7, v70, v66, s78
    v_perm_b32 v70, v70, v66, s79
    v_mov_b32 v66, v7
    v_perm_b32 v7, v71, v67, s78
    v_perm_b32 v71, v71, v67, s79
    v_mov_b32 v67, v7
    v_perm_b32 v7, v76, v72, s78
    v_perm_b32 v76, v76, v72, s79
    v_mov_b32 v72, v7
    v_perm_b32 v7, v77, v73, s78
    v_perm_b32 v77, v77, v73, s79
    v_mov_b32 v73, v7
    v_perm_b32 v7, v78, v74, s78
    v_perm_b32 v78, v78, v74, s79
    v_mov_b32 v74, v7
    v_perm_b32 v7, v79, v75, s78
    v_perm_b32 v79, v79, v75, s79
    v_mov_b32 v75, v7
    v_perm_b32 v7, v84, v80, s78
    v_perm_b32 v84, v84, v80, s79
    v_mov_b32 v80, v7
    v_perm_b32 v7, v85, v81, s78
    v_perm_b32 v85, v85, v81, s79
    v_mov_b32 v81, v7
    v_perm_b32 v7, v86, v82, s78
    v_perm_b32 v86, v86, v82, s79
    v_mov_b32 v82, v7
    v_perm_b32 v7, v87, v83, s78
    v_perm_b32 v87, v87, v83, s79
    v_mov_b32 v83, v7
    v_perm_b32 v7, v92, v88, s78
    v_perm_b32 v92, v92, v88, s79
    v_mov_b32 v88, v7
    v_perm_b32 v7, v93, v89, s78
    v_perm_b32 v93, v93, v89, s79
    v_mov_b32 v89, v7
    v_perm_b32 v7, v94, v90, s78
    v_perm_b32 v94, v94, v90, s79
    v_mov_b32 v90, v7
    v_perm_b32 v7, v95, v91, s78
    v_perm_b32 v95, v95, v91, s79
    v_mov_b32 v91, v7
    v_perm_b32 v7, v100, v96, s78
    v_perm_b32 v100, v100, v96, s79
    v_mov_b32 v96, v7
    v_perm_b32 v7, v101, v97, s78
    v_perm_b32 v101, v101, v97, s79
    v_mov_b32 v97, v7
    v_perm_b32 v7, v102, v98, s78
    v_perm_b32 v102, v102, v98, s79
    v_mov_b32 v98, v7
    v_perm_b32 v7, v103, v99, s78
    v_perm_b32 v103, v103, v99, s79
    v_mov_b32 v99, v7
    v_perm_b32 v7, v108, v104, s78
    v_perm_b32 v108, v108, v104, s79
    v_mov_b32 v104, v7
    v_perm_b32 v7, v109, v105, s78
    v_perm_b32 v109, v109, v105, s79
    v_mov_b32 v105, v7
    v_perm_b32 v7, v110, v106, s78
    v_perm_b32 v110, v110, v106, s79
    v_mov_b32 v106, v7
    v_perm_b32 v7, v111, v107, s78
    v_perm_b32 v111, v111, v107, s79
    v_mov_b32 v107, v7
    v_perm_b32 v7, v116, v112, s78
    v_perm_b32 v116, v116, v112, s79
    v_mov_b32 v112, v7
    v_perm_b32 v7, v117, v113, s78
    v_perm_b32 v117, v117, v113, s79
    v_mov_b32 v113, v7
    v_perm_b32 v7, v118, v114, s78
    v_perm_b32 v118, v118, v114, s79
    v_mov_b32 v114, v7
    v_perm_b32 v7, v119, v115, s78
    v_perm_b32 v119, v119, v115, s79
    v_mov_b32 v115, v7
    v_perm_b32 v7, v124, v120, s78
    v_perm_b32 v124, v124, v120, s79
    v_mov_b32 v120, v7
    v_perm_b32 v7, v125, v121, s78
    v_perm_b32 v125, v125, v121, s79
    v_mov_b32 v121, v7
    v_perm_b32 v7, v126, v122, s78
    v_perm_b32 v126, v126, v122, s79
    v_mov_b32 v122, v7
    v_perm_b32 v7, v127, v123, s78
    v_perm_b32 v127, v127, v123, s79
    v_mov_b32 v123, v7
    v_perm_b32 v7, v132, v128, s78
    v_perm_b32 v132, v132, v128, s79
    v_mov_b32 v128, v7
    v_perm_b32 v7, v133, v129, s78
    v_perm_b32 v133, v133, v129, s79
    v_mov_b32 v129, v7
    v_perm_b32 v7, v134, v130, s78
    v_perm_b32 v134, v134, v130, s79
    v_mov_b32 v130, v7
    v_perm_b32 v7, v135, v131, s78
    v_perm_b32 v135, v135, v131, s79
    v_mov_b32 v131, v7
    v_perm_b32 v7, v140, v136, s78
    v_perm_b32 v140, v140, v136, s79
    v_mov_b32 v136, v7
    v_perm_b32 v7, v141, v137, s78
    v_perm_b32 v141, v141, v137, s79
    v_mov_b32 v137, v7
    v_perm_b32 v7, v142, v138, s78
    v_perm_b32 v142, v142, v138, s79
    v_mov_b32 v138, v7
    v_perm_b32 v7, v143, v139, s78
    v_perm_b32 v143, v143, v139, s79
    v_mov_b32 v139, v7
    v_perm_b32 v7, v148, v144, s78
    v_perm_b32 v148, v148, v144, s79
    v_mov_b32 v144, v7
    v_perm_b32 v7, v149, v145, s78
    v_perm_b32 v149, v149, v145, s79
    v_mov_b32 v145, v7
    v_perm_b32 v7, v150, v146, s78
    v_perm_b32 v150, v150, v146, s79
    v_mov_b32 v146, v7
    v_perm_b32 v7, v151, v147, s78
    v_perm_b32 v151, v151, v147, s79
    v_mov_b32 v147, v7
    v_perm_b32 v7, v156, v152, s78
    v_perm_b32 v156, v156, v152, s79
    v_mov_b32 v152, v7
    v_perm_b32 v7, v157, v153, s78
    v_perm_b32 v157, v157, v153, s79
    v_mov_b32 v153, v7
    v_perm_b32 v7, v158, v154, s78
    v_perm_b32 v158, v158, v154, s79
    v_mov_b32 v154, v7
    v_perm_b32 v7, v159, v155, s78
    v_perm_b32 v159, v159, v155, s79
    v_mov_b32 v155, v7
    v_lshrrev_b32 v8, 3, v2
    v_and_b32 v9, 7, v2
    v_lshlrev_b32 v10, 4, v9
    v_lshl_add_u32 v11, v8, 13, v10
    v_and_b32 v12, 15, v2
    v_lshlrev_b32 v12, 13, v12
    v_lshl_add_u32 v13, v8, 9, v10
    v_lshl_add_u32 v14, v9, 3, v8
    s_lshl_b32 s80, s74, 2
    s_add_u32 s80, s80, s76
    s_lshl_b32 s78, s80, 9
    s_add_u32 s78, s78, 524288
    s_add_u32 s79, s78, 65536
    s_lshl_b32 s81, s73, 13
    s_add_u32 s81, s81, 655360
    s_lshl_b32 s80, s80, 9
    s_add_u32 s80, s80, s81
    s_barrier
    s_mov_b32 s85, 0
Lspin_21:
    s_add_u32 s85, s85, 1
    s_cmp_gt_u32 s85, 400000
    s_cbranch_scc1 L_end
    buffer_load_dword v24, v12, s[36:39], s78 offen offset:128 sc1
    buffer_load_dwordx4 v[16:19], v11, s[36:39], s78 offen sc1
    buffer_load_dwordx4 v[20:23], v11, s[36:39], s79 offen sc1
    s_waitcnt vmcnt(0)
    v_max3_u32 v25, v16, v18, v20
    v_max3_u32 v25, v25, v22, v24
    v_cmp_eq_u32 vcc, -1, v25
    s_cbranch_vccnz Lspin_21
    v_max_f32_dpp v24, v24, v24 row_ror:8 row_mask:0xf bank_mask:0xf
    s_nop 1
    v_max_f32_dpp v24, v24, v24 row_ror:4 row_mask:0xf bank_mask:0xf
    s_nop 1
    v_max_f32_dpp v24, v24, v24 row_ror:2 row_mask:0xf bank_mask:0xf
    s_nop 1
    v_max_f32_dpp v24, v24, v24 row_ror:1 row_mask:0xf bank_mask:0xf
    s_nop 0
    v_readfirstlane_b32 s97, v24
    s_cmp_ge_u32 s73, 56
    s_cbranch_scc1 L_red
    s_bitcmp1_b32 s97, 10
    s_cselect_b64 vcc, -1, 0
    s_bfe_u32 s78, s97, 0x30007
    s_lshl_b32 s78, s78, 5
    v_lshl_add_u32 v25, v8, 2, s78
    v_cndmask_b32 v16, v16, v20, vcc
    v_cndmask_b32 v17, v17, v21, vcc
    v_cndmask_b32 v18, v18, v22, vcc
    v_cndmask_b32 v19, v19, v23, vcc
    ds_bpermute_b32 v20, v25, v16
    ds_bpermute_b32 v21, v25, v17
    ds_bpermute_b32 v22, v25, v18
    ds_bpermute_b32 v23, v25, v19
    v_mov_b32 v26, 163344
    ds_write_b32 v26, v24
    v_lshlrev_b32 v15, 3, v14
    s_waitcnt lgkmcnt(0)
    v_dot2_f32_bf16 v28, v64, v20, 0
    v_dot2_f32_bf16 v29, v68, v20, 0
    v_dot2_f32_bf16 v30, v65, v20, 0
    v_dot2_f32_bf16 v31, v69, v20, 0
    v_dot2_f32_bf16 v32, v66, v20, 0
    v_dot2_f32_bf16 v33, v70, v20, 0
    v_dot2_f32_bf16 v34, v67, v20, 0
    v_dot2_f32_bf16 v35, v71, v20, 0
    v_dot2_f32_bf16 v28, v72, v21, v28
    v_dot2_f32_bf16 v29, v76, v21, v29
    v_dot2_f32_bf16 v30, v73, v21, v30
    v_dot2_f32_bf16 v31, v77, v21, v31
    v_dot2_f32_bf16 v32, v74, v21, v32
    v_dot2_f32_bf16 v33, v78, v21, v33
    v_dot2_f32_bf16 v34, v75, v21, v34
    v_dot2_f32_bf16 v35, v79, v21, v35
    v_dot2_f32_bf16 v28, v80, v22, v28
    v_dot2_f32_bf16 v29, v84, v22, v29
    v_dot2_f32_bf16 v30, v81, v22, v30
    v_dot2_f32_bf16 v31, v85, v22, v31
    v_dot2_f32_bf16 v32, v82, v22, v32
    v_dot2_f32_bf16 v33, v86, v22, v33
    v_dot2_f32_bf16 v34, v83, v22, v34
    v_dot2_f32_bf16 v35, v87, v22, v35
    v_dot2_f32_bf16 v28, v88, v23, v28
    v_dot2_f32_bf16 v29, v92, v23, v29
    v_dot2_f32_bf16 v30, v89, v23, v30
    v_dot2_f32_bf16 v31, v93, v23, v31
    v_dot2_f32_bf16 v32, v90, v23, v32
    v_dot2_f32_bf16 v33, v94, v23, v33
    v_dot2_f32_bf16 v34, v91, v23, v34
    v_dot2_f32_bf16 v35, v95, v23, v35
    v_dot2_f32_bf16 v36, v96, v20, 0
    v_dot2_f32_bf16 v37, v100, v20, 0
    v_dot2_f32_bf16 v38, v97, v20, 0
    v_dot2_f32_bf16 v39, v101, v20, 0
    v_dot2_f32_bf16 v40, v98, v20, 0
    v_dot2_f32_bf16 v41, v102, v20, 0
    v_dot2_f32_bf16 v42, v99, v20, 0
    v_dot2_f32_bf16 v43, v103, v20, 0
    v_dot2_f32_bf16 v36, v104, v21, v36
    v_dot2_f32_bf16 v37, v108, v21, v37
    v_dot2_f32_bf16 v38, v105, v21, v38
    v_dot2_f32_bf16 v39, v109, v21, v39
    v_dot2_f32_bf16 v40, v106, v21, v40
    v_dot2_f32_bf16 v41, v110, v21, v41
    v_dot2_f32_bf16 v42, v107, v21, v42
    v_dot2_f32_bf16 v43, v111, v21, v43
    v_dot2_f32_bf16 v36, v112, v22, v36
    v_dot2_f32_bf16 v37, v116, v22, v37
    v_dot2_f32_bf16 v38, v113, v22, v38
    v_dot2_f32_bf16 v39, v117, v22, v39
    v_dot2_f32_bf16 v40, v114, v22, v40
    v_dot2_f32_bf16 v41, v118, v22, v41
    v_dot2_f32_bf16 v42, v115, v22, v42
    v_dot2_f32_bf16 v43, v119, v22, v43
    v_dot2_f32_bf16 v36, v120, v23, v36
    v_dot2_f32_bf16 v37, v124, v23, v37
    v_dot2_f32_bf16 v38, v121, v23, v38
    v_dot2_f32_bf16 v39, v125, v23, v39
    v_dot2_f32_bf16 v40, v122, v23, v40
    v_dot2_f32_bf16 v41, v126, v23, v41
    v_dot2_f32_bf16 v42, v123, v23, v42
    v_dot2_f32_bf16 v43, v127, v23, v43
    v_permlane32_swap_b32 v28, v32
    v_permlane32_swap_b32 v29, v33
    v_permlane32_swap_b32 v30, v34
    v_permlane32_swap_b32 v31, v35
    v_pk_add_f32 v[28:29], v[28:29], v[32:33]
    v_pk_add_f32 v[30:31], v[30:31], v[34:35]
    s_nop 1
    v_permlane16_swap_b32 v28, v30
    v_permlane16_swap_b32 v29, v31
    v_pk_add_f32 v[28:29], v[28:29], v[30:31]
    s_nop 1
    v_add_f32_dpp v44, v28, v28 row_ror:8 row_mask:0xf bank_mask:0x3
    s_nop 1
    v_add_f32_dpp v44, v29, v29 row_ror:8 row_mask:0xf bank_mask:0xc
    v_permlane32_swap_b32 v36, v40
    v_permlane32_swap_b32 v37, v41
    v_permlane32_swap_b32 v38, v42
    v_permlane32_swap_b32 v39, v43
    v_pk_add_f32 v[36:37], v[36:37], v[40:41]
    v_pk_add_f32 v[38:39], v[38:39], v[42:43]
    s_nop 1
    v_permlane16_swap_b32 v36, v38
    v_permlane16_swap_b32 v37, v39
    v_pk_add_f32 v[36:37], v[36:37], v[38:39]
    s_nop 1
    v_add_f32_dpp v45, v36, v36 row_ror:8 row_mask:0xf bank_mask:0x3
    s_nop 1
    v_add_f32_dpp v45, v37, v37 row_ror:8 row_mask:0xf bank_mask:0xc
    buffer_store_dwordx2 v[44:45], v15, s[36:39], s80 offen sc1
    s_barrier
    s_lshl_b32 s78, s76, 7
    s_add_u32 s78, s78, s81
    s_add_u32 s79, s78, 4096
    v_lshrrev_b32 v26, 5, v2
    v_lshl_add_u32 v26, v9, 1, v26
    s_lshl_b32 s80, s76, 5
    s_add_u32 s80, s80, 163456
    v_lshl_add_u32 v26, v26, 1, s80
    v_lshlrev_b32 v27, 4, v8
    v_add_u32 v27, 163456, v27
    v_lshlrev_b32 v15, 2, v14
    s_mul_i32 s80, s74, 56
    s_add_u32 s80, s80, s73
    s_lshl_b32 s80, s80, 10
    s_lshl_b32 s82, s76, 8
    s_add_u32 s80, s80, s82
    s_add_u32 s80, s80, 1114112
    s_mov_b32 s85, 0
Lspin_22:
    s_add_u32 s85, s85, 1
    s_cmp_gt_u32 s85, 400000
    s_cbranch_scc1 L_end
    buffer_load_dwordx4 v[16:19], v13, s[36:39], s78 offen sc1
    buffer_load_dwordx4 v[20:23], v13, s[36:39], s79 offen sc1
    s_waitcnt vmcnt(0)
    v_max3_u32 v25, v16, v18, v20
    v_max_u32 v25, v25, v22
    v_cmp_eq_u32 vcc, -1, v25
    s_cbranch_vccnz Lspin_22
    v_pk_add_f32 v[16:17], v[16:17], v[20:21]
    v_pk_add_f32 v[18:19], v[18:19], v[22:23]
    s_nop 1
    v_permlane32_swap_b32 v16, v18
    v_permlane32_swap_b32 v17, v19
    v_pk_add_f32 v[16:17], v[16:17], v[18:19]
    v_mov_b32 v18, v16
    v_mov_b32 v19, v17
    s_nop 0
    v_permlane16_swap_b32 v16, v18
    v_permlane16_swap_b32 v17, v19
    v_pk_add_f32 v[16:17], v[16:17], v[18:19]
    s_nop 1
    v_add_f32_dpp v16, v16, v16 row_ror:8 row_mask:0xf bank_mask:0xf
    v_add_f32_dpp v17, v17, v17 row_ror:8 row_mask:0xf bank_mask:0xf
    v_cvt_pk_bf16_f32 v16, v16, v16
    v_and_b32 v16, 0xffff0000, v16
    v_cvt_pk_bf16_f32 v17, v17, v17
    v_and_b32 v17, 0xffff0000, v17
    v_mul_f32 v18, 0xbfb8aa3b, v16
    v_exp_f32 v18, v18
    s_nop 0
    v_add_f32 v18, 1.0, v18
    v_rcp_f32 v18, v18
    s_nop 0
    v_mul_f32 v16, v16, v18
    v_cvt_pk_bf16_f32 v16, v16, v16
    v_and_b32 v16, 0xffff0000, v16
    v_mul_f32 v16, v16, v17
    v_cvt_pk_bf16_f32 v16, v16, v16
    ds_write_b16 v26, v16
    s_waitcnt lgkmcnt(0)
    s_barrier
    ds_read_b128 v[20:23], v27
    s_waitcnt lgkmcnt(0)
    v_dot2_f32_bf16 v28, v128, v20, 0
    v_dot2_f32_bf16 v29, v132, v20, 0
    v_dot2_f32_bf16 v30, v129, v20, 0
    v_dot2_f32_bf16 v31, v133, v20, 0
    v_dot2_f32_bf16 v32, v130, v20, 0
    v_dot2_f32_bf16 v33, v134, v20, 0
    v_dot2_f32_bf16 v34, v131, v20, 0
    v_dot2_f32_bf16 v35, v135, v20, 0
    v_dot2_f32_bf16 v28, v136, v21, v28
    v_dot2_f32_bf16 v29, v140, v21, v29
    v_dot2_f32_bf16 v30, v137, v21, v30
    v_dot2_f32_bf16 v31, v141, v21, v31
    v_dot2_f32_bf16 v32, v138, v21, v32
    v_dot2_f32_bf16 v33, v142, v21, v33
    v_dot2_f32_bf16 v34, v139, v21, v34
    v_dot2_f32_bf16 v35, v143, v21, v35
    v_dot2_f32_bf16 v28, v144, v22, v28
    v_dot2_f32_bf16 v29, v148, v22, v29
    v_dot2_f32_bf16 v30, v145, v22, v30
    v_dot2_f32_bf16 v31, v149, v22, v31
    v_dot2_f32_bf16 v32, v146, v22, v32
    v_dot2_f32_bf16 v33, v150, v22, v33
    v_dot2_f32_bf16 v34, v147, v22, v34
    v_dot2_f32_bf16 v35, v151, v22, v35
    v_dot2_f32_bf16 v28, v152, v23, v28
    v_dot2_f32_bf16 v29, v156, v23, v29
    v_dot2_f32_bf16 v30, v153, v23, v30
    v_dot2_f32_bf16 v31, v157, v23, v31
    v_dot2_f32_bf16 v32, v154, v23, v32
    v_dot2_f32_bf16 v33, v158, v23, v33
    v_dot2_f32_bf16 v34, v155, v23, v34
    v_dot2_f32_bf16 v35, v159, v23, v35
    v_permlane32_swap_b32 v28, v32
    v_permlane32_swap_b32 v29, v33
    v_permlane32_swap_b32 v30, v34
    v_permlane32_swap_b32 v31, v35
    v_pk_add_f32 v[28:29], v[28:29], v[32:33]
    v_pk_add_f32 v[30:31], v[30:31], v[34:35]
    s_nop 1
    v_permlane16_swap_b32 v28, v30
    v_permlane16_swap_b32 v29, v31
    v_pk_add_f32 v[28:29], v[28:29], v[30:31]
    s_nop 1
    v_add_f32_dpp v44, v28, v28 row_ror:8 row_mask:0xf bank_mask:0x3
    s_nop 1
    v_add_f32_dpp v44, v29, v29 row_ror:8 row_mask:0xf bank_mask:0xc
    buffer_store_dword v44, v15, s[36:39], s80 offen sc1
    s_branch L_fin
L_red:
    v_mov_b32 v26, 163344
    ds_write_b32 v26, v24
    s_waitcnt lgkmcnt(0)
    s_barrier
    s_cmp_lg_u32 s76, 0
    s_cbranch_scc1 L_fin
    s_sub_u32 s83, s2, 224
    v_lshrrev_b32 v14, 4, v2
    v_lshl_add_u32 v14, v9, 2, v14
    v_lshlrev_b32 v15, 2, v14
    v_lshlrev_b32 v14, 1, v14
    s_bfe_u32 s78, s97, 0x40007
    s_lshl_b32 s78, s78, 13
    s_lshr_b32 s79, s83, 1
    s_lshl_b32 s79, s79, 9
    s_add_u32 s78, s78, s79
    s_and_b32 s79, s83, 1
    s_lshl_b32 s79, s79, 7
    s_add_u32 s78, s78, s79
    s_add_u32 s78, s78, 524544
    s_mov_b32 s85, 0
Lspin_23:
    s_add_u32 s85, s85, 1
    s_cmp_gt_u32 s85, 400000
    s_cbranch_scc1 L_end
    buffer_load_dword v46, v15, s[36:39], s78 offen sc1
    s_waitcnt vmcnt(0)
    v_cmp_eq_u32 vcc, -1, v46
    s_cbranch_vccnz Lspin_23
    v_cvt_pk_bf16_f32 v47, v24, v24
    v_and_b32 v47, 0xffff0000, v47
    v_mul_f32 v47, 0xbfb8aa3b, v47
    v_exp_f32 v47, v47
    s_nop 0
    v_add_f32 v47, 1.0, v47
    v_rcp_f32 v47, v47
    s_nop 0
    v_cvt_pk_bf16_f32 v47, v47, v47
    v_and_b32 v47, 0xffff0000, v47
    v_lshl_add_u32 v13, v8, 10, v10
    s_lshr_b32 s78, s83, 3
    s_mul_i32 s78, s78, 57344
    s_and_b32 s79, s83, 7
    s_lshl_b32 s79, s79, 7
    s_add_u32 s78, s78, s79
    s_add_u32 s78, s78, 1114112
    s_and_b32 s80, s97, 0x7ff
    s_lshl_b32 s80, s80, 11
    s_lshl_b32 s79, s83, 6
    s_add_u32 s80, s80, s79
    s_mov_b32 s85, 0
Lspin_24:
    s_add_u32 s85, s85, 1
    s_cmp_gt_u32 s85, 400000
    s_cbranch_scc1 L_end
    s_add_u32 s79, s78, 0
    buffer_load_dwordx4 v[16:19], v13, s[36:39], s79 offen sc1
    s_add_u32 s79, s78, 8192
    buffer_load_dwordx4 v[20:23], v13, s[36:39], s79 offen sc1
    s_add_u32 s79, s78, 16384
    buffer_load_dwordx4 v[24:27], v13, s[36:39], s79 offen sc1
    s_add_u32 s79, s78, 24576
    buffer_load_dwordx4 v[28:31], v13, s[36:39], s79 offen sc1
    s_add_u32 s79, s78, 32768
    buffer_load_dwordx4 v[32:35], v13, s[36:39], s79 offen sc1
    s_add_u32 s79, s78, 40960
    buffer_load_dwordx4 v[36:39], v13, s[36:39], s79 offen sc1
    s_add_u32 s79, s78, 49152
    buffer_load_dwordx4 v[40:43], v13, s[36:39], s79 offen sc1
    s_waitcnt vmcnt(0)
    v_max3_u32 v48, v16, v20, v24
    v_max3_u32 v48, v48, v28, v32
    v_max3_u32 v48, v48, v36, v40
    v_cmp_eq_u32 vcc, -1, v48
    s_cbranch_vccnz Lspin_24
    v_pk_add_f32 v[16:17], v[16:17], v[20:21]
    v_pk_add_f32 v[24:25], v[24:25], v[28:29]
    v_pk_add_f32 v[32:33], v[32:33], v[36:37]
    v_pk_add_f32 v[16:17], v[16:17], v[24:25]
    v_pk_add_f32 v[32:33], v[32:33], v[40:41]
    v_pk_add_f32 v[16:17], v[16:17], v[32:33]
    v_pk_add_f32 v[18:19], v[18:19], v[22:23]
    v_pk_add_f32 v[26:27], v[26:27], v[30:31]
    v_pk_add_f32 v[34:35], v[34:35], v[38:39]
    v_pk_add_f32 v[18:19], v[18:19], v[26:27]
    v_pk_add_f32 v[34:35], v[34:35], v[42:43]
    v_pk_add_f32 v[18:19], v[18:19], v[34:35]
    s_nop 1
    v_permlane32_swap_b32 v16, v18
    v_permlane32_swap_b32 v17, v19
    v_pk_add_f32 v[16:17], v[16:17], v[18:19]
    s_nop 1
    v_permlane16_swap_b32 v16, v17
    v_add_f32 v16, v16, v17
    s_nop 1
    v_add_f32_dpp v16, v16, v16 row_ror:8 row_mask:0xf bank_mask:0xf
    v_cvt_pk_bf16_f32 v16, v16, v16
    v_and_b32 v16, 0xffff0000, v16
    v_mul_f32 v16, v16, v47
    v_cvt_pk_bf16_f32 v16, v16, v16
    v_and_b32 v16, 0xffff0000, v16
    v_add_f32 v16, v16, v46
    v_cvt_pk_bf16_f32 v16, v16, v16
    s_mov_b32 exec_lo, 0x00ff00ff
    s_mov_b32 exec_hi, 0x00ff00ff
    buffer_store_short v16, v14, s[44:47], s80 offen
    s_mov_b64 exec, -1
    s_cmp_lg_u32 s2, 224
    s_cbranch_scc1 Lep_25
    s_cmp_lg_u32 s76, 0
    s_cbranch_scc1 Lep_25
    v_mov_b32 v196, s75
    v_mov_b32 v197, 0
    s_mov_b64 exec, 1
    buffer_store_dword v196, v197, s[36:39], 0 offen sc1
    s_mov_b64 exec, -1
Lep_25:
L_fin:
L_end:
    s_endpgm
.fill 64, 4, 0xbf800000
s_endpgm
.section .rodata,"a"
.p2align 6
.amdhsa_kernel sequential_preLN__linear_kernel_hedgehog__moe_arch_mod__prompt_kernel
  .amdhsa_next_free_vgpr 256
  .amdhsa_next_free_sgpr 102
  .amdhsa_accum_offset 256
  .amdhsa_group_segment_fixed_size 0
  .amdhsa_kernarg_size 96
  .amdhsa_user_sgpr_count 2
  .amdhsa_user_sgpr_kernarg_segment_ptr 1
  .amdhsa_system_sgpr_workgroup_id_x 1
  .amdhsa_float_denorm_mode_32 3
.end_amdhsa_kernel
```

```asm
; @launch grid=(256,1,1) block=(512,1,1) lds=163840
.amdgcn_target "amdgcn-amd-amdhsa--gfx950"
.text
.globl sequential_preLN__linear_kernel_hedgehog__moe_arch_mod__prompt_kernel
.p2align 8
.type sequential_preLN__linear_kernel_hedgehog__moe_arch_mod__prompt_kernel,@function
sequential_preLN__linear_kernel_hedgehog__moe_arch_mod__prompt_kernel:
    s_cmp_ge_u32 s2, 256
    s_cbranch_scc1 L_end
    s_load_dwordx16 s[4:19], s[0:1], 0
    s_load_dwordx8 s[20:27], s[0:1], 64
    v_lshrrev_b32 v1, 6, v0
    v_and_b32 v2, 63, v0
    v_readfirstlane_b32 s68, v1
    s_and_b32 s69, s2, 1
    s_lshl_b32 s69, s69, 3
    s_bfe_u32 s78, s2, 0x30003
    s_or_b32 s69, s69, s78
    s_and_b32 s70, s2, 6
    s_lshl_b32 s70, s70, 1
    s_lshr_b32 s78, s2, 6
    s_or_b32 s70, s70, s78
    s_and_b32 s76, s68, 3
    s_cmp_ge_u32 s68, 4
    s_cbranch_scc1 L_M
    v_lshrrev_b32 v196, 3, v2
    v_and_b32 v197, 7, v2
    v_lshrrev_b32_e64 v198, 4, v2
    s_mul_i32 s78, s76, 98304
    s_lshl_b32 s79, s70, 7
    s_add_u32 s78, s78, s79
    s_movk_i32 s79, 6144
    v_mov_b32 v199, s78
    v_mad_u32_u24 v199, v196, s79, v199
    v_and_b32 v200, 2, v196
    v_xor_b32 v200, v200, v197
    v_lshl_add_u32 v6, v200, 4, v199
    v_xor_b32_e64 v7, 64, v6
    v_add_u32 v7, 48128, v7
    s_lshl_b32 s78, s69, 2
    s_add_u32 s78, s78, s76
    s_lshl_b32 s78, s78, 16
    v_lshl_add_u32 v199, v196, 11, s78
    v_xor_b32 v200, v198, v197
    v_lshl_add_u32 v4, v200, 4, v199
    v_xor_b32_e64 v5, 64, v4
    v_add_u32 v5, 15360, v5
    s_lshl_b32 s88, s76, 12
    s_lshl_b32 s89, s76, 11
    s_and_b32 s78, s70, 14
    s_and_b32 s79, s69, 14
    s_add_u32 s78, s78, s79
    s_sub_u32 s78, 32, s78
    s_and_b32 s78, s78, 15
    s_lshl_b32 s86, s78, 7
    s_mul_i32 s87, s78, 393216
    s_mov_b32 s30, 0x400000
    s_mov_b32 s31, 0x20000
    s_mov_b32 s34, 0x600000
    s_mov_b32 s35, 0x20000
    s_waitcnt lgkmcnt(0)
    s_mov_b32 s32, s6
    s_and_b32 s33, s7, 0xffff
    s_mov_b32 s28, s4
    s_nop 0
    s_and_b32 s29, s5, 0xffff
    s_add_u32 m0, s88, 118784
    s_add_u32 s100, s87, 2048
    buffer_load_dwordx4 v4, s[28:31], s86 offen  lds
    buffer_load_dwordx4 v5, s[28:31], s86 offen offset:1024  lds
    s_add_u32 m0, s89, 143360
    s_add_u32 s101, s86, 32768
    buffer_load_dwordx4 v6, s[32:35], s100 offen  lds
    buffer_load_dwordx4 v7, s[32:35], s100 offen offset:1024  lds
    s_add_u32 m0, s88, 120832
    s_add_u32 s100, s87, 4096
    buffer_load_dwordx4 v4, s[28:31], s101 offen  lds
    buffer_load_dwordx4 v5, s[28:31], s101 offen offset:1024  lds
    s_add_u32 m0, s89, 151552
    s_add_u32 s86, s86, 128
    buffer_load_dwordx4 v6, s[32:35], s100 offen  lds
    buffer_load_dwordx4 v7, s[32:35], s100 offen offset:1024  lds
    s_add_u32 m0, s89, 135168
    s_nop 0
    buffer_load_dwordx4 v6, s[32:35], s87 offen  lds
    buffer_load_dwordx4 v7, s[32:35], s87 offen offset:1024  lds
    s_add_u32 s87, s87, 393216
    s_and_b32 s86, s86, 2047
    s_cselect_b32 s87, s87, 0
    s_load_dword s75, s[26:27], 0
    s_mov_b32 s60, s8
    s_and_b32 s61, s9, 0xffff
    s_mov_b32 s62, 0x10000
    s_mov_b32 s63, 0x20000
    v_lshlrev_b32_e64 v14, 4, v2
    s_lshl_b32 s78, s70, 12
    s_lshl_b32 s79, s76, 10
    s_add_u32 s78, s78, s79
    s_add_u32 m0, s79, 159744
    s_nop 0
    buffer_load_dwordx4 v14, s[60:63], s78 offen lds
    s_and_b32 s78, s2, 7
    s_lshr_b32 s79, s2, 3
    s_and_b32 s71, s78, 3
    s_lshl_b32 s71, s71, 2
    s_and_b32 s72, s79, 3
    s_add_u32 s71, s71, s72
    s_lshr_b32 s72, s78, 2
    s_lshl_b32 s72, s72, 3
    s_lshr_b32 s79, s79, 2
    s_add_u32 s72, s72, s79
    s_lshr_b32 s73, s2, 2
    s_and_b32 s74, s2, 3
    s_lshl_b32 s77, s70, 4
    s_add_u32 s77, s77, s69
    s_mov_b32 s36, s26
    s_and_b32 s37, s27, 0xffff
    s_mov_b32 s38, 0x10000000
    s_mov_b32 s39, 0x20000
    s_mov_b32 s40, s10
    s_and_b32 s41, s11, 0xffff
    s_mov_b32 s42, 0x200000
    s_mov_b32 s43, 0x20000
    s_mov_b32 s44, s22
    s_and_b32 s45, s23, 0xffff
    s_mov_b32 s46, 0x400000
    s_mov_b32 s47, 0x20000
    s_mov_b32 s48, s16
    s_and_b32 s49, s17, 0xffff
    s_mov_b32 s50, 0x700000
    s_mov_b32 s51, 0x20000
    s_mov_b32 s52, s18
    s_and_b32 s53, s19, 0xffff
    s_mov_b32 s54, 0x700000
    s_mov_b32 s55, 0x20000
    s_mov_b32 s56, s20
    s_and_b32 s57, s21, 0xffff
    s_mov_b32 s58, 0x700000
    s_mov_b32 s59, 0x20000
    v_mov_b32 v16, -1
    v_mov_b32 v17, -1
    v_mov_b32 v18, -1
    v_mov_b32 v19, -1
    s_lshl_b32 s94, s77, 14
    s_lshl_b32 s78, s76, 12
    s_add_u32 s94, s94, s78
    s_add_u32 s94, s94, 4194304
    s_lshl_b32 s96, s77, 10
    s_add_u32 s96, s96, 8388608
    s_cmp_eq_u32 s76, 3
    s_cselect_b32 s96, s96, 0x10000000
    v_and_b32 v196, 15, v2
    v_lshrrev_b32 v197, 1, v196
    v_lshlrev_b32 v199, 7, v196
    v_add_u32 v199, s88, v199
    v_xor_b32_e64 v200, v198, v197
    v_lshl_add_u32 v60, v200, 4, v199
    v_xor_b32_e64 v61, 64, v60
    v_bfe_u32 v196, v2, 2, 2
    v_and_b32_e64 v197, 3, v2
    v_lshl_add_u32 v199, v198, 3, v196
    v_lshlrev_b32_e64 v199, 7, v199
    v_lshl_add_u32 v199, v197, 3, v199
    v_lshrrev_b32 v196, 1, v196
    v_and_b32 v197, 1, v198
    v_lshl_add_u32 v196, v197, 1, v196
    s_mul_i32 s80, s76, 3
    s_add_u32 s78, s80, 0
    s_and_b32 s79, s78, 3
    s_lshr_b32 s78, s78, 2
    s_lshl_b32 s78, s78, 13
    s_add_u32 s78, s78, 16384
    v_xor_b32 v197, s79, v196
    v_lshl_add_u32 v197, v197, 5, v199
    v_add_u32_e64 v240, s78, v197
    s_add_u32 s78, s80, 1
    s_and_b32 s79, s78, 3
    s_lshr_b32 s78, s78, 2
    s_lshl_b32 s78, s78, 13
    s_add_u32 s78, s78, 16384
    v_xor_b32_e64 v197, s79, v196
    v_lshl_add_u32 v197, v197, 5, v199
    v_add_u32_e64 v241, s78, v197
    s_add_u32 s78, s80, 2
    s_and_b32 s79, s78, 3
    s_lshr_b32 s78, s78, 2
    s_lshl_b32 s78, s78, 13
    s_add_u32 s78, s78, 16384
    v_xor_b32_e64 v197, s79, v196
    v_lshl_add_u32 v197, v197, 5, v199
    v_add_u32_e64 v242, s78, v197
    s_and_b32 s82, s70, 1
    s_and_b32 s83, s69, 1
    s_add_u32 m0, s88, 36864
    s_add_u32 s100, s87, 2048
    buffer_load_dwordx4 v4, s[28:31], s86 offen  lds
    v_lshrrev_b32 v196, 3, v2
    v_and_b32 v197, 7, v2
    v_lshlrev_b32_e64 v199, 4, v197
    v_mul_u32_u24 v244, 57344, v196
    v_add_u32_e64 v244, v244, v199
    buffer_load_dwordx4 v5, s[28:31], s86 offen offset:1024  lds
    v_lshl_add_u32 v245, v196, 14, v199
    s_lshl_b32 s78, s74, 2
    s_add_u32 s78, s78, s76
    s_mul_i32 s79, s78, 458752
    s_lshl_b32 s80, s73, 7
    s_add_u32 m0, s89, 61440
    s_add_u32 s101, s86, 32768
    buffer_load_dwordx4 v6, s[32:35], s100 offen  lds
    s_add_u32 s79, s79, s80
    s_cmp_ge_u32 s73, 56
    s_cselect_b32 s79, 0x8000000, s79
    v_add_u32_e64 v244, s79, v244
    s_lshl_b32 s78, s78, 7
    s_lshl_b32 s80, s73, 17
    s_add_u32 s78, s78, s80
    buffer_load_dwordx4 v7, s[32:35], s100 offen offset:1024  lds
    v_add_u32 v245, s78, v245
    s_lshl_b32 s78, s72, 7
    v_lshl_add_u32 v196, v196, 11, s78
    v_lshlrev_b32 v199, 1, v198
    v_xor_b32 v199, v199, v197
    v_lshl_add_u32 v246, v199, 4, v196
    s_add_u32 m0, s88, 38912
    s_add_u32 s100, s87, 4096
    buffer_load_dwordx4 v4, s[28:31], s101 offen  lds
    s_lshl_b32 s78, s71, 2
    s_add_u32 s78, s78, s76
    s_lshl_b32 s78, s78, 16
    v_add_u32 v196, s78, v196
    v_xor_b32_e64 v199, v198, v197
    buffer_load_dwordx4 v5, s[28:31], s101 offen offset:1024  lds
    v_lshl_add_u32 v247, v199, 4, v196
    v_xor_b32 v248, 64, v247
    s_lshl_b32 s78, s76, 14
    v_add_u32 v246, s78, v246
    s_lshl_b32 s81, s76, 10
    s_add_u32 m0, s89, 69632
    s_add_u32 s86, s86, 128
    buffer_load_dwordx4 v6, s[32:35], s100 offen  lds
    s_and_b32 s78, s70, 3
    s_lshl_b32 s78, s78, 3
    s_and_b32 s79, s69, 7
    s_add_u32 s78, s78, s79
    s_mul_i32 s78, s78, 12288
    s_and_b32 s79, s70, 8
    buffer_load_dwordx4 v7, s[32:35], s100 offen offset:1024  lds
    s_add_u32 s79, s79, 3
    s_lshl_b32 s79, s79, 7
    s_add_u32 s78, s78, s79
    s_bitcmp1_b32 s70, 2
    s_cselect_b32 s78, 0x8000000, s78
    v_lshl_add_u32 v62, v2, 11, s78
    s_and_b32 s78, s70, 8
    s_add_u32 m0, s89, 53248
    s_nop 0
    buffer_load_dwordx4 v6, s[32:35], s87 offen  lds
    s_add_u32 s78, s78, 2
    s_and_b32 s79, s69, 8
    s_add_u32 s78, s78, s79
    s_sub_u32 s3, 35, s78
    s_lshr_b32 s78, s2, 3
    buffer_load_dwordx4 v7, s[32:35], s87 offen offset:1024  lds
    s_add_u32 s87, s87, 393216
    s_and_b32 s86, s86, 2047
    s_cselect_b32 s87, s87, 0
    s_lshl_b32 s78, s78, 16
    s_and_b32 s79, s72, 8
    s_add_u32 s79, s79, 3
    s_lshl_b32 s79, s79, 7
    s_add_u32 s78, s78, s79
    v_lshl_add_u32 v63, v2, 11, s78
    s_waitcnt vmcnt(10)
    s_barrier
    s_cmp_lg_u32 s82, 0
    s_cbranch_scc1 Lsx_1
    v_add_u32 v196, 118784, v60
    v_add_u32 v197, 118784, v61
    ds_read_b128 v[20:23], v196 offset:0
    ds_read_b128 v[24:27], v196 offset:2048
    ds_read_b128 v[28:31], v197 offset:0
    ds_read_b128 v[32:35], v197 offset:2048
Lsx_1:
    s_cmp_lg_u32 s83, 0
    s_cbranch_scc1 Lsw_2
    v_add_u32 v198, 118784, v240
    v_add_u32 v199, 118784, v241
    v_add_u32 v200, 118784, v242
    ds_read_b64_tr_b16 v[36:37], v198 offset:0
    ds_read_b64_tr_b16 v[38:39], v198 offset:512
    ds_read_b64_tr_b16 v[40:41], v198 offset:4096
    ds_read_b64_tr_b16 v[42:43], v198 offset:4608
    ds_read_b64_tr_b16 v[44:45], v199 offset:0
    ds_read_b64_tr_b16 v[46:47], v199 offset:512
    ds_read_b64_tr_b16 v[48:49], v199 offset:4096
    ds_read_b64_tr_b16 v[50:51], v199 offset:4608
    ds_read_b64_tr_b16 v[52:53], v200 offset:0
    ds_read_b64_tr_b16 v[54:55], v200 offset:512
    ds_read_b64_tr_b16 v[56:57], v200 offset:4096
    ds_read_b64_tr_b16 v[58:59], v200 offset:4608
Lsw_2:
    s_cmp_lg_u32 s76, 0
    s_cbranch_scc1 Lc3_3
    s_add_u32 s100, s3, 0
    s_and_b32 s100, s100, 15
    s_mul_i32 s100, s100, 393216
    s_mov_b64 exec, 63
    buffer_load_dword v237, v62, s[32:35], s100 offen
    s_mov_b64 exec, -1
Lc3_3:
    s_add_u32 m0, s88, 77824
    s_add_u32 s100, s87, 2048
    buffer_load_dwordx4 v4, s[28:31], s86 offen  lds
    buffer_load_dwordx4 v5, s[28:31], s86 offen offset:1024  lds
    s_add_u32 m0, s89, 102400
    s_add_u32 s101, s86, 32768
    buffer_load_dwordx4 v6, s[32:35], s100 offen  lds
    buffer_load_dwordx4 v7, s[32:35], s100 offen offset:1024  lds
    s_add_u32 m0, s88, 79872
    s_add_u32 s100, s87, 4096
    buffer_load_dwordx4 v4, s[28:31], s101 offen  lds
    buffer_load_dwordx4 v5, s[28:31], s101 offen offset:1024  lds
    s_add_u32 m0, s89, 110592
    s_add_u32 s86, s86, 128
    buffer_load_dwordx4 v6, s[32:35], s100 offen  lds
    buffer_load_dwordx4 v7, s[32:35], s100 offen offset:1024  lds
    s_add_u32 m0, s89, 94208
    s_nop 0
    buffer_load_dwordx4 v6, s[32:35], s87 offen  lds
    buffer_load_dwordx4 v7, s[32:35], s87 offen offset:1024  lds
    s_add_u32 s87, s87, 393216
    s_and_b32 s86, s86, 2047
    s_cselect_b32 s87, s87, 0
    s_lshl_b32 s100, s77, 13
    s_add_u32 s100, s100, s89
    buffer_load_dwordx4 v[160:163], v14, s[40:43], s100 offen offset:0
    s_waitcnt lgkmcnt(0)
    s_mul_i32 s75, s75, 0x9E3779B1
    s_add_u32 s75, s75, 0x7F4A7C15
    s_waitcnt vmcnt(11)
    s_waitcnt lgkmcnt(0)
    s_barrier
    s_cmp_lg_u32 s82, 1
    s_cbranch_scc1 Lsx_4
    v_add_u32 v196, 36864, v60
    v_add_u32 v197, 36864, v61
    ds_read_b128 v[20:23], v196 offset:0
    ds_read_b128 v[24:27], v196 offset:2048
    ds_read_b128 v[28:31], v197 offset:0
    ds_read_b128 v[32:35], v197 offset:2048
Lsx_4:
    s_cmp_lg_u32 s83, 1
    s_cbranch_scc1 Lsw_5
    v_add_u32 v198, 36864, v240
    v_add_u32 v199, 36864, v241
    v_add_u32 v200, 36864, v242
    ds_read_b64_tr_b16 v[36:37], v198 offset:0
    ds_read_b64_tr_b16 v[38:39], v198 offset:512
    ds_read_b64_tr_b16 v[40:41], v198 offset:4096
    ds_read_b64_tr_b16 v[42:43], v198 offset:4608
    ds_read_b64_tr_b16 v[44:45], v199 offset:0
    ds_read_b64_tr_b16 v[46:47], v199 offset:512
    ds_read_b64_tr_b16 v[48:49], v199 offset:4096
    ds_read_b64_tr_b16 v[50:51], v199 offset:4608
    ds_read_b64_tr_b16 v[52:53], v200 offset:0
    ds_read_b64_tr_b16 v[54:55], v200 offset:512
    ds_read_b64_tr_b16 v[56:57], v200 offset:4096
    ds_read_b64_tr_b16 v[58:59], v200 offset:4608
Lsw_5:
    s_cmp_lg_u32 s76, 1
    s_cbranch_scc1 Lc3_6
    s_add_u32 s100, s3, 1
    s_and_b32 s100, s100, 15
    s_mul_i32 s100, s100, 393216
    s_mov_b64 exec, 63
    buffer_load_dword v237, v62, s[32:35], s100 offen
    s_mov_b64 exec, -1
Lc3_6:
    s_add_u32 m0, s88, 118784
    s_add_u32 s100, s87, 2048
    buffer_load_dwordx4 v4, s[28:31], s86 offen  lds
    buffer_load_dwordx4 v5, s[28:31], s86 offen offset:1024  lds
    s_add_u32 m0, s89, 143360
    s_add_u32 s101, s86, 32768
    buffer_load_dwordx4 v6, s[32:35], s100 offen  lds
    buffer_load_dwordx4 v7, s[32:35], s100 offen offset:1024  lds
    s_add_u32 m0, s88, 120832
    s_add_u32 s100, s87, 4096
    buffer_load_dwordx4 v4, s[28:31], s101 offen  lds
    buffer_load_dwordx4 v5, s[28:31], s101 offen offset:1024  lds
    s_add_u32 m0, s89, 151552
    s_add_u32 s86, s86, 128
    buffer_load_dwordx4 v6, s[32:35], s100 offen  lds
    buffer_load_dwordx4 v7, s[32:35], s100 offen offset:1024  lds
    s_add_u32 m0, s89, 135168
    s_nop 0
    buffer_load_dwordx4 v6, s[32:35], s87 offen  lds
    buffer_load_dwordx4 v7, s[32:35], s87 offen offset:1024  lds
    s_add_u32 s87, s87, 393216
    s_and_b32 s86, s86, 2047
    s_cselect_b32 s87, s87, 0
    s_lshl_b32 s100, s77, 13
    s_add_u32 s100, s100, s89
    buffer_load_dwordx4 v[160:163], v14, s[40:43], s100 offen offset:1024
    s_waitcnt vmcnt(12)
    s_waitcnt lgkmcnt(0)
    s_barrier
    s_cmp_lg_u32 s76, 2
    s_cbranch_scc1 Lc3_7
    s_add_u32 s100, s3, 2
    s_and_b32 s100, s100, 15
    s_mul_i32 s100, s100, 393216
    s_mov_b64 exec, 63
    buffer_load_dword v237, v62, s[32:35], s100 offen
    s_mov_b64 exec, -1
Lc3_7:
    s_setprio 2
    s_add_u32 m0, s88, 36864
    s_add_u32 s100, s87, 2048
    buffer_load_dwordx4 v4, s[28:31], s86 offen  lds
    v_mov_b32 v200, 0x3f803f80
    v_mov_b32 v201, 0x3f803f80
    v_mov_b32 v202, 0x3f803f80
    v_mov_b32 v203, 0x3f803f80
    buffer_load_dwordx4 v5, s[28:31], s86 offen offset:1024  lds
    s_nop 0
    s_nop 0
    v_mfma_f32_16x16x32_bf16 v[204:207], v[200:203], v[20:23], 0
    v_mfma_f32_16x16x32_bf16 v[212:215], v[20:23], v[20:23], 0
    v_mfma_f32_16x16x32_bf16 v[208:211], v[200:203], v[24:27], 0
    v_mfma_f32_16x16x32_bf16 v[216:219], v[24:27], v[24:27], 0
    v_mfma_f32_16x16x32_bf16 v[220:223], v[200:203], v[36:39], 0
    s_add_u32 m0, s89, 61440
    s_add_u32 s101, s86, 32768
    buffer_load_dwordx4 v6, s[32:35], s100 offen  lds
    v_mfma_f32_16x16x32_bf16 v[224:227], v[200:203], v[44:47], 0
    v_mfma_f32_16x16x32_bf16 v[228:231], v[200:203], v[52:55], 0
    v_mfma_f32_16x16x32_bf16 v[204:207], v[200:203], v[28:31], v[204:207]
    v_mfma_f32_16x16x32_bf16 v[212:215], v[28:31], v[28:31], v[212:215]
    v_mfma_f32_16x16x32_bf16 v[208:211], v[200:203], v[32:35], v[208:211]
    buffer_load_dwordx4 v7, s[32:35], s100 offen offset:1024  lds
    v_mfma_f32_16x16x32_bf16 v[216:219], v[32:35], v[32:35], v[216:219]
    v_mfma_f32_16x16x32_bf16 v[220:223], v[200:203], v[40:43], v[220:223]
    v_mfma_f32_16x16x32_bf16 v[224:227], v[200:203], v[48:51], v[224:227]
    v_mfma_f32_16x16x32_bf16 v[228:231], v[200:203], v[56:59], v[228:231]
    v_and_b32_e64 v196, 3, v2
    s_add_u32 m0, s88, 38912
    s_add_u32 s100, s87, 4096
    buffer_load_dwordx4 v4, s[28:31], s101 offen  lds
    v_cmp_eq_u32 s[90:91], 1, v196
    v_cmp_eq_u32 s[92:93], 2, v196
    v_cmp_eq_u32_e64 vcc, 3, v196
    v_cndmask_b32 v212, v212, v213, s[90:91]
    v_cndmask_b32 v212, v212, v214, s[92:93]
    buffer_load_dwordx4 v5, s[28:31], s101 offen offset:1024  lds
    v_cndmask_b32_e64 v205, v212, v215, vcc
    v_cndmask_b32 v216, v216, v217, s[90:91]
    v_cndmask_b32 v216, v216, v218, s[92:93]
    v_cndmask_b32 v209, v216, v219, vcc
    v_lshrrev_b32 v196, 4, v2
    s_add_u32 m0, s89, 69632
    s_add_u32 s86, s86, 128
    buffer_load_dwordx4 v6, s[32:35], s100 offen  lds
    v_cmp_eq_u32 s[90:91], 1, v196
    v_cmp_eq_u32 vcc, 2, v196
    s_nop 0
    v_cndmask_b32 v220, v220, v224, s[90:91]
    v_cndmask_b32_e64 v220, v220, v228, vcc
    s_mul_i32 s78, s77, 768
    buffer_load_dwordx4 v7, s[32:35], s100 offen offset:1024  lds
    s_mul_i32 s79, s76, 192
    s_add_u32 s78, s78, s79
    s_add_u32 s78, s78, 327680
    v_lshlrev_b32 v197, 2, v2
    s_mov_b32 exec_hi, 0xffff
    buffer_store_dword v220, v197, s[36:39], s78 offen sc1
    s_mov_b32 exec_hi, -1
    s_add_u32 m0, s89, 53248
    s_nop 0
    buffer_load_dwordx4 v6, s[32:35], s87 offen  lds
    s_lshl_b32 s78, s69, 4
    s_add_u32 s78, s78, s70
    s_lshl_b32 s78, s78, 10
    s_lshl_b32 s79, s76, 8
    s_add_u32 s78, s78, s79
    buffer_load_dwordx4 v7, s[32:35], s87 offen offset:1024  lds
    s_add_u32 s87, s87, 393216
    s_and_b32 s86, s86, 2047
    s_cselect_b32 s87, s87, 0
    s_add_u32 s78, s78, 65536
    v_and_b32 v198, 15, v2
    v_lshlrev_b32 v198, 3, v198
    s_mov_b32 exec_lo, 0x00f0000f
    s_mov_b32 exec_hi, 0xf0000f00
    buffer_store_dwordx2 v[204:205], v198, s[36:39], s78 offen offset:0 sc1
    s_mov_b64 exec, -1
    s_mov_b32 exec_lo, 0x00f0000f
    s_mov_b32 exec_hi, 0xf0000f00
    buffer_store_dwordx2 v[208:209], v198, s[36:39], s78 offen offset:128 sc1
    s_mov_b64 exec, -1
    s_setprio 0
    s_waitcnt vmcnt(14)
    s_waitcnt lgkmcnt(0)
    s_barrier
    s_cmp_lg_u32 s76, 3
    s_cbranch_scc1 Lc3_8
    s_add_u32 s100, s3, 3
    s_and_b32 s100, s100, 15
    s_mul_i32 s100, s100, 393216
    s_mov_b64 exec, 63
    buffer_load_dword v237, v62, s[32:35], s100 offen
    s_mov_b64 exec, -1
Lc3_8:
    s_add_u32 m0, s88, 77824
    s_add_u32 s100, s87, 2048
    buffer_load_dwordx4 v4, s[28:31], s86 offen  lds
    buffer_load_dwordx4 v5, s[28:31], s86 offen offset:1024  lds
    s_add_u32 m0, s89, 102400
    s_add_u32 s101, s86, 32768
    buffer_load_dwordx4 v6, s[32:35], s100 offen  lds
    buffer_load_dwordx4 v7, s[32:35], s100 offen offset:1024  lds
    s_add_u32 m0, s88, 79872
    s_add_u32 s100, s87, 4096
    buffer_load_dwordx4 v4, s[28:31], s101 offen  lds
    buffer_load_dwordx4 v5, s[28:31], s101 offen offset:1024  lds
    s_add_u32 m0, s89, 110592
    s_add_u32 s86, s86, 128
    buffer_load_dwordx4 v6, s[32:35], s100 offen  lds
    buffer_load_dwordx4 v7, s[32:35], s100 offen offset:1024  lds
    s_add_u32 m0, s89, 94208
    s_nop 0
    buffer_load_dwordx4 v6, s[32:35], s87 offen  lds
    buffer_load_dwordx4 v7, s[32:35], s87 offen offset:1024  lds
    s_add_u32 s87, s87, 393216
    s_and_b32 s86, s86, 2047
    s_cselect_b32 s87, s87, 0
    buffer_store_dwordx4 v[16:19], v14, s[36:39], s96 offen offset:0 sc1
    s_waitcnt vmcnt(13)
    s_waitcnt lgkmcnt(0)
    s_barrier
    s_cmp_lg_u32 s76, 0
    s_cbranch_scc1 Lc3_9
    s_add_u32 s100, s3, 4
    s_and_b32 s100, s100, 15
    s_mul_i32 s100, s100, 393216
    s_mov_b64 exec, 63
    buffer_load_dword v237, v62, s[32:35], s100 offen
    s_mov_b64 exec, -1
Lc3_9:
    s_nop 0
    s_add_u32 m0, s88, 118784
    s_add_u32 s100, s87, 2048
    buffer_load_dwordx4 v4, s[28:31], s86 offen  lds
    buffer_load_dwordx4 v5, s[28:31], s86 offen offset:1024  lds
    s_add_u32 m0, s89, 143360
    s_add_u32 s101, s86, 32768
    buffer_load_dwordx4 v6, s[32:35], s100 offen  lds
    buffer_load_dwordx4 v7, s[32:35], s100 offen offset:1024  lds
    s_add_u32 m0, s88, 120832
    s_add_u32 s100, s87, 4096
    buffer_load_dwordx4 v4, s[28:31], s101 offen  lds
    buffer_load_dwordx4 v5, s[28:31], s101 offen offset:1024  lds
    s_add_u32 m0, s89, 151552
    s_add_u32 s86, s86, 128
    buffer_load_dwordx4 v6, s[32:35], s100 offen  lds
    buffer_load_dwordx4 v7, s[32:35], s100 offen offset:1024  lds
    s_add_u32 m0, s89, 135168
    s_nop 0
    buffer_load_dwordx4 v6, s[32:35], s87 offen  lds
    buffer_load_dwordx4 v7, s[32:35], s87 offen offset:1024  lds
    s_add_u32 s87, s87, 393216
    s_and_b32 s86, s86, 2047
    s_cselect_b32 s87, s87, 0
    s_waitcnt vmcnt(10)
    s_barrier
    s_cmp_lg_u32 s76, 1
    s_cbranch_scc1 Lc3_10
    s_add_u32 s100, s3, 5
    s_and_b32 s100, s100, 15
    s_mul_i32 s100, s100, 393216
    s_mov_b64 exec, 63
    buffer_load_dword v237, v62, s[32:35], s100 offen
    s_mov_b64 exec, -1
Lc3_10:
    s_cmp_lg_u32 s76, 0
    s_cbranch_scc1 Lfl_11
    s_lshl_b32 s78, s77, 7
    s_add_u32 s78, s78, 4096
    v_mov_b32 v196, s75
    v_lshlrev_b32 v197, 2, v2
    s_mov_b32 exec_hi, 0
    buffer_store_dword v196, v197, s[36:39], s78 offen sc1
    s_mov_b64 exec, -1
    v_not_b32_e64 v196, v196
    s_lshl_b32 s78, s77, 7
    s_add_u32 s79, s78, 8781824
    s_add_u32 s78, s78, 8716288
    s_lshl_b32 s80, s71, 4
    s_add_u32 s80, s80, s72
    s_lshl_b32 s80, s80, 7
    s_add_u32 s80, s80, 8847360
    s_mov_b32 exec_hi, 0
    buffer_store_dword v196, v197, s[36:39], s78 offen sc1
    buffer_store_dword v196, v197, s[36:39], s79 offen sc1
    buffer_store_dword v196, v197, s[36:39], s80 offen sc1
    s_mov_b64 exec, -1
    v_and_b32 v196, 15, v2
    v_lshlrev_b32 v197, 4, v196
    v_add_u32 v197, s69, v197
    s_lshl_b32 s78, s70, 4
    v_add_u32 v196, s78, v196
    v_and_b32 v198, 16, v2
    v_cmp_eq_u32 vcc, 0, v198
    s_nop 1
    v_cndmask_b32 v196, v196, v197, vcc
    v_lshlrev_b32_e64 v196, 7, v196
    v_add_u32 v196, 4096, v196
Lfl_11:
    s_add_u32 m0, s88, 36864
    s_add_u32 s100, s87, 2048
    buffer_load_dwordx4 v4, s[28:31], s86 offen  lds
    buffer_load_dwordx4 v5, s[28:31], s86 offen offset:1024  lds
    s_add_u32 m0, s89, 61440
    s_add_u32 s101, s86, 32768
    buffer_load_dwordx4 v6, s[32:35], s100 offen  lds
    buffer_load_dwordx4 v7, s[32:35], s100 offen offset:1024  lds
    s_add_u32 m0, s88, 38912
    s_add_u32 s100, s87, 4096
    buffer_load_dwordx4 v4, s[28:31], s101 offen  lds
    buffer_load_dwordx4 v5, s[28:31], s101 offen offset:1024  lds
    s_add_u32 m0, s89, 69632
    s_add_u32 s86, s86, 128
    buffer_load_dwordx4 v6, s[32:35], s100 offen  lds
    buffer_load_dwordx4 v7, s[32:35], s100 offen offset:1024  lds
    s_add_u32 m0, s89, 53248
    s_nop 0
    buffer_load_dwordx4 v6, s[32:35], s87 offen  lds
    buffer_load_dwordx4 v7, s[32:35], s87 offen offset:1024  lds
    s_add_u32 s87, s87, 393216
    s_and_b32 s86, s86, 2047
    s_cselect_b32 s87, s87, 0
    s_waitcnt vmcnt(10)
    s_barrier
    s_cmp_lg_u32 s76, 2
    s_cbranch_scc1 Lc3_12
    s_add_u32 s100, s3, 6
    s_and_b32 s100, s100, 15
    s_mul_i32 s100, s100, 393216
    s_mov_b64 exec, 63
    buffer_load_dword v237, v62, s[32:35], s100 offen
    s_mov_b64 exec, -1
Lc3_12:
    s_add_u32 m0, s88, 77824
    s_add_u32 s100, s87, 2048
    buffer_load_dwordx4 v4, s[28:31], s86 offen  lds
    buffer_load_dwordx4 v5, s[28:31], s86 offen offset:1024  lds
    s_add_u32 m0, s89, 102400
    s_add_u32 s101, s86, 32768
    buffer_load_dwordx4 v6, s[32:35], s100 offen  lds
    buffer_load_dwordx4 v7, s[32:35], s100 offen offset:1024  lds
    s_add_u32 m0, s88, 79872
    s_add_u32 s100, s87, 4096
    buffer_load_dwordx4 v4, s[28:31], s101 offen  lds
    buffer_load_dwordx4 v5, s[28:31], s101 offen offset:1024  lds
    s_add_u32 m0, s89, 110592
    s_add_u32 s86, s86, 128
    buffer_load_dwordx4 v6, s[32:35], s100 offen  lds
    buffer_load_dwordx4 v7, s[32:35], s100 offen offset:1024  lds
    s_add_u32 m0, s89, 94208
    s_nop 0
    buffer_load_dwordx4 v6, s[32:35], s87 offen  lds
    buffer_load_dwordx4 v7, s[32:35], s87 offen offset:1024  lds
    s_add_u32 s87, s87, 393216
    s_and_b32 s86, s86, 2047
    s_cselect_b32 s87, s87, 0
    s_waitcnt vmcnt(10)
    s_barrier
    s_cmp_lg_u32 s76, 3
    s_cbranch_scc1 Lc3_13
    s_add_u32 s100, s3, 7
    s_and_b32 s100, s100, 15
    s_mul_i32 s100, s100, 393216
    s_mov_b64 exec, 63
    buffer_load_dword v237, v62, s[32:35], s100 offen
    s_mov_b64 exec, -1
Lc3_13:
    s_add_u32 m0, s88, 118784
    s_add_u32 s100, s87, 2048
    buffer_load_dwordx4 v4, s[28:31], s86 offen  lds
    buffer_load_dwordx4 v5, s[28:31], s86 offen offset:1024  lds
    s_add_u32 m0, s89, 143360
    s_add_u32 s101, s86, 32768
    buffer_load_dwordx4 v6, s[32:35], s100 offen  lds
    buffer_load_dwordx4 v7, s[32:35], s100 offen offset:1024  lds
    s_add_u32 m0, s88, 120832
    s_add_u32 s100, s87, 4096
    buffer_load_dwordx4 v4, s[28:31], s101 offen  lds
    buffer_load_dwordx4 v5, s[28:31], s101 offen offset:1024  lds
    s_add_u32 m0, s89, 151552
    s_add_u32 s86, s86, 128
    buffer_load_dwordx4 v6, s[32:35], s100 offen  lds
    buffer_load_dwordx4 v7, s[32:35], s100 offen offset:1024  lds
    s_add_u32 m0, s89, 135168
    s_nop 0
    buffer_load_dwordx4 v6, s[32:35], s87 offen  lds
    buffer_load_dwordx4 v7, s[32:35], s87 offen offset:1024  lds
    s_add_u32 s87, s87, 393216
    s_and_b32 s86, s86, 2047
    s_cselect_b32 s87, s87, 0
    s_waitcnt vmcnt(10)
    s_barrier
    s_cmp_lg_u32 s76, 0
    s_cbranch_scc1 Lc3_14
    s_add_u32 s100, s3, 8
    s_and_b32 s100, s100, 15
    s_mul_i32 s100, s100, 393216
    s_mov_b64 exec, 63
    buffer_load_dword v237, v62, s[32:35], s100 offen
    s_mov_b64 exec, -1
Lc3_14:
    s_add_u32 m0, s88, 36864
    s_add_u32 s100, s87, 2048
    buffer_load_dwordx4 v4, s[28:31], s86 offen  lds
    buffer_load_dwordx4 v5, s[28:31], s86 offen offset:1024  lds
    s_add_u32 m0, s89, 61440
    s_add_u32 s101, s86, 32768
    buffer_load_dwordx4 v6, s[32:35], s100 offen  lds
    buffer_load_dwordx4 v7, s[32:35], s100 offen offset:1024  lds
    s_add_u32 m0, s88, 38912
    s_add_u32 s100, s87, 4096
    buffer_load_dwordx4 v4, s[28:31], s101 offen  lds
    buffer_load_dwordx4 v5, s[28:31], s101 offen offset:1024  lds
    s_add_u32 m0, s89, 69632
    s_add_u32 s86, s86, 128
    buffer_load_dwordx4 v6, s[32:35], s100 offen  lds
    buffer_load_dwordx4 v7, s[32:35], s100 offen offset:1024  lds
    s_add_u32 m0, s89, 53248
    s_nop 0
    buffer_load_dwordx4 v6, s[32:35], s87 offen  lds
    buffer_load_dwordx4 v7, s[32:35], s87 offen offset:1024  lds
    s_add_u32 s87, s87, 393216
    s_and_b32 s86, s86, 2047
    s_cselect_b32 s87, s87, 0
    s_waitcnt vmcnt(10)
    s_barrier
    s_cmp_lg_u32 s76, 1
    s_cbranch_scc1 Lc3_15
    s_add_u32 s100, s3, 9
    s_and_b32 s100, s100, 15
    s_mul_i32 s100, s100, 393216
    s_mov_b64 exec, 63
    buffer_load_dword v237, v62, s[32:35], s100 offen
    s_mov_b64 exec, -1
Lc3_15:
    s_add_u32 m0, s88, 77824
    s_add_u32 s100, s87, 2048
    buffer_load_dwordx4 v4, s[28:31], s86 offen  lds
    buffer_load_dwordx4 v5, s[28:31], s86 offen offset:1024  lds
    s_add_u32 m0, s89, 102400
    s_add_u32 s101, s86, 32768
    buffer_load_dwordx4 v6, s[32:35], s100 offen  lds
    buffer_load_dwordx4 v7, s[32:35], s100 offen offset:1024  lds
    s_add_u32 m0, s88, 79872
    s_add_u32 s100, s87, 4096
    buffer_load_dwordx4 v4, s[28:31], s101 offen  lds
    buffer_load_dwordx4 v5, s[28:31], s101 offen offset:1024  lds
    s_add_u32 m0, s89, 110592
    s_add_u32 s86, s86, 128
    buffer_load_dwordx4 v6, s[32:35], s100 offen  lds
    buffer_load_dwordx4 v7, s[32:35], s100 offen offset:1024  lds
    s_add_u32 m0, s89, 94208
    s_nop 0
    buffer_load_dwordx4 v6, s[32:35], s87 offen  lds
    buffer_load_dwordx4 v7, s[32:35], s87 offen offset:1024  lds
    s_add_u32 s87, s87, 393216
    s_and_b32 s86, s86, 2047
    s_cselect_b32 s87, s87, 0
    s_waitcnt vmcnt(10)
    s_barrier
    s_cmp_lg_u32 s76, 2
    s_cbranch_scc1 Lc3_16
    s_add_u32 s100, s3, 10
    s_and_b32 s100, s100, 15
    s_mul_i32 s100, s100, 393216
    s_mov_b64 exec, 63
    buffer_load_dword v237, v62, s[32:35], s100 offen
    s_mov_b64 exec, -1
Lc3_16:
    s_add_u32 m0, s88, 118784
    s_add_u32 s100, s87, 2048
    buffer_load_dwordx4 v4, s[28:31], s86 offen  lds
    buffer_load_dwordx4 v5, s[28:31], s86 offen offset:1024  lds
    s_add_u32 m0, s89, 143360
    s_add_u32 s101, s86, 32768
    buffer_load_dwordx4 v6, s[32:35], s100 offen  lds
    buffer_load_dwordx4 v7, s[32:35], s100 offen offset:1024  lds
    s_add_u32 m0, s88, 120832
    s_add_u32 s100, s87, 4096
    buffer_load_dwordx4 v4, s[28:31], s101 offen  lds
    buffer_load_dwordx4 v5, s[28:31], s101 offen offset:1024  lds
    s_add_u32 m0, s89, 151552
    s_add_u32 s86, s86, 128
    buffer_load_dwordx4 v6, s[32:35], s100 offen  lds
    buffer_load_dwordx4 v7, s[32:35], s100 offen offset:1024  lds
    s_add_u32 m0, s89, 135168
    s_nop 0
    buffer_load_dwordx4 v6, s[32:35], s87 offen  lds
    buffer_load_dwordx4 v7, s[32:35], s87 offen offset:1024  lds
    s_add_u32 s87, s87, 393216
    s_and_b32 s86, s86, 2047
    s_cselect_b32 s87, s87, 0
    s_waitcnt vmcnt(10)
    s_barrier
    s_cmp_lg_u32 s76, 3
    s_cbranch_scc1 Lc3_17
    s_add_u32 s100, s3, 11
    s_and_b32 s100, s100, 15
    s_mul_i32 s100, s100, 393216
    s_mov_b64 exec, 63
    buffer_load_dword v237, v62, s[32:35], s100 offen
    s_mov_b64 exec, -1
Lc3_17:
    s_add_u32 m0, s88, 36864
    s_add_u32 s100, s87, 2048
    buffer_load_dwordx4 v4, s[28:31], s86 offen  lds
    buffer_load_dwordx4 v5, s[28:31], s86 offen offset:1024  lds
    s_add_u32 m0, s89, 61440
    s_add_u32 s101, s86, 32768
    buffer_load_dwordx4 v6, s[32:35], s100 offen  lds
    buffer_load_dwordx4 v7, s[32:35], s100 offen offset:1024  lds
    s_add_u32 m0, s88, 38912
    s_add_u32 s100, s87, 4096
    buffer_load_dwordx4 v4, s[28:31], s101 offen  lds
    buffer_load_dwordx4 v5, s[28:31], s101 offen offset:1024  lds
    s_add_u32 m0, s89, 69632
    s_add_u32 s86, s86, 128
    buffer_load_dwordx4 v6, s[32:35], s100 offen  lds
    buffer_load_dwordx4 v7, s[32:35], s100 offen offset:1024  lds
    s_add_u32 m0, s89, 53248
    s_nop 0
    buffer_load_dwordx4 v6, s[32:35], s87 offen  lds
    buffer_load_dwordx4 v7, s[32:35], s87 offen offset:1024  lds
    s_add_u32 s87, s87, 393216
    s_and_b32 s86, s86, 2047
    s_cselect_b32 s87, s87, 0
    s_waitcnt vmcnt(10)
    s_barrier
    s_cmp_lg_u32 s76, 0
    s_cbranch_scc1 Lc3_18
    s_add_u32 s100, s3, 12
    s_and_b32 s100, s100, 15
    s_mul_i32 s100, s100, 393216
    s_mov_b64 exec, 63
    buffer_load_dword v237, v62, s[32:35], s100 offen
    s_mov_b64 exec, -1
Lc3_18:
    s_cmp_lg_u32 s76, 2
    s_cbranch_scc1 Lc4_19
    s_mov_b32 exec_hi, 0
    buffer_load_dword v238, v63, s[40:43], 0 offen
    s_mov_b64 exec, -1
Lc4_19:
    s_cmp_lg_u32 s76, 0
    s_cbranch_scc1 Lpl_20
    s_mov_b32 exec_hi, 0
    buffer_load_dword v197, v196, s[36:39], 0 offen sc1
    s_mov_b64 exec, -1
Lpl_20:
    s_add_u32 m0, s88, 77824
    s_add_u32 s100, s87, 2048
    buffer_load_dwordx4 v4, s[28:31], s86 offen  lds
    buffer_load_dwordx4 v5, s[28:31], s86 offen offset:1024  lds
    s_add_u32 m0, s89, 102400
    s_add_u32 s101, s86, 32768
    buffer_load_dwordx4 v6, s[32:35], s100 offen  lds
    buffer_load_dwordx4 v7, s[32:35], s100 offen offset:1024  lds
    s_add_u32 m0, s88, 79872
    s_add_u32 s100, s87, 4096
    buffer_load_dwordx4 v4, s[28:31], s101 offen  lds
    buffer_load_dwordx4 v5, s[28:31], s101 offen offset:1024  lds
    s_add_u32 m0, s89, 110592
    s_add_u32 s86, s86, 128
    buffer_load_dwordx4 v6, s[32:35], s100 offen  lds
    buffer_load_dwordx4 v7, s[32:35], s100 offen offset:1024  lds
    s_add_u32 m0, s89, 94208
    s_nop 0
    buffer_load_dwordx4 v6, s[32:35], s87 offen  lds
    buffer_load_dwordx4 v7, s[32:35], s87 offen offset:1024  lds
    s_add_u32 s87, s87, 393216
    s_and_b32 s86, s86, 2047
    s_cselect_b32 s87, s87, 0
    s_waitcnt vmcnt(10)
    s_barrier
    s_add_u32 m0, s88, 118784
    s_add_u32 s100, s87, 2048
    buffer_load_dwordx4 v4, s[28:31], s86 offen  lds
    buffer_load_dwordx4 v5, s[28:31], s86 offen offset:1024  lds
    s_add_u32 m0, s89, 143360
    s_add_u32 s101, s86, 32768
    buffer_load_dwordx4 v6, s[32:35], s100 offen  lds
    buffer_load_dwordx4 v7, s[32:35], s100 offen offset:1024  lds
    s_add_u32 m0, s88, 120832
    s_add_u32 s100, s87, 4096
    buffer_load_dwordx4 v4, s[28:31], s101 offen  lds
    buffer_load_dwordx4 v5, s[28:31], s101 offen offset:1024  lds
    s_add_u32 m0, s89, 151552
    s_add_u32 s86, s86, 128
    buffer_load_dwordx4 v6, s[32:35], s100 offen  lds
    buffer_load_dwordx4 v7, s[32:35], s100 offen offset:1024  lds
    s_add_u32 m0, s89, 135168
    s_nop 0
    buffer_load_dwordx4 v6, s[32:35], s87 offen  lds
    buffer_load_dwordx4 v7, s[32:35], s87 offen offset:1024  lds
    s_add_u32 s87, s87, 393216
    s_and_b32 s86, s86, 2047
    s_cselect_b32 s87, s87, 0
    s_waitcnt vmcnt(10)
    s_cmp_lg_u32 s76, 0
    s_cbranch_scc1 Lpc_21
    s_mov_b32 exec_hi, 0
    s_mov_b32 s85, 0
    s_branch Lpk_22
Lspin_23:
    s_add_u32 s85, s85, 1
    s_cmp_gt_u32 s85, 400000
    s_cbranch_scc1 L_end
    buffer_load_dword v197, v196, s[36:39], 0 offen sc1
    s_waitcnt vmcnt(0)
Lpk_22:
    v_cmp_ne_u32 vcc, s75, v197
    s_cbranch_vccnz Lspin_23
    s_mov_b64 exec, -1
Lpc_21:
    s_barrier
    v_lshrrev_b32 v196, 4, v2
    v_and_b32 v197, 15, v2
    v_lshlrev_b32 v197, 4, v197
    v_lshl_add_u32 v198, v196, 10, v197
    s_lshl_b32 s78, s69, 14
    s_lshl_b32 s79, s76, 8
    s_add_u32 s78, s78, s79
    s_nop 0
    s_add_u32 s78, s78, 65536
    buffer_load_dwordx4 v[20:23], v198, s[36:39], s78 offen sc1
    s_add_u32 s78, s78, 4096
    buffer_load_dwordx4 v[24:27], v198, s[36:39], s78 offen sc1
    s_add_u32 s78, s78, 4096
    buffer_load_dwordx4 v[28:31], v198, s[36:39], s78 offen sc1
    s_add_u32 s78, s78, 4096
    buffer_load_dwordx4 v[32:35], v198, s[36:39], s78 offen sc1
    v_mul_u32_u24 v198, 768, v196
    v_add_u32_e64 v198, v198, v197
    s_mul_i32 s78, s70, 12288
    s_lshl_b32 s79, s76, 8
    s_add_u32 s78, s78, s79
    s_add_u32 s78, s78, 327680
    s_cmp_eq_u32 s76, 3
    s_nop 0
    s_cselect_b32 s78, 0x10000000, s78
    buffer_load_dwordx4 v[36:39], v198, s[36:39], s78 offen sc1
    s_add_u32 s78, s78, 3072
    buffer_load_dwordx4 v[40:43], v198, s[36:39], s78 offen sc1
    s_add_u32 s78, s78, 3072
    buffer_load_dwordx4 v[44:47], v198, s[36:39], s78 offen sc1
    s_add_u32 s78, s78, 3072
    buffer_load_dwordx4 v[48:51], v198, s[36:39], s78 offen sc1
    s_add_u32 m0, s81, 36864
    s_mov_b32 s100, 589824
    buffer_load_dwordx4 v246, s[40:43], s100 offen  lds
    s_add_u32 m0, s81, 40960
    s_mov_b32 s100, 655360
    buffer_load_dwordx4 v246, s[40:43], s100 offen  lds
    s_waitcnt vmcnt(10)
    s_waitcnt lgkmcnt(0)
    s_barrier
    s_setprio 2
    s_add_u32 m0, s81, 45056
    s_mov_b32 s100, 720896
    buffer_load_dwordx4 v246, s[40:43], s100 offen  lds
    s_waitcnt vmcnt(7)
    v_add_f32 v20, v20, v24
    v_add_f32 v21, v21, v25
    v_add_f32 v22, v22, v26
    v_add_f32 v23, v23, v27
    v_add_f32 v20, v20, v28
    v_add_f32 v21, v21, v29
    v_add_f32 v22, v22, v30
    v_add_f32_e64 v23, v23, v31
    s_add_u32 m0, s81, 49152
    s_mov_b32 s100, 786432
    buffer_load_dwordx4 v246, s[40:43], s100 offen  lds
    v_add_f32 v20, v20, v32
    v_add_f32 v21, v21, v33
    v_add_f32 v22, v22, v34
    v_add_f32 v23, v23, v35
    s_nop 0
    v_permlane32_swap_b32 v20, v22
    v_permlane32_swap_b32 v21, v23
    v_add_f32 v20, v20, v22
    v_add_f32 v21, v21, v23
    v_mov_b32 v22, v20
    v_mov_b32_e64 v23, v21
    s_add_u32 m0, s81, 53248
    s_mov_b32 s100, 851968
    buffer_load_dwordx4 v246, s[40:43], s100 offen  lds
    v_permlane16_swap_b32 v20, v22
    v_permlane16_swap_b32 v21, v23
    v_add_f32 v20, v20, v22
    v_add_f32 v21, v21, v23
    v_mul_f32 v24, 0x3a800000, v20
    v_mul_f32 v26, 0x3a800000, v21
    v_fma_f32 v26, -v24, v24, v26
    v_max_f32_e64 v26, 0, v26
    v_cvt_pk_bf16_f32 v24, v24, v24
    v_and_b32 v24, 0xffff0000, v24
    s_add_u32 m0, s81, 57344
    s_mov_b32 s100, 917504
    buffer_load_dwordx4 v246, s[40:43], s100 offen  lds
    v_cvt_pk_bf16_f32 v26, v26, v26
    v_and_b32 v26, 0xffff0000, v26
    v_add_f32 v26, 0x3727c5ac, v26
    v_cvt_pk_bf16_f32 v26, v26, v26
    v_and_b32 v26, 0xffff0000, v26
    v_sqrt_f32 v26, v26
    s_nop 0
    v_cvt_pk_bf16_f32 v26, v26, v26
    v_and_b32 v26, 0xffff0000, v26
    v_rcp_f32_e64 v25, v26
    v_xor_b32 v26, 0x80000000, v24
    s_add_u32 m0, s81, 61440
    s_mov_b32 s100, 983040
    buffer_load_dwordx4 v246, s[40:43], s100 offen  lds
    v_lshrrev_b32 v27, 16, v26
    v_or_b32 v26, v26, v27
    v_mov_b32 v27, 0
    v_and_b32 v196, 15, v2
    v_lshrrev_b32_e64 v197, 5, v2
    v_lshl_add_u32 v196, v196, 1, v197
    s_lshl_b32 s78, s76, 5
    v_add_u32 v196, s78, v196
    v_lshlrev_b32_e64 v197, 3, v196
    v_add_u32 v197, 159744, v197
    s_add_u32 m0, s81, 65536
    s_mov_b32 s100, 1048576
    buffer_load_dwordx4 v246, s[40:43], s100 offen  lds
    v_lshlrev_b32_e64 v196, 2, v196
    v_add_u32 v196, 162304, v196
    ds_write_b64 v197, v[26:27]
    ds_write_b32 v196, v25
    s_waitcnt vmcnt(8)
    v_add_f32 v36, v36, v40
    v_add_f32 v37, v37, v41
    v_add_f32 v38, v38, v42
    v_add_f32 v39, v39, v43
    v_add_f32 v36, v36, v44
    s_add_u32 m0, s81, 69632
    s_mov_b32 s100, 1114112
    buffer_load_dwordx4 v246, s[40:43], s100 offen  lds
    v_add_f32 v37, v37, v45
    v_add_f32 v38, v38, v46
    v_add_f32 v39, v39, v47
    v_add_f32 v36, v36, v48
    v_add_f32 v37, v37, v49
    v_add_f32 v38, v38, v50
    v_add_f32 v39, v39, v51
    s_nop 0
    v_permlane32_swap_b32 v36, v38
    v_permlane32_swap_b32 v37, v39
    v_add_f32_e64 v36, v36, v38
    s_add_u32 m0, s81, 73728
    s_mov_b32 s100, 1179648
    buffer_load_dwordx4 v246, s[40:43], s100 offen  lds
    v_add_f32 v37, v37, v39
    s_nop 1
    v_permlane16_swap_b32 v36, v37
    v_add_f32 v36, v36, v37
    v_cvt_pk_bf16_f32 v37, v36, v36
    v_and_b32 v37, 0xffff0000, v37
    v_sub_f32_e64 v38, v36, v37
    v_cvt_pk_bf16_f32 v38, v37, v38
    v_mov_b32 v39, 0
    v_and_b32 v196, 15, v2
    v_lshrrev_b32_e64 v197, 4, v2
    s_add_u32 m0, s81, 77824
    s_mov_b32 s100, 1245184
    buffer_load_dwordx4 v246, s[40:43], s100 offen  lds
    v_lshl_add_u32 v196, v196, 2, v197
    s_lshl_b32 s78, s76, 9
    s_add_u32 s78, s78, 160768
    v_lshl_add_u32 v196, v196, 3, s78
    v_and_b32 v197, 15, v2
    v_lshlrev_b32_e64 v197, 3, v197
    v_add_u32 v197, 162816, v197
    v_mov_b32 v198, 0x3f803f80
    s_cmp_eq_u32 s76, 3
    s_cselect_b64 vcc, -1, 0
    v_cndmask_b32 v196, v196, v197, vcc
    v_cndmask_b32 v38, v38, v198, vcc
    v_cndmask_b32_e64 v39, v39, v198, vcc
    ds_write_b64 v196, v[38:39]
    s_setprio 0
    s_waitcnt lgkmcnt(0)
    s_barrier
    s_nop 0
    s_add_u32 m0, s81, 81920
    s_mov_b32 s100, 1310720
    buffer_load_dwordx4 v246, s[40:43], s100 offen  lds
    s_add_u32 m0, s81, 86016
    s_mov_b32 s100, 1376256
    buffer_load_dwordx4 v246, s[40:43], s100 offen  lds
    s_add_u32 m0, s81, 90112
    s_mov_b32 s100, 1441792
    buffer_load_dwordx4 v246, s[40:43], s100 offen  lds
    s_add_u32 m0, s81, 94208
    s_mov_b32 s100, 1507328
    buffer_load_dwordx4 v246, s[40:43], s100 offen  lds
    s_add_u32 m0, s81, 98304
    s_mov_b32 s100, 1572864
    buffer_load_dwordx4 v246, s[40:43], s100 offen  lds
    s_add_u32 m0, s81, 102400
    s_mov_b32 s100, 1638400
    buffer_load_dwordx4 v246, s[40:43], s100 offen  lds
    s_add_u32 m0, s81, 106496
    s_mov_b32 s100, 1703936
    buffer_load_dwordx4 v246, s[40:43], s100 offen  lds
    s_add_u32 m0, s81, 0
    s_mov_b32 s100, 0
    buffer_load_dwordx4 v246, s[40:43], s100 offen  lds
    s_add_u32 m0, s81, 4096
    s_mov_b32 s100, 65536
    buffer_load_dwordx4 v246, s[40:43], s100 offen  lds
    s_add_u32 m0, s81, 8192
    s_mov_b32 s100, 131072
    buffer_load_dwordx4 v246, s[40:43], s100 offen  lds
    s_add_u32 m0, s81, 12288
    s_mov_b32 s100, 196608
    buffer_load_dwordx4 v246, s[40:43], s100 offen  lds
    s_add_u32 m0, s81, 16384
    s_mov_b32 s100, 262144
    buffer_load_dwordx4 v246, s[40:43], s100 offen  lds
    s_add_u32 m0, s81, 20480
    s_mov_b32 s100, 327680
    buffer_load_dwordx4 v246, s[40:43], s100 offen  lds
    s_add_u32 m0, s81, 24576
    s_mov_b32 s100, 393216
    buffer_load_dwordx4 v246, s[40:43], s100 offen  lds
    s_add_u32 m0, s81, 28672
    s_mov_b32 s100, 458752
    buffer_load_dwordx4 v246, s[40:43], s100 offen  lds
    s_add_u32 m0, s81, 32768
    s_mov_b32 s100, 524288
    buffer_load_dwordx4 v246, s[40:43], s100 offen  lds
    s_mov_b32 s100, 1769472
    buffer_load_dwordx4 v[160:163], v246, s[40:43], s100 offen
    s_mov_b32 s100, 1835008
    buffer_load_dwordx4 v[164:167], v246, s[40:43], s100 offen
    s_mov_b32 s100, 1900544
    buffer_load_dwordx4 v[168:171], v246, s[40:43], s100 offen
    s_mov_b32 s100, 1966080
    buffer_load_dwordx4 v[172:175], v246, s[40:43], s100 offen
    s_mov_b32 s100, 2031616
    buffer_load_dwordx4 v[176:179], v246, s[40:43], s100 offen
    s_mov_b32 s100, 0
    s_nop 0
    buffer_load_dwordx4 v[180:183], v247, s[28:31], s100 offen
    s_mov_b32 s100, 16384
    buffer_load_dwordx4 v[184:187], v248, s[28:31], s100 offen
    s_mov_b32 s100, 32768
    buffer_load_dwordx4 v[188:191], v247, s[28:31], s100 offen
    s_mov_b32 s100, 49152
    buffer_load_dwordx4 v[192:195], v248, s[28:31], s100 offen
    s_mov_b32 s100, 0
    buffer_load_dwordx4 v[64:67], v244, s[48:51], s100 offen nt
    s_mov_b32 s100, 0
    buffer_load_dwordx4 v[96:99], v244, s[52:55], s100 offen nt
    s_mov_b32 s100, 7168
    buffer_load_dwordx4 v[68:71], v244, s[48:51], s100 offen nt
    s_mov_b32 s100, 7168
    buffer_load_dwordx4 v[100:103], v244, s[52:55], s100 offen nt
    s_mov_b32 s100, 14336
    buffer_load_dwordx4 v[72:75], v244, s[48:51], s100 offen nt
    s_mov_b32 s100, 14336
    buffer_load_dwordx4 v[104:107], v244, s[52:55], s100 offen nt
    s_mov_b32 s100, 21504
    buffer_load_dwordx4 v[76:79], v244, s[48:51], s100 offen nt
    v_lshrrev_b32 v198, 2, v2
    v_and_b32 v199, 7, v198
    v_and_b32 v200, 3, v2
    v_xor_b32 v199, v199, v200
    s_lshr_b32 s78, s76, 1
    s_and_b32 s79, s76, 1
    s_lshl_b32 s80, s79, 2
    s_lshl_b32 s81, s78, 2
    v_xor_b32 v200, s80, v199
    v_xor_b32 v201, s81, v199
    v_lshlrev_b32 v198, 7, v198
    s_lshl_b32 s80, s78, 14
    s_add_u32 s80, s80, 110592
    v_lshl_add_u32 v196, v200, 4, v198
    v_add_u32_e64 v196, s80, v196
    v_lshl_add_u32 v197, v201, 4, v198
    v_add_u32 v197, 143360, v197
    v_mov_b32 v200, 0x3f803f80
    v_mov_b32 v201, 0x3f803f80
    v_mov_b32 v202, 0x3f803f80
    v_mov_b32 v203, 0x3f803f80
    v_lshrrev_b32 v198, 4, v2
    v_and_b32 v199, 15, v2
    v_lshlrev_b32_e64 v199, 4, v199
    v_lshl_add_u32 v198, v198, 13, v199
    s_lshl_b32 s78, s70, 2
    s_add_u32 s78, s78, s76
    s_lshl_b32 s78, s78, 15
    s_lshl_b32 s79, s69, 9
    s_add_u32 s78, s78, s79
    s_add_u32 s78, s78, 2097152
    s_lshl_b32 s79, s77, 10
    s_lshl_b32 s80, s76, 6
    s_add_u32 s79, s79, s80
    s_add_u32 s79, s79, 8389120
    s_lshl_b32 s80, s70, 11
    s_add_u32 s80, s80, 8716288
    v_lshl_add_u32 v60, v2, 7, s80
    s_lshl_b32 s80, s71, 7
    s_add_u32 s80, s80, 8781824
    v_lshl_add_u32 v61, v2, 11, s80
    s_and_b32 s94, s69, 1
    s_and_b32 s96, s75, 1
    v_mov_b32 v54, s96
    s_and_b32 s83, s75, 1
    s_lshl_b32 s83, s83, 16
    s_sub_u32 s83, 0, s83
    s_barrier
    s_cmp_lg_u32 s76, 0
    s_cbranch_scc1 Lfs_24
    s_lshl_b32 s100, s77, 7
    s_add_u32 s100, s100, 8716288
    v_mov_b32 v52, s75
    v_lshlrev_b32_e64 v53, 2, v2
    s_mov_b32 exec_hi, 0
    buffer_store_dword v52, v53, s[36:39], s100 offen sc1
    s_mov_b64 exec, -1
Lfs_24:
    s_nop 0
    ds_read_b64_tr_b16 v[4:5], v196 offset:0
    ds_read_b64_tr_b16 v[6:7], v196 offset:2048
    ds_read_b64_tr_b16 v[8:9], v196 offset:8
    ds_read_b64_tr_b16 v[10:11], v196 offset:2056
    ds_read_b64_tr_b16 v[12:13], v197 offset:0
    ds_read_b64_tr_b16 v[14:15], v197 offset:2048
    ds_read_b64_tr_b16 v[16:17], v197 offset:8
    ds_read_b64_tr_b16 v[18:19], v197 offset:2056
    ds_read_b64_tr_b16 v[20:21], v196 offset:4096
    ds_read_b64_tr_b16 v[22:23], v196 offset:6144
    ds_read_b64_tr_b16 v[24:25], v196 offset:4104
    ds_read_b64_tr_b16 v[26:27], v196 offset:6152
    ds_read_b64_tr_b16 v[28:29], v197 offset:4096
    ds_read_b64_tr_b16 v[30:31], v197 offset:6144
    ds_read_b64_tr_b16 v[32:33], v197 offset:4104
    ds_read_b64_tr_b16 v[34:35], v197 offset:6152
    s_waitcnt lgkmcnt(8)
    s_nop 0
    v_mfma_f32_16x16x32_bf16 v[204:207], v[4:7], v[12:15], 0
    v_mfma_f32_16x16x32_bf16 v[208:211], v[8:11], v[12:15], 0
    v_mfma_f32_16x16x32_bf16 v[212:215], v[4:7], v[16:19], 0
    v_mfma_f32_16x16x32_bf16 v[216:219], v[8:11], v[16:19], 0
    v_mfma_f32_16x16x32_bf16 v[220:223], v[4:7], v[200:203], 0
    v_mfma_f32_16x16x32_bf16 v[224:227], v[8:11], v[200:203], 0
    ds_read_b64_tr_b16 v[36:37], v196 offset:8192
    ds_read_b64_tr_b16 v[38:39], v196 offset:10240
    ds_read_b64_tr_b16 v[40:41], v196 offset:8200
    ds_read_b64_tr_b16 v[42:43], v196 offset:10248
    ds_read_b64_tr_b16 v[44:45], v197 offset:8192
    ds_read_b64_tr_b16 v[46:47], v197 offset:10240
    ds_read_b64_tr_b16 v[48:49], v197 offset:8200
    ds_read_b64_tr_b16 v[50:51], v197 offset:10248
    s_waitcnt lgkmcnt(8)
    s_nop 0
    v_mfma_f32_16x16x32_bf16 v[204:207], v[20:23], v[28:31], v[204:207]
    v_mfma_f32_16x16x32_bf16 v[208:211], v[24:27], v[28:31], v[208:211]
    v_mfma_f32_16x16x32_bf16 v[212:215], v[20:23], v[32:35], v[212:215]
    v_mfma_f32_16x16x32_bf16 v[216:219], v[24:27], v[32:35], v[216:219]
    v_mfma_f32_16x16x32_bf16 v[220:223], v[20:23], v[200:203], v[220:223]
    v_mfma_f32_16x16x32_bf16 v[224:227], v[24:27], v[200:203], v[224:227]
    ds_read_b64_tr_b16 v[228:229], v196 offset:12288
    ds_read_b64_tr_b16 v[230:231], v196 offset:14336
    ds_read_b64_tr_b16 v[232:233], v196 offset:12296
    ds_read_b64_tr_b16 v[234:235], v196 offset:14344
    ds_read_b64_tr_b16 v[236:237], v197 offset:12288
    ds_read_b64_tr_b16 v[238:239], v197 offset:14336
    ds_read_b64_tr_b16 v[240:241], v197 offset:12296
    ds_read_b64_tr_b16 v[242:243], v197 offset:14344
    s_waitcnt lgkmcnt(8)
    s_nop 0
    v_mfma_f32_16x16x32_bf16 v[204:207], v[36:39], v[44:47], v[204:207]
    v_mfma_f32_16x16x32_bf16 v[208:211], v[40:43], v[44:47], v[208:211]
    v_mfma_f32_16x16x32_bf16 v[212:215], v[36:39], v[48:51], v[212:215]
    v_mfma_f32_16x16x32_bf16 v[216:219], v[40:43], v[48:51], v[216:219]
    v_mfma_f32_16x16x32_bf16 v[220:223], v[36:39], v[200:203], v[220:223]
    v_mfma_f32_16x16x32_bf16 v[224:227], v[40:43], v[200:203], v[224:227]
    s_waitcnt lgkmcnt(0)
    s_nop 0
    v_mfma_f32_16x16x32_bf16 v[204:207], v[228:231], v[236:239], v[204:207]
    v_mfma_f32_16x16x32_bf16 v[208:211], v[232:235], v[236:239], v[208:211]
    v_mfma_f32_16x16x32_bf16 v[212:215], v[228:231], v[240:243], v[212:215]
    v_mfma_f32_16x16x32_bf16 v[216:219], v[232:235], v[240:243], v[216:219]
    v_mfma_f32_16x16x32_bf16 v[220:223], v[228:231], v[200:203], v[220:223]
    v_mfma_f32_16x16x32_bf16 v[224:227], v[232:235], v[200:203], v[224:227]
    s_nop 2
    v_cvt_pk_bf16_f32 v4, v204, v205
    v_cvt_pk_bf16_f32 v5, v206, v207
    v_cvt_pk_bf16_f32 v6, v208, v209
    v_cvt_pk_bf16_f32 v7, v210, v211
    v_add_u32 v4, s94, v4
    v_and_or_b32 v4, v4, -2, v54
    v_add_u32_e64 v5, s94, v5
    v_and_or_b32 v5, v5, -2, v54
    v_add_u32_e64 v6, s94, v6
    v_and_or_b32 v6, v6, -2, v54
    v_add_u32_e64 v7, s94, v7
    v_and_or_b32 v7, v7, -2, v54
    buffer_store_dwordx4 v[4:7], v198, s[36:39], s78 offen offset:0 sc1
    v_cvt_pk_bf16_f32 v8, v212, v213
    v_cvt_pk_bf16_f32 v9, v214, v215
    v_cvt_pk_bf16_f32 v10, v216, v217
    v_cvt_pk_bf16_f32 v11, v218, v219
    v_add_u32_e64 v8, s94, v8
    v_and_or_b32 v8, v8, -2, v54
    v_add_u32_e64 v9, s94, v9
    v_and_or_b32 v9, v9, -2, v54
    v_add_u32_e64 v10, s94, v10
    v_and_or_b32 v10, v10, -2, v54
    v_add_u32_e64 v11, s94, v11
    v_and_or_b32 v11, v11, -2, v54
    buffer_store_dwordx4 v[8:11], v198, s[36:39], s78 offen offset:256 sc1
    v_cvt_pk_bf16_f32 v12, v220, v221
    v_cvt_pk_bf16_f32 v13, v222, v223
    v_cvt_pk_bf16_f32 v14, v224, v225
    v_cvt_pk_bf16_f32 v15, v226, v227
    s_mov_b32 exec_lo, 0x00010001
    s_mov_b32 exec_hi, 0x00010001
    buffer_store_dwordx4 v[12:15], v2, s[36:39], s79 offen sc1
    s_mov_b64 exec, -1
    v_lshrrev_b32 v196, 3, v2
    v_and_b32 v197, 7, v2
    v_lshlrev_b32 v197, 4, v197
    v_lshl_add_u32 v198, v196, 9, v197
    v_lshl_add_u32 v199, v196, 1, v197
    s_lshl_b32 s78, s77, 13
    s_lshl_b32 s80, s76, 7
    s_add_u32 s78, s78, s80
    s_add_u32 s78, s78, 2097152
    s_add_u32 s79, s78, 4096
    s_lshl_b32 s81, s77, 10
    s_add_u32 s81, s81, s80
    s_add_u32 s81, s81, 8388608
    v_lshrrev_b32 v200, 2, v2
    v_and_b32 v197, 3, v2
    v_lshlrev_b32 v197, 4, v197
    v_lshl_add_u32 v200, v200, 10, v197
    s_lshl_b32 s82, s70, 14
    s_lshl_b32 s80, s76, 6
    s_add_u32 s82, s82, s80
    s_add_u32 s82, s82, 8389120
    v_lshl_add_u32 v201, v196, 1, v197
    s_add_u32 s80, s80, 162944
    v_add_u32 v201, s80, v201
    s_mov_b64 exec, 0xffff
    s_mov_b32 s85, 0
Lspin_25:
    s_add_u32 s85, s85, 1
    s_cmp_gt_u32 s85, 400000
    s_cbranch_scc1 L_end
    buffer_load_dword v52, v60, s[36:39], 0 offen sc1
    s_waitcnt vmcnt(0)
    v_cmp_ne_u32_e64 vcc, s75, v52
    s_cbranch_vccnz Lspin_25
    s_mov_b64 exec, -1
    s_mov_b32 s85, 0
Lspin_26:
    s_add_u32 s85, s85, 1
    s_cmp_gt_u32 s85, 400000
    s_cbranch_scc1 L_end
    buffer_load_dwordx4 v[20:23], v198, s[36:39], s78 offen sc1
    buffer_load_dwordx4 v[24:27], v198, s[36:39], s79 offen sc1
    buffer_load_dwordx4 v[16:19], v200, s[36:39], s82 offen sc1
    s_waitcnt vmcnt(0)
Lchk_27:
    v_bitop3_b32 v28, v20, v24, v54 bitop3:0x7e
    v_bitop3_b32 v29, v21, v25, v54 bitop3:0x7e
    v_bitop3_b32 v30, v22, v26, v54 bitop3:0x7e
    v_bitop3_b32 v31, v23, v27, v54 bitop3:0x7e
    v_or3_b32 v28, v28, v29, v30
    v_cmp_eq_u32 s[90:91], -1, v16
    v_or_b32 v28, v28, v31
    v_and_b32 v28, 1, v28
    v_cmp_ne_u32_e64 vcc, 0, v28
    s_or_b64 vcc, vcc, s[90:91]
    s_cbranch_vccnz Lspin_26
    v_lshl_add_u32 v28, v20, 16, s83
    v_and_b32 v29, 0xffff0000, v20
    v_lshl_add_u32 v36, v24, 16, s83
    v_and_b32 v37, 0xffff0000, v24
    v_pk_add_f32 v[28:29], v[28:29], v[36:37]
    v_lshl_add_u32 v30, v21, 16, s83
    v_and_b32 v31, 0xffff0000, v21
    v_lshl_add_u32 v38, v25, 16, s83
    v_and_b32 v39, 0xffff0000, v25
    v_pk_add_f32 v[30:31], v[30:31], v[38:39]
    v_lshl_add_u32 v32, v22, 16, s83
    v_and_b32 v33, 0xffff0000, v22
    v_lshl_add_u32 v40, v26, 16, s83
    v_and_b32 v41, 0xffff0000, v26
    v_pk_add_f32 v[32:33], v[32:33], v[40:41]
    v_lshl_add_u32 v34, v23, 16, s83
    v_and_b32 v35, 0xffff0000, v23
    v_lshl_add_u32 v42, v27, 16, s83
    v_and_b32 v43, 0xffff0000, v27
    v_pk_add_f32 v[34:35], v[34:35], v[42:43]
    v_permlane32_swap_b32 v28, v32
    v_permlane32_swap_b32 v29, v33
    v_permlane32_swap_b32 v30, v34
    v_permlane32_swap_b32 v31, v35
    v_pk_add_f32 v[28:29], v[28:29], v[32:33]
    v_pk_add_f32 v[30:31], v[30:31], v[34:35]
    s_nop 1
    v_permlane16_swap_b32 v28, v30
    v_permlane16_swap_b32_e64 v29, v31
    v_pk_add_f32 v[28:29], v[28:29], v[30:31]
    s_nop 1
    s_nop 0
    v_add_f32_dpp v28, v28, v28 row_ror:8 row_mask:0xf bank_mask:0xf
    v_add_f32_dpp v29, v29, v29 row_ror:8 row_mask:0xf bank_mask:0xf
    v_cvt_pk_bf16_f32 v36, v28, v29
    s_mov_b32 exec_lo, 0x00ff00ff
    s_mov_b32 exec_hi, 0x00ff00ff
    buffer_store_dword v36, v199, s[36:39], s81 offen sc1
    s_mov_b64 exec, -1
    v_lshlrev_b32 v28, 16, v16
    v_and_b32 v29, 0xffff0000, v16
    v_lshlrev_b32_e64 v30, 16, v17
    v_and_b32 v31, 0xffff0000, v17
    v_lshlrev_b32_e64 v32, 16, v18
    v_and_b32 v33, 0xffff0000, v18
    v_lshlrev_b32_e64 v34, 16, v19
    v_and_b32 v35, 0xffff0000, v19
    v_permlane32_swap_b32 v28, v32
    v_permlane32_swap_b32 v29, v33
    v_permlane32_swap_b32 v30, v34
    v_permlane32_swap_b32 v31, v35
    v_pk_add_f32 v[28:29], v[28:29], v[32:33]
    v_pk_add_f32 v[30:31], v[30:31], v[34:35]
    s_nop 1
    v_permlane16_swap_b32 v28, v30
    v_permlane16_swap_b32_e64 v29, v31
    v_pk_add_f32 v[28:29], v[28:29], v[30:31]
    s_nop 1
    v_add_f32_dpp v38, v28, v28 row_ror:8 row_mask:0xf bank_mask:0x3
    s_nop 1
    v_add_f32_dpp v38, v29, v29 row_ror:8 row_mask:0xf bank_mask:0xc
    s_nop 1
    v_add_f32_dpp v37, v38, v38 row_shr:4 row_mask:0xf bank_mask:0xf
    v_cvt_pk_bf16_f32 v37, v37, v37
    s_mov_b32 exec_lo, 0xf0f0f0f0
    s_mov_b32 exec_hi, 0xf0f0f0f0
    ds_write_b16 v201, v37
    s_mov_b64 exec, -1
    s_waitcnt lgkmcnt(0)
    s_barrier
    v_lshlrev_b32 v4, 4, v2
    s_lshl_b32 s78, s76, 10
    s_add_u32 s78, s78, 110592
    v_add_u32 v5, s78, v4
    s_lshl_b32 s78, s76, 12
    s_add_u32 s78, s78, 131072
    v_add_u32_e64 v6, s78, v4
    ds_write_b128 v5, v[160:163] offset:0
    ds_write_b128 v5, v[164:167] offset:4096
    ds_write_b128 v5, v[168:171] offset:8192
    ds_write_b128 v5, v[172:175] offset:12288
    ds_write_b128 v5, v[176:179] offset:16384
    ds_write_b128 v6, v[180:183] offset:0
    ds_write_b128 v6, v[184:187] offset:1024
    ds_write_b128 v6, v[188:191] offset:2048
    ds_write_b128 v6, v[192:195] offset:3072
    s_waitcnt lgkmcnt(0)
    s_barrier
    s_barrier
    s_nop 0
    s_mov_b32 s100, 21504
    buffer_load_dwordx4 v[108:111], v244, s[52:55], s100 offen nt
    s_mov_b32 s100, 28672
    buffer_load_dwordx4 v[80:83], v244, s[48:51], s100 offen nt
    s_mov_b32 s100, 28672
    buffer_load_dwordx4 v[112:115], v244, s[52:55], s100 offen nt
    s_mov_b32 s100, 35840
    buffer_load_dwordx4 v[84:87], v244, s[48:51], s100 offen nt
    s_barrier
    s_cmp_lg_u32 s76, 0
    s_cbranch_scc1 Lfs_28
    s_lshl_b32 s100, s77, 7
    s_add_u32 s100, s100, 8781824
    v_mov_b32 v52, s75
    v_lshlrev_b32_e64 v53, 2, v2
    s_mov_b32 exec_hi, 0
    buffer_store_dword v52, v53, s[36:39], s100 offen sc1
    s_mov_b64 exec, -1
Lfs_28:
    s_lshl_b32 s83, s71, 4
    s_add_u32 s83, s83, s72
    s_lshl_b32 s78, s2, 11
    s_and_b32 s79, s76, 1
    s_lshl_b32 s79, s79, 10
    s_add_u32 s78, s78, s79
    s_add_u32 s78, s78, 655360
    s_mul_i32 s79, s74, 56
    s_add_u32 s79, s79, s73
    s_lshl_b32 s79, s79, 10
    s_add_u32 s79, s79, 1114112
    s_cmp_eq_u32 s76, 1
    s_cselect_b32 s78, s79, s78
    s_cmp_ge_u32 s73, 56
    s_cselect_b32 s78, 0x10000000, s78
    s_lshl_b32 s79, s83, 9
    s_add_u32 s79, s79, 524288
    s_cmp_eq_u32 s76, 0
    s_cselect_b32 s78, s79, s78
    s_cselect_b32 s79, 0, -1
    v_mov_b32 v56, -1
    v_mov_b32 v57, -1
    v_mov_b32 v58, -1
    v_mov_b32 v59, -1
    s_mov_b32 exec_hi, s79
    buffer_store_dwordx4 v[56:59], v4, s[36:39], s78 offen sc1
    s_mov_b32 exec_hi, -1
    s_cmp_lg_u32 s76, 1
    s_cbranch_scc1 Lf2_29
    s_mov_b64 exec, 0xffff
    s_mov_b32 s85, 0
Lspin_30:
    s_add_u32 s85, s85, 1
    s_cmp_gt_u32 s85, 400000
    s_cbranch_scc1 L_end
    buffer_load_dword v52, v61, s[36:39], 0 offen sc1
    s_waitcnt vmcnt(0)
    v_cmp_ne_u32 vcc, s75, v52
    s_cbranch_vccnz Lspin_30
    s_mov_b64 exec, -1
Lf2_29:
    s_barrier
    s_waitcnt vmcnt(0)
    s_mov_b32 s100, 0x05040100
    s_mov_b32 s101, 0x07060302
    v_perm_b32 v7, v68, v64, s100
    v_perm_b32 v68, v68, v64, s101
    v_mov_b32_e64 v64, v7
    v_perm_b32 v7, v69, v65, s100
    v_perm_b32 v69, v69, v65, s101
    v_mov_b32_e64 v65, v7
    v_perm_b32 v7, v70, v66, s100
    v_perm_b32 v70, v70, v66, s101
    v_mov_b32_e64 v66, v7
    v_perm_b32 v7, v71, v67, s100
    v_perm_b32 v71, v71, v67, s101
    v_mov_b32_e64 v67, v7
    v_perm_b32 v7, v100, v96, s100
    v_perm_b32 v100, v100, v96, s101
    v_mov_b32_e64 v96, v7
    v_perm_b32 v7, v101, v97, s100
    v_perm_b32 v101, v101, v97, s101
    v_mov_b32_e64 v97, v7
    v_perm_b32 v7, v102, v98, s100
    v_perm_b32 v102, v102, v98, s101
    v_mov_b32_e64 v98, v7
    v_perm_b32 v7, v103, v99, s100
    v_perm_b32 v103, v103, v99, s101
    v_mov_b32_e64 v99, v7
    v_perm_b32 v7, v76, v72, s100
    v_perm_b32 v76, v76, v72, s101
    v_mov_b32_e64 v72, v7
    v_perm_b32 v7, v77, v73, s100
    v_perm_b32 v77, v77, v73, s101
    v_mov_b32_e64 v73, v7
    v_perm_b32 v7, v78, v74, s100
    v_perm_b32 v78, v78, v74, s101
    v_mov_b32_e64 v74, v7
    v_perm_b32 v7, v79, v75, s100
    v_perm_b32 v79, v79, v75, s101
    v_mov_b32_e64 v75, v7
    v_perm_b32 v7, v108, v104, s100
    v_perm_b32 v108, v108, v104, s101
    v_mov_b32_e64 v104, v7
    v_perm_b32 v7, v109, v105, s100
    v_perm_b32 v109, v109, v105, s101
    v_mov_b32_e64 v105, v7
    v_perm_b32 v7, v110, v106, s100
    v_perm_b32 v110, v110, v106, s101
    v_mov_b32_e64 v106, v7
    v_perm_b32 v7, v111, v107, s100
    v_perm_b32 v111, v111, v107, s101
    v_mov_b32_e64 v107, v7
    v_perm_b32 v7, v84, v80, s100
    v_perm_b32 v84, v84, v80, s101
    v_mov_b32_e64 v80, v7
    v_perm_b32 v7, v85, v81, s100
    v_perm_b32 v85, v85, v81, s101
    v_mov_b32_e64 v81, v7
    v_perm_b32 v7, v86, v82, s100
    v_perm_b32 v86, v86, v82, s101
    v_mov_b32_e64 v82, v7
    v_perm_b32 v7, v87, v83, s100
    v_perm_b32 v87, v87, v83, s101
    v_mov_b32 v83, v7
    v_lshrrev_b32 v8, 3, v2
    v_and_b32 v9, 7, v2
    v_lshlrev_b32 v10, 4, v9
    v_lshl_add_u32 v11, v8, 13, v10
    v_and_b32 v12, 15, v2
    v_lshlrev_b32 v12, 13, v12
    v_lshl_add_u32 v13, v8, 9, v10
    v_lshl_add_u32 v14, v9, 3, v8
    s_lshl_b32 s80, s74, 2
    s_add_u32 s80, s80, s76
    s_lshl_b32 s78, s80, 9
    s_add_u32 s78, s78, 524288
    s_add_u32 s79, s78, 65536
    s_lshl_b32 s81, s73, 13
    s_add_u32 s81, s81, 655360
    s_lshl_b32 s80, s80, 9
    s_add_u32 s80, s80, s81
    s_lshl_b32 s82, s71, 11
    s_add_u32 s82, s82, 8847360
    v_lshl_add_u32 v60, v2, 7, s82
    s_barrier
    s_mov_b32 s100, 35840
    buffer_load_dwordx4 v[116:119], v244, s[52:55], s100 offen nt
    s_mov_b32 s100, 43008
    buffer_load_dwordx4 v[88:91], v244, s[48:51], s100 offen nt
    s_mov_b32 s100, 43008
    buffer_load_dwordx4 v[120:123], v244, s[52:55], s100 offen nt
    s_mov_b32 s100, 50176
    buffer_load_dwordx4 v[92:95], v244, s[48:51], s100 offen nt
    s_mov_b32 s100, 50176
    buffer_load_dwordx4 v[124:127], v244, s[52:55], s100 offen nt
    s_mov_b32 s100, 0
    s_nop 0
    buffer_load_dwordx4 v[128:131], v245, s[56:59], s100 offen nt
    s_mov_b32 s100, 2048
    buffer_load_dwordx4 v[132:135], v245, s[56:59], s100 offen nt
    s_mov_b32 s100, 4096
    buffer_load_dwordx4 v[136:139], v245, s[56:59], s100 offen nt
    s_mov_b32 s100, 6144
    buffer_load_dwordx4 v[140:143], v245, s[56:59], s100 offen nt
    s_barrier
    s_cmp_lg_u32 s76, 0
    s_cbranch_scc1 Lfs_31
    s_lshl_b32 s100, s83, 7
    s_add_u32 s100, s100, 8847360
    v_mov_b32 v52, s75
    v_lshlrev_b32_e64 v53, 2, v2
    s_mov_b32 exec_hi, 0
    buffer_store_dword v52, v53, s[36:39], s100 offen sc1
    s_mov_b64 exec, -1
Lfs_31:
    s_cmp_lg_u32 s76, 1
    s_cbranch_scc1 Lf3_32
    s_sleep 8
    s_mov_b64 exec, 0xffff
    s_mov_b32 s85, 0
Lspin_33:
    s_add_u32 s85, s85, 1
    s_cmp_gt_u32 s85, 400000
    s_cbranch_scc1 L_end
    buffer_load_dword v52, v60, s[36:39], 0 offen sc1
    s_waitcnt vmcnt(0)
    v_cmp_ne_u32_e64 vcc, s75, v52
    s_cbranch_vccnz Lspin_33
    s_mov_b64 exec, -1
Lf3_32:
    s_barrier
    s_waitcnt vmcnt(0)
    s_mov_b32 s100, 0x05040100
    s_mov_b32 s101, 0x07060302
    v_perm_b32 v7, v116, v112, s100
    v_perm_b32 v116, v116, v112, s101
    v_mov_b32_e64 v112, v7
    v_perm_b32 v7, v117, v113, s100
    v_perm_b32 v117, v117, v113, s101
    v_mov_b32_e64 v113, v7
    v_perm_b32 v7, v118, v114, s100
    v_perm_b32 v118, v118, v114, s101
    v_mov_b32_e64 v114, v7
    v_perm_b32 v7, v119, v115, s100
    v_perm_b32 v119, v119, v115, s101
    v_mov_b32_e64 v115, v7
    v_perm_b32 v7, v92, v88, s100
    v_perm_b32 v92, v92, v88, s101
    v_mov_b32_e64 v88, v7
    v_perm_b32 v7, v93, v89, s100
    v_perm_b32 v93, v93, v89, s101
    v_mov_b32_e64 v89, v7
    v_perm_b32 v7, v94, v90, s100
    v_perm_b32 v94, v94, v90, s101
    v_mov_b32_e64 v90, v7
    v_perm_b32 v7, v95, v91, s100
    v_perm_b32 v95, v95, v91, s101
    v_mov_b32_e64 v91, v7
    v_perm_b32 v7, v124, v120, s100
    v_perm_b32 v124, v124, v120, s101
    v_mov_b32_e64 v120, v7
    v_perm_b32 v7, v125, v121, s100
    v_perm_b32 v125, v125, v121, s101
    v_mov_b32_e64 v121, v7
    v_perm_b32 v7, v126, v122, s100
    v_perm_b32 v126, v126, v122, s101
    v_mov_b32_e64 v122, v7
    v_perm_b32 v7, v127, v123, s100
    v_perm_b32 v127, v127, v123, s101
    v_mov_b32_e64 v123, v7
    v_perm_b32 v7, v132, v128, s100
    v_perm_b32 v132, v132, v128, s101
    v_mov_b32_e64 v128, v7
    v_perm_b32 v7, v133, v129, s100
    v_perm_b32 v133, v133, v129, s101
    v_mov_b32_e64 v129, v7
    v_perm_b32 v7, v134, v130, s100
    v_perm_b32 v134, v134, v130, s101
    v_mov_b32_e64 v130, v7
    v_perm_b32 v7, v135, v131, s100
    v_perm_b32 v135, v135, v131, s101
    v_mov_b32_e64 v131, v7
    v_perm_b32 v7, v140, v136, s100
    v_perm_b32 v140, v140, v136, s101
    v_mov_b32_e64 v136, v7
    v_perm_b32 v7, v141, v137, s100
    v_perm_b32 v141, v141, v137, s101
    v_mov_b32_e64 v137, v7
    v_perm_b32 v7, v142, v138, s100
    v_perm_b32 v142, v142, v138, s101
    v_mov_b32_e64 v138, v7
    v_perm_b32 v7, v143, v139, s100
    v_perm_b32 v143, v143, v139, s101
    v_mov_b32 v139, v7
    s_barrier
    s_mov_b32 s100, 8192
    buffer_load_dwordx4 v[144:147], v245, s[56:59], s100 offen nt
    s_mov_b32 s100, 10240
    buffer_load_dwordx4 v[148:151], v245, s[56:59], s100 offen nt
    s_mov_b32 s100, 12288
    buffer_load_dwordx4 v[152:155], v245, s[56:59], s100 offen nt
    s_mov_b32 s100, 14336
    buffer_load_dwordx4 v[156:159], v245, s[56:59], s100 offen nt
    s_sleep 8
    s_mov_b64 exec, 0xffff
    s_mov_b32 s85, 0
Lspin_34:
    s_add_u32 s85, s85, 1
    s_cmp_gt_u32 s85, 400000
    s_cbranch_scc1 L_end
    buffer_load_dwordx2 v[24:25], v12, s[36:39], s78 offen offset:128 sc1
    s_waitcnt vmcnt(0)
    v_cmp_ne_u32_e64 vcc, s75, v25
    s_cbranch_vccnz Lspin_34
    v_max_f32_dpp v24, v24, v24 row_ror:8 row_mask:0xf bank_mask:0xf
    s_nop 1
    v_max_f32_dpp v24, v24, v24 row_ror:4 row_mask:0xf bank_mask:0xf
    s_nop 1
    v_max_f32_dpp v24, v24, v24 row_ror:2 row_mask:0xf bank_mask:0xf
    s_nop 1
    v_max_f32_dpp v24, v24, v24 row_ror:1 row_mask:0xf bank_mask:0xf
    s_nop 0
    v_readfirstlane_b32 s97, v24
    s_mov_b64 exec, -1
    s_nop 0
    v_mov_b32 v24, s97
    s_cmp_ge_u32 s73, 56
    s_cbranch_scc1 L_red
    s_bfe_u32 s79, s97, 0x40007
    s_lshl_b32 s79, s79, 13
    s_add_u32 s78, s78, s79
    v_lshlrev_b32_e64 v25, 4, v8
    s_mov_b32 s85, 0
Lspin_35:
    s_add_u32 s85, s85, 1
    s_cmp_gt_u32 s85, 400000
    s_cbranch_scc1 L_end
    buffer_load_dwordx4 v[20:23], v25, s[36:39], s78 offen sc1
    v_mov_b32 v26, 163344
    ds_write_b32 v26, v24
    v_lshlrev_b32 v15, 3, v14
    s_waitcnt vmcnt(0) lgkmcnt(0)
    v_max_u32 v16, v20, v22
    v_cmp_eq_u32 vcc, -1, v16
    s_cbranch_vccnz Lspin_35
    v_dot2_f32_bf16 v28, v64, v20, 0
    v_dot2_f32_bf16 v29, v68, v20, 0
    v_dot2_f32_bf16 v30, v65, v20, 0
    v_dot2_f32_bf16 v31, v69, v20, 0
    v_dot2_f32_bf16 v32, v66, v20, 0
    v_dot2_f32_bf16 v33, v70, v20, 0
    v_dot2_f32_bf16 v34, v67, v20, 0
    v_dot2_f32_bf16 v35, v71, v20, 0
    v_dot2_f32_bf16 v28, v72, v21, v28
    v_dot2_f32_bf16 v29, v76, v21, v29
    v_dot2_f32_bf16 v30, v73, v21, v30
    v_dot2_f32_bf16 v31, v77, v21, v31
    v_dot2_f32_bf16 v32, v74, v21, v32
    v_dot2_f32_bf16 v33, v78, v21, v33
    v_dot2_f32_bf16 v34, v75, v21, v34
    v_dot2_f32_bf16 v35, v79, v21, v35
    v_dot2_f32_bf16 v28, v80, v22, v28
    v_dot2_f32_bf16 v29, v84, v22, v29
    v_dot2_f32_bf16 v30, v81, v22, v30
    v_dot2_f32_bf16 v31, v85, v22, v31
    v_dot2_f32_bf16 v32, v82, v22, v32
    v_dot2_f32_bf16 v33, v86, v22, v33
    v_dot2_f32_bf16 v34, v83, v22, v34
    v_dot2_f32_bf16 v35, v87, v22, v35
    v_dot2_f32_bf16 v28, v88, v23, v28
    v_dot2_f32_bf16 v29, v92, v23, v29
    v_dot2_f32_bf16 v30, v89, v23, v30
    v_dot2_f32_bf16 v31, v93, v23, v31
    v_dot2_f32_bf16 v32, v90, v23, v32
    v_dot2_f32_bf16 v33, v94, v23, v33
    v_dot2_f32_bf16 v34, v91, v23, v34
    v_dot2_f32_bf16 v35, v95, v23, v35
    v_dot2_f32_bf16 v36, v96, v20, 0
    v_dot2_f32_bf16 v37, v100, v20, 0
    v_dot2_f32_bf16 v38, v97, v20, 0
    v_dot2_f32_bf16 v39, v101, v20, 0
    v_dot2_f32_bf16 v40, v98, v20, 0
    v_dot2_f32_bf16 v41, v102, v20, 0
    v_dot2_f32_bf16 v42, v99, v20, 0
    v_dot2_f32_bf16 v43, v103, v20, 0
    v_dot2_f32_bf16 v36, v104, v21, v36
    v_dot2_f32_bf16 v37, v108, v21, v37
    v_dot2_f32_bf16 v38, v105, v21, v38
    v_dot2_f32_bf16 v39, v109, v21, v39
    v_dot2_f32_bf16 v40, v106, v21, v40
    v_dot2_f32_bf16 v41, v110, v21, v41
    v_dot2_f32_bf16 v42, v107, v21, v42
    v_dot2_f32_bf16 v43, v111, v21, v43
    v_dot2_f32_bf16 v36, v112, v22, v36
    v_dot2_f32_bf16 v37, v116, v22, v37
    v_dot2_f32_bf16 v38, v113, v22, v38
    v_dot2_f32_bf16 v39, v117, v22, v39
    v_dot2_f32_bf16 v40, v114, v22, v40
    v_dot2_f32_bf16 v41, v118, v22, v41
    v_dot2_f32_bf16 v42, v115, v22, v42
    v_dot2_f32_bf16 v43, v119, v22, v43
    v_dot2_f32_bf16 v36, v120, v23, v36
    v_dot2_f32_bf16 v37, v124, v23, v37
    v_dot2_f32_bf16 v38, v121, v23, v38
    v_dot2_f32_bf16 v39, v125, v23, v39
    v_dot2_f32_bf16 v40, v122, v23, v40
    v_dot2_f32_bf16 v41, v126, v23, v41
    v_dot2_f32_bf16 v42, v123, v23, v42
    v_dot2_f32_bf16 v43, v127, v23, v43
    v_permlane32_swap_b32 v28, v32
    v_permlane32_swap_b32 v29, v33
    v_permlane32_swap_b32 v30, v34
    v_permlane32_swap_b32 v31, v35
    v_pk_add_f32 v[28:29], v[28:29], v[32:33]
    v_pk_add_f32 v[30:31], v[30:31], v[34:35]
    s_nop 1
    v_permlane16_swap_b32 v28, v30
    v_permlane16_swap_b32_e64 v29, v31
    v_pk_add_f32 v[28:29], v[28:29], v[30:31]
    s_nop 1
    v_add_f32_dpp v44, v28, v28 row_ror:8 row_mask:0xf bank_mask:0x3
    s_nop 1
    v_add_f32_dpp v44, v29, v29 row_ror:8 row_mask:0xf bank_mask:0xc
    v_permlane32_swap_b32 v36, v40
    v_permlane32_swap_b32 v37, v41
    v_permlane32_swap_b32 v38, v42
    v_permlane32_swap_b32 v39, v43
    v_pk_add_f32 v[36:37], v[36:37], v[40:41]
    v_pk_add_f32 v[38:39], v[38:39], v[42:43]
    s_nop 1
    v_permlane16_swap_b32 v36, v38
    v_permlane16_swap_b32_e64 v37, v39
    v_pk_add_f32 v[36:37], v[36:37], v[38:39]
    s_nop 1
    v_add_f32_dpp v45, v36, v36 row_ror:8 row_mask:0xf bank_mask:0x3
    s_nop 1
    v_add_f32_dpp v45, v37, v37 row_ror:8 row_mask:0xf bank_mask:0xc
    buffer_store_dwordx2 v[44:45], v15, s[36:39], s80 offen sc1
    s_barrier
    s_lshl_b32 s78, s76, 7
    s_add_u32 s78, s78, s81
    s_add_u32 s79, s78, 4096
    v_lshrrev_b32 v26, 5, v2
    v_lshl_add_u32 v26, v9, 1, v26
    s_lshl_b32 s80, s76, 5
    s_add_u32 s80, s80, 163456
    v_lshl_add_u32 v26, v26, 1, s80
    v_lshlrev_b32 v27, 4, v8
    v_add_u32 v27, 163456, v27
    v_lshlrev_b32 v15, 2, v14
    s_mul_i32 s80, s74, 56
    s_add_u32 s80, s80, s73
    s_lshl_b32 s80, s80, 10
    s_lshl_b32 s82, s76, 8
    s_add_u32 s80, s80, s82
    s_add_u32 s80, s80, 1114112
    s_waitcnt vmcnt(0)
    s_mov_b32 s100, 0x05040100
    s_mov_b32 s101, 0x07060302
    v_perm_b32 v7, v148, v144, s100
    v_perm_b32 v148, v148, v144, s101
    v_mov_b32 v144, v7
    v_perm_b32 v7, v149, v145, s100
    v_perm_b32 v149, v149, v145, s101
    v_mov_b32_e64 v145, v7
    v_perm_b32 v7, v150, v146, s100
    v_perm_b32 v150, v150, v146, s101
    v_mov_b32_e64 v146, v7
    v_perm_b32 v7, v151, v147, s100
    v_perm_b32 v151, v151, v147, s101
    v_mov_b32_e64 v147, v7
    v_perm_b32 v7, v156, v152, s100
    v_perm_b32 v156, v156, v152, s101
    v_mov_b32_e64 v152, v7
    v_perm_b32 v7, v157, v153, s100
    v_perm_b32 v157, v157, v153, s101
    v_mov_b32_e64 v153, v7
    v_perm_b32 v7, v158, v154, s100
    v_perm_b32 v158, v158, v154, s101
    v_mov_b32_e64 v154, v7
    v_perm_b32 v7, v159, v155, s100
    v_perm_b32 v159, v159, v155, s101
    v_mov_b32_e64 v155, v7
    s_mov_b32 s85, 0
Lspin_36:
    s_add_u32 s85, s85, 1
    s_cmp_gt_u32 s85, 400000
    s_cbranch_scc1 L_end
    buffer_load_dwordx4 v[16:19], v13, s[36:39], s78 offen sc1
    buffer_load_dwordx4 v[20:23], v13, s[36:39], s79 offen sc1
    s_waitcnt vmcnt(0)
    v_max3_u32 v25, v16, v18, v20
    v_max_u32 v25, v25, v22
    v_cmp_eq_u32_e64 vcc, -1, v25
    s_cbranch_vccnz Lspin_36
    v_pk_add_f32 v[16:17], v[16:17], v[20:21]
    v_pk_add_f32 v[18:19], v[18:19], v[22:23]
    s_nop 1
    v_permlane32_swap_b32 v16, v18
    v_permlane32_swap_b32_e64 v17, v19
    v_pk_add_f32 v[16:17], v[16:17], v[18:19]
    v_mov_b32 v18, v16
    v_mov_b32 v19, v17
    s_nop 0
    v_permlane16_swap_b32 v16, v18
    v_permlane16_swap_b32_e64 v17, v19
    v_pk_add_f32 v[16:17], v[16:17], v[18:19]
    s_nop 1
    s_nop 0
    v_add_f32_dpp v16, v16, v16 row_ror:8 row_mask:0xf bank_mask:0xf
    v_add_f32_dpp v17, v17, v17 row_ror:8 row_mask:0xf bank_mask:0xf
    v_cvt_pk_bf16_f32 v16, v16, v16
    v_and_b32 v16, 0xffff0000, v16
    v_cvt_pk_bf16_f32 v17, v17, v17
    v_and_b32 v17, 0xffff0000, v17
    v_mul_f32 v18, 0xbfb8aa3b, v16
    v_exp_f32 v18, v18
    s_nop 0
    v_add_f32 v18, 1.0, v18
    v_rcp_f32 v18, v18
    s_nop 0
    v_mul_f32 v16, v16, v18
    v_cvt_pk_bf16_f32 v16, v16, v16
    v_and_b32 v16, 0xffff0000, v16
    v_mul_f32_e64 v16, v16, v17
    v_cvt_pk_bf16_f32 v16, v16, v16
    ds_write_b16 v26, v16
    s_waitcnt lgkmcnt(0)
    s_barrier
    ds_read_b128 v[20:23], v27
    s_waitcnt lgkmcnt(0)
    s_nop 0
    v_dot2_f32_bf16 v28, v128, v20, 0
    v_dot2_f32_bf16 v29, v132, v20, 0
    v_dot2_f32_bf16 v30, v129, v20, 0
    v_dot2_f32_bf16 v31, v133, v20, 0
    v_dot2_f32_bf16 v32, v130, v20, 0
    v_dot2_f32_bf16 v33, v134, v20, 0
    v_dot2_f32_bf16 v34, v131, v20, 0
    v_dot2_f32_bf16 v35, v135, v20, 0
    v_dot2_f32_bf16 v28, v136, v21, v28
    v_dot2_f32_bf16 v29, v140, v21, v29
    v_dot2_f32_bf16 v30, v137, v21, v30
    v_dot2_f32_bf16 v31, v141, v21, v31
    v_dot2_f32_bf16 v32, v138, v21, v32
    v_dot2_f32_bf16 v33, v142, v21, v33
    v_dot2_f32_bf16 v34, v139, v21, v34
    v_dot2_f32_bf16 v35, v143, v21, v35
    v_dot2_f32_bf16 v28, v144, v22, v28
    v_dot2_f32_bf16 v29, v148, v22, v29
    v_dot2_f32_bf16 v30, v145, v22, v30
    v_dot2_f32_bf16 v31, v149, v22, v31
    v_dot2_f32_bf16 v32, v146, v22, v32
    v_dot2_f32_bf16 v33, v150, v22, v33
    v_dot2_f32_bf16 v34, v147, v22, v34
    v_dot2_f32_bf16 v35, v151, v22, v35
    v_dot2_f32_bf16 v28, v152, v23, v28
    v_dot2_f32_bf16 v29, v156, v23, v29
    v_dot2_f32_bf16 v30, v153, v23, v30
    v_dot2_f32_bf16 v31, v157, v23, v31
    v_dot2_f32_bf16 v32, v154, v23, v32
    v_dot2_f32_bf16 v33, v158, v23, v33
    v_dot2_f32_bf16 v34, v155, v23, v34
    v_dot2_f32_bf16 v35, v159, v23, v35
    v_permlane32_swap_b32 v28, v32
    v_permlane32_swap_b32 v29, v33
    v_permlane32_swap_b32 v30, v34
    v_permlane32_swap_b32 v31, v35
    v_pk_add_f32 v[28:29], v[28:29], v[32:33]
    v_pk_add_f32 v[30:31], v[30:31], v[34:35]
    s_nop 1
    v_permlane16_swap_b32 v28, v30
    v_permlane16_swap_b32_e64 v29, v31
    v_pk_add_f32 v[28:29], v[28:29], v[30:31]
    s_nop 1
    v_add_f32_dpp v44, v28, v28 row_ror:8 row_mask:0xf bank_mask:0x3
    s_nop 1
    v_add_f32_dpp v44, v29, v29 row_ror:8 row_mask:0xf bank_mask:0xc
    buffer_store_dword v44, v15, s[36:39], s80 offen sc1
    s_branch L_fin
L_red:
    v_mov_b32 v26, 163344
    ds_write_b32 v26, v24
    s_waitcnt lgkmcnt(0)
    s_barrier
    s_cmp_lg_u32 s76, 0
    s_cbranch_scc1 L_fin
    s_sub_u32 s83, s2, 224
    v_lshrrev_b32 v14, 4, v2
    v_lshl_add_u32 v14, v9, 2, v14
    v_lshlrev_b32 v15, 2, v14
    v_lshlrev_b32 v14, 1, v14
    s_bfe_u32 s78, s97, 0x40007
    s_lshl_b32 s78, s78, 13
    s_lshr_b32 s79, s83, 1
    s_lshl_b32 s79, s79, 9
    s_add_u32 s78, s78, s79
    s_and_b32 s79, s83, 1
    s_lshl_b32 s79, s79, 7
    s_add_u32 s78, s78, s79
    s_add_u32 s78, s78, 524544
    s_mov_b32 s85, 0
Lspin_37:
    s_add_u32 s85, s85, 1
    s_cmp_gt_u32 s85, 400000
    s_cbranch_scc1 L_end
    buffer_load_dword v46, v15, s[36:39], s78 offen sc1
    s_waitcnt vmcnt(0)
    v_cmp_eq_u32_e64 vcc, -1, v46
    s_cbranch_vccnz Lspin_37
    v_cvt_pk_bf16_f32 v47, v24, v24
    v_and_b32 v47, 0xffff0000, v47
    v_mul_f32 v47, 0xbfb8aa3b, v47
    v_exp_f32 v47, v47
    s_nop 0
    v_add_f32 v47, 1.0, v47
    v_rcp_f32_e64 v47, v47
    s_nop 0
    v_cvt_pk_bf16_f32 v47, v47, v47
    v_and_b32 v47, 0xffff0000, v47
    v_lshl_add_u32 v13, v8, 10, v10
    s_lshr_b32 s78, s83, 3
    s_mul_i32 s78, s78, 57344
    s_and_b32 s79, s83, 7
    s_lshl_b32 s79, s79, 7
    s_add_u32 s78, s78, s79
    s_add_u32 s78, s78, 1114112
    s_and_b32 s80, s97, 0x7ff
    s_lshl_b32 s80, s80, 11
    s_lshl_b32 s79, s83, 6
    s_add_u32 s80, s80, s79
    s_sleep 30
    s_mov_b32 s85, 0
Lspin_38:
    s_add_u32 s85, s85, 1
    s_cmp_gt_u32 s85, 400000
    s_cbranch_scc1 L_end
    s_add_u32 s79, s78, 0
    buffer_load_dwordx4 v[16:19], v13, s[36:39], s79 offen sc1
    s_add_u32 s79, s78, 8192
    buffer_load_dwordx4 v[20:23], v13, s[36:39], s79 offen sc1
    s_add_u32 s79, s78, 16384
    buffer_load_dwordx4 v[24:27], v13, s[36:39], s79 offen sc1
    s_add_u32 s79, s78, 24576
    buffer_load_dwordx4 v[28:31], v13, s[36:39], s79 offen sc1
    s_add_u32 s79, s78, 32768
    buffer_load_dwordx4 v[32:35], v13, s[36:39], s79 offen sc1
    s_add_u32 s79, s78, 40960
    buffer_load_dwordx4 v[36:39], v13, s[36:39], s79 offen sc1
    s_add_u32 s79, s78, 49152
    buffer_load_dwordx4 v[40:43], v13, s[36:39], s79 offen sc1
    s_waitcnt vmcnt(0)
    v_max_u32 v48, v16, v17
    v_max_u32_e64 v49, v18, v19
    v_max3_u32 v48, v48, v20, v21
    v_max3_u32 v49, v49, v22, v23
    v_max3_u32 v48, v48, v24, v25
    v_max3_u32 v49, v49, v26, v27
    v_max3_u32 v48, v48, v28, v29
    v_max3_u32 v49, v49, v30, v31
    v_max3_u32 v48, v48, v32, v33
    v_max3_u32 v49, v49, v34, v35
    v_max3_u32 v48, v48, v36, v37
    v_max3_u32 v49, v49, v38, v39
    v_max3_u32 v48, v48, v40, v41
    v_max3_u32 v49, v49, v42, v43
    v_max_u32 v48, v48, v49
    v_cmp_eq_u32_e64 vcc, -1, v48
    s_cbranch_vccnz Lspin_38
    v_pk_add_f32 v[16:17], v[16:17], v[20:21]
    v_pk_add_f32 v[24:25], v[24:25], v[28:29]
    v_pk_add_f32 v[32:33], v[32:33], v[36:37]
    v_pk_add_f32 v[16:17], v[16:17], v[24:25]
    v_pk_add_f32 v[32:33], v[32:33], v[40:41]
    v_pk_add_f32 v[16:17], v[16:17], v[32:33]
    v_pk_add_f32 v[18:19], v[18:19], v[22:23]
    v_pk_add_f32 v[26:27], v[26:27], v[30:31]
    v_pk_add_f32 v[34:35], v[34:35], v[38:39]
    v_pk_add_f32 v[18:19], v[18:19], v[26:27]
    v_pk_add_f32 v[34:35], v[34:35], v[42:43]
    v_pk_add_f32 v[18:19], v[18:19], v[34:35]
    s_nop 1
    v_permlane32_swap_b32 v16, v18
    v_permlane32_swap_b32_e64 v17, v19
    v_pk_add_f32 v[16:17], v[16:17], v[18:19]
    s_nop 1
    v_permlane16_swap_b32 v16, v17
    v_add_f32 v16, v16, v17
    s_nop 1
    v_add_f32_dpp v16, v16, v16 row_ror:8 row_mask:0xf bank_mask:0xf
    v_cvt_pk_bf16_f32 v16, v16, v16
    v_and_b32 v16, 0xffff0000, v16
    v_mul_f32_e64 v16, v16, v47
    v_cvt_pk_bf16_f32 v16, v16, v16
    v_and_b32 v16, 0xffff0000, v16
    v_add_f32_e64 v16, v16, v46
    v_cvt_pk_bf16_f32 v16, v16, v16
    s_mov_b32 exec_lo, 0x00ff00ff
    s_mov_b32 exec_hi, 0x00ff00ff
    buffer_store_short v16, v14, s[44:47], s80 offen
    s_mov_b64 exec, -1
    s_cmp_lg_u32 s2, 224
    s_cbranch_scc1 Lep_39
    s_cmp_lg_u32 s76, 0
    s_cbranch_scc1 Lep_39
    v_mov_b32 v196, s75
    v_mov_b32_e64 v197, 0
    s_mov_b64 exec, 1
    buffer_store_dword v196, v197, s[36:39], 0 offen sc1
    s_mov_b64 exec, -1
Lep_39:
    s_branch L_fin
    .p2align 3
L_M:
    s_setprio 1
    s_and_b32 s78, s2, 7
    s_lshr_b32 s79, s2, 3
    s_and_b32 s71, s78, 3
    s_lshl_b32 s71, s71, 2
    s_and_b32 s72, s79, 3
    s_add_u32 s71, s71, s72
    s_lshr_b32 s72, s78, 2
    s_lshl_b32 s72, s72, 3
    s_lshr_b32 s79, s79, 2
    s_add_u32 s72, s72, s79
    s_lshr_b32 s73, s2, 2
    s_and_b32 s74, s2, 3
    s_lshl_b32 s77, s70, 4
    s_add_u32 s77, s77, s69
    s_and_b32 s80, s76, 1
    s_lshr_b32 s81, s76, 1
    v_and_b32 v8, 15, v2
    v_lshrrev_b32 v9, 4, v2
    v_lshrrev_b32_e64 v10, 1, v8
    s_lshl_b32 s78, s80, 13
    s_add_u32 s78, s78, 118784
    v_lshlrev_b32 v11, 7, v8
    v_add_u32 v11, s78, v11
    v_add_u32 v12, 0, v9
    v_xor_b32 v12, v12, v10
    v_lshl_add_u32 v4, v12, 4, v11
    v_add_u32 v12, 4, v9
    v_xor_b32 v12, v12, v10
    v_lshl_add_u32 v5, v12, 4, v11
    v_bfe_u32 v10, v2, 2, 2
    v_and_b32_e64 v11, 3, v2
    v_lshl_add_u32 v12, v9, 3, v10
    v_lshlrev_b32_e64 v12, 7, v12
    v_lshl_add_u32 v12, v11, 3, v12
    v_add_u32 v12, 135168, v12
    v_lshrrev_b32 v13, 1, v10
    v_and_b32 v14, 1, v9
    v_lshl_add_u32 v13, v14, 1, v13
    s_lshl_b32 s78, s81, 1
    s_add_u32 s79, s78, 0
    v_xor_b32_e64 v14, s79, v13
    v_lshl_add_u32 v6, v14, 5, v12
    s_add_u32 s79, s78, 1
    v_xor_b32 v14, s79, v13
    v_lshl_add_u32 v7, v14, 5, v12
    v_lshrrev_b32_e64 v13, 5, v2
    v_lshl_add_u32 v13, v13, 3, v10
    v_lshlrev_b32 v13, 6, v13
    v_and_b32 v14, 1, v9
    v_lshl_add_u32 v13, v14, 5, v13
    v_lshl_add_u32 v13, v11, 3, v13
    s_lshl_b32 s78, s81, 11
    s_add_u32 s78, s78, 159744
    v_add_u32 v15, s78, v13
    v_mov_b64 v[128:129], 0
    v_mov_b64 v[130:131], 0
    v_mov_b64 v[132:133], 0
    v_mov_b64 v[134:135], 0
    v_mov_b64 v[136:137], 0
    v_mov_b64 v[138:139], 0
    v_mov_b64 v[140:141], 0
    v_mov_b64 v[142:143], 0
    v_mov_b64 v[144:145], 0
    v_mov_b64 v[146:147], 0
    v_mov_b64 v[148:149], 0
    v_mov_b64 v[150:151], 0
    v_mov_b64 v[152:153], 0
    v_mov_b64 v[154:155], 0
    v_mov_b64 v[156:157], 0
    v_mov_b64 v[158:159], 0
    v_mov_b64 v[160:161], 0
    v_mov_b64 v[162:163], 0
    v_mov_b64 v[164:165], 0
    v_mov_b64 v[166:167], 0
    v_mov_b64 v[168:169], 0
    v_mov_b64 v[170:171], 0
    v_mov_b64 v[172:173], 0
    v_mov_b64 v[174:175], 0
    v_mov_b64 v[176:177], 0
    v_mov_b64 v[178:179], 0
    v_mov_b64 v[180:181], 0
    v_mov_b64 v[182:183], 0
    v_mov_b64 v[184:185], 0
    v_mov_b64 v[186:187], 0
    v_mov_b64 v[188:189], 0
    v_mov_b64 v[190:191], 0
    v_mov_b64 v[192:193], 0
    v_mov_b64 v[194:195], 0
    v_mov_b64 v[196:197], 0
    v_mov_b64 v[198:199], 0
    v_mov_b64 v[200:201], 0
    v_mov_b64 v[202:203], 0
    v_mov_b64 v[204:205], 0
    v_mov_b64 v[206:207], 0
    v_mov_b64 v[208:209], 0
    v_mov_b64 v[210:211], 0
    v_mov_b64 v[212:213], 0
    v_mov_b64 v[214:215], 0
    v_mov_b64 v[216:217], 0
    v_mov_b64 v[218:219], 0
    v_mov_b64 v[220:221], 0
    v_mov_b64 v[222:223], 0
    v_mov_b64 v[104:105], 0
    v_mov_b64 v[106:107], 0
    v_mov_b64 v[108:109], 0
    v_mov_b64 v[110:111], 0
    v_and_b32 v14, 31, v2
    v_lshrrev_b32_e64 v13, 5, v2
    s_lshl_b32 s78, s81, 14
    s_lshl_b32 s79, s80, 13
    s_add_u32 s78, s78, s79
    s_add_u32 s78, s78, 110592
    v_lshl_add_u32 v12, v14, 7, s78
    v_and_b32 v14, 7, v14
    v_xor_b32 v14, v14, v13
    v_xor_b32_e64 v13, 0, v14
    v_lshl_add_u32 v112, v13, 4, v12
    v_xor_b32_e64 v13, 2, v14
    v_lshl_add_u32 v113, v13, 4, v12
    v_xor_b32_e64 v13, 4, v14
    v_lshl_add_u32 v114, v13, 4, v12
    v_xor_b32_e64 v13, 6, v14
    v_lshl_add_u32 v115, v13, 4, v12
    s_add_u32 s79, s79, 143360
    v_lshl_add_u32 v12, v8, 7, s79
    s_lshl_b32 s78, s81, 2
    v_add_u32 v14, s78, v9
    v_and_b32 v13, 7, v8
    v_xor_b32 v14, v14, v13
    v_lshl_add_u32 v116, v14, 4, v12
    s_lshl_b32 s78, s80, 6
    v_add_u32 v10, s78, v8
    v_lshlrev_b32_e64 v11, 3, v10
    v_add_u32 v11, 159744, v11
    s_lshl_b32 s79, s81, 5
    v_add_u32 v12, s79, v8
    v_lshlrev_b32_e64 v12, 3, v12
    v_add_u32 v12, 160768, v12
    v_lshlrev_b32_e64 v13, 2, v10
    v_add_u32 v13, 162304, v13
    v_and_b32 v14, 31, v2
    v_add_u32 v14, s78, v14
    v_lshlrev_b32_e64 v14, 2, v14
    v_add_u32 v14, 162304, v14
    s_waitcnt lgkmcnt(0)
    s_load_dword s75, s[26:27], 0
    s_mov_b32 s36, s26
    s_and_b32 s37, s27, 0xffff
    s_mov_b32 s38, 0x10000000
    s_mov_b32 s39, 0x20000
    s_mov_b32 s64, s14
    s_and_b32 s65, s15, 0xffff
    s_mov_b32 s66, 0x800
    s_mov_b32 s67, 0x20000
    s_mov_b32 s44, s22
    s_and_b32 s45, s23, 0xffff
    s_mov_b32 s46, 0x400000
    s_mov_b32 s47, 0x20000
    v_lshlrev_b32 v10, 3, v9
    s_lshl_b32 s78, s72, 7
    buffer_load_dwordx2 v[118:119], v10, s[64:67], s78 offen offset:0
    buffer_load_dwordx2 v[120:121], v10, s[64:67], s78 offen offset:32
    buffer_load_dwordx2 v[122:123], v10, s[64:67], s78 offen offset:64
    buffer_load_dwordx2 v[124:125], v10, s[64:67], s78 offen offset:96
    s_waitcnt lgkmcnt(0)
    s_mul_i32 s75, s75, 0x9E3779B1
    s_add_u32 s75, s75, 0x7F4A7C15
    s_mov_b32 s84, 0
    s_mov_b32 s82, 2
    s_mov_b32 s83, 0xfffec000
    s_barrier
    ds_read_b128 v[16:19], v4 offset:0
    ds_read_b64_tr_b16 v[40:41], v6 offset:8192
    ds_read_b64_tr_b16 v[42:43], v6 offset:8704
    ds_read_b128 v[20:23], v4 offset:2048
    ds_read_b128 v[24:27], v4 offset:4096
    ds_read_b128 v[28:31], v4 offset:6144
    ds_read_b64_tr_b16 v[44:45], v7 offset:8192
    ds_read_b64_tr_b16 v[46:47], v7 offset:8704
    ds_read_b64_tr_b16 v[48:49], v6 offset:16384
    ds_read_b64_tr_b16 v[50:51], v6 offset:16896
    ds_read_b64_tr_b16 v[52:53], v7 offset:16384
    ds_read_b64_tr_b16 v[54:55], v7 offset:16896
    ds_read_b64_tr_b16 v[32:33], v6 offset:0
    ds_read_b64_tr_b16 v[34:35], v6 offset:512
    ds_read_b64_tr_b16 v[36:37], v7 offset:0
    ds_read_b64_tr_b16 v[38:39], v7 offset:512
    ds_read_b64_tr_b16 v[96:97], v15 offset:0
    ds_read_b64_tr_b16 v[98:99], v15 offset:1024
    ds_read_b64_tr_b16 v[100:101], v15 offset:256
    ds_read_b64_tr_b16 v[102:103], v15 offset:1280
    .p2align 3
L_Mloop:
    s_waitcnt lgkmcnt(0)
    s_nop 0
    v_mfma_f32_16x16x32_bf16 v[160:163], v[40:43], v[16:19], v[160:163]
    ds_read_b128 v[56:59], v5 offset:0
    v_mfma_f32_16x16x32_bf16 v[164:167], v[40:43], v[20:23], v[164:167]
    ds_read_b64_tr_b16 v[80:81], v6 offset:12288
    v_mfma_f32_16x16x32_bf16 v[168:171], v[40:43], v[24:27], v[168:171]
    ds_read_b64_tr_b16 v[82:83], v6 offset:12800
    v_mfma_f32_16x16x32_bf16 v[172:175], v[40:43], v[28:31], v[172:175]
    ds_read_b128 v[60:63], v5 offset:2048
    v_mfma_f32_16x16x32_bf16 v[188:191], v[44:47], v[28:31], v[188:191]
    ds_read_b128 v[64:67], v5 offset:4096
    v_mfma_f32_16x16x32_bf16 v[184:187], v[44:47], v[24:27], v[184:187]
    ds_read_b128 v[68:71], v5 offset:6144
    v_mfma_f32_16x16x32_bf16 v[180:183], v[44:47], v[20:23], v[180:183]
    ds_read_b64_tr_b16 v[84:85], v7 offset:12288
    v_mfma_f32_16x16x32_bf16 v[176:179], v[44:47], v[16:19], v[176:179]
    ds_read_b64_tr_b16 v[86:87], v7 offset:12800
    v_mfma_f32_16x16x32_bf16 v[192:195], v[48:51], v[16:19], v[192:195]
    ds_read_b64_tr_b16 v[88:89], v6 offset:20480
    v_mfma_f32_16x16x32_bf16 v[196:199], v[48:51], v[20:23], v[196:199]
    ds_read_b64_tr_b16 v[90:91], v6 offset:20992
    v_mfma_f32_16x16x32_bf16 v[200:203], v[48:51], v[24:27], v[200:203]
    ds_read_b64_tr_b16 v[92:93], v7 offset:20480
    v_mfma_f32_16x16x32_bf16 v[204:207], v[48:51], v[28:31], v[204:207]
    ds_read_b64_tr_b16 v[94:95], v7 offset:20992
    v_mfma_f32_16x16x32_bf16 v[220:223], v[52:55], v[28:31], v[220:223]
    ds_read_b64_tr_b16 v[72:73], v6 offset:4096
    v_mfma_f32_16x16x32_bf16 v[216:219], v[52:55], v[24:27], v[216:219]
    ds_read_b64_tr_b16 v[74:75], v6 offset:4608
    v_mfma_f32_16x16x32_bf16 v[212:215], v[52:55], v[20:23], v[212:215]
    ds_read_b64_tr_b16 v[76:77], v7 offset:4096
    v_mfma_f32_16x16x32_bf16 v[208:211], v[52:55], v[16:19], v[208:211]
    ds_read_b64_tr_b16 v[78:79], v7 offset:4608
    v_mfma_f32_16x16x32_bf16 v[128:131], v[32:35], v[16:19], v[128:131]
    s_add_u32 s84, s84, 1
    s_cmp_eq_u32 s82, 2
    s_cselect_b32 s78, s83, 40960
    s_cselect_b32 s82, -1, s82
    s_add_u32 s82, s82, 1
    v_mfma_f32_16x16x32_bf16 v[132:135], v[32:35], v[20:23], v[132:135]
    v_add_u32 v4, s78, v4
    v_add_u32 v5, s78, v5
    v_mfma_f32_16x16x32_bf16 v[136:139], v[32:35], v[24:27], v[136:139]
    v_add_u32 v6, s78, v6
    v_add_u32 v7, s78, v7
    v_mfma_f32_16x16x32_bf16 v[140:143], v[32:35], v[28:31], v[140:143]
    v_mfma_f32_16x16x32_bf16 v[156:159], v[36:39], v[28:31], v[156:159]
    v_mfma_f32_16x16x32_bf16 v[152:155], v[36:39], v[24:27], v[152:155]
    v_mfma_f32_16x16x32_bf16 v[148:151], v[36:39], v[20:23], v[148:151]
    v_mfma_f32_16x16x32_bf16 v[144:147], v[36:39], v[16:19], v[144:147]
    s_waitcnt vmcnt(0) lgkmcnt(0)
    v_mfma_f32_16x16x32_bf16 v[160:163], v[80:83], v[56:59], v[160:163]
    v_mfma_f32_16x16x32_bf16 v[164:167], v[80:83], v[60:63], v[164:167]
    s_barrier
    s_cmp_eq_u32 s84, 16
    s_cbranch_scc1 L_Mtail
    v_mfma_f32_16x16x32_bf16 v[168:171], v[80:83], v[64:67], v[168:171]
    ds_read_b128 v[16:19], v4 offset:0
    v_mfma_f32_16x16x32_bf16 v[172:175], v[80:83], v[68:71], v[172:175]
    ds_read_b64_tr_b16 v[40:41], v6 offset:8192
    v_mfma_f32_16x16x32_bf16 v[188:191], v[84:87], v[68:71], v[188:191]
    ds_read_b64_tr_b16 v[42:43], v6 offset:8704
    v_mfma_f32_16x16x32_bf16 v[184:187], v[84:87], v[64:67], v[184:187]
    ds_read_b128 v[20:23], v4 offset:2048
    v_mfma_f32_16x16x32_bf16 v[180:183], v[84:87], v[60:63], v[180:183]
    ds_read_b128 v[24:27], v4 offset:4096
    v_mfma_f32_16x16x32_bf16 v[176:179], v[84:87], v[56:59], v[176:179]
    ds_read_b128 v[28:31], v4 offset:6144
    v_mfma_f32_16x16x32_bf16 v[192:195], v[88:91], v[56:59], v[192:195]
    ds_read_b64_tr_b16 v[44:45], v7 offset:8192
    v_mfma_f32_16x16x32_bf16 v[196:199], v[88:91], v[60:63], v[196:199]
    ds_read_b64_tr_b16 v[46:47], v7 offset:8704
    v_mfma_f32_16x16x32_bf16 v[200:203], v[88:91], v[64:67], v[200:203]
    ds_read_b64_tr_b16 v[48:49], v6 offset:16384
    v_mfma_f32_16x16x32_bf16 v[204:207], v[88:91], v[68:71], v[204:207]
    ds_read_b64_tr_b16 v[50:51], v6 offset:16896
    v_mfma_f32_16x16x32_bf16 v[220:223], v[92:95], v[68:71], v[220:223]
    ds_read_b64_tr_b16 v[52:53], v7 offset:16384
    v_mfma_f32_16x16x32_bf16 v[216:219], v[92:95], v[64:67], v[216:219]
    ds_read_b64_tr_b16 v[54:55], v7 offset:16896
    v_mfma_f32_16x16x32_bf16 v[212:215], v[92:95], v[60:63], v[212:215]
    ds_read_b64_tr_b16 v[32:33], v6 offset:0
    v_mfma_f32_16x16x32_bf16 v[208:211], v[92:95], v[56:59], v[208:211]
    ds_read_b64_tr_b16 v[34:35], v6 offset:512
    v_mfma_f32_16x16x32_bf16 v[128:131], v[72:75], v[56:59], v[128:131]
    ds_read_b64_tr_b16 v[36:37], v7 offset:0
    v_mfma_f32_16x16x32_bf16 v[132:135], v[72:75], v[60:63], v[132:135]
    ds_read_b64_tr_b16 v[38:39], v7 offset:512
    v_mfma_f32_16x16x32_bf16 v[136:139], v[72:75], v[64:67], v[136:139]
    v_mfma_f32_16x16x32_bf16 v[140:143], v[72:75], v[68:71], v[140:143]
    v_mfma_f32_16x16x32_bf16 v[156:159], v[76:79], v[68:71], v[156:159]
    v_mfma_f32_16x16x32_bf16 v[152:155], v[76:79], v[64:67], v[152:155]
    v_mfma_f32_16x16x32_bf16 v[148:151], v[76:79], v[60:63], v[148:151]
    v_mfma_f32_16x16x32_bf16 v[144:147], v[76:79], v[56:59], v[144:147]
    s_branch L_Mloop
    .p2align 3
L_Mtail:
    s_mov_b64 exec, 0xffff
    ds_read_b64 v[104:105], v11 offset:0
    ds_read_b64 v[106:107], v11 offset:128
    ds_read_b64 v[108:109], v11 offset:256
    ds_read_b64 v[110:111], v11 offset:384
    s_mov_b64 exec, -1
    s_nop 0
    v_mfma_f32_16x16x32_bf16 v[168:171], v[80:83], v[64:67], v[168:171]
    ds_read_b64 v[20:21], v12 offset:512
    v_mfma_f32_16x16x32_bf16 v[172:175], v[80:83], v[68:71], v[172:175]
    ds_read_b64 v[22:23], v12 offset:640
    v_mfma_f32_16x16x32_bf16 v[188:191], v[84:87], v[68:71], v[188:191]
    ds_read_b64 v[24:25], v12 offset:1024
    v_mfma_f32_16x16x32_bf16 v[184:187], v[84:87], v[64:67], v[184:187]
    ds_read_b64 v[26:27], v12 offset:1152
    v_mfma_f32_16x16x32_bf16 v[180:183], v[84:87], v[60:63], v[180:183]
    ds_read_b64 v[16:17], v12 offset:0
    v_mfma_f32_16x16x32_bf16 v[176:179], v[84:87], v[56:59], v[176:179]
    ds_read_b64 v[18:19], v12 offset:128
    v_mfma_f32_16x16x32_bf16 v[192:195], v[88:91], v[56:59], v[192:195]
    ds_read2_b32 v[32:33], v14 offset0:0 offset1:32
    v_mfma_f32_16x16x32_bf16 v[196:199], v[88:91], v[60:63], v[196:199]
    ds_read_b32 v28, v13 offset:0
    v_mfma_f32_16x16x32_bf16 v[200:203], v[88:91], v[64:67], v[200:203]
    ds_read_b32 v30, v13 offset:64
    v_mfma_f32_16x16x32_bf16 v[204:207], v[88:91], v[68:71], v[204:207]
    ds_read_b32 v44, v13 offset:128
    v_mfma_f32_16x16x32_bf16 v[220:223], v[92:95], v[68:71], v[220:223]
    ds_read_b32 v46, v13 offset:192
    v_mfma_f32_16x16x32_bf16 v[216:219], v[92:95], v[64:67], v[216:219]
    v_mfma_f32_16x16x32_bf16 v[212:215], v[92:95], v[60:63], v[212:215]
    v_mfma_f32_16x16x32_bf16 v[208:211], v[92:95], v[56:59], v[208:211]
    s_waitcnt lgkmcnt(0)
    s_nop 0
    v_mfma_f32_16x16x16_bf16 v[160:163], v[20:21], v[104:105], v[160:163]
    v_mfma_f32_16x16x16_bf16 v[176:179], v[22:23], v[104:105], v[176:179]
    v_mfma_f32_16x16x16_bf16 v[164:167], v[20:21], v[106:107], v[164:167]
    v_mfma_f32_16x16x16_bf16 v[180:183], v[22:23], v[106:107], v[180:183]
    v_mfma_f32_16x16x16_bf16 v[168:171], v[20:21], v[108:109], v[168:171]
    v_mfma_f32_16x16x16_bf16 v[184:187], v[22:23], v[108:109], v[184:187]
    v_mfma_f32_16x16x16_bf16 v[172:175], v[20:21], v[110:111], v[172:175]
    v_mfma_f32_16x16x16_bf16 v[188:191], v[22:23], v[110:111], v[188:191]
    v_mul_f32 v34, 0x3fb8aa3b, v32
    v_mul_f32 v48, 0x3fb8aa3b, v33
    v_mfma_f32_16x16x16_bf16 v[192:195], v[24:25], v[104:105], v[192:195]
    v_mfma_f32_16x16x16_bf16 v[208:211], v[26:27], v[104:105], v[208:211]
    v_mfma_f32_16x16x16_bf16 v[196:199], v[24:25], v[106:107], v[196:199]
    v_cvt_pk_bf16_f32 v160, v160, v161
    v_cvt_pk_bf16_f32 v161, v162, v163
    v_cvt_pk_bf16_f32 v162, v176, v177
    v_cvt_pk_bf16_f32 v163, v178, v179
    v_mfma_f32_16x16x16_bf16 v[212:215], v[26:27], v[106:107], v[212:215]
    v_cvt_pk_bf16_f32 v164, v164, v165
    v_cvt_pk_bf16_f32 v165, v166, v167
    v_cvt_pk_bf16_f32 v166, v180, v181
    v_cvt_pk_bf16_f32 v167, v182, v183
    v_mfma_f32_16x16x16_bf16 v[200:203], v[24:25], v[108:109], v[200:203]
    v_cvt_pk_bf16_f32 v168, v168, v169
    v_cvt_pk_bf16_f32 v169, v170, v171
    v_cvt_pk_bf16_f32 v170, v184, v185
    v_cvt_pk_bf16_f32 v171, v186, v187
    v_mfma_f32_16x16x16_bf16 v[216:219], v[26:27], v[108:109], v[216:219]
    v_cvt_pk_bf16_f32 v172, v172, v173
    v_cvt_pk_bf16_f32 v173, v174, v175
    v_cvt_pk_bf16_f32 v174, v188, v189
    v_cvt_pk_bf16_f32 v175, v190, v191
    v_mfma_f32_16x16x16_bf16 v[204:207], v[24:25], v[110:111], v[204:207]
    v_permlane16_swap_b32 v160, v164
    v_permlane16_swap_b32 v161, v165
    v_permlane16_swap_b32 v162, v166
    v_permlane16_swap_b32 v163, v167
    v_mfma_f32_16x16x16_bf16 v[220:223], v[26:27], v[110:111], v[220:223]
    v_permlane16_swap_b32 v168, v172
    v_permlane16_swap_b32 v169, v173
    v_permlane16_swap_b32 v170, v174
    v_permlane16_swap_b32 v171, v175
    v_mfma_f32_32x32x16_bf16 v[224:239], v[96:99], v[160:163], 0
    v_mfma_f32_32x32x16_bf16 v[224:239], v[100:103], v[164:167], v[224:239]
    v_mfma_f32_32x32x16_bf16 v[240:255], v[96:99], v[168:171], 0
    v_mfma_f32_32x32x16_bf16 v[240:255], v[100:103], v[172:175], v[240:255]
    v_pk_mul_f32 v[192:193], v[192:193], v[28:29] op_sel_hi:[1,0]
    v_pk_mul_f32 v[194:195], v[194:195], v[28:29] op_sel_hi:[1,0]
    v_pk_mul_f32 v[208:209], v[208:209], v[28:29] op_sel_hi:[1,0]
    v_pk_mul_f32 v[210:211], v[210:211], v[28:29] op_sel_hi:[1,0]
    v_cvt_pk_bf16_f32 v192, v192, v193
    v_cvt_pk_bf16_f32 v193, v194, v195
    v_cvt_pk_bf16_f32 v194, v208, v209
    v_cvt_pk_bf16_f32 v195, v210, v211
    v_pk_mul_f32 v[196:197], v[196:197], v[30:31] op_sel_hi:[1,0]
    v_pk_mul_f32 v[198:199], v[198:199], v[30:31] op_sel_hi:[1,0]
    v_pk_mul_f32 v[212:213], v[212:213], v[30:31] op_sel_hi:[1,0]
    v_pk_mul_f32 v[214:215], v[214:215], v[30:31] op_sel_hi:[1,0]
    v_cvt_pk_bf16_f32 v196, v196, v197
    v_cvt_pk_bf16_f32 v197, v198, v199
    v_cvt_pk_bf16_f32 v198, v212, v213
    v_cvt_pk_bf16_f32 v199, v214, v215
    v_pk_mul_f32 v[200:201], v[200:201], v[44:45] op_sel_hi:[1,0]
    v_pk_mul_f32 v[202:203], v[202:203], v[44:45] op_sel_hi:[1,0]
    v_pk_mul_f32 v[216:217], v[216:217], v[44:45] op_sel_hi:[1,0]
    v_pk_mul_f32 v[218:219], v[218:219], v[44:45] op_sel_hi:[1,0]
    v_cvt_pk_bf16_f32 v200, v200, v201
    v_cvt_pk_bf16_f32 v201, v202, v203
    v_cvt_pk_bf16_f32 v202, v216, v217
    v_cvt_pk_bf16_f32 v203, v218, v219
    v_pk_mul_f32 v[204:205], v[204:205], v[46:47] op_sel_hi:[1,0]
    v_pk_mul_f32 v[206:207], v[206:207], v[46:47] op_sel_hi:[1,0]
    v_pk_mul_f32 v[220:221], v[220:221], v[46:47] op_sel_hi:[1,0]
    v_pk_mul_f32 v[222:223], v[222:223], v[46:47] op_sel_hi:[1,0]
    v_cvt_pk_bf16_f32 v204, v204, v205
    v_cvt_pk_bf16_f32 v205, v206, v207
    v_cvt_pk_bf16_f32 v206, v220, v221
    v_cvt_pk_bf16_f32 v207, v222, v223
    v_mfma_f32_16x16x32_bf16 v[128:131], v[72:75], v[56:59], v[128:131]
    v_max3_f32 v36, v224, v225, v226
    v_max3_f32 v38, -v224, -v225, -v226
    v_max3_f32 v36, v36, v227, v228
    v_max3_f32 v38, v38, -v227, -v228
    v_mfma_f32_16x16x32_bf16 v[132:135], v[72:75], v[60:63], v[132:135]
    v_max3_f32 v36, v36, v229, v230
    v_max3_f32 v38, v38, -v229, -v230
    v_max3_f32 v36, v36, v231, v232
    v_max3_f32 v38, v38, -v231, -v232
    v_mfma_f32_16x16x32_bf16 v[136:139], v[72:75], v[64:67], v[136:139]
    v_max3_f32 v36, v36, v233, v234
    v_max3_f32 v38, v38, -v233, -v234
    v_max3_f32 v36, v36, v235, v236
    v_max3_f32 v38, v38, -v235, -v236
    v_mfma_f32_16x16x32_bf16 v[140:143], v[72:75], v[68:71], v[140:143]
    v_max3_f32 v36, v36, v237, v238
    v_max3_f32 v38, v38, -v237, -v238
    v_max_f32_e64 v36, v36, v239
    v_max_f32 v38, v38, -v239
    v_mfma_f32_16x16x32_bf16 v[156:159], v[76:79], v[68:71], v[156:159]
    v_max3_f32 v37, v240, v241, v242
    v_max3_f32 v39, -v240, -v241, -v242
    v_max3_f32 v37, v37, v243, v244
    v_max3_f32 v39, v39, -v243, -v244
    v_mfma_f32_16x16x32_bf16 v[152:155], v[76:79], v[64:67], v[152:155]
    v_max3_f32 v37, v37, v245, v246
    v_max3_f32 v39, v39, -v245, -v246
    v_max3_f32 v37, v37, v247, v248
    v_max3_f32 v39, v39, -v247, -v248
    v_mfma_f32_16x16x32_bf16 v[148:151], v[76:79], v[60:63], v[148:151]
    v_max3_f32 v37, v37, v249, v250
    v_max3_f32 v39, v39, -v249, -v250
    v_max3_f32 v37, v37, v251, v252
    v_max3_f32 v39, v39, -v251, -v252
    v_mfma_f32_16x16x32_bf16 v[144:147], v[76:79], v[56:59], v[144:147]
    v_max3_f32 v37, v37, v253, v254
    v_max3_f32 v39, v39, -v253, -v254
    v_max_f32_e64 v37, v37, v255
    v_max_f32 v39, v39, -v255
    v_permlane32_swap_b32 v36, v38
    s_nop 0
    v_permlane32_swap_b32 v37, v39
    v_max_f32 v36, v36, v38
    v_max_f32_e64 v37, v37, v39
    v_mul_f32 v36, -v36, v34
    v_mul_f32 v37, -v37, v48
    v_mov_b32 v38, v36
    v_mov_b32 v39, v37
    s_nop 0
    v_permlane32_swap_b32 v36, v38
    v_permlane32_swap_b32_e64 v37, v39
    v_pk_fma_f32 v[60:61], v[224:225], v[34:35], v[36:37] op_sel_hi:[1,0,0]
    v_pk_fma_f32 v[62:63], v[226:227], v[34:35], v[36:37] op_sel_hi:[1,0,0]
    v_pk_fma_f32 v[64:65], v[228:229], v[34:35], v[36:37] op_sel_hi:[1,0,0]
    v_pk_fma_f32 v[66:67], v[230:231], v[34:35], v[36:37] op_sel_hi:[1,0,0]
    v_pk_fma_f32 v[68:69], v[232:233], v[34:35], v[36:37] op_sel_hi:[1,0,0]
    v_pk_fma_f32 v[70:71], v[234:235], v[34:35], v[36:37] op_sel_hi:[1,0,0]
    v_pk_fma_f32 v[72:73], v[236:237], v[34:35], v[36:37] op_sel_hi:[1,0,0]
    v_pk_fma_f32 v[74:75], v[238:239], v[34:35], v[36:37] op_sel_hi:[1,0,0]
    v_pk_fma_f32 v[76:77], v[224:225], v[34:35], v[38:39] op_sel_hi:[1,0,0] neg_lo:[1,0,0] neg_hi:[1,0,0]
    v_pk_fma_f32 v[78:79], v[226:227], v[34:35], v[38:39] op_sel_hi:[1,0,0] neg_lo:[1,0,0] neg_hi:[1,0,0]
    v_pk_fma_f32 v[80:81], v[228:229], v[34:35], v[38:39] op_sel_hi:[1,0,0] neg_lo:[1,0,0] neg_hi:[1,0,0]
    v_pk_fma_f32 v[82:83], v[230:231], v[34:35], v[38:39] op_sel_hi:[1,0,0] neg_lo:[1,0,0] neg_hi:[1,0,0]
    v_pk_fma_f32 v[84:85], v[232:233], v[34:35], v[38:39] op_sel_hi:[1,0,0] neg_lo:[1,0,0] neg_hi:[1,0,0]
    v_pk_fma_f32 v[86:87], v[234:235], v[34:35], v[38:39] op_sel_hi:[1,0,0] neg_lo:[1,0,0] neg_hi:[1,0,0]
    v_pk_fma_f32 v[88:89], v[236:237], v[34:35], v[38:39] op_sel_hi:[1,0,0] neg_lo:[1,0,0] neg_hi:[1,0,0]
    v_pk_fma_f32 v[90:91], v[238:239], v[34:35], v[38:39] op_sel_hi:[1,0,0] neg_lo:[1,0,0] neg_hi:[1,0,0]
    v_exp_f32 v60, v60
    v_exp_f32 v61, v61
    v_exp_f32 v62, v62
    v_exp_f32 v63, v63
    v_exp_f32 v64, v64
    v_exp_f32 v65, v65
    v_exp_f32 v66, v66
    v_exp_f32 v67, v67
    v_exp_f32 v68, v68
    v_exp_f32 v69, v69
    v_exp_f32 v70, v70
    v_exp_f32 v71, v71
    v_exp_f32 v72, v72
    v_exp_f32 v73, v73
    v_exp_f32 v74, v74
    v_exp_f32 v75, v75
    v_exp_f32 v76, v76
    v_exp_f32 v77, v77
    v_exp_f32 v78, v78
    v_exp_f32 v79, v79
    v_exp_f32 v80, v80
    v_exp_f32 v81, v81
    v_exp_f32 v82, v82
    v_exp_f32 v83, v83
    v_exp_f32 v84, v84
    v_exp_f32 v85, v85
    v_exp_f32 v86, v86
    v_exp_f32 v87, v87
    v_exp_f32 v88, v88
    v_exp_f32 v89, v89
    v_exp_f32 v90, v90
    v_exp_f32 v91, v91
    v_pk_add_f32 v[40:41], v[60:61], v[62:63]
    v_pk_add_f32 v[42:43], v[76:77], v[78:79]
    v_pk_add_f32 v[40:41], v[40:41], v[64:65]
    v_pk_add_f32 v[42:43], v[42:43], v[80:81]
    v_pk_add_f32 v[40:41], v[40:41], v[66:67]
    v_pk_add_f32 v[42:43], v[42:43], v[82:83]
    v_pk_add_f32 v[40:41], v[40:41], v[68:69]
    v_pk_add_f32 v[42:43], v[42:43], v[84:85]
    v_pk_add_f32 v[40:41], v[40:41], v[70:71]
    v_pk_add_f32 v[42:43], v[42:43], v[86:87]
    v_pk_add_f32 v[40:41], v[40:41], v[72:73]
    v_pk_add_f32 v[42:43], v[42:43], v[88:89]
    v_pk_add_f32 v[40:41], v[40:41], v[74:75]
    v_pk_add_f32 v[42:43], v[42:43], v[90:91]
    v_add_f32 v40, v40, v41
    v_add_f32 v42, v42, v43
    s_nop 1
    v_permlane32_swap_b32 v40, v42
    v_add_f32 v40, v40, v42
    v_rcp_f32 v40, v40
    s_nop 0
    v_mov_b32 v42, v40
    s_nop 1
    v_permlane32_swap_b32 v40, v42
    v_pk_mul_f32 v[60:61], v[60:61], v[40:41] op_sel_hi:[1,0]
    v_pk_mul_f32 v[62:63], v[62:63], v[40:41] op_sel_hi:[1,0]
    v_pk_mul_f32 v[64:65], v[64:65], v[40:41] op_sel_hi:[1,0]
    v_pk_mul_f32 v[66:67], v[66:67], v[40:41] op_sel_hi:[1,0]
    v_cvt_pk_bf16_f32 v160, v60, v61
    v_cvt_pk_bf16_f32 v161, v62, v63
    v_cvt_pk_bf16_f32 v162, v64, v65
    v_cvt_pk_bf16_f32 v163, v66, v67
    v_pk_mul_f32 v[68:69], v[68:69], v[40:41] op_sel_hi:[1,0]
    v_pk_mul_f32 v[70:71], v[70:71], v[40:41] op_sel_hi:[1,0]
    v_pk_mul_f32 v[72:73], v[72:73], v[40:41] op_sel_hi:[1,0]
    v_pk_mul_f32 v[74:75], v[74:75], v[40:41] op_sel_hi:[1,0]
    v_cvt_pk_bf16_f32 v164, v68, v69
    v_cvt_pk_bf16_f32 v165, v70, v71
    v_cvt_pk_bf16_f32 v166, v72, v73
    v_cvt_pk_bf16_f32 v167, v74, v75
    v_pk_mul_f32 v[76:77], v[76:77], v[42:43] op_sel_hi:[1,0]
    v_pk_mul_f32 v[78:79], v[78:79], v[42:43] op_sel_hi:[1,0]
    v_pk_mul_f32 v[80:81], v[80:81], v[42:43] op_sel_hi:[1,0]
    v_pk_mul_f32 v[82:83], v[82:83], v[42:43] op_sel_hi:[1,0]
    v_cvt_pk_bf16_f32 v168, v76, v77
    v_cvt_pk_bf16_f32 v169, v78, v79
    v_cvt_pk_bf16_f32 v170, v80, v81
    v_cvt_pk_bf16_f32 v171, v82, v83
    v_pk_mul_f32 v[84:85], v[84:85], v[42:43] op_sel_hi:[1,0]
    v_pk_mul_f32 v[86:87], v[86:87], v[42:43] op_sel_hi:[1,0]
    v_pk_mul_f32 v[88:89], v[88:89], v[42:43] op_sel_hi:[1,0]
    v_pk_mul_f32 v[90:91], v[90:91], v[42:43] op_sel_hi:[1,0]
    v_cvt_pk_bf16_f32 v172, v84, v85
    v_cvt_pk_bf16_f32 v173, v86, v87
    v_cvt_pk_bf16_f32 v174, v88, v89
    v_cvt_pk_bf16_f32 v175, v90, v91
    v_pk_fma_f32 v[60:61], v[240:241], v[48:49], v[36:37] op_sel:[0,0,1] op_sel_hi:[1,0,1]
    v_pk_fma_f32 v[62:63], v[242:243], v[48:49], v[36:37] op_sel:[0,0,1] op_sel_hi:[1,0,1]
    v_pk_fma_f32 v[64:65], v[244:245], v[48:49], v[36:37] op_sel:[0,0,1] op_sel_hi:[1,0,1]
    v_pk_fma_f32 v[66:67], v[246:247], v[48:49], v[36:37] op_sel:[0,0,1] op_sel_hi:[1,0,1]
    v_pk_fma_f32 v[68:69], v[248:249], v[48:49], v[36:37] op_sel:[0,0,1] op_sel_hi:[1,0,1]
    v_pk_fma_f32 v[70:71], v[250:251], v[48:49], v[36:37] op_sel:[0,0,1] op_sel_hi:[1,0,1]
    v_pk_fma_f32 v[72:73], v[252:253], v[48:49], v[36:37] op_sel:[0,0,1] op_sel_hi:[1,0,1]
    v_pk_fma_f32 v[74:75], v[254:255], v[48:49], v[36:37] op_sel:[0,0,1] op_sel_hi:[1,0,1]
    v_pk_fma_f32 v[76:77], v[240:241], v[48:49], v[38:39] op_sel:[0,0,1] op_sel_hi:[1,0,1] neg_lo:[1,0,0] neg_hi:[1,0,0]
    v_pk_fma_f32 v[78:79], v[242:243], v[48:49], v[38:39] op_sel:[0,0,1] op_sel_hi:[1,0,1] neg_lo:[1,0,0] neg_hi:[1,0,0]
    v_pk_fma_f32 v[80:81], v[244:245], v[48:49], v[38:39] op_sel:[0,0,1] op_sel_hi:[1,0,1] neg_lo:[1,0,0] neg_hi:[1,0,0]
    v_pk_fma_f32 v[82:83], v[246:247], v[48:49], v[38:39] op_sel:[0,0,1] op_sel_hi:[1,0,1] neg_lo:[1,0,0] neg_hi:[1,0,0]
    v_pk_fma_f32 v[84:85], v[248:249], v[48:49], v[38:39] op_sel:[0,0,1] op_sel_hi:[1,0,1] neg_lo:[1,0,0] neg_hi:[1,0,0]
    v_pk_fma_f32 v[86:87], v[250:251], v[48:49], v[38:39] op_sel:[0,0,1] op_sel_hi:[1,0,1] neg_lo:[1,0,0] neg_hi:[1,0,0]
    v_pk_fma_f32 v[88:89], v[252:253], v[48:49], v[38:39] op_sel:[0,0,1] op_sel_hi:[1,0,1] neg_lo:[1,0,0] neg_hi:[1,0,0]
    v_pk_fma_f32 v[90:91], v[254:255], v[48:49], v[38:39] op_sel:[0,0,1] op_sel_hi:[1,0,1] neg_lo:[1,0,0] neg_hi:[1,0,0]
    v_exp_f32 v60, v60
    v_exp_f32 v61, v61
    v_exp_f32 v62, v62
    v_exp_f32 v63, v63
    ds_write_b128 v116, v[192:195] offset:0
    v_exp_f32 v64, v64
    v_exp_f32 v65, v65
    v_exp_f32 v66, v66
    v_exp_f32 v67, v67
    ds_write_b128 v116, v[196:199] offset:2048
    v_exp_f32 v68, v68
    v_exp_f32 v69, v69
    v_exp_f32 v70, v70
    v_exp_f32 v71, v71
    ds_write_b128 v116, v[200:203] offset:4096
    v_exp_f32 v72, v72
    v_exp_f32 v73, v73
    v_exp_f32 v74, v74
    v_exp_f32 v75, v75
    ds_write_b128 v116, v[204:207] offset:6144
    v_exp_f32 v76, v76
    v_exp_f32 v77, v77
    v_exp_f32 v78, v78
    v_exp_f32 v79, v79
    ds_write_b128 v112, v[160:163] offset:0
    v_exp_f32 v80, v80
    v_exp_f32 v81, v81
    v_exp_f32 v82, v82
    v_exp_f32 v83, v83
    ds_write_b128 v113, v[164:167] offset:0
    v_exp_f32 v84, v84
    v_exp_f32 v85, v85
    v_exp_f32 v86, v86
    v_exp_f32 v87, v87
    ds_write_b128 v114, v[168:171] offset:0
    v_exp_f32 v88, v88
    v_exp_f32 v89, v89
    v_exp_f32 v90, v90
    v_exp_f32 v91, v91
    ds_write_b128 v115, v[172:175] offset:0
    v_pk_add_f32 v[40:41], v[60:61], v[62:63]
    v_pk_add_f32 v[42:43], v[76:77], v[78:79]
    v_pk_add_f32 v[40:41], v[40:41], v[64:65]
    v_pk_add_f32 v[42:43], v[42:43], v[80:81]
    v_pk_add_f32 v[40:41], v[40:41], v[66:67]
    v_pk_add_f32 v[42:43], v[42:43], v[82:83]
    v_pk_add_f32 v[40:41], v[40:41], v[68:69]
    v_pk_add_f32 v[42:43], v[42:43], v[84:85]
    v_pk_add_f32 v[40:41], v[40:41], v[70:71]
    v_pk_add_f32 v[42:43], v[42:43], v[86:87]
    v_pk_add_f32 v[40:41], v[40:41], v[72:73]
    v_pk_add_f32 v[42:43], v[42:43], v[88:89]
    v_pk_add_f32 v[40:41], v[40:41], v[74:75]
    v_pk_add_f32 v[42:43], v[42:43], v[90:91]
    v_add_f32 v40, v40, v41
    v_add_f32 v42, v42, v43
    s_nop 1
    v_permlane32_swap_b32 v40, v42
    v_add_f32 v40, v40, v42
    v_rcp_f32 v40, v40
    s_nop 0
    v_mov_b32 v42, v40
    s_nop 1
    v_permlane32_swap_b32 v40, v42
    v_pk_mul_f32 v[60:61], v[60:61], v[40:41] op_sel_hi:[1,0]
    v_pk_mul_f32 v[62:63], v[62:63], v[40:41] op_sel_hi:[1,0]
    v_pk_mul_f32 v[64:65], v[64:65], v[40:41] op_sel_hi:[1,0]
    v_pk_mul_f32 v[66:67], v[66:67], v[40:41] op_sel_hi:[1,0]
    v_cvt_pk_bf16_f32 v176, v60, v61
    v_cvt_pk_bf16_f32 v177, v62, v63
    v_cvt_pk_bf16_f32 v178, v64, v65
    v_cvt_pk_bf16_f32 v179, v66, v67
    ds_write_b128 v112, v[176:179] offset:4096
    v_pk_mul_f32 v[68:69], v[68:69], v[40:41] op_sel_hi:[1,0]
    v_pk_mul_f32 v[70:71], v[70:71], v[40:41] op_sel_hi:[1,0]
    v_pk_mul_f32 v[72:73], v[72:73], v[40:41] op_sel_hi:[1,0]
    v_pk_mul_f32 v[74:75], v[74:75], v[40:41] op_sel_hi:[1,0]
    v_cvt_pk_bf16_f32 v180, v68, v69
    v_cvt_pk_bf16_f32 v181, v70, v71
    v_cvt_pk_bf16_f32 v182, v72, v73
    v_cvt_pk_bf16_f32 v183, v74, v75
    ds_write_b128 v113, v[180:183] offset:4096
    v_pk_mul_f32 v[76:77], v[76:77], v[42:43] op_sel_hi:[1,0]
    v_pk_mul_f32 v[78:79], v[78:79], v[42:43] op_sel_hi:[1,0]
    v_pk_mul_f32 v[80:81], v[80:81], v[42:43] op_sel_hi:[1,0]
    v_pk_mul_f32 v[82:83], v[82:83], v[42:43] op_sel_hi:[1,0]
    v_cvt_pk_bf16_f32 v184, v76, v77
    v_cvt_pk_bf16_f32 v185, v78, v79
    v_cvt_pk_bf16_f32 v186, v80, v81
    v_cvt_pk_bf16_f32 v187, v82, v83
    ds_write_b128 v114, v[184:187] offset:4096
    v_pk_mul_f32 v[84:85], v[84:85], v[42:43] op_sel_hi:[1,0]
    v_pk_mul_f32 v[86:87], v[86:87], v[42:43] op_sel_hi:[1,0]
    v_pk_mul_f32 v[88:89], v[88:89], v[42:43] op_sel_hi:[1,0]
    v_pk_mul_f32 v[90:91], v[90:91], v[42:43] op_sel_hi:[1,0]
    v_cvt_pk_bf16_f32 v188, v84, v85
    v_cvt_pk_bf16_f32 v189, v86, v87
    v_cvt_pk_bf16_f32 v190, v88, v89
    v_cvt_pk_bf16_f32 v191, v90, v91
    ds_write_b128 v115, v[188:191] offset:4096
    s_waitcnt lgkmcnt(0)
    s_barrier
    s_setprio 0
    v_lshlrev_b32 v14, 4, v2
    buffer_load_dwordx4 v[60:63], v14, s[64:67], 0 offen
    buffer_load_dwordx4 v[64:67], v14, s[64:67], 0 offen offset:1024
    v_mfma_f32_16x16x16_bf16 v[128:131], v[16:17], v[104:105], v[128:131]
    v_mfma_f32_16x16x16_bf16 v[144:147], v[18:19], v[104:105], v[144:147]
    v_mfma_f32_16x16x16_bf16 v[132:135], v[16:17], v[106:107], v[132:135]
    v_mfma_f32_16x16x16_bf16 v[148:151], v[18:19], v[106:107], v[148:151]
    v_mfma_f32_16x16x16_bf16 v[136:139], v[16:17], v[108:109], v[136:139]
    v_mfma_f32_16x16x16_bf16 v[152:155], v[18:19], v[108:109], v[152:155]
    v_mfma_f32_16x16x16_bf16 v[140:143], v[16:17], v[110:111], v[140:143]
    v_mfma_f32_16x16x16_bf16 v[156:159], v[18:19], v[110:111], v[156:159]
    v_lshrrev_b32 v10, 5, v2
    s_lshl_b32 s78, s81, 7
    s_add_u32 s78, s78, 162944
    v_lshl_add_u32 v10, v10, 4, s78
    v_and_b32 v13, 1, v2
    v_cmp_eq_u32 vcc, 1, v13
    v_mov_b32 v13, 162816
    s_nop 0
    v_cndmask_b32 v10, v10, v13, vcc
    v_lshrrev_b32 v11, 5, v2
    v_and_b32 v12, 31, v2
    v_lshlrev_b32_e64 v12, 4, v12
    v_lshl_add_u32 v11, v11, 10, v12
    v_bfe_u32 v12, v2, 4, 1
    v_lshlrev_b32 v12, 15, v12
    v_lshrrev_b32 v13, 5, v2
    v_lshl_add_u32 v12, v13, 8, v12
    v_lshl_add_u32 v12, v8, 4, v12
    v_cvt_pk_bf16_f32 v128, v128, v129
    v_cvt_pk_bf16_f32 v129, v130, v131
    v_cvt_pk_bf16_f32 v130, v144, v145
    v_cvt_pk_bf16_f32 v131, v146, v147
    v_cvt_pk_bf16_f32 v132, v132, v133
    v_cvt_pk_bf16_f32 v133, v134, v135
    v_cvt_pk_bf16_f32 v134, v148, v149
    v_cvt_pk_bf16_f32 v135, v150, v151
    v_cvt_pk_bf16_f32 v136, v136, v137
    v_cvt_pk_bf16_f32 v137, v138, v139
    v_cvt_pk_bf16_f32 v138, v152, v153
    v_cvt_pk_bf16_f32 v139, v154, v155
    v_cvt_pk_bf16_f32 v140, v140, v141
    v_cvt_pk_bf16_f32 v141, v142, v143
    v_cvt_pk_bf16_f32 v142, v156, v157
    v_cvt_pk_bf16_f32 v143, v158, v159
    v_permlane16_swap_b32 v128, v132
    v_permlane16_swap_b32 v129, v133
    v_permlane16_swap_b32 v130, v134
    v_permlane16_swap_b32 v131, v135
    v_permlane16_swap_b32 v136, v140
    v_permlane16_swap_b32 v137, v141
    v_permlane16_swap_b32 v138, v142
    v_permlane16_swap_b32 v139, v143
    v_mfma_f32_32x32x16_bf16 v[224:239], v[96:99], v[128:131], 0
    v_mfma_f32_32x32x16_bf16 v[224:239], v[100:103], v[132:135], v[224:239]
    v_mfma_f32_32x32x16_bf16 v[240:255], v[96:99], v[136:139], 0
    v_mfma_f32_32x32x16_bf16 v[240:255], v[100:103], v[140:143], v[240:255]
    v_bfe_u32 v16, v2, 2, 2
    v_and_b32 v17, 3, v2
    v_and_b32 v18, 1, v9
    v_lshrrev_b32_e64 v19, 1, v9
    v_lshl_add_u32 v20, v18, 2, v16
    v_lshrrev_b32_e64 v21, 1, v20
    v_lshl_add_u32 v20, v19, 4, v20
    v_lshlrev_b32_e64 v20, 7, v20
    v_lshl_add_u32 v20, v17, 3, v20
    s_and_b32 s82, s72, 3
    s_lshl_b32 s78, s82, 15
    v_add_u32 v20, s78, v20
    v_xor_b32 v22, 0, v21
    v_lshl_add_u32 v4, v22, 5, v20
    v_xor_b32_e64 v22, 1, v21
    v_lshl_add_u32 v5, v22, 5, v20
    v_xor_b32_e64 v22, 2, v21
    v_lshl_add_u32 v6, v22, 5, v20
    v_xor_b32_e64 v22, 3, v21
    v_lshl_add_u32 v7, v22, 5, v20
    s_lshl_b32 s78, s76, 12
    s_add_u32 s78, s78, 131072
    v_lshl_add_u32 v20, v8, 7, s78
    v_lshl_add_u32 v20, v18, 3, v20
    v_lshrrev_b32 v21, 1, v8
    v_xor_b32 v21, v21, v19
    v_xor_b32 v22, 0, v21
    v_lshl_add_u32 v112, v22, 4, v20
    v_xor_b32_e64 v22, 2, v21
    v_lshl_add_u32 v113, v22, 4, v20
    v_xor_b32_e64 v22, 4, v21
    v_lshl_add_u32 v114, v22, 4, v20
    v_xor_b32_e64 v22, 6, v21
    v_lshl_add_u32 v115, v22, 4, v20
    v_add_u32 v15, 32768, v14
    s_lshl_b32 s83, s71, 2
    s_add_u32 s83, s83, s76
    s_lshl_b32 s83, s83, 16
    s_add_u32 s83, s83, 4194304
    s_lshl_b32 s88, s82, 13
    s_add_u32 s88, s88, s83
    s_nop 0
    s_add_u32 s89, s88, 4096
    v_max3_f32 v36, v224, v225, v226
    v_max3_f32 v38, -v224, -v225, -v226
    v_max3_f32 v36, v36, v227, v228
    v_max3_f32 v38, v38, -v227, -v228
    v_max3_f32 v36, v36, v229, v230
    v_max3_f32 v38, v38, -v229, -v230
    v_max3_f32 v36, v36, v231, v232
    v_max3_f32 v38, v38, -v231, -v232
    v_max3_f32 v36, v36, v233, v234
    v_max3_f32 v38, v38, -v233, -v234
    v_max3_f32 v36, v36, v235, v236
    v_max3_f32 v38, v38, -v235, -v236
    v_max3_f32 v36, v36, v237, v238
    v_max3_f32 v38, v38, -v237, -v238
    v_max_f32_e64 v36, v36, v239
    v_max_f32 v38, v38, -v239
    v_max3_f32 v37, v240, v241, v242
    v_max3_f32 v39, -v240, -v241, -v242
    v_max3_f32 v37, v37, v243, v244
    v_max3_f32 v39, v39, -v243, -v244
    v_max3_f32 v37, v37, v245, v246
    v_max3_f32 v39, v39, -v245, -v246
    v_max3_f32 v37, v37, v247, v248
    v_max3_f32 v39, v39, -v247, -v248
    v_max3_f32 v37, v37, v249, v250
    v_max3_f32 v39, v39, -v249, -v250
    v_max3_f32 v37, v37, v251, v252
    v_max3_f32 v39, v39, -v251, -v252
    v_max3_f32 v37, v37, v253, v254
    v_max3_f32 v39, v39, -v253, -v254
    v_max_f32_e64 v37, v37, v255
    v_max_f32 v39, v39, -v255
    v_permlane32_swap_b32 v36, v38
    s_nop 0
    v_permlane32_swap_b32 v37, v39
    v_max_f32 v36, v36, v38
    v_max_f32_e64 v37, v37, v39
    v_mul_f32 v36, -v36, v34
    v_mul_f32 v37, -v37, v48
    v_mov_b32 v38, v36
    v_mov_b32 v39, v37
    s_nop 0
    v_permlane32_swap_b32 v36, v38
    v_permlane32_swap_b32_e64 v37, v39
    v_pk_fma_f32 v[160:161], v[224:225], v[34:35], v[36:37] op_sel_hi:[1,0,0]
    v_pk_fma_f32 v[162:163], v[226:227], v[34:35], v[36:37] op_sel_hi:[1,0,0]
    v_pk_fma_f32 v[164:165], v[228:229], v[34:35], v[36:37] op_sel_hi:[1,0,0]
    v_pk_fma_f32 v[166:167], v[230:231], v[34:35], v[36:37] op_sel_hi:[1,0,0]
    v_pk_fma_f32 v[168:169], v[232:233], v[34:35], v[36:37] op_sel_hi:[1,0,0]
    v_pk_fma_f32 v[170:171], v[234:235], v[34:35], v[36:37] op_sel_hi:[1,0,0]
    v_pk_fma_f32 v[172:173], v[236:237], v[34:35], v[36:37] op_sel_hi:[1,0,0]
    v_pk_fma_f32 v[174:175], v[238:239], v[34:35], v[36:37] op_sel_hi:[1,0,0]
    v_pk_fma_f32 v[176:177], v[224:225], v[34:35], v[38:39] op_sel_hi:[1,0,0] neg_lo:[1,0,0] neg_hi:[1,0,0]
    v_pk_fma_f32 v[178:179], v[226:227], v[34:35], v[38:39] op_sel_hi:[1,0,0] neg_lo:[1,0,0] neg_hi:[1,0,0]
    v_pk_fma_f32 v[180:181], v[228:229], v[34:35], v[38:39] op_sel_hi:[1,0,0] neg_lo:[1,0,0] neg_hi:[1,0,0]
    v_pk_fma_f32 v[182:183], v[230:231], v[34:35], v[38:39] op_sel_hi:[1,0,0] neg_lo:[1,0,0] neg_hi:[1,0,0]
    v_pk_fma_f32 v[184:185], v[232:233], v[34:35], v[38:39] op_sel_hi:[1,0,0] neg_lo:[1,0,0] neg_hi:[1,0,0]
    v_pk_fma_f32 v[186:187], v[234:235], v[34:35], v[38:39] op_sel_hi:[1,0,0] neg_lo:[1,0,0] neg_hi:[1,0,0]
    v_pk_fma_f32 v[188:189], v[236:237], v[34:35], v[38:39] op_sel_hi:[1,0,0] neg_lo:[1,0,0] neg_hi:[1,0,0]
    v_pk_fma_f32 v[190:191], v[238:239], v[34:35], v[38:39] op_sel_hi:[1,0,0] neg_lo:[1,0,0] neg_hi:[1,0,0]
    v_exp_f32 v160, v160
    v_exp_f32 v161, v161
    v_exp_f32 v162, v162
    v_exp_f32 v163, v163
    v_exp_f32 v164, v164
    v_exp_f32 v165, v165
    v_exp_f32 v166, v166
    v_exp_f32 v167, v167
    v_exp_f32 v168, v168
    v_exp_f32 v169, v169
    v_exp_f32 v170, v170
    v_exp_f32 v171, v171
    v_exp_f32 v172, v172
    v_exp_f32 v173, v173
    v_exp_f32 v174, v174
    v_exp_f32 v175, v175
    v_exp_f32 v176, v176
    v_exp_f32 v177, v177
    v_exp_f32 v178, v178
    v_exp_f32 v179, v179
    v_exp_f32 v180, v180
    v_exp_f32 v181, v181
    v_exp_f32 v182, v182
    v_exp_f32 v183, v183
    v_exp_f32 v184, v184
    v_exp_f32 v185, v185
    v_exp_f32 v186, v186
    v_exp_f32 v187, v187
    v_exp_f32 v188, v188
    v_exp_f32 v189, v189
    v_exp_f32 v190, v190
    v_exp_f32 v191, v191
    v_cvt_pk_bf16_f32 v128, v160, v161
    v_cvt_pk_bf16_f32 v129, v162, v163
    v_cvt_pk_bf16_f32 v130, v164, v165
    v_cvt_pk_bf16_f32 v131, v166, v167
    v_cvt_pk_bf16_f32 v132, v168, v169
    v_cvt_pk_bf16_f32 v133, v170, v171
    v_cvt_pk_bf16_f32 v134, v172, v173
    v_cvt_pk_bf16_f32 v135, v174, v175
    v_cvt_pk_bf16_f32 v136, v176, v177
    v_cvt_pk_bf16_f32 v137, v178, v179
    v_cvt_pk_bf16_f32 v138, v180, v181
    v_cvt_pk_bf16_f32 v139, v182, v183
    v_cvt_pk_bf16_f32 v140, v184, v185
    v_cvt_pk_bf16_f32 v141, v186, v187
    v_cvt_pk_bf16_f32 v142, v188, v189
    v_cvt_pk_bf16_f32 v143, v190, v191
    v_pk_fma_f32 v[192:193], v[240:241], v[48:49], v[36:37] op_sel:[0,0,1] op_sel_hi:[1,0,1]
    v_pk_fma_f32 v[194:195], v[242:243], v[48:49], v[36:37] op_sel:[0,0,1] op_sel_hi:[1,0,1]
    v_pk_fma_f32 v[196:197], v[244:245], v[48:49], v[36:37] op_sel:[0,0,1] op_sel_hi:[1,0,1]
    v_pk_fma_f32 v[198:199], v[246:247], v[48:49], v[36:37] op_sel:[0,0,1] op_sel_hi:[1,0,1]
    v_pk_fma_f32 v[200:201], v[248:249], v[48:49], v[36:37] op_sel:[0,0,1] op_sel_hi:[1,0,1]
    v_pk_fma_f32 v[202:203], v[250:251], v[48:49], v[36:37] op_sel:[0,0,1] op_sel_hi:[1,0,1]
    v_pk_fma_f32 v[204:205], v[252:253], v[48:49], v[36:37] op_sel:[0,0,1] op_sel_hi:[1,0,1]
    v_pk_fma_f32 v[206:207], v[254:255], v[48:49], v[36:37] op_sel:[0,0,1] op_sel_hi:[1,0,1]
    v_pk_fma_f32 v[208:209], v[240:241], v[48:49], v[38:39] op_sel:[0,0,1] op_sel_hi:[1,0,1] neg_lo:[1,0,0] neg_hi:[1,0,0]
    v_pk_fma_f32 v[210:211], v[242:243], v[48:49], v[38:39] op_sel:[0,0,1] op_sel_hi:[1,0,1] neg_lo:[1,0,0] neg_hi:[1,0,0]
    v_pk_fma_f32 v[212:213], v[244:245], v[48:49], v[38:39] op_sel:[0,0,1] op_sel_hi:[1,0,1] neg_lo:[1,0,0] neg_hi:[1,0,0]
    v_pk_fma_f32 v[214:215], v[246:247], v[48:49], v[38:39] op_sel:[0,0,1] op_sel_hi:[1,0,1] neg_lo:[1,0,0] neg_hi:[1,0,0]
    v_pk_fma_f32 v[216:217], v[248:249], v[48:49], v[38:39] op_sel:[0,0,1] op_sel_hi:[1,0,1] neg_lo:[1,0,0] neg_hi:[1,0,0]
    v_pk_fma_f32 v[218:219], v[250:251], v[48:49], v[38:39] op_sel:[0,0,1] op_sel_hi:[1,0,1] neg_lo:[1,0,0] neg_hi:[1,0,0]
    v_pk_fma_f32 v[220:221], v[252:253], v[48:49], v[38:39] op_sel:[0,0,1] op_sel_hi:[1,0,1] neg_lo:[1,0,0] neg_hi:[1,0,0]
    v_pk_fma_f32 v[222:223], v[254:255], v[48:49], v[38:39] op_sel:[0,0,1] op_sel_hi:[1,0,1] neg_lo:[1,0,0] neg_hi:[1,0,0]
    v_exp_f32 v192, v192
    v_exp_f32 v193, v193
    v_exp_f32 v194, v194
    v_exp_f32 v195, v195
    v_exp_f32 v196, v196
    v_exp_f32 v197, v197
    v_exp_f32 v198, v198
    v_exp_f32 v199, v199
    v_exp_f32 v200, v200
    v_exp_f32 v201, v201
    v_exp_f32 v202, v202
    v_exp_f32 v203, v203
    v_exp_f32 v204, v204
    v_exp_f32 v205, v205
    v_exp_f32 v206, v206
    v_exp_f32 v207, v207
    v_exp_f32 v208, v208
    v_exp_f32 v209, v209
    v_exp_f32 v210, v210
    v_exp_f32 v211, v211
    v_exp_f32 v212, v212
    v_exp_f32 v213, v213
    v_exp_f32 v214, v214
    v_exp_f32 v215, v215
    v_exp_f32 v216, v216
    v_exp_f32 v217, v217
    v_exp_f32 v218, v218
    v_exp_f32 v219, v219
    v_exp_f32 v220, v220
    v_exp_f32 v221, v221
    v_exp_f32 v222, v222
    v_exp_f32 v223, v223
    v_cvt_pk_bf16_f32 v144, v192, v193
    v_cvt_pk_bf16_f32 v145, v194, v195
    v_cvt_pk_bf16_f32 v146, v196, v197
    v_cvt_pk_bf16_f32 v147, v198, v199
    v_cvt_pk_bf16_f32 v148, v200, v201
    v_cvt_pk_bf16_f32 v149, v202, v203
    v_cvt_pk_bf16_f32 v150, v204, v205
    v_cvt_pk_bf16_f32 v151, v206, v207
    v_cvt_pk_bf16_f32 v152, v208, v209
    v_cvt_pk_bf16_f32 v153, v210, v211
    v_cvt_pk_bf16_f32 v154, v212, v213
    v_cvt_pk_bf16_f32 v155, v214, v215
    v_cvt_pk_bf16_f32 v156, v216, v217
    v_cvt_pk_bf16_f32 v157, v218, v219
    v_cvt_pk_bf16_f32 v158, v220, v221
    v_cvt_pk_bf16_f32 v159, v222, v223
    v_lshlrev_b32_e64 v44, 16, v118
    v_and_b32 v45, 0xffff0000, v118
    v_lshlrev_b32_e64 v46, 16, v119
    v_and_b32 v47, 0xffff0000, v119
    v_lshlrev_b32_e64 v48, 16, v120
    v_and_b32 v49, 0xffff0000, v120
    v_lshlrev_b32_e64 v50, 16, v121
    v_and_b32 v51, 0xffff0000, v121
    v_lshlrev_b32_e64 v52, 16, v122
    v_and_b32 v53, 0xffff0000, v122
    v_lshlrev_b32_e64 v54, 16, v123
    v_and_b32 v55, 0xffff0000, v123
    v_lshlrev_b32_e64 v56, 16, v124
    v_and_b32 v57, 0xffff0000, v124
    v_lshlrev_b32_e64 v58, 16, v125
    v_and_b32 v59, 0xffff0000, v125
    s_mov_b32 s78, 0x3f803f80
    s_waitcnt vmcnt(0)
    s_nop 0
    v_dot2_f32_bf16 v126, v60, s78, 0
    v_dot2_f32_bf16 v126, v61, s78, v126
    v_dot2_f32_bf16 v126, v62, s78, v126
    v_dot2_f32_bf16 v126, v63, s78, v126
    v_dot2_f32_bf16 v126, v64, s78, v126
    v_dot2_f32_bf16 v126, v65, s78, v126
    v_dot2_f32_bf16 v126, v66, s78, v126
    v_dot2_f32_bf16 v126, v67, s78, v126
    s_nop 2
    v_add_f32_dpp v126, v126, v126 row_ror:8 row_mask:0xf bank_mask:0xf
    s_nop 1
    v_add_f32_dpp v126, v126, v126 row_ror:4 row_mask:0xf bank_mask:0xf
    s_nop 1
    v_add_f32_dpp v126, v126, v126 row_ror:2 row_mask:0xf bank_mask:0xf
    s_nop 1
    v_add_f32_dpp v126, v126, v126 row_ror:1 row_mask:0xf bank_mask:0xf
    v_mov_b32 v127, v126
    s_nop 1
    v_permlane32_swap_b32 v126, v127
    v_add_f32 v126, v126, v127
    v_mov_b32 v127, v126
    s_nop 1
    v_permlane16_swap_b32 v126, v127
    v_add_f32_e64 v126, v126, v127
    s_lshl_b32 s94, s70, 14
    s_lshl_b32 s79, s81, 13
    s_add_u32 s94, s94, s79
    s_add_u32 s94, s94, 8388608
    s_add_u32 s95, s94, 4096
    s_lshl_b32 s78, s69, 3
    s_lshl_b32 s79, s80, 2
    s_add_u32 s78, s78, s79
    s_lshl_b32 s78, s78, 5
    s_lshl_b32 s79, s70, 1
    s_add_u32 s78, s78, s79
    s_add_u32 s78, s78, s81
    s_lshl_b32 s78, s78, 10
    s_add_u32 s96, s78, 4194304
    s_add_u32 s97, s96, 65536
    s_barrier
    s_setprio 1
    ds_read_b128 v[16:19], v10 offset:0
    ds_read_b128 v[20:23], v10 offset:32
    ds_read_b128 v[24:27], v10 offset:64
    ds_read_b128 v[28:31], v10 offset:96
    s_waitcnt lgkmcnt(3)
    v_mfma_f32_32x32x16_bf16 v[60:75], v[16:19], v[128:131], 0
    s_waitcnt lgkmcnt(2)
    v_mfma_f32_32x32x16_bf16 v[60:75], v[20:23], v[132:135], v[60:75]
    s_waitcnt lgkmcnt(1)
    v_mfma_f32_32x32x16_bf16 v[76:91], v[24:27], v[136:139], 0
    s_waitcnt lgkmcnt(0)
    v_mfma_f32_32x32x16_bf16 v[76:91], v[28:31], v[140:143], v[76:91]
    v_mfma_f32_32x32x16_bf16 v[224:239], v[16:19], v[144:147], 0
    v_mfma_f32_32x32x16_bf16 v[224:239], v[20:23], v[148:151], v[224:239]
    v_mfma_f32_32x32x16_bf16 v[240:255], v[24:27], v[152:155], 0
    v_mfma_f32_32x32x16_bf16 v[240:255], v[28:31], v[156:159], v[240:255]
    s_nop 3
    v_rcp_f32 v36, v61
    s_nop 2
    v_rcp_f32 v38, v77
    v_mov_b32 v40, 0x358637bd
    v_fmac_f32 v40, v60, v36
    v_fmac_f32 v40, v76, v38
    v_rcp_f32 v40, v40
    s_nop 0
    v_mul_f32 v36, v36, v40
    v_mul_f32 v38, v38, v40
    v_pk_mul_f32 v[160:161], v[160:161], v[36:37] op_sel_hi:[1,0]
    v_pk_mul_f32 v[162:163], v[162:163], v[36:37] op_sel_hi:[1,0]
    v_pk_mul_f32 v[164:165], v[164:165], v[36:37] op_sel_hi:[1,0]
    v_pk_mul_f32 v[166:167], v[166:167], v[36:37] op_sel_hi:[1,0]
    v_pk_mul_f32 v[168:169], v[168:169], v[36:37] op_sel_hi:[1,0]
    v_pk_mul_f32 v[170:171], v[170:171], v[36:37] op_sel_hi:[1,0]
    v_pk_mul_f32 v[172:173], v[172:173], v[36:37] op_sel_hi:[1,0]
    v_pk_mul_f32 v[174:175], v[174:175], v[36:37] op_sel_hi:[1,0]
    v_pk_mul_f32 v[176:177], v[176:177], v[38:39] op_sel_hi:[1,0]
    v_pk_mul_f32 v[178:179], v[178:179], v[38:39] op_sel_hi:[1,0]
    v_pk_mul_f32 v[180:181], v[180:181], v[38:39] op_sel_hi:[1,0]
    v_pk_mul_f32 v[182:183], v[182:183], v[38:39] op_sel_hi:[1,0]
    v_pk_mul_f32 v[184:185], v[184:185], v[38:39] op_sel_hi:[1,0]
    v_pk_mul_f32 v[186:187], v[186:187], v[38:39] op_sel_hi:[1,0]
    v_pk_mul_f32 v[188:189], v[188:189], v[38:39] op_sel_hi:[1,0]
    v_pk_mul_f32 v[190:191], v[190:191], v[38:39] op_sel_hi:[1,0]
    v_cvt_pk_bf16_f32 v128, v160, v161
    v_cvt_pk_bf16_f32 v129, v162, v163
    v_cvt_pk_bf16_f32 v130, v164, v165
    v_cvt_pk_bf16_f32 v131, v166, v167
    v_cvt_pk_bf16_f32 v132, v168, v169
    v_cvt_pk_bf16_f32 v133, v170, v171
    v_cvt_pk_bf16_f32 v134, v172, v173
    v_cvt_pk_bf16_f32 v135, v174, v175
    v_cvt_pk_bf16_f32 v136, v176, v177
    v_cvt_pk_bf16_f32 v137, v178, v179
    v_cvt_pk_bf16_f32 v138, v180, v181
    v_cvt_pk_bf16_f32 v139, v182, v183
    v_cvt_pk_bf16_f32 v140, v184, v185
    v_cvt_pk_bf16_f32 v141, v186, v187
    v_cvt_pk_bf16_f32 v142, v188, v189
    v_cvt_pk_bf16_f32 v143, v190, v191
    v_rcp_f32 v36, v225
    v_rcp_f32 v38, v241
    v_mov_b32 v40, 0x358637bd
    v_fmac_f32 v40, v224, v36
    v_fmac_f32 v40, v240, v38
    v_rcp_f32 v40, v40
    s_nop 0
    v_mul_f32 v36, v36, v40
    v_mul_f32 v38, v38, v40
    buffer_load_dwordx4 v[96:99], v11, s[36:39], s94 offen offset:0 sc1
    buffer_load_dwordx4 v[100:103], v11, s[36:39], s94 offen offset:2048 sc1
    buffer_load_dwordx4 v[104:107], v11, s[36:39], s95 offen offset:0 sc1
    buffer_load_dwordx4 v[108:111], v11, s[36:39], s95 offen offset:2048 sc1
    v_pk_mul_f32 v[192:193], v[192:193], v[36:37] op_sel_hi:[1,0]
    v_pk_mul_f32 v[194:195], v[194:195], v[36:37] op_sel_hi:[1,0]
    v_pk_mul_f32 v[196:197], v[196:197], v[36:37] op_sel_hi:[1,0]
    v_pk_mul_f32 v[198:199], v[198:199], v[36:37] op_sel_hi:[1,0]
    v_pk_mul_f32 v[200:201], v[200:201], v[36:37] op_sel_hi:[1,0]
    v_pk_mul_f32 v[202:203], v[202:203], v[36:37] op_sel_hi:[1,0]
    v_pk_mul_f32 v[204:205], v[204:205], v[36:37] op_sel_hi:[1,0]
    v_pk_mul_f32 v[206:207], v[206:207], v[36:37] op_sel_hi:[1,0]
    v_pk_mul_f32 v[208:209], v[208:209], v[38:39] op_sel_hi:[1,0]
    v_pk_mul_f32 v[210:211], v[210:211], v[38:39] op_sel_hi:[1,0]
    v_pk_mul_f32 v[212:213], v[212:213], v[38:39] op_sel_hi:[1,0]
    v_pk_mul_f32 v[214:215], v[214:215], v[38:39] op_sel_hi:[1,0]
    v_pk_mul_f32 v[216:217], v[216:217], v[38:39] op_sel_hi:[1,0]
    v_pk_mul_f32 v[218:219], v[218:219], v[38:39] op_sel_hi:[1,0]
    v_pk_mul_f32 v[220:221], v[220:221], v[38:39] op_sel_hi:[1,0]
    v_pk_mul_f32 v[222:223], v[222:223], v[38:39] op_sel_hi:[1,0]
    v_cvt_pk_bf16_f32 v144, v192, v193
    v_cvt_pk_bf16_f32 v145, v194, v195
    v_cvt_pk_bf16_f32 v146, v196, v197
    v_cvt_pk_bf16_f32 v147, v198, v199
    v_cvt_pk_bf16_f32 v148, v200, v201
    v_cvt_pk_bf16_f32 v149, v202, v203
    v_cvt_pk_bf16_f32 v150, v204, v205
    v_cvt_pk_bf16_f32 v151, v206, v207
    v_cvt_pk_bf16_f32 v152, v208, v209
    v_cvt_pk_bf16_f32 v153, v210, v211
    v_cvt_pk_bf16_f32 v154, v212, v213
    v_cvt_pk_bf16_f32 v155, v214, v215
    v_cvt_pk_bf16_f32 v156, v216, v217
    v_cvt_pk_bf16_f32 v157, v218, v219
    v_cvt_pk_bf16_f32 v158, v220, v221
    v_cvt_pk_bf16_f32 v159, v222, v223
    s_barrier
    s_mov_b32 s85, 0
    s_branch L_kvchk
L_kvspin:
    s_add_u32 s85, s85, 1
    s_cmp_gt_u32 s85, 400000
    s_cbranch_scc1 L_end
    buffer_load_dwordx4 v[96:99], v11, s[36:39], s94 offen offset:0 sc1
    buffer_load_dwordx4 v[100:103], v11, s[36:39], s94 offen offset:2048 sc1
    buffer_load_dwordx4 v[104:107], v11, s[36:39], s95 offen offset:0 sc1
    buffer_load_dwordx4 v[108:111], v11, s[36:39], s95 offen offset:2048 sc1
L_kvchk:
    s_waitcnt vmcnt(0)
    v_max3_u32 v13, v96, v97, v98
    v_max3_u32 v10, v99, v100, v101
    v_max3_u32 v13, v13, v102, v103
    v_max3_u32 v10, v10, v104, v105
    v_max3_u32 v13, v13, v106, v107
    v_max3_u32 v10, v10, v108, v109
    v_max3_u32 v13, v13, v110, v111
    v_max_u32 v13, v13, v10
    v_cmp_eq_u32_e64 vcc, -1, v13
    s_cbranch_vccnz L_kvspin
    v_mfma_f32_32x32x16_bf16 v[60:75], v[96:99], v[128:131], 0
    v_mfma_f32_32x32x16_bf16 v[60:75], v[100:103], v[132:135], v[60:75]
    v_mfma_f32_32x32x16_bf16 v[60:75], v[104:107], v[136:139], v[60:75]
    v_mfma_f32_32x32x16_bf16 v[60:75], v[108:111], v[140:143], v[60:75]
    v_mfma_f32_32x32x16_bf16 v[76:91], v[96:99], v[144:147], 0
    v_mfma_f32_32x32x16_bf16 v[76:91], v[100:103], v[148:151], v[76:91]
    v_mfma_f32_32x32x16_bf16 v[76:91], v[104:107], v[152:155], v[76:91]
    v_mfma_f32_32x32x16_bf16 v[76:91], v[108:111], v[156:159], v[76:91]
    s_nop 7
    s_nop 0
    v_cvt_pk_bf16_f32 v16, v60, v61
    v_cvt_pk_bf16_f32 v17, v62, v63
    v_cvt_pk_bf16_f32 v18, v64, v65
    v_cvt_pk_bf16_f32 v19, v66, v67
    buffer_store_dwordx4 v[16:19], v12, s[36:39], s96 offen offset:0 sc1
    v_cvt_pk_bf16_f32 v20, v68, v69
    v_cvt_pk_bf16_f32 v21, v70, v71
    v_cvt_pk_bf16_f32 v22, v72, v73
    v_cvt_pk_bf16_f32 v23, v74, v75
    buffer_store_dwordx4 v[20:23], v12, s[36:39], s96 offen offset:512 sc1
    v_cvt_pk_bf16_f32 v24, v76, v77
    v_cvt_pk_bf16_f32 v25, v78, v79
    v_cvt_pk_bf16_f32 v26, v80, v81
    v_cvt_pk_bf16_f32 v27, v82, v83
    buffer_store_dwordx4 v[24:27], v12, s[36:39], s97 offen offset:0 sc1
    v_cvt_pk_bf16_f32 v28, v84, v85
    v_cvt_pk_bf16_f32 v29, v86, v87
    v_cvt_pk_bf16_f32 v30, v88, v89
    v_cvt_pk_bf16_f32 v31, v90, v91
    buffer_store_dwordx4 v[28:31], v12, s[36:39], s97 offen offset:512 sc1
    s_barrier
    s_nop 0
    ds_read_b64 v[96:97], v112 offset:0
    ds_read_b64 v[98:99], v112 offset:2048
    ds_read_b64 v[100:101], v113 offset:0
    ds_read_b64 v[102:103], v113 offset:2048
    ds_read_b64 v[104:105], v114 offset:0
    ds_read_b64 v[106:107], v114 offset:2048
    ds_read_b64 v[108:109], v115 offset:0
    ds_read_b64 v[110:111], v115 offset:2048
    s_waitcnt lgkmcnt(0)
    s_nop 0
    ds_read_b64_tr_b16 v[128:129], v4 offset:0
    ds_read_b64_tr_b16 v[130:131], v4 offset:1024
    ds_read_b64_tr_b16 v[132:133], v5 offset:0
    ds_read_b64_tr_b16 v[134:135], v5 offset:1024
    ds_read_b64_tr_b16 v[136:137], v6 offset:0
    ds_read_b64_tr_b16 v[138:139], v6 offset:1024
    ds_read_b64_tr_b16 v[140:141], v7 offset:0
    ds_read_b64_tr_b16 v[142:143], v7 offset:1024
    v_lshlrev_b32_e64 v224, 16, v96
    v_and_b32 v225, 0xffff0000, v96
    v_lshlrev_b32_e64 v226, 16, v97
    v_and_b32 v227, 0xffff0000, v97
    v_lshlrev_b32_e64 v228, 16, v98
    v_and_b32 v229, 0xffff0000, v98
    v_lshlrev_b32_e64 v230, 16, v99
    v_and_b32 v231, 0xffff0000, v99
    v_lshlrev_b32_e64 v232, 16, v100
    v_and_b32 v233, 0xffff0000, v100
    v_lshlrev_b32_e64 v234, 16, v101
    v_and_b32 v235, 0xffff0000, v101
    v_lshlrev_b32_e64 v236, 16, v102
    v_and_b32 v237, 0xffff0000, v102
    v_lshlrev_b32_e64 v238, 16, v103
    v_and_b32 v239, 0xffff0000, v103
    v_lshlrev_b32_e64 v240, 16, v104
    v_and_b32 v241, 0xffff0000, v104
    v_lshlrev_b32_e64 v242, 16, v105
    v_and_b32 v243, 0xffff0000, v105
    v_lshlrev_b32_e64 v244, 16, v106
    v_and_b32 v245, 0xffff0000, v106
    v_lshlrev_b32_e64 v246, 16, v107
    v_and_b32 v247, 0xffff0000, v107
    v_lshlrev_b32_e64 v248, 16, v108
    v_and_b32 v249, 0xffff0000, v108
    v_lshlrev_b32_e64 v250, 16, v109
    v_and_b32 v251, 0xffff0000, v109
    v_lshlrev_b32_e64 v252, 16, v110
    v_and_b32 v253, 0xffff0000, v110
    v_lshlrev_b32_e64 v254, 16, v111
    v_and_b32 v255, 0xffff0000, v111
    s_waitcnt vmcnt(0)
    s_barrier
    s_barrier
    s_nop 0
    buffer_load_dwordx4 v[160:163], v14, s[36:39], s88 offen offset:0 sc1
    buffer_load_dwordx4 v[164:167], v15, s[36:39], s88 offen offset:0 sc1
    buffer_load_dwordx4 v[168:171], v14, s[36:39], s88 offen offset:1024 sc1
    buffer_load_dwordx4 v[172:175], v15, s[36:39], s88 offen offset:1024 sc1
    buffer_load_dwordx4 v[176:179], v14, s[36:39], s88 offen offset:2048 sc1
    buffer_load_dwordx4 v[180:183], v15, s[36:39], s88 offen offset:2048 sc1
    buffer_load_dwordx4 v[184:187], v14, s[36:39], s88 offen offset:3072 sc1
    buffer_load_dwordx4 v[188:191], v15, s[36:39], s88 offen offset:3072 sc1
    buffer_load_dwordx4 v[192:195], v14, s[36:39], s89 offen offset:0 sc1
    buffer_load_dwordx4 v[196:199], v15, s[36:39], s89 offen offset:0 sc1
    buffer_load_dwordx4 v[200:203], v14, s[36:39], s89 offen offset:1024 sc1
    buffer_load_dwordx4 v[204:207], v15, s[36:39], s89 offen offset:1024 sc1
    buffer_load_dwordx4 v[208:211], v14, s[36:39], s89 offen offset:2048 sc1
    buffer_load_dwordx4 v[212:215], v15, s[36:39], s89 offen offset:2048 sc1
    s_mov_b32 s84, 0
    s_mov_b32 s85, 0
    .p2align 3
L_G2:
    s_mov_b32 s86, s88
    s_mov_b32 s87, s89
    s_add_u32 s82, s82, 1
    s_and_b32 s82, s82, 3
    s_lshl_b32 s88, s82, 13
    s_add_u32 s88, s88, s83
    s_add_u32 s84, s84, 1
    s_cmp_eq_u32 s84, 4
    s_cselect_b32 s88, 0x10000000, s88
    s_add_u32 s89, s88, 4096
    s_waitcnt vmcnt(12)
    s_waitcnt lgkmcnt(6)
    v_mfma_f32_16x16x32_bf16 v[224:227], v[128:131], v[160:163], v[224:227]
    ds_read_b64_tr_b16 v[144:145], v4 offset:4096
    buffer_load_dwordx4 v[216:219], v14, s[36:39], s87 offen offset:3072 sc1
    v_mfma_f32_16x16x32_bf16 v[228:231], v[128:131], v[164:167], v[228:231]
    ds_read_b64_tr_b16 v[146:147], v4 offset:5120
    s_waitcnt lgkmcnt(6)
    v_mfma_f32_16x16x32_bf16 v[236:239], v[132:135], v[164:167], v[236:239]
    ds_read_b64_tr_b16 v[148:149], v5 offset:4096
    v_mfma_f32_16x16x32_bf16 v[232:235], v[132:135], v[160:163], v[232:235]
    ds_read_b64_tr_b16 v[150:151], v5 offset:5120
    s_waitcnt lgkmcnt(6)
    v_mfma_f32_16x16x32_bf16 v[240:243], v[136:139], v[160:163], v[240:243]
    ds_read_b64_tr_b16 v[152:153], v6 offset:4096
    buffer_load_dwordx4 v[220:223], v15, s[36:39], s87 offen offset:3072 sc1
    v_mfma_f32_16x16x32_bf16 v[244:247], v[136:139], v[164:167], v[244:247]
    ds_read_b64_tr_b16 v[154:155], v6 offset:5120
    s_waitcnt lgkmcnt(6)
    v_mfma_f32_16x16x32_bf16 v[252:255], v[140:143], v[164:167], v[252:255]
    ds_read_b64_tr_b16 v[156:157], v7 offset:4096
    v_mfma_f32_16x16x32_bf16 v[248:251], v[140:143], v[160:163], v[248:251]
    ds_read_b64_tr_b16 v[158:159], v7 offset:5120
    s_cmp_lg_u32 s84, 4
    s_cbranch_scc1 L_G3
    s_barrier
L_G3:
    s_waitcnt vmcnt(12)
    s_waitcnt lgkmcnt(6)
    v_mfma_f32_16x16x32_bf16 v[224:227], v[144:147], v[168:171], v[224:227]
    ds_read_b64_tr_b16 v[128:129], v4 offset:8192
    buffer_load_dwordx4 v[160:163], v14, s[36:39], s88 offen offset:0 sc1
    v_mfma_f32_16x16x32_bf16 v[228:231], v[144:147], v[172:175], v[228:231]
    ds_read_b64_tr_b16 v[130:131], v4 offset:9216
    s_waitcnt lgkmcnt(6)
    v_mfma_f32_16x16x32_bf16 v[236:239], v[148:151], v[172:175], v[236:239]
    ds_read_b64_tr_b16 v[132:133], v5 offset:8192
    v_mfma_f32_16x16x32_bf16 v[232:235], v[148:151], v[168:171], v[232:235]
    ds_read_b64_tr_b16 v[134:135], v5 offset:9216
    s_waitcnt lgkmcnt(6)
    v_mfma_f32_16x16x32_bf16 v[240:243], v[152:155], v[168:171], v[240:243]
    ds_read_b64_tr_b16 v[136:137], v6 offset:8192
    buffer_load_dwordx4 v[164:167], v15, s[36:39], s88 offen offset:0 sc1
    v_mfma_f32_16x16x32_bf16 v[244:247], v[152:155], v[172:175], v[244:247]
    ds_read_b64_tr_b16 v[138:139], v6 offset:9216
    s_waitcnt lgkmcnt(6)
    v_mfma_f32_16x16x32_bf16 v[252:255], v[156:159], v[172:175], v[252:255]
    ds_read_b64_tr_b16 v[140:141], v7 offset:8192
    v_mfma_f32_16x16x32_bf16 v[248:251], v[156:159], v[168:171], v[248:251]
    ds_read_b64_tr_b16 v[142:143], v7 offset:9216
    s_waitcnt vmcnt(12)
    s_waitcnt lgkmcnt(6)
    v_mfma_f32_16x16x32_bf16 v[224:227], v[128:131], v[176:179], v[224:227]
    ds_read_b64_tr_b16 v[144:145], v4 offset:12288
    buffer_load_dwordx4 v[168:171], v14, s[36:39], s88 offen offset:1024 sc1
    v_mfma_f32_16x16x32_bf16 v[228:231], v[128:131], v[180:183], v[228:231]
    ds_read_b64_tr_b16 v[146:147], v4 offset:13312
    s_waitcnt lgkmcnt(6)
    v_mfma_f32_16x16x32_bf16 v[236:239], v[132:135], v[180:183], v[236:239]
    ds_read_b64_tr_b16 v[148:149], v5 offset:12288
    v_mfma_f32_16x16x32_bf16 v[232:235], v[132:135], v[176:179], v[232:235]
    ds_read_b64_tr_b16 v[150:151], v5 offset:13312
    s_waitcnt lgkmcnt(6)
    v_mfma_f32_16x16x32_bf16 v[240:243], v[136:139], v[176:179], v[240:243]
    ds_read_b64_tr_b16 v[152:153], v6 offset:12288
    buffer_load_dwordx4 v[172:175], v15, s[36:39], s88 offen offset:1024 sc1
    v_mfma_f32_16x16x32_bf16 v[244:247], v[136:139], v[180:183], v[244:247]
    ds_read_b64_tr_b16 v[154:155], v6 offset:13312
    s_waitcnt lgkmcnt(6)
    v_mfma_f32_16x16x32_bf16 v[252:255], v[140:143], v[180:183], v[252:255]
    ds_read_b64_tr_b16 v[156:157], v7 offset:12288
    v_mfma_f32_16x16x32_bf16 v[248:251], v[140:143], v[176:179], v[248:251]
    ds_read_b64_tr_b16 v[158:159], v7 offset:13312
    s_waitcnt vmcnt(12)
    s_waitcnt lgkmcnt(6)
    v_mfma_f32_16x16x32_bf16 v[224:227], v[144:147], v[184:187], v[224:227]
    ds_read_b64_tr_b16 v[128:129], v4 offset:16384
    buffer_load_dwordx4 v[176:179], v14, s[36:39], s88 offen offset:2048 sc1
    v_mfma_f32_16x16x32_bf16 v[228:231], v[144:147], v[188:191], v[228:231]
    ds_read_b64_tr_b16 v[130:131], v4 offset:17408
    s_waitcnt lgkmcnt(6)
    v_mfma_f32_16x16x32_bf16 v[236:239], v[148:151], v[188:191], v[236:239]
    ds_read_b64_tr_b16 v[132:133], v5 offset:16384
    v_mfma_f32_16x16x32_bf16 v[232:235], v[148:151], v[184:187], v[232:235]
    ds_read_b64_tr_b16 v[134:135], v5 offset:17408
    s_waitcnt lgkmcnt(6)
    v_mfma_f32_16x16x32_bf16 v[240:243], v[152:155], v[184:187], v[240:243]
    ds_read_b64_tr_b16 v[136:137], v6 offset:16384
    buffer_load_dwordx4 v[180:183], v15, s[36:39], s88 offen offset:2048 sc1
    v_mfma_f32_16x16x32_bf16 v[244:247], v[152:155], v[188:191], v[244:247]
    ds_read_b64_tr_b16 v[138:139], v6 offset:17408
    s_waitcnt lgkmcnt(6)
    v_mfma_f32_16x16x32_bf16 v[252:255], v[156:159], v[188:191], v[252:255]
    ds_read_b64_tr_b16 v[140:141], v7 offset:16384
    v_mfma_f32_16x16x32_bf16 v[248:251], v[156:159], v[184:187], v[248:251]
    ds_read_b64_tr_b16 v[142:143], v7 offset:17408
    s_waitcnt vmcnt(12)
    s_waitcnt lgkmcnt(6)
    v_mfma_f32_16x16x32_bf16 v[224:227], v[128:131], v[192:195], v[224:227]
    ds_read_b64_tr_b16 v[144:145], v4 offset:20480
    buffer_load_dwordx4 v[184:187], v14, s[36:39], s88 offen offset:3072 sc1
    v_mfma_f32_16x16x32_bf16 v[228:231], v[128:131], v[196:199], v[228:231]
    ds_read_b64_tr_b16 v[146:147], v4 offset:21504
    s_waitcnt lgkmcnt(6)
    v_mfma_f32_16x16x32_bf16 v[236:239], v[132:135], v[196:199], v[236:239]
    ds_read_b64_tr_b16 v[148:149], v5 offset:20480
    v_mfma_f32_16x16x32_bf16 v[232:235], v[132:135], v[192:195], v[232:235]
    ds_read_b64_tr_b16 v[150:151], v5 offset:21504
    s_waitcnt lgkmcnt(6)
    v_mfma_f32_16x16x32_bf16 v[240:243], v[136:139], v[192:195], v[240:243]
    ds_read_b64_tr_b16 v[152:153], v6 offset:20480
    buffer_load_dwordx4 v[188:191], v15, s[36:39], s88 offen offset:3072 sc1
    v_mfma_f32_16x16x32_bf16 v[244:247], v[136:139], v[196:199], v[244:247]
    ds_read_b64_tr_b16 v[154:155], v6 offset:21504
    s_waitcnt lgkmcnt(6)
    v_mfma_f32_16x16x32_bf16 v[252:255], v[140:143], v[196:199], v[252:255]
    ds_read_b64_tr_b16 v[156:157], v7 offset:20480
    v_mfma_f32_16x16x32_bf16 v[248:251], v[140:143], v[192:195], v[248:251]
    ds_read_b64_tr_b16 v[158:159], v7 offset:21504
    s_waitcnt vmcnt(12)
    s_waitcnt lgkmcnt(6)
    v_mfma_f32_16x16x32_bf16 v[224:227], v[144:147], v[200:203], v[224:227]
    ds_read_b64_tr_b16 v[128:129], v4 offset:24576
    buffer_load_dwordx4 v[192:195], v14, s[36:39], s89 offen offset:0 sc1
    v_mfma_f32_16x16x32_bf16 v[228:231], v[144:147], v[204:207], v[228:231]
    ds_read_b64_tr_b16 v[130:131], v4 offset:25600
    s_waitcnt lgkmcnt(6)
    v_mfma_f32_16x16x32_bf16 v[236:239], v[148:151], v[204:207], v[236:239]
    ds_read_b64_tr_b16 v[132:133], v5 offset:24576
    v_mfma_f32_16x16x32_bf16 v[232:235], v[148:151], v[200:203], v[232:235]
    ds_read_b64_tr_b16 v[134:135], v5 offset:25600
    s_waitcnt lgkmcnt(6)
    v_mfma_f32_16x16x32_bf16 v[240:243], v[152:155], v[200:203], v[240:243]
    ds_read_b64_tr_b16 v[136:137], v6 offset:24576
    buffer_load_dwordx4 v[196:199], v15, s[36:39], s89 offen offset:0 sc1
    v_mfma_f32_16x16x32_bf16 v[244:247], v[152:155], v[204:207], v[244:247]
    ds_read_b64_tr_b16 v[138:139], v6 offset:25600
    s_waitcnt lgkmcnt(6)
    v_mfma_f32_16x16x32_bf16 v[252:255], v[156:159], v[204:207], v[252:255]
    ds_read_b64_tr_b16 v[140:141], v7 offset:24576
    v_mfma_f32_16x16x32_bf16 v[248:251], v[156:159], v[200:203], v[248:251]
    ds_read_b64_tr_b16 v[142:143], v7 offset:25600
    s_waitcnt vmcnt(12)
    s_waitcnt lgkmcnt(6)
    v_mfma_f32_16x16x32_bf16 v[224:227], v[128:131], v[208:211], v[224:227]
    ds_read_b64_tr_b16 v[144:145], v4 offset:28672
    buffer_load_dwordx4 v[200:203], v14, s[36:39], s89 offen offset:1024 sc1
    v_mfma_f32_16x16x32_bf16 v[228:231], v[128:131], v[212:215], v[228:231]
    ds_read_b64_tr_b16 v[146:147], v4 offset:29696
    s_waitcnt lgkmcnt(6)
    v_mfma_f32_16x16x32_bf16 v[236:239], v[132:135], v[212:215], v[236:239]
    ds_read_b64_tr_b16 v[148:149], v5 offset:28672
    v_mfma_f32_16x16x32_bf16 v[232:235], v[132:135], v[208:211], v[232:235]
    ds_read_b64_tr_b16 v[150:151], v5 offset:29696
    s_waitcnt lgkmcnt(6)
    v_mfma_f32_16x16x32_bf16 v[240:243], v[136:139], v[208:211], v[240:243]
    ds_read_b64_tr_b16 v[152:153], v6 offset:28672
    buffer_load_dwordx4 v[204:207], v15, s[36:39], s89 offen offset:1024 sc1
    v_mfma_f32_16x16x32_bf16 v[244:247], v[136:139], v[212:215], v[244:247]
    ds_read_b64_tr_b16 v[154:155], v6 offset:29696
    s_waitcnt lgkmcnt(6)
    v_mfma_f32_16x16x32_bf16 v[252:255], v[140:143], v[212:215], v[252:255]
    ds_read_b64_tr_b16 v[156:157], v7 offset:28672
    v_mfma_f32_16x16x32_bf16 v[248:251], v[140:143], v[208:211], v[248:251]
    ds_read_b64_tr_b16 v[158:159], v7 offset:29696
    s_waitcnt vmcnt(12)
    s_nop 0
    v_add_u32 v4, 0x8000, v4
    v_and_b32 v4, 0x1ffff, v4
    v_add_u32 v5, 0x8000, v5
    v_and_b32 v5, 0x1ffff, v5
    v_add_u32 v6, 0x8000, v6
    v_and_b32 v6, 0x1ffff, v6
    v_add_u32 v7, 0x8000, v7
    v_and_b32 v7, 0x1ffff, v7
    s_waitcnt lgkmcnt(6)
    v_mfma_f32_16x16x32_bf16 v[224:227], v[144:147], v[216:219], v[224:227]
    ds_read_b64_tr_b16 v[128:129], v4 offset:0
    buffer_load_dwordx4 v[208:211], v14, s[36:39], s89 offen offset:2048 sc1
    v_mfma_f32_16x16x32_bf16 v[228:231], v[144:147], v[220:223], v[228:231]
    ds_read_b64_tr_b16 v[130:131], v4 offset:1024
    s_waitcnt lgkmcnt(6)
    v_mfma_f32_16x16x32_bf16 v[236:239], v[148:151], v[220:223], v[236:239]
    ds_read_b64_tr_b16 v[132:133], v5 offset:0
    v_mfma_f32_16x16x32_bf16 v[232:235], v[148:151], v[216:219], v[232:235]
    ds_read_b64_tr_b16 v[134:135], v5 offset:1024
    s_waitcnt lgkmcnt(6)
    v_mfma_f32_16x16x32_bf16 v[240:243], v[152:155], v[216:219], v[240:243]
    ds_read_b64_tr_b16 v[136:137], v6 offset:0
    buffer_load_dwordx4 v[212:215], v15, s[36:39], s89 offen offset:2048 sc1
    v_mfma_f32_16x16x32_bf16 v[244:247], v[152:155], v[220:223], v[244:247]
    ds_read_b64_tr_b16 v[138:139], v6 offset:1024
    s_waitcnt lgkmcnt(6)
    v_mfma_f32_16x16x32_bf16 v[252:255], v[156:159], v[220:223], v[252:255]
    ds_read_b64_tr_b16 v[140:141], v7 offset:0
    v_mfma_f32_16x16x32_bf16 v[248:251], v[156:159], v[216:219], v[248:251]
    ds_read_b64_tr_b16 v[142:143], v7 offset:1024
    s_cmp_lt_u32 s84, 4
    s_cbranch_scc1 L_G2
L_G2done:
    s_barrier
    v_lshrrev_b32 v12, 5, v2
    v_lshlrev_b32_e64 v13, 4, v8
    v_lshl_add_u32 v12, v12, 8, v13
    v_lshl_add_u32 v13, v9, 13, v13
    s_lshl_b32 s78, s71, 15
    s_lshl_b32 s79, s76, 9
    s_add_u32 s78, s78, s79
    s_add_u32 s78, s78, 1572864
    s_add_u32 s79, s78, 4096
    s_lshl_b32 s80, s72, 11
    s_add_u32 s80, s80, s78
    s_waitcnt lgkmcnt(0)
    s_nop 2
    s_nop 0
    v_pk_mul_f32 v[18:19], v[224:225], v[224:225]
    v_pk_mul_f32 v[20:21], v[224:225], v[44:45]
    v_pk_add_f32 v[16:17], v[224:225], v[226:227]
    v_pk_fma_f32 v[18:19], v[226:227], v[226:227], v[18:19]
    v_pk_fma_f32 v[20:21], v[226:227], v[46:47], v[20:21]
    v_pk_add_f32 v[16:17], v[16:17], v[232:233]
    v_pk_fma_f32 v[18:19], v[232:233], v[232:233], v[18:19]
    v_pk_fma_f32 v[20:21], v[232:233], v[48:49], v[20:21]
    v_pk_add_f32 v[16:17], v[16:17], v[234:235]
    v_pk_fma_f32 v[18:19], v[234:235], v[234:235], v[18:19]
    v_pk_fma_f32 v[20:21], v[234:235], v[50:51], v[20:21]
    v_pk_add_f32 v[16:17], v[16:17], v[240:241]
    v_pk_fma_f32 v[18:19], v[240:241], v[240:241], v[18:19]
    v_pk_fma_f32 v[20:21], v[240:241], v[52:53], v[20:21]
    v_pk_add_f32 v[16:17], v[16:17], v[242:243]
    v_pk_fma_f32 v[18:19], v[242:243], v[242:243], v[18:19]
    v_pk_fma_f32 v[20:21], v[242:243], v[54:55], v[20:21]
    v_pk_add_f32 v[16:17], v[16:17], v[248:249]
    v_pk_fma_f32 v[18:19], v[248:249], v[248:249], v[18:19]
    v_pk_fma_f32 v[20:21], v[248:249], v[56:57], v[20:21]
    v_pk_add_f32 v[16:17], v[16:17], v[250:251]
    v_pk_fma_f32 v[18:19], v[250:251], v[250:251], v[18:19]
    v_pk_fma_f32 v[20:21], v[250:251], v[58:59], v[20:21]
    v_pk_mul_f32 v[24:25], v[228:229], v[228:229]
    v_pk_mul_f32 v[26:27], v[228:229], v[44:45]
    v_pk_add_f32 v[22:23], v[228:229], v[230:231]
    v_pk_fma_f32 v[24:25], v[230:231], v[230:231], v[24:25]
    v_pk_fma_f32 v[26:27], v[230:231], v[46:47], v[26:27]
    v_pk_add_f32 v[22:23], v[22:23], v[236:237]
    v_pk_fma_f32 v[24:25], v[236:237], v[236:237], v[24:25]
    v_pk_fma_f32 v[26:27], v[236:237], v[48:49], v[26:27]
    v_pk_add_f32 v[22:23], v[22:23], v[238:239]
    v_pk_fma_f32 v[24:25], v[238:239], v[238:239], v[24:25]
    v_pk_fma_f32 v[26:27], v[238:239], v[50:51], v[26:27]
    v_pk_add_f32 v[22:23], v[22:23], v[244:245]
    v_pk_fma_f32 v[24:25], v[244:245], v[244:245], v[24:25]
    v_pk_fma_f32 v[26:27], v[244:245], v[52:53], v[26:27]
    v_pk_add_f32 v[22:23], v[22:23], v[246:247]
    v_pk_fma_f32 v[24:25], v[246:247], v[246:247], v[24:25]
    v_pk_fma_f32 v[26:27], v[246:247], v[54:55], v[26:27]
    v_pk_add_f32 v[22:23], v[22:23], v[252:253]
    v_pk_fma_f32 v[24:25], v[252:253], v[252:253], v[24:25]
    v_pk_fma_f32 v[26:27], v[252:253], v[56:57], v[26:27]
    v_pk_add_f32 v[22:23], v[22:23], v[254:255]
    v_pk_fma_f32 v[24:25], v[254:255], v[254:255], v[24:25]
    v_pk_fma_f32 v[26:27], v[254:255], v[58:59], v[26:27]
    v_add_f32 v28, v16, v17
    v_add_f32 v29, v18, v19
    v_add_f32 v30, v20, v21
    v_add_f32 v32, v22, v23
    v_add_f32 v33, v24, v25
    v_add_f32 v34, v26, v27
    v_permlane32_swap_b32 v28, v32
    v_permlane32_swap_b32 v29, v33
    v_permlane32_swap_b32 v30, v34
    v_add_f32 v28, v28, v32
    v_add_f32 v29, v29, v33
    v_add_f32 v30, v30, v34
    v_mov_b32 v32, v28
    v_mov_b32 v33, v29
    v_mov_b32 v34, v30
    v_permlane16_swap_b32 v28, v32
    v_permlane16_swap_b32 v29, v33
    v_permlane16_swap_b32 v30, v34
    v_add_f32 v28, v28, v32
    v_add_f32 v29, v29, v33
    v_add_f32 v30, v30, v34
    v_mov_b32 v31, s75
    s_mov_b32 exec_lo, 0xffff
    s_mov_b32 exec_hi, 0xffff
    buffer_store_dwordx4 v[28:31], v12, s[36:39], s80 offen sc1
    s_mov_b64 exec, -1
    s_barrier
    s_mov_b32 s85, 0
Lspin_40:
    s_add_u32 s85, s85, 1
    s_cmp_gt_u32 s85, 400000
    s_cbranch_scc1 L_end
    s_nop 0
    buffer_load_dwordx4 v[64:67], v13, s[36:39], s78 offen offset:0 sc1
    buffer_load_dwordx4 v[68:71], v13, s[36:39], s78 offen offset:2048 sc1
    buffer_load_dwordx4 v[72:75], v13, s[36:39], s79 offen offset:0 sc1
    buffer_load_dwordx4 v[76:79], v13, s[36:39], s79 offen offset:2048 sc1
    buffer_load_dwordx4 v[80:83], v13, s[36:39], s78 offen offset:256 sc1
    buffer_load_dwordx4 v[84:87], v13, s[36:39], s78 offen offset:2304 sc1
    buffer_load_dwordx4 v[88:91], v13, s[36:39], s79 offen offset:256 sc1
    buffer_load_dwordx4 v[92:95], v13, s[36:39], s79 offen offset:2304 sc1
    s_waitcnt vmcnt(0)
    s_nop 0
    v_max3_u32 v14, v67, v71, v75
    v_max3_u32 v14, v14, v79, v83
    v_max3_u32 v14, v14, v87, v91
    v_max3_u32 v14, v14, v95, s75
    v_min3_u32 v15, v67, v71, v75
    v_min3_u32 v15, v15, v79, v83
    v_min3_u32 v15, v15, v87, v91
    v_min3_u32 v15, v15, v95, s75
    v_cmp_ne_u32 vcc, v14, v15
    s_cbranch_vccnz Lspin_40
    v_pk_add_f32 v[64:65], v[64:65], v[68:69]
    v_pk_add_f32 v[72:73], v[72:73], v[76:77]
    v_add_f32 v66, v66, v70
    v_add_f32 v74, v74, v78
    v_pk_add_f32 v[28:29], v[64:65], v[72:73]
    v_add_f32_e64 v30, v66, v74
    v_pk_add_f32 v[80:81], v[80:81], v[84:85]
    v_pk_add_f32 v[88:89], v[88:89], v[92:93]
    v_add_f32 v82, v82, v86
    v_add_f32 v90, v90, v94
    v_pk_add_f32 v[32:33], v[80:81], v[88:89]
    v_add_f32 v34, v82, v90
    s_nop 0
    v_permlane32_swap_b32 v28, v32
    v_permlane32_swap_b32 v29, v33
    v_permlane32_swap_b32 v30, v34
    v_add_f32 v28, v28, v32
    v_add_f32 v29, v29, v33
    v_add_f32 v30, v30, v34
    v_mov_b32 v32, v28
    v_mov_b32 v33, v29
    v_mov_b32 v34, v30
    v_permlane16_swap_b32 v28, v32
    v_permlane16_swap_b32 v29, v33
    v_permlane16_swap_b32 v30, v34
    v_add_f32 v28, v28, v32
    v_add_f32 v29, v29, v33
    v_add_f32_e64 v30, v30, v34
    v_mul_f32 v36, 0x3a800000, v28
    v_mul_f32 v40, 0x3a800000, v29
    v_fma_f32 v40, -v36, v36, v40
    v_max_f32_e64 v40, 0, v40
    v_cvt_pk_bf16_f32 v36, v36, v36
    v_and_b32 v36, 0xffff0000, v36
    v_cvt_pk_bf16_f32 v40, v40, v40
    v_and_b32 v40, 0xffff0000, v40
    v_add_f32 v40, 0x3727c5ac, v40
    v_cvt_pk_bf16_f32 v40, v40, v40
    v_and_b32 v40, 0xffff0000, v40
    v_sqrt_f32 v40, v40
    s_nop 0
    v_cvt_pk_bf16_f32 v40, v40, v40
    v_and_b32 v40, 0xffff0000, v40
    v_rcp_f32_e64 v38, v40
    v_fma_f32 v42, -v36, v126, v30
    v_mul_f32 v42, v42, v38
    s_lshl_b32 s78, s71, 2
    s_add_u32 s78, s78, s76
    s_lshl_b32 s78, s78, 5
    v_lshrrev_b32 v14, 4, v12
    v_add_u32 v14, s78, v14
    s_mov_b32 s79, 0xfffff800
    v_and_or_b32 v42, v42, s79, v14
    s_nop 1
    v_max_f32_dpp v42, v42, v42 row_ror:8 row_mask:0xf bank_mask:0xf
    s_nop 1
    v_max_f32_dpp v42, v42, v42 row_ror:4 row_mask:0xf bank_mask:0xf
    s_nop 1
    v_max_f32_dpp v42, v42, v42 row_ror:2 row_mask:0xf bank_mask:0xf
    s_nop 1
    v_max_f32_dpp v42, v42, v42 row_ror:1 row_mask:0xf bank_mask:0xf
    v_mov_b32 v14, v42
    s_nop 1
    v_permlane32_swap_b32 v42, v14
    v_max_f32_e64 v42, v42, v14
    s_lshl_b32 s78, s76, 2
    s_add_u32 s78, s78, 163328
    v_mov_b32_e64 v14, s78
    ds_write_b32 v14, v42
    v_mul_f32 v48, -v36, v38
    v_mov_b32 v44, v38
    v_mov_b32 v46, v38
    v_mov_b32 v50, v48
    s_nop 0
    v_permlane32_swap_b32 v44, v46
    v_permlane32_swap_b32 v48, v50
    v_add_f32 v52, 1.0, v44
    v_add_f32 v54, 1.0, v46
    v_mov_b32 v14, 163328
    s_waitcnt lgkmcnt(0)
    s_barrier
    ds_read_b128 v[56:59], v14
    v_pk_fma_f32 v[160:161], v[224:225], v[52:53], v[48:49] op_sel_hi:[1,0,0]
    v_pk_fma_f32 v[162:163], v[226:227], v[52:53], v[48:49] op_sel_hi:[1,0,0]
    v_pk_fma_f32 v[164:165], v[228:229], v[54:55], v[50:51] op_sel_hi:[1,0,0]
    v_pk_fma_f32 v[166:167], v[230:231], v[54:55], v[50:51] op_sel_hi:[1,0,0]
    v_pk_fma_f32 v[168:169], v[232:233], v[52:53], v[48:49] op_sel_hi:[1,0,0]
    v_pk_fma_f32 v[170:171], v[234:235], v[52:53], v[48:49] op_sel_hi:[1,0,0]
    v_pk_fma_f32 v[172:173], v[236:237], v[54:55], v[50:51] op_sel_hi:[1,0,0]
    v_pk_fma_f32 v[174:175], v[238:239], v[54:55], v[50:51] op_sel_hi:[1,0,0]
    v_pk_fma_f32 v[176:177], v[240:241], v[52:53], v[48:49] op_sel_hi:[1,0,0]
    v_pk_fma_f32 v[178:179], v[242:243], v[52:53], v[48:49] op_sel_hi:[1,0,0]
    v_pk_fma_f32 v[180:181], v[244:245], v[54:55], v[50:51] op_sel_hi:[1,0,0]
    v_pk_fma_f32 v[182:183], v[246:247], v[54:55], v[50:51] op_sel_hi:[1,0,0]
    v_pk_fma_f32 v[184:185], v[248:249], v[52:53], v[48:49] op_sel_hi:[1,0,0]
    v_pk_fma_f32 v[186:187], v[250:251], v[52:53], v[48:49] op_sel_hi:[1,0,0]
    v_pk_fma_f32 v[188:189], v[252:253], v[54:55], v[50:51] op_sel_hi:[1,0,0]
    v_pk_fma_f32 v[190:191], v[254:255], v[54:55], v[50:51] op_sel_hi:[1,0,0]
    s_waitcnt lgkmcnt(0)
    v_max3_f32 v56, v56, v57, v58
    v_max_f32 v56, v56, v59
    v_mov_b32 v57, s75
    v_readfirstlane_b32 s97, v56
    s_bfe_u32 s78, s97, 0x20005
    s_cmp_lg_u32 s78, s76
    s_cbranch_scc1 L_nocand
    s_and_b32 s78, s97, 15
    s_lshl_b32 s90, 0x00010001, s78
    s_lshl_b32 s79, s71, 4
    s_add_u32 s79, s79, s72
    s_lshl_b32 s79, s79, 9
    s_add_u32 s79, s79, 524288
    v_lshlrev_b32 v14, 3, v9
    v_lshlrev_b32 v15, 4, v9
    s_mov_b32 exec_lo, s90
    s_mov_b32 exec_hi, s90
    s_bitcmp1_b32 s97, 4
    s_cbranch_scc1 L_cand1
    v_pk_fma_f32 v[64:65], v[224:225], v[44:45], v[48:49] op_sel_hi:[1,0,0]
    v_pk_fma_f32 v[66:67], v[226:227], v[44:45], v[48:49] op_sel_hi:[1,0,0]
    v_cvt_pk_bf16_f32 v80, v64, v65
    v_cvt_pk_bf16_f32 v81, v66, v67
    buffer_store_dwordx2 v[80:81], v14, s[36:39], s79 offen offset:0 sc1
    v_pk_fma_f32 v[68:69], v[232:233], v[44:45], v[48:49] op_sel_hi:[1,0,0]
    v_pk_fma_f32 v[70:71], v[234:235], v[44:45], v[48:49] op_sel_hi:[1,0,0]
    v_cvt_pk_bf16_f32 v82, v68, v69
    v_cvt_pk_bf16_f32 v83, v70, v71
    buffer_store_dwordx2 v[82:83], v14, s[36:39], s79 offen offset:32 sc1
    v_pk_fma_f32 v[72:73], v[240:241], v[44:45], v[48:49] op_sel_hi:[1,0,0]
    v_pk_fma_f32 v[74:75], v[242:243], v[44:45], v[48:49] op_sel_hi:[1,0,0]
    v_cvt_pk_bf16_f32 v84, v72, v73
    v_cvt_pk_bf16_f32 v85, v74, v75
    buffer_store_dwordx2 v[84:85], v14, s[36:39], s79 offen offset:64 sc1
    v_pk_fma_f32 v[76:77], v[248:249], v[44:45], v[48:49] op_sel_hi:[1,0,0]
    v_pk_fma_f32 v[78:79], v[250:251], v[44:45], v[48:49] op_sel_hi:[1,0,0]
    v_cvt_pk_bf16_f32 v86, v76, v77
    v_cvt_pk_bf16_f32 v87, v78, v79
    buffer_store_dwordx2 v[86:87], v14, s[36:39], s79 offen offset:96 sc1
    buffer_store_dwordx2 v[56:57], v14, s[36:39], s79 offen offset:128 sc1
    buffer_store_dwordx4 v[160:163], v15, s[36:39], s79 offen offset:256 sc1
    buffer_store_dwordx4 v[168:171], v15, s[36:39], s79 offen offset:320 sc1
    buffer_store_dwordx4 v[176:179], v15, s[36:39], s79 offen offset:384 sc1
    buffer_store_dwordx4 v[184:187], v15, s[36:39], s79 offen offset:448 sc1
    s_branch L_cand2
L_cand1:
    s_nop 0
    v_pk_fma_f32 v[64:65], v[228:229], v[46:47], v[50:51] op_sel_hi:[1,0,0]
    v_pk_fma_f32 v[66:67], v[230:231], v[46:47], v[50:51] op_sel_hi:[1,0,0]
    v_cvt_pk_bf16_f32 v80, v64, v65
    v_cvt_pk_bf16_f32 v81, v66, v67
    buffer_store_dwordx2 v[80:81], v14, s[36:39], s79 offen offset:0 sc1
    v_pk_fma_f32 v[68:69], v[236:237], v[46:47], v[50:51] op_sel_hi:[1,0,0]
    v_pk_fma_f32 v[70:71], v[238:239], v[46:47], v[50:51] op_sel_hi:[1,0,0]
    v_cvt_pk_bf16_f32 v82, v68, v69
    v_cvt_pk_bf16_f32 v83, v70, v71
    buffer_store_dwordx2 v[82:83], v14, s[36:39], s79 offen offset:32 sc1
    v_pk_fma_f32 v[72:73], v[244:245], v[46:47], v[50:51] op_sel_hi:[1,0,0]
    v_pk_fma_f32 v[74:75], v[246:247], v[46:47], v[50:51] op_sel_hi:[1,0,0]
    v_cvt_pk_bf16_f32 v84, v72, v73
    v_cvt_pk_bf16_f32 v85, v74, v75
    buffer_store_dwordx2 v[84:85], v14, s[36:39], s79 offen offset:64 sc1
    v_pk_fma_f32 v[76:77], v[252:253], v[46:47], v[50:51] op_sel_hi:[1,0,0]
    v_pk_fma_f32 v[78:79], v[254:255], v[46:47], v[50:51] op_sel_hi:[1,0,0]
    v_cvt_pk_bf16_f32 v86, v76, v77
    v_cvt_pk_bf16_f32 v87, v78, v79
    buffer_store_dwordx2 v[86:87], v14, s[36:39], s79 offen offset:96 sc1
    buffer_store_dwordx2 v[56:57], v14, s[36:39], s79 offen offset:128 sc1
    buffer_store_dwordx4 v[164:167], v15, s[36:39], s79 offen offset:256 sc1
    buffer_store_dwordx4 v[172:175], v15, s[36:39], s79 offen offset:320 sc1
    buffer_store_dwordx4 v[180:183], v15, s[36:39], s79 offen offset:384 sc1
    buffer_store_dwordx4 v[188:191], v15, s[36:39], s79 offen offset:448 sc1
L_cand2:
    s_mov_b64 exec, -1
L_nocand:
    s_nop 0
    v_cvt_pk_bf16_f32 v192, v160, v161
    v_cvt_pk_bf16_f32 v193, v162, v163
    ds_write_b64 v112, v[192:193] offset:0
    v_cvt_pk_bf16_f32 v194, v164, v165
    v_cvt_pk_bf16_f32 v195, v166, v167
    ds_write_b64 v112, v[194:195] offset:2048
    v_cvt_pk_bf16_f32 v196, v168, v169
    v_cvt_pk_bf16_f32 v197, v170, v171
    ds_write_b64 v113, v[196:197] offset:0
    v_cvt_pk_bf16_f32 v198, v172, v173
    v_cvt_pk_bf16_f32 v199, v174, v175
    ds_write_b64 v113, v[198:199] offset:2048
    v_cvt_pk_bf16_f32 v200, v176, v177
    v_cvt_pk_bf16_f32 v201, v178, v179
    ds_write_b64 v114, v[200:201] offset:0
    v_cvt_pk_bf16_f32 v202, v180, v181
    v_cvt_pk_bf16_f32 v203, v182, v183
    ds_write_b64 v114, v[202:203] offset:2048
    v_cvt_pk_bf16_f32 v204, v184, v185
    v_cvt_pk_bf16_f32 v205, v186, v187
    ds_write_b64 v115, v[204:205] offset:0
    v_cvt_pk_bf16_f32 v206, v188, v189
    v_cvt_pk_bf16_f32 v207, v190, v191
    ds_write_b64 v115, v[206:207] offset:2048
    s_lshl_b32 s78, s76, 12
    s_add_u32 s78, s78, 131072
    v_lshl_add_u32 v14, v2, 4, s78
    s_waitcnt lgkmcnt(0)
    ds_read_b128 v[208:211], v14 offset:0
    ds_read_b128 v[212:215], v14 offset:1024
    ds_read_b128 v[216:219], v14 offset:2048
    ds_read_b128 v[220:223], v14 offset:3072
    v_lshrrev_b32 v16, 3, v2
    v_and_b32 v17, 7, v2
    v_xor_b32 v17, v17, v9
    v_xor_b32 v18, 4, v17
    s_lshl_b32 s78, s71, 2
    s_add_u32 s78, s78, s76
    s_lshl_b32 s78, s78, 5
    v_add_u32_e64 v16, s78, v16
    s_lshl_b32 s79, s72, 7
    v_lshl_add_u32 v19, v16, 11, s79
    v_lshl_add_u32 v17, v17, 4, v19
    v_lshl_add_u32 v18, v18, 4, v19
    v_mov_b32 v14, 163344
    s_barrier
    ds_read_b32 v15, v14
    s_waitcnt lgkmcnt(0)
    v_and_b32 v15, 0x7ff, v15
    v_sub_u32 v15, v15, v16
    s_mov_b32 s78, 0
    v_cmp_ne_u32 vcc, 0, v15
    s_mov_b64 exec, vcc
    buffer_store_dwordx4 v[208:211], v17, s[44:47], s78 offen sc1
    s_mov_b64 exec, -1
    s_mov_b32 s78, 16384
    v_cmp_ne_u32_e64 vcc, 8, v15
    s_mov_b64 exec, vcc
    buffer_store_dwordx4 v[212:215], v18, s[44:47], s78 offen sc1
    s_mov_b64 exec, -1
    s_mov_b32 s78, 32768
    v_cmp_ne_u32_e64 vcc, 16, v15
    s_mov_b64 exec, vcc
    buffer_store_dwordx4 v[216:219], v17, s[44:47], s78 offen sc1
    s_mov_b64 exec, -1
    s_mov_b32 s78, 49152
    v_cmp_ne_u32_e64 vcc, 24, v15
    s_mov_b64 exec, vcc
    buffer_store_dwordx4 v[220:223], v18, s[44:47], s78 offen sc1
    s_mov_b64 exec, -1
    s_barrier
    s_branch L_fin
L_fin:
L_end:
    s_endpgm
.fill 64, 4, 0xbf800000
s_endpgm
.section .rodata,"a"
.p2align 6
.amdhsa_kernel sequential_preLN__linear_kernel_hedgehog__moe_arch_mod__prompt_kernel
  .amdhsa_next_free_vgpr 256
  .amdhsa_next_free_sgpr 102
  .amdhsa_accum_offset 256
  .amdhsa_group_segment_fixed_size 0
  .amdhsa_kernarg_size 96
  .amdhsa_user_sgpr_count 2
  .amdhsa_user_sgpr_kernarg_segment_ptr 1
  .amdhsa_system_sgpr_workgroup_id_x 1
  .amdhsa_float_denorm_mode_32 3
.end_amdhsa_kernel
```

```asm
; @launch grid=(256,1,1) block=(512,1,1) lds=163840
.amdgcn_target "amdgcn-amd-amdhsa--gfx950"
.text
.globl sequential_preLN__linear_kernel_hedgehog__moe_arch_mod__prompt_kernel
.p2align 8
.type sequential_preLN__linear_kernel_hedgehog__moe_arch_mod__prompt_kernel,@function
sequential_preLN__linear_kernel_hedgehog__moe_arch_mod__prompt_kernel:
    s_cmp_ge_u32 s2, 256
    s_cbranch_scc1 L_end
    s_load_dwordx16 s[4:19], s[0:1], 0
    s_load_dwordx8 s[20:27], s[0:1], 64
    v_lshrrev_b32 v1, 6, v0
    v_and_b32 v2, 63, v0
    v_readfirstlane_b32 s68, v1
    s_and_b32 s69, s2, 1
    s_lshl_b32 s69, s69, 3
    s_bfe_u32 s78, s2, 0x30003
    s_or_b32 s69, s69, s78
    s_and_b32 s70, s2, 6
    s_lshl_b32 s70, s70, 1
    s_lshr_b32 s78, s2, 6
    s_or_b32 s70, s70, s78
    s_and_b32 s76, s68, 3
    s_cmp_ge_u32 s68, 4
    s_cbranch_scc1 L_M
    v_lshrrev_b32 v196, 3, v2
    v_and_b32 v197, 7, v2
    v_lshrrev_b32_e64 v198, 4, v2
    s_mul_i32 s78, s76, 98304
    s_lshl_b32 s79, s70, 7
    s_add_u32 s78, s78, s79
    s_movk_i32 s79, 6144
    v_mov_b32 v199, s78
    v_mad_u32_u24 v199, v196, s79, v199
    v_and_b32 v200, 2, v196
    v_xor_b32 v200, v200, v197
    v_lshl_add_u32 v6, v200, 4, v199
    v_xor_b32_e64 v7, 64, v6
    v_add_u32 v7, 48128, v7
    s_lshl_b32 s78, s69, 2
    s_add_u32 s78, s78, s76
    s_lshl_b32 s78, s78, 16
    v_lshl_add_u32 v199, v196, 11, s78
    v_xor_b32 v200, v198, v197
    v_lshl_add_u32 v4, v200, 4, v199
    v_xor_b32_e64 v5, 64, v4
    v_add_u32 v5, 15360, v5
    s_lshl_b32 s88, s76, 12
    s_lshl_b32 s89, s76, 11
    s_and_b32 s78, s70, 14
    s_and_b32 s79, s69, 14
    s_add_u32 s78, s78, s79
    s_sub_u32 s78, 32, s78
    s_and_b32 s78, s78, 15
    s_lshl_b32 s86, s78, 7
    s_mul_i32 s87, s78, 393216
    s_mov_b32 s30, 0x400000
    s_mov_b32 s31, 0x20000
    s_mov_b32 s34, 0x600000
    s_mov_b32 s35, 0x20000
    s_waitcnt lgkmcnt(0)
    s_mov_b32 s32, s6
    s_and_b32 s33, s7, 0xffff
    s_mov_b32 s28, s4
    s_and_b32 s29, s5, 0xffff
    s_add_u32 m0, s88, 118784
    s_nop 0
    buffer_load_dwordx4 v4, s[28:31], s86 offen  lds
    buffer_load_dwordx4 v5, s[28:31], s86 offen offset:1024  lds
    s_add_u32 m0, s89, 143360
    s_add_u32 s101, s87, 2048
    buffer_load_dwordx4 v6, s[32:35], s101 offen  lds
    buffer_load_dwordx4 v7, s[32:35], s101 offen offset:1024  lds
    s_add_u32 m0, s88, 120832
    s_add_u32 s101, s86, 32768
    buffer_load_dwordx4 v4, s[28:31], s101 offen  lds
    buffer_load_dwordx4 v5, s[28:31], s101 offen offset:1024  lds
    s_add_u32 m0, s89, 151552
    s_add_u32 s101, s87, 4096
    buffer_load_dwordx4 v6, s[32:35], s101 offen  lds
    buffer_load_dwordx4 v7, s[32:35], s101 offen offset:1024  lds
    s_add_u32 m0, s89, 135168
    s_nop 0
    buffer_load_dwordx4 v6, s[32:35], s87 offen  lds
    buffer_load_dwordx4 v7, s[32:35], s87 offen offset:1024  lds
    s_add_u32 s86, s86, 128
    s_add_u32 s87, s87, 393216
    s_and_b32 s86, s86, 2047
    s_cselect_b32 s87, s87, 0
    s_load_dword s75, s[26:27], 0
    s_mov_b32 s60, s8
    s_and_b32 s61, s9, 0xffff
    s_mov_b32 s62, 0x10000
    s_mov_b32 s63, 0x20000
    v_lshlrev_b32_e64 v14, 4, v2
    s_lshl_b32 s78, s70, 12
    s_lshl_b32 s79, s76, 10
    s_add_u32 s78, s78, s79
    s_add_u32 m0, s79, 159744
    s_nop 0
    buffer_load_dwordx4 v14, s[60:63], s78 offen lds
    s_and_b32 s78, s70, 3
    s_lshl_b32 s78, s78, 3
    s_and_b32 s79, s69, 7
    s_add_u32 s78, s78, s79
    s_mul_i32 s78, s78, 12288
    s_and_b32 s79, s70, 8
    s_add_u32 s79, s79, 3
    s_lshl_b32 s79, s79, 7
    s_add_u32 s78, s78, s79
    s_bitcmp1_b32 s70, 2
    s_cselect_b32 s78, 0x8000000, s78
    v_lshl_add_u32 v62, v197, 11, s78
    s_and_b32 s78, s70, 8
    s_add_u32 s78, s78, 2
    s_and_b32 s79, s69, 8
    s_add_u32 s78, s78, s79
    s_sub_u32 s3, 35, s78
    s_cmp_lg_u32 s76, 3
    s_cbranch_scc1 Lc0_1
    v_lshlrev_b32 v201, 1, v196
    v_sub_u32 v201, 14, v201
    v_cmp_eq_u32 vcc, 4, v196
    v_mov_b32 v202, 15
    s_nop 0
    v_cndmask_b32 v201, v201, v202, vcc
    v_add_u32 v201, s3, v201
    v_and_b32_e64 v201, 15, v201
    v_mul_u32_u24 v201, 393216, v201
    v_add_u32_e64 v201, v201, v62
    s_mov_b32 exec_lo, 0x3f3f3f3f
    s_mov_b32 exec_hi, 0x3f
    buffer_load_dword v237, v201, s[32:35], 0 offen
    s_mov_b64 exec, -1
Lc0_1:
    s_and_b32 s78, s2, 7
    s_lshr_b32 s79, s2, 3
    s_lshl_b32 s71, s78, 1
    s_and_b32 s72, s79, 1
    s_add_u32 s71, s71, s72
    s_lshr_b32 s72, s79, 1
    s_cmp_gt_u32 s70, 3
    s_cselect_b32 s78, 1, 0
    s_cmp_gt_u32 s70, 11
    s_cselect_b32 s78, 2, s78
    s_sub_u32 s78, s70, s78
    s_cmp_eq_u32 s70, 3
    s_cselect_b32 s78, 14, s78
    s_cmp_eq_u32 s70, 11
    s_cselect_b32 s78, 15, s78
    s_lshl_b32 s0, s78, 4
    s_add_u32 s0, s0, s69
    s_lshr_b32 s73, s0, 2
    s_and_b32 s74, s0, 3
    s_lshl_b32 s77, s70, 4
    s_add_u32 s77, s77, s69
    s_mov_b32 s36, s26
    s_and_b32 s37, s27, 0xffff
    s_mov_b32 s38, 0x10000000
    s_mov_b32 s39, 0x20000
    s_mov_b32 s40, s10
    s_and_b32 s41, s11, 0xffff
    s_mov_b32 s42, 0x200000
    s_mov_b32 s43, 0x20000
    s_mov_b32 s44, s22
    s_and_b32 s45, s23, 0xffff
    s_mov_b32 s46, 0x400000
    s_mov_b32 s47, 0x20000
    s_mov_b32 s48, s16
    s_and_b32 s49, s17, 0xffff
    s_mov_b32 s50, 0x700000
    s_mov_b32 s51, 0x20000
    s_mov_b32 s52, s18
    s_and_b32 s53, s19, 0xffff
    s_mov_b32 s54, 0x700000
    s_mov_b32 s55, 0x20000
    s_mov_b32 s56, s20
    s_and_b32 s57, s21, 0xffff
    s_mov_b32 s58, 0x700000
    s_mov_b32 s59, 0x20000
    v_mov_b32 v16, -1
    v_mov_b32 v17, -1
    v_mov_b32 v18, -1
    v_mov_b32 v19, -1
    s_lshl_b32 s94, s77, 14
    s_lshl_b32 s78, s76, 12
    s_add_u32 s94, s94, s78
    s_add_u32 s94, s94, 4194304
    s_lshl_b32 s96, s77, 10
    s_add_u32 s96, s96, 8388608
    s_cmp_eq_u32 s76, 3
    s_cselect_b32 s96, s96, 0x10000000
    v_and_b32 v196, 15, v2
    v_lshrrev_b32 v197, 1, v196
    v_lshlrev_b32 v199, 7, v196
    v_add_u32 v199, s88, v199
    v_xor_b32_e64 v200, v198, v197
    v_lshl_add_u32 v60, v200, 4, v199
    v_xor_b32_e64 v61, 64, v60
    v_bfe_u32 v196, v2, 2, 2
    v_and_b32_e64 v197, 3, v2
    v_lshl_add_u32 v199, v198, 3, v196
    v_lshlrev_b32_e64 v199, 7, v199
    v_lshl_add_u32 v199, v197, 3, v199
    v_lshrrev_b32 v196, 1, v196
    v_and_b32 v197, 1, v198
    v_lshl_add_u32 v196, v197, 1, v196
    s_mul_i32 s80, s76, 3
    s_add_u32 s78, s80, 0
    s_and_b32 s79, s78, 3
    s_lshr_b32 s78, s78, 2
    s_lshl_b32 s78, s78, 13
    s_add_u32 s78, s78, 16384
    v_xor_b32 v197, s79, v196
    v_lshl_add_u32 v197, v197, 5, v199
    v_add_u32_e64 v240, s78, v197
    s_add_u32 s78, s80, 1
    s_and_b32 s79, s78, 3
    s_lshr_b32 s78, s78, 2
    s_lshl_b32 s78, s78, 13
    s_add_u32 s78, s78, 16384
    v_xor_b32_e64 v197, s79, v196
    v_lshl_add_u32 v197, v197, 5, v199
    v_add_u32_e64 v241, s78, v197
    s_add_u32 s78, s80, 2
    s_and_b32 s79, s78, 3
    s_lshr_b32 s78, s78, 2
    s_lshl_b32 s78, s78, 13
    s_add_u32 s78, s78, 16384
    v_xor_b32_e64 v197, s79, v196
    v_lshl_add_u32 v197, v197, 5, v199
    v_add_u32_e64 v242, s78, v197
    s_and_b32 s82, s70, 1
    s_and_b32 s83, s69, 1
    s_add_u32 m0, s88, 36864
    s_nop 0
    buffer_load_dwordx4 v4, s[28:31], s86 offen  lds
    v_lshrrev_b32 v196, 3, v2
    v_and_b32 v197, 7, v2
    v_lshlrev_b32 v199, 4, v197
    buffer_load_dwordx4 v5, s[28:31], s86 offen offset:1024  lds
    v_mul_u32_u24 v244, 57344, v196
    v_add_u32_e64 v244, v244, v199
    v_lshl_add_u32 v245, v196, 14, v199
    s_lshl_b32 s78, s74, 2
    s_add_u32 m0, s89, 61440
    s_add_u32 s101, s87, 2048
    buffer_load_dwordx4 v6, s[32:35], s101 offen  lds
    s_add_u32 s78, s78, s76
    s_mul_i32 s79, s78, 458752
    s_lshl_b32 s80, s73, 7
    s_add_u32 s79, s79, s80
    buffer_load_dwordx4 v7, s[32:35], s101 offen offset:1024  lds
    s_cmp_ge_u32 s73, 56
    s_cselect_b32 s79, 0x8000000, s79
    v_add_u32_e64 v244, s79, v244
    s_lshl_b32 s78, s78, 7
    s_lshl_b32 s80, s73, 17
    s_add_u32 s78, s78, s80
    s_add_u32 m0, s88, 38912
    s_add_u32 s101, s86, 32768
    buffer_load_dwordx4 v4, s[28:31], s101 offen  lds
    v_add_u32 v245, s78, v245
    s_lshl_b32 s78, s72, 7
    v_lshl_add_u32 v196, v196, 11, s78
    v_and_b32_e64 v199, 1, v198
    buffer_load_dwordx4 v5, s[28:31], s101 offen offset:1024  lds
    v_lshlrev_b32 v199, 2, v199
    v_xor_b32 v199, v199, v197
    v_lshl_add_u32 v246, v199, 4, v196
    s_lshl_b32 s78, s71, 2
    s_add_u32 m0, s89, 69632
    s_add_u32 s101, s87, 4096
    buffer_load_dwordx4 v6, s[32:35], s101 offen  lds
    s_add_u32 s78, s78, s76
    s_lshl_b32 s78, s78, 16
    v_add_u32 v196, s78, v196
    v_xor_b32_e64 v199, v198, v197
    buffer_load_dwordx4 v7, s[32:35], s101 offen offset:1024  lds
    v_lshl_add_u32 v247, v199, 4, v196
    v_xor_b32 v248, 64, v247
    s_lshl_b32 s78, s76, 14
    v_add_u32_e64 v246, s78, v246
    s_add_u32 m0, s89, 53248
    s_nop 0
    buffer_load_dwordx4 v6, s[32:35], s87 offen  lds
    s_lshl_b32 s84, s76, 10
    s_bfe_u32 s78, s2, 0x40003
    s_lshl_b32 s78, s78, 17
    s_and_b32 s79, s72, 8
    buffer_load_dwordx4 v7, s[32:35], s87 offen offset:1024  lds
    s_add_u32 s86, s86, 128
    s_add_u32 s87, s87, 393216
    s_and_b32 s86, s86, 2047
    s_cselect_b32 s87, s87, 0
    s_add_u32 s79, s79, 3
    s_lshl_b32 s79, s79, 7
    s_add_u32 s78, s78, s79
    v_lshl_add_u32 v63, v2, 11, s78
    s_waitcnt vmcnt(10)
    s_barrier
    s_cmp_lg_u32 s82, 0
    s_cbranch_scc1 Lsx_2
    v_add_u32 v196, 118784, v60
    v_add_u32 v197, 118784, v61
    ds_read_b128 v[20:23], v196 offset:0
    ds_read_b128 v[24:27], v196 offset:2048
    ds_read_b128 v[28:31], v197 offset:0
    ds_read_b128 v[32:35], v197 offset:2048
Lsx_2:
    s_cmp_lg_u32 s83, 0
    s_cbranch_scc1 Lsw_3
    v_add_u32 v198, 118784, v240
    v_add_u32 v199, 118784, v241
    v_add_u32 v200, 118784, v242
    ds_read_b64_tr_b16 v[36:37], v198 offset:0
    ds_read_b64_tr_b16 v[38:39], v198 offset:512
    ds_read_b64_tr_b16 v[40:41], v198 offset:4096
    ds_read_b64_tr_b16 v[42:43], v198 offset:4608
    ds_read_b64_tr_b16 v[44:45], v199 offset:0
    ds_read_b64_tr_b16 v[46:47], v199 offset:512
    ds_read_b64_tr_b16 v[48:49], v199 offset:4096
    ds_read_b64_tr_b16 v[50:51], v199 offset:4608
    ds_read_b64_tr_b16 v[52:53], v200 offset:0
    ds_read_b64_tr_b16 v[54:55], v200 offset:512
    ds_read_b64_tr_b16 v[56:57], v200 offset:4096
    ds_read_b64_tr_b16 v[58:59], v200 offset:4608
Lsw_3:
    s_cmp_lg_u32 s76, 0
    s_cbranch_scc1 Lc3_4
    s_add_u32 s100, s3, 0
    s_and_b32 s100, s100, 15
    s_mul_i32 s100, s100, 393216
    s_mov_b64 exec, 63
    buffer_load_dword v237, v62, s[32:35], s100 offen
    s_mov_b64 exec, -1
Lc3_4:
    s_add_u32 m0, s88, 77824
    s_nop 0
    s_nop 0
    buffer_load_dwordx4 v4, s[28:31], s86 offen  lds
    buffer_load_dwordx4 v5, s[28:31], s86 offen offset:1024  lds
    s_add_u32 m0, s89, 102400
    s_add_u32 s101, s87, 2048
    buffer_load_dwordx4 v6, s[32:35], s101 offen  lds
    buffer_load_dwordx4 v7, s[32:35], s101 offen offset:1024  lds
    s_add_u32 m0, s88, 79872
    s_add_u32 s101, s86, 32768
    buffer_load_dwordx4 v4, s[28:31], s101 offen  lds
    buffer_load_dwordx4 v5, s[28:31], s101 offen offset:1024  lds
    s_add_u32 m0, s89, 110592
    s_add_u32 s101, s87, 4096
    buffer_load_dwordx4 v6, s[32:35], s101 offen  lds
    buffer_load_dwordx4 v7, s[32:35], s101 offen offset:1024  lds
    s_add_u32 m0, s89, 94208
    s_nop 0
    buffer_load_dwordx4 v6, s[32:35], s87 offen  lds
    buffer_load_dwordx4 v7, s[32:35], s87 offen offset:1024  lds
    s_add_u32 s86, s86, 128
    s_add_u32 s87, s87, 393216
    s_and_b32 s86, s86, 2047
    s_cselect_b32 s87, s87, 0
    s_waitcnt lgkmcnt(0)
    s_mul_i32 s75, s75, 0x9E3779B1
    s_add_u32 s75, s75, 0x7F4A7C15
    s_waitcnt vmcnt(10)
    s_waitcnt lgkmcnt(0)
    s_barrier
    s_cmp_lg_u32 s82, 1
    s_cbranch_scc1 Lsx_5
    v_add_u32 v196, 36864, v60
    v_add_u32 v197, 36864, v61
    ds_read_b128 v[20:23], v196 offset:0
    ds_read_b128 v[24:27], v196 offset:2048
    ds_read_b128 v[28:31], v197 offset:0
    ds_read_b128 v[32:35], v197 offset:2048
Lsx_5:
    s_cmp_lg_u32 s83, 1
    s_cbranch_scc1 Lsw_6
    v_add_u32 v198, 36864, v240
    v_add_u32 v199, 36864, v241
    v_add_u32 v200, 36864, v242
    ds_read_b64_tr_b16 v[36:37], v198 offset:0
    ds_read_b64_tr_b16 v[38:39], v198 offset:512
    ds_read_b64_tr_b16 v[40:41], v198 offset:4096
    ds_read_b64_tr_b16 v[42:43], v198 offset:4608
    ds_read_b64_tr_b16 v[44:45], v199 offset:0
    ds_read_b64_tr_b16 v[46:47], v199 offset:512
    ds_read_b64_tr_b16 v[48:49], v199 offset:4096
    ds_read_b64_tr_b16 v[50:51], v199 offset:4608
    ds_read_b64_tr_b16 v[52:53], v200 offset:0
    ds_read_b64_tr_b16 v[54:55], v200 offset:512
    ds_read_b64_tr_b16 v[56:57], v200 offset:4096
    ds_read_b64_tr_b16 v[58:59], v200 offset:4608
Lsw_6:
    s_cmp_lg_u32 s76, 1
    s_cbranch_scc1 Lc3_7
    s_add_u32 s100, s3, 1
    s_and_b32 s100, s100, 15
    s_mul_i32 s100, s100, 393216
    s_mov_b64 exec, 63
    buffer_load_dword v237, v62, s[32:35], s100 offen
    s_mov_b64 exec, -1
Lc3_7:
    s_add_u32 m0, s88, 118784
    s_nop 0
    s_nop 0
    buffer_load_dwordx4 v4, s[28:31], s86 offen  lds
    buffer_load_dwordx4 v5, s[28:31], s86 offen offset:1024  lds
    s_add_u32 m0, s89, 143360
    s_add_u32 s101, s87, 2048
    buffer_load_dwordx4 v6, s[32:35], s101 offen  lds
    buffer_load_dwordx4 v7, s[32:35], s101 offen offset:1024  lds
    s_add_u32 m0, s88, 120832
    s_add_u32 s101, s86, 32768
    buffer_load_dwordx4 v4, s[28:31], s101 offen  lds
    buffer_load_dwordx4 v5, s[28:31], s101 offen offset:1024  lds
    s_add_u32 m0, s89, 151552
    s_add_u32 s101, s87, 4096
    buffer_load_dwordx4 v6, s[32:35], s101 offen  lds
    buffer_load_dwordx4 v7, s[32:35], s101 offen offset:1024  lds
    s_add_u32 m0, s89, 135168
    s_nop 0
    buffer_load_dwordx4 v6, s[32:35], s87 offen  lds
    buffer_load_dwordx4 v7, s[32:35], s87 offen offset:1024  lds
    s_add_u32 s86, s86, 128
    s_add_u32 s87, s87, 393216
    s_and_b32 s86, s86, 2047
    s_cselect_b32 s87, s87, 0
    s_waitcnt vmcnt(10)
    s_waitcnt lgkmcnt(0)
    s_barrier
    s_cmp_lg_u32 s76, 2
    s_cbranch_scc1 Lc3_8
    s_add_u32 s100, s3, 2
    s_and_b32 s100, s100, 15
    s_mul_i32 s100, s100, 393216
    s_mov_b64 exec, 63
    buffer_load_dword v237, v62, s[32:35], s100 offen
    s_mov_b64 exec, -1
Lc3_8:
    s_setprio 2
    s_add_u32 m0, s88, 36864
    s_nop 0
    s_nop 0
    buffer_load_dwordx4 v4, s[28:31], s86 offen  lds
    v_mov_b32 v200, 0x3f803f80
    v_mov_b32 v201, 0x3f803f80
    v_mov_b32 v202, 0x3f803f80
    v_mov_b32 v203, 0x3f803f80
    buffer_load_dwordx4 v5, s[28:31], s86 offen offset:1024  lds
    s_nop 0
    s_nop 0
    v_mfma_f32_16x16x32_bf16 v[204:207], v[200:203], v[20:23], 0
    v_mfma_f32_16x16x32_bf16 v[212:215], v[20:23], v[20:23], 0
    v_mfma_f32_16x16x32_bf16 v[208:211], v[200:203], v[24:27], 0
    v_mfma_f32_16x16x32_bf16 v[216:219], v[24:27], v[24:27], 0
    v_mfma_f32_16x16x32_bf16 v[220:223], v[200:203], v[36:39], 0
    s_add_u32 m0, s89, 61440
    s_add_u32 s101, s87, 2048
    buffer_load_dwordx4 v6, s[32:35], s101 offen  lds
    v_mfma_f32_16x16x32_bf16 v[224:227], v[200:203], v[44:47], 0
    v_mfma_f32_16x16x32_bf16 v[228:231], v[200:203], v[52:55], 0
    v_mfma_f32_16x16x32_bf16 v[204:207], v[200:203], v[28:31], v[204:207]
    v_mfma_f32_16x16x32_bf16 v[212:215], v[28:31], v[28:31], v[212:215]
    v_mfma_f32_16x16x32_bf16 v[208:211], v[200:203], v[32:35], v[208:211]
    buffer_load_dwordx4 v7, s[32:35], s101 offen offset:1024  lds
    v_mfma_f32_16x16x32_bf16 v[216:219], v[32:35], v[32:35], v[216:219]
    v_mfma_f32_16x16x32_bf16 v[220:223], v[200:203], v[40:43], v[220:223]
    v_mfma_f32_16x16x32_bf16 v[224:227], v[200:203], v[48:51], v[224:227]
    v_mfma_f32_16x16x32_bf16 v[228:231], v[200:203], v[56:59], v[228:231]
    v_and_b32_e64 v196, 3, v2
    s_add_u32 m0, s88, 38912
    s_add_u32 s101, s86, 32768
    buffer_load_dwordx4 v4, s[28:31], s101 offen  lds
    v_cmp_eq_u32 s[90:91], 1, v196
    v_cmp_eq_u32 s[92:93], 2, v196
    v_cmp_eq_u32_e64 vcc, 3, v196
    v_cndmask_b32 v212, v212, v213, s[90:91]
    v_cndmask_b32 v212, v212, v214, s[92:93]
    buffer_load_dwordx4 v5, s[28:31], s101 offen offset:1024  lds
    v_cndmask_b32_e64 v205, v212, v215, vcc
    v_cndmask_b32 v216, v216, v217, s[90:91]
    v_cndmask_b32 v216, v216, v218, s[92:93]
    v_cndmask_b32 v209, v216, v219, vcc
    v_lshrrev_b32 v196, 4, v2
    s_add_u32 m0, s89, 69632
    s_add_u32 s101, s87, 4096
    buffer_load_dwordx4 v6, s[32:35], s101 offen  lds
    v_cmp_eq_u32 s[90:91], 1, v196
    v_cmp_eq_u32 vcc, 2, v196
    s_nop 0
    v_cndmask_b32 v220, v220, v224, s[90:91]
    v_cndmask_b32_e64 v220, v220, v228, vcc
    s_mul_i32 s78, s77, 768
    buffer_load_dwordx4 v7, s[32:35], s101 offen offset:1024  lds
    s_mul_i32 s79, s76, 192
    s_add_u32 s78, s78, s79
    s_add_u32 s78, s78, 327680
    v_lshlrev_b32 v197, 2, v2
    s_mov_b32 exec_hi, 0xffff
    buffer_store_dword v220, v197, s[36:39], s78 offen sc1
    s_mov_b32 exec_hi, -1
    s_add_u32 m0, s89, 53248
    s_nop 0
    buffer_load_dwordx4 v6, s[32:35], s87 offen  lds
    s_lshl_b32 s78, s69, 4
    s_add_u32 s78, s78, s70
    s_lshl_b32 s78, s78, 10
    s_lshl_b32 s79, s76, 8
    s_add_u32 s78, s78, s79
    buffer_load_dwordx4 v7, s[32:35], s87 offen offset:1024  lds
    s_add_u32 s86, s86, 128
    s_add_u32 s87, s87, 393216
    s_and_b32 s86, s86, 2047
    s_cselect_b32 s87, s87, 0
    s_add_u32 s78, s78, 65536
    v_and_b32 v198, 15, v2
    v_lshlrev_b32 v198, 3, v198
    s_mov_b32 exec_lo, 0x00f0000f
    s_mov_b32 exec_hi, 0xf0000f00
    buffer_store_dwordx2 v[204:205], v198, s[36:39], s78 offen offset:0 sc1
    s_mov_b64 exec, -1
    s_mov_b32 exec_lo, 0x00f0000f
    s_mov_b32 exec_hi, 0xf0000f00
    buffer_store_dwordx2 v[208:209], v198, s[36:39], s78 offen offset:128 sc1
    s_mov_b64 exec, -1
    s_setprio 0
    s_waitcnt vmcnt(13)
    s_waitcnt lgkmcnt(0)
    s_barrier
    s_cmp_lg_u32 s76, 3
    s_cbranch_scc1 Lc3_9
    s_add_u32 s100, s3, 3
    s_and_b32 s100, s100, 15
    s_mul_i32 s100, s100, 393216
    s_mov_b64 exec, 63
    buffer_load_dword v237, v62, s[32:35], s100 offen
    s_mov_b64 exec, -1
Lc3_9:
    s_add_u32 m0, s88, 77824
    s_nop 0
    s_nop 0
    buffer_load_dwordx4 v4, s[28:31], s86 offen  lds
    buffer_load_dwordx4 v5, s[28:31], s86 offen offset:1024  lds
    s_add_u32 m0, s89, 102400
    s_add_u32 s101, s87, 2048
    buffer_load_dwordx4 v6, s[32:35], s101 offen  lds
    buffer_load_dwordx4 v7, s[32:35], s101 offen offset:1024  lds
    s_add_u32 m0, s88, 79872
    s_add_u32 s101, s86, 32768
    buffer_load_dwordx4 v4, s[28:31], s101 offen  lds
    buffer_load_dwordx4 v5, s[28:31], s101 offen offset:1024  lds
    s_add_u32 m0, s89, 110592
    s_add_u32 s101, s87, 4096
    buffer_load_dwordx4 v6, s[32:35], s101 offen  lds
    buffer_load_dwordx4 v7, s[32:35], s101 offen offset:1024  lds
    s_add_u32 m0, s89, 94208
    s_nop 0
    buffer_load_dwordx4 v6, s[32:35], s87 offen  lds
    buffer_load_dwordx4 v7, s[32:35], s87 offen offset:1024  lds
    s_add_u32 s86, s86, 128
    s_add_u32 s87, s87, 393216
    s_and_b32 s86, s86, 2047
    s_cselect_b32 s87, s87, 0
    buffer_store_dwordx4 v[16:19], v14, s[36:39], s96 offen offset:0 sc1
    s_mov_b32 s100, 0
    buffer_load_dwordx4 v[64:67], v244, s[48:51], s100 offen nt
    s_mov_b32 s100, 0
    buffer_load_dwordx4 v[96:99], v244, s[52:55], s100 offen nt
    s_mov_b32 s100, 7168
    buffer_load_dwordx4 v[68:71], v244, s[48:51], s100 offen nt
    s_mov_b32 s100, 7168
    buffer_load_dwordx4 v[100:103], v244, s[52:55], s100 offen nt
    s_mov_b32 s100, 14336
    buffer_load_dwordx4 v[72:75], v244, s[48:51], s100 offen nt
    s_mov_b32 s100, 14336
    buffer_load_dwordx4 v[104:107], v244, s[52:55], s100 offen nt
    s_waitcnt vmcnt(19)
    s_waitcnt lgkmcnt(0)
    s_barrier
    s_cmp_lg_u32 s76, 0
    s_cbranch_scc1 Lc3_10
    s_add_u32 s100, s3, 4
    s_and_b32 s100, s100, 15
    s_mul_i32 s100, s100, 393216
    s_mov_b64 exec, 63
    buffer_load_dword v237, v62, s[32:35], s100 offen
    s_mov_b64 exec, -1
Lc3_10:
    s_add_u32 m0, s88, 118784
    s_nop 0
    buffer_load_dwordx4 v4, s[28:31], s86 offen  lds
    buffer_load_dwordx4 v5, s[28:31], s86 offen offset:1024  lds
    s_add_u32 m0, s89, 143360
    s_add_u32 s101, s87, 2048
    buffer_load_dwordx4 v6, s[32:35], s101 offen  lds
    buffer_load_dwordx4 v7, s[32:35], s101 offen offset:1024  lds
    s_add_u32 m0, s88, 120832
    s_add_u32 s101, s86, 32768
    buffer_load_dwordx4 v4, s[28:31], s101 offen  lds
    buffer_load_dwordx4 v5, s[28:31], s101 offen offset:1024  lds
    s_add_u32 m0, s89, 151552
    s_add_u32 s101, s87, 4096
    buffer_load_dwordx4 v6, s[32:35], s101 offen  lds
    buffer_load_dwordx4 v7, s[32:35], s101 offen offset:1024  lds
    s_add_u32 m0, s89, 135168
    s_nop 0
    buffer_load_dwordx4 v6, s[32:35], s87 offen  lds
    buffer_load_dwordx4 v7, s[32:35], s87 offen offset:1024  lds
    s_add_u32 s86, s86, 128
    s_add_u32 s87, s87, 393216
    s_and_b32 s86, s86, 2047
    s_cselect_b32 s87, s87, 0
    s_waitcnt vmcnt(16)
    s_barrier
    s_cmp_lg_u32 s76, 1
    s_cbranch_scc1 Lc3_11
    s_add_u32 s100, s3, 5
    s_and_b32 s100, s100, 15
    s_mul_i32 s100, s100, 393216
    s_mov_b64 exec, 63
    buffer_load_dword v237, v62, s[32:35], s100 offen
    s_mov_b64 exec, -1
Lc3_11:
    s_cmp_lg_u32 s76, 0
    s_cbranch_scc1 Lfl_12
    s_lshl_b32 s78, s77, 7
    s_add_u32 s78, s78, 4096
    v_mov_b32 v196, s75
    v_lshlrev_b32 v197, 2, v2
    s_mov_b32 exec_hi, 0
    buffer_store_dword v196, v197, s[36:39], s78 offen sc1
    s_mov_b64 exec, -1
    v_not_b32_e64 v196, v196
    s_lshl_b32 s78, s77, 7
    s_add_u32 s79, s78, 8781824
    s_add_u32 s78, s78, 8716288
    s_lshl_b32 s80, s71, 4
    s_add_u32 s80, s80, s72
    s_lshl_b32 s80, s80, 7
    s_add_u32 s80, s80, 8847360
    s_mov_b32 exec_hi, 0
    buffer_store_dword v196, v197, s[36:39], s78 offen sc1
    buffer_store_dword v196, v197, s[36:39], s79 offen sc1
    buffer_store_dword v196, v197, s[36:39], s80 offen sc1
    s_mov_b64 exec, -1
    v_and_b32 v196, 15, v2
    v_lshlrev_b32 v197, 4, v196
    v_add_u32 v197, s69, v197
    s_lshl_b32 s78, s70, 4
    v_add_u32 v196, s78, v196
    v_and_b32 v198, 16, v2
    v_cmp_eq_u32 vcc, 0, v198
    s_nop 1
    v_cndmask_b32 v196, v196, v197, vcc
    v_lshlrev_b32_e64 v196, 7, v196
    v_add_u32 v196, 4096, v196
Lfl_12:
    s_add_u32 m0, s88, 36864
    s_nop 0
    s_nop 0
    buffer_load_dwordx4 v4, s[28:31], s86 offen  lds
    buffer_load_dwordx4 v5, s[28:31], s86 offen offset:1024  lds
    s_add_u32 m0, s89, 61440
    s_add_u32 s101, s87, 2048
    buffer_load_dwordx4 v6, s[32:35], s101 offen  lds
    buffer_load_dwordx4 v7, s[32:35], s101 offen offset:1024  lds
    s_add_u32 m0, s88, 38912
    s_add_u32 s101, s86, 32768
    buffer_load_dwordx4 v4, s[28:31], s101 offen  lds
    buffer_load_dwordx4 v5, s[28:31], s101 offen offset:1024  lds
    s_add_u32 m0, s89, 69632
    s_add_u32 s101, s87, 4096
    buffer_load_dwordx4 v6, s[32:35], s101 offen  lds
    buffer_load_dwordx4 v7, s[32:35], s101 offen offset:1024  lds
    s_add_u32 m0, s89, 53248
    s_nop 0
    buffer_load_dwordx4 v6, s[32:35], s87 offen  lds
    buffer_load_dwordx4 v7, s[32:35], s87 offen offset:1024  lds
    s_add_u32 s86, s86, 128
    s_add_u32 s87, s87, 393216
    s_and_b32 s86, s86, 2047
    s_cselect_b32 s87, s87, 0
    s_waitcnt vmcnt(10)
    s_barrier
    s_cmp_lg_u32 s76, 2
    s_cbranch_scc1 Lc3_13
    s_add_u32 s100, s3, 6
    s_and_b32 s100, s100, 15
    s_mul_i32 s100, s100, 393216
    s_mov_b64 exec, 63
    buffer_load_dword v237, v62, s[32:35], s100 offen
    s_mov_b64 exec, -1
Lc3_13:
    s_add_u32 m0, s88, 77824
    s_nop 0
    s_nop 0
    buffer_load_dwordx4 v4, s[28:31], s86 offen  lds
    buffer_load_dwordx4 v5, s[28:31], s86 offen offset:1024  lds
    s_add_u32 m0, s89, 102400
    s_add_u32 s101, s87, 2048
    buffer_load_dwordx4 v6, s[32:35], s101 offen  lds
    buffer_load_dwordx4 v7, s[32:35], s101 offen offset:1024  lds
    s_add_u32 m0, s88, 79872
    s_add_u32 s101, s86, 32768
    buffer_load_dwordx4 v4, s[28:31], s101 offen  lds
    buffer_load_dwordx4 v5, s[28:31], s101 offen offset:1024  lds
    s_add_u32 m0, s89, 110592
    s_add_u32 s101, s87, 4096
    buffer_load_dwordx4 v6, s[32:35], s101 offen  lds
    buffer_load_dwordx4 v7, s[32:35], s101 offen offset:1024  lds
    s_add_u32 m0, s89, 94208
    s_nop 0
    buffer_load_dwordx4 v6, s[32:35], s87 offen  lds
    buffer_load_dwordx4 v7, s[32:35], s87 offen offset:1024  lds
    s_add_u32 s86, s86, 128
    s_add_u32 s87, s87, 393216
    s_and_b32 s86, s86, 2047
    s_cselect_b32 s87, s87, 0
    s_waitcnt vmcnt(10)
    s_barrier
    s_cmp_lg_u32 s76, 3
    s_cbranch_scc1 Lc3_14
    s_add_u32 s100, s3, 7
    s_and_b32 s100, s100, 15
    s_mul_i32 s100, s100, 393216
    s_mov_b64 exec, 63
    buffer_load_dword v237, v62, s[32:35], s100 offen
    s_mov_b64 exec, -1
Lc3_14:
    s_add_u32 m0, s88, 118784
    s_nop 0
    s_nop 0
    buffer_load_dwordx4 v4, s[28:31], s86 offen  lds
    buffer_load_dwordx4 v5, s[28:31], s86 offen offset:1024  lds
    s_add_u32 m0, s89, 143360
    s_add_u32 s101, s87, 2048
    buffer_load_dwordx4 v6, s[32:35], s101 offen  lds
    buffer_load_dwordx4 v7, s[32:35], s101 offen offset:1024  lds
    s_add_u32 m0, s88, 120832
    s_add_u32 s101, s86, 32768
    buffer_load_dwordx4 v4, s[28:31], s101 offen  lds
    buffer_load_dwordx4 v5, s[28:31], s101 offen offset:1024  lds
    s_add_u32 m0, s89, 151552
    s_add_u32 s101, s87, 4096
    buffer_load_dwordx4 v6, s[32:35], s101 offen  lds
    buffer_load_dwordx4 v7, s[32:35], s101 offen offset:1024  lds
    s_add_u32 m0, s89, 135168
    s_nop 0
    buffer_load_dwordx4 v6, s[32:35], s87 offen  lds
    buffer_load_dwordx4 v7, s[32:35], s87 offen offset:1024  lds
    s_add_u32 s86, s86, 128
    s_add_u32 s87, s87, 393216
    s_and_b32 s86, s86, 2047
    s_cselect_b32 s87, s87, 0
    s_waitcnt vmcnt(10)
    s_barrier
    s_cmp_lg_u32 s76, 0
    s_cbranch_scc1 Lc3_15
    s_add_u32 s100, s3, 8
    s_and_b32 s100, s100, 15
    s_mul_i32 s100, s100, 393216
    s_mov_b64 exec, 63
    buffer_load_dword v237, v62, s[32:35], s100 offen
    s_mov_b64 exec, -1
Lc3_15:
    s_add_u32 m0, s88, 36864
    s_nop 0
    s_nop 0
    buffer_load_dwordx4 v4, s[28:31], s86 offen  lds
    buffer_load_dwordx4 v5, s[28:31], s86 offen offset:1024  lds
    s_add_u32 m0, s89, 61440
    s_add_u32 s101, s87, 2048
    buffer_load_dwordx4 v6, s[32:35], s101 offen  lds
    buffer_load_dwordx4 v7, s[32:35], s101 offen offset:1024  lds
    s_add_u32 m0, s88, 38912
    s_add_u32 s101, s86, 32768
    buffer_load_dwordx4 v4, s[28:31], s101 offen  lds
    buffer_load_dwordx4 v5, s[28:31], s101 offen offset:1024  lds
    s_add_u32 m0, s89, 69632
    s_add_u32 s101, s87, 4096
    buffer_load_dwordx4 v6, s[32:35], s101 offen  lds
    buffer_load_dwordx4 v7, s[32:35], s101 offen offset:1024  lds
    s_add_u32 m0, s89, 53248
    s_nop 0
    buffer_load_dwordx4 v6, s[32:35], s87 offen  lds
    buffer_load_dwordx4 v7, s[32:35], s87 offen offset:1024  lds
    s_add_u32 s86, s86, 128
    s_add_u32 s87, s87, 393216
    s_and_b32 s86, s86, 2047
    s_cselect_b32 s87, s87, 0
    s_waitcnt vmcnt(10)
    s_barrier
    s_cmp_lg_u32 s76, 1
    s_cbranch_scc1 Lc3_16
    s_add_u32 s100, s3, 9
    s_and_b32 s100, s100, 15
    s_mul_i32 s100, s100, 393216
    s_mov_b64 exec, 63
    buffer_load_dword v237, v62, s[32:35], s100 offen
    s_mov_b64 exec, -1
Lc3_16:
    s_add_u32 m0, s88, 77824
    s_nop 0
    s_nop 0
    buffer_load_dwordx4 v4, s[28:31], s86 offen  lds
    buffer_load_dwordx4 v5, s[28:31], s86 offen offset:1024  lds
    s_add_u32 m0, s89, 102400
    s_add_u32 s101, s87, 2048
    buffer_load_dwordx4 v6, s[32:35], s101 offen  lds
    buffer_load_dwordx4 v7, s[32:35], s101 offen offset:1024  lds
    s_add_u32 m0, s88, 79872
    s_add_u32 s101, s86, 32768
    buffer_load_dwordx4 v4, s[28:31], s101 offen  lds
    buffer_load_dwordx4 v5, s[28:31], s101 offen offset:1024  lds
    s_add_u32 m0, s89, 110592
    s_add_u32 s101, s87, 4096
    buffer_load_dwordx4 v6, s[32:35], s101 offen  lds
    buffer_load_dwordx4 v7, s[32:35], s101 offen offset:1024  lds
    s_add_u32 m0, s89, 94208
    s_nop 0
    buffer_load_dwordx4 v6, s[32:35], s87 offen  lds
    buffer_load_dwordx4 v7, s[32:35], s87 offen offset:1024  lds
    s_add_u32 s86, s86, 128
    s_add_u32 s87, s87, 393216
    s_and_b32 s86, s86, 2047
    s_cselect_b32 s87, s87, 0
    s_mov_b32 s100, 21504
    buffer_load_dwordx4 v[76:79], v244, s[48:51], s100 offen nt
    s_mov_b32 s100, 21504
    buffer_load_dwordx4 v[108:111], v244, s[52:55], s100 offen nt
    s_mov_b32 s100, 28672
    buffer_load_dwordx4 v[80:83], v244, s[48:51], s100 offen nt
    s_mov_b32 s100, 28672
    buffer_load_dwordx4 v[112:115], v244, s[52:55], s100 offen nt
    s_mov_b32 s100, 35840
    buffer_load_dwordx4 v[84:87], v244, s[48:51], s100 offen nt
    s_mov_b32 s100, 35840
    buffer_load_dwordx4 v[116:119], v244, s[52:55], s100 offen nt
    s_waitcnt vmcnt(16)
    s_barrier
    s_cmp_lg_u32 s76, 2
    s_cbranch_scc1 Lc3_17
    s_add_u32 s100, s3, 10
    s_and_b32 s100, s100, 15
    s_mul_i32 s100, s100, 393216
    s_mov_b64 exec, 63
    buffer_load_dword v237, v62, s[32:35], s100 offen
    s_mov_b64 exec, -1
Lc3_17:
    s_add_u32 m0, s88, 118784
    s_nop 0
    s_nop 0
    buffer_load_dwordx4 v4, s[28:31], s86 offen  lds
    buffer_load_dwordx4 v5, s[28:31], s86 offen offset:1024  lds
    s_add_u32 m0, s89, 143360
    s_add_u32 s101, s87, 2048
    buffer_load_dwordx4 v6, s[32:35], s101 offen  lds
    buffer_load_dwordx4 v7, s[32:35], s101 offen offset:1024  lds
    s_add_u32 m0, s88, 120832
    s_add_u32 s101, s86, 32768
    buffer_load_dwordx4 v4, s[28:31], s101 offen  lds
    buffer_load_dwordx4 v5, s[28:31], s101 offen offset:1024  lds
    s_add_u32 m0, s89, 151552
    s_add_u32 s101, s87, 4096
    buffer_load_dwordx4 v6, s[32:35], s101 offen  lds
    buffer_load_dwordx4 v7, s[32:35], s101 offen offset:1024  lds
    s_add_u32 m0, s89, 135168
    s_nop 0
    buffer_load_dwordx4 v6, s[32:35], s87 offen  lds
    buffer_load_dwordx4 v7, s[32:35], s87 offen offset:1024  lds
    s_add_u32 s86, s86, 128
    s_add_u32 s87, s87, 393216
    s_and_b32 s86, s86, 2047
    s_cselect_b32 s87, s87, 0
    s_waitcnt vmcnt(16)
    s_barrier
    s_cmp_lg_u32 s76, 3
    s_cbranch_scc1 Lc3_18
    s_add_u32 s100, s3, 11
    s_and_b32 s100, s100, 15
    s_mul_i32 s100, s100, 393216
    s_mov_b64 exec, 63
    buffer_load_dword v237, v62, s[32:35], s100 offen
    s_mov_b64 exec, -1
Lc3_18:
    s_add_u32 m0, s88, 36864
    s_nop 0
    s_nop 0
    buffer_load_dwordx4 v4, s[28:31], s86 offen  lds
    buffer_load_dwordx4 v5, s[28:31], s86 offen offset:1024  lds
    s_add_u32 m0, s89, 61440
    s_add_u32 s101, s87, 2048
    buffer_load_dwordx4 v6, s[32:35], s101 offen  lds
    buffer_load_dwordx4 v7, s[32:35], s101 offen offset:1024  lds
    s_add_u32 m0, s88, 38912
    s_add_u32 s101, s86, 32768
    buffer_load_dwordx4 v4, s[28:31], s101 offen  lds
    buffer_load_dwordx4 v5, s[28:31], s101 offen offset:1024  lds
    s_add_u32 m0, s89, 69632
    s_add_u32 s101, s87, 4096
    buffer_load_dwordx4 v6, s[32:35], s101 offen  lds
    buffer_load_dwordx4 v7, s[32:35], s101 offen offset:1024  lds
    s_add_u32 m0, s89, 53248
    s_nop 0
    buffer_load_dwordx4 v6, s[32:35], s87 offen  lds
    buffer_load_dwordx4 v7, s[32:35], s87 offen offset:1024  lds
    s_add_u32 s86, s86, 128
    s_add_u32 s87, s87, 393216
    s_and_b32 s86, s86, 2047
    s_cselect_b32 s87, s87, 0
    s_waitcnt vmcnt(10)
    s_barrier
    s_cmp_lg_u32 s76, 0
    s_cbranch_scc1 Lc3_19
    s_add_u32 s100, s3, 12
    s_and_b32 s100, s100, 15
    s_mul_i32 s100, s100, 393216
    s_mov_b64 exec, 63
    buffer_load_dword v237, v62, s[32:35], s100 offen
    s_mov_b64 exec, -1
Lc3_19:
    s_cmp_lg_u32 s76, 2
    s_cbranch_scc1 Lc4_20
    s_mov_b32 exec_hi, -1
    buffer_load_dword v238, v63, s[40:43], 0 offen
    s_mov_b64 exec, -1
Lc4_20:
    s_cmp_lg_u32 s76, 0
    s_cbranch_scc1 Lpl_21
    s_mov_b32 exec_hi, 0
    buffer_load_dword v197, v196, s[36:39], 0 offen sc1
    s_mov_b64 exec, -1
Lpl_21:
    s_add_u32 m0, s88, 77824
    s_nop 0
    s_nop 0
    buffer_load_dwordx4 v4, s[28:31], s86 offen  lds
    buffer_load_dwordx4 v5, s[28:31], s86 offen offset:1024  lds
    s_add_u32 m0, s89, 102400
    s_add_u32 s101, s87, 2048
    buffer_load_dwordx4 v6, s[32:35], s101 offen  lds
    buffer_load_dwordx4 v7, s[32:35], s101 offen offset:1024  lds
    s_add_u32 m0, s88, 79872
    s_add_u32 s101, s86, 32768
    buffer_load_dwordx4 v4, s[28:31], s101 offen  lds
    buffer_load_dwordx4 v5, s[28:31], s101 offen offset:1024  lds
    s_add_u32 m0, s89, 110592
    s_add_u32 s101, s87, 4096
    buffer_load_dwordx4 v6, s[32:35], s101 offen  lds
    buffer_load_dwordx4 v7, s[32:35], s101 offen offset:1024  lds
    s_add_u32 m0, s89, 94208
    s_nop 0
    buffer_load_dwordx4 v6, s[32:35], s87 offen  lds
    buffer_load_dwordx4 v7, s[32:35], s87 offen offset:1024  lds
    s_add_u32 s86, s86, 128
    s_add_u32 s87, s87, 393216
    s_and_b32 s86, s86, 2047
    s_cselect_b32 s87, s87, 0
    s_waitcnt vmcnt(10)
    s_barrier
    s_add_u32 m0, s88, 118784
    s_nop 0
    s_nop 0
    buffer_load_dwordx4 v4, s[28:31], s86 offen  lds
    buffer_load_dwordx4 v5, s[28:31], s86 offen offset:1024  lds
    s_add_u32 m0, s89, 143360
    s_add_u32 s101, s87, 2048
    buffer_load_dwordx4 v6, s[32:35], s101 offen  lds
    buffer_load_dwordx4 v7, s[32:35], s101 offen offset:1024  lds
    s_add_u32 m0, s88, 120832
    s_add_u32 s101, s86, 32768
    buffer_load_dwordx4 v4, s[28:31], s101 offen  lds
    buffer_load_dwordx4 v5, s[28:31], s101 offen offset:1024  lds
    s_add_u32 m0, s89, 151552
    s_add_u32 s101, s87, 4096
    buffer_load_dwordx4 v6, s[32:35], s101 offen  lds
    buffer_load_dwordx4 v7, s[32:35], s101 offen offset:1024  lds
    s_add_u32 m0, s89, 135168
    s_nop 0
    buffer_load_dwordx4 v6, s[32:35], s87 offen  lds
    buffer_load_dwordx4 v7, s[32:35], s87 offen offset:1024  lds
    s_add_u32 s86, s86, 128
    s_add_u32 s87, s87, 393216
    s_and_b32 s86, s86, 2047
    s_cselect_b32 s87, s87, 0
    s_waitcnt vmcnt(10)
    s_cmp_lg_u32 s76, 0
    s_cbranch_scc1 Lpc_22
    s_mov_b32 exec_hi, 0
    s_mov_b32 s85, 0
    s_branch Lpk_23
Lspin_24:
    s_add_u32 s85, s85, 1
    s_cmp_gt_u32 s85, 400000
    s_cbranch_scc1 L_end
    buffer_load_dword v197, v196, s[36:39], 0 offen sc1
    s_waitcnt vmcnt(0)
Lpk_23:
    v_cmp_ne_u32 vcc, s75, v197
    s_cbranch_vccnz Lspin_24
    s_mov_b64 exec, -1
Lpc_22:
    s_barrier
    v_lshrrev_b32 v196, 4, v2
    v_and_b32 v197, 15, v2
    v_lshlrev_b32 v197, 4, v197
    v_lshl_add_u32 v198, v196, 10, v197
    s_lshl_b32 s78, s69, 14
    s_lshl_b32 s79, s76, 8
    s_add_u32 s78, s78, s79
    s_nop 0
    s_add_u32 s78, s78, 65536
    buffer_load_dwordx4 v[20:23], v198, s[36:39], s78 offen sc1
    s_add_u32 s78, s78, 4096
    buffer_load_dwordx4 v[24:27], v198, s[36:39], s78 offen sc1
    s_add_u32 s78, s78, 4096
    buffer_load_dwordx4 v[28:31], v198, s[36:39], s78 offen sc1
    s_add_u32 s78, s78, 4096
    buffer_load_dwordx4 v[32:35], v198, s[36:39], s78 offen sc1
    v_mul_u32_u24 v198, 768, v196
    v_add_u32_e64 v198, v198, v197
    s_mul_i32 s78, s70, 12288
    s_lshl_b32 s79, s76, 8
    s_add_u32 s78, s78, s79
    s_add_u32 s78, s78, 327680
    s_cmp_eq_u32 s76, 3
    s_nop 0
    s_cselect_b32 s78, 0x10000000, s78
    buffer_load_dwordx4 v[36:39], v198, s[36:39], s78 offen sc1
    s_add_u32 s78, s78, 3072
    buffer_load_dwordx4 v[40:43], v198, s[36:39], s78 offen sc1
    s_add_u32 s78, s78, 3072
    buffer_load_dwordx4 v[44:47], v198, s[36:39], s78 offen sc1
    s_add_u32 s78, s78, 3072
    buffer_load_dwordx4 v[48:51], v198, s[36:39], s78 offen sc1
    s_add_u32 m0, s84, 0
    s_mov_b32 s100, 0
    buffer_load_dwordx4 v246, s[40:43], s100 offen  lds
    s_add_u32 m0, s84, 4096
    s_mov_b32 s100, 65536
    buffer_load_dwordx4 v246, s[40:43], s100 offen  lds
    s_waitcnt vmcnt(10)
    s_waitcnt lgkmcnt(0)
    s_barrier
    s_setprio 2
    s_add_u32 m0, s84, 8192
    s_mov_b32 s100, 131072
    buffer_load_dwordx4 v246, s[40:43], s100 offen  lds
    s_waitcnt vmcnt(7)
    v_add_f32 v20, v20, v24
    v_add_f32 v21, v21, v25
    v_add_f32 v22, v22, v26
    v_add_f32 v23, v23, v27
    v_add_f32 v20, v20, v28
    v_add_f32 v21, v21, v29
    v_add_f32 v22, v22, v30
    v_add_f32_e64 v23, v23, v31
    s_add_u32 m0, s84, 12288
    s_mov_b32 s100, 196608
    buffer_load_dwordx4 v246, s[40:43], s100 offen  lds
    v_add_f32 v20, v20, v32
    v_add_f32 v21, v21, v33
    v_add_f32 v22, v22, v34
    v_add_f32 v23, v23, v35
    s_nop 0
    v_permlane32_swap_b32 v20, v22
    v_permlane32_swap_b32 v21, v23
    v_add_f32 v20, v20, v22
    v_add_f32 v21, v21, v23
    v_mov_b32 v22, v20
    v_mov_b32_e64 v23, v21
    s_add_u32 m0, s84, 16384
    s_mov_b32 s100, 262144
    buffer_load_dwordx4 v246, s[40:43], s100 offen  lds
    v_permlane16_swap_b32 v20, v22
    v_permlane16_swap_b32 v21, v23
    v_add_f32 v20, v20, v22
    v_add_f32 v21, v21, v23
    v_mul_f32 v24, 0x3a800000, v20
    v_mul_f32 v26, 0x3a800000, v21
    v_fma_f32 v26, -v24, v24, v26
    v_max_f32_e64 v26, 0, v26
    v_cvt_pk_bf16_f32 v24, v24, v24
    v_and_b32 v24, 0xffff0000, v24
    s_add_u32 m0, s84, 20480
    s_mov_b32 s100, 327680
    buffer_load_dwordx4 v246, s[40:43], s100 offen  lds
    v_cvt_pk_bf16_f32 v26, v26, v26
    v_and_b32 v26, 0xffff0000, v26
    v_add_f32 v26, 0x3727c5ac, v26
    v_cvt_pk_bf16_f32 v26, v26, v26
    v_and_b32 v26, 0xffff0000, v26
    v_sqrt_f32 v26, v26
    s_nop 0
    v_cvt_pk_bf16_f32 v26, v26, v26
    v_and_b32 v26, 0xffff0000, v26
    v_rcp_f32_e64 v25, v26
    v_xor_b32 v26, 0x80000000, v24
    s_add_u32 m0, s84, 24576
    s_mov_b32 s100, 393216
    buffer_load_dwordx4 v246, s[40:43], s100 offen  lds
    v_lshrrev_b32 v27, 16, v26
    v_or_b32 v26, v26, v27
    v_mov_b32 v27, 0
    v_and_b32 v196, 15, v2
    v_lshrrev_b32_e64 v197, 5, v2
    v_lshl_add_u32 v196, v196, 1, v197
    s_lshl_b32 s78, s76, 5
    v_add_u32 v196, s78, v196
    v_lshlrev_b32_e64 v197, 3, v196
    v_add_u32 v197, 159744, v197
    s_add_u32 m0, s84, 28672
    s_mov_b32 s100, 458752
    buffer_load_dwordx4 v246, s[40:43], s100 offen  lds
    v_lshlrev_b32_e64 v196, 2, v196
    v_add_u32 v196, 162304, v196
    ds_write_b64 v197, v[26:27]
    ds_write_b32 v196, v25
    s_waitcnt vmcnt(8)
    v_add_f32 v36, v36, v40
    v_add_f32 v37, v37, v41
    v_add_f32 v38, v38, v42
    v_add_f32 v39, v39, v43
    v_add_f32 v36, v36, v44
    s_add_u32 m0, s84, 32768
    s_mov_b32 s100, 524288
    buffer_load_dwordx4 v246, s[40:43], s100 offen  lds
    v_add_f32 v37, v37, v45
    v_add_f32 v38, v38, v46
    v_add_f32 v39, v39, v47
    v_add_f32 v36, v36, v48
    v_add_f32 v37, v37, v49
    v_add_f32 v38, v38, v50
    v_add_f32 v39, v39, v51
    s_nop 0
    v_permlane32_swap_b32 v36, v38
    v_permlane32_swap_b32 v37, v39
    v_add_f32_e64 v36, v36, v38
    s_add_u32 m0, s84, 36864
    s_mov_b32 s100, 589824
    buffer_load_dwordx4 v246, s[40:43], s100 offen  lds
    v_add_f32 v37, v37, v39
    s_nop 1
    v_permlane16_swap_b32 v36, v37
    v_add_f32 v36, v36, v37
    v_cvt_pk_bf16_f32 v37, v36, v36
    v_and_b32 v37, 0xffff0000, v37
    v_sub_f32_e64 v38, v36, v37
    v_cvt_pk_bf16_f32 v38, v37, v38
    v_mov_b32 v39, 0
    v_and_b32 v196, 15, v2
    v_lshrrev_b32_e64 v197, 4, v2
    s_add_u32 m0, s84, 40960
    s_mov_b32 s100, 655360
    buffer_load_dwordx4 v246, s[40:43], s100 offen  lds
    v_lshl_add_u32 v196, v196, 2, v197
    s_lshl_b32 s78, s76, 9
    s_add_u32 s78, s78, 160768
    v_lshl_add_u32 v196, v196, 3, s78
    v_and_b32 v197, 15, v2
    v_lshlrev_b32_e64 v197, 3, v197
    v_add_u32 v197, 162816, v197
    v_mov_b32 v198, 0x3f803f80
    s_cmp_eq_u32 s76, 3
    s_cselect_b64 vcc, -1, 0
    v_cndmask_b32 v196, v196, v197, vcc
    v_cndmask_b32 v38, v38, v198, vcc
    v_cndmask_b32_e64 v39, v39, v198, vcc
    ds_write_b64 v196, v[38:39]
    s_setprio 0
    s_waitcnt lgkmcnt(0)
    s_barrier
    s_nop 0
    s_add_u32 m0, s84, 45056
    s_mov_b32 s100, 720896
    buffer_load_dwordx4 v246, s[40:43], s100 offen  lds
    s_add_u32 m0, s84, 49152
    s_mov_b32 s100, 786432
    buffer_load_dwordx4 v246, s[40:43], s100 offen  lds
    s_add_u32 m0, s84, 53248
    s_mov_b32 s100, 851968
    buffer_load_dwordx4 v246, s[40:43], s100 offen  lds
    s_add_u32 m0, s84, 57344
    s_mov_b32 s100, 917504
    buffer_load_dwordx4 v246, s[40:43], s100 offen  lds
    s_add_u32 m0, s84, 61440
    s_mov_b32 s100, 983040
    buffer_load_dwordx4 v246, s[40:43], s100 offen  lds
    s_add_u32 m0, s84, 65536
    s_mov_b32 s100, 1048576
    buffer_load_dwordx4 v246, s[40:43], s100 offen  lds
    s_add_u32 m0, s84, 69632
    s_mov_b32 s100, 1114112
    buffer_load_dwordx4 v246, s[40:43], s100 offen  lds
    s_add_u32 m0, s84, 73728
    s_mov_b32 s100, 1179648
    buffer_load_dwordx4 v246, s[40:43], s100 offen  lds
    s_add_u32 m0, s84, 77824
    s_mov_b32 s100, 1245184
    buffer_load_dwordx4 v246, s[40:43], s100 offen  lds
    s_add_u32 m0, s84, 81920
    s_mov_b32 s100, 1310720
    buffer_load_dwordx4 v246, s[40:43], s100 offen  lds
    s_add_u32 m0, s84, 86016
    s_mov_b32 s100, 1376256
    buffer_load_dwordx4 v246, s[40:43], s100 offen  lds
    s_add_u32 m0, s84, 90112
    s_mov_b32 s100, 1441792
    buffer_load_dwordx4 v246, s[40:43], s100 offen  lds
    s_add_u32 m0, s84, 94208
    s_mov_b32 s100, 1507328
    buffer_load_dwordx4 v246, s[40:43], s100 offen  lds
    s_add_u32 m0, s84, 98304
    s_mov_b32 s100, 1572864
    buffer_load_dwordx4 v246, s[40:43], s100 offen  lds
    s_add_u32 m0, s84, 102400
    s_mov_b32 s100, 1638400
    buffer_load_dwordx4 v246, s[40:43], s100 offen  lds
    s_add_u32 m0, s84, 106496
    s_mov_b32 s100, 1703936
    buffer_load_dwordx4 v246, s[40:43], s100 offen  lds
    s_mov_b32 s100, 2031616
    buffer_load_dwordx4 v[160:163], v246, s[40:43], s100 offen
    s_mov_b32 s100, 1966080
    buffer_load_dwordx4 v[164:167], v246, s[40:43], s100 offen
    s_mov_b32 s100, 1900544
    buffer_load_dwordx4 v[168:171], v246, s[40:43], s100 offen
    s_mov_b32 s100, 1835008
    buffer_load_dwordx4 v[172:175], v246, s[40:43], s100 offen
    s_mov_b32 s100, 1769472
    buffer_load_dwordx4 v[176:179], v246, s[40:43], s100 offen
    s_mov_b32 s100, 0
    s_nop 0
    buffer_load_dwordx4 v[180:183], v247, s[28:31], s100 offen
    s_mov_b32 s100, 16384
    buffer_load_dwordx4 v[184:187], v248, s[28:31], s100 offen
    s_mov_b32 s100, 32768
    buffer_load_dwordx4 v[188:191], v247, s[28:31], s100 offen
    s_mov_b32 s100, 49152
    buffer_load_dwordx4 v[192:195], v248, s[28:31], s100 offen
    s_mov_b32 s100, 43008
    buffer_load_dwordx4 v[88:91], v244, s[48:51], s100 offen nt
    s_mov_b32 s100, 43008
    buffer_load_dwordx4 v[120:123], v244, s[52:55], s100 offen nt
    s_mov_b32 s100, 50176
    buffer_load_dwordx4 v[92:95], v244, s[48:51], s100 offen nt
    s_mov_b32 s100, 50176
    buffer_load_dwordx4 v[124:127], v244, s[52:55], s100 offen nt
    s_mov_b32 s100, 0
    buffer_load_dwordx4 v[128:131], v245, s[56:59], s100 offen nt
    s_mov_b32 s100, 2048
    buffer_load_dwordx4 v[132:135], v245, s[56:59], s100 offen nt
    v_lshrrev_b32 v198, 2, v2
    v_and_b32 v199, 7, v198
    v_and_b32 v200, 3, v2
    v_xor_b32 v199, v199, v200
    s_lshr_b32 s78, s76, 1
    s_and_b32 s79, s76, 1
    s_lshl_b32 s80, s79, 2
    s_lshl_b32 s81, s78, 2
    v_xor_b32 v200, s80, v199
    v_xor_b32 v201, s81, v199
    v_lshlrev_b32_e64 v198, 7, v198
    s_lshl_b32 s80, s78, 14
    s_add_u32 s80, s80, 110592
    v_lshl_add_u32 v196, v200, 4, v198
    v_add_u32_e64 v196, s80, v196
    v_lshl_add_u32 v197, v201, 4, v198
    v_add_u32 v197, 143360, v197
    v_mov_b32 v200, 0x3f803f80
    v_mov_b32 v201, 0x3f803f80
    v_mov_b32 v202, 0x3f803f80
    v_mov_b32 v203, 0x3f803f80
    v_lshrrev_b32 v198, 4, v2
    v_and_b32 v199, 15, v2
    v_lshlrev_b32_e64 v199, 4, v199
    v_lshl_add_u32 v198, v198, 13, v199
    s_lshl_b32 s78, s70, 2
    s_add_u32 s78, s78, s76
    s_lshl_b32 s78, s78, 15
    s_lshl_b32 s79, s69, 9
    s_add_u32 s78, s78, s79
    s_add_u32 s78, s78, 2097152
    s_lshl_b32 s79, s77, 10
    s_lshl_b32 s80, s76, 6
    s_add_u32 s79, s79, s80
    s_add_u32 s79, s79, 8389120
    s_lshl_b32 s80, s70, 11
    s_add_u32 s80, s80, 8716288
    v_lshl_add_u32 v60, v2, 7, s80
    s_lshl_b32 s80, s71, 7
    s_add_u32 s80, s80, 8781824
    v_lshl_add_u32 v61, v2, 11, s80
    s_and_b32 s94, s69, 1
    s_and_b32 s96, s75, 1
    v_mov_b32 v54, s96
    s_and_b32 s83, s75, 1
    s_lshl_b32 s83, s83, 16
    s_sub_u32 s83, 0, s83
    s_barrier
    s_cmp_lg_u32 s76, 0
    s_cbranch_scc1 Lfs_25
    s_lshl_b32 s100, s77, 7
    s_add_u32 s100, s100, 8716288
    v_mov_b32 v52, s75
    v_lshlrev_b32_e64 v53, 2, v2
    s_mov_b32 exec_hi, 0
    buffer_store_dword v52, v53, s[36:39], s100 offen sc1
    s_mov_b64 exec, -1
Lfs_25:
    s_nop 0
    ds_read_b64_tr_b16 v[4:5], v196 offset:0
    ds_read_b64_tr_b16 v[6:7], v196 offset:2048
    ds_read_b64_tr_b16 v[8:9], v196 offset:8
    ds_read_b64_tr_b16 v[10:11], v196 offset:2056
    ds_read_b64_tr_b16 v[12:13], v197 offset:0
    ds_read_b64_tr_b16 v[14:15], v197 offset:2048
    ds_read_b64_tr_b16 v[16:17], v197 offset:8
    ds_read_b64_tr_b16 v[18:19], v197 offset:2056
    ds_read_b64_tr_b16 v[20:21], v196 offset:4096
    ds_read_b64_tr_b16 v[22:23], v196 offset:6144
    ds_read_b64_tr_b16 v[24:25], v196 offset:4104
    ds_read_b64_tr_b16 v[26:27], v196 offset:6152
    ds_read_b64_tr_b16 v[28:29], v197 offset:4096
    ds_read_b64_tr_b16 v[30:31], v197 offset:6144
    ds_read_b64_tr_b16 v[32:33], v197 offset:4104
    ds_read_b64_tr_b16 v[34:35], v197 offset:6152
    s_waitcnt lgkmcnt(8)
    s_nop 0
    v_mfma_f32_16x16x32_bf16 v[204:207], v[4:7], v[12:15], 0
    v_mfma_f32_16x16x32_bf16 v[208:211], v[8:11], v[12:15], 0
    v_mfma_f32_16x16x32_bf16 v[212:215], v[4:7], v[16:19], 0
    v_mfma_f32_16x16x32_bf16 v[216:219], v[8:11], v[16:19], 0
    v_mfma_f32_16x16x32_bf16 v[220:223], v[4:7], v[200:203], 0
    v_mfma_f32_16x16x32_bf16 v[224:227], v[8:11], v[200:203], 0
    ds_read_b64_tr_b16 v[36:37], v196 offset:8192
    ds_read_b64_tr_b16 v[38:39], v196 offset:10240
    ds_read_b64_tr_b16 v[40:41], v196 offset:8200
    ds_read_b64_tr_b16 v[42:43], v196 offset:10248
    ds_read_b64_tr_b16 v[44:45], v197 offset:8192
    ds_read_b64_tr_b16 v[46:47], v197 offset:10240
    ds_read_b64_tr_b16 v[48:49], v197 offset:8200
    ds_read_b64_tr_b16 v[50:51], v197 offset:10248
    s_waitcnt lgkmcnt(8)
    s_nop 0
    v_mfma_f32_16x16x32_bf16 v[204:207], v[20:23], v[28:31], v[204:207]
    v_mfma_f32_16x16x32_bf16 v[208:211], v[24:27], v[28:31], v[208:211]
    v_mfma_f32_16x16x32_bf16 v[212:215], v[20:23], v[32:35], v[212:215]
    v_mfma_f32_16x16x32_bf16 v[216:219], v[24:27], v[32:35], v[216:219]
    v_mfma_f32_16x16x32_bf16 v[220:223], v[20:23], v[200:203], v[220:223]
    v_mfma_f32_16x16x32_bf16 v[224:227], v[24:27], v[200:203], v[224:227]
    ds_read_b64_tr_b16 v[228:229], v196 offset:12288
    ds_read_b64_tr_b16 v[230:231], v196 offset:14336
    ds_read_b64_tr_b16 v[232:233], v196 offset:12296
    ds_read_b64_tr_b16 v[234:235], v196 offset:14344
    ds_read_b64_tr_b16 v[236:237], v197 offset:12288
    ds_read_b64_tr_b16 v[238:239], v197 offset:14336
    ds_read_b64_tr_b16 v[240:241], v197 offset:12296
    ds_read_b64_tr_b16 v[242:243], v197 offset:14344
    s_waitcnt lgkmcnt(8)
    s_nop 0
    v_mfma_f32_16x16x32_bf16 v[204:207], v[36:39], v[44:47], v[204:207]
    v_mfma_f32_16x16x32_bf16 v[208:211], v[40:43], v[44:47], v[208:211]
    v_mfma_f32_16x16x32_bf16 v[212:215], v[36:39], v[48:51], v[212:215]
    v_mfma_f32_16x16x32_bf16 v[216:219], v[40:43], v[48:51], v[216:219]
    v_mfma_f32_16x16x32_bf16 v[220:223], v[36:39], v[200:203], v[220:223]
    v_mfma_f32_16x16x32_bf16 v[224:227], v[40:43], v[200:203], v[224:227]
    s_waitcnt lgkmcnt(0)
    s_nop 0
    v_mfma_f32_16x16x32_bf16 v[204:207], v[228:231], v[236:239], v[204:207]
    v_mfma_f32_16x16x32_bf16 v[208:211], v[232:235], v[236:239], v[208:211]
    v_mfma_f32_16x16x32_bf16 v[212:215], v[228:231], v[240:243], v[212:215]
    v_mfma_f32_16x16x32_bf16 v[216:219], v[232:235], v[240:243], v[216:219]
    v_mfma_f32_16x16x32_bf16 v[220:223], v[228:231], v[200:203], v[220:223]
    v_mfma_f32_16x16x32_bf16 v[224:227], v[232:235], v[200:203], v[224:227]
    s_nop 2
    v_cvt_pk_bf16_f32 v4, v204, v205
    v_cvt_pk_bf16_f32 v5, v206, v207
    v_cvt_pk_bf16_f32 v6, v208, v209
    v_cvt_pk_bf16_f32 v7, v210, v211
    v_add_u32 v4, s94, v4
    v_and_or_b32 v4, v4, -2, v54
    v_add_u32_e64 v5, s94, v5
    v_and_or_b32 v5, v5, -2, v54
    v_add_u32_e64 v6, s94, v6
    v_and_or_b32 v6, v6, -2, v54
    v_add_u32_e64 v7, s94, v7
    v_and_or_b32 v7, v7, -2, v54
    buffer_store_dwordx4 v[4:7], v198, s[36:39], s78 offen offset:0 sc1
    v_cvt_pk_bf16_f32 v8, v212, v213
    v_cvt_pk_bf16_f32 v9, v214, v215
    v_cvt_pk_bf16_f32 v10, v216, v217
    v_cvt_pk_bf16_f32 v11, v218, v219
    v_add_u32_e64 v8, s94, v8
    v_and_or_b32 v8, v8, -2, v54
    v_add_u32_e64 v9, s94, v9
    v_and_or_b32 v9, v9, -2, v54
    v_add_u32_e64 v10, s94, v10
    v_and_or_b32 v10, v10, -2, v54
    v_add_u32_e64 v11, s94, v11
    v_and_or_b32 v11, v11, -2, v54
    buffer_store_dwordx4 v[8:11], v198, s[36:39], s78 offen offset:256 sc1
    v_cvt_pk_bf16_f32 v12, v220, v221
    v_cvt_pk_bf16_f32 v13, v222, v223
    v_cvt_pk_bf16_f32 v14, v224, v225
    v_cvt_pk_bf16_f32 v15, v226, v227
    s_mov_b32 exec_lo, 0x00010001
    s_mov_b32 exec_hi, 0x00010001
    buffer_store_dwordx4 v[12:15], v2, s[36:39], s79 offen sc1
    s_mov_b64 exec, -1
    v_lshrrev_b32 v196, 3, v2
    v_and_b32 v197, 7, v2
    v_lshlrev_b32 v197, 4, v197
    v_lshl_add_u32 v198, v196, 9, v197
    v_lshl_add_u32 v199, v196, 1, v197
    s_lshl_b32 s78, s77, 13
    s_lshl_b32 s80, s76, 7
    s_add_u32 s78, s78, s80
    s_add_u32 s78, s78, 2097152
    s_add_u32 s79, s78, 4096
    s_lshl_b32 s81, s77, 10
    s_add_u32 s81, s81, s80
    s_add_u32 s81, s81, 8388608
    v_lshrrev_b32 v200, 2, v2
    v_and_b32 v197, 3, v2
    v_lshlrev_b32 v197, 4, v197
    v_lshl_add_u32 v200, v200, 10, v197
    s_lshl_b32 s82, s70, 14
    s_lshl_b32 s80, s76, 6
    s_add_u32 s82, s82, s80
    s_add_u32 s82, s82, 8389120
    v_lshl_add_u32 v201, v196, 1, v197
    s_add_u32 s80, s80, 162944
    v_add_u32 v201, s80, v201
    s_mov_b64 exec, 0xffff
    s_mov_b32 s85, 0
Lspin_26:
    s_add_u32 s85, s85, 1
    s_cmp_gt_u32 s85, 400000
    s_cbranch_scc1 L_end
    buffer_load_dword v52, v60, s[36:39], 0 offen sc1
    s_waitcnt vmcnt(0)
    v_cmp_ne_u32 vcc, s75, v52
    s_cbranch_vccnz Lspin_26
    s_mov_b64 exec, -1
    s_sleep 3
    s_mov_b32 s85, 0
Lspin_27:
    s_add_u32 s85, s85, 1
    s_cmp_gt_u32 s85, 400000
    s_cbranch_scc1 L_end
    buffer_load_dwordx4 v[20:23], v198, s[36:39], s78 offen sc1
    buffer_load_dwordx4 v[24:27], v198, s[36:39], s79 offen sc1
    buffer_load_dwordx4 v[16:19], v200, s[36:39], s82 offen sc1
    s_waitcnt vmcnt(0)
Lchk_28:
    v_bitop3_b32 v28, v20, v24, v54 bitop3:0x7e
    v_bitop3_b32 v29, v21, v25, v54 bitop3:0x7e
    v_bitop3_b32 v30, v22, v26, v54 bitop3:0x7e
    v_bitop3_b32 v31, v23, v27, v54 bitop3:0x7e
    v_or3_b32 v28, v28, v29, v30
    v_cmp_eq_u32 s[90:91], -1, v16
    v_or_b32 v28, v28, v31
    v_and_b32 v28, 1, v28
    v_cmp_ne_u32_e64 vcc, 0, v28
    s_or_b64 vcc, vcc, s[90:91]
    s_cbranch_vccnz Lspin_27
    v_lshl_add_u32 v28, v20, 16, s83
    v_and_b32 v29, 0xffff0000, v20
    v_lshl_add_u32 v36, v24, 16, s83
    v_and_b32 v37, 0xffff0000, v24
    v_pk_add_f32 v[28:29], v[28:29], v[36:37]
    v_lshl_add_u32 v30, v21, 16, s83
    v_and_b32 v31, 0xffff0000, v21
    v_lshl_add_u32 v38, v25, 16, s83
    v_and_b32 v39, 0xffff0000, v25
    v_pk_add_f32 v[30:31], v[30:31], v[38:39]
    v_lshl_add_u32 v32, v22, 16, s83
    v_and_b32 v33, 0xffff0000, v22
    v_lshl_add_u32 v40, v26, 16, s83
    v_and_b32 v41, 0xffff0000, v26
    v_pk_add_f32 v[32:33], v[32:33], v[40:41]
    v_lshl_add_u32 v34, v23, 16, s83
    v_and_b32 v35, 0xffff0000, v23
    v_lshl_add_u32 v42, v27, 16, s83
    v_and_b32 v43, 0xffff0000, v27
    v_pk_add_f32 v[34:35], v[34:35], v[42:43]
    v_permlane32_swap_b32 v28, v32
    v_permlane32_swap_b32 v29, v33
    v_permlane32_swap_b32 v30, v34
    v_permlane32_swap_b32 v31, v35
    v_pk_add_f32 v[28:29], v[28:29], v[32:33]
    v_pk_add_f32 v[30:31], v[30:31], v[34:35]
    s_nop 1
    v_permlane16_swap_b32 v28, v30
    v_permlane16_swap_b32_e64 v29, v31
    v_pk_add_f32 v[28:29], v[28:29], v[30:31]
    s_nop 1
    s_nop 0
    v_add_f32_dpp v28, v28, v28 row_ror:8 row_mask:0xf bank_mask:0xf
    v_add_f32_dpp v29, v29, v29 row_ror:8 row_mask:0xf bank_mask:0xf
    v_cvt_pk_bf16_f32 v36, v28, v29
    s_mov_b32 exec_lo, 0x00ff00ff
    s_mov_b32 exec_hi, 0x00ff00ff
    buffer_store_dword v36, v199, s[36:39], s81 offen sc1
    s_mov_b64 exec, -1
    v_lshlrev_b32 v28, 16, v16
    v_and_b32 v29, 0xffff0000, v16
    v_lshlrev_b32_e64 v30, 16, v17
    v_and_b32 v31, 0xffff0000, v17
    v_lshlrev_b32_e64 v32, 16, v18
    v_and_b32 v33, 0xffff0000, v18
    v_lshlrev_b32_e64 v34, 16, v19
    v_and_b32 v35, 0xffff0000, v19
    v_permlane32_swap_b32 v28, v32
    v_permlane32_swap_b32 v29, v33
    v_permlane32_swap_b32 v30, v34
    v_permlane32_swap_b32 v31, v35
    v_pk_add_f32 v[28:29], v[28:29], v[32:33]
    v_pk_add_f32 v[30:31], v[30:31], v[34:35]
    s_nop 1
    v_permlane16_swap_b32 v28, v30
    v_permlane16_swap_b32_e64 v29, v31
    v_pk_add_f32 v[28:29], v[28:29], v[30:31]
    s_nop 1
    v_add_f32_dpp v38, v28, v28 row_ror:8 row_mask:0xf bank_mask:0x3
    s_nop 1
    v_add_f32_dpp v38, v29, v29 row_ror:8 row_mask:0xf bank_mask:0xc
    s_nop 1
    v_add_f32_dpp v37, v38, v38 row_shr:4 row_mask:0xf bank_mask:0xf
    v_cvt_pk_bf16_f32 v37, v37, v37
    s_mov_b32 exec_lo, 0xf0f0f0f0
    s_mov_b32 exec_hi, 0xf0f0f0f0
    ds_write_b16 v201, v37
    s_mov_b64 exec, -1
    s_waitcnt lgkmcnt(0)
    s_barrier
    v_lshlrev_b32 v4, 4, v2
    s_lshl_b32 s78, s76, 10
    s_add_u32 s78, s78, 110592
    v_add_u32 v5, s78, v4
    s_lshl_b32 s78, s76, 12
    s_add_u32 s78, s78, 131072
    v_add_u32_e64 v6, s78, v4
    ds_write_b128 v5, v[160:163] offset:16384
    ds_write_b128 v5, v[164:167] offset:12288
    ds_write_b128 v5, v[168:171] offset:8192
    ds_write_b128 v5, v[172:175] offset:4096
    ds_write_b128 v5, v[176:179] offset:0
    ds_write_b128 v6, v[180:183] offset:0
    ds_write_b128 v6, v[184:187] offset:1024
    ds_write_b128 v6, v[188:191] offset:2048
    ds_write_b128 v6, v[192:195] offset:3072
    s_waitcnt lgkmcnt(0)
    s_barrier
    s_barrier
    s_barrier
    s_cmp_lg_u32 s76, 0
    s_cbranch_scc1 Lfs_29
    s_lshl_b32 s100, s77, 7
    s_add_u32 s100, s100, 8781824
    v_mov_b32 v52, s75
    v_lshlrev_b32 v53, 2, v2
    s_mov_b32 exec_hi, 0
    buffer_store_dword v52, v53, s[36:39], s100 offen sc1
    s_mov_b64 exec, -1
Lfs_29:
    s_lshl_b32 s83, s71, 4
    s_add_u32 s83, s83, s72
    s_lshl_b32 s78, s0, 11
    s_and_b32 s79, s76, 1
    s_lshl_b32 s79, s79, 10
    s_add_u32 s78, s78, s79
    s_add_u32 s78, s78, 655360
    s_mul_i32 s79, s74, 56
    s_add_u32 s79, s79, s73
    s_lshl_b32 s79, s79, 10
    s_add_u32 s79, s79, 1114112
    s_cmp_eq_u32 s76, 1
    s_cselect_b32 s78, s79, s78
    s_cmp_ge_u32 s73, 56
    s_cselect_b32 s78, 0x10000000, s78
    s_lshl_b32 s79, s83, 9
    s_add_u32 s79, s79, 524288
    s_cmp_eq_u32 s76, 0
    s_cselect_b32 s78, s79, s78
    s_cselect_b32 s79, 0, -1
    v_mov_b32 v56, -1
    v_mov_b32 v57, -1
    v_mov_b32 v58, -1
    v_mov_b32 v59, -1
    s_mov_b32 exec_hi, s79
    buffer_store_dwordx4 v[56:59], v4, s[36:39], s78 offen sc1
    s_mov_b32 exec_hi, -1
    s_cmp_lg_u32 s76, 1
    s_cbranch_scc1 Lf2_30
    s_sleep 14
    s_mov_b64 exec, 0xffff
    s_mov_b32 s85, 0
Lspin_31:
    s_add_u32 s85, s85, 1
    s_cmp_gt_u32 s85, 400000
    s_cbranch_scc1 L_end
    buffer_load_dword v52, v61, s[36:39], 0 offen sc1
    s_waitcnt vmcnt(0)
    v_cmp_ne_u32_e64 vcc, s75, v52
    s_cbranch_vccnz Lspin_31
    s_mov_b64 exec, -1
Lf2_30:
    s_barrier
    s_waitcnt vmcnt(0)
    s_mov_b32 s100, 0x05040100
    s_mov_b32 s101, 0x07060302
    v_perm_b32 v7, v68, v64, s100
    v_perm_b32 v68, v68, v64, s101
    v_mov_b32_e64 v64, v7
    v_perm_b32 v7, v69, v65, s100
    v_perm_b32 v69, v69, v65, s101
    v_mov_b32_e64 v65, v7
    v_perm_b32 v7, v70, v66, s100
    v_perm_b32 v70, v70, v66, s101
    v_mov_b32_e64 v66, v7
    v_perm_b32 v7, v71, v67, s100
    v_perm_b32 v71, v71, v67, s101
    v_mov_b32_e64 v67, v7
    v_perm_b32 v7, v100, v96, s100
    v_perm_b32 v100, v100, v96, s101
    v_mov_b32_e64 v96, v7
    v_perm_b32 v7, v101, v97, s100
    v_perm_b32 v101, v101, v97, s101
    v_mov_b32_e64 v97, v7
    v_perm_b32 v7, v102, v98, s100
    v_perm_b32 v102, v102, v98, s101
    v_mov_b32_e64 v98, v7
    v_perm_b32 v7, v103, v99, s100
    v_perm_b32 v103, v103, v99, s101
    v_mov_b32_e64 v99, v7
    v_perm_b32 v7, v76, v72, s100
    v_perm_b32 v76, v76, v72, s101
    v_mov_b32_e64 v72, v7
    v_perm_b32 v7, v77, v73, s100
    v_perm_b32 v77, v77, v73, s101
    v_mov_b32_e64 v73, v7
    v_perm_b32 v7, v78, v74, s100
    v_perm_b32 v78, v78, v74, s101
    v_mov_b32_e64 v74, v7
    v_perm_b32 v7, v79, v75, s100
    v_perm_b32 v79, v79, v75, s101
    v_mov_b32_e64 v75, v7
    v_perm_b32 v7, v108, v104, s100
    v_perm_b32 v108, v108, v104, s101
    v_mov_b32_e64 v104, v7
    v_perm_b32 v7, v109, v105, s100
    v_perm_b32 v109, v109, v105, s101
    v_mov_b32_e64 v105, v7
    v_perm_b32 v7, v110, v106, s100
    v_perm_b32 v110, v110, v106, s101
    v_mov_b32_e64 v106, v7
    v_perm_b32 v7, v111, v107, s100
    v_perm_b32 v111, v111, v107, s101
    v_mov_b32_e64 v107, v7
    v_perm_b32 v7, v84, v80, s100
    v_perm_b32 v84, v84, v80, s101
    v_mov_b32_e64 v80, v7
    v_perm_b32 v7, v85, v81, s100
    v_perm_b32 v85, v85, v81, s101
    v_mov_b32_e64 v81, v7
    v_perm_b32 v7, v86, v82, s100
    v_perm_b32 v86, v86, v82, s101
    v_mov_b32_e64 v82, v7
    v_perm_b32 v7, v87, v83, s100
    v_perm_b32 v87, v87, v83, s101
    v_mov_b32_e64 v83, v7
    v_perm_b32 v7, v116, v112, s100
    v_perm_b32 v116, v116, v112, s101
    v_mov_b32_e64 v112, v7
    v_perm_b32 v7, v117, v113, s100
    v_perm_b32 v117, v117, v113, s101
    v_mov_b32_e64 v113, v7
    v_perm_b32 v7, v118, v114, s100
    v_perm_b32 v118, v118, v114, s101
    v_mov_b32_e64 v114, v7
    v_perm_b32 v7, v119, v115, s100
    v_perm_b32 v119, v119, v115, s101
    v_mov_b32_e64 v115, v7
    v_perm_b32 v7, v92, v88, s100
    v_perm_b32 v92, v92, v88, s101
    v_mov_b32_e64 v88, v7
    v_perm_b32 v7, v93, v89, s100
    v_perm_b32 v93, v93, v89, s101
    v_mov_b32_e64 v89, v7
    v_perm_b32 v7, v94, v90, s100
    v_perm_b32 v94, v94, v90, s101
    v_mov_b32_e64 v90, v7
    v_perm_b32 v7, v95, v91, s100
    v_perm_b32 v95, v95, v91, s101
    v_mov_b32_e64 v91, v7
    v_perm_b32 v7, v124, v120, s100
    v_perm_b32 v124, v124, v120, s101
    v_mov_b32_e64 v120, v7
    v_perm_b32 v7, v125, v121, s100
    v_perm_b32 v125, v125, v121, s101
    v_mov_b32_e64 v121, v7
    v_perm_b32 v7, v126, v122, s100
    v_perm_b32 v126, v126, v122, s101
    v_mov_b32_e64 v122, v7
    v_perm_b32 v7, v127, v123, s100
    v_perm_b32 v127, v127, v123, s101
    v_mov_b32_e64 v123, v7
    v_perm_b32 v7, v132, v128, s100
    v_perm_b32 v132, v132, v128, s101
    v_mov_b32_e64 v128, v7
    v_perm_b32 v7, v133, v129, s100
    v_perm_b32 v133, v133, v129, s101
    v_mov_b32_e64 v129, v7
    v_perm_b32 v7, v134, v130, s100
    v_perm_b32 v134, v134, v130, s101
    v_mov_b32_e64 v130, v7
    v_perm_b32 v7, v135, v131, s100
    v_perm_b32 v135, v135, v131, s101
    v_mov_b32 v131, v7
    v_lshrrev_b32 v8, 3, v2
    v_and_b32 v9, 7, v2
    v_lshlrev_b32 v10, 4, v9
    v_lshl_add_u32 v11, v8, 13, v10
    v_and_b32 v12, 15, v2
    v_lshlrev_b32 v12, 13, v12
    v_lshl_add_u32 v13, v8, 9, v10
    v_lshl_add_u32 v14, v9, 3, v8
    s_lshl_b32 s80, s74, 2
    s_add_u32 s80, s80, s76
    s_lshl_b32 s78, s80, 9
    s_add_u32 s78, s78, 524288
    s_add_u32 s79, s78, 65536
    s_lshl_b32 s81, s73, 13
    s_add_u32 s81, s81, 655360
    s_lshl_b32 s80, s80, 9
    s_add_u32 s80, s80, s81
    s_lshl_b32 s82, s71, 11
    s_add_u32 s82, s82, 8847360
    v_lshl_add_u32 v60, v2, 7, s82
    s_barrier
    s_mov_b32 s100, 4096
    buffer_load_dwordx4 v[136:139], v245, s[56:59], s100 offen nt
    s_mov_b32 s100, 6144
    buffer_load_dwordx4 v[140:143], v245, s[56:59], s100 offen nt
    s_mov_b32 s100, 8192
    buffer_load_dwordx4 v[144:147], v245, s[56:59], s100 offen nt
    s_mov_b32 s100, 10240
    buffer_load_dwordx4 v[148:151], v245, s[56:59], s100 offen nt
    s_mov_b32 s100, 12288
    buffer_load_dwordx4 v[152:155], v245, s[56:59], s100 offen nt
    s_mov_b32 s100, 14336
    buffer_load_dwordx4 v[156:159], v245, s[56:59], s100 offen nt
    s_barrier
    s_cmp_lg_u32 s76, 0
    s_cbranch_scc1 Lfs_32
    s_lshl_b32 s100, s83, 7
    s_add_u32 s100, s100, 8847360
    v_mov_b32 v52, s75
    v_lshlrev_b32_e64 v53, 2, v2
    s_mov_b32 exec_hi, 0
    buffer_store_dword v52, v53, s[36:39], s100 offen sc1
    s_mov_b64 exec, -1
Lfs_32:
    s_barrier
    s_cmp_lg_u32 s76, 1
    s_cbranch_scc1 Lf3_33
    s_mov_b64 exec, 0xffff
    s_mov_b32 s85, 0
Lspin_34:
    s_add_u32 s85, s85, 1
    s_cmp_gt_u32 s85, 400000
    s_cbranch_scc1 L_end
    buffer_load_dword v52, v60, s[36:39], 0 offen sc1
    s_waitcnt vmcnt(0)
    v_cmp_ne_u32_e64 vcc, s75, v52
    s_cbranch_vccnz Lspin_34
    s_mov_b64 exec, -1
Lf3_33:
    s_barrier
    s_waitcnt vmcnt(0)
    s_mov_b32 s100, 0x05040100
    s_mov_b32 s101, 0x07060302
    v_perm_b32 v7, v140, v136, s100
    v_perm_b32 v140, v140, v136, s101
    v_mov_b32_e64 v136, v7
    v_perm_b32 v7, v141, v137, s100
    v_perm_b32 v141, v141, v137, s101
    v_mov_b32_e64 v137, v7
    v_perm_b32 v7, v142, v138, s100
    v_perm_b32 v142, v142, v138, s101
    v_mov_b32_e64 v138, v7
    v_perm_b32 v7, v143, v139, s100
    v_perm_b32 v143, v143, v139, s101
    v_mov_b32_e64 v139, v7
    v_perm_b32 v7, v148, v144, s100
    v_perm_b32 v148, v148, v144, s101
    v_mov_b32_e64 v144, v7
    v_perm_b32 v7, v149, v145, s100
    v_perm_b32 v149, v149, v145, s101
    v_mov_b32_e64 v145, v7
    v_perm_b32 v7, v150, v146, s100
    v_perm_b32 v150, v150, v146, s101
    v_mov_b32_e64 v146, v7
    v_perm_b32 v7, v151, v147, s100
    v_perm_b32 v151, v151, v147, s101
    v_mov_b32_e64 v147, v7
    v_perm_b32 v7, v156, v152, s100
    v_perm_b32 v156, v156, v152, s101
    v_mov_b32_e64 v152, v7
    v_perm_b32 v7, v157, v153, s100
    v_perm_b32 v157, v157, v153, s101
    v_mov_b32_e64 v153, v7
    v_perm_b32 v7, v158, v154, s100
    v_perm_b32 v158, v158, v154, s101
    v_mov_b32_e64 v154, v7
    v_perm_b32 v7, v159, v155, s100
    v_perm_b32 v159, v159, v155, s101
    v_mov_b32_e64 v155, v7
    s_barrier
    s_sleep 16
    s_mov_b64 exec, 0xffff
    s_mov_b32 s85, 0
Lspin_35:
    s_add_u32 s85, s85, 1
    s_cmp_gt_u32 s85, 400000
    s_cbranch_scc1 L_end
    buffer_load_dwordx2 v[24:25], v12, s[36:39], s78 offen offset:128 sc1
    s_waitcnt vmcnt(0)
    v_cmp_ne_u32 vcc, s75, v25
    s_cbranch_vccnz Lspin_35
    v_max_f32_dpp v24, v24, v24 row_ror:8 row_mask:0xf bank_mask:0xf
    s_nop 1
    v_max_f32_dpp v24, v24, v24 row_ror:4 row_mask:0xf bank_mask:0xf
    s_nop 1
    v_max_f32_dpp v24, v24, v24 row_ror:2 row_mask:0xf bank_mask:0xf
    s_nop 1
    v_max_f32_dpp v24, v24, v24 row_ror:1 row_mask:0xf bank_mask:0xf
    s_nop 0
    v_readfirstlane_b32 s97, v24
    s_mov_b64 exec, -1
    s_nop 0
    v_mov_b32 v24, s97
    s_cmp_ge_u32 s73, 56
    s_cbranch_scc1 L_red
    s_bfe_u32 s79, s97, 0x40007
    s_lshl_b32 s79, s79, 13
    s_add_u32 s78, s78, s79
    v_lshlrev_b32_e64 v25, 4, v8
    s_mov_b32 s85, 0
Lspin_36:
    s_add_u32 s85, s85, 1
    s_cmp_gt_u32 s85, 400000
    s_cbranch_scc1 L_end
    buffer_load_dwordx4 v[20:23], v25, s[36:39], s78 offen sc1
    v_mov_b32 v26, 163360
    ds_write_b32 v26, v24
    v_lshlrev_b32_e64 v15, 3, v14
    s_waitcnt vmcnt(0) lgkmcnt(0)
    v_max3_u32 v16, v20, v21, v22
    v_max_u32 v16, v16, v23
    v_cmp_eq_u32_e64 vcc, -1, v16
    s_cbranch_vccnz Lspin_36
    v_dot2_f32_bf16 v28, v64, v20, 0
    v_dot2_f32_bf16 v29, v68, v20, 0
    v_dot2_f32_bf16 v30, v65, v20, 0
    v_dot2_f32_bf16 v31, v69, v20, 0
    v_dot2_f32_bf16 v32, v66, v20, 0
    v_dot2_f32_bf16 v33, v70, v20, 0
    v_dot2_f32_bf16 v34, v67, v20, 0
    v_dot2_f32_bf16 v35, v71, v20, 0
    v_dot2_f32_bf16 v28, v72, v21, v28
    v_dot2_f32_bf16 v29, v76, v21, v29
    v_dot2_f32_bf16 v30, v73, v21, v30
    v_dot2_f32_bf16 v31, v77, v21, v31
    v_dot2_f32_bf16 v32, v74, v21, v32
    v_dot2_f32_bf16 v33, v78, v21, v33
    v_dot2_f32_bf16 v34, v75, v21, v34
    v_dot2_f32_bf16 v35, v79, v21, v35
    v_dot2_f32_bf16 v28, v80, v22, v28
    v_dot2_f32_bf16 v29, v84, v22, v29
    v_dot2_f32_bf16 v30, v81, v22, v30
    v_dot2_f32_bf16 v31, v85, v22, v31
    v_dot2_f32_bf16 v32, v82, v22, v32
    v_dot2_f32_bf16 v33, v86, v22, v33
    v_dot2_f32_bf16 v34, v83, v22, v34
    v_dot2_f32_bf16 v35, v87, v22, v35
    v_dot2_f32_bf16 v28, v88, v23, v28
    v_dot2_f32_bf16 v29, v92, v23, v29
    v_dot2_f32_bf16 v30, v89, v23, v30
    v_dot2_f32_bf16 v31, v93, v23, v31
    v_dot2_f32_bf16 v32, v90, v23, v32
    v_dot2_f32_bf16 v33, v94, v23, v33
    v_dot2_f32_bf16 v34, v91, v23, v34
    v_dot2_f32_bf16 v35, v95, v23, v35
    v_dot2_f32_bf16 v36, v96, v20, 0
    v_dot2_f32_bf16 v37, v100, v20, 0
    v_dot2_f32_bf16 v38, v97, v20, 0
    v_dot2_f32_bf16 v39, v101, v20, 0
    v_dot2_f32_bf16 v40, v98, v20, 0
    v_dot2_f32_bf16 v41, v102, v20, 0
    v_dot2_f32_bf16 v42, v99, v20, 0
    v_dot2_f32_bf16 v43, v103, v20, 0
    v_dot2_f32_bf16 v36, v104, v21, v36
    v_dot2_f32_bf16 v37, v108, v21, v37
    v_dot2_f32_bf16 v38, v105, v21, v38
    v_dot2_f32_bf16 v39, v109, v21, v39
    v_dot2_f32_bf16 v40, v106, v21, v40
    v_dot2_f32_bf16 v41, v110, v21, v41
    v_dot2_f32_bf16 v42, v107, v21, v42
    v_dot2_f32_bf16 v43, v111, v21, v43
    v_dot2_f32_bf16 v36, v112, v22, v36
    v_dot2_f32_bf16 v37, v116, v22, v37
    v_dot2_f32_bf16 v38, v113, v22, v38
    v_dot2_f32_bf16 v39, v117, v22, v39
    v_dot2_f32_bf16 v40, v114, v22, v40
    v_dot2_f32_bf16 v41, v118, v22, v41
    v_dot2_f32_bf16 v42, v115, v22, v42
    v_dot2_f32_bf16 v43, v119, v22, v43
    v_dot2_f32_bf16 v36, v120, v23, v36
    v_dot2_f32_bf16 v37, v124, v23, v37
    v_dot2_f32_bf16 v38, v121, v23, v38
    v_dot2_f32_bf16 v39, v125, v23, v39
    v_dot2_f32_bf16 v40, v122, v23, v40
    v_dot2_f32_bf16 v41, v126, v23, v41
    v_dot2_f32_bf16 v42, v123, v23, v42
    v_dot2_f32_bf16 v43, v127, v23, v43
    v_permlane32_swap_b32 v28, v32
    v_permlane32_swap_b32 v29, v33
    v_permlane32_swap_b32 v30, v34
    v_permlane32_swap_b32 v31, v35
    v_pk_add_f32 v[28:29], v[28:29], v[32:33]
    v_pk_add_f32 v[30:31], v[30:31], v[34:35]
    s_nop 1
    v_permlane16_swap_b32 v28, v30
    v_permlane16_swap_b32_e64 v29, v31
    v_pk_add_f32 v[28:29], v[28:29], v[30:31]
    s_nop 1
    v_add_f32_dpp v44, v28, v28 row_ror:8 row_mask:0xf bank_mask:0x3
    s_nop 1
    v_add_f32_dpp v44, v29, v29 row_ror:8 row_mask:0xf bank_mask:0xc
    v_permlane32_swap_b32 v36, v40
    v_permlane32_swap_b32 v37, v41
    v_permlane32_swap_b32 v38, v42
    v_permlane32_swap_b32 v39, v43
    v_pk_add_f32 v[36:37], v[36:37], v[40:41]
    v_pk_add_f32 v[38:39], v[38:39], v[42:43]
    s_nop 1
    v_permlane16_swap_b32 v36, v38
    v_permlane16_swap_b32_e64 v37, v39
    v_pk_add_f32 v[36:37], v[36:37], v[38:39]
    s_nop 1
    v_add_f32_dpp v45, v36, v36 row_ror:8 row_mask:0xf bank_mask:0x3
    s_nop 1
    v_add_f32_dpp v45, v37, v37 row_ror:8 row_mask:0xf bank_mask:0xc
    buffer_store_dwordx2 v[44:45], v15, s[36:39], s80 offen sc1
    s_barrier
    s_lshl_b32 s78, s76, 7
    s_add_u32 s78, s78, s81
    s_add_u32 s79, s78, 4096
    v_lshrrev_b32 v26, 5, v2
    v_lshl_add_u32 v26, v9, 1, v26
    s_lshl_b32 s80, s76, 5
    s_add_u32 s80, s80, 163456
    v_lshl_add_u32 v26, v26, 1, s80
    v_lshlrev_b32 v27, 4, v8
    v_add_u32 v27, 163456, v27
    v_lshlrev_b32 v15, 2, v14
    s_mul_i32 s80, s74, 56
    s_add_u32 s80, s80, s73
    s_lshl_b32 s80, s80, 10
    s_lshl_b32 s82, s76, 8
    s_add_u32 s80, s80, s82
    s_add_u32 s80, s80, 1114112
    s_sleep 8
    s_mov_b32 s85, 0
Lspin_37:
    s_add_u32 s85, s85, 1
    s_cmp_gt_u32 s85, 400000
    s_cbranch_scc1 L_end
    buffer_load_dwordx4 v[16:19], v13, s[36:39], s78 offen sc1
    buffer_load_dwordx4 v[20:23], v13, s[36:39], s79 offen sc1
    s_waitcnt vmcnt(0)
    v_max3_u32 v25, v16, v18, v20
    v_max_u32 v25, v25, v22
    v_cmp_eq_u32 vcc, -1, v25
    s_cbranch_vccnz Lspin_37
    v_pk_add_f32 v[16:17], v[16:17], v[20:21]
    v_pk_add_f32 v[18:19], v[18:19], v[22:23]
    s_nop 1
    v_permlane32_swap_b32 v16, v18
    v_permlane32_swap_b32_e64 v17, v19
    v_pk_add_f32 v[16:17], v[16:17], v[18:19]
    v_mov_b32 v18, v16
    v_mov_b32 v19, v17
    s_nop 0
    v_permlane16_swap_b32 v16, v18
    v_permlane16_swap_b32_e64 v17, v19
    v_pk_add_f32 v[16:17], v[16:17], v[18:19]
    s_nop 1
    s_nop 0
    v_add_f32_dpp v16, v16, v16 row_ror:8 row_mask:0xf bank_mask:0xf
    v_add_f32_dpp v17, v17, v17 row_ror:8 row_mask:0xf bank_mask:0xf
    v_cvt_pk_bf16_f32 v16, v16, v16
    v_and_b32 v16, 0xffff0000, v16
    v_cvt_pk_bf16_f32 v17, v17, v17
    v_and_b32 v17, 0xffff0000, v17
    v_mul_f32 v18, 0xbfb8aa3b, v16
    v_exp_f32 v18, v18
    s_nop 0
    v_add_f32 v18, 1.0, v18
    v_rcp_f32 v18, v18
    s_nop 0
    v_mul_f32 v16, v16, v18
    v_cvt_pk_bf16_f32 v16, v16, v16
    v_and_b32 v16, 0xffff0000, v16
    v_mul_f32_e64 v16, v16, v17
    v_cvt_pk_bf16_f32 v16, v16, v16
    ds_write_b16 v26, v16
    s_waitcnt lgkmcnt(0)
    s_barrier
    ds_read_b128 v[20:23], v27
    s_waitcnt lgkmcnt(0)
    s_nop 0
    v_dot2_f32_bf16 v28, v128, v20, 0
    v_dot2_f32_bf16 v29, v132, v20, 0
    v_dot2_f32_bf16 v30, v129, v20, 0
    v_dot2_f32_bf16 v31, v133, v20, 0
    v_dot2_f32_bf16 v32, v130, v20, 0
    v_dot2_f32_bf16 v33, v134, v20, 0
    v_dot2_f32_bf16 v34, v131, v20, 0
    v_dot2_f32_bf16 v35, v135, v20, 0
    v_dot2_f32_bf16 v28, v136, v21, v28
    v_dot2_f32_bf16 v29, v140, v21, v29
    v_dot2_f32_bf16 v30, v137, v21, v30
    v_dot2_f32_bf16 v31, v141, v21, v31
    v_dot2_f32_bf16 v32, v138, v21, v32
    v_dot2_f32_bf16 v33, v142, v21, v33
    v_dot2_f32_bf16 v34, v139, v21, v34
    v_dot2_f32_bf16 v35, v143, v21, v35
    v_dot2_f32_bf16 v28, v144, v22, v28
    v_dot2_f32_bf16 v29, v148, v22, v29
    v_dot2_f32_bf16 v30, v145, v22, v30
    v_dot2_f32_bf16 v31, v149, v22, v31
    v_dot2_f32_bf16 v32, v146, v22, v32
    v_dot2_f32_bf16 v33, v150, v22, v33
    v_dot2_f32_bf16 v34, v147, v22, v34
    v_dot2_f32_bf16 v35, v151, v22, v35
    v_dot2_f32_bf16 v28, v152, v23, v28
    v_dot2_f32_bf16 v29, v156, v23, v29
    v_dot2_f32_bf16 v30, v153, v23, v30
    v_dot2_f32_bf16 v31, v157, v23, v31
    v_dot2_f32_bf16 v32, v154, v23, v32
    v_dot2_f32_bf16 v33, v158, v23, v33
    v_dot2_f32_bf16 v34, v155, v23, v34
    v_dot2_f32_bf16 v35, v159, v23, v35
    v_permlane32_swap_b32 v28, v32
    v_permlane32_swap_b32 v29, v33
    v_permlane32_swap_b32 v30, v34
    v_permlane32_swap_b32 v31, v35
    v_pk_add_f32 v[28:29], v[28:29], v[32:33]
    v_pk_add_f32 v[30:31], v[30:31], v[34:35]
    s_nop 1
    v_permlane16_swap_b32 v28, v30
    v_permlane16_swap_b32_e64 v29, v31
    v_pk_add_f32 v[28:29], v[28:29], v[30:31]
    s_nop 1
    v_add_f32_dpp v44, v28, v28 row_ror:8 row_mask:0xf bank_mask:0x3
    s_nop 1
    v_add_f32_dpp v44, v29, v29 row_ror:8 row_mask:0xf bank_mask:0xc
    buffer_store_dword v44, v15, s[36:39], s80 offen sc1
    s_barrier
    s_branch L_fin
L_red:
    v_mov_b32 v26, 163360
    ds_write_b32 v26, v24
    s_waitcnt lgkmcnt(0)
    s_barrier
    s_barrier
    s_barrier
    s_cmp_lg_u32 s76, 0
    s_cbranch_scc1 L_fin
    s_sub_u32 s83, s0, 224
    v_lshrrev_b32_e64 v14, 4, v2
    v_lshl_add_u32 v14, v9, 2, v14
    v_lshlrev_b32 v15, 2, v14
    v_lshlrev_b32 v14, 1, v14
    s_bfe_u32 s78, s97, 0x40007
    s_lshl_b32 s78, s78, 13
    s_lshr_b32 s79, s83, 1
    s_lshl_b32 s79, s79, 9
    s_add_u32 s78, s78, s79
    s_and_b32 s79, s83, 1
    s_lshl_b32 s79, s79, 7
    s_add_u32 s78, s78, s79
    s_add_u32 s78, s78, 524544
    s_mov_b32 s85, 0
Lspin_38:
    s_add_u32 s85, s85, 1
    s_cmp_gt_u32 s85, 400000
    s_cbranch_scc1 L_end
    buffer_load_dword v46, v15, s[36:39], s78 offen sc1
    s_waitcnt vmcnt(0)
    v_cmp_eq_u32_e64 vcc, -1, v46
    s_cbranch_vccnz Lspin_38
    v_cvt_pk_bf16_f32 v47, v24, v24
    v_and_b32 v47, 0xffff0000, v47
    v_mul_f32 v47, 0xbfb8aa3b, v47
    v_exp_f32 v47, v47
    s_nop 0
    v_add_f32 v47, 1.0, v47
    v_rcp_f32_e64 v47, v47
    s_nop 0
    v_cvt_pk_bf16_f32 v47, v47, v47
    v_and_b32 v47, 0xffff0000, v47
    v_lshl_add_u32 v13, v8, 10, v10
    s_lshr_b32 s78, s83, 3
    s_mul_i32 s78, s78, 57344
    s_and_b32 s79, s83, 7
    s_lshl_b32 s79, s79, 7
    s_add_u32 s78, s78, s79
    s_add_u32 s78, s78, 1114112
    s_and_b32 s80, s97, 0x7ff
    s_lshl_b32 s80, s80, 11
    s_lshl_b32 s79, s83, 6
    s_add_u32 s80, s80, s79
    s_sleep 35
    s_mov_b32 s85, 0
Lspin_39:
    s_add_u32 s85, s85, 1
    s_cmp_gt_u32 s85, 400000
    s_cbranch_scc1 L_end
    s_add_u32 s79, s78, 0
    buffer_load_dwordx4 v[16:19], v13, s[36:39], s79 offen sc1
    s_add_u32 s79, s78, 8192
    buffer_load_dwordx4 v[20:23], v13, s[36:39], s79 offen sc1
    s_add_u32 s79, s78, 16384
    buffer_load_dwordx4 v[24:27], v13, s[36:39], s79 offen sc1
    s_add_u32 s79, s78, 24576
    buffer_load_dwordx4 v[28:31], v13, s[36:39], s79 offen sc1
    s_add_u32 s79, s78, 32768
    buffer_load_dwordx4 v[32:35], v13, s[36:39], s79 offen sc1
    s_add_u32 s79, s78, 40960
    buffer_load_dwordx4 v[36:39], v13, s[36:39], s79 offen sc1
    s_add_u32 s79, s78, 49152
    buffer_load_dwordx4 v[40:43], v13, s[36:39], s79 offen sc1
    s_waitcnt vmcnt(0)
    v_max_u32 v48, v16, v17
    v_max_u32_e64 v49, v18, v19
    v_max3_u32 v48, v48, v20, v21
    v_max3_u32 v49, v49, v22, v23
    v_max3_u32 v48, v48, v24, v25
    v_max3_u32 v49, v49, v26, v27
    v_max3_u32 v48, v48, v28, v29
    v_max3_u32 v49, v49, v30, v31
    v_max3_u32 v48, v48, v32, v33
    v_max3_u32 v49, v49, v34, v35
    v_max3_u32 v48, v48, v36, v37
    v_max3_u32 v49, v49, v38, v39
    v_max3_u32 v48, v48, v40, v41
    v_max3_u32 v49, v49, v42, v43
    v_max_u32 v48, v48, v49
    v_cmp_eq_u32_e64 vcc, -1, v48
    s_cbranch_vccnz Lspin_39
    v_pk_add_f32 v[16:17], v[16:17], v[20:21]
    v_pk_add_f32 v[24:25], v[24:25], v[28:29]
    v_pk_add_f32 v[32:33], v[32:33], v[36:37]
    v_pk_add_f32 v[16:17], v[16:17], v[24:25]
    v_pk_add_f32 v[32:33], v[32:33], v[40:41]
    v_pk_add_f32 v[16:17], v[16:17], v[32:33]
    v_pk_add_f32 v[18:19], v[18:19], v[22:23]
    v_pk_add_f32 v[26:27], v[26:27], v[30:31]
    v_pk_add_f32 v[34:35], v[34:35], v[38:39]
    v_pk_add_f32 v[18:19], v[18:19], v[26:27]
    v_pk_add_f32 v[34:35], v[34:35], v[42:43]
    v_pk_add_f32 v[18:19], v[18:19], v[34:35]
    s_nop 1
    v_permlane32_swap_b32 v16, v18
    v_permlane32_swap_b32_e64 v17, v19
    v_pk_add_f32 v[16:17], v[16:17], v[18:19]
    s_nop 1
    v_permlane16_swap_b32 v16, v17
    v_add_f32 v16, v16, v17
    s_nop 1
    v_add_f32_dpp v16, v16, v16 row_ror:8 row_mask:0xf bank_mask:0xf
    v_cvt_pk_bf16_f32 v16, v16, v16
    v_and_b32 v16, 0xffff0000, v16
    v_mul_f32_e64 v16, v16, v47
    v_cvt_pk_bf16_f32 v16, v16, v16
    v_and_b32 v16, 0xffff0000, v16
    v_add_f32_e64 v16, v16, v46
    v_cvt_pk_bf16_f32 v16, v16, v16
    s_mov_b32 exec_lo, 0x00ff00ff
    s_mov_b32 exec_hi, 0x00ff00ff
    buffer_store_short v16, v14, s[44:47], s80 offen
    s_mov_b64 exec, -1
    s_cmp_lg_u32 s0, 224
    s_cbranch_scc1 Lep_40
    s_cmp_lg_u32 s76, 0
    s_cbranch_scc1 Lep_40
    v_mov_b32 v196, s75
    v_mov_b32_e64 v197, 0
    s_mov_b64 exec, 1
    buffer_store_dword v196, v197, s[36:39], 0 offen sc1
    s_mov_b64 exec, -1
Lep_40:
    s_branch L_fin
    .p2align 3
L_M:
    s_setprio 1
    s_and_b32 s78, s2, 7
    s_lshr_b32 s79, s2, 3
    s_lshl_b32 s71, s78, 1
    s_and_b32 s72, s79, 1
    s_add_u32 s71, s71, s72
    s_lshr_b32 s72, s79, 1
    s_cmp_gt_u32 s70, 3
    s_cselect_b32 s78, 1, 0
    s_cmp_gt_u32 s70, 11
    s_cselect_b32 s78, 2, s78
    s_sub_u32 s78, s70, s78
    s_cmp_eq_u32 s70, 3
    s_cselect_b32 s78, 14, s78
    s_cmp_eq_u32 s70, 11
    s_cselect_b32 s78, 15, s78
    s_lshl_b32 s0, s78, 4
    s_add_u32 s0, s0, s69
    s_lshr_b32 s73, s0, 2
    s_and_b32 s74, s0, 3
    s_lshl_b32 s77, s70, 4
    s_add_u32 s77, s77, s69
    s_and_b32 s80, s76, 1
    s_lshr_b32 s81, s76, 1
    v_and_b32 v8, 15, v2
    v_lshrrev_b32 v9, 4, v2
    v_lshrrev_b32 v10, 1, v8
    s_lshl_b32 s78, s80, 13
    s_add_u32 s78, s78, 118784
    v_lshlrev_b32 v11, 7, v8
    v_add_u32 v11, s78, v11
    v_add_u32 v12, 0, v9
    v_xor_b32 v12, v12, v10
    v_lshl_add_u32 v4, v12, 4, v11
    v_add_u32 v12, 4, v9
    v_xor_b32 v12, v12, v10
    v_lshl_add_u32 v5, v12, 4, v11
    v_bfe_u32 v10, v2, 2, 2
    v_and_b32_e64 v11, 3, v2
    v_lshl_add_u32 v12, v9, 3, v10
    v_lshlrev_b32_e64 v12, 7, v12
    v_lshl_add_u32 v12, v11, 3, v12
    v_add_u32 v12, 135168, v12
    v_lshrrev_b32 v13, 1, v10
    v_and_b32 v14, 1, v9
    v_lshl_add_u32 v13, v14, 1, v13
    s_lshl_b32 s78, s81, 1
    s_add_u32 s79, s78, 0
    v_xor_b32_e64 v14, s79, v13
    v_lshl_add_u32 v6, v14, 5, v12
    s_add_u32 s79, s78, 1
    v_xor_b32 v14, s79, v13
    v_lshl_add_u32 v7, v14, 5, v12
    v_lshrrev_b32_e64 v13, 5, v2
    v_lshl_add_u32 v13, v13, 3, v10
    v_lshlrev_b32 v13, 6, v13
    v_and_b32 v14, 1, v9
    v_lshl_add_u32 v13, v14, 5, v13
    v_lshl_add_u32 v13, v11, 3, v13
    s_lshl_b32 s78, s81, 11
    s_add_u32 s78, s78, 159744
    v_add_u32 v15, s78, v13
    v_mov_b64 v[128:129], 0
    v_mov_b64 v[130:131], 0
    v_mov_b64 v[132:133], 0
    v_mov_b64 v[134:135], 0
    v_mov_b64 v[136:137], 0
    v_mov_b64 v[138:139], 0
    v_mov_b64 v[140:141], 0
    v_mov_b64 v[142:143], 0
    v_mov_b64 v[144:145], 0
    v_mov_b64 v[146:147], 0
    v_mov_b64 v[148:149], 0
    v_mov_b64 v[150:151], 0
    v_mov_b64 v[152:153], 0
    v_mov_b64 v[154:155], 0
    v_mov_b64 v[156:157], 0
    v_mov_b64 v[158:159], 0
    v_mov_b64 v[160:161], 0
    v_mov_b64 v[162:163], 0
    v_mov_b64 v[164:165], 0
    v_mov_b64 v[166:167], 0
    v_mov_b64 v[168:169], 0
    v_mov_b64 v[170:171], 0
    v_mov_b64 v[172:173], 0
    v_mov_b64 v[174:175], 0
    v_mov_b64 v[176:177], 0
    v_mov_b64 v[178:179], 0
    v_mov_b64 v[180:181], 0
    v_mov_b64 v[182:183], 0
    v_mov_b64 v[184:185], 0
    v_mov_b64 v[186:187], 0
    v_mov_b64 v[188:189], 0
    v_mov_b64 v[190:191], 0
    v_mov_b64 v[192:193], 0
    v_mov_b64 v[194:195], 0
    v_mov_b64 v[196:197], 0
    v_mov_b64 v[198:199], 0
    v_mov_b64 v[200:201], 0
    v_mov_b64 v[202:203], 0
    v_mov_b64 v[204:205], 0
    v_mov_b64 v[206:207], 0
    v_mov_b64 v[208:209], 0
    v_mov_b64 v[210:211], 0
    v_mov_b64 v[212:213], 0
    v_mov_b64 v[214:215], 0
    v_mov_b64 v[216:217], 0
    v_mov_b64 v[218:219], 0
    v_mov_b64 v[220:221], 0
    v_mov_b64 v[222:223], 0
    v_mov_b64 v[104:105], 0
    v_mov_b64 v[106:107], 0
    v_mov_b64 v[108:109], 0
    v_mov_b64 v[110:111], 0
    v_and_b32 v14, 31, v2
    v_lshrrev_b32_e64 v13, 5, v2
    s_lshl_b32 s78, s81, 14
    s_lshl_b32 s79, s80, 13
    s_add_u32 s78, s78, s79
    s_add_u32 s78, s78, 110592
    v_lshl_add_u32 v12, v14, 7, s78
    v_and_b32 v14, 7, v14
    v_xor_b32 v14, v14, v13
    v_xor_b32_e64 v13, 0, v14
    v_lshl_add_u32 v112, v13, 4, v12
    v_xor_b32_e64 v13, 2, v14
    v_lshl_add_u32 v113, v13, 4, v12
    v_xor_b32_e64 v13, 4, v14
    v_lshl_add_u32 v114, v13, 4, v12
    v_xor_b32_e64 v13, 6, v14
    v_lshl_add_u32 v115, v13, 4, v12
    s_add_u32 s79, s79, 143360
    v_lshl_add_u32 v12, v8, 7, s79
    s_lshl_b32 s78, s81, 2
    v_add_u32 v14, s78, v9
    v_and_b32 v13, 7, v8
    v_xor_b32 v14, v14, v13
    v_lshl_add_u32 v116, v14, 4, v12
    s_lshl_b32 s78, s80, 6
    v_add_u32 v10, s78, v8
    v_lshlrev_b32_e64 v11, 3, v10
    v_add_u32 v11, 159744, v11
    s_lshl_b32 s79, s81, 5
    v_add_u32 v12, s79, v8
    v_lshlrev_b32_e64 v12, 3, v12
    v_add_u32 v12, 160768, v12
    v_lshlrev_b32_e64 v13, 2, v10
    v_add_u32 v13, 162304, v13
    v_and_b32 v14, 31, v2
    v_add_u32 v14, s78, v14
    v_lshlrev_b32_e64 v14, 2, v14
    v_add_u32 v14, 162304, v14
    s_waitcnt lgkmcnt(0)
    s_load_dword s75, s[26:27], 0
    s_mov_b32 s36, s26
    s_and_b32 s37, s27, 0xffff
    s_mov_b32 s38, 0x10000000
    s_mov_b32 s39, 0x20000
    s_mov_b32 s64, s14
    s_and_b32 s65, s15, 0xffff
    s_mov_b32 s66, 0x800
    s_mov_b32 s67, 0x20000
    s_mov_b32 s44, s22
    s_and_b32 s45, s23, 0xffff
    s_mov_b32 s46, 0x400000
    s_mov_b32 s47, 0x20000
    s_lshl_b32 s78, s72, 7
    buffer_load_dword v118, off, s[64:67], s78
    s_waitcnt lgkmcnt(0)
    s_mul_i32 s75, s75, 0x9E3779B1
    s_add_u32 s75, s75, 0x7F4A7C15
    s_mov_b32 s84, 0
    s_mov_b32 s82, 2
    s_mov_b32 s83, 0xfffec000
    s_barrier
    s_nop 0
    ds_read_b128 v[16:19], v4 offset:0
    ds_read_b64_tr_b16 v[40:41], v6 offset:8192
    ds_read_b64_tr_b16 v[42:43], v6 offset:8704
    ds_read_b128 v[20:23], v4 offset:2048
    ds_read_b128 v[24:27], v4 offset:4096
    ds_read_b128 v[28:31], v4 offset:6144
    ds_read_b64_tr_b16 v[44:45], v7 offset:8192
    ds_read_b64_tr_b16 v[46:47], v7 offset:8704
    ds_read_b64_tr_b16 v[48:49], v6 offset:16384
    ds_read_b64_tr_b16 v[50:51], v6 offset:16896
    ds_read_b64_tr_b16 v[52:53], v7 offset:16384
    ds_read_b64_tr_b16 v[54:55], v7 offset:16896
    ds_read_b64_tr_b16 v[32:33], v6 offset:0
    ds_read_b64_tr_b16 v[34:35], v6 offset:512
    ds_read_b64_tr_b16 v[36:37], v7 offset:0
    ds_read_b64_tr_b16 v[38:39], v7 offset:512
    ds_read_b64_tr_b16 v[96:97], v15 offset:0
    ds_read_b64_tr_b16 v[98:99], v15 offset:1024
    ds_read_b64_tr_b16 v[100:101], v15 offset:256
    ds_read_b64_tr_b16 v[102:103], v15 offset:1280
    .p2align 3
L_Mloop:
    s_waitcnt lgkmcnt(0)
    s_nop 0
    v_mfma_f32_16x16x32_bf16 v[160:163], v[40:43], v[16:19], v[160:163]
    ds_read_b128 v[56:59], v5 offset:0
    v_mfma_f32_16x16x32_bf16 v[164:167], v[40:43], v[20:23], v[164:167]
    ds_read_b64_tr_b16 v[80:81], v6 offset:12288
    v_mfma_f32_16x16x32_bf16 v[168:171], v[40:43], v[24:27], v[168:171]
    ds_read_b64_tr_b16 v[82:83], v6 offset:12800
    v_mfma_f32_16x16x32_bf16 v[172:175], v[40:43], v[28:31], v[172:175]
    ds_read_b128 v[60:63], v5 offset:2048
    v_mfma_f32_16x16x32_bf16 v[188:191], v[44:47], v[28:31], v[188:191]
    ds_read_b128 v[64:67], v5 offset:4096
    v_mfma_f32_16x16x32_bf16 v[184:187], v[44:47], v[24:27], v[184:187]
    ds_read_b128 v[68:71], v5 offset:6144
    v_mfma_f32_16x16x32_bf16 v[180:183], v[44:47], v[20:23], v[180:183]
    ds_read_b64_tr_b16 v[84:85], v7 offset:12288
    v_mfma_f32_16x16x32_bf16 v[176:179], v[44:47], v[16:19], v[176:179]
    ds_read_b64_tr_b16 v[86:87], v7 offset:12800
    v_mfma_f32_16x16x32_bf16 v[192:195], v[48:51], v[16:19], v[192:195]
    ds_read_b64_tr_b16 v[88:89], v6 offset:20480
    v_mfma_f32_16x16x32_bf16 v[196:199], v[48:51], v[20:23], v[196:199]
    ds_read_b64_tr_b16 v[90:91], v6 offset:20992
    v_mfma_f32_16x16x32_bf16 v[200:203], v[48:51], v[24:27], v[200:203]
    ds_read_b64_tr_b16 v[92:93], v7 offset:20480
    v_mfma_f32_16x16x32_bf16 v[204:207], v[48:51], v[28:31], v[204:207]
    ds_read_b64_tr_b16 v[94:95], v7 offset:20992
    v_mfma_f32_16x16x32_bf16 v[220:223], v[52:55], v[28:31], v[220:223]
    ds_read_b64_tr_b16 v[72:73], v6 offset:4096
    v_mfma_f32_16x16x32_bf16 v[216:219], v[52:55], v[24:27], v[216:219]
    ds_read_b64_tr_b16 v[74:75], v6 offset:4608
    v_mfma_f32_16x16x32_bf16 v[212:215], v[52:55], v[20:23], v[212:215]
    ds_read_b64_tr_b16 v[76:77], v7 offset:4096
    v_mfma_f32_16x16x32_bf16 v[208:211], v[52:55], v[16:19], v[208:211]
    ds_read_b64_tr_b16 v[78:79], v7 offset:4608
    v_mfma_f32_16x16x32_bf16 v[128:131], v[32:35], v[16:19], v[128:131]
    s_add_u32 s84, s84, 1
    s_cmp_eq_u32 s82, 2
    s_cselect_b32 s78, s83, 40960
    s_cselect_b32 s82, -1, s82
    s_add_u32 s82, s82, 1
    v_mfma_f32_16x16x32_bf16 v[132:135], v[32:35], v[20:23], v[132:135]
    v_add_u32 v4, s78, v4
    v_add_u32 v5, s78, v5
    v_mfma_f32_16x16x32_bf16 v[136:139], v[32:35], v[24:27], v[136:139]
    v_add_u32 v6, s78, v6
    v_add_u32 v7, s78, v7
    v_mfma_f32_16x16x32_bf16 v[140:143], v[32:35], v[28:31], v[140:143]
    v_mfma_f32_16x16x32_bf16 v[156:159], v[36:39], v[28:31], v[156:159]
    v_mfma_f32_16x16x32_bf16 v[152:155], v[36:39], v[24:27], v[152:155]
    v_mfma_f32_16x16x32_bf16 v[148:151], v[36:39], v[20:23], v[148:151]
    v_mfma_f32_16x16x32_bf16 v[144:147], v[36:39], v[16:19], v[144:147]
    s_waitcnt vmcnt(0) lgkmcnt(0)
    v_mfma_f32_16x16x32_bf16 v[160:163], v[80:83], v[56:59], v[160:163]
    v_mfma_f32_16x16x32_bf16 v[164:167], v[80:83], v[60:63], v[164:167]
    s_barrier
    s_cmp_eq_u32 s84, 16
    s_cbranch_scc1 L_Mtail
    v_mfma_f32_16x16x32_bf16 v[168:171], v[80:83], v[64:67], v[168:171]
    ds_read_b128 v[16:19], v4 offset:0
    v_mfma_f32_16x16x32_bf16 v[172:175], v[80:83], v[68:71], v[172:175]
    ds_read_b64_tr_b16 v[40:41], v6 offset:8192
    v_mfma_f32_16x16x32_bf16 v[188:191], v[84:87], v[68:71], v[188:191]
    ds_read_b64_tr_b16 v[42:43], v6 offset:8704
    v_mfma_f32_16x16x32_bf16 v[184:187], v[84:87], v[64:67], v[184:187]
    ds_read_b128 v[20:23], v4 offset:2048
    v_mfma_f32_16x16x32_bf16 v[180:183], v[84:87], v[60:63], v[180:183]
    ds_read_b128 v[24:27], v4 offset:4096
    v_mfma_f32_16x16x32_bf16 v[176:179], v[84:87], v[56:59], v[176:179]
    ds_read_b128 v[28:31], v4 offset:6144
    v_mfma_f32_16x16x32_bf16 v[192:195], v[88:91], v[56:59], v[192:195]
    ds_read_b64_tr_b16 v[44:45], v7 offset:8192
    v_mfma_f32_16x16x32_bf16 v[196:199], v[88:91], v[60:63], v[196:199]
    ds_read_b64_tr_b16 v[46:47], v7 offset:8704
    v_mfma_f32_16x16x32_bf16 v[200:203], v[88:91], v[64:67], v[200:203]
    ds_read_b64_tr_b16 v[48:49], v6 offset:16384
    v_mfma_f32_16x16x32_bf16 v[204:207], v[88:91], v[68:71], v[204:207]
    ds_read_b64_tr_b16 v[50:51], v6 offset:16896
    v_mfma_f32_16x16x32_bf16 v[220:223], v[92:95], v[68:71], v[220:223]
    ds_read_b64_tr_b16 v[52:53], v7 offset:16384
    v_mfma_f32_16x16x32_bf16 v[216:219], v[92:95], v[64:67], v[216:219]
    ds_read_b64_tr_b16 v[54:55], v7 offset:16896
    v_mfma_f32_16x16x32_bf16 v[212:215], v[92:95], v[60:63], v[212:215]
    ds_read_b64_tr_b16 v[32:33], v6 offset:0
    v_mfma_f32_16x16x32_bf16 v[208:211], v[92:95], v[56:59], v[208:211]
    ds_read_b64_tr_b16 v[34:35], v6 offset:512
    v_mfma_f32_16x16x32_bf16 v[128:131], v[72:75], v[56:59], v[128:131]
    ds_read_b64_tr_b16 v[36:37], v7 offset:0
    v_mfma_f32_16x16x32_bf16 v[132:135], v[72:75], v[60:63], v[132:135]
    ds_read_b64_tr_b16 v[38:39], v7 offset:512
    v_mfma_f32_16x16x32_bf16 v[136:139], v[72:75], v[64:67], v[136:139]
    v_mfma_f32_16x16x32_bf16 v[140:143], v[72:75], v[68:71], v[140:143]
    v_mfma_f32_16x16x32_bf16 v[156:159], v[76:79], v[68:71], v[156:159]
    v_mfma_f32_16x16x32_bf16 v[152:155], v[76:79], v[64:67], v[152:155]
    v_mfma_f32_16x16x32_bf16 v[148:151], v[76:79], v[60:63], v[148:151]
    v_mfma_f32_16x16x32_bf16 v[144:147], v[76:79], v[56:59], v[144:147]
    s_branch L_Mloop
    .p2align 3
L_Mtail:
    s_mov_b64 exec, 0xffff
    ds_read_b64 v[104:105], v11 offset:0
    ds_read_b64 v[106:107], v11 offset:128
    ds_read_b64 v[108:109], v11 offset:256
    ds_read_b64 v[110:111], v11 offset:384
    s_mov_b64 exec, -1
    s_nop 0
    v_mfma_f32_16x16x32_bf16 v[168:171], v[80:83], v[64:67], v[168:171]
    ds_read_b64 v[20:21], v12 offset:512
    v_mfma_f32_16x16x32_bf16 v[172:175], v[80:83], v[68:71], v[172:175]
    ds_read_b64 v[22:23], v12 offset:640
    v_mfma_f32_16x16x32_bf16 v[188:191], v[84:87], v[68:71], v[188:191]
    ds_read_b64 v[24:25], v12 offset:1024
    v_mfma_f32_16x16x32_bf16 v[184:187], v[84:87], v[64:67], v[184:187]
    ds_read_b64 v[26:27], v12 offset:1152
    v_mfma_f32_16x16x32_bf16 v[180:183], v[84:87], v[60:63], v[180:183]
    ds_read_b64 v[16:17], v12 offset:0
    v_mfma_f32_16x16x32_bf16 v[176:179], v[84:87], v[56:59], v[176:179]
    ds_read_b64 v[18:19], v12 offset:128
    v_mfma_f32_16x16x32_bf16 v[192:195], v[88:91], v[56:59], v[192:195]
    ds_read2_b32 v[32:33], v14 offset0:0 offset1:32
    v_mfma_f32_16x16x32_bf16 v[196:199], v[88:91], v[60:63], v[196:199]
    ds_read_b32 v28, v13 offset:0
    v_mfma_f32_16x16x32_bf16 v[200:203], v[88:91], v[64:67], v[200:203]
    ds_read_b32 v30, v13 offset:64
    v_mfma_f32_16x16x32_bf16 v[204:207], v[88:91], v[68:71], v[204:207]
    ds_read_b32 v44, v13 offset:128
    v_mfma_f32_16x16x32_bf16 v[220:223], v[92:95], v[68:71], v[220:223]
    ds_read_b32 v46, v13 offset:192
    v_mfma_f32_16x16x32_bf16 v[216:219], v[92:95], v[64:67], v[216:219]
    v_mfma_f32_16x16x32_bf16 v[212:215], v[92:95], v[60:63], v[212:215]
    v_mfma_f32_16x16x32_bf16 v[208:211], v[92:95], v[56:59], v[208:211]
    s_waitcnt lgkmcnt(0)
    s_nop 0
    v_mfma_f32_16x16x16_bf16 v[160:163], v[20:21], v[104:105], v[160:163]
    v_mfma_f32_16x16x16_bf16 v[176:179], v[22:23], v[104:105], v[176:179]
    v_mfma_f32_16x16x16_bf16 v[164:167], v[20:21], v[106:107], v[164:167]
    v_mfma_f32_16x16x16_bf16 v[180:183], v[22:23], v[106:107], v[180:183]
    v_mfma_f32_16x16x16_bf16 v[168:171], v[20:21], v[108:109], v[168:171]
    v_mfma_f32_16x16x16_bf16 v[184:187], v[22:23], v[108:109], v[184:187]
    v_mfma_f32_16x16x16_bf16 v[172:175], v[20:21], v[110:111], v[172:175]
    v_mfma_f32_16x16x16_bf16 v[188:191], v[22:23], v[110:111], v[188:191]
    v_mul_f32 v34, 0x3fb8aa3b, v32
    v_mul_f32 v48, 0x3fb8aa3b, v33
    v_mfma_f32_16x16x16_bf16 v[192:195], v[24:25], v[104:105], v[192:195]
    v_mfma_f32_16x16x16_bf16 v[208:211], v[26:27], v[104:105], v[208:211]
    v_mfma_f32_16x16x16_bf16 v[196:199], v[24:25], v[106:107], v[196:199]
    v_cvt_pk_bf16_f32 v160, v160, v161
    v_cvt_pk_bf16_f32 v161, v162, v163
    v_cvt_pk_bf16_f32 v162, v176, v177
    v_cvt_pk_bf16_f32 v163, v178, v179
    v_mfma_f32_16x16x16_bf16 v[212:215], v[26:27], v[106:107], v[212:215]
    v_cvt_pk_bf16_f32 v164, v164, v165
    v_cvt_pk_bf16_f32 v165, v166, v167
    v_cvt_pk_bf16_f32 v166, v180, v181
    v_cvt_pk_bf16_f32 v167, v182, v183
    v_mfma_f32_16x16x16_bf16 v[200:203], v[24:25], v[108:109], v[200:203]
    v_cvt_pk_bf16_f32 v168, v168, v169
    v_cvt_pk_bf16_f32 v169, v170, v171
    v_cvt_pk_bf16_f32 v170, v184, v185
    v_cvt_pk_bf16_f32 v171, v186, v187
    v_mfma_f32_16x16x16_bf16 v[216:219], v[26:27], v[108:109], v[216:219]
    v_cvt_pk_bf16_f32 v172, v172, v173
    v_cvt_pk_bf16_f32 v173, v174, v175
    v_cvt_pk_bf16_f32 v174, v188, v189
    v_cvt_pk_bf16_f32 v175, v190, v191
    v_mfma_f32_16x16x16_bf16 v[204:207], v[24:25], v[110:111], v[204:207]
    v_permlane16_swap_b32 v160, v164
    v_permlane16_swap_b32 v161, v165
    v_permlane16_swap_b32 v162, v166
    v_permlane16_swap_b32 v163, v167
    v_mfma_f32_16x16x16_bf16 v[220:223], v[26:27], v[110:111], v[220:223]
    v_permlane16_swap_b32 v168, v172
    v_permlane16_swap_b32 v169, v173
    v_permlane16_swap_b32 v170, v174
    v_permlane16_swap_b32 v171, v175
    v_mfma_f32_32x32x16_bf16 v[224:239], v[96:99], v[160:163], 0
    v_mfma_f32_32x32x16_bf16 v[224:239], v[100:103], v[164:167], v[224:239]
    v_mfma_f32_32x32x16_bf16 v[240:255], v[96:99], v[168:171], 0
    v_mfma_f32_32x32x16_bf16 v[240:255], v[100:103], v[172:175], v[240:255]
    v_pk_mul_f32 v[192:193], v[192:193], v[28:29] op_sel_hi:[1,0]
    v_pk_mul_f32 v[194:195], v[194:195], v[28:29] op_sel_hi:[1,0]
    v_pk_mul_f32 v[208:209], v[208:209], v[28:29] op_sel_hi:[1,0]
    v_pk_mul_f32 v[210:211], v[210:211], v[28:29] op_sel_hi:[1,0]
    v_cvt_pk_bf16_f32 v192, v192, v193
    v_cvt_pk_bf16_f32 v193, v194, v195
    v_cvt_pk_bf16_f32 v194, v208, v209
    v_cvt_pk_bf16_f32 v195, v210, v211
    v_pk_mul_f32 v[196:197], v[196:197], v[30:31] op_sel_hi:[1,0]
    v_pk_mul_f32 v[198:199], v[198:199], v[30:31] op_sel_hi:[1,0]
    v_pk_mul_f32 v[212:213], v[212:213], v[30:31] op_sel_hi:[1,0]
    v_pk_mul_f32 v[214:215], v[214:215], v[30:31] op_sel_hi:[1,0]
    v_cvt_pk_bf16_f32 v196, v196, v197
    v_cvt_pk_bf16_f32 v197, v198, v199
    v_cvt_pk_bf16_f32 v198, v212, v213
    v_cvt_pk_bf16_f32 v199, v214, v215
    v_pk_mul_f32 v[200:201], v[200:201], v[44:45] op_sel_hi:[1,0]
    v_pk_mul_f32 v[202:203], v[202:203], v[44:45] op_sel_hi:[1,0]
    v_pk_mul_f32 v[216:217], v[216:217], v[44:45] op_sel_hi:[1,0]
    v_pk_mul_f32 v[218:219], v[218:219], v[44:45] op_sel_hi:[1,0]
    v_cvt_pk_bf16_f32 v200, v200, v201
    v_cvt_pk_bf16_f32 v201, v202, v203
    v_cvt_pk_bf16_f32 v202, v216, v217
    v_cvt_pk_bf16_f32 v203, v218, v219
    v_pk_mul_f32 v[204:205], v[204:205], v[46:47] op_sel_hi:[1,0]
    v_pk_mul_f32 v[206:207], v[206:207], v[46:47] op_sel_hi:[1,0]
    v_pk_mul_f32 v[220:221], v[220:221], v[46:47] op_sel_hi:[1,0]
    v_pk_mul_f32 v[222:223], v[222:223], v[46:47] op_sel_hi:[1,0]
    v_cvt_pk_bf16_f32 v204, v204, v205
    v_cvt_pk_bf16_f32 v205, v206, v207
    v_cvt_pk_bf16_f32 v206, v220, v221
    v_cvt_pk_bf16_f32 v207, v222, v223
    v_mfma_f32_16x16x32_bf16 v[128:131], v[72:75], v[56:59], v[128:131]
    v_max3_f32 v36, v224, v225, v226
    v_max3_f32 v38, -v224, -v225, -v226
    v_max3_f32 v36, v36, v227, v228
    v_max3_f32 v38, v38, -v227, -v228
    v_mfma_f32_16x16x32_bf16 v[132:135], v[72:75], v[60:63], v[132:135]
    v_max3_f32 v36, v36, v229, v230
    v_max3_f32 v38, v38, -v229, -v230
    v_max3_f32 v36, v36, v231, v232
    v_max3_f32 v38, v38, -v231, -v232
    v_mfma_f32_16x16x32_bf16 v[136:139], v[72:75], v[64:67], v[136:139]
    v_max3_f32 v36, v36, v233, v234
    v_max3_f32 v38, v38, -v233, -v234
    v_max3_f32 v36, v36, v235, v236
    v_max3_f32 v38, v38, -v235, -v236
    v_mfma_f32_16x16x32_bf16 v[140:143], v[72:75], v[68:71], v[140:143]
    v_max3_f32 v36, v36, v237, v238
    v_max3_f32 v38, v38, -v237, -v238
    v_max_f32_e64 v36, v36, v239
    v_max_f32 v38, v38, -v239
    v_mfma_f32_16x16x32_bf16 v[156:159], v[76:79], v[68:71], v[156:159]
    v_max3_f32 v37, v240, v241, v242
    v_max3_f32 v39, -v240, -v241, -v242
    v_max3_f32 v37, v37, v243, v244
    v_max3_f32 v39, v39, -v243, -v244
    v_mfma_f32_16x16x32_bf16 v[152:155], v[76:79], v[64:67], v[152:155]
    v_max3_f32 v37, v37, v245, v246
    v_max3_f32 v39, v39, -v245, -v246
    v_max3_f32 v37, v37, v247, v248
    v_max3_f32 v39, v39, -v247, -v248
    v_mfma_f32_16x16x32_bf16 v[148:151], v[76:79], v[60:63], v[148:151]
    v_max3_f32 v37, v37, v249, v250
    v_max3_f32 v39, v39, -v249, -v250
    v_max3_f32 v37, v37, v251, v252
    v_max3_f32 v39, v39, -v251, -v252
    v_mfma_f32_16x16x32_bf16 v[144:147], v[76:79], v[56:59], v[144:147]
    v_max3_f32 v37, v37, v253, v254
    v_max3_f32 v39, v39, -v253, -v254
    v_max_f32_e64 v37, v37, v255
    v_max_f32 v39, v39, -v255
    v_permlane32_swap_b32 v36, v38
    s_nop 0
    v_permlane32_swap_b32 v37, v39
    v_max_f32 v36, v36, v38
    v_max_f32_e64 v37, v37, v39
    v_mul_f32 v36, -v36, v34
    v_mul_f32 v37, -v37, v48
    v_mov_b32 v38, v36
    v_mov_b32 v39, v37
    s_nop 0
    v_permlane32_swap_b32 v36, v38
    v_permlane32_swap_b32_e64 v37, v39
    v_pk_fma_f32 v[60:61], v[224:225], v[34:35], v[36:37] op_sel_hi:[1,0,0]
    v_pk_fma_f32 v[62:63], v[226:227], v[34:35], v[36:37] op_sel_hi:[1,0,0]
    v_pk_fma_f32 v[64:65], v[228:229], v[34:35], v[36:37] op_sel_hi:[1,0,0]
    v_pk_fma_f32 v[66:67], v[230:231], v[34:35], v[36:37] op_sel_hi:[1,0,0]
    v_pk_fma_f32 v[68:69], v[232:233], v[34:35], v[36:37] op_sel_hi:[1,0,0]
    v_pk_fma_f32 v[70:71], v[234:235], v[34:35], v[36:37] op_sel_hi:[1,0,0]
    v_pk_fma_f32 v[72:73], v[236:237], v[34:35], v[36:37] op_sel_hi:[1,0,0]
    v_pk_fma_f32 v[74:75], v[238:239], v[34:35], v[36:37] op_sel_hi:[1,0,0]
    v_pk_fma_f32 v[76:77], v[224:225], v[34:35], v[38:39] op_sel_hi:[1,0,0] neg_lo:[1,0,0] neg_hi:[1,0,0]
    v_pk_fma_f32 v[78:79], v[226:227], v[34:35], v[38:39] op_sel_hi:[1,0,0] neg_lo:[1,0,0] neg_hi:[1,0,0]
    v_pk_fma_f32 v[80:81], v[228:229], v[34:35], v[38:39] op_sel_hi:[1,0,0] neg_lo:[1,0,0] neg_hi:[1,0,0]
    v_pk_fma_f32 v[82:83], v[230:231], v[34:35], v[38:39] op_sel_hi:[1,0,0] neg_lo:[1,0,0] neg_hi:[1,0,0]
    v_pk_fma_f32 v[84:85], v[232:233], v[34:35], v[38:39] op_sel_hi:[1,0,0] neg_lo:[1,0,0] neg_hi:[1,0,0]
    v_pk_fma_f32 v[86:87], v[234:235], v[34:35], v[38:39] op_sel_hi:[1,0,0] neg_lo:[1,0,0] neg_hi:[1,0,0]
    v_pk_fma_f32 v[88:89], v[236:237], v[34:35], v[38:39] op_sel_hi:[1,0,0] neg_lo:[1,0,0] neg_hi:[1,0,0]
    v_pk_fma_f32 v[90:91], v[238:239], v[34:35], v[38:39] op_sel_hi:[1,0,0] neg_lo:[1,0,0] neg_hi:[1,0,0]
    v_exp_f32 v60, v60
    v_exp_f32 v61, v61
    v_exp_f32 v62, v62
    v_exp_f32 v63, v63
    v_exp_f32 v64, v64
    v_exp_f32 v65, v65
    v_exp_f32 v66, v66
    v_exp_f32 v67, v67
    v_exp_f32 v68, v68
    v_exp_f32 v69, v69
    v_exp_f32 v70, v70
    v_exp_f32 v71, v71
    v_exp_f32 v72, v72
    v_exp_f32 v73, v73
    v_exp_f32 v74, v74
    v_exp_f32 v75, v75
    v_exp_f32 v76, v76
    v_exp_f32 v77, v77
    v_exp_f32 v78, v78
    v_exp_f32 v79, v79
    v_exp_f32 v80, v80
    v_exp_f32 v81, v81
    v_exp_f32 v82, v82
    v_exp_f32 v83, v83
    v_exp_f32 v84, v84
    v_exp_f32 v85, v85
    v_exp_f32 v86, v86
    v_exp_f32 v87, v87
    v_exp_f32 v88, v88
    v_exp_f32 v89, v89
    v_exp_f32 v90, v90
    v_exp_f32 v91, v91
    v_pk_add_f32 v[40:41], v[60:61], v[62:63]
    v_pk_add_f32 v[42:43], v[76:77], v[78:79]
    v_pk_add_f32 v[40:41], v[40:41], v[64:65]
    v_pk_add_f32 v[42:43], v[42:43], v[80:81]
    v_pk_add_f32 v[40:41], v[40:41], v[66:67]
    v_pk_add_f32 v[42:43], v[42:43], v[82:83]
    v_pk_add_f32 v[40:41], v[40:41], v[68:69]
    v_pk_add_f32 v[42:43], v[42:43], v[84:85]
    v_pk_add_f32 v[40:41], v[40:41], v[70:71]
    v_pk_add_f32 v[42:43], v[42:43], v[86:87]
    v_pk_add_f32 v[40:41], v[40:41], v[72:73]
    v_pk_add_f32 v[42:43], v[42:43], v[88:89]
    v_pk_add_f32 v[40:41], v[40:41], v[74:75]
    v_pk_add_f32 v[42:43], v[42:43], v[90:91]
    v_add_f32 v40, v40, v41
    v_add_f32 v42, v42, v43
    s_nop 1
    v_permlane32_swap_b32 v40, v42
    v_add_f32 v40, v40, v42
    v_rcp_f32 v40, v40
    s_nop 0
    v_mov_b32 v42, v40
    s_nop 1
    v_permlane32_swap_b32 v40, v42
    v_pk_mul_f32 v[60:61], v[60:61], v[40:41] op_sel_hi:[1,0]
    v_pk_mul_f32 v[62:63], v[62:63], v[40:41] op_sel_hi:[1,0]
    v_pk_mul_f32 v[64:65], v[64:65], v[40:41] op_sel_hi:[1,0]
    v_pk_mul_f32 v[66:67], v[66:67], v[40:41] op_sel_hi:[1,0]
    v_cvt_pk_bf16_f32 v160, v60, v61
    v_cvt_pk_bf16_f32 v161, v62, v63
    v_cvt_pk_bf16_f32 v162, v64, v65
    v_cvt_pk_bf16_f32 v163, v66, v67
    v_pk_mul_f32 v[68:69], v[68:69], v[40:41] op_sel_hi:[1,0]
    v_pk_mul_f32 v[70:71], v[70:71], v[40:41] op_sel_hi:[1,0]
    v_pk_mul_f32 v[72:73], v[72:73], v[40:41] op_sel_hi:[1,0]
    v_pk_mul_f32 v[74:75], v[74:75], v[40:41] op_sel_hi:[1,0]
    v_cvt_pk_bf16_f32 v164, v68, v69
    v_cvt_pk_bf16_f32 v165, v70, v71
    v_cvt_pk_bf16_f32 v166, v72, v73
    v_cvt_pk_bf16_f32 v167, v74, v75
    v_pk_mul_f32 v[76:77], v[76:77], v[42:43] op_sel_hi:[1,0]
    v_pk_mul_f32 v[78:79], v[78:79], v[42:43] op_sel_hi:[1,0]
    v_pk_mul_f32 v[80:81], v[80:81], v[42:43] op_sel_hi:[1,0]
    v_pk_mul_f32 v[82:83], v[82:83], v[42:43] op_sel_hi:[1,0]
    v_cvt_pk_bf16_f32 v168, v76, v77
    v_cvt_pk_bf16_f32 v169, v78, v79
    v_cvt_pk_bf16_f32 v170, v80, v81
    v_cvt_pk_bf16_f32 v171, v82, v83
    v_pk_mul_f32 v[84:85], v[84:85], v[42:43] op_sel_hi:[1,0]
    v_pk_mul_f32 v[86:87], v[86:87], v[42:43] op_sel_hi:[1,0]
    v_pk_mul_f32 v[88:89], v[88:89], v[42:43] op_sel_hi:[1,0]
    v_pk_mul_f32 v[90:91], v[90:91], v[42:43] op_sel_hi:[1,0]
    v_cvt_pk_bf16_f32 v172, v84, v85
    v_cvt_pk_bf16_f32 v173, v86, v87
    v_cvt_pk_bf16_f32 v174, v88, v89
    v_cvt_pk_bf16_f32 v175, v90, v91
    v_pk_fma_f32 v[60:61], v[240:241], v[48:49], v[36:37] op_sel:[0,0,1] op_sel_hi:[1,0,1]
    v_pk_fma_f32 v[62:63], v[242:243], v[48:49], v[36:37] op_sel:[0,0,1] op_sel_hi:[1,0,1]
    v_pk_fma_f32 v[64:65], v[244:245], v[48:49], v[36:37] op_sel:[0,0,1] op_sel_hi:[1,0,1]
    v_pk_fma_f32 v[66:67], v[246:247], v[48:49], v[36:37] op_sel:[0,0,1] op_sel_hi:[1,0,1]
    v_pk_fma_f32 v[68:69], v[248:249], v[48:49], v[36:37] op_sel:[0,0,1] op_sel_hi:[1,0,1]
    v_pk_fma_f32 v[70:71], v[250:251], v[48:49], v[36:37] op_sel:[0,0,1] op_sel_hi:[1,0,1]
    v_pk_fma_f32 v[72:73], v[252:253], v[48:49], v[36:37] op_sel:[0,0,1] op_sel_hi:[1,0,1]
    v_pk_fma_f32 v[74:75], v[254:255], v[48:49], v[36:37] op_sel:[0,0,1] op_sel_hi:[1,0,1]
    v_pk_fma_f32 v[76:77], v[240:241], v[48:49], v[38:39] op_sel:[0,0,1] op_sel_hi:[1,0,1] neg_lo:[1,0,0] neg_hi:[1,0,0]
    v_pk_fma_f32 v[78:79], v[242:243], v[48:49], v[38:39] op_sel:[0,0,1] op_sel_hi:[1,0,1] neg_lo:[1,0,0] neg_hi:[1,0,0]
    v_pk_fma_f32 v[80:81], v[244:245], v[48:49], v[38:39] op_sel:[0,0,1] op_sel_hi:[1,0,1] neg_lo:[1,0,0] neg_hi:[1,0,0]
    v_pk_fma_f32 v[82:83], v[246:247], v[48:49], v[38:39] op_sel:[0,0,1] op_sel_hi:[1,0,1] neg_lo:[1,0,0] neg_hi:[1,0,0]
    v_pk_fma_f32 v[84:85], v[248:249], v[48:49], v[38:39] op_sel:[0,0,1] op_sel_hi:[1,0,1] neg_lo:[1,0,0] neg_hi:[1,0,0]
    v_pk_fma_f32 v[86:87], v[250:251], v[48:49], v[38:39] op_sel:[0,0,1] op_sel_hi:[1,0,1] neg_lo:[1,0,0] neg_hi:[1,0,0]
    v_pk_fma_f32 v[88:89], v[252:253], v[48:49], v[38:39] op_sel:[0,0,1] op_sel_hi:[1,0,1] neg_lo:[1,0,0] neg_hi:[1,0,0]
    v_pk_fma_f32 v[90:91], v[254:255], v[48:49], v[38:39] op_sel:[0,0,1] op_sel_hi:[1,0,1] neg_lo:[1,0,0] neg_hi:[1,0,0]
    v_exp_f32 v60, v60
    v_exp_f32 v61, v61
    v_exp_f32 v62, v62
    v_exp_f32 v63, v63
    ds_write_b128 v116, v[192:195] offset:0
    v_exp_f32 v64, v64
    v_exp_f32 v65, v65
    v_exp_f32 v66, v66
    v_exp_f32 v67, v67
    ds_write_b128 v116, v[196:199] offset:2048
    v_exp_f32 v68, v68
    v_exp_f32 v69, v69
    v_exp_f32 v70, v70
    v_exp_f32 v71, v71
    ds_write_b128 v116, v[200:203] offset:4096
    v_exp_f32 v72, v72
    v_exp_f32 v73, v73
    v_exp_f32 v74, v74
    v_exp_f32 v75, v75
    ds_write_b128 v116, v[204:207] offset:6144
    v_exp_f32 v76, v76
    v_exp_f32 v77, v77
    v_exp_f32 v78, v78
    v_exp_f32 v79, v79
    ds_write_b128 v112, v[160:163] offset:0
    v_exp_f32 v80, v80
    v_exp_f32 v81, v81
    v_exp_f32 v82, v82
    v_exp_f32 v83, v83
    ds_write_b128 v113, v[164:167] offset:0
    v_exp_f32 v84, v84
    v_exp_f32 v85, v85
    v_exp_f32 v86, v86
    v_exp_f32 v87, v87
    ds_write_b128 v114, v[168:171] offset:0
    v_exp_f32 v88, v88
    v_exp_f32 v89, v89
    v_exp_f32 v90, v90
    v_exp_f32 v91, v91
    ds_write_b128 v115, v[172:175] offset:0
    v_pk_add_f32 v[40:41], v[60:61], v[62:63]
    v_pk_add_f32 v[42:43], v[76:77], v[78:79]
    v_pk_add_f32 v[40:41], v[40:41], v[64:65]
    v_pk_add_f32 v[42:43], v[42:43], v[80:81]
    v_pk_add_f32 v[40:41], v[40:41], v[66:67]
    v_pk_add_f32 v[42:43], v[42:43], v[82:83]
    v_pk_add_f32 v[40:41], v[40:41], v[68:69]
    v_pk_add_f32 v[42:43], v[42:43], v[84:85]
    v_pk_add_f32 v[40:41], v[40:41], v[70:71]
    v_pk_add_f32 v[42:43], v[42:43], v[86:87]
    v_pk_add_f32 v[40:41], v[40:41], v[72:73]
    v_pk_add_f32 v[42:43], v[42:43], v[88:89]
    v_pk_add_f32 v[40:41], v[40:41], v[74:75]
    v_pk_add_f32 v[42:43], v[42:43], v[90:91]
    v_add_f32 v40, v40, v41
    v_add_f32 v42, v42, v43
    s_nop 1
    v_permlane32_swap_b32 v40, v42
    v_add_f32 v40, v40, v42
    v_rcp_f32 v40, v40
    s_nop 0
    v_mov_b32 v42, v40
    s_nop 1
    v_permlane32_swap_b32 v40, v42
    v_pk_mul_f32 v[60:61], v[60:61], v[40:41] op_sel_hi:[1,0]
    v_pk_mul_f32 v[62:63], v[62:63], v[40:41] op_sel_hi:[1,0]
    v_pk_mul_f32 v[64:65], v[64:65], v[40:41] op_sel_hi:[1,0]
    v_pk_mul_f32 v[66:67], v[66:67], v[40:41] op_sel_hi:[1,0]
    v_cvt_pk_bf16_f32 v176, v60, v61
    v_cvt_pk_bf16_f32 v177, v62, v63
    v_cvt_pk_bf16_f32 v178, v64, v65
    v_cvt_pk_bf16_f32 v179, v66, v67
    ds_write_b128 v112, v[176:179] offset:4096
    v_pk_mul_f32 v[68:69], v[68:69], v[40:41] op_sel_hi:[1,0]
    v_pk_mul_f32 v[70:71], v[70:71], v[40:41] op_sel_hi:[1,0]
    v_pk_mul_f32 v[72:73], v[72:73], v[40:41] op_sel_hi:[1,0]
    v_pk_mul_f32 v[74:75], v[74:75], v[40:41] op_sel_hi:[1,0]
    v_cvt_pk_bf16_f32 v180, v68, v69
    v_cvt_pk_bf16_f32 v181, v70, v71
    v_cvt_pk_bf16_f32 v182, v72, v73
    v_cvt_pk_bf16_f32 v183, v74, v75
    ds_write_b128 v113, v[180:183] offset:4096
    v_pk_mul_f32 v[76:77], v[76:77], v[42:43] op_sel_hi:[1,0]
    v_pk_mul_f32 v[78:79], v[78:79], v[42:43] op_sel_hi:[1,0]
    v_pk_mul_f32 v[80:81], v[80:81], v[42:43] op_sel_hi:[1,0]
    v_pk_mul_f32 v[82:83], v[82:83], v[42:43] op_sel_hi:[1,0]
    v_cvt_pk_bf16_f32 v184, v76, v77
    v_cvt_pk_bf16_f32 v185, v78, v79
    v_cvt_pk_bf16_f32 v186, v80, v81
    v_cvt_pk_bf16_f32 v187, v82, v83
    ds_write_b128 v114, v[184:187] offset:4096
    v_pk_mul_f32 v[84:85], v[84:85], v[42:43] op_sel_hi:[1,0]
    v_pk_mul_f32 v[86:87], v[86:87], v[42:43] op_sel_hi:[1,0]
    v_pk_mul_f32 v[88:89], v[88:89], v[42:43] op_sel_hi:[1,0]
    v_pk_mul_f32 v[90:91], v[90:91], v[42:43] op_sel_hi:[1,0]
    v_cvt_pk_bf16_f32 v188, v84, v85
    v_cvt_pk_bf16_f32 v189, v86, v87
    v_cvt_pk_bf16_f32 v190, v88, v89
    v_cvt_pk_bf16_f32 v191, v90, v91
    ds_write_b128 v115, v[188:191] offset:4096
    s_waitcnt lgkmcnt(0)
    s_barrier
    s_setprio 0
    s_nop 0
    v_mfma_f32_16x16x16_bf16 v[128:131], v[16:17], v[104:105], v[128:131]
    v_mfma_f32_16x16x16_bf16 v[144:147], v[18:19], v[104:105], v[144:147]
    v_mfma_f32_16x16x16_bf16 v[132:135], v[16:17], v[106:107], v[132:135]
    v_mfma_f32_16x16x16_bf16 v[148:151], v[18:19], v[106:107], v[148:151]
    v_mfma_f32_16x16x16_bf16 v[136:139], v[16:17], v[108:109], v[136:139]
    v_mfma_f32_16x16x16_bf16 v[152:155], v[18:19], v[108:109], v[152:155]
    v_mfma_f32_16x16x16_bf16 v[140:143], v[16:17], v[110:111], v[140:143]
    v_mfma_f32_16x16x16_bf16 v[156:159], v[18:19], v[110:111], v[156:159]
    v_lshrrev_b32 v11, 5, v2
    s_lshl_b32 s78, s81, 7
    s_add_u32 s78, s78, 162944
    v_lshl_add_u32 v10, v11, 4, s78
    v_and_b32 v12, 31, v2
    v_lshlrev_b32 v12, 4, v12
    v_lshl_add_u32 v11, v11, 10, v12
    v_lshlrev_b32_e64 v14, 4, v2
    v_cvt_pk_bf16_f32 v128, v128, v129
    v_cvt_pk_bf16_f32 v129, v130, v131
    v_cvt_pk_bf16_f32 v130, v144, v145
    v_cvt_pk_bf16_f32 v131, v146, v147
    v_cvt_pk_bf16_f32 v132, v132, v133
    v_cvt_pk_bf16_f32 v133, v134, v135
    v_cvt_pk_bf16_f32 v134, v148, v149
    v_cvt_pk_bf16_f32 v135, v150, v151
    v_cvt_pk_bf16_f32 v136, v136, v137
    v_cvt_pk_bf16_f32 v137, v138, v139
    v_cvt_pk_bf16_f32 v138, v152, v153
    v_cvt_pk_bf16_f32 v139, v154, v155
    v_cvt_pk_bf16_f32 v140, v140, v141
    v_cvt_pk_bf16_f32 v141, v142, v143
    v_cvt_pk_bf16_f32 v142, v156, v157
    v_cvt_pk_bf16_f32 v143, v158, v159
    v_permlane16_swap_b32 v128, v132
    v_permlane16_swap_b32 v129, v133
    v_permlane16_swap_b32 v130, v134
    v_permlane16_swap_b32 v131, v135
    v_permlane16_swap_b32 v136, v140
    v_permlane16_swap_b32 v137, v141
    v_permlane16_swap_b32 v138, v142
    v_permlane16_swap_b32 v139, v143
    v_mfma_f32_32x32x16_bf16 v[224:239], v[96:99], v[128:131], 0
    v_mfma_f32_32x32x16_bf16 v[224:239], v[100:103], v[132:135], v[224:239]
    v_mfma_f32_32x32x16_bf16 v[240:255], v[96:99], v[136:139], 0
    v_mfma_f32_32x32x16_bf16 v[240:255], v[100:103], v[140:143], v[240:255]
    s_lshl_b32 s94, s70, 14
    s_lshl_b32 s79, s81, 13
    s_add_u32 s94, s94, s79
    s_add_u32 s94, s94, 8388608
    s_add_u32 s95, s94, 4096
    s_lshl_b32 s78, s69, 1
    s_add_u32 s78, s78, s80
    s_lshl_b32 s78, s78, 6
    s_lshl_b32 s79, s70, 1
    s_add_u32 s78, s78, s79
    s_add_u32 s78, s78, s81
    s_lshl_b32 s78, s78, 11
    s_add_u32 s96, s78, 4194304
    s_add_u32 s97, s96, 65536
    v_max3_f32 v36, v224, v225, v226
    v_max3_f32 v38, -v224, -v225, -v226
    v_max3_f32 v36, v36, v227, v228
    v_max3_f32 v38, v38, -v227, -v228
    v_max3_f32 v36, v36, v229, v230
    v_max3_f32 v38, v38, -v229, -v230
    v_max3_f32 v36, v36, v231, v232
    v_max3_f32 v38, v38, -v231, -v232
    v_max3_f32 v36, v36, v233, v234
    v_max3_f32 v38, v38, -v233, -v234
    v_max3_f32 v36, v36, v235, v236
    v_max3_f32 v38, v38, -v235, -v236
    v_max3_f32 v36, v36, v237, v238
    v_max3_f32 v38, v38, -v237, -v238
    v_max_f32_e64 v36, v36, v239
    v_max_f32 v38, v38, -v239
    v_max3_f32 v37, v240, v241, v242
    v_max3_f32 v39, -v240, -v241, -v242
    v_max3_f32 v37, v37, v243, v244
    v_max3_f32 v39, v39, -v243, -v244
    v_max3_f32 v37, v37, v245, v246
    v_max3_f32 v39, v39, -v245, -v246
    v_max3_f32 v37, v37, v247, v248
    v_max3_f32 v39, v39, -v247, -v248
    v_max3_f32 v37, v37, v249, v250
    v_max3_f32 v39, v39, -v249, -v250
    v_max3_f32 v37, v37, v251, v252
    v_max3_f32 v39, v39, -v251, -v252
    v_max3_f32 v37, v37, v253, v254
    v_max3_f32 v39, v39, -v253, -v254
    v_max_f32_e64 v37, v37, v255
    v_max_f32 v39, v39, -v255
    v_permlane32_swap_b32 v36, v38
    s_nop 0
    v_permlane32_swap_b32 v37, v39
    v_max_f32 v36, v36, v38
    v_max_f32_e64 v37, v37, v39
    v_mul_f32 v36, -v36, v34
    v_mul_f32 v37, -v37, v48
    v_mov_b32 v38, v36
    v_mov_b32 v39, v37
    s_nop 0
    v_permlane32_swap_b32 v36, v38
    v_permlane32_swap_b32_e64 v37, v39
    v_pk_fma_f32 v[60:61], v[224:225], v[34:35], v[36:37] op_sel_hi:[1,0,0]
    v_pk_fma_f32 v[62:63], v[226:227], v[34:35], v[36:37] op_sel_hi:[1,0,0]
    v_pk_fma_f32 v[64:65], v[228:229], v[34:35], v[36:37] op_sel_hi:[1,0,0]
    v_pk_fma_f32 v[66:67], v[230:231], v[34:35], v[36:37] op_sel_hi:[1,0,0]
    v_pk_fma_f32 v[68:69], v[232:233], v[34:35], v[36:37] op_sel_hi:[1,0,0]
    v_pk_fma_f32 v[70:71], v[234:235], v[34:35], v[36:37] op_sel_hi:[1,0,0]
    v_pk_fma_f32 v[72:73], v[236:237], v[34:35], v[36:37] op_sel_hi:[1,0,0]
    v_pk_fma_f32 v[74:75], v[238:239], v[34:35], v[36:37] op_sel_hi:[1,0,0]
    v_pk_fma_f32 v[76:77], v[224:225], v[34:35], v[38:39] op_sel_hi:[1,0,0] neg_lo:[1,0,0] neg_hi:[1,0,0]
    v_pk_fma_f32 v[78:79], v[226:227], v[34:35], v[38:39] op_sel_hi:[1,0,0] neg_lo:[1,0,0] neg_hi:[1,0,0]
    v_pk_fma_f32 v[80:81], v[228:229], v[34:35], v[38:39] op_sel_hi:[1,0,0] neg_lo:[1,0,0] neg_hi:[1,0,0]
    v_pk_fma_f32 v[82:83], v[230:231], v[34:35], v[38:39] op_sel_hi:[1,0,0] neg_lo:[1,0,0] neg_hi:[1,0,0]
    v_pk_fma_f32 v[84:85], v[232:233], v[34:35], v[38:39] op_sel_hi:[1,0,0] neg_lo:[1,0,0] neg_hi:[1,0,0]
    v_pk_fma_f32 v[86:87], v[234:235], v[34:35], v[38:39] op_sel_hi:[1,0,0] neg_lo:[1,0,0] neg_hi:[1,0,0]
    v_pk_fma_f32 v[88:89], v[236:237], v[34:35], v[38:39] op_sel_hi:[1,0,0] neg_lo:[1,0,0] neg_hi:[1,0,0]
    v_pk_fma_f32 v[90:91], v[238:239], v[34:35], v[38:39] op_sel_hi:[1,0,0] neg_lo:[1,0,0] neg_hi:[1,0,0]
    v_exp_f32 v60, v60
    v_exp_f32 v61, v61
    v_exp_f32 v62, v62
    v_exp_f32 v63, v63
    v_exp_f32 v64, v64
    v_exp_f32 v65, v65
    v_exp_f32 v66, v66
    v_exp_f32 v67, v67
    v_exp_f32 v68, v68
    v_exp_f32 v69, v69
    v_exp_f32 v70, v70
    v_exp_f32 v71, v71
    v_exp_f32 v72, v72
    v_exp_f32 v73, v73
    v_exp_f32 v74, v74
    v_exp_f32 v75, v75
    v_exp_f32 v76, v76
    v_exp_f32 v77, v77
    v_exp_f32 v78, v78
    v_exp_f32 v79, v79
    v_exp_f32 v80, v80
    v_exp_f32 v81, v81
    v_exp_f32 v82, v82
    v_exp_f32 v83, v83
    v_exp_f32 v84, v84
    v_exp_f32 v85, v85
    v_exp_f32 v86, v86
    v_exp_f32 v87, v87
    v_exp_f32 v88, v88
    v_exp_f32 v89, v89
    v_exp_f32 v90, v90
    v_exp_f32 v91, v91
    v_pk_add_f32 v[40:41], v[60:61], v[62:63]
    v_pk_add_f32 v[42:43], v[76:77], v[78:79]
    v_pk_add_f32 v[40:41], v[40:41], v[64:65]
    v_pk_add_f32 v[42:43], v[42:43], v[80:81]
    v_pk_add_f32 v[40:41], v[40:41], v[66:67]
    v_pk_add_f32 v[42:43], v[42:43], v[82:83]
    v_pk_add_f32 v[40:41], v[40:41], v[68:69]
    v_pk_add_f32 v[42:43], v[42:43], v[84:85]
    v_pk_add_f32 v[40:41], v[40:41], v[70:71]
    v_pk_add_f32 v[42:43], v[42:43], v[86:87]
    v_pk_add_f32 v[40:41], v[40:41], v[72:73]
    v_pk_add_f32 v[42:43], v[42:43], v[88:89]
    v_pk_add_f32 v[40:41], v[40:41], v[74:75]
    v_pk_add_f32 v[42:43], v[42:43], v[90:91]
    v_add_f32 v40, v40, v41
    v_add_f32 v42, v42, v43
    s_nop 1
    v_permlane32_swap_b32 v40, v42
    v_add_f32 v40, v40, v42
    v_rcp_f32 v40, v40
    s_nop 0
    v_mov_b32 v42, v40
    s_nop 1
    v_permlane32_swap_b32 v40, v42
    v_pk_mul_f32 v[60:61], v[60:61], v[40:41] op_sel_hi:[1,0]
    v_pk_mul_f32 v[62:63], v[62:63], v[40:41] op_sel_hi:[1,0]
    v_pk_mul_f32 v[64:65], v[64:65], v[40:41] op_sel_hi:[1,0]
    v_pk_mul_f32 v[66:67], v[66:67], v[40:41] op_sel_hi:[1,0]
    v_cvt_pk_bf16_f32 v160, v60, v61
    v_cvt_pk_bf16_f32 v161, v62, v63
    v_cvt_pk_bf16_f32 v162, v64, v65
    v_cvt_pk_bf16_f32 v163, v66, v67
    v_pk_mul_f32 v[68:69], v[68:69], v[40:41] op_sel_hi:[1,0]
    v_pk_mul_f32 v[70:71], v[70:71], v[40:41] op_sel_hi:[1,0]
    v_pk_mul_f32 v[72:73], v[72:73], v[40:41] op_sel_hi:[1,0]
    v_pk_mul_f32 v[74:75], v[74:75], v[40:41] op_sel_hi:[1,0]
    v_cvt_pk_bf16_f32 v164, v68, v69
    v_cvt_pk_bf16_f32 v165, v70, v71
    v_cvt_pk_bf16_f32 v166, v72, v73
    v_cvt_pk_bf16_f32 v167, v74, v75
    v_pk_mul_f32 v[76:77], v[76:77], v[42:43] op_sel_hi:[1,0]
    v_pk_mul_f32 v[78:79], v[78:79], v[42:43] op_sel_hi:[1,0]
    v_pk_mul_f32 v[80:81], v[80:81], v[42:43] op_sel_hi:[1,0]
    v_pk_mul_f32 v[82:83], v[82:83], v[42:43] op_sel_hi:[1,0]
    v_cvt_pk_bf16_f32 v168, v76, v77
    v_cvt_pk_bf16_f32 v169, v78, v79
    v_cvt_pk_bf16_f32 v170, v80, v81
    v_cvt_pk_bf16_f32 v171, v82, v83
    v_pk_mul_f32 v[84:85], v[84:85], v[42:43] op_sel_hi:[1,0]
    v_pk_mul_f32 v[86:87], v[86:87], v[42:43] op_sel_hi:[1,0]
    v_pk_mul_f32 v[88:89], v[88:89], v[42:43] op_sel_hi:[1,0]
    v_pk_mul_f32 v[90:91], v[90:91], v[42:43] op_sel_hi:[1,0]
    v_cvt_pk_bf16_f32 v172, v84, v85
    v_cvt_pk_bf16_f32 v173, v86, v87
    v_cvt_pk_bf16_f32 v174, v88, v89
    v_cvt_pk_bf16_f32 v175, v90, v91
    v_pk_fma_f32 v[60:61], v[240:241], v[48:49], v[36:37] op_sel:[0,0,1] op_sel_hi:[1,0,1]
    v_pk_fma_f32 v[62:63], v[242:243], v[48:49], v[36:37] op_sel:[0,0,1] op_sel_hi:[1,0,1]
    v_pk_fma_f32 v[64:65], v[244:245], v[48:49], v[36:37] op_sel:[0,0,1] op_sel_hi:[1,0,1]
    v_pk_fma_f32 v[66:67], v[246:247], v[48:49], v[36:37] op_sel:[0,0,1] op_sel_hi:[1,0,1]
    v_pk_fma_f32 v[68:69], v[248:249], v[48:49], v[36:37] op_sel:[0,0,1] op_sel_hi:[1,0,1]
    v_pk_fma_f32 v[70:71], v[250:251], v[48:49], v[36:37] op_sel:[0,0,1] op_sel_hi:[1,0,1]
    v_pk_fma_f32 v[72:73], v[252:253], v[48:49], v[36:37] op_sel:[0,0,1] op_sel_hi:[1,0,1]
    v_pk_fma_f32 v[74:75], v[254:255], v[48:49], v[36:37] op_sel:[0,0,1] op_sel_hi:[1,0,1]
    v_pk_fma_f32 v[76:77], v[240:241], v[48:49], v[38:39] op_sel:[0,0,1] op_sel_hi:[1,0,1] neg_lo:[1,0,0] neg_hi:[1,0,0]
    v_pk_fma_f32 v[78:79], v[242:243], v[48:49], v[38:39] op_sel:[0,0,1] op_sel_hi:[1,0,1] neg_lo:[1,0,0] neg_hi:[1,0,0]
    v_pk_fma_f32 v[80:81], v[244:245], v[48:49], v[38:39] op_sel:[0,0,1] op_sel_hi:[1,0,1] neg_lo:[1,0,0] neg_hi:[1,0,0]
    v_pk_fma_f32 v[82:83], v[246:247], v[48:49], v[38:39] op_sel:[0,0,1] op_sel_hi:[1,0,1] neg_lo:[1,0,0] neg_hi:[1,0,0]
    v_pk_fma_f32 v[84:85], v[248:249], v[48:49], v[38:39] op_sel:[0,0,1] op_sel_hi:[1,0,1] neg_lo:[1,0,0] neg_hi:[1,0,0]
    v_pk_fma_f32 v[86:87], v[250:251], v[48:49], v[38:39] op_sel:[0,0,1] op_sel_hi:[1,0,1] neg_lo:[1,0,0] neg_hi:[1,0,0]
    v_pk_fma_f32 v[88:89], v[252:253], v[48:49], v[38:39] op_sel:[0,0,1] op_sel_hi:[1,0,1] neg_lo:[1,0,0] neg_hi:[1,0,0]
    v_pk_fma_f32 v[90:91], v[254:255], v[48:49], v[38:39] op_sel:[0,0,1] op_sel_hi:[1,0,1] neg_lo:[1,0,0] neg_hi:[1,0,0]
    v_exp_f32 v60, v60
    v_exp_f32 v61, v61
    v_exp_f32 v62, v62
    v_exp_f32 v63, v63
    v_exp_f32 v64, v64
    v_exp_f32 v65, v65
    v_exp_f32 v66, v66
    v_exp_f32 v67, v67
    v_exp_f32 v68, v68
    v_exp_f32 v69, v69
    v_exp_f32 v70, v70
    v_exp_f32 v71, v71
    v_exp_f32 v72, v72
    v_exp_f32 v73, v73
    v_exp_f32 v74, v74
    v_exp_f32 v75, v75
    v_exp_f32 v76, v76
    v_exp_f32 v77, v77
    v_exp_f32 v78, v78
    v_exp_f32 v79, v79
    v_exp_f32 v80, v80
    v_exp_f32 v81, v81
    v_exp_f32 v82, v82
    v_exp_f32 v83, v83
    v_exp_f32 v84, v84
    v_exp_f32 v85, v85
    v_exp_f32 v86, v86
    v_exp_f32 v87, v87
    v_exp_f32 v88, v88
    v_exp_f32 v89, v89
    v_exp_f32 v90, v90
    v_exp_f32 v91, v91
    v_pk_add_f32 v[40:41], v[60:61], v[62:63]
    v_pk_add_f32 v[42:43], v[76:77], v[78:79]
    v_pk_add_f32 v[40:41], v[40:41], v[64:65]
    v_pk_add_f32 v[42:43], v[42:43], v[80:81]
    v_pk_add_f32 v[40:41], v[40:41], v[66:67]
    v_pk_add_f32 v[42:43], v[42:43], v[82:83]
    v_pk_add_f32 v[40:41], v[40:41], v[68:69]
    v_pk_add_f32 v[42:43], v[42:43], v[84:85]
    v_pk_add_f32 v[40:41], v[40:41], v[70:71]
    v_pk_add_f32 v[42:43], v[42:43], v[86:87]
    v_pk_add_f32 v[40:41], v[40:41], v[72:73]
    v_pk_add_f32 v[42:43], v[42:43], v[88:89]
    v_pk_add_f32 v[40:41], v[40:41], v[74:75]
    v_pk_add_f32 v[42:43], v[42:43], v[90:91]
    v_add_f32 v40, v40, v41
    v_add_f32 v42, v42, v43
    s_nop 1
    v_permlane32_swap_b32 v40, v42
    v_add_f32 v40, v40, v42
    v_rcp_f32 v40, v40
    s_nop 0
    v_mov_b32 v42, v40
    s_nop 1
    v_permlane32_swap_b32 v40, v42
    v_pk_mul_f32 v[60:61], v[60:61], v[40:41] op_sel_hi:[1,0]
    v_pk_mul_f32 v[62:63], v[62:63], v[40:41] op_sel_hi:[1,0]
    v_pk_mul_f32 v[64:65], v[64:65], v[40:41] op_sel_hi:[1,0]
    v_pk_mul_f32 v[66:67], v[66:67], v[40:41] op_sel_hi:[1,0]
    v_cvt_pk_bf16_f32 v176, v60, v61
    v_cvt_pk_bf16_f32 v177, v62, v63
    v_cvt_pk_bf16_f32 v178, v64, v65
    v_cvt_pk_bf16_f32 v179, v66, v67
    v_pk_mul_f32 v[68:69], v[68:69], v[40:41] op_sel_hi:[1,0]
    v_pk_mul_f32 v[70:71], v[70:71], v[40:41] op_sel_hi:[1,0]
    v_pk_mul_f32 v[72:73], v[72:73], v[40:41] op_sel_hi:[1,0]
    v_pk_mul_f32 v[74:75], v[74:75], v[40:41] op_sel_hi:[1,0]
    v_cvt_pk_bf16_f32 v180, v68, v69
    v_cvt_pk_bf16_f32 v181, v70, v71
    v_cvt_pk_bf16_f32 v182, v72, v73
    v_cvt_pk_bf16_f32 v183, v74, v75
    v_pk_mul_f32 v[76:77], v[76:77], v[42:43] op_sel_hi:[1,0]
    v_pk_mul_f32 v[78:79], v[78:79], v[42:43] op_sel_hi:[1,0]
    v_pk_mul_f32 v[80:81], v[80:81], v[42:43] op_sel_hi:[1,0]
    v_pk_mul_f32 v[82:83], v[82:83], v[42:43] op_sel_hi:[1,0]
    v_cvt_pk_bf16_f32 v184, v76, v77
    v_cvt_pk_bf16_f32 v185, v78, v79
    v_cvt_pk_bf16_f32 v186, v80, v81
    v_cvt_pk_bf16_f32 v187, v82, v83
    v_pk_mul_f32 v[84:85], v[84:85], v[42:43] op_sel_hi:[1,0]
    v_pk_mul_f32 v[86:87], v[86:87], v[42:43] op_sel_hi:[1,0]
    v_pk_mul_f32 v[88:89], v[88:89], v[42:43] op_sel_hi:[1,0]
    v_pk_mul_f32 v[90:91], v[90:91], v[42:43] op_sel_hi:[1,0]
    v_cvt_pk_bf16_f32 v188, v84, v85
    v_cvt_pk_bf16_f32 v189, v86, v87
    v_cvt_pk_bf16_f32 v190, v88, v89
    v_cvt_pk_bf16_f32 v191, v90, v91
    s_barrier
    s_setprio 1
    ds_read_b128 v[16:19], v10 offset:0
    ds_read_b128 v[20:23], v10 offset:32
    ds_read_b128 v[24:27], v10 offset:64
    ds_read_b128 v[28:31], v10 offset:96
    s_waitcnt lgkmcnt(3)
    v_mfma_f32_32x32x16_bf16 v[224:239], v[16:19], v[160:163], 0
    s_waitcnt lgkmcnt(2)
    v_mfma_f32_32x32x16_bf16 v[224:239], v[20:23], v[164:167], v[224:239]
    s_waitcnt lgkmcnt(1)
    v_mfma_f32_32x32x16_bf16 v[224:239], v[24:27], v[168:171], v[224:239]
    s_waitcnt lgkmcnt(0)
    v_mfma_f32_32x32x16_bf16 v[224:239], v[28:31], v[172:175], v[224:239]
    v_mfma_f32_32x32x16_bf16 v[240:255], v[16:19], v[176:179], 0
    v_mfma_f32_32x32x16_bf16 v[240:255], v[20:23], v[180:183], v[240:255]
    v_mfma_f32_32x32x16_bf16 v[240:255], v[24:27], v[184:187], v[240:255]
    v_mfma_f32_32x32x16_bf16 v[240:255], v[28:31], v[188:191], v[240:255]
    s_sleep 6
    buffer_load_dwordx4 v[96:99], v11, s[36:39], s94 offen offset:0 sc1
    buffer_load_dwordx4 v[100:103], v11, s[36:39], s94 offen offset:2048 sc1
    buffer_load_dwordx4 v[104:107], v11, s[36:39], s95 offen offset:0 sc1
    buffer_load_dwordx4 v[108:111], v11, s[36:39], s95 offen offset:2048 sc1
    s_nop 2
    v_add_f32 v36, 0x358637bd, v224
    s_nop 2
    v_add_f32 v38, 0x358637bd, v240
    v_rcp_f32 v36, v36
    v_rcp_f32_e64 v38, v38
    s_barrier
    s_mov_b32 s85, 0
    s_branch L_kvchk
L_kvspin:
    s_add_u32 s85, s85, 1
    s_cmp_gt_u32 s85, 400000
    s_cbranch_scc1 L_end
    buffer_load_dwordx4 v[96:99], v11, s[36:39], s94 offen offset:0 sc1
    buffer_load_dwordx4 v[100:103], v11, s[36:39], s94 offen offset:2048 sc1
    buffer_load_dwordx4 v[104:107], v11, s[36:39], s95 offen offset:0 sc1
    buffer_load_dwordx4 v[108:111], v11, s[36:39], s95 offen offset:2048 sc1
L_kvchk:
    s_waitcnt vmcnt(0)
    v_max3_u32 v13, v96, v97, v98
    v_max3_u32 v10, v99, v100, v101
    v_max3_u32 v13, v13, v102, v103
    v_max3_u32 v10, v10, v104, v105
    v_max3_u32 v13, v13, v106, v107
    v_max3_u32 v10, v10, v108, v109
    v_max3_u32 v13, v13, v110, v111
    v_max_u32 v13, v13, v10
    v_cmp_eq_u32_e64 vcc, -1, v13
    s_cbranch_vccnz L_kvspin
    v_mfma_f32_32x32x16_bf16 v[60:75], v[96:99], v[160:163], 0
    v_mfma_f32_32x32x16_bf16 v[60:75], v[100:103], v[164:167], v[60:75]
    v_mfma_f32_32x32x16_bf16 v[60:75], v[104:107], v[168:171], v[60:75]
    v_mfma_f32_32x32x16_bf16 v[60:75], v[108:111], v[172:175], v[60:75]
    v_mfma_f32_32x32x16_bf16 v[76:91], v[96:99], v[176:179], 0
    v_mfma_f32_32x32x16_bf16 v[76:91], v[100:103], v[180:183], v[76:91]
    v_mfma_f32_32x32x16_bf16 v[76:91], v[104:107], v[184:187], v[76:91]
    v_mfma_f32_32x32x16_bf16 v[76:91], v[108:111], v[188:191], v[76:91]
    s_nop 7
    v_mul_f32 v60, v60, v36
    v_mul_f32 v61, v61, v36
    v_mul_f32 v62, v62, v36
    v_mul_f32 v63, v63, v36
    v_mul_f32 v64, v64, v36
    v_mul_f32 v65, v65, v36
    v_mul_f32 v66, v66, v36
    v_mul_f32_e64 v67, v67, v36
    v_cvt_pk_bf16_f32 v16, v60, v61
    v_cvt_pk_bf16_f32 v17, v62, v63
    v_cvt_pk_bf16_f32 v18, v64, v65
    v_cvt_pk_bf16_f32 v19, v66, v67
    buffer_store_dwordx4 v[16:19], v14, s[36:39], s96 offen offset:0 sc1
    v_mul_f32 v68, v68, v36
    v_mul_f32 v69, v69, v36
    v_mul_f32 v70, v70, v36
    v_mul_f32 v71, v71, v36
    v_mul_f32 v72, v72, v36
    v_mul_f32 v73, v73, v36
    v_mul_f32 v74, v74, v36
    v_mul_f32 v75, v75, v36
    v_cvt_pk_bf16_f32 v20, v68, v69
    v_cvt_pk_bf16_f32 v21, v70, v71
    v_cvt_pk_bf16_f32 v22, v72, v73
    v_cvt_pk_bf16_f32 v23, v74, v75
    buffer_store_dwordx4 v[20:23], v14, s[36:39], s96 offen offset:1024 sc1
    v_pk_mul_f32 v[76:77], v[76:77], v[38:39] op_sel_hi:[1,0]
    v_pk_mul_f32 v[78:79], v[78:79], v[38:39] op_sel_hi:[1,0]
    v_pk_mul_f32 v[80:81], v[80:81], v[38:39] op_sel_hi:[1,0]
    v_pk_mul_f32 v[82:83], v[82:83], v[38:39] op_sel_hi:[1,0]
    v_cvt_pk_bf16_f32 v24, v76, v77
    v_cvt_pk_bf16_f32 v25, v78, v79
    v_cvt_pk_bf16_f32 v26, v80, v81
    v_cvt_pk_bf16_f32 v27, v82, v83
    buffer_store_dwordx4 v[24:27], v14, s[36:39], s97 offen offset:0 sc1
    v_pk_mul_f32 v[84:85], v[84:85], v[38:39] op_sel_hi:[1,0]
    v_pk_mul_f32 v[86:87], v[86:87], v[38:39] op_sel_hi:[1,0]
    v_pk_mul_f32 v[88:89], v[88:89], v[38:39] op_sel_hi:[1,0]
    v_pk_mul_f32 v[90:91], v[90:91], v[38:39] op_sel_hi:[1,0]
    v_cvt_pk_bf16_f32 v28, v84, v85
    v_cvt_pk_bf16_f32 v29, v86, v87
    v_cvt_pk_bf16_f32 v30, v88, v89
    v_cvt_pk_bf16_f32 v31, v90, v91
    buffer_store_dwordx4 v[28:31], v14, s[36:39], s97 offen offset:1024 sc1
    v_and_b32 v8, 31, v2
    v_lshrrev_b32 v9, 5, v2
    v_lshlrev_b32 v10, 3, v9
    s_lshl_b32 s78, s72, 7
    buffer_load_dwordx2 v[32:33], v10, s[64:67], s78 offen offset:0
    buffer_load_dwordx2 v[34:35], v10, s[64:67], s78 offen offset:16
    buffer_load_dwordx2 v[36:37], v10, s[64:67], s78 offen offset:32
    buffer_load_dwordx2 v[38:39], v10, s[64:67], s78 offen offset:48
    buffer_load_dwordx2 v[40:41], v10, s[64:67], s78 offen offset:64
    buffer_load_dwordx2 v[42:43], v10, s[64:67], s78 offen offset:80
    buffer_load_dwordx2 v[44:45], v10, s[64:67], s78 offen offset:96
    buffer_load_dwordx2 v[46:47], v10, s[64:67], s78 offen offset:112
    buffer_load_dwordx4 v[48:51], v14, s[64:67], 0 offen
    buffer_load_dwordx4 v[52:55], v14, s[64:67], 0 offen offset:1024
    s_barrier
    s_lshl_b32 s78, s76, 12
    s_add_u32 s78, s78, 131072
    v_lshl_add_u32 v6, v8, 7, s78
    v_add_u32_e64 v6, v6, v10
    v_bfe_u32 v11, v8, 1, 3
    v_lshl_add_u32 v6, v11, 4, v6
    v_xor_b32_e64 v112, 0, v6
    ds_read_b64 v[96:97], v112
    v_xor_b32_e64 v113, 16, v6
    ds_read_b64 v[98:99], v113
    v_xor_b32_e64 v114, 32, v6
    ds_read_b64 v[100:101], v114
    v_xor_b32_e64 v115, 48, v6
    ds_read_b64 v[102:103], v115
    v_xor_b32_e64 v116, 64, v6
    ds_read_b64 v[104:105], v116
    v_xor_b32 v117, 80, v6
    ds_read_b64 v[106:107], v117
    v_xor_b32 v118, 96, v6
    ds_read_b64 v[108:109], v118
    v_xor_b32 v119, 112, v6
    ds_read_b64 v[110:111], v119
    v_bfe_u32 v11, v2, 2, 2
    v_lshl_add_u32 v12, v9, 2, v11
    v_lshlrev_b32 v12, 7, v12
    v_lshrrev_b32 v11, 1, v11
    v_lshl_add_u32 v12, v11, 6, v12
    v_bfe_u32 v11, v2, 4, 1
    v_lshl_add_u32 v12, v11, 5, v12
    v_and_b32_e64 v11, 3, v2
    v_lshl_add_u32 v12, v11, 3, v12
    s_lshl_b32 s82, s72, 0
    s_and_b32 s82, s82, 15
    s_lshl_b32 s78, s82, 13
    v_add_u32 v4, s78, v12
    v_xor_b32 v5, 64, v4
    s_lshl_b32 s83, s71, 2
    s_add_u32 s83, s83, s76
    s_lshl_b32 s83, s83, 16
    s_add_u32 s83, s83, 4194304
    s_lshl_b32 s82, s82, 12
    s_add_u32 s88, s82, s83
    s_waitcnt lgkmcnt(0)
    v_lshlrev_b32 v224, 16, v96
    v_and_b32 v225, 0xffff0000, v96
    v_lshlrev_b32_e64 v226, 16, v97
    v_and_b32 v227, 0xffff0000, v97
    v_lshlrev_b32_e64 v228, 16, v98
    v_and_b32 v229, 0xffff0000, v98
    v_lshlrev_b32_e64 v230, 16, v99
    v_and_b32 v231, 0xffff0000, v99
    v_lshlrev_b32_e64 v232, 16, v100
    v_and_b32 v233, 0xffff0000, v100
    v_lshlrev_b32_e64 v234, 16, v101
    v_and_b32 v235, 0xffff0000, v101
    v_lshlrev_b32_e64 v236, 16, v102
    v_and_b32 v237, 0xffff0000, v102
    v_lshlrev_b32_e64 v238, 16, v103
    v_and_b32 v239, 0xffff0000, v103
    v_lshlrev_b32_e64 v240, 16, v104
    v_and_b32 v241, 0xffff0000, v104
    v_lshlrev_b32_e64 v242, 16, v105
    v_and_b32 v243, 0xffff0000, v105
    v_lshlrev_b32_e64 v244, 16, v106
    v_and_b32 v245, 0xffff0000, v106
    v_lshlrev_b32_e64 v246, 16, v107
    v_and_b32 v247, 0xffff0000, v107
    v_lshlrev_b32_e64 v248, 16, v108
    v_and_b32 v249, 0xffff0000, v108
    v_lshlrev_b32_e64 v250, 16, v109
    v_and_b32 v251, 0xffff0000, v109
    v_lshlrev_b32_e64 v252, 16, v110
    v_and_b32 v253, 0xffff0000, v110
    v_lshlrev_b32_e64 v254, 16, v111
    v_and_b32 v255, 0xffff0000, v111
    s_waitcnt vmcnt(0)
    s_barrier
    v_lshlrev_b32_e64 v60, 16, v32
    v_and_b32 v61, 0xffff0000, v32
    v_lshlrev_b32_e64 v62, 16, v33
    v_and_b32 v63, 0xffff0000, v33
    v_lshlrev_b32_e64 v64, 16, v34
    v_and_b32 v65, 0xffff0000, v34
    v_lshlrev_b32_e64 v66, 16, v35
    v_and_b32 v67, 0xffff0000, v35
    v_lshlrev_b32_e64 v68, 16, v36
    v_and_b32 v69, 0xffff0000, v36
    v_lshlrev_b32_e64 v70, 16, v37
    v_and_b32 v71, 0xffff0000, v37
    v_lshlrev_b32_e64 v72, 16, v38
    v_and_b32 v73, 0xffff0000, v38
    v_lshlrev_b32_e64 v74, 16, v39
    v_and_b32 v75, 0xffff0000, v39
    v_lshlrev_b32_e64 v76, 16, v40
    v_and_b32 v77, 0xffff0000, v40
    v_lshlrev_b32_e64 v78, 16, v41
    v_and_b32 v79, 0xffff0000, v41
    v_lshlrev_b32_e64 v80, 16, v42
    v_and_b32 v81, 0xffff0000, v42
    v_lshlrev_b32_e64 v82, 16, v43
    v_and_b32 v83, 0xffff0000, v43
    v_lshlrev_b32_e64 v84, 16, v44
    v_and_b32 v85, 0xffff0000, v44
    v_lshlrev_b32_e64 v86, 16, v45
    v_and_b32 v87, 0xffff0000, v45
    v_lshlrev_b32_e64 v88, 16, v46
    v_and_b32 v89, 0xffff0000, v46
    v_lshlrev_b32_e64 v90, 16, v47
    v_and_b32 v91, 0xffff0000, v47
    s_mov_b32 s78, 0x3f803f80
    v_dot2_f32_bf16 v126, v48, s78, 0
    v_dot2_f32_bf16 v126, v49, s78, v126
    v_dot2_f32_bf16 v126, v50, s78, v126
    v_dot2_f32_bf16 v126, v51, s78, v126
    v_dot2_f32_bf16 v126, v52, s78, v126
    v_dot2_f32_bf16 v126, v53, s78, v126
    v_dot2_f32_bf16 v126, v54, s78, v126
    v_dot2_f32_bf16 v126, v55, s78, v126
    s_nop 2
    v_add_f32_dpp v126, v126, v126 row_ror:8 row_mask:0xf bank_mask:0xf
    s_nop 1
    v_add_f32_dpp v126, v126, v126 row_ror:4 row_mask:0xf bank_mask:0xf
    s_nop 1
    v_add_f32_dpp v126, v126, v126 row_ror:2 row_mask:0xf bank_mask:0xf
    s_nop 1
    v_add_f32_dpp v126, v126, v126 row_ror:1 row_mask:0xf bank_mask:0xf
    v_mov_b32 v127, v126
    s_nop 1
    v_permlane32_swap_b32 v126, v127
    v_add_f32 v126, v126, v127
    v_mov_b32 v127, v126
    s_nop 1
    v_permlane16_swap_b32 v126, v127
    v_add_f32 v126, v126, v127
    v_lshlrev_b32_e64 v12, 4, v8
    v_lshl_add_u32 v12, v9, 14, v12
    s_lshl_b32 s94, s71, 15
    s_lshl_b32 s79, s76, 9
    s_add_u32 s94, s94, s79
    s_add_u32 s94, s94, 1572864
    s_lshl_b32 s95, s72, 11
    s_add_u32 s95, s95, s94
    s_lshl_b32 s78, s76, 5
    v_add_u32 v11, s78, v8
    v_and_b32 v13, 7, v8
    v_xor_b32 v13, v13, v9
    v_lshlrev_b32 v13, 4, v13
    v_lshl_add_u32 v13, v11, 8, v13
    v_lshlrev_b32_e64 v10, 3, v11
    v_add_u32 v10, 159744, v10
    s_lshl_b32 s78, s71, 7
    v_add_u32 v11, s78, v11
    s_mov_b32 s84, 0
    s_barrier
    buffer_load_dwordx4 v[160:163], v14, s[36:39], s88 offen offset:0 sc1
    ds_read_b64_tr_b16 v[128:129], v4 offset:0
    buffer_load_dwordx4 v[164:167], v14, s[36:39], s88 offen offset:1024 sc1
    ds_read_b64_tr_b16 v[130:131], v4 offset:1024
    buffer_load_dwordx4 v[168:171], v14, s[36:39], s88 offen offset:2048 sc1
    ds_read_b64_tr_b16 v[132:133], v5 offset:0
    buffer_load_dwordx4 v[172:175], v14, s[36:39], s88 offen offset:3072 sc1
    s_add_u32 s82, s82, 4096
    s_and_b32 s82, s82, 0xffff
    s_add_u32 s88, s82, s83
    s_nop 0
    ds_read_b64_tr_b16 v[134:135], v5 offset:1024
    buffer_load_dwordx4 v[176:179], v14, s[36:39], s88 offen offset:0 sc1
    ds_read_b64_tr_b16 v[136:137], v4 offset:2048
    buffer_load_dwordx4 v[180:183], v14, s[36:39], s88 offen offset:1024 sc1
    ds_read_b64_tr_b16 v[138:139], v4 offset:3072
    buffer_load_dwordx4 v[184:187], v14, s[36:39], s88 offen offset:2048 sc1
    ds_read_b64_tr_b16 v[140:141], v5 offset:2048
    buffer_load_dwordx4 v[188:191], v14, s[36:39], s88 offen offset:3072 sc1
    s_add_u32 s82, s82, 4096
    s_and_b32 s82, s82, 0xffff
    s_add_u32 s88, s82, s83
    s_nop 0
    ds_read_b64_tr_b16 v[142:143], v5 offset:3072
    buffer_load_dwordx4 v[192:195], v14, s[36:39], s88 offen offset:0 sc1
    buffer_load_dwordx4 v[196:199], v14, s[36:39], s88 offen offset:1024 sc1
    buffer_load_dwordx4 v[200:203], v14, s[36:39], s88 offen offset:2048 sc1
    buffer_load_dwordx4 v[204:207], v14, s[36:39], s88 offen offset:3072 sc1
    s_add_u32 s82, s82, 4096
    s_and_b32 s82, s82, 0xffff
    s_add_u32 s88, s82, s83
    buffer_load_dwordx4 v[208:211], v14, s[36:39], s88 offen offset:0 sc1
    buffer_load_dwordx4 v[212:215], v14, s[36:39], s88 offen offset:1024 sc1
    .p2align 3
L_G2:
    s_add_u32 s84, s84, 1
    s_waitcnt vmcnt(12) lgkmcnt(6)
    v_mfma_f32_32x32x16_bf16 v[224:239], v[128:131], v[160:163], v[224:239]
    ds_read_b64_tr_b16 v[144:145], v4 offset:4096
    ds_read_b64_tr_b16 v[146:147], v4 offset:5120
    buffer_load_dwordx4 v[216:219], v14, s[36:39], s88 offen offset:2048 sc1
    s_waitcnt lgkmcnt(6)
    v_mfma_f32_32x32x16_bf16 v[240:255], v[132:135], v[160:163], v[240:255]
    ds_read_b64_tr_b16 v[148:149], v5 offset:4096
    ds_read_b64_tr_b16 v[150:151], v5 offset:5120
    s_waitcnt lgkmcnt(6)
    v_mfma_f32_32x32x16_bf16 v[224:239], v[136:139], v[164:167], v[224:239]
    ds_read_b64_tr_b16 v[152:153], v4 offset:6144
    ds_read_b64_tr_b16 v[154:155], v4 offset:7168
    buffer_load_dwordx4 v[220:223], v14, s[36:39], s88 offen offset:3072 sc1
    s_add_u32 s82, s82, 4096
    s_and_b32 s82, s82, 0xffff
    s_add_u32 s88, s82, s83
    s_waitcnt lgkmcnt(6)
    v_mfma_f32_32x32x16_bf16 v[240:255], v[140:143], v[164:167], v[240:255]
    ds_read_b64_tr_b16 v[156:157], v5 offset:6144
    ds_read_b64_tr_b16 v[158:159], v5 offset:7168
    v_add_u32 v4, 0x2000, v4
    v_and_b32 v4, 0x1ffff, v4
    v_xor_b32 v5, 64, v4
    s_waitcnt vmcnt(12) lgkmcnt(6)
    v_mfma_f32_32x32x16_bf16 v[224:239], v[144:147], v[168:171], v[224:239]
    ds_read_b64_tr_b16 v[128:129], v4 offset:0
    ds_read_b64_tr_b16 v[130:131], v4 offset:1024
    buffer_load_dwordx4 v[160:163], v14, s[36:39], s88 offen offset:0 sc1
    s_waitcnt lgkmcnt(6)
    v_mfma_f32_32x32x16_bf16 v[240:255], v[148:151], v[168:171], v[240:255]
    ds_read_b64_tr_b16 v[132:133], v5 offset:0
    ds_read_b64_tr_b16 v[134:135], v5 offset:1024
    s_waitcnt lgkmcnt(6)
    v_mfma_f32_32x32x16_bf16 v[224:239], v[152:155], v[172:175], v[224:239]
    ds_read_b64_tr_b16 v[136:137], v4 offset:2048
    ds_read_b64_tr_b16 v[138:139], v4 offset:3072
    buffer_load_dwordx4 v[164:167], v14, s[36:39], s88 offen offset:1024 sc1
    s_waitcnt lgkmcnt(6)
    v_mfma_f32_32x32x16_bf16 v[240:255], v[156:159], v[172:175], v[240:255]
    ds_read_b64_tr_b16 v[140:141], v5 offset:2048
    ds_read_b64_tr_b16 v[142:143], v5 offset:3072
    s_waitcnt vmcnt(12) lgkmcnt(6)
    v_mfma_f32_32x32x16_bf16 v[224:239], v[128:131], v[176:179], v[224:239]
    ds_read_b64_tr_b16 v[144:145], v4 offset:4096
    ds_read_b64_tr_b16 v[146:147], v4 offset:5120
    buffer_load_dwordx4 v[168:171], v14, s[36:39], s88 offen offset:2048 sc1
    s_waitcnt lgkmcnt(6)
    v_mfma_f32_32x32x16_bf16 v[240:255], v[132:135], v[176:179], v[240:255]
    ds_read_b64_tr_b16 v[148:149], v5 offset:4096
    ds_read_b64_tr_b16 v[150:151], v5 offset:5120
    s_waitcnt lgkmcnt(6)
    v_mfma_f32_32x32x16_bf16 v[224:239], v[136:139], v[180:183], v[224:239]
    ds_read_b64_tr_b16 v[152:153], v4 offset:6144
    ds_read_b64_tr_b16 v[154:155], v4 offset:7168
    buffer_load_dwordx4 v[172:175], v14, s[36:39], s88 offen offset:3072 sc1
    s_add_u32 s82, s82, 4096
    s_and_b32 s82, s82, 0xffff
    s_add_u32 s88, s82, s83
    s_waitcnt lgkmcnt(6)
    v_mfma_f32_32x32x16_bf16 v[240:255], v[140:143], v[180:183], v[240:255]
    ds_read_b64_tr_b16 v[156:157], v5 offset:6144
    ds_read_b64_tr_b16 v[158:159], v5 offset:7168
    v_add_u32 v4, 0x2000, v4
    v_and_b32 v4, 0x1ffff, v4
    v_xor_b32 v5, 64, v4
    s_waitcnt vmcnt(12) lgkmcnt(6)
    v_mfma_f32_32x32x16_bf16 v[224:239], v[144:147], v[184:187], v[224:239]
    ds_read_b64_tr_b16 v[128:129], v4 offset:0
    ds_read_b64_tr_b16 v[130:131], v4 offset:1024
    buffer_load_dwordx4 v[176:179], v14, s[36:39], s88 offen offset:0 sc1
    s_waitcnt lgkmcnt(6)
    v_mfma_f32_32x32x16_bf16 v[240:255], v[148:151], v[184:187], v[240:255]
    ds_read_b64_tr_b16 v[132:133], v5 offset:0
    ds_read_b64_tr_b16 v[134:135], v5 offset:1024
    s_waitcnt lgkmcnt(6)
    v_mfma_f32_32x32x16_bf16 v[224:239], v[152:155], v[188:191], v[224:239]
    ds_read_b64_tr_b16 v[136:137], v4 offset:2048
    ds_read_b64_tr_b16 v[138:139], v4 offset:3072
    buffer_load_dwordx4 v[180:183], v14, s[36:39], s88 offen offset:1024 sc1
    s_waitcnt lgkmcnt(6)
    v_mfma_f32_32x32x16_bf16 v[240:255], v[156:159], v[188:191], v[240:255]
    ds_read_b64_tr_b16 v[140:141], v5 offset:2048
    ds_read_b64_tr_b16 v[142:143], v5 offset:3072
    s_waitcnt vmcnt(12) lgkmcnt(6)
    v_mfma_f32_32x32x16_bf16 v[224:239], v[128:131], v[192:195], v[224:239]
    ds_read_b64_tr_b16 v[144:145], v4 offset:4096
    ds_read_b64_tr_b16 v[146:147], v4 offset:5120
    buffer_load_dwordx4 v[184:187], v14, s[36:39], s88 offen offset:2048 sc1
    s_waitcnt lgkmcnt(6)
    v_mfma_f32_32x32x16_bf16 v[240:255], v[132:135], v[192:195], v[240:255]
    ds_read_b64_tr_b16 v[148:149], v5 offset:4096
    ds_read_b64_tr_b16 v[150:151], v5 offset:5120
    s_waitcnt lgkmcnt(6)
    v_mfma_f32_32x32x16_bf16 v[224:239], v[136:139], v[196:199], v[224:239]
    ds_read_b64_tr_b16 v[152:153], v4 offset:6144
    ds_read_b64_tr_b16 v[154:155], v4 offset:7168
    buffer_load_dwordx4 v[188:191], v14, s[36:39], s88 offen offset:3072 sc1
    s_add_u32 s82, s82, 4096
    s_and_b32 s82, s82, 0xffff
    s_add_u32 s88, s82, s83
    s_waitcnt lgkmcnt(6)
    v_mfma_f32_32x32x16_bf16 v[240:255], v[140:143], v[196:199], v[240:255]
    ds_read_b64_tr_b16 v[156:157], v5 offset:6144
    ds_read_b64_tr_b16 v[158:159], v5 offset:7168
    v_add_u32 v4, 0x2000, v4
    v_and_b32 v4, 0x1ffff, v4
    v_xor_b32 v5, 64, v4
    s_waitcnt vmcnt(12) lgkmcnt(6)
    v_mfma_f32_32x32x16_bf16 v[224:239], v[144:147], v[200:203], v[224:239]
    ds_read_b64_tr_b16 v[128:129], v4 offset:0
    ds_read_b64_tr_b16 v[130:131], v4 offset:1024
    buffer_load_dwordx4 v[192:195], v14, s[36:39], s88 offen offset:0 sc1
    s_waitcnt lgkmcnt(6)
    v_mfma_f32_32x32x16_bf16 v[240:255], v[148:151], v[200:203], v[240:255]
    ds_read_b64_tr_b16 v[132:133], v5 offset:0
    ds_read_b64_tr_b16 v[134:135], v5 offset:1024
    s_waitcnt lgkmcnt(6)
    v_mfma_f32_32x32x16_bf16 v[224:239], v[152:155], v[204:207], v[224:239]
    ds_read_b64_tr_b16 v[136:137], v4 offset:2048
    ds_read_b64_tr_b16 v[138:139], v4 offset:3072
    buffer_load_dwordx4 v[196:199], v14, s[36:39], s88 offen offset:1024 sc1
    s_waitcnt lgkmcnt(6)
    v_mfma_f32_32x32x16_bf16 v[240:255], v[156:159], v[204:207], v[240:255]
    ds_read_b64_tr_b16 v[140:141], v5 offset:2048
    ds_read_b64_tr_b16 v[142:143], v5 offset:3072
    s_waitcnt vmcnt(12) lgkmcnt(6)
    v_mfma_f32_32x32x16_bf16 v[224:239], v[128:131], v[208:211], v[224:239]
    ds_read_b64_tr_b16 v[144:145], v4 offset:4096
    ds_read_b64_tr_b16 v[146:147], v4 offset:5120
    buffer_load_dwordx4 v[200:203], v14, s[36:39], s88 offen offset:2048 sc1
    s_waitcnt lgkmcnt(6)
    v_mfma_f32_32x32x16_bf16 v[240:255], v[132:135], v[208:211], v[240:255]
    ds_read_b64_tr_b16 v[148:149], v5 offset:4096
    ds_read_b64_tr_b16 v[150:151], v5 offset:5120
    s_waitcnt lgkmcnt(6)
    v_mfma_f32_32x32x16_bf16 v[224:239], v[136:139], v[212:215], v[224:239]
    ds_read_b64_tr_b16 v[152:153], v4 offset:6144
    ds_read_b64_tr_b16 v[154:155], v4 offset:7168
    buffer_load_dwordx4 v[204:207], v14, s[36:39], s88 offen offset:3072 sc1
    s_add_u32 s82, s82, 4096
    s_and_b32 s82, s82, 0xffff
    s_add_u32 s88, s82, s83
    s_waitcnt lgkmcnt(6)
    v_mfma_f32_32x32x16_bf16 v[240:255], v[140:143], v[212:215], v[240:255]
    ds_read_b64_tr_b16 v[156:157], v5 offset:6144
    ds_read_b64_tr_b16 v[158:159], v5 offset:7168
    v_add_u32 v4, 0x2000, v4
    v_and_b32 v4, 0x1ffff, v4
    v_xor_b32 v5, 64, v4
    s_waitcnt vmcnt(12) lgkmcnt(6)
    v_mfma_f32_32x32x16_bf16 v[224:239], v[144:147], v[216:219], v[224:239]
    ds_read_b64_tr_b16 v[128:129], v4 offset:0
    ds_read_b64_tr_b16 v[130:131], v4 offset:1024
    buffer_load_dwordx4 v[208:211], v14, s[36:39], s88 offen offset:0 sc1
    s_waitcnt lgkmcnt(6)
    v_mfma_f32_32x32x16_bf16 v[240:255], v[148:151], v[216:219], v[240:255]
    ds_read_b64_tr_b16 v[132:133], v5 offset:0
    ds_read_b64_tr_b16 v[134:135], v5 offset:1024
    s_waitcnt lgkmcnt(6)
    v_mfma_f32_32x32x16_bf16 v[224:239], v[152:155], v[220:223], v[224:239]
    ds_read_b64_tr_b16 v[136:137], v4 offset:2048
    ds_read_b64_tr_b16 v[138:139], v4 offset:3072
    buffer_load_dwordx4 v[212:215], v14, s[36:39], s88 offen offset:1024 sc1
    s_waitcnt lgkmcnt(6)
    v_mfma_f32_32x32x16_bf16 v[240:255], v[156:159], v[220:223], v[240:255]
    ds_read_b64_tr_b16 v[140:141], v5 offset:2048
    ds_read_b64_tr_b16 v[142:143], v5 offset:3072
    s_cmp_lt_u32 s84, 3
    s_cbranch_scc1 L_G2
    s_waitcnt vmcnt(12) lgkmcnt(6)
    v_mfma_f32_32x32x16_bf16 v[224:239], v[128:131], v[160:163], v[224:239]
    ds_read_b64_tr_b16 v[144:145], v4 offset:4096
    ds_read_b64_tr_b16 v[146:147], v4 offset:5120
    buffer_load_dwordx4 v[216:219], v14, s[36:39], s88 offen offset:2048 sc1
    s_waitcnt lgkmcnt(6)
    v_mfma_f32_32x32x16_bf16 v[240:255], v[132:135], v[160:163], v[240:255]
    ds_read_b64_tr_b16 v[148:149], v5 offset:4096
    ds_read_b64_tr_b16 v[150:151], v5 offset:5120
    s_waitcnt lgkmcnt(6)
    v_mfma_f32_32x32x16_bf16 v[224:239], v[136:139], v[164:167], v[224:239]
    ds_read_b64_tr_b16 v[152:153], v4 offset:6144
    ds_read_b64_tr_b16 v[154:155], v4 offset:7168
    buffer_load_dwordx4 v[220:223], v14, s[36:39], s88 offen offset:3072 sc1
    s_add_u32 s82, s82, 4096
    s_and_b32 s82, s82, 0xffff
    s_add_u32 s88, s82, s83
    s_waitcnt lgkmcnt(6)
    v_mfma_f32_32x32x16_bf16 v[240:255], v[140:143], v[164:167], v[240:255]
    ds_read_b64_tr_b16 v[156:157], v5 offset:6144
    ds_read_b64_tr_b16 v[158:159], v5 offset:7168
    s_barrier
    v_add_u32 v4, 0x2000, v4
    v_and_b32 v4, 0x1ffff, v4
    v_xor_b32_e64 v5, 64, v4
    s_waitcnt vmcnt(12) lgkmcnt(6)
    v_mfma_f32_32x32x16_bf16 v[224:239], v[144:147], v[168:171], v[224:239]
    ds_read_b64_tr_b16 v[128:129], v4 offset:0
    ds_read_b64_tr_b16 v[130:131], v4 offset:1024
    s_waitcnt lgkmcnt(6)
    v_mfma_f32_32x32x16_bf16 v[240:255], v[148:151], v[168:171], v[240:255]
    ds_read_b64_tr_b16 v[132:133], v5 offset:0
    ds_read_b64_tr_b16 v[134:135], v5 offset:1024
    s_waitcnt lgkmcnt(6)
    v_mfma_f32_32x32x16_bf16 v[224:239], v[152:155], v[172:175], v[224:239]
    ds_read_b64_tr_b16 v[136:137], v4 offset:2048
    ds_read_b64_tr_b16 v[138:139], v4 offset:3072
    s_waitcnt lgkmcnt(6)
    v_mfma_f32_32x32x16_bf16 v[240:255], v[156:159], v[172:175], v[240:255]
    ds_read_b64_tr_b16 v[140:141], v5 offset:2048
    ds_read_b64_tr_b16 v[142:143], v5 offset:3072
    s_waitcnt vmcnt(10) lgkmcnt(6)
    v_mfma_f32_32x32x16_bf16 v[224:239], v[128:131], v[176:179], v[224:239]
    ds_read_b64_tr_b16 v[144:145], v4 offset:4096
    ds_read_b64_tr_b16 v[146:147], v4 offset:5120
    s_waitcnt lgkmcnt(6)
    v_mfma_f32_32x32x16_bf16 v[240:255], v[132:135], v[176:179], v[240:255]
    ds_read_b64_tr_b16 v[148:149], v5 offset:4096
    ds_read_b64_tr_b16 v[150:151], v5 offset:5120
    s_waitcnt lgkmcnt(6)
    v_mfma_f32_32x32x16_bf16 v[224:239], v[136:139], v[180:183], v[224:239]
    ds_read_b64_tr_b16 v[152:153], v4 offset:6144
    ds_read_b64_tr_b16 v[154:155], v4 offset:7168
    s_waitcnt lgkmcnt(6)
    v_mfma_f32_32x32x16_bf16 v[240:255], v[140:143], v[180:183], v[240:255]
    ds_read_b64_tr_b16 v[156:157], v5 offset:6144
    ds_read_b64_tr_b16 v[158:159], v5 offset:7168
    v_add_u32 v4, 0x2000, v4
    v_and_b32 v4, 0x1ffff, v4
    v_xor_b32_e64 v5, 64, v4
    s_waitcnt vmcnt(8) lgkmcnt(6)
    v_mfma_f32_32x32x16_bf16 v[224:239], v[144:147], v[184:187], v[224:239]
    ds_read_b64_tr_b16 v[128:129], v4 offset:0
    ds_read_b64_tr_b16 v[130:131], v4 offset:1024
    s_waitcnt lgkmcnt(6)
    v_mfma_f32_32x32x16_bf16 v[240:255], v[148:151], v[184:187], v[240:255]
    ds_read_b64_tr_b16 v[132:133], v5 offset:0
    ds_read_b64_tr_b16 v[134:135], v5 offset:1024
    s_waitcnt lgkmcnt(6)
    v_mfma_f32_32x32x16_bf16 v[224:239], v[152:155], v[188:191], v[224:239]
    ds_read_b64_tr_b16 v[136:137], v4 offset:2048
    ds_read_b64_tr_b16 v[138:139], v4 offset:3072
    s_waitcnt lgkmcnt(6)
    v_mfma_f32_32x32x16_bf16 v[240:255], v[156:159], v[188:191], v[240:255]
    ds_read_b64_tr_b16 v[140:141], v5 offset:2048
    ds_read_b64_tr_b16 v[142:143], v5 offset:3072
    s_barrier
    s_waitcnt vmcnt(6) lgkmcnt(6)
    v_mfma_f32_32x32x16_bf16 v[224:239], v[128:131], v[192:195], v[224:239]
    ds_read_b64_tr_b16 v[144:145], v4 offset:4096
    ds_read_b64_tr_b16 v[146:147], v4 offset:5120
    s_waitcnt lgkmcnt(6)
    v_mfma_f32_32x32x16_bf16 v[240:255], v[132:135], v[192:195], v[240:255]
    ds_read_b64_tr_b16 v[148:149], v5 offset:4096
    ds_read_b64_tr_b16 v[150:151], v5 offset:5120
    s_waitcnt lgkmcnt(6)
    v_mfma_f32_32x32x16_bf16 v[224:239], v[136:139], v[196:199], v[224:239]
    ds_read_b64_tr_b16 v[152:153], v4 offset:6144
    ds_read_b64_tr_b16 v[154:155], v4 offset:7168
    s_waitcnt lgkmcnt(6)
    v_mfma_f32_32x32x16_bf16 v[240:255], v[140:143], v[196:199], v[240:255]
    ds_read_b64_tr_b16 v[156:157], v5 offset:6144
    ds_read_b64_tr_b16 v[158:159], v5 offset:7168
    v_add_u32 v4, 0x2000, v4
    v_and_b32 v4, 0x1ffff, v4
    v_xor_b32 v5, 64, v4
    s_waitcnt vmcnt(4) lgkmcnt(6)
    v_mfma_f32_32x32x16_bf16 v[224:239], v[144:147], v[200:203], v[224:239]
    ds_read_b64_tr_b16 v[128:129], v4 offset:0
    ds_read_b64_tr_b16 v[130:131], v4 offset:1024
    s_waitcnt lgkmcnt(6)
    v_mfma_f32_32x32x16_bf16 v[240:255], v[148:151], v[200:203], v[240:255]
    ds_read_b64_tr_b16 v[132:133], v5 offset:0
    ds_read_b64_tr_b16 v[134:135], v5 offset:1024
    s_waitcnt lgkmcnt(6)
    v_mfma_f32_32x32x16_bf16 v[224:239], v[152:155], v[204:207], v[224:239]
    ds_read_b64_tr_b16 v[136:137], v4 offset:2048
    ds_read_b64_tr_b16 v[138:139], v4 offset:3072
    s_waitcnt lgkmcnt(6)
    v_mfma_f32_32x32x16_bf16 v[240:255], v[156:159], v[204:207], v[240:255]
    ds_read_b64_tr_b16 v[140:141], v5 offset:2048
    ds_read_b64_tr_b16 v[142:143], v5 offset:3072
    s_waitcnt vmcnt(2) lgkmcnt(6)
    v_mfma_f32_32x32x16_bf16 v[224:239], v[128:131], v[208:211], v[224:239]
    ds_read_b64_tr_b16 v[144:145], v4 offset:4096
    ds_read_b64_tr_b16 v[146:147], v4 offset:5120
    s_waitcnt lgkmcnt(6)
    v_mfma_f32_32x32x16_bf16 v[240:255], v[132:135], v[208:211], v[240:255]
    ds_read_b64_tr_b16 v[148:149], v5 offset:4096
    ds_read_b64_tr_b16 v[150:151], v5 offset:5120
    s_waitcnt lgkmcnt(6)
    v_mfma_f32_32x32x16_bf16 v[224:239], v[136:139], v[212:215], v[224:239]
    ds_read_b64_tr_b16 v[152:153], v4 offset:6144
    ds_read_b64_tr_b16 v[154:155], v4 offset:7168
    s_waitcnt lgkmcnt(6)
    v_mfma_f32_32x32x16_bf16 v[240:255], v[140:143], v[212:215], v[240:255]
    ds_read_b64_tr_b16 v[156:157], v5 offset:6144
    ds_read_b64_tr_b16 v[158:159], v5 offset:7168
    s_waitcnt vmcnt(0) lgkmcnt(6)
    v_mfma_f32_32x32x16_bf16 v[224:239], v[144:147], v[216:219], v[224:239]
    s_waitcnt lgkmcnt(4)
    v_mfma_f32_32x32x16_bf16 v[240:255], v[148:151], v[216:219], v[240:255]
    s_waitcnt lgkmcnt(2)
    v_mfma_f32_32x32x16_bf16 v[224:239], v[152:155], v[220:223], v[224:239]
    s_waitcnt lgkmcnt(0)
    v_mfma_f32_32x32x16_bf16 v[240:255], v[156:159], v[220:223], v[240:255]
    s_nop 9
    v_pk_mul_f32 v[18:19], v[224:225], v[224:225]
    v_pk_mul_f32 v[20:21], v[224:225], v[60:61]
    v_pk_add_f32 v[16:17], v[224:225], v[226:227]
    v_pk_fma_f32 v[18:19], v[226:227], v[226:227], v[18:19]
    v_pk_fma_f32 v[20:21], v[226:227], v[62:63], v[20:21]
    v_pk_add_f32 v[16:17], v[16:17], v[228:229]
    v_pk_fma_f32 v[18:19], v[228:229], v[228:229], v[18:19]
    v_pk_fma_f32 v[20:21], v[228:229], v[64:65], v[20:21]
    v_pk_add_f32 v[16:17], v[16:17], v[230:231]
    v_pk_fma_f32 v[18:19], v[230:231], v[230:231], v[18:19]
    v_pk_fma_f32 v[20:21], v[230:231], v[66:67], v[20:21]
    v_pk_add_f32 v[16:17], v[16:17], v[232:233]
    v_pk_fma_f32 v[18:19], v[232:233], v[232:233], v[18:19]
    v_pk_fma_f32 v[20:21], v[232:233], v[68:69], v[20:21]
    v_pk_add_f32 v[16:17], v[16:17], v[234:235]
    v_pk_fma_f32 v[18:19], v[234:235], v[234:235], v[18:19]
    v_pk_fma_f32 v[20:21], v[234:235], v[70:71], v[20:21]
    v_pk_add_f32 v[16:17], v[16:17], v[236:237]
    v_pk_fma_f32 v[18:19], v[236:237], v[236:237], v[18:19]
    v_pk_fma_f32 v[20:21], v[236:237], v[72:73], v[20:21]
    v_pk_add_f32 v[16:17], v[16:17], v[238:239]
    v_pk_fma_f32 v[18:19], v[238:239], v[238:239], v[18:19]
    v_pk_fma_f32 v[20:21], v[238:239], v[74:75], v[20:21]
    v_pk_add_f32 v[16:17], v[16:17], v[240:241]
    v_pk_fma_f32 v[18:19], v[240:241], v[240:241], v[18:19]
    v_pk_fma_f32 v[20:21], v[240:241], v[76:77], v[20:21]
    v_pk_add_f32 v[16:17], v[16:17], v[242:243]
    v_pk_fma_f32 v[18:19], v[242:243], v[242:243], v[18:19]
    v_pk_fma_f32 v[20:21], v[242:243], v[78:79], v[20:21]
    v_pk_add_f32 v[16:17], v[16:17], v[244:245]
    v_pk_fma_f32 v[18:19], v[244:245], v[244:245], v[18:19]
    v_pk_fma_f32 v[20:21], v[244:245], v[80:81], v[20:21]
    v_pk_add_f32 v[16:17], v[16:17], v[246:247]
    v_pk_fma_f32 v[18:19], v[246:247], v[246:247], v[18:19]
    v_pk_fma_f32 v[20:21], v[246:247], v[82:83], v[20:21]
    v_pk_add_f32 v[16:17], v[16:17], v[248:249]
    v_pk_fma_f32 v[18:19], v[248:249], v[248:249], v[18:19]
    v_pk_fma_f32 v[20:21], v[248:249], v[84:85], v[20:21]
    v_pk_add_f32 v[16:17], v[16:17], v[250:251]
    v_pk_fma_f32 v[18:19], v[250:251], v[250:251], v[18:19]
    v_pk_fma_f32 v[20:21], v[250:251], v[86:87], v[20:21]
    v_pk_add_f32 v[16:17], v[16:17], v[252:253]
    v_pk_fma_f32 v[18:19], v[252:253], v[252:253], v[18:19]
    v_pk_fma_f32 v[20:21], v[252:253], v[88:89], v[20:21]
    v_pk_add_f32 v[16:17], v[16:17], v[254:255]
    v_pk_fma_f32 v[18:19], v[254:255], v[254:255], v[18:19]
    v_pk_fma_f32 v[20:21], v[254:255], v[90:91], v[20:21]
    v_mov_b32 v27, s75
    v_add_f32 v24, v16, v17
    v_add_f32 v25, v18, v19
    v_add_f32 v26, v20, v21
    v_mov_b32 v28, v24
    v_mov_b32 v29, v25
    v_mov_b32 v30, v26
    v_permlane32_swap_b32 v24, v28
    v_permlane32_swap_b32 v25, v29
    v_permlane32_swap_b32 v26, v30
    v_pk_add_f32 v[24:25], v[24:25], v[28:29]
    v_add_f32 v26, v26, v30
    s_mov_b32 exec_hi, 0
    buffer_store_dwordx4 v[24:27], v14, s[36:39], s95 offen sc1
    s_mov_b32 exec_hi, -1
    s_barrier
    v_xor_b32_e64 v112, 0, v13
    ds_write_b128 v112, v[224:227]
    v_xor_b32_e64 v113, 32, v13
    ds_write_b128 v113, v[228:231]
    v_xor_b32_e64 v114, 64, v13
    ds_write_b128 v114, v[232:235]
    v_xor_b32 v115, 96, v13
    ds_write_b128 v115, v[236:239]
    v_xor_b32 v116, 128, v13
    ds_write_b128 v116, v[240:243]
    v_xor_b32 v117, 160, v13
    ds_write_b128 v117, v[244:247]
    v_xor_b32 v118, 192, v13
    ds_write_b128 v118, v[248:251]
    v_xor_b32 v119, 224, v13
    ds_write_b128 v119, v[252:255]
    s_add_u32 s79, s94, 4096
    s_add_u32 s80, s94, 8192
    s_add_u32 s81, s94, 12288
    s_barrier
    s_mov_b32 s85, 0
Lspin_41:
    s_add_u32 s85, s85, 1
    s_cmp_gt_u32 s85, 400000
    s_cbranch_scc1 L_end
    buffer_load_dwordx4 v[64:67], v12, s[36:39], s94 offen offset:0 sc1
    buffer_load_dwordx4 v[68:71], v12, s[36:39], s94 offen offset:2048 sc1
    buffer_load_dwordx4 v[72:75], v12, s[36:39], s79 offen offset:0 sc1
    buffer_load_dwordx4 v[76:79], v12, s[36:39], s79 offen offset:2048 sc1
    buffer_load_dwordx4 v[80:83], v12, s[36:39], s80 offen offset:0 sc1
    buffer_load_dwordx4 v[84:87], v12, s[36:39], s80 offen offset:2048 sc1
    buffer_load_dwordx4 v[88:91], v12, s[36:39], s81 offen offset:0 sc1
    buffer_load_dwordx4 v[92:95], v12, s[36:39], s81 offen offset:2048 sc1
    s_waitcnt vmcnt(0)
    s_nop 0
    v_max3_u32 v16, v67, v71, v75
    v_max3_u32 v16, v16, v79, v83
    v_max3_u32 v16, v16, v87, v91
    v_max3_u32 v16, v16, v95, s75
    v_min3_u32 v17, v67, v71, v75
    v_min3_u32 v17, v17, v79, v83
    v_min3_u32 v17, v17, v87, v91
    v_min3_u32 v17, v17, v95, s75
    v_cmp_ne_u32 vcc, v16, v17
    s_cbranch_vccnz Lspin_41
    v_pk_add_f32 v[64:65], v[64:65], v[68:69]
    v_add_f32_e64 v66, v66, v70
    v_pk_add_f32 v[72:73], v[72:73], v[76:77]
    v_add_f32_e64 v74, v74, v78
    v_pk_add_f32 v[80:81], v[80:81], v[84:85]
    v_add_f32_e64 v82, v82, v86
    v_pk_add_f32 v[88:89], v[88:89], v[92:93]
    v_add_f32_e64 v90, v90, v94
    v_pk_add_f32 v[64:65], v[64:65], v[72:73]
    v_add_f32_e64 v66, v66, v74
    v_pk_add_f32 v[80:81], v[80:81], v[88:89]
    v_add_f32 v82, v82, v90
    v_add_f32 v24, v64, v80
    v_add_f32 v25, v65, v81
    v_add_f32 v26, v66, v82
    v_mov_b32 v28, v24
    v_mov_b32 v29, v25
    v_mov_b32 v30, v26
    v_permlane32_swap_b32 v24, v28
    v_permlane32_swap_b32 v25, v29
    v_permlane32_swap_b32 v26, v30
    v_pk_add_f32 v[24:25], v[24:25], v[28:29]
    v_add_f32_e64 v26, v26, v30
    v_mul_f32 v36, 0x3a800000, v24
    v_mul_f32 v40, 0x3a800000, v25
    v_fma_f32 v40, -v36, v36, v40
    v_max_f32_e64 v40, 0, v40
    v_cvt_pk_bf16_f32 v36, v36, v36
    v_and_b32 v36, 0xffff0000, v36
    v_cvt_pk_bf16_f32 v40, v40, v40
    v_and_b32 v40, 0xffff0000, v40
    v_add_f32 v40, 0x3727c5ac, v40
    v_cvt_pk_bf16_f32 v40, v40, v40
    v_and_b32 v40, 0xffff0000, v40
    v_sqrt_f32 v40, v40
    s_nop 0
    v_cvt_pk_bf16_f32 v40, v40, v40
    v_and_b32 v40, 0xffff0000, v40
    v_rcp_f32_e64 v38, v40
    v_fma_f32 v42, -v36, v126, v26
    s_mov_b32 s79, 0xfffff800
    v_mul_f32_e64 v42, v42, v38
    v_mul_f32 v39, -v36, v38
    v_and_or_b32 v42, v42, s79, v11
    ds_write_b64 v10, v[38:39]
    s_nop 0
    v_max_f32_dpp v42, v42, v42 row_ror:8 row_mask:0xf bank_mask:0xf
    s_nop 1
    v_max_f32_dpp v42, v42, v42 row_ror:4 row_mask:0xf bank_mask:0xf
    s_nop 1
    v_max_f32_dpp v42, v42, v42 row_ror:2 row_mask:0xf bank_mask:0xf
    s_nop 1
    v_max_f32_dpp v42, v42, v42 row_ror:1 row_mask:0xf bank_mask:0xf
    s_lshl_b32 s78, s76, 3
    s_add_u32 s78, s78, 163328
    v_bfe_u32 v16, v2, 4, 1
    v_lshl_add_u32 v16, v16, 2, s78
    ds_write_b32 v16, v42
    v_mov_b32 v16, 163328
    s_waitcnt lgkmcnt(0)
    s_barrier
    ds_read_b128 v[20:23], v16
    ds_read_b128 v[24:27], v16 offset:16
    s_lshl_b32 s79, s71, 4
    s_add_u32 s79, s79, s72
    s_lshl_b32 s79, s79, 9
    s_add_u32 s79, s79, 524288
    v_lshlrev_b32 v17, 3, v2
    v_lshlrev_b32_e64 v18, 2, v2
    s_waitcnt lgkmcnt(0)
    v_max3_f32 v20, v20, v21, v22
    v_max3_f32 v24, v24, v25, v26
    v_max_f32_e64 v23, v23, v27
    v_max3_f32 v20, v20, v24, v23
    v_mov_b32 v21, s75
    s_cmp_lg_u32 s76, 0
    s_cbranch_scc1 L_nocand
    s_mov_b32 exec_hi, 0
    v_and_b32 v22, 127, v20
    v_and_b32 v23, 7, v20
    v_lshlrev_b32 v23, 4, v23
    v_xor_b32_e64 v23, v23, v17
    v_lshl_add_u32 v23, v22, 8, v23
    v_lshlrev_b32_e64 v22, 3, v22
    ds_read_b64 v[24:25], v23
    v_add_u32 v22, 159744, v22
    ds_read_b64 v[26:27], v22
    s_mov_b32 exec_lo, 0xffff
    buffer_store_dwordx2 v[20:21], v17, s[36:39], s79 offen offset:128 sc1
    s_mov_b32 exec_lo, -1
    s_waitcnt lgkmcnt(0)
    v_fma_f32 v28, v24, v26, v27
    v_fma_f32 v29, v25, v26, v27
    v_cvt_pk_bf16_f32 v30, v28, v29
    buffer_store_dword v30, v18, s[36:39], s79 offen sc1
    v_add_f32 v28, v28, v24
    v_add_f32 v29, v29, v25
    buffer_store_dwordx2 v[28:29], v17, s[36:39], s79 offen offset:256 sc1
    s_mov_b32 exec_hi, -1
L_nocand:
    v_lshrrev_b32 v16, 3, v2
    v_and_b32 v17, 7, v2
    s_lshl_b32 s78, s76, 5
    v_add_u32 v18, s78, v16
    v_lshlrev_b32 v19, 1, v17
    v_xor_b32 v19, v19, v16
    v_lshlrev_b32 v19, 4, v19
    v_lshl_add_u32 v19, v18, 8, v19
    v_xor_b32 v32, 16, v19
    v_lshlrev_b32 v33, 3, v18
    v_add_u32 v33, 159744, v33
    ds_read_b128 v[64:67], v19 offset:0
    ds_read_b128 v[68:71], v32 offset:0
    ds_read_b64 v[96:97], v33 offset:0
    ds_read_b128 v[72:75], v19 offset:2048
    ds_read_b128 v[76:79], v32 offset:2048
    ds_read_b64 v[98:99], v33 offset:64
    ds_read_b128 v[80:83], v19 offset:4096
    ds_read_b128 v[84:87], v32 offset:4096
    ds_read_b64 v[100:101], v33 offset:128
    ds_read_b128 v[88:91], v19 offset:6144
    ds_read_b128 v[92:95], v32 offset:6144
    ds_read_b64 v[102:103], v33 offset:192
    s_lshl_b32 s78, s71, 7
    v_add_u32_e64 v18, s78, v18
    s_lshl_b32 s79, s72, 7
    v_lshl_add_u32 v19, v18, 11, s79
    v_lshl_add_u32 v19, v17, 4, v19
    v_mov_b32 v16, 163360
    s_waitcnt lgkmcnt(0)
    v_add_f32 v96, 1.0, v96
    v_pk_fma_f32 v[64:65], v[64:65], v[96:97], v[96:97] op_sel:[0,0,1] op_sel_hi:[1,0,1]
    v_pk_fma_f32 v[66:67], v[66:67], v[96:97], v[96:97] op_sel:[0,0,1] op_sel_hi:[1,0,1]
    v_pk_fma_f32 v[68:69], v[68:69], v[96:97], v[96:97] op_sel:[0,0,1] op_sel_hi:[1,0,1]
    v_pk_fma_f32 v[70:71], v[70:71], v[96:97], v[96:97] op_sel:[0,0,1] op_sel_hi:[1,0,1]
    v_cvt_pk_bf16_f32 v104, v64, v65
    v_cvt_pk_bf16_f32 v105, v66, v67
    v_cvt_pk_bf16_f32 v106, v68, v69
    v_cvt_pk_bf16_f32 v107, v70, v71
    v_add_f32_e64 v98, 1.0, v98
    v_pk_fma_f32 v[72:73], v[72:73], v[98:99], v[98:99] op_sel:[0,0,1] op_sel_hi:[1,0,1]
    v_pk_fma_f32 v[74:75], v[74:75], v[98:99], v[98:99] op_sel:[0,0,1] op_sel_hi:[1,0,1]
    v_pk_fma_f32 v[76:77], v[76:77], v[98:99], v[98:99] op_sel:[0,0,1] op_sel_hi:[1,0,1]
    v_pk_fma_f32 v[78:79], v[78:79], v[98:99], v[98:99] op_sel:[0,0,1] op_sel_hi:[1,0,1]
    v_cvt_pk_bf16_f32 v108, v72, v73
    v_cvt_pk_bf16_f32 v109, v74, v75
    v_cvt_pk_bf16_f32 v110, v76, v77
    v_cvt_pk_bf16_f32 v111, v78, v79
    v_add_f32_e64 v100, 1.0, v100
    v_pk_fma_f32 v[80:81], v[80:81], v[100:101], v[100:101] op_sel:[0,0,1] op_sel_hi:[1,0,1]
    v_pk_fma_f32 v[82:83], v[82:83], v[100:101], v[100:101] op_sel:[0,0,1] op_sel_hi:[1,0,1]
    v_pk_fma_f32 v[84:85], v[84:85], v[100:101], v[100:101] op_sel:[0,0,1] op_sel_hi:[1,0,1]
    v_pk_fma_f32 v[86:87], v[86:87], v[100:101], v[100:101] op_sel:[0,0,1] op_sel_hi:[1,0,1]
    v_cvt_pk_bf16_f32 v112, v80, v81
    v_cvt_pk_bf16_f32 v113, v82, v83
    v_cvt_pk_bf16_f32 v114, v84, v85
    v_cvt_pk_bf16_f32 v115, v86, v87
    v_add_f32_e64 v102, 1.0, v102
    v_pk_fma_f32 v[88:89], v[88:89], v[102:103], v[102:103] op_sel:[0,0,1] op_sel_hi:[1,0,1]
    v_pk_fma_f32 v[90:91], v[90:91], v[102:103], v[102:103] op_sel:[0,0,1] op_sel_hi:[1,0,1]
    v_pk_fma_f32 v[92:93], v[92:93], v[102:103], v[102:103] op_sel:[0,0,1] op_sel_hi:[1,0,1]
    v_pk_fma_f32 v[94:95], v[94:95], v[102:103], v[102:103] op_sel:[0,0,1] op_sel_hi:[1,0,1]
    v_cvt_pk_bf16_f32 v116, v88, v89
    v_cvt_pk_bf16_f32 v117, v90, v91
    v_cvt_pk_bf16_f32 v118, v92, v93
    v_cvt_pk_bf16_f32 v119, v94, v95
    s_barrier
    ds_read_b32 v17, v16
    s_waitcnt lgkmcnt(0)
    v_and_b32 v17, 0x7ff, v17
    v_sub_u32 v17, v17, v18
    s_barrier
    s_barrier
    s_mov_b32 s78, 0
    v_cmp_ne_u32_e64 vcc, 0, v17
    s_mov_b64 exec, vcc
    s_cbranch_execz Lo_42
    buffer_store_dwordx4 v[104:107], v19, s[44:47], s78 offen sc1
Lo_42:
    s_mov_b64 exec, -1
    s_mov_b32 s78, 16384
    v_cmp_ne_u32 vcc, 8, v17
    s_mov_b64 exec, vcc
    s_cbranch_execz Lo_43
    buffer_store_dwordx4 v[108:111], v19, s[44:47], s78 offen sc1
Lo_43:
    s_mov_b64 exec, -1
    s_mov_b32 s78, 32768
    v_cmp_ne_u32 vcc, 16, v17
    s_mov_b64 exec, vcc
    s_cbranch_execz Lo_44
    buffer_store_dwordx4 v[112:115], v19, s[44:47], s78 offen sc1
Lo_44:
    s_mov_b64 exec, -1
    s_mov_b32 s78, 49152
    v_cmp_ne_u32 vcc, 24, v17
    s_mov_b64 exec, vcc
    s_cbranch_execz Lo_45
    buffer_store_dwordx4 v[116:119], v19, s[44:47], s78 offen sc1
Lo_45:
    s_mov_b64 exec, -1
    s_branch L_fin
L_fin:
L_end:
    s_endpgm
.fill 64, 4, 0xbf800000
s_endpgm
.section .rodata,"a"
.p2align 6
.amdhsa_kernel sequential_preLN__linear_kernel_hedgehog__moe_arch_mod__prompt_kernel
  .amdhsa_next_free_vgpr 256
  .amdhsa_next_free_sgpr 102
  .amdhsa_accum_offset 256
  .amdhsa_group_segment_fixed_size 0
  .amdhsa_kernarg_size 96
  .amdhsa_user_sgpr_count 2
  .amdhsa_user_sgpr_kernarg_segment_ptr 1
  .amdhsa_system_sgpr_workgroup_id_x 1
  .amdhsa_float_denorm_mode_32 3
.end_amdhsa_kernel
```

```asm
; @launch grid=(256,1,1) block=(512,1,1) lds=163840
.amdgcn_target "amdgcn-amd-amdhsa--gfx950"
.text
.globl sequential_preLN__linear_kernel_hedgehog__moe_arch_mod__prompt_kernel
.p2align 8
.type sequential_preLN__linear_kernel_hedgehog__moe_arch_mod__prompt_kernel,@function
sequential_preLN__linear_kernel_hedgehog__moe_arch_mod__prompt_kernel:
    s_cmp_ge_u32 s2, 256
    s_cbranch_scc1 L_end
    s_load_dwordx16 s[4:19], s[0:1], 0
    s_load_dwordx8 s[20:27], s[0:1], 64
    v_lshrrev_b32 v1, 6, v0
    v_and_b32_e64 v2, 63, v0
    v_readfirstlane_b32 s68, v1
    s_lshr_b32 s69, s2, 4
    s_and_b32 s70, s2, 7
    s_lshl_b32 s70, s70, 1
    s_bfe_u32 s78, s2, 0x10003
    s_or_b32 s70, s70, s78
    s_and_b32 s76, s68, 3
    s_cmp_ge_u32 s68, 4
    s_cbranch_scc1 L_M
    v_lshrrev_b32 v196, 3, v2
    v_and_b32 v197, 7, v2
    v_lshrrev_b32_e64 v198, 4, v2
    s_mul_i32 s78, s76, 98304
    s_lshl_b32 s79, s70, 7
    s_add_u32 s78, s78, s79
    s_movk_i32 s79, 6144
    v_mov_b32 v199, s78
    v_mad_u32_u24 v199, v196, s79, v199
    v_and_b32 v200, 2, v196
    v_xor_b32 v200, v200, v197
    v_lshl_add_u32 v6, v200, 4, v199
    v_xor_b32_e64 v7, 64, v6
    v_add_u32 v7, 48128, v7
    s_lshl_b32 s78, s69, 2
    s_add_u32 s78, s78, s76
    s_lshl_b32 s78, s78, 16
    v_lshl_add_u32 v199, v196, 11, s78
    v_xor_b32 v200, v198, v197
    v_lshl_add_u32 v4, v200, 4, v199
    v_xor_b32_e64 v5, 64, v4
    v_add_u32 v5, 15360, v5
    s_lshl_b32 s88, s76, 12
    s_lshl_b32 s89, s76, 11
    s_and_b32 s78, s70, 14
    s_and_b32 s79, s69, 14
    s_add_u32 s78, s78, s79
    s_sub_u32 s78, 32, s78
    s_and_b32 s78, s78, 15
    s_lshl_b32 s86, s78, 7
    s_mul_i32 s87, s78, 393216
    s_mov_b32 s30, 0x400000
    s_mov_b32 s31, 0x20000
    s_mov_b32 s34, 0x600000
    s_mov_b32 s35, 0x20000
    s_waitcnt lgkmcnt(0)
    s_mov_b32 s32, s6
    s_and_b32 s33, s7, 0xffff
    s_mov_b32 s28, s4
    s_and_b32 s29, s5, 0xffff
    s_add_u32 m0, s88, 118784
    s_nop 0
    buffer_load_dwordx4 v4, s[28:31], s86 offen  lds
    buffer_load_dwordx4 v5, s[28:31], s86 offen offset:1024  lds
    s_add_u32 m0, s89, 143360
    s_add_u32 s101, s87, 2048
    buffer_load_dwordx4 v6, s[32:35], s101 offen  lds
    buffer_load_dwordx4 v7, s[32:35], s101 offen offset:1024  lds
    s_add_u32 m0, s88, 120832
    s_add_u32 s101, s86, 32768
    buffer_load_dwordx4 v4, s[28:31], s101 offen  lds
    buffer_load_dwordx4 v5, s[28:31], s101 offen offset:1024  lds
    s_add_u32 m0, s89, 151552
    s_add_u32 s101, s87, 4096
    buffer_load_dwordx4 v6, s[32:35], s101 offen  lds
    buffer_load_dwordx4 v7, s[32:35], s101 offen offset:1024  lds
    s_add_u32 m0, s89, 135168
    s_nop 0
    buffer_load_dwordx4 v6, s[32:35], s87 offen  lds
    buffer_load_dwordx4 v7, s[32:35], s87 offen offset:1024  lds
    s_add_u32 s86, s86, 128
    s_add_u32 s87, s87, 393216
    s_and_b32 s86, s86, 2047
    s_cselect_b32 s87, s87, 0
    s_load_dword s75, s[26:27], 0
    s_mov_b32 s60, s8
    s_and_b32 s61, s9, 0xffff
    s_mov_b32 s62, 0x10000
    s_mov_b32 s63, 0x20000
    v_lshlrev_b32_e64 v14, 4, v2
    s_lshl_b32 s78, s70, 12
    s_lshl_b32 s79, s76, 10
    s_add_u32 s78, s78, s79
    s_add_u32 m0, s79, 159744
    s_nop 0
    buffer_load_dwordx4 v14, s[60:63], s78 offen lds
    s_and_b32 s78, s2, 7
    s_lshr_b32 s79, s2, 3
    s_lshl_b32 s71, s78, 1
    s_and_b32 s72, s79, 1
    s_add_u32 s71, s71, s72
    s_lshr_b32 s72, s79, 1
    s_cmp_gt_u32 s70, 3
    s_cselect_b32 s78, 1, 0
    s_cmp_gt_u32 s70, 11
    s_cselect_b32 s78, 2, s78
    s_sub_u32 s78, s70, s78
    s_cmp_eq_u32 s70, 3
    s_cselect_b32 s78, 14, s78
    s_cmp_eq_u32 s70, 11
    s_cselect_b32 s78, 15, s78
    s_lshl_b32 s0, s78, 4
    s_add_u32 s0, s0, s69
    s_lshr_b32 s73, s0, 2
    s_and_b32 s74, s0, 3
    s_lshl_b32 s77, s70, 4
    s_add_u32 s77, s77, s69
    s_mov_b32 s36, s26
    s_and_b32 s37, s27, 0xffff
    s_mov_b32 s38, 0x10000000
    s_mov_b32 s39, 0x20000
    s_mov_b32 s40, s10
    s_and_b32 s41, s11, 0xffff
    s_mov_b32 s42, 0x200000
    s_mov_b32 s43, 0x20000
    s_mov_b32 s44, s22
    s_and_b32 s45, s23, 0xffff
    s_mov_b32 s46, 0x400000
    s_mov_b32 s47, 0x20000
    s_mov_b32 s48, s16
    s_and_b32 s49, s17, 0xffff
    s_mov_b32 s50, 0x700000
    s_mov_b32 s51, 0x20000
    s_mov_b32 s52, s18
    s_and_b32 s53, s19, 0xffff
    s_mov_b32 s54, 0x700000
    s_mov_b32 s55, 0x20000
    s_mov_b32 s56, s20
    s_and_b32 s57, s21, 0xffff
    s_mov_b32 s58, 0x700000
    s_mov_b32 s59, 0x20000
    v_mov_b32 v16, -1
    v_mov_b32 v17, -1
    v_mov_b32 v18, -1
    v_mov_b32_e64 v19, -1
    s_lshl_b32 s94, s77, 14
    s_lshl_b32 s78, s76, 12
    s_add_u32 s94, s94, s78
    s_add_u32 s94, s94, 4194304
    s_lshl_b32 s96, s77, 10
    s_add_u32 s96, s96, 8388608
    s_cmp_eq_u32 s76, 3
    s_cselect_b32 s96, s96, 0x10000000
    v_and_b32 v196, 15, v2
    v_lshrrev_b32 v197, 1, v196
    v_lshlrev_b32 v199, 7, v196
    v_add_u32 v199, s88, v199
    v_xor_b32_e64 v200, v198, v197
    v_lshl_add_u32 v60, v200, 4, v199
    v_xor_b32_e64 v61, 64, v60
    v_bfe_u32 v196, v2, 2, 2
    v_and_b32_e64 v197, 3, v2
    v_lshl_add_u32 v199, v198, 3, v196
    v_lshlrev_b32_e64 v199, 7, v199
    v_lshl_add_u32 v199, v197, 3, v199
    v_lshrrev_b32 v196, 1, v196
    v_and_b32 v197, 1, v198
    v_lshl_add_u32 v196, v197, 1, v196
    s_mul_i32 s80, s76, 3
    s_add_u32 s78, s80, 0
    s_and_b32 s79, s78, 3
    s_lshr_b32 s78, s78, 2
    s_lshl_b32 s78, s78, 13
    s_add_u32 s78, s78, 16384
    v_xor_b32 v197, s79, v196
    v_lshl_add_u32 v197, v197, 5, v199
    v_add_u32_e64 v240, s78, v197
    s_add_u32 s78, s80, 1
    s_and_b32 s79, s78, 3
    s_lshr_b32 s78, s78, 2
    s_lshl_b32 s78, s78, 13
    s_add_u32 s78, s78, 16384
    v_xor_b32_e64 v197, s79, v196
    v_lshl_add_u32 v197, v197, 5, v199
    v_add_u32_e64 v241, s78, v197
    s_add_u32 s78, s80, 2
    s_and_b32 s79, s78, 3
    s_lshr_b32 s78, s78, 2
    s_lshl_b32 s78, s78, 13
    s_add_u32 s78, s78, 16384
    v_xor_b32_e64 v197, s79, v196
    v_lshl_add_u32 v197, v197, 5, v199
    v_add_u32_e64 v242, s78, v197
    s_and_b32 s82, s70, 1
    s_and_b32 s83, s69, 1
    s_add_u32 m0, s88, 36864
    s_nop 0
    buffer_load_dwordx4 v4, s[28:31], s86 offen  lds
    v_lshrrev_b32 v196, 3, v2
    v_and_b32 v197, 7, v2
    v_lshlrev_b32 v199, 4, v197
    v_mul_u32_u24 v244, 57344, v196
    buffer_load_dwordx4 v5, s[28:31], s86 offen offset:1024  lds
    v_add_u32_e64 v244, v244, v199
    v_lshl_add_u32 v245, v196, 14, v199
    s_lshl_b32 s78, s74, 2
    s_add_u32 s78, s78, s76
    s_add_u32 m0, s89, 61440
    s_add_u32 s101, s87, 2048
    buffer_load_dwordx4 v6, s[32:35], s101 offen  lds
    s_mul_i32 s79, s78, 458752
    s_add_u32 s80, s73, s76
    s_and_b32 s80, s80, 3
    s_andn2_b32 s100, s73, 3
    buffer_load_dwordx4 v7, s[32:35], s101 offen offset:1024  lds
    s_or_b32 s80, s80, s100
    s_lshl_b32 s80, s80, 7
    s_add_u32 s79, s79, s80
    s_cmp_ge_u32 s73, 56
    s_cselect_b32 s79, 0x8000000, s79
    v_add_u32_e64 v244, s79, v244
    s_lshl_b32 s78, s78, 7
    s_add_u32 m0, s88, 38912
    s_add_u32 s101, s86, 32768
    buffer_load_dwordx4 v4, s[28:31], s101 offen  lds
    s_lshl_b32 s80, s73, 17
    s_add_u32 s78, s78, s80
    v_add_u32 v245, s78, v245
    s_lshl_b32 s78, s72, 7
    buffer_load_dwordx4 v5, s[28:31], s101 offen offset:1024  lds
    v_lshl_add_u32 v196, v196, 11, s78
    v_and_b32 v199, 1, v198
    v_lshlrev_b32 v199, 2, v199
    v_xor_b32_e64 v199, v199, v197
    s_add_u32 m0, s89, 69632
    s_add_u32 s101, s87, 4096
    buffer_load_dwordx4 v6, s[32:35], s101 offen  lds
    v_lshl_add_u32 v246, v199, 4, v196
    s_lshl_b32 s78, s71, 2
    s_add_u32 s78, s78, s76
    s_lshl_b32 s78, s78, 16
    v_add_u32 v196, s78, v196
    buffer_load_dwordx4 v7, s[32:35], s101 offen offset:1024  lds
    v_xor_b32_e64 v199, v198, v197
    v_lshl_add_u32 v247, v199, 4, v196
    v_xor_b32 v248, 64, v247
    s_lshl_b32 s78, s76, 14
    s_add_u32 m0, s89, 53248
    s_nop 0
    buffer_load_dwordx4 v6, s[32:35], s87 offen  lds
    v_add_u32_e64 v246, s78, v246
    s_lshl_b32 s84, s76, 10
    s_bfe_u32 s78, s2, 0x40003
    s_lshl_b32 s78, s78, 17
    buffer_load_dwordx4 v7, s[32:35], s87 offen offset:1024  lds
    s_add_u32 s86, s86, 128
    s_add_u32 s87, s87, 393216
    s_and_b32 s86, s86, 2047
    s_cselect_b32 s87, s87, 0
    s_and_b32 s79, s72, 8
    s_add_u32 s79, s79, 3
    s_lshl_b32 s79, s79, 7
    s_add_u32 s78, s78, s79
    v_lshl_add_u32 v63, v2, 11, s78
    s_waitcnt vmcnt(10)
    s_barrier
    s_cmp_lg_u32 s82, 0
    s_cbranch_scc1 Lsx_1
    v_add_u32 v196, 118784, v60
    v_add_u32 v197, 118784, v61
    ds_read_b128 v[20:23], v196 offset:0
    ds_read_b128 v[24:27], v196 offset:2048
    ds_read_b128 v[28:31], v197 offset:0
    ds_read_b128 v[32:35], v197 offset:2048
Lsx_1:
    s_cmp_lg_u32 s83, 0
    s_cbranch_scc1 Lsw_2
    v_add_u32 v198, 118784, v240
    v_add_u32 v199, 118784, v241
    v_add_u32 v200, 118784, v242
    ds_read_b64_tr_b16 v[36:37], v198 offset:0
    ds_read_b64_tr_b16 v[38:39], v198 offset:512
    ds_read_b64_tr_b16 v[40:41], v198 offset:4096
    ds_read_b64_tr_b16 v[42:43], v198 offset:4608
    ds_read_b64_tr_b16 v[44:45], v199 offset:0
    ds_read_b64_tr_b16 v[46:47], v199 offset:512
    ds_read_b64_tr_b16 v[48:49], v199 offset:4096
    ds_read_b64_tr_b16 v[50:51], v199 offset:4608
    ds_read_b64_tr_b16 v[52:53], v200 offset:0
    ds_read_b64_tr_b16 v[54:55], v200 offset:512
    ds_read_b64_tr_b16 v[56:57], v200 offset:4096
    ds_read_b64_tr_b16 v[58:59], v200 offset:4608
Lsw_2:
    s_add_u32 m0, s88, 77824
    s_nop 0
    s_nop 0
    buffer_load_dwordx4 v4, s[28:31], s86 offen  lds
    buffer_load_dwordx4 v5, s[28:31], s86 offen offset:1024  lds
    s_add_u32 m0, s89, 102400
    s_add_u32 s101, s87, 2048
    buffer_load_dwordx4 v6, s[32:35], s101 offen  lds
    buffer_load_dwordx4 v7, s[32:35], s101 offen offset:1024  lds
    s_add_u32 m0, s88, 79872
    s_add_u32 s101, s86, 32768
    buffer_load_dwordx4 v4, s[28:31], s101 offen  lds
    buffer_load_dwordx4 v5, s[28:31], s101 offen offset:1024  lds
    s_add_u32 m0, s89, 110592
    s_add_u32 s101, s87, 4096
    buffer_load_dwordx4 v6, s[32:35], s101 offen  lds
    buffer_load_dwordx4 v7, s[32:35], s101 offen offset:1024  lds
    s_add_u32 m0, s89, 94208
    s_nop 0
    buffer_load_dwordx4 v6, s[32:35], s87 offen  lds
    buffer_load_dwordx4 v7, s[32:35], s87 offen offset:1024  lds
    s_add_u32 s86, s86, 128
    s_add_u32 s87, s87, 393216
    s_and_b32 s86, s86, 2047
    s_cselect_b32 s87, s87, 0
    s_waitcnt lgkmcnt(0)
    s_mul_i32 s75, s75, 0x9E3779B1
    s_add_u32 s75, s75, 0x7F4A7C15
    s_waitcnt vmcnt(10)
    s_waitcnt lgkmcnt(0)
    s_barrier
    s_cmp_lg_u32 s82, 1
    s_cbranch_scc1 Lsx_3
    v_add_u32 v196, 36864, v60
    v_add_u32 v197, 36864, v61
    ds_read_b128 v[20:23], v196 offset:0
    ds_read_b128 v[24:27], v196 offset:2048
    ds_read_b128 v[28:31], v197 offset:0
    ds_read_b128 v[32:35], v197 offset:2048
Lsx_3:
    s_cmp_lg_u32 s83, 1
    s_cbranch_scc1 Lsw_4
    v_add_u32 v198, 36864, v240
    v_add_u32 v199, 36864, v241
    v_add_u32 v200, 36864, v242
    ds_read_b64_tr_b16 v[36:37], v198 offset:0
    ds_read_b64_tr_b16 v[38:39], v198 offset:512
    ds_read_b64_tr_b16 v[40:41], v198 offset:4096
    ds_read_b64_tr_b16 v[42:43], v198 offset:4608
    ds_read_b64_tr_b16 v[44:45], v199 offset:0
    ds_read_b64_tr_b16 v[46:47], v199 offset:512
    ds_read_b64_tr_b16 v[48:49], v199 offset:4096
    ds_read_b64_tr_b16 v[50:51], v199 offset:4608
    ds_read_b64_tr_b16 v[52:53], v200 offset:0
    ds_read_b64_tr_b16 v[54:55], v200 offset:512
    ds_read_b64_tr_b16 v[56:57], v200 offset:4096
    ds_read_b64_tr_b16 v[58:59], v200 offset:4608
Lsw_4:
    s_add_u32 m0, s88, 118784
    s_nop 0
    s_nop 0
    buffer_load_dwordx4 v4, s[28:31], s86 offen  lds
    buffer_load_dwordx4 v5, s[28:31], s86 offen offset:1024  lds
    s_add_u32 m0, s89, 143360
    s_add_u32 s101, s87, 2048
    buffer_load_dwordx4 v6, s[32:35], s101 offen  lds
    buffer_load_dwordx4 v7, s[32:35], s101 offen offset:1024  lds
    s_add_u32 m0, s88, 120832
    s_add_u32 s101, s86, 32768
    buffer_load_dwordx4 v4, s[28:31], s101 offen  lds
    buffer_load_dwordx4 v5, s[28:31], s101 offen offset:1024  lds
    s_add_u32 m0, s89, 151552
    s_add_u32 s101, s87, 4096
    buffer_load_dwordx4 v6, s[32:35], s101 offen  lds
    buffer_load_dwordx4 v7, s[32:35], s101 offen offset:1024  lds
    s_add_u32 m0, s89, 135168
    s_nop 0
    buffer_load_dwordx4 v6, s[32:35], s87 offen  lds
    buffer_load_dwordx4 v7, s[32:35], s87 offen offset:1024  lds
    s_add_u32 s86, s86, 128
    s_add_u32 s87, s87, 393216
    s_and_b32 s86, s86, 2047
    s_cselect_b32 s87, s87, 0
    s_waitcnt vmcnt(10)
    s_waitcnt lgkmcnt(0)
    s_barrier
    s_setprio 2
    s_add_u32 m0, s88, 36864
    s_nop 0
    s_nop 0
    buffer_load_dwordx4 v4, s[28:31], s86 offen  lds
    v_mov_b32 v200, 0x3f803f80
    v_mov_b32 v201, 0x3f803f80
    v_mov_b32 v202, 0x3f803f80
    v_mov_b32 v203, 0x3f803f80
    buffer_load_dwordx4 v5, s[28:31], s86 offen offset:1024  lds
    s_nop 0
    s_nop 0
    v_mfma_f32_16x16x32_bf16 v[204:207], v[200:203], v[20:23], 0
    v_mfma_f32_16x16x32_bf16 v[212:215], v[20:23], v[20:23], 0
    v_mfma_f32_16x16x32_bf16 v[208:211], v[200:203], v[24:27], 0
    v_mfma_f32_16x16x32_bf16 v[216:219], v[24:27], v[24:27], 0
    v_mfma_f32_16x16x32_bf16 v[220:223], v[200:203], v[36:39], 0
    s_add_u32 m0, s89, 61440
    s_add_u32 s101, s87, 2048
    buffer_load_dwordx4 v6, s[32:35], s101 offen  lds
    v_mfma_f32_16x16x32_bf16 v[224:227], v[200:203], v[44:47], 0
    v_mfma_f32_16x16x32_bf16 v[228:231], v[200:203], v[52:55], 0
    v_mfma_f32_16x16x32_bf16 v[204:207], v[200:203], v[28:31], v[204:207]
    v_mfma_f32_16x16x32_bf16 v[212:215], v[28:31], v[28:31], v[212:215]
    v_mfma_f32_16x16x32_bf16 v[208:211], v[200:203], v[32:35], v[208:211]
    buffer_load_dwordx4 v7, s[32:35], s101 offen offset:1024  lds
    v_mfma_f32_16x16x32_bf16 v[216:219], v[32:35], v[32:35], v[216:219]
    v_mfma_f32_16x16x32_bf16 v[220:223], v[200:203], v[40:43], v[220:223]
    v_mfma_f32_16x16x32_bf16 v[224:227], v[200:203], v[48:51], v[224:227]
    v_mfma_f32_16x16x32_bf16 v[228:231], v[200:203], v[56:59], v[228:231]
    v_and_b32_e64 v196, 3, v2
    s_add_u32 m0, s88, 38912
    s_add_u32 s101, s86, 32768
    buffer_load_dwordx4 v4, s[28:31], s101 offen  lds
    v_cmp_eq_u32 s[90:91], 1, v196
    v_cmp_eq_u32 s[92:93], 2, v196
    v_cmp_eq_u32_e64 vcc, 3, v196
    v_cndmask_b32 v212, v212, v213, s[90:91]
    v_cndmask_b32 v212, v212, v214, s[92:93]
    buffer_load_dwordx4 v5, s[28:31], s101 offen offset:1024  lds
    v_cndmask_b32_e64 v205, v212, v215, vcc
    v_cndmask_b32 v216, v216, v217, s[90:91]
    v_cndmask_b32 v216, v216, v218, s[92:93]
    v_cndmask_b32 v209, v216, v219, vcc
    v_lshrrev_b32 v196, 4, v2
    s_add_u32 m0, s89, 69632
    s_add_u32 s101, s87, 4096
    buffer_load_dwordx4 v6, s[32:35], s101 offen  lds
    v_cmp_eq_u32 s[90:91], 1, v196
    v_cmp_eq_u32 vcc, 2, v196
    s_nop 0
    v_cndmask_b32 v220, v220, v224, s[90:91]
    v_cndmask_b32_e64 v220, v220, v228, vcc
    s_mul_i32 s78, s77, 768
    buffer_load_dwordx4 v7, s[32:35], s101 offen offset:1024  lds
    s_mul_i32 s79, s76, 192
    s_add_u32 s78, s78, s79
    s_add_u32 s78, s78, 327680
    v_lshlrev_b32 v197, 2, v2
    s_mov_b32 exec_hi, 0xffff
    buffer_store_dword v220, v197, s[36:39], s78 offen sc1
    s_mov_b32 exec_hi, -1
    s_add_u32 m0, s89, 53248
    s_nop 0
    buffer_load_dwordx4 v6, s[32:35], s87 offen  lds
    s_lshl_b32 s78, s69, 4
    s_add_u32 s78, s78, s70
    s_lshl_b32 s78, s78, 10
    s_lshl_b32 s79, s76, 8
    s_add_u32 s78, s78, s79
    buffer_load_dwordx4 v7, s[32:35], s87 offen offset:1024  lds
    s_add_u32 s86, s86, 128
    s_add_u32 s87, s87, 393216
    s_and_b32 s86, s86, 2047
    s_cselect_b32 s87, s87, 0
    s_add_u32 s78, s78, 65536
    v_and_b32 v198, 15, v2
    v_lshlrev_b32 v198, 3, v198
    s_mov_b32 exec_lo, 0x00f0000f
    s_mov_b32 exec_hi, 0xf0000f00
    buffer_store_dwordx2 v[204:205], v198, s[36:39], s78 offen offset:0 sc1
    s_mov_b64 exec, -1
    s_mov_b32 exec_lo, 0x00f0000f
    s_mov_b32 exec_hi, 0xf0000f00
    buffer_store_dwordx2 v[208:209], v198, s[36:39], s78 offen offset:128 sc1
    s_mov_b64 exec, -1
    s_setprio 0
    s_waitcnt vmcnt(13)
    s_waitcnt lgkmcnt(0)
    s_barrier
    s_mul_i32 s100, s69, 52
    s_lshr_b32 s100, s100, 8
    s_mul_i32 s100, s100, 5
    s_sub_u32 s100, s69, s100
    s_cmp_eq_u32 s100, 1
    s_cbranch_scc1 L_ph1
    s_cmp_eq_u32 s100, 2
    s_cbranch_scc1 L_ph2
    s_cmp_eq_u32 s100, 3
    s_cbranch_scc1 L_ph3
    s_cmp_eq_u32 s100, 4
    s_cbranch_scc1 L_ph4
    s_add_u32 m0, s88, 77824
    s_nop 0
    s_nop 0
    buffer_load_dwordx4 v4, s[28:31], s86 offen  lds
    buffer_load_dwordx4 v5, s[28:31], s86 offen offset:1024  lds
    s_add_u32 m0, s89, 102400
    s_add_u32 s101, s87, 2048
    buffer_load_dwordx4 v6, s[32:35], s101 offen  lds
    buffer_load_dwordx4 v7, s[32:35], s101 offen offset:1024  lds
    s_add_u32 m0, s88, 79872
    s_add_u32 s101, s86, 32768
    buffer_load_dwordx4 v4, s[28:31], s101 offen  lds
    buffer_load_dwordx4 v5, s[28:31], s101 offen offset:1024  lds
    s_add_u32 m0, s89, 110592
    s_add_u32 s101, s87, 4096
    buffer_load_dwordx4 v6, s[32:35], s101 offen  lds
    buffer_load_dwordx4 v7, s[32:35], s101 offen offset:1024  lds
    s_add_u32 m0, s89, 94208
    s_nop 0
    buffer_load_dwordx4 v6, s[32:35], s87 offen  lds
    buffer_load_dwordx4 v7, s[32:35], s87 offen offset:1024  lds
    s_add_u32 s86, s86, 128
    s_add_u32 s87, s87, 393216
    s_and_b32 s86, s86, 2047
    s_cselect_b32 s87, s87, 0
    buffer_store_dwordx4 v[16:19], v14, s[36:39], s96 offen offset:0 sc1
    s_mov_b32 s100, 0
    buffer_load_dwordx4 v[64:67], v244, s[48:51], s100 offen nt
    s_mov_b32 s100, 0
    buffer_load_dwordx4 v[96:99], v244, s[52:55], s100 offen nt
    s_mov_b32 s100, 7168
    buffer_load_dwordx4 v[68:71], v244, s[48:51], s100 offen nt
    s_mov_b32 s100, 7168
    buffer_load_dwordx4 v[100:103], v244, s[52:55], s100 offen nt
    s_mov_b32 s100, 14336
    buffer_load_dwordx4 v[72:75], v244, s[48:51], s100 offen nt
    s_mov_b32 s100, 14336
    buffer_load_dwordx4 v[104:107], v244, s[52:55], s100 offen nt
    s_mov_b32 s100, 21504
    buffer_load_dwordx4 v[76:79], v244, s[48:51], s100 offen nt
    s_waitcnt vmcnt(20)
    s_waitcnt lgkmcnt(0)
    s_barrier
    s_add_u32 m0, s88, 118784
    s_nop 0
    buffer_load_dwordx4 v4, s[28:31], s86 offen  lds
    buffer_load_dwordx4 v5, s[28:31], s86 offen offset:1024  lds
    s_add_u32 m0, s89, 143360
    s_add_u32 s101, s87, 2048
    buffer_load_dwordx4 v6, s[32:35], s101 offen  lds
    buffer_load_dwordx4 v7, s[32:35], s101 offen offset:1024  lds
    s_add_u32 m0, s88, 120832
    s_add_u32 s101, s86, 32768
    buffer_load_dwordx4 v4, s[28:31], s101 offen  lds
    buffer_load_dwordx4 v5, s[28:31], s101 offen offset:1024  lds
    s_add_u32 m0, s89, 151552
    s_add_u32 s101, s87, 4096
    buffer_load_dwordx4 v6, s[32:35], s101 offen  lds
    buffer_load_dwordx4 v7, s[32:35], s101 offen offset:1024  lds
    s_add_u32 m0, s89, 135168
    s_nop 0
    buffer_load_dwordx4 v6, s[32:35], s87 offen  lds
    buffer_load_dwordx4 v7, s[32:35], s87 offen offset:1024  lds
    s_add_u32 s86, s86, 128
    s_add_u32 s87, s87, 393216
    s_and_b32 s86, s86, 2047
    s_cselect_b32 s87, s87, 0
    s_waitcnt vmcnt(17)
    s_barrier
    s_cmp_lg_u32 s76, 0
    s_cbranch_scc1 Lfl_5
    s_getreg_b32 s99, hwreg(HW_REG_XCC_ID, 0, 4)
    v_mov_b32 v198, s75
    v_mov_b32 v199, s99
    v_lshlrev_b32_e64 v197, 3, v2
    s_lshl_b32 s78, s77, 7
    s_add_u32 s79, s78, 8781824
    s_add_u32 s78, s78, 4096
    s_lshl_b32 s80, s71, 4
    s_add_u32 s80, s80, s72
    s_lshl_b32 s80, s80, 7
    s_add_u32 s80, s80, 8847360
    s_mov_b64 exec, 0xffff
    buffer_store_dwordx2 v[198:199], v197, s[36:39], s78 offen sc1
    buffer_store_dwordx2 v[198:199], v197, s[36:39], s80 offen sc1
    v_not_b32 v200, v198
    v_mov_b32_e64 v201, 0
    buffer_store_dwordx2 v[200:201], v197, s[36:39], s79 offen sc1
    s_mov_b64 exec, -1
    v_and_b32 v196, 15, v2
    v_lshlrev_b32 v197, 4, v196
    v_add_u32 v197, s69, v197
    s_lshl_b32 s78, s70, 4
    s_lshl_b32 s79, s71, 4
    s_add_u32 s79, s79, 69088
    v_mov_b32 v202, s78
    v_mov_b32 v203, s79
    v_cmp_gt_u32 vcc, 32, v2
    s_nop 1
    v_cndmask_b32 v202, v203, v202, vcc
    v_add_u32 v196, v202, v196
    v_cmp_gt_u32 vcc, 16, v2
    s_nop 1
    v_cndmask_b32 v196, v196, v197, vcc
    v_lshlrev_b32 v196, 7, v196
    v_add_u32 v196, 4096, v196
Lfl_5:
    s_add_u32 m0, s88, 36864
    s_nop 0
    s_nop 0
    buffer_load_dwordx4 v4, s[28:31], s86 offen  lds
    buffer_load_dwordx4 v5, s[28:31], s86 offen offset:1024  lds
    s_add_u32 m0, s89, 61440
    s_add_u32 s101, s87, 2048
    buffer_load_dwordx4 v6, s[32:35], s101 offen  lds
    buffer_load_dwordx4 v7, s[32:35], s101 offen offset:1024  lds
    s_add_u32 m0, s88, 38912
    s_add_u32 s101, s86, 32768
    buffer_load_dwordx4 v4, s[28:31], s101 offen  lds
    buffer_load_dwordx4 v5, s[28:31], s101 offen offset:1024  lds
    s_add_u32 m0, s89, 69632
    s_add_u32 s101, s87, 4096
    buffer_load_dwordx4 v6, s[32:35], s101 offen  lds
    buffer_load_dwordx4 v7, s[32:35], s101 offen offset:1024  lds
    s_add_u32 m0, s89, 53248
    s_nop 0
    buffer_load_dwordx4 v6, s[32:35], s87 offen  lds
    buffer_load_dwordx4 v7, s[32:35], s87 offen offset:1024  lds
    s_add_u32 s86, s86, 128
    s_add_u32 s87, s87, 393216
    s_and_b32 s86, s86, 2047
    s_cselect_b32 s87, s87, 0
    s_waitcnt vmcnt(10)
    s_barrier
    s_add_u32 m0, s88, 77824
    s_nop 0
    s_nop 0
    buffer_load_dwordx4 v4, s[28:31], s86 offen  lds
    buffer_load_dwordx4 v5, s[28:31], s86 offen offset:1024  lds
    s_add_u32 m0, s89, 102400
    s_add_u32 s101, s87, 2048
    buffer_load_dwordx4 v6, s[32:35], s101 offen  lds
    buffer_load_dwordx4 v7, s[32:35], s101 offen offset:1024  lds
    s_add_u32 m0, s88, 79872
    s_add_u32 s101, s86, 32768
    buffer_load_dwordx4 v4, s[28:31], s101 offen  lds
    buffer_load_dwordx4 v5, s[28:31], s101 offen offset:1024  lds
    s_add_u32 m0, s89, 110592
    s_add_u32 s101, s87, 4096
    buffer_load_dwordx4 v6, s[32:35], s101 offen  lds
    buffer_load_dwordx4 v7, s[32:35], s101 offen offset:1024  lds
    s_add_u32 m0, s89, 94208
    s_nop 0
    buffer_load_dwordx4 v6, s[32:35], s87 offen  lds
    buffer_load_dwordx4 v7, s[32:35], s87 offen offset:1024  lds
    s_add_u32 s86, s86, 128
    s_add_u32 s87, s87, 393216
    s_and_b32 s86, s86, 2047
    s_cselect_b32 s87, s87, 0
    s_waitcnt vmcnt(10)
    s_barrier
    s_add_u32 m0, s88, 118784
    s_nop 0
    s_nop 0
    buffer_load_dwordx4 v4, s[28:31], s86 offen  lds
    buffer_load_dwordx4 v5, s[28:31], s86 offen offset:1024  lds
    s_add_u32 m0, s89, 143360
    s_add_u32 s101, s87, 2048
    buffer_load_dwordx4 v6, s[32:35], s101 offen  lds
    buffer_load_dwordx4 v7, s[32:35], s101 offen offset:1024  lds
    s_add_u32 m0, s88, 120832
    s_add_u32 s101, s86, 32768
    buffer_load_dwordx4 v4, s[28:31], s101 offen  lds
    buffer_load_dwordx4 v5, s[28:31], s101 offen offset:1024  lds
    s_add_u32 m0, s89, 151552
    s_add_u32 s101, s87, 4096
    buffer_load_dwordx4 v6, s[32:35], s101 offen  lds
    buffer_load_dwordx4 v7, s[32:35], s101 offen offset:1024  lds
    s_add_u32 m0, s89, 135168
    s_nop 0
    buffer_load_dwordx4 v6, s[32:35], s87 offen  lds
    buffer_load_dwordx4 v7, s[32:35], s87 offen offset:1024  lds
    s_add_u32 s86, s86, 128
    s_add_u32 s87, s87, 393216
    s_and_b32 s86, s86, 2047
    s_cselect_b32 s87, s87, 0
    s_waitcnt vmcnt(10)
    s_barrier
    s_add_u32 m0, s88, 36864
    s_nop 0
    s_nop 0
    buffer_load_dwordx4 v4, s[28:31], s86 offen  lds
    buffer_load_dwordx4 v5, s[28:31], s86 offen offset:1024  lds
    s_add_u32 m0, s89, 61440
    s_add_u32 s101, s87, 2048
    buffer_load_dwordx4 v6, s[32:35], s101 offen  lds
    buffer_load_dwordx4 v7, s[32:35], s101 offen offset:1024  lds
    s_add_u32 m0, s88, 38912
    s_add_u32 s101, s86, 32768
    buffer_load_dwordx4 v4, s[28:31], s101 offen  lds
    buffer_load_dwordx4 v5, s[28:31], s101 offen offset:1024  lds
    s_add_u32 m0, s89, 69632
    s_add_u32 s101, s87, 4096
    buffer_load_dwordx4 v6, s[32:35], s101 offen  lds
    buffer_load_dwordx4 v7, s[32:35], s101 offen offset:1024  lds
    s_add_u32 m0, s89, 53248
    s_nop 0
    buffer_load_dwordx4 v6, s[32:35], s87 offen  lds
    buffer_load_dwordx4 v7, s[32:35], s87 offen offset:1024  lds
    s_add_u32 s86, s86, 128
    s_add_u32 s87, s87, 393216
    s_and_b32 s86, s86, 2047
    s_cselect_b32 s87, s87, 0
    s_mov_b32 s100, 21504
    buffer_load_dwordx4 v[108:111], v244, s[52:55], s100 offen nt
    s_mov_b32 s100, 28672
    buffer_load_dwordx4 v[80:83], v244, s[48:51], s100 offen nt
    s_mov_b32 s100, 28672
    buffer_load_dwordx4 v[112:115], v244, s[52:55], s100 offen nt
    s_mov_b32 s100, 35840
    buffer_load_dwordx4 v[84:87], v244, s[48:51], s100 offen nt
    s_mov_b32 s100, 35840
    buffer_load_dwordx4 v[116:119], v244, s[52:55], s100 offen nt
    s_mov_b32 s100, 43008
    buffer_load_dwordx4 v[88:91], v244, s[48:51], s100 offen nt
    s_mov_b32 s100, 43008
    buffer_load_dwordx4 v[120:123], v244, s[52:55], s100 offen nt
    s_waitcnt vmcnt(17)
    s_barrier
    s_add_u32 m0, s88, 77824
    s_nop 0
    s_nop 0
    buffer_load_dwordx4 v4, s[28:31], s86 offen  lds
    buffer_load_dwordx4 v5, s[28:31], s86 offen offset:1024  lds
    s_add_u32 m0, s89, 102400
    s_add_u32 s101, s87, 2048
    buffer_load_dwordx4 v6, s[32:35], s101 offen  lds
    buffer_load_dwordx4 v7, s[32:35], s101 offen offset:1024  lds
    s_add_u32 m0, s88, 79872
    s_add_u32 s101, s86, 32768
    buffer_load_dwordx4 v4, s[28:31], s101 offen  lds
    buffer_load_dwordx4 v5, s[28:31], s101 offen offset:1024  lds
    s_add_u32 m0, s89, 110592
    s_add_u32 s101, s87, 4096
    buffer_load_dwordx4 v6, s[32:35], s101 offen  lds
    buffer_load_dwordx4 v7, s[32:35], s101 offen offset:1024  lds
    s_add_u32 m0, s89, 94208
    s_nop 0
    buffer_load_dwordx4 v6, s[32:35], s87 offen  lds
    buffer_load_dwordx4 v7, s[32:35], s87 offen offset:1024  lds
    s_add_u32 s86, s86, 128
    s_add_u32 s87, s87, 393216
    s_and_b32 s86, s86, 2047
    s_cselect_b32 s87, s87, 0
    s_waitcnt vmcnt(17)
    s_barrier
    s_add_u32 m0, s88, 118784
    s_nop 0
    s_nop 0
    buffer_load_dwordx4 v4, s[28:31], s86 offen  lds
    buffer_load_dwordx4 v5, s[28:31], s86 offen offset:1024  lds
    s_add_u32 m0, s89, 143360
    s_add_u32 s101, s87, 2048
    buffer_load_dwordx4 v6, s[32:35], s101 offen  lds
    buffer_load_dwordx4 v7, s[32:35], s101 offen offset:1024  lds
    s_add_u32 m0, s88, 120832
    s_add_u32 s101, s86, 32768
    buffer_load_dwordx4 v4, s[28:31], s101 offen  lds
    buffer_load_dwordx4 v5, s[28:31], s101 offen offset:1024  lds
    s_add_u32 m0, s89, 151552
    s_add_u32 s101, s87, 4096
    buffer_load_dwordx4 v6, s[32:35], s101 offen  lds
    buffer_load_dwordx4 v7, s[32:35], s101 offen offset:1024  lds
    s_add_u32 m0, s89, 135168
    s_nop 0
    buffer_load_dwordx4 v6, s[32:35], s87 offen  lds
    buffer_load_dwordx4 v7, s[32:35], s87 offen offset:1024  lds
    s_add_u32 s86, s86, 128
    s_add_u32 s87, s87, 393216
    s_and_b32 s86, s86, 2047
    s_cselect_b32 s87, s87, 0
    s_waitcnt vmcnt(10)
    s_barrier
    s_add_u32 m0, s88, 36864
    s_nop 0
    s_nop 0
    buffer_load_dwordx4 v4, s[28:31], s86 offen  lds
    buffer_load_dwordx4 v5, s[28:31], s86 offen offset:1024  lds
    s_add_u32 m0, s89, 61440
    s_add_u32 s101, s87, 2048
    buffer_load_dwordx4 v6, s[32:35], s101 offen  lds
    buffer_load_dwordx4 v7, s[32:35], s101 offen offset:1024  lds
    s_add_u32 m0, s88, 38912
    s_add_u32 s101, s86, 32768
    buffer_load_dwordx4 v4, s[28:31], s101 offen  lds
    buffer_load_dwordx4 v5, s[28:31], s101 offen offset:1024  lds
    s_add_u32 m0, s89, 69632
    s_add_u32 s101, s87, 4096
    buffer_load_dwordx4 v6, s[32:35], s101 offen  lds
    buffer_load_dwordx4 v7, s[32:35], s101 offen offset:1024  lds
    s_add_u32 m0, s89, 53248
    s_nop 0
    buffer_load_dwordx4 v6, s[32:35], s87 offen  lds
    buffer_load_dwordx4 v7, s[32:35], s87 offen offset:1024  lds
    s_add_u32 s86, s86, 128
    s_add_u32 s87, s87, 393216
    s_and_b32 s86, s86, 2047
    s_cselect_b32 s87, s87, 0
    s_waitcnt vmcnt(10)
    s_barrier
    s_cmp_lg_u32 s76, 2
    s_cbranch_scc1 Lc4_6
    s_mov_b32 exec_hi, -1
    buffer_load_dword v238, v63, s[40:43], 0 offen
    s_mov_b64 exec, -1
Lc4_6:
    s_cmp_lg_u32 s76, 0
    s_cbranch_scc1 Lpl_7
    s_mov_b32 exec_hi, 0xffff
    buffer_load_dwordx2 v[198:199], v196, s[36:39], 0 offen sc1
    s_mov_b64 exec, -1
Lpl_7:
    s_add_u32 m0, s88, 77824
    s_nop 0
    buffer_load_dwordx4 v4, s[28:31], s86 offen  lds
    buffer_load_dwordx4 v5, s[28:31], s86 offen offset:1024  lds
    s_add_u32 m0, s89, 102400
    s_add_u32 s101, s87, 2048
    buffer_load_dwordx4 v6, s[32:35], s101 offen  lds
    buffer_load_dwordx4 v7, s[32:35], s101 offen offset:1024  lds
    s_add_u32 m0, s88, 79872
    s_add_u32 s101, s86, 32768
    buffer_load_dwordx4 v4, s[28:31], s101 offen  lds
    buffer_load_dwordx4 v5, s[28:31], s101 offen offset:1024  lds
    s_add_u32 m0, s89, 110592
    s_add_u32 s101, s87, 4096
    buffer_load_dwordx4 v6, s[32:35], s101 offen  lds
    buffer_load_dwordx4 v7, s[32:35], s101 offen offset:1024  lds
    s_add_u32 m0, s89, 94208
    s_nop 0
    buffer_load_dwordx4 v6, s[32:35], s87 offen  lds
    buffer_load_dwordx4 v7, s[32:35], s87 offen offset:1024  lds
    s_add_u32 s86, s86, 128
    s_add_u32 s87, s87, 393216
    s_and_b32 s86, s86, 2047
    s_cselect_b32 s87, s87, 0
    s_waitcnt vmcnt(10)
    s_barrier
    s_add_u32 m0, s88, 118784
    s_nop 0
    s_nop 0
    buffer_load_dwordx4 v4, s[28:31], s86 offen  lds
    buffer_load_dwordx4 v5, s[28:31], s86 offen offset:1024  lds
    s_add_u32 m0, s89, 143360
    s_add_u32 s101, s87, 2048
    buffer_load_dwordx4 v6, s[32:35], s101 offen  lds
    buffer_load_dwordx4 v7, s[32:35], s101 offen offset:1024  lds
    s_add_u32 m0, s88, 120832
    s_add_u32 s101, s86, 32768
    buffer_load_dwordx4 v4, s[28:31], s101 offen  lds
    buffer_load_dwordx4 v5, s[28:31], s101 offen offset:1024  lds
    s_add_u32 m0, s89, 151552
    s_add_u32 s101, s87, 4096
    buffer_load_dwordx4 v6, s[32:35], s101 offen  lds
    buffer_load_dwordx4 v7, s[32:35], s101 offen offset:1024  lds
    s_add_u32 m0, s89, 135168
    s_nop 0
    buffer_load_dwordx4 v6, s[32:35], s87 offen  lds
    buffer_load_dwordx4 v7, s[32:35], s87 offen offset:1024  lds
    s_add_u32 s86, s86, 128
    s_add_u32 s87, s87, 393216
    s_and_b32 s86, s86, 2047
    s_cselect_b32 s87, s87, 0
    s_waitcnt vmcnt(10)
    s_cmp_lg_u32 s76, 0
    s_cbranch_scc1 Lpc_8
    s_mov_b32 exec_hi, 0xffff
    s_mov_b32 s85, 0
    s_branch Lpk_9
Lspin_10:
    s_add_u32 s85, s85, 1
    s_cmp_gt_u32 s85, 400000
    s_cbranch_scc1 L_end
    buffer_load_dwordx2 v[198:199], v196, s[36:39], 0 offen sc1
    s_waitcnt vmcnt(0)
Lpk_9:
    v_cmp_ne_u32 vcc, s75, v198
    s_cbranch_vccnz Lspin_10
    v_cmp_ne_u32 vcc, s99, v199
    s_mov_b64 exec, -1
    s_lshr_b32 s78, vcc_lo, 16
    s_cselect_b32 s78, 0, 1
    s_cmp_eq_u32 vcc_hi, 0
    s_cselect_b32 s79, 2, 0
    s_or_b32 s78, s78, s79
    s_and_b32 s78, s78, 3
    v_mov_b32_e64 v198, s78
    v_mov_b32 v199, 163584
    ds_write_b32 v199, v198
    s_waitcnt lgkmcnt(0)
Lpc_8:
    s_barrier
    v_lshrrev_b32 v196, 4, v2
    v_and_b32 v197, 15, v2
    v_lshlrev_b32_e64 v197, 4, v197
    v_lshl_add_u32 v198, v196, 10, v197
    s_lshl_b32 s78, s69, 14
    s_lshl_b32 s79, s76, 8
    s_add_u32 s78, s78, s79
    s_nop 0
    s_add_u32 s78, s78, 65536
    buffer_load_dwordx4 v[20:23], v198, s[36:39], s78 offen sc1
    s_add_u32 s78, s78, 4096
    buffer_load_dwordx4 v[24:27], v198, s[36:39], s78 offen sc1
    s_add_u32 s78, s78, 4096
    buffer_load_dwordx4 v[28:31], v198, s[36:39], s78 offen sc1
    s_add_u32 s78, s78, 4096
    buffer_load_dwordx4 v[32:35], v198, s[36:39], s78 offen sc1
    v_mul_u32_u24 v198, 768, v196
    v_add_u32_e64 v198, v198, v197
    s_mul_i32 s78, s70, 12288
    s_lshl_b32 s79, s76, 8
    s_add_u32 s78, s78, s79
    s_add_u32 s78, s78, 327680
    s_cmp_eq_u32 s76, 3
    s_nop 0
    s_cselect_b32 s78, 0x10000000, s78
    buffer_load_dwordx4 v[36:39], v198, s[36:39], s78 offen sc1
    s_add_u32 s78, s78, 3072
    buffer_load_dwordx4 v[40:43], v198, s[36:39], s78 offen sc1
    s_add_u32 s78, s78, 3072
    buffer_load_dwordx4 v[44:47], v198, s[36:39], s78 offen sc1
    s_add_u32 s78, s78, 3072
    buffer_load_dwordx4 v[48:51], v198, s[36:39], s78 offen sc1
    s_add_u32 m0, s84, 0
    s_mov_b32 s100, 0
    buffer_load_dwordx4 v246, s[40:43], s100 offen  lds
    s_add_u32 m0, s84, 4096
    s_mov_b32 s100, 65536
    buffer_load_dwordx4 v246, s[40:43], s100 offen  lds
    s_waitcnt vmcnt(10)
    s_waitcnt lgkmcnt(0)
    s_barrier
    s_setprio 2
    s_add_u32 m0, s84, 8192
    s_mov_b32 s100, 131072
    buffer_load_dwordx4 v246, s[40:43], s100 offen  lds
    s_waitcnt vmcnt(7)
    v_add_f32 v20, v20, v24
    v_add_f32 v21, v21, v25
    v_add_f32 v22, v22, v26
    v_add_f32 v23, v23, v27
    v_add_f32 v20, v20, v28
    v_add_f32 v21, v21, v29
    v_add_f32 v22, v22, v30
    v_add_f32_e64 v23, v23, v31
    s_add_u32 m0, s84, 12288
    s_mov_b32 s100, 196608
    buffer_load_dwordx4 v246, s[40:43], s100 offen  lds
    v_add_f32 v20, v20, v32
    v_add_f32 v21, v21, v33
    v_add_f32 v22, v22, v34
    v_add_f32 v23, v23, v35
    s_nop 0
    v_permlane32_swap_b32 v20, v22
    v_permlane32_swap_b32 v21, v23
    v_add_f32 v20, v20, v22
    v_add_f32 v21, v21, v23
    v_mov_b32 v22, v20
    v_mov_b32_e64 v23, v21
    s_add_u32 m0, s84, 16384
    s_mov_b32 s100, 262144
    buffer_load_dwordx4 v246, s[40:43], s100 offen  lds
    v_permlane16_swap_b32 v20, v22
    v_permlane16_swap_b32 v21, v23
    v_add_f32 v20, v20, v22
    v_add_f32 v21, v21, v23
    v_mul_f32 v24, 0x3a800000, v20
    v_mul_f32 v26, 0x3a800000, v21
    v_fma_f32 v26, -v24, v24, v26
    v_max_f32_e64 v26, 0, v26
    v_cvt_pk_bf16_f32 v24, v24, v24
    v_and_b32 v24, 0xffff0000, v24
    s_add_u32 m0, s84, 20480
    s_mov_b32 s100, 327680
    buffer_load_dwordx4 v246, s[40:43], s100 offen  lds
    v_cvt_pk_bf16_f32 v26, v26, v26
    v_and_b32 v26, 0xffff0000, v26
    v_add_f32 v26, 0x3727c5ac, v26
    v_cvt_pk_bf16_f32 v26, v26, v26
    v_and_b32 v26, 0xffff0000, v26
    v_sqrt_f32 v26, v26
    s_nop 0
    v_cvt_pk_bf16_f32 v26, v26, v26
    v_and_b32 v26, 0xffff0000, v26
    v_rcp_f32_e64 v25, v26
    v_xor_b32 v26, 0x80000000, v24
    s_add_u32 m0, s84, 24576
    s_mov_b32 s100, 393216
    buffer_load_dwordx4 v246, s[40:43], s100 offen  lds
    v_lshrrev_b32 v27, 16, v26
    v_or_b32 v26, v26, v27
    v_mov_b32 v27, 0
    v_and_b32 v196, 15, v2
    v_lshrrev_b32_e64 v197, 5, v2
    v_lshl_add_u32 v196, v196, 1, v197
    s_lshl_b32 s78, s76, 5
    v_add_u32 v196, s78, v196
    v_lshlrev_b32_e64 v197, 3, v196
    v_add_u32 v197, 159744, v197
    s_add_u32 m0, s84, 28672
    s_mov_b32 s100, 458752
    buffer_load_dwordx4 v246, s[40:43], s100 offen  lds
    v_lshlrev_b32_e64 v196, 2, v196
    v_add_u32 v196, 162304, v196
    ds_write_b64 v197, v[26:27]
    ds_write_b32 v196, v25
    s_waitcnt vmcnt(8)
    v_add_f32 v36, v36, v40
    v_add_f32 v37, v37, v41
    v_add_f32 v38, v38, v42
    v_add_f32 v39, v39, v43
    v_add_f32 v36, v36, v44
    s_add_u32 m0, s84, 32768
    s_mov_b32 s100, 524288
    buffer_load_dwordx4 v246, s[40:43], s100 offen  lds
    v_add_f32 v37, v37, v45
    v_add_f32 v38, v38, v46
    v_add_f32 v39, v39, v47
    v_add_f32 v36, v36, v48
    v_add_f32 v37, v37, v49
    v_add_f32 v38, v38, v50
    v_add_f32 v39, v39, v51
    s_nop 0
    v_permlane32_swap_b32 v36, v38
    v_permlane32_swap_b32 v37, v39
    v_add_f32_e64 v36, v36, v38
    s_add_u32 m0, s84, 36864
    s_mov_b32 s100, 589824
    buffer_load_dwordx4 v246, s[40:43], s100 offen  lds
    v_add_f32 v37, v37, v39
    s_nop 1
    v_permlane16_swap_b32 v36, v37
    v_add_f32 v36, v36, v37
    v_cvt_pk_bf16_f32 v37, v36, v36
    v_and_b32 v37, 0xffff0000, v37
    v_sub_f32_e64 v38, v36, v37
    v_cvt_pk_bf16_f32 v38, v37, v38
    v_mov_b32 v39, 0
    v_and_b32 v196, 15, v2
    v_lshrrev_b32_e64 v197, 4, v2
    s_add_u32 m0, s84, 40960
    s_mov_b32 s100, 655360
    buffer_load_dwordx4 v246, s[40:43], s100 offen  lds
    v_lshl_add_u32 v196, v196, 2, v197
    s_lshl_b32 s78, s76, 9
    s_add_u32 s78, s78, 160768
    v_lshl_add_u32 v196, v196, 3, s78
    v_and_b32 v197, 15, v2
    v_lshlrev_b32_e64 v197, 3, v197
    v_add_u32 v197, 162816, v197
    v_mov_b32 v198, 0x3f803f80
    s_cmp_eq_u32 s76, 3
    s_cselect_b64 vcc, -1, 0
    v_cndmask_b32 v196, v196, v197, vcc
    v_cndmask_b32 v38, v38, v198, vcc
    v_cndmask_b32_e64 v39, v39, v198, vcc
    ds_write_b64 v196, v[38:39]
    s_setprio 0
    s_waitcnt lgkmcnt(0)
    s_barrier
    s_branch L_phend
L_ph1:
    s_add_u32 m0, s88, 77824
    s_nop 0
    s_nop 0
    buffer_load_dwordx4 v4, s[28:31], s86 offen  lds
    buffer_load_dwordx4 v5, s[28:31], s86 offen offset:1024  lds
    s_add_u32 m0, s89, 102400
    s_add_u32 s101, s87, 2048
    buffer_load_dwordx4 v6, s[32:35], s101 offen  lds
    buffer_load_dwordx4 v7, s[32:35], s101 offen offset:1024  lds
    s_add_u32 m0, s88, 79872
    s_add_u32 s101, s86, 32768
    buffer_load_dwordx4 v4, s[28:31], s101 offen  lds
    buffer_load_dwordx4 v5, s[28:31], s101 offen offset:1024  lds
    s_add_u32 m0, s89, 110592
    s_add_u32 s101, s87, 4096
    buffer_load_dwordx4 v6, s[32:35], s101 offen  lds
    buffer_load_dwordx4 v7, s[32:35], s101 offen offset:1024  lds
    s_add_u32 m0, s89, 94208
    s_nop 0
    buffer_load_dwordx4 v6, s[32:35], s87 offen  lds
    buffer_load_dwordx4 v7, s[32:35], s87 offen offset:1024  lds
    s_add_u32 s86, s86, 128
    s_add_u32 s87, s87, 393216
    s_and_b32 s86, s86, 2047
    s_cselect_b32 s87, s87, 0
    buffer_store_dwordx4 v[16:19], v14, s[36:39], s96 offen offset:0 sc1
    s_waitcnt vmcnt(13)
    s_waitcnt lgkmcnt(0)
    s_barrier
    s_add_u32 m0, s88, 118784
    s_nop 0
    buffer_load_dwordx4 v4, s[28:31], s86 offen  lds
    buffer_load_dwordx4 v5, s[28:31], s86 offen offset:1024  lds
    s_add_u32 m0, s89, 143360
    s_add_u32 s101, s87, 2048
    buffer_load_dwordx4 v6, s[32:35], s101 offen  lds
    buffer_load_dwordx4 v7, s[32:35], s101 offen offset:1024  lds
    s_add_u32 m0, s88, 120832
    s_add_u32 s101, s86, 32768
    buffer_load_dwordx4 v4, s[28:31], s101 offen  lds
    buffer_load_dwordx4 v5, s[28:31], s101 offen offset:1024  lds
    s_add_u32 m0, s89, 151552
    s_add_u32 s101, s87, 4096
    buffer_load_dwordx4 v6, s[32:35], s101 offen  lds
    buffer_load_dwordx4 v7, s[32:35], s101 offen offset:1024  lds
    s_add_u32 m0, s89, 135168
    s_nop 0
    buffer_load_dwordx4 v6, s[32:35], s87 offen  lds
    buffer_load_dwordx4 v7, s[32:35], s87 offen offset:1024  lds
    s_add_u32 s86, s86, 128
    s_add_u32 s87, s87, 393216
    s_and_b32 s86, s86, 2047
    s_cselect_b32 s87, s87, 0
    s_mov_b32 s100, 0
    buffer_load_dwordx4 v[64:67], v244, s[48:51], s100 offen nt
    s_mov_b32 s100, 0
    buffer_load_dwordx4 v[96:99], v244, s[52:55], s100 offen nt
    s_mov_b32 s100, 7168
    buffer_load_dwordx4 v[68:71], v244, s[48:51], s100 offen nt
    s_mov_b32 s100, 7168
    buffer_load_dwordx4 v[100:103], v244, s[52:55], s100 offen nt
    s_mov_b32 s100, 14336
    buffer_load_dwordx4 v[72:75], v244, s[48:51], s100 offen nt
    s_mov_b32 s100, 14336
    buffer_load_dwordx4 v[104:107], v244, s[52:55], s100 offen nt
    s_mov_b32 s100, 21504
    buffer_load_dwordx4 v[76:79], v244, s[48:51], s100 offen nt
    s_waitcnt vmcnt(17)
    s_barrier
    s_cmp_lg_u32 s76, 0
    s_cbranch_scc1 Lfl_11
    s_getreg_b32 s99, hwreg(HW_REG_XCC_ID, 0, 4)
    v_mov_b32 v198, s75
    v_mov_b32 v199, s99
    v_lshlrev_b32_e64 v197, 3, v2
    s_lshl_b32 s78, s77, 7
    s_add_u32 s79, s78, 8781824
    s_add_u32 s78, s78, 4096
    s_lshl_b32 s80, s71, 4
    s_add_u32 s80, s80, s72
    s_lshl_b32 s80, s80, 7
    s_add_u32 s80, s80, 8847360
    s_mov_b64 exec, 0xffff
    buffer_store_dwordx2 v[198:199], v197, s[36:39], s78 offen sc1
    buffer_store_dwordx2 v[198:199], v197, s[36:39], s80 offen sc1
    v_not_b32 v200, v198
    v_mov_b32_e64 v201, 0
    buffer_store_dwordx2 v[200:201], v197, s[36:39], s79 offen sc1
    s_mov_b64 exec, -1
    v_and_b32 v196, 15, v2
    v_lshlrev_b32 v197, 4, v196
    v_add_u32 v197, s69, v197
    s_lshl_b32 s78, s70, 4
    s_lshl_b32 s79, s71, 4
    s_add_u32 s79, s79, 69088
    v_mov_b32 v202, s78
    v_mov_b32 v203, s79
    v_cmp_gt_u32 vcc, 32, v2
    s_nop 1
    v_cndmask_b32 v202, v203, v202, vcc
    v_add_u32 v196, v202, v196
    v_cmp_gt_u32 vcc, 16, v2
    s_nop 1
    v_cndmask_b32 v196, v196, v197, vcc
    v_lshlrev_b32 v196, 7, v196
    v_add_u32 v196, 4096, v196
Lfl_11:
    s_add_u32 m0, s88, 36864
    s_nop 0
    s_nop 0
    buffer_load_dwordx4 v4, s[28:31], s86 offen  lds
    buffer_load_dwordx4 v5, s[28:31], s86 offen offset:1024  lds
    s_add_u32 m0, s89, 61440
    s_add_u32 s101, s87, 2048
    buffer_load_dwordx4 v6, s[32:35], s101 offen  lds
    buffer_load_dwordx4 v7, s[32:35], s101 offen offset:1024  lds
    s_add_u32 m0, s88, 38912
    s_add_u32 s101, s86, 32768
    buffer_load_dwordx4 v4, s[28:31], s101 offen  lds
    buffer_load_dwordx4 v5, s[28:31], s101 offen offset:1024  lds
    s_add_u32 m0, s89, 69632
    s_add_u32 s101, s87, 4096
    buffer_load_dwordx4 v6, s[32:35], s101 offen  lds
    buffer_load_dwordx4 v7, s[32:35], s101 offen offset:1024  lds
    s_add_u32 m0, s89, 53248
    s_nop 0
    buffer_load_dwordx4 v6, s[32:35], s87 offen  lds
    buffer_load_dwordx4 v7, s[32:35], s87 offen offset:1024  lds
    s_add_u32 s86, s86, 128
    s_add_u32 s87, s87, 393216
    s_and_b32 s86, s86, 2047
    s_cselect_b32 s87, s87, 0
    s_waitcnt vmcnt(17)
    s_barrier
    s_add_u32 m0, s88, 77824
    s_nop 0
    s_nop 0
    buffer_load_dwordx4 v4, s[28:31], s86 offen  lds
    buffer_load_dwordx4 v5, s[28:31], s86 offen offset:1024  lds
    s_add_u32 m0, s89, 102400
    s_add_u32 s101, s87, 2048
    buffer_load_dwordx4 v6, s[32:35], s101 offen  lds
    buffer_load_dwordx4 v7, s[32:35], s101 offen offset:1024  lds
    s_add_u32 m0, s88, 79872
    s_add_u32 s101, s86, 32768
    buffer_load_dwordx4 v4, s[28:31], s101 offen  lds
    buffer_load_dwordx4 v5, s[28:31], s101 offen offset:1024  lds
    s_add_u32 m0, s89, 110592
    s_add_u32 s101, s87, 4096
    buffer_load_dwordx4 v6, s[32:35], s101 offen  lds
    buffer_load_dwordx4 v7, s[32:35], s101 offen offset:1024  lds
    s_add_u32 m0, s89, 94208
    s_nop 0
    buffer_load_dwordx4 v6, s[32:35], s87 offen  lds
    buffer_load_dwordx4 v7, s[32:35], s87 offen offset:1024  lds
    s_add_u32 s86, s86, 128
    s_add_u32 s87, s87, 393216
    s_and_b32 s86, s86, 2047
    s_cselect_b32 s87, s87, 0
    s_waitcnt vmcnt(10)
    s_barrier
    s_add_u32 m0, s88, 118784
    s_nop 0
    s_nop 0
    buffer_load_dwordx4 v4, s[28:31], s86 offen  lds
    buffer_load_dwordx4 v5, s[28:31], s86 offen offset:1024  lds
    s_add_u32 m0, s89, 143360
    s_add_u32 s101, s87, 2048
    buffer_load_dwordx4 v6, s[32:35], s101 offen  lds
    buffer_load_dwordx4 v7, s[32:35], s101 offen offset:1024  lds
    s_add_u32 m0, s88, 120832
    s_add_u32 s101, s86, 32768
    buffer_load_dwordx4 v4, s[28:31], s101 offen  lds
    buffer_load_dwordx4 v5, s[28:31], s101 offen offset:1024  lds
    s_add_u32 m0, s89, 151552
    s_add_u32 s101, s87, 4096
    buffer_load_dwordx4 v6, s[32:35], s101 offen  lds
    buffer_load_dwordx4 v7, s[32:35], s101 offen offset:1024  lds
    s_add_u32 m0, s89, 135168
    s_nop 0
    buffer_load_dwordx4 v6, s[32:35], s87 offen  lds
    buffer_load_dwordx4 v7, s[32:35], s87 offen offset:1024  lds
    s_add_u32 s86, s86, 128
    s_add_u32 s87, s87, 393216
    s_and_b32 s86, s86, 2047
    s_cselect_b32 s87, s87, 0
    s_waitcnt vmcnt(10)
    s_barrier
    s_add_u32 m0, s88, 36864
    s_nop 0
    s_nop 0
    buffer_load_dwordx4 v4, s[28:31], s86 offen  lds
    buffer_load_dwordx4 v5, s[28:31], s86 offen offset:1024  lds
    s_add_u32 m0, s89, 61440
    s_add_u32 s101, s87, 2048
    buffer_load_dwordx4 v6, s[32:35], s101 offen  lds
    buffer_load_dwordx4 v7, s[32:35], s101 offen offset:1024  lds
    s_add_u32 m0, s88, 38912
    s_add_u32 s101, s86, 32768
    buffer_load_dwordx4 v4, s[28:31], s101 offen  lds
    buffer_load_dwordx4 v5, s[28:31], s101 offen offset:1024  lds
    s_add_u32 m0, s89, 69632
    s_add_u32 s101, s87, 4096
    buffer_load_dwordx4 v6, s[32:35], s101 offen  lds
    buffer_load_dwordx4 v7, s[32:35], s101 offen offset:1024  lds
    s_add_u32 m0, s89, 53248
    s_nop 0
    buffer_load_dwordx4 v6, s[32:35], s87 offen  lds
    buffer_load_dwordx4 v7, s[32:35], s87 offen offset:1024  lds
    s_add_u32 s86, s86, 128
    s_add_u32 s87, s87, 393216
    s_and_b32 s86, s86, 2047
    s_cselect_b32 s87, s87, 0
    s_waitcnt vmcnt(10)
    s_barrier
    s_add_u32 m0, s88, 77824
    s_nop 0
    s_nop 0
    buffer_load_dwordx4 v4, s[28:31], s86 offen  lds
    buffer_load_dwordx4 v5, s[28:31], s86 offen offset:1024  lds
    s_add_u32 m0, s89, 102400
    s_add_u32 s101, s87, 2048
    buffer_load_dwordx4 v6, s[32:35], s101 offen  lds
    buffer_load_dwordx4 v7, s[32:35], s101 offen offset:1024  lds
    s_add_u32 m0, s88, 79872
    s_add_u32 s101, s86, 32768
    buffer_load_dwordx4 v4, s[28:31], s101 offen  lds
    buffer_load_dwordx4 v5, s[28:31], s101 offen offset:1024  lds
    s_add_u32 m0, s89, 110592
    s_add_u32 s101, s87, 4096
    buffer_load_dwordx4 v6, s[32:35], s101 offen  lds
    buffer_load_dwordx4 v7, s[32:35], s101 offen offset:1024  lds
    s_add_u32 m0, s89, 94208
    s_nop 0
    buffer_load_dwordx4 v6, s[32:35], s87 offen  lds
    buffer_load_dwordx4 v7, s[32:35], s87 offen offset:1024  lds
    s_add_u32 s86, s86, 128
    s_add_u32 s87, s87, 393216
    s_and_b32 s86, s86, 2047
    s_cselect_b32 s87, s87, 0
    s_mov_b32 s100, 21504
    buffer_load_dwordx4 v[108:111], v244, s[52:55], s100 offen nt
    s_mov_b32 s100, 28672
    buffer_load_dwordx4 v[80:83], v244, s[48:51], s100 offen nt
    s_mov_b32 s100, 28672
    buffer_load_dwordx4 v[112:115], v244, s[52:55], s100 offen nt
    s_mov_b32 s100, 35840
    buffer_load_dwordx4 v[84:87], v244, s[48:51], s100 offen nt
    s_mov_b32 s100, 35840
    buffer_load_dwordx4 v[116:119], v244, s[52:55], s100 offen nt
    s_mov_b32 s100, 43008
    buffer_load_dwordx4 v[88:91], v244, s[48:51], s100 offen nt
    s_mov_b32 s100, 43008
    buffer_load_dwordx4 v[120:123], v244, s[52:55], s100 offen nt
    s_waitcnt vmcnt(17)
    s_barrier
    s_add_u32 m0, s88, 118784
    s_nop 0
    s_nop 0
    buffer_load_dwordx4 v4, s[28:31], s86 offen  lds
    buffer_load_dwordx4 v5, s[28:31], s86 offen offset:1024  lds
    s_add_u32 m0, s89, 143360
    s_add_u32 s101, s87, 2048
    buffer_load_dwordx4 v6, s[32:35], s101 offen  lds
    buffer_load_dwordx4 v7, s[32:35], s101 offen offset:1024  lds
    s_add_u32 m0, s88, 120832
    s_add_u32 s101, s86, 32768
    buffer_load_dwordx4 v4, s[28:31], s101 offen  lds
    buffer_load_dwordx4 v5, s[28:31], s101 offen offset:1024  lds
    s_add_u32 m0, s89, 151552
    s_add_u32 s101, s87, 4096
    buffer_load_dwordx4 v6, s[32:35], s101 offen  lds
    buffer_load_dwordx4 v7, s[32:35], s101 offen offset:1024  lds
    s_add_u32 m0, s89, 135168
    s_nop 0
    buffer_load_dwordx4 v6, s[32:35], s87 offen  lds
    buffer_load_dwordx4 v7, s[32:35], s87 offen offset:1024  lds
    s_add_u32 s86, s86, 128
    s_add_u32 s87, s87, 393216
    s_and_b32 s86, s86, 2047
    s_cselect_b32 s87, s87, 0
    s_waitcnt vmcnt(17)
    s_barrier
    s_add_u32 m0, s88, 36864
    s_nop 0
    s_nop 0
    buffer_load_dwordx4 v4, s[28:31], s86 offen  lds
    buffer_load_dwordx4 v5, s[28:31], s86 offen offset:1024  lds
    s_add_u32 m0, s89, 61440
    s_add_u32 s101, s87, 2048
    buffer_load_dwordx4 v6, s[32:35], s101 offen  lds
    buffer_load_dwordx4 v7, s[32:35], s101 offen offset:1024  lds
    s_add_u32 m0, s88, 38912
    s_add_u32 s101, s86, 32768
    buffer_load_dwordx4 v4, s[28:31], s101 offen  lds
    buffer_load_dwordx4 v5, s[28:31], s101 offen offset:1024  lds
    s_add_u32 m0, s89, 69632
    s_add_u32 s101, s87, 4096
    buffer_load_dwordx4 v6, s[32:35], s101 offen  lds
    buffer_load_dwordx4 v7, s[32:35], s101 offen offset:1024  lds
    s_add_u32 m0, s89, 53248
    s_nop 0
    buffer_load_dwordx4 v6, s[32:35], s87 offen  lds
    buffer_load_dwordx4 v7, s[32:35], s87 offen offset:1024  lds
    s_add_u32 s86, s86, 128
    s_add_u32 s87, s87, 393216
    s_and_b32 s86, s86, 2047
    s_cselect_b32 s87, s87, 0
    s_waitcnt vmcnt(10)
    s_barrier
    s_cmp_lg_u32 s76, 2
    s_cbranch_scc1 Lc4_12
    s_mov_b32 exec_hi, -1
    buffer_load_dword v238, v63, s[40:43], 0 offen
    s_mov_b64 exec, -1
Lc4_12:
    s_cmp_lg_u32 s76, 0
    s_cbranch_scc1 Lpl_13
    s_mov_b32 exec_hi, 0xffff
    buffer_load_dwordx2 v[198:199], v196, s[36:39], 0 offen sc1
    s_mov_b64 exec, -1
Lpl_13:
    s_add_u32 m0, s88, 77824
    s_nop 0
    buffer_load_dwordx4 v4, s[28:31], s86 offen  lds
    buffer_load_dwordx4 v5, s[28:31], s86 offen offset:1024  lds
    s_add_u32 m0, s89, 102400
    s_add_u32 s101, s87, 2048
    buffer_load_dwordx4 v6, s[32:35], s101 offen  lds
    buffer_load_dwordx4 v7, s[32:35], s101 offen offset:1024  lds
    s_add_u32 m0, s88, 79872
    s_add_u32 s101, s86, 32768
    buffer_load_dwordx4 v4, s[28:31], s101 offen  lds
    buffer_load_dwordx4 v5, s[28:31], s101 offen offset:1024  lds
    s_add_u32 m0, s89, 110592
    s_add_u32 s101, s87, 4096
    buffer_load_dwordx4 v6, s[32:35], s101 offen  lds
    buffer_load_dwordx4 v7, s[32:35], s101 offen offset:1024  lds
    s_add_u32 m0, s89, 94208
    s_nop 0
    buffer_load_dwordx4 v6, s[32:35], s87 offen  lds
    buffer_load_dwordx4 v7, s[32:35], s87 offen offset:1024  lds
    s_add_u32 s86, s86, 128
    s_add_u32 s87, s87, 393216
    s_and_b32 s86, s86, 2047
    s_cselect_b32 s87, s87, 0
    s_waitcnt vmcnt(10)
    s_barrier
    s_add_u32 m0, s88, 118784
    s_nop 0
    s_nop 0
    buffer_load_dwordx4 v4, s[28:31], s86 offen  lds
    buffer_load_dwordx4 v5, s[28:31], s86 offen offset:1024  lds
    s_add_u32 m0, s89, 143360
    s_add_u32 s101, s87, 2048
    buffer_load_dwordx4 v6, s[32:35], s101 offen  lds
    buffer_load_dwordx4 v7, s[32:35], s101 offen offset:1024  lds
    s_add_u32 m0, s88, 120832
    s_add_u32 s101, s86, 32768
    buffer_load_dwordx4 v4, s[28:31], s101 offen  lds
    buffer_load_dwordx4 v5, s[28:31], s101 offen offset:1024  lds
    s_add_u32 m0, s89, 151552
    s_add_u32 s101, s87, 4096
    buffer_load_dwordx4 v6, s[32:35], s101 offen  lds
    buffer_load_dwordx4 v7, s[32:35], s101 offen offset:1024  lds
    s_add_u32 m0, s89, 135168
    s_nop 0
    buffer_load_dwordx4 v6, s[32:35], s87 offen  lds
    buffer_load_dwordx4 v7, s[32:35], s87 offen offset:1024  lds
    s_add_u32 s86, s86, 128
    s_add_u32 s87, s87, 393216
    s_and_b32 s86, s86, 2047
    s_cselect_b32 s87, s87, 0
    s_waitcnt vmcnt(10)
    s_cmp_lg_u32 s76, 0
    s_cbranch_scc1 Lpc_14
    s_mov_b32 exec_hi, 0xffff
    s_mov_b32 s85, 0
    s_branch Lpk_15
Lspin_16:
    s_add_u32 s85, s85, 1
    s_cmp_gt_u32 s85, 400000
    s_cbranch_scc1 L_end
    buffer_load_dwordx2 v[198:199], v196, s[36:39], 0 offen sc1
    s_waitcnt vmcnt(0)
Lpk_15:
    v_cmp_ne_u32 vcc, s75, v198
    s_cbranch_vccnz Lspin_16
    v_cmp_ne_u32 vcc, s99, v199
    s_mov_b64 exec, -1
    s_lshr_b32 s78, vcc_lo, 16
    s_cselect_b32 s78, 0, 1
    s_cmp_eq_u32 vcc_hi, 0
    s_cselect_b32 s79, 2, 0
    s_or_b32 s78, s78, s79
    s_and_b32 s78, s78, 3
    v_mov_b32_e64 v198, s78
    v_mov_b32 v199, 163584
    ds_write_b32 v199, v198
    s_waitcnt lgkmcnt(0)
Lpc_14:
    s_barrier
    v_lshrrev_b32 v196, 4, v2
    v_and_b32 v197, 15, v2
    v_lshlrev_b32_e64 v197, 4, v197
    v_lshl_add_u32 v198, v196, 10, v197
    s_lshl_b32 s78, s69, 14
    s_lshl_b32 s79, s76, 8
    s_add_u32 s78, s78, s79
    s_nop 0
    s_add_u32 s78, s78, 65536
    buffer_load_dwordx4 v[20:23], v198, s[36:39], s78 offen sc1
    s_add_u32 s78, s78, 4096
    buffer_load_dwordx4 v[24:27], v198, s[36:39], s78 offen sc1
    s_add_u32 s78, s78, 4096
    buffer_load_dwordx4 v[28:31], v198, s[36:39], s78 offen sc1
    s_add_u32 s78, s78, 4096
    buffer_load_dwordx4 v[32:35], v198, s[36:39], s78 offen sc1
    v_mul_u32_u24 v198, 768, v196
    v_add_u32_e64 v198, v198, v197
    s_mul_i32 s78, s70, 12288
    s_lshl_b32 s79, s76, 8
    s_add_u32 s78, s78, s79
    s_add_u32 s78, s78, 327680
    s_cmp_eq_u32 s76, 3
    s_nop 0
    s_cselect_b32 s78, 0x10000000, s78
    buffer_load_dwordx4 v[36:39], v198, s[36:39], s78 offen sc1
    s_add_u32 s78, s78, 3072
    buffer_load_dwordx4 v[40:43], v198, s[36:39], s78 offen sc1
    s_add_u32 s78, s78, 3072
    buffer_load_dwordx4 v[44:47], v198, s[36:39], s78 offen sc1
    s_add_u32 s78, s78, 3072
    buffer_load_dwordx4 v[48:51], v198, s[36:39], s78 offen sc1
    s_add_u32 m0, s84, 0
    s_mov_b32 s100, 0
    buffer_load_dwordx4 v246, s[40:43], s100 offen  lds
    s_add_u32 m0, s84, 4096
    s_mov_b32 s100, 65536
    buffer_load_dwordx4 v246, s[40:43], s100 offen  lds
    s_waitcnt vmcnt(10)
    s_waitcnt lgkmcnt(0)
    s_barrier
    s_setprio 2
    s_add_u32 m0, s84, 8192
    s_mov_b32 s100, 131072
    buffer_load_dwordx4 v246, s[40:43], s100 offen  lds
    s_waitcnt vmcnt(7)
    v_add_f32 v20, v20, v24
    v_add_f32 v21, v21, v25
    v_add_f32 v22, v22, v26
    v_add_f32 v23, v23, v27
    v_add_f32 v20, v20, v28
    v_add_f32 v21, v21, v29
    v_add_f32 v22, v22, v30
    v_add_f32_e64 v23, v23, v31
    s_add_u32 m0, s84, 12288
    s_mov_b32 s100, 196608
    buffer_load_dwordx4 v246, s[40:43], s100 offen  lds
    v_add_f32 v20, v20, v32
    v_add_f32 v21, v21, v33
    v_add_f32 v22, v22, v34
    v_add_f32 v23, v23, v35
    s_nop 0
    v_permlane32_swap_b32 v20, v22
    v_permlane32_swap_b32 v21, v23
    v_add_f32 v20, v20, v22
    v_add_f32 v21, v21, v23
    v_mov_b32 v22, v20
    v_mov_b32_e64 v23, v21
    s_add_u32 m0, s84, 16384
    s_mov_b32 s100, 262144
    buffer_load_dwordx4 v246, s[40:43], s100 offen  lds
    v_permlane16_swap_b32 v20, v22
    v_permlane16_swap_b32 v21, v23
    v_add_f32 v20, v20, v22
    v_add_f32 v21, v21, v23
    v_mul_f32 v24, 0x3a800000, v20
    v_mul_f32 v26, 0x3a800000, v21
    v_fma_f32 v26, -v24, v24, v26
    v_max_f32_e64 v26, 0, v26
    v_cvt_pk_bf16_f32 v24, v24, v24
    v_and_b32 v24, 0xffff0000, v24
    s_add_u32 m0, s84, 20480
    s_mov_b32 s100, 327680
    buffer_load_dwordx4 v246, s[40:43], s100 offen  lds
    v_cvt_pk_bf16_f32 v26, v26, v26
    v_and_b32 v26, 0xffff0000, v26
    v_add_f32 v26, 0x3727c5ac, v26
    v_cvt_pk_bf16_f32 v26, v26, v26
    v_and_b32 v26, 0xffff0000, v26
    v_sqrt_f32 v26, v26
    s_nop 0
    v_cvt_pk_bf16_f32 v26, v26, v26
    v_and_b32 v26, 0xffff0000, v26
    v_rcp_f32_e64 v25, v26
    v_xor_b32 v26, 0x80000000, v24
    s_add_u32 m0, s84, 24576
    s_mov_b32 s100, 393216
    buffer_load_dwordx4 v246, s[40:43], s100 offen  lds
    v_lshrrev_b32 v27, 16, v26
    v_or_b32 v26, v26, v27
    v_mov_b32 v27, 0
    v_and_b32 v196, 15, v2
    v_lshrrev_b32_e64 v197, 5, v2
    v_lshl_add_u32 v196, v196, 1, v197
    s_lshl_b32 s78, s76, 5
    v_add_u32 v196, s78, v196
    v_lshlrev_b32_e64 v197, 3, v196
    v_add_u32 v197, 159744, v197
    s_add_u32 m0, s84, 28672
    s_mov_b32 s100, 458752
    buffer_load_dwordx4 v246, s[40:43], s100 offen  lds
    v_lshlrev_b32_e64 v196, 2, v196
    v_add_u32 v196, 162304, v196
    ds_write_b64 v197, v[26:27]
    ds_write_b32 v196, v25
    s_waitcnt vmcnt(8)
    v_add_f32 v36, v36, v40
    v_add_f32 v37, v37, v41
    v_add_f32 v38, v38, v42
    v_add_f32 v39, v39, v43
    v_add_f32 v36, v36, v44
    s_add_u32 m0, s84, 32768
    s_mov_b32 s100, 524288
    buffer_load_dwordx4 v246, s[40:43], s100 offen  lds
    v_add_f32 v37, v37, v45
    v_add_f32 v38, v38, v46
    v_add_f32 v39, v39, v47
    v_add_f32 v36, v36, v48
    v_add_f32 v37, v37, v49
    v_add_f32 v38, v38, v50
    v_add_f32 v39, v39, v51
    s_nop 0
    v_permlane32_swap_b32 v36, v38
    v_permlane32_swap_b32 v37, v39
    v_add_f32_e64 v36, v36, v38
    s_add_u32 m0, s84, 36864
    s_mov_b32 s100, 589824
    buffer_load_dwordx4 v246, s[40:43], s100 offen  lds
    v_add_f32 v37, v37, v39
    s_nop 1
    v_permlane16_swap_b32 v36, v37
    v_add_f32 v36, v36, v37
    v_cvt_pk_bf16_f32 v37, v36, v36
    v_and_b32 v37, 0xffff0000, v37
    v_sub_f32_e64 v38, v36, v37
    v_cvt_pk_bf16_f32 v38, v37, v38
    v_mov_b32 v39, 0
    v_and_b32 v196, 15, v2
    v_lshrrev_b32_e64 v197, 4, v2
    s_add_u32 m0, s84, 40960
    s_mov_b32 s100, 655360
    buffer_load_dwordx4 v246, s[40:43], s100 offen  lds
    v_lshl_add_u32 v196, v196, 2, v197
    s_lshl_b32 s78, s76, 9
    s_add_u32 s78, s78, 160768
    v_lshl_add_u32 v196, v196, 3, s78
    v_and_b32 v197, 15, v2
    v_lshlrev_b32_e64 v197, 3, v197
    v_add_u32 v197, 162816, v197
    v_mov_b32 v198, 0x3f803f80
    s_cmp_eq_u32 s76, 3
    s_cselect_b64 vcc, -1, 0
    v_cndmask_b32 v196, v196, v197, vcc
    v_cndmask_b32 v38, v38, v198, vcc
    v_cndmask_b32_e64 v39, v39, v198, vcc
    ds_write_b64 v196, v[38:39]
    s_setprio 0
    s_waitcnt lgkmcnt(0)
    s_barrier
    s_branch L_phend
L_ph2:
    s_add_u32 m0, s88, 77824
    s_nop 0
    s_nop 0
    buffer_load_dwordx4 v4, s[28:31], s86 offen  lds
    buffer_load_dwordx4 v5, s[28:31], s86 offen offset:1024  lds
    s_add_u32 m0, s89, 102400
    s_add_u32 s101, s87, 2048
    buffer_load_dwordx4 v6, s[32:35], s101 offen  lds
    buffer_load_dwordx4 v7, s[32:35], s101 offen offset:1024  lds
    s_add_u32 m0, s88, 79872
    s_add_u32 s101, s86, 32768
    buffer_load_dwordx4 v4, s[28:31], s101 offen  lds
    buffer_load_dwordx4 v5, s[28:31], s101 offen offset:1024  lds
    s_add_u32 m0, s89, 110592
    s_add_u32 s101, s87, 4096
    buffer_load_dwordx4 v6, s[32:35], s101 offen  lds
    buffer_load_dwordx4 v7, s[32:35], s101 offen offset:1024  lds
    s_add_u32 m0, s89, 94208
    s_nop 0
    buffer_load_dwordx4 v6, s[32:35], s87 offen  lds
    buffer_load_dwordx4 v7, s[32:35], s87 offen offset:1024  lds
    s_add_u32 s86, s86, 128
    s_add_u32 s87, s87, 393216
    s_and_b32 s86, s86, 2047
    s_cselect_b32 s87, s87, 0
    buffer_store_dwordx4 v[16:19], v14, s[36:39], s96 offen offset:0 sc1
    s_waitcnt vmcnt(13)
    s_waitcnt lgkmcnt(0)
    s_barrier
    s_add_u32 m0, s88, 118784
    s_nop 0
    buffer_load_dwordx4 v4, s[28:31], s86 offen  lds
    buffer_load_dwordx4 v5, s[28:31], s86 offen offset:1024  lds
    s_add_u32 m0, s89, 143360
    s_add_u32 s101, s87, 2048
    buffer_load_dwordx4 v6, s[32:35], s101 offen  lds
    buffer_load_dwordx4 v7, s[32:35], s101 offen offset:1024  lds
    s_add_u32 m0, s88, 120832
    s_add_u32 s101, s86, 32768
    buffer_load_dwordx4 v4, s[28:31], s101 offen  lds
    buffer_load_dwordx4 v5, s[28:31], s101 offen offset:1024  lds
    s_add_u32 m0, s89, 151552
    s_add_u32 s101, s87, 4096
    buffer_load_dwordx4 v6, s[32:35], s101 offen  lds
    buffer_load_dwordx4 v7, s[32:35], s101 offen offset:1024  lds
    s_add_u32 m0, s89, 135168
    s_nop 0
    buffer_load_dwordx4 v6, s[32:35], s87 offen  lds
    buffer_load_dwordx4 v7, s[32:35], s87 offen offset:1024  lds
    s_add_u32 s86, s86, 128
    s_add_u32 s87, s87, 393216
    s_and_b32 s86, s86, 2047
    s_cselect_b32 s87, s87, 0
    s_waitcnt vmcnt(10)
    s_barrier
    s_cmp_lg_u32 s76, 0
    s_cbranch_scc1 Lfl_17
    s_getreg_b32 s99, hwreg(HW_REG_XCC_ID, 0, 4)
    v_mov_b32 v198, s75
    v_mov_b32 v199, s99
    v_lshlrev_b32_e64 v197, 3, v2
    s_lshl_b32 s78, s77, 7
    s_add_u32 s79, s78, 8781824
    s_add_u32 s78, s78, 4096
    s_lshl_b32 s80, s71, 4
    s_add_u32 s80, s80, s72
    s_lshl_b32 s80, s80, 7
    s_add_u32 s80, s80, 8847360
    s_mov_b64 exec, 0xffff
    buffer_store_dwordx2 v[198:199], v197, s[36:39], s78 offen sc1
    buffer_store_dwordx2 v[198:199], v197, s[36:39], s80 offen sc1
    v_not_b32 v200, v198
    v_mov_b32_e64 v201, 0
    buffer_store_dwordx2 v[200:201], v197, s[36:39], s79 offen sc1
    s_mov_b64 exec, -1
    v_and_b32 v196, 15, v2
    v_lshlrev_b32 v197, 4, v196
    v_add_u32 v197, s69, v197
    s_lshl_b32 s78, s70, 4
    s_lshl_b32 s79, s71, 4
    s_add_u32 s79, s79, 69088
    v_mov_b32 v202, s78
    v_mov_b32 v203, s79
    v_cmp_gt_u32 vcc, 32, v2
    s_nop 1
    v_cndmask_b32 v202, v203, v202, vcc
    v_add_u32 v196, v202, v196
    v_cmp_gt_u32 vcc, 16, v2
    s_nop 1
    v_cndmask_b32 v196, v196, v197, vcc
    v_lshlrev_b32 v196, 7, v196
    v_add_u32 v196, 4096, v196
Lfl_17:
    s_add_u32 m0, s88, 36864
    s_nop 0
    s_nop 0
    buffer_load_dwordx4 v4, s[28:31], s86 offen  lds
    buffer_load_dwordx4 v5, s[28:31], s86 offen offset:1024  lds
    s_add_u32 m0, s89, 61440
    s_add_u32 s101, s87, 2048
    buffer_load_dwordx4 v6, s[32:35], s101 offen  lds
    buffer_load_dwordx4 v7, s[32:35], s101 offen offset:1024  lds
    s_add_u32 m0, s88, 38912
    s_add_u32 s101, s86, 32768
    buffer_load_dwordx4 v4, s[28:31], s101 offen  lds
    buffer_load_dwordx4 v5, s[28:31], s101 offen offset:1024  lds
    s_add_u32 m0, s89, 69632
    s_add_u32 s101, s87, 4096
    buffer_load_dwordx4 v6, s[32:35], s101 offen  lds
    buffer_load_dwordx4 v7, s[32:35], s101 offen offset:1024  lds
    s_add_u32 m0, s89, 53248
    s_nop 0
    buffer_load_dwordx4 v6, s[32:35], s87 offen  lds
    buffer_load_dwordx4 v7, s[32:35], s87 offen offset:1024  lds
    s_add_u32 s86, s86, 128
    s_add_u32 s87, s87, 393216
    s_and_b32 s86, s86, 2047
    s_cselect_b32 s87, s87, 0
    s_mov_b32 s100, 0
    buffer_load_dwordx4 v[64:67], v244, s[48:51], s100 offen nt
    s_mov_b32 s100, 0
    buffer_load_dwordx4 v[96:99], v244, s[52:55], s100 offen nt
    s_mov_b32 s100, 7168
    buffer_load_dwordx4 v[68:71], v244, s[48:51], s100 offen nt
    s_mov_b32 s100, 7168
    buffer_load_dwordx4 v[100:103], v244, s[52:55], s100 offen nt
    s_mov_b32 s100, 14336
    buffer_load_dwordx4 v[72:75], v244, s[48:51], s100 offen nt
    s_mov_b32 s100, 14336
    buffer_load_dwordx4 v[104:107], v244, s[52:55], s100 offen nt
    s_mov_b32 s100, 21504
    buffer_load_dwordx4 v[76:79], v244, s[48:51], s100 offen nt
    s_waitcnt vmcnt(17)
    s_barrier
    s_add_u32 m0, s88, 77824
    s_nop 0
    s_nop 0
    buffer_load_dwordx4 v4, s[28:31], s86 offen  lds
    buffer_load_dwordx4 v5, s[28:31], s86 offen offset:1024  lds
    s_add_u32 m0, s89, 102400
    s_add_u32 s101, s87, 2048
    buffer_load_dwordx4 v6, s[32:35], s101 offen  lds
    buffer_load_dwordx4 v7, s[32:35], s101 offen offset:1024  lds
    s_add_u32 m0, s88, 79872
    s_add_u32 s101, s86, 32768
    buffer_load_dwordx4 v4, s[28:31], s101 offen  lds
    buffer_load_dwordx4 v5, s[28:31], s101 offen offset:1024  lds
    s_add_u32 m0, s89, 110592
    s_add_u32 s101, s87, 4096
    buffer_load_dwordx4 v6, s[32:35], s101 offen  lds
    buffer_load_dwordx4 v7, s[32:35], s101 offen offset:1024  lds
    s_add_u32 m0, s89, 94208
    s_nop 0
    buffer_load_dwordx4 v6, s[32:35], s87 offen  lds
    buffer_load_dwordx4 v7, s[32:35], s87 offen offset:1024  lds
    s_add_u32 s86, s86, 128
    s_add_u32 s87, s87, 393216
    s_and_b32 s86, s86, 2047
    s_cselect_b32 s87, s87, 0
    s_waitcnt vmcnt(17)
    s_barrier
    s_add_u32 m0, s88, 118784
    s_nop 0
    s_nop 0
    buffer_load_dwordx4 v4, s[28:31], s86 offen  lds
    buffer_load_dwordx4 v5, s[28:31], s86 offen offset:1024  lds
    s_add_u32 m0, s89, 143360
    s_add_u32 s101, s87, 2048
    buffer_load_dwordx4 v6, s[32:35], s101 offen  lds
    buffer_load_dwordx4 v7, s[32:35], s101 offen offset:1024  lds
    s_add_u32 m0, s88, 120832
    s_add_u32 s101, s86, 32768
    buffer_load_dwordx4 v4, s[28:31], s101 offen  lds
    buffer_load_dwordx4 v5, s[28:31], s101 offen offset:1024  lds
    s_add_u32 m0, s89, 151552
    s_add_u32 s101, s87, 4096
    buffer_load_dwordx4 v6, s[32:35], s101 offen  lds
    buffer_load_dwordx4 v7, s[32:35], s101 offen offset:1024  lds
    s_add_u32 m0, s89, 135168
    s_nop 0
    buffer_load_dwordx4 v6, s[32:35], s87 offen  lds
    buffer_load_dwordx4 v7, s[32:35], s87 offen offset:1024  lds
    s_add_u32 s86, s86, 128
    s_add_u32 s87, s87, 393216
    s_and_b32 s86, s86, 2047
    s_cselect_b32 s87, s87, 0
    s_waitcnt vmcnt(10)
    s_barrier
    s_add_u32 m0, s88, 36864
    s_nop 0
    s_nop 0
    buffer_load_dwordx4 v4, s[28:31], s86 offen  lds
    buffer_load_dwordx4 v5, s[28:31], s86 offen offset:1024  lds
    s_add_u32 m0, s89, 61440
    s_add_u32 s101, s87, 2048
    buffer_load_dwordx4 v6, s[32:35], s101 offen  lds
    buffer_load_dwordx4 v7, s[32:35], s101 offen offset:1024  lds
    s_add_u32 m0, s88, 38912
    s_add_u32 s101, s86, 32768
    buffer_load_dwordx4 v4, s[28:31], s101 offen  lds
    buffer_load_dwordx4 v5, s[28:31], s101 offen offset:1024  lds
    s_add_u32 m0, s89, 69632
    s_add_u32 s101, s87, 4096
    buffer_load_dwordx4 v6, s[32:35], s101 offen  lds
    buffer_load_dwordx4 v7, s[32:35], s101 offen offset:1024  lds
    s_add_u32 m0, s89, 53248
    s_nop 0
    buffer_load_dwordx4 v6, s[32:35], s87 offen  lds
    buffer_load_dwordx4 v7, s[32:35], s87 offen offset:1024  lds
    s_add_u32 s86, s86, 128
    s_add_u32 s87, s87, 393216
    s_and_b32 s86, s86, 2047
    s_cselect_b32 s87, s87, 0
    s_waitcnt vmcnt(10)
    s_barrier
    s_add_u32 m0, s88, 77824
    s_nop 0
    s_nop 0
    buffer_load_dwordx4 v4, s[28:31], s86 offen  lds
    buffer_load_dwordx4 v5, s[28:31], s86 offen offset:1024  lds
    s_add_u32 m0, s89, 102400
    s_add_u32 s101, s87, 2048
    buffer_load_dwordx4 v6, s[32:35], s101 offen  lds
    buffer_load_dwordx4 v7, s[32:35], s101 offen offset:1024  lds
    s_add_u32 m0, s88, 79872
    s_add_u32 s101, s86, 32768
    buffer_load_dwordx4 v4, s[28:31], s101 offen  lds
    buffer_load_dwordx4 v5, s[28:31], s101 offen offset:1024  lds
    s_add_u32 m0, s89, 110592
    s_add_u32 s101, s87, 4096
    buffer_load_dwordx4 v6, s[32:35], s101 offen  lds
    buffer_load_dwordx4 v7, s[32:35], s101 offen offset:1024  lds
    s_add_u32 m0, s89, 94208
    s_nop 0
    buffer_load_dwordx4 v6, s[32:35], s87 offen  lds
    buffer_load_dwordx4 v7, s[32:35], s87 offen offset:1024  lds
    s_add_u32 s86, s86, 128
    s_add_u32 s87, s87, 393216
    s_and_b32 s86, s86, 2047
    s_cselect_b32 s87, s87, 0
    s_waitcnt vmcnt(10)
    s_barrier
    s_add_u32 m0, s88, 118784
    s_nop 0
    s_nop 0
    buffer_load_dwordx4 v4, s[28:31], s86 offen  lds
    buffer_load_dwordx4 v5, s[28:31], s86 offen offset:1024  lds
    s_add_u32 m0, s89, 143360
    s_add_u32 s101, s87, 2048
    buffer_load_dwordx4 v6, s[32:35], s101 offen  lds
    buffer_load_dwordx4 v7, s[32:35], s101 offen offset:1024  lds
    s_add_u32 m0, s88, 120832
    s_add_u32 s101, s86, 32768
    buffer_load_dwordx4 v4, s[28:31], s101 offen  lds
    buffer_load_dwordx4 v5, s[28:31], s101 offen offset:1024  lds
    s_add_u32 m0, s89, 151552
    s_add_u32 s101, s87, 4096
    buffer_load_dwordx4 v6, s[32:35], s101 offen  lds
    buffer_load_dwordx4 v7, s[32:35], s101 offen offset:1024  lds
    s_add_u32 m0, s89, 135168
    s_nop 0
    buffer_load_dwordx4 v6, s[32:35], s87 offen  lds
    buffer_load_dwordx4 v7, s[32:35], s87 offen offset:1024  lds
    s_add_u32 s86, s86, 128
    s_add_u32 s87, s87, 393216
    s_and_b32 s86, s86, 2047
    s_cselect_b32 s87, s87, 0
    s_mov_b32 s100, 21504
    buffer_load_dwordx4 v[108:111], v244, s[52:55], s100 offen nt
    s_mov_b32 s100, 28672
    buffer_load_dwordx4 v[80:83], v244, s[48:51], s100 offen nt
    s_mov_b32 s100, 28672
    buffer_load_dwordx4 v[112:115], v244, s[52:55], s100 offen nt
    s_mov_b32 s100, 35840
    buffer_load_dwordx4 v[84:87], v244, s[48:51], s100 offen nt
    s_mov_b32 s100, 35840
    buffer_load_dwordx4 v[116:119], v244, s[52:55], s100 offen nt
    s_mov_b32 s100, 43008
    buffer_load_dwordx4 v[88:91], v244, s[48:51], s100 offen nt
    s_mov_b32 s100, 43008
    buffer_load_dwordx4 v[120:123], v244, s[52:55], s100 offen nt
    s_waitcnt vmcnt(17)
    s_barrier
    s_add_u32 m0, s88, 36864
    s_nop 0
    s_nop 0
    buffer_load_dwordx4 v4, s[28:31], s86 offen  lds
    buffer_load_dwordx4 v5, s[28:31], s86 offen offset:1024  lds
    s_add_u32 m0, s89, 61440
    s_add_u32 s101, s87, 2048
    buffer_load_dwordx4 v6, s[32:35], s101 offen  lds
    buffer_load_dwordx4 v7, s[32:35], s101 offen offset:1024  lds
    s_add_u32 m0, s88, 38912
    s_add_u32 s101, s86, 32768
    buffer_load_dwordx4 v4, s[28:31], s101 offen  lds
    buffer_load_dwordx4 v5, s[28:31], s101 offen offset:1024  lds
    s_add_u32 m0, s89, 69632
    s_add_u32 s101, s87, 4096
    buffer_load_dwordx4 v6, s[32:35], s101 offen  lds
    buffer_load_dwordx4 v7, s[32:35], s101 offen offset:1024  lds
    s_add_u32 m0, s89, 53248
    s_nop 0
    buffer_load_dwordx4 v6, s[32:35], s87 offen  lds
    buffer_load_dwordx4 v7, s[32:35], s87 offen offset:1024  lds
    s_add_u32 s86, s86, 128
    s_add_u32 s87, s87, 393216
    s_and_b32 s86, s86, 2047
    s_cselect_b32 s87, s87, 0
    s_waitcnt vmcnt(17)
    s_barrier
    s_cmp_lg_u32 s76, 2
    s_cbranch_scc1 Lc4_18
    s_mov_b32 exec_hi, -1
    buffer_load_dword v238, v63, s[40:43], 0 offen
    s_mov_b64 exec, -1
Lc4_18:
    s_cmp_lg_u32 s76, 0
    s_cbranch_scc1 Lpl_19
    s_mov_b32 exec_hi, 0xffff
    buffer_load_dwordx2 v[198:199], v196, s[36:39], 0 offen sc1
    s_mov_b64 exec, -1
Lpl_19:
    s_add_u32 m0, s88, 77824
    s_nop 0
    buffer_load_dwordx4 v4, s[28:31], s86 offen  lds
    buffer_load_dwordx4 v5, s[28:31], s86 offen offset:1024  lds
    s_add_u32 m0, s89, 102400
    s_add_u32 s101, s87, 2048
    buffer_load_dwordx4 v6, s[32:35], s101 offen  lds
    buffer_load_dwordx4 v7, s[32:35], s101 offen offset:1024  lds
    s_add_u32 m0, s88, 79872
    s_add_u32 s101, s86, 32768
    buffer_load_dwordx4 v4, s[28:31], s101 offen  lds
    buffer_load_dwordx4 v5, s[28:31], s101 offen offset:1024  lds
    s_add_u32 m0, s89, 110592
    s_add_u32 s101, s87, 4096
    buffer_load_dwordx4 v6, s[32:35], s101 offen  lds
    buffer_load_dwordx4 v7, s[32:35], s101 offen offset:1024  lds
    s_add_u32 m0, s89, 94208
    s_nop 0
    buffer_load_dwordx4 v6, s[32:35], s87 offen  lds
    buffer_load_dwordx4 v7, s[32:35], s87 offen offset:1024  lds
    s_add_u32 s86, s86, 128
    s_add_u32 s87, s87, 393216
    s_and_b32 s86, s86, 2047
    s_cselect_b32 s87, s87, 0
    s_waitcnt vmcnt(10)
    s_barrier
    s_add_u32 m0, s88, 118784
    s_nop 0
    s_nop 0
    buffer_load_dwordx4 v4, s[28:31], s86 offen  lds
    buffer_load_dwordx4 v5, s[28:31], s86 offen offset:1024  lds
    s_add_u32 m0, s89, 143360
    s_add_u32 s101, s87, 2048
    buffer_load_dwordx4 v6, s[32:35], s101 offen  lds
    buffer_load_dwordx4 v7, s[32:35], s101 offen offset:1024  lds
    s_add_u32 m0, s88, 120832
    s_add_u32 s101, s86, 32768
    buffer_load_dwordx4 v4, s[28:31], s101 offen  lds
    buffer_load_dwordx4 v5, s[28:31], s101 offen offset:1024  lds
    s_add_u32 m0, s89, 151552
    s_add_u32 s101, s87, 4096
    buffer_load_dwordx4 v6, s[32:35], s101 offen  lds
    buffer_load_dwordx4 v7, s[32:35], s101 offen offset:1024  lds
    s_add_u32 m0, s89, 135168
    s_nop 0
    buffer_load_dwordx4 v6, s[32:35], s87 offen  lds
    buffer_load_dwordx4 v7, s[32:35], s87 offen offset:1024  lds
    s_add_u32 s86, s86, 128
    s_add_u32 s87, s87, 393216
    s_and_b32 s86, s86, 2047
    s_cselect_b32 s87, s87, 0
    s_waitcnt vmcnt(10)
    s_cmp_lg_u32 s76, 0
    s_cbranch_scc1 Lpc_20
    s_mov_b32 exec_hi, 0xffff
    s_mov_b32 s85, 0
    s_branch Lpk_21
Lspin_22:
    s_add_u32 s85, s85, 1
    s_cmp_gt_u32 s85, 400000
    s_cbranch_scc1 L_end
    buffer_load_dwordx2 v[198:199], v196, s[36:39], 0 offen sc1
    s_waitcnt vmcnt(0)
Lpk_21:
    v_cmp_ne_u32 vcc, s75, v198
    s_cbranch_vccnz Lspin_22
    v_cmp_ne_u32 vcc, s99, v199
    s_mov_b64 exec, -1
    s_lshr_b32 s78, vcc_lo, 16
    s_cselect_b32 s78, 0, 1
    s_cmp_eq_u32 vcc_hi, 0
    s_cselect_b32 s79, 2, 0
    s_or_b32 s78, s78, s79
    s_and_b32 s78, s78, 3
    v_mov_b32_e64 v198, s78
    v_mov_b32 v199, 163584
    ds_write_b32 v199, v198
    s_waitcnt lgkmcnt(0)
Lpc_20:
    s_barrier
    v_lshrrev_b32 v196, 4, v2
    v_and_b32 v197, 15, v2
    v_lshlrev_b32_e64 v197, 4, v197
    v_lshl_add_u32 v198, v196, 10, v197
    s_lshl_b32 s78, s69, 14
    s_lshl_b32 s79, s76, 8
    s_add_u32 s78, s78, s79
    s_nop 0
    s_add_u32 s78, s78, 65536
    buffer_load_dwordx4 v[20:23], v198, s[36:39], s78 offen sc1
    s_add_u32 s78, s78, 4096
    buffer_load_dwordx4 v[24:27], v198, s[36:39], s78 offen sc1
    s_add_u32 s78, s78, 4096
    buffer_load_dwordx4 v[28:31], v198, s[36:39], s78 offen sc1
    s_add_u32 s78, s78, 4096
    buffer_load_dwordx4 v[32:35], v198, s[36:39], s78 offen sc1
    v_mul_u32_u24 v198, 768, v196
    v_add_u32_e64 v198, v198, v197
    s_mul_i32 s78, s70, 12288
    s_lshl_b32 s79, s76, 8
    s_add_u32 s78, s78, s79
    s_add_u32 s78, s78, 327680
    s_cmp_eq_u32 s76, 3
    s_nop 0
    s_cselect_b32 s78, 0x10000000, s78
    buffer_load_dwordx4 v[36:39], v198, s[36:39], s78 offen sc1
    s_add_u32 s78, s78, 3072
    buffer_load_dwordx4 v[40:43], v198, s[36:39], s78 offen sc1
    s_add_u32 s78, s78, 3072
    buffer_load_dwordx4 v[44:47], v198, s[36:39], s78 offen sc1
    s_add_u32 s78, s78, 3072
    buffer_load_dwordx4 v[48:51], v198, s[36:39], s78 offen sc1
    s_add_u32 m0, s84, 0
    s_mov_b32 s100, 0
    buffer_load_dwordx4 v246, s[40:43], s100 offen  lds
    s_add_u32 m0, s84, 4096
    s_mov_b32 s100, 65536
    buffer_load_dwordx4 v246, s[40:43], s100 offen  lds
    s_waitcnt vmcnt(10)
    s_waitcnt lgkmcnt(0)
    s_barrier
    s_setprio 2
    s_add_u32 m0, s84, 8192
    s_mov_b32 s100, 131072
    buffer_load_dwordx4 v246, s[40:43], s100 offen  lds
    s_waitcnt vmcnt(7)
    v_add_f32 v20, v20, v24
    v_add_f32 v21, v21, v25
    v_add_f32 v22, v22, v26
    v_add_f32 v23, v23, v27
    v_add_f32 v20, v20, v28
    v_add_f32 v21, v21, v29
    v_add_f32 v22, v22, v30
    v_add_f32_e64 v23, v23, v31
    s_add_u32 m0, s84, 12288
    s_mov_b32 s100, 196608
    buffer_load_dwordx4 v246, s[40:43], s100 offen  lds
    v_add_f32 v20, v20, v32
    v_add_f32 v21, v21, v33
    v_add_f32 v22, v22, v34
    v_add_f32 v23, v23, v35
    s_nop 0
    v_permlane32_swap_b32 v20, v22
    v_permlane32_swap_b32 v21, v23
    v_add_f32 v20, v20, v22
    v_add_f32 v21, v21, v23
    v_mov_b32 v22, v20
    v_mov_b32_e64 v23, v21
    s_add_u32 m0, s84, 16384
    s_mov_b32 s100, 262144
    buffer_load_dwordx4 v246, s[40:43], s100 offen  lds
    v_permlane16_swap_b32 v20, v22
    v_permlane16_swap_b32 v21, v23
    v_add_f32 v20, v20, v22
    v_add_f32 v21, v21, v23
    v_mul_f32 v24, 0x3a800000, v20
    v_mul_f32 v26, 0x3a800000, v21
    v_fma_f32 v26, -v24, v24, v26
    v_max_f32_e64 v26, 0, v26
    v_cvt_pk_bf16_f32 v24, v24, v24
    v_and_b32 v24, 0xffff0000, v24
    s_add_u32 m0, s84, 20480
    s_mov_b32 s100, 327680
    buffer_load_dwordx4 v246, s[40:43], s100 offen  lds
    v_cvt_pk_bf16_f32 v26, v26, v26
    v_and_b32 v26, 0xffff0000, v26
    v_add_f32 v26, 0x3727c5ac, v26
    v_cvt_pk_bf16_f32 v26, v26, v26
    v_and_b32 v26, 0xffff0000, v26
    v_sqrt_f32 v26, v26
    s_nop 0
    v_cvt_pk_bf16_f32 v26, v26, v26
    v_and_b32 v26, 0xffff0000, v26
    v_rcp_f32_e64 v25, v26
    v_xor_b32 v26, 0x80000000, v24
    s_add_u32 m0, s84, 24576
    s_mov_b32 s100, 393216
    buffer_load_dwordx4 v246, s[40:43], s100 offen  lds
    v_lshrrev_b32 v27, 16, v26
    v_or_b32 v26, v26, v27
    v_mov_b32 v27, 0
    v_and_b32 v196, 15, v2
    v_lshrrev_b32_e64 v197, 5, v2
    v_lshl_add_u32 v196, v196, 1, v197
    s_lshl_b32 s78, s76, 5
    v_add_u32 v196, s78, v196
    v_lshlrev_b32_e64 v197, 3, v196
    v_add_u32 v197, 159744, v197
    s_add_u32 m0, s84, 28672
    s_mov_b32 s100, 458752
    buffer_load_dwordx4 v246, s[40:43], s100 offen  lds
    v_lshlrev_b32_e64 v196, 2, v196
    v_add_u32 v196, 162304, v196
    ds_write_b64 v197, v[26:27]
    ds_write_b32 v196, v25
    s_waitcnt vmcnt(8)
    v_add_f32 v36, v36, v40
    v_add_f32 v37, v37, v41
    v_add_f32 v38, v38, v42
    v_add_f32 v39, v39, v43
    v_add_f32 v36, v36, v44
    s_add_u32 m0, s84, 32768
    s_mov_b32 s100, 524288
    buffer_load_dwordx4 v246, s[40:43], s100 offen  lds
    v_add_f32 v37, v37, v45
    v_add_f32 v38, v38, v46
    v_add_f32 v39, v39, v47
    v_add_f32 v36, v36, v48
    v_add_f32 v37, v37, v49
    v_add_f32 v38, v38, v50
    v_add_f32 v39, v39, v51
    s_nop 0
    v_permlane32_swap_b32 v36, v38
    v_permlane32_swap_b32 v37, v39
    v_add_f32_e64 v36, v36, v38
    s_add_u32 m0, s84, 36864
    s_mov_b32 s100, 589824
    buffer_load_dwordx4 v246, s[40:43], s100 offen  lds
    v_add_f32 v37, v37, v39
    s_nop 1
    v_permlane16_swap_b32 v36, v37
    v_add_f32 v36, v36, v37
    v_cvt_pk_bf16_f32 v37, v36, v36
    v_and_b32 v37, 0xffff0000, v37
    v_sub_f32_e64 v38, v36, v37
    v_cvt_pk_bf16_f32 v38, v37, v38
    v_mov_b32 v39, 0
    v_and_b32 v196, 15, v2
    v_lshrrev_b32_e64 v197, 4, v2
    s_add_u32 m0, s84, 40960
    s_mov_b32 s100, 655360
    buffer_load_dwordx4 v246, s[40:43], s100 offen  lds
    v_lshl_add_u32 v196, v196, 2, v197
    s_lshl_b32 s78, s76, 9
    s_add_u32 s78, s78, 160768
    v_lshl_add_u32 v196, v196, 3, s78
    v_and_b32 v197, 15, v2
    v_lshlrev_b32_e64 v197, 3, v197
    v_add_u32 v197, 162816, v197
    v_mov_b32 v198, 0x3f803f80
    s_cmp_eq_u32 s76, 3
    s_cselect_b64 vcc, -1, 0
    v_cndmask_b32 v196, v196, v197, vcc
    v_cndmask_b32 v38, v38, v198, vcc
    v_cndmask_b32_e64 v39, v39, v198, vcc
    ds_write_b64 v196, v[38:39]
    s_setprio 0
    s_waitcnt lgkmcnt(0)
    s_barrier
    s_branch L_phend
L_ph3:
    s_add_u32 m0, s88, 77824
    s_nop 0
    s_nop 0
    buffer_load_dwordx4 v4, s[28:31], s86 offen  lds
    buffer_load_dwordx4 v5, s[28:31], s86 offen offset:1024  lds
    s_add_u32 m0, s89, 102400
    s_add_u32 s101, s87, 2048
    buffer_load_dwordx4 v6, s[32:35], s101 offen  lds
    buffer_load_dwordx4 v7, s[32:35], s101 offen offset:1024  lds
    s_add_u32 m0, s88, 79872
    s_add_u32 s101, s86, 32768
    buffer_load_dwordx4 v4, s[28:31], s101 offen  lds
    buffer_load_dwordx4 v5, s[28:31], s101 offen offset:1024  lds
    s_add_u32 m0, s89, 110592
    s_add_u32 s101, s87, 4096
    buffer_load_dwordx4 v6, s[32:35], s101 offen  lds
    buffer_load_dwordx4 v7, s[32:35], s101 offen offset:1024  lds
    s_add_u32 m0, s89, 94208
    s_nop 0
    buffer_load_dwordx4 v6, s[32:35], s87 offen  lds
    buffer_load_dwordx4 v7, s[32:35], s87 offen offset:1024  lds
    s_add_u32 s86, s86, 128
    s_add_u32 s87, s87, 393216
    s_and_b32 s86, s86, 2047
    s_cselect_b32 s87, s87, 0
    buffer_store_dwordx4 v[16:19], v14, s[36:39], s96 offen offset:0 sc1
    s_waitcnt vmcnt(13)
    s_waitcnt lgkmcnt(0)
    s_barrier
    s_add_u32 m0, s88, 118784
    s_nop 0
    buffer_load_dwordx4 v4, s[28:31], s86 offen  lds
    buffer_load_dwordx4 v5, s[28:31], s86 offen offset:1024  lds
    s_add_u32 m0, s89, 143360
    s_add_u32 s101, s87, 2048
    buffer_load_dwordx4 v6, s[32:35], s101 offen  lds
    buffer_load_dwordx4 v7, s[32:35], s101 offen offset:1024  lds
    s_add_u32 m0, s88, 120832
    s_add_u32 s101, s86, 32768
    buffer_load_dwordx4 v4, s[28:31], s101 offen  lds
    buffer_load_dwordx4 v5, s[28:31], s101 offen offset:1024  lds
    s_add_u32 m0, s89, 151552
    s_add_u32 s101, s87, 4096
    buffer_load_dwordx4 v6, s[32:35], s101 offen  lds
    buffer_load_dwordx4 v7, s[32:35], s101 offen offset:1024  lds
    s_add_u32 m0, s89, 135168
    s_nop 0
    buffer_load_dwordx4 v6, s[32:35], s87 offen  lds
    buffer_load_dwordx4 v7, s[32:35], s87 offen offset:1024  lds
    s_add_u32 s86, s86, 128
    s_add_u32 s87, s87, 393216
    s_and_b32 s86, s86, 2047
    s_cselect_b32 s87, s87, 0
    s_waitcnt vmcnt(10)
    s_barrier
    s_cmp_lg_u32 s76, 0
    s_cbranch_scc1 Lfl_23
    s_getreg_b32 s99, hwreg(HW_REG_XCC_ID, 0, 4)
    v_mov_b32 v198, s75
    v_mov_b32 v199, s99
    v_lshlrev_b32_e64 v197, 3, v2
    s_lshl_b32 s78, s77, 7
    s_add_u32 s79, s78, 8781824
    s_add_u32 s78, s78, 4096
    s_lshl_b32 s80, s71, 4
    s_add_u32 s80, s80, s72
    s_lshl_b32 s80, s80, 7
    s_add_u32 s80, s80, 8847360
    s_mov_b64 exec, 0xffff
    buffer_store_dwordx2 v[198:199], v197, s[36:39], s78 offen sc1
    buffer_store_dwordx2 v[198:199], v197, s[36:39], s80 offen sc1
    v_not_b32 v200, v198
    v_mov_b32_e64 v201, 0
    buffer_store_dwordx2 v[200:201], v197, s[36:39], s79 offen sc1
    s_mov_b64 exec, -1
    v_and_b32 v196, 15, v2
    v_lshlrev_b32 v197, 4, v196
    v_add_u32 v197, s69, v197
    s_lshl_b32 s78, s70, 4
    s_lshl_b32 s79, s71, 4
    s_add_u32 s79, s79, 69088
    v_mov_b32 v202, s78
    v_mov_b32 v203, s79
    v_cmp_gt_u32 vcc, 32, v2
    s_nop 1
    v_cndmask_b32 v202, v203, v202, vcc
    v_add_u32 v196, v202, v196
    v_cmp_gt_u32 vcc, 16, v2
    s_nop 1
    v_cndmask_b32 v196, v196, v197, vcc
    v_lshlrev_b32 v196, 7, v196
    v_add_u32 v196, 4096, v196
Lfl_23:
    s_add_u32 m0, s88, 36864
    s_nop 0
    s_nop 0
    buffer_load_dwordx4 v4, s[28:31], s86 offen  lds
    buffer_load_dwordx4 v5, s[28:31], s86 offen offset:1024  lds
    s_add_u32 m0, s89, 61440
    s_add_u32 s101, s87, 2048
    buffer_load_dwordx4 v6, s[32:35], s101 offen  lds
    buffer_load_dwordx4 v7, s[32:35], s101 offen offset:1024  lds
    s_add_u32 m0, s88, 38912
    s_add_u32 s101, s86, 32768
    buffer_load_dwordx4 v4, s[28:31], s101 offen  lds
    buffer_load_dwordx4 v5, s[28:31], s101 offen offset:1024  lds
    s_add_u32 m0, s89, 69632
    s_add_u32 s101, s87, 4096
    buffer_load_dwordx4 v6, s[32:35], s101 offen  lds
    buffer_load_dwordx4 v7, s[32:35], s101 offen offset:1024  lds
    s_add_u32 m0, s89, 53248
    s_nop 0
    buffer_load_dwordx4 v6, s[32:35], s87 offen  lds
    buffer_load_dwordx4 v7, s[32:35], s87 offen offset:1024  lds
    s_add_u32 s86, s86, 128
    s_add_u32 s87, s87, 393216
    s_and_b32 s86, s86, 2047
    s_cselect_b32 s87, s87, 0
    s_waitcnt vmcnt(10)
    s_barrier
    s_add_u32 m0, s88, 77824
    s_nop 0
    s_nop 0
    buffer_load_dwordx4 v4, s[28:31], s86 offen  lds
    buffer_load_dwordx4 v5, s[28:31], s86 offen offset:1024  lds
    s_add_u32 m0, s89, 102400
    s_add_u32 s101, s87, 2048
    buffer_load_dwordx4 v6, s[32:35], s101 offen  lds
    buffer_load_dwordx4 v7, s[32:35], s101 offen offset:1024  lds
    s_add_u32 m0, s88, 79872
    s_add_u32 s101, s86, 32768
    buffer_load_dwordx4 v4, s[28:31], s101 offen  lds
    buffer_load_dwordx4 v5, s[28:31], s101 offen offset:1024  lds
    s_add_u32 m0, s89, 110592
    s_add_u32 s101, s87, 4096
    buffer_load_dwordx4 v6, s[32:35], s101 offen  lds
    buffer_load_dwordx4 v7, s[32:35], s101 offen offset:1024  lds
    s_add_u32 m0, s89, 94208
    s_nop 0
    buffer_load_dwordx4 v6, s[32:35], s87 offen  lds
    buffer_load_dwordx4 v7, s[32:35], s87 offen offset:1024  lds
    s_add_u32 s86, s86, 128
    s_add_u32 s87, s87, 393216
    s_and_b32 s86, s86, 2047
    s_cselect_b32 s87, s87, 0
    s_mov_b32 s100, 0
    buffer_load_dwordx4 v[64:67], v244, s[48:51], s100 offen nt
    s_mov_b32 s100, 0
    buffer_load_dwordx4 v[96:99], v244, s[52:55], s100 offen nt
    s_mov_b32 s100, 7168
    buffer_load_dwordx4 v[68:71], v244, s[48:51], s100 offen nt
    s_mov_b32 s100, 7168
    buffer_load_dwordx4 v[100:103], v244, s[52:55], s100 offen nt
    s_mov_b32 s100, 14336
    buffer_load_dwordx4 v[72:75], v244, s[48:51], s100 offen nt
    s_mov_b32 s100, 14336
    buffer_load_dwordx4 v[104:107], v244, s[52:55], s100 offen nt
    s_mov_b32 s100, 21504
    buffer_load_dwordx4 v[76:79], v244, s[48:51], s100 offen nt
    s_waitcnt vmcnt(17)
    s_barrier
    s_add_u32 m0, s88, 118784
    s_nop 0
    s_nop 0
    buffer_load_dwordx4 v4, s[28:31], s86 offen  lds
    buffer_load_dwordx4 v5, s[28:31], s86 offen offset:1024  lds
    s_add_u32 m0, s89, 143360
    s_add_u32 s101, s87, 2048
    buffer_load_dwordx4 v6, s[32:35], s101 offen  lds
    buffer_load_dwordx4 v7, s[32:35], s101 offen offset:1024  lds
    s_add_u32 m0, s88, 120832
    s_add_u32 s101, s86, 32768
    buffer_load_dwordx4 v4, s[28:31], s101 offen  lds
    buffer_load_dwordx4 v5, s[28:31], s101 offen offset:1024  lds
    s_add_u32 m0, s89, 151552
    s_add_u32 s101, s87, 4096
    buffer_load_dwordx4 v6, s[32:35], s101 offen  lds
    buffer_load_dwordx4 v7, s[32:35], s101 offen offset:1024  lds
    s_add_u32 m0, s89, 135168
    s_nop 0
    buffer_load_dwordx4 v6, s[32:35], s87 offen  lds
    buffer_load_dwordx4 v7, s[32:35], s87 offen offset:1024  lds
    s_add_u32 s86, s86, 128
    s_add_u32 s87, s87, 393216
    s_and_b32 s86, s86, 2047
    s_cselect_b32 s87, s87, 0
    s_waitcnt vmcnt(17)
    s_barrier
    s_add_u32 m0, s88, 36864
    s_nop 0
    s_nop 0
    buffer_load_dwordx4 v4, s[28:31], s86 offen  lds
    buffer_load_dwordx4 v5, s[28:31], s86 offen offset:1024  lds
    s_add_u32 m0, s89, 61440
    s_add_u32 s101, s87, 2048
    buffer_load_dwordx4 v6, s[32:35], s101 offen  lds
    buffer_load_dwordx4 v7, s[32:35], s101 offen offset:1024  lds
    s_add_u32 m0, s88, 38912
    s_add_u32 s101, s86, 32768
    buffer_load_dwordx4 v4, s[28:31], s101 offen  lds
    buffer_load_dwordx4 v5, s[28:31], s101 offen offset:1024  lds
    s_add_u32 m0, s89, 69632
    s_add_u32 s101, s87, 4096
    buffer_load_dwordx4 v6, s[32:35], s101 offen  lds
    buffer_load_dwordx4 v7, s[32:35], s101 offen offset:1024  lds
    s_add_u32 m0, s89, 53248
    s_nop 0
    buffer_load_dwordx4 v6, s[32:35], s87 offen  lds
    buffer_load_dwordx4 v7, s[32:35], s87 offen offset:1024  lds
    s_add_u32 s86, s86, 128
    s_add_u32 s87, s87, 393216
    s_and_b32 s86, s86, 2047
    s_cselect_b32 s87, s87, 0
    s_waitcnt vmcnt(10)
    s_barrier
    s_add_u32 m0, s88, 77824
    s_nop 0
    s_nop 0
    buffer_load_dwordx4 v4, s[28:31], s86 offen  lds
    buffer_load_dwordx4 v5, s[28:31], s86 offen offset:1024  lds
    s_add_u32 m0, s89, 102400
    s_add_u32 s101, s87, 2048
    buffer_load_dwordx4 v6, s[32:35], s101 offen  lds
    buffer_load_dwordx4 v7, s[32:35], s101 offen offset:1024  lds
    s_add_u32 m0, s88, 79872
    s_add_u32 s101, s86, 32768
    buffer_load_dwordx4 v4, s[28:31], s101 offen  lds
    buffer_load_dwordx4 v5, s[28:31], s101 offen offset:1024  lds
    s_add_u32 m0, s89, 110592
    s_add_u32 s101, s87, 4096
    buffer_load_dwordx4 v6, s[32:35], s101 offen  lds
    buffer_load_dwordx4 v7, s[32:35], s101 offen offset:1024  lds
    s_add_u32 m0, s89, 94208
    s_nop 0
    buffer_load_dwordx4 v6, s[32:35], s87 offen  lds
    buffer_load_dwordx4 v7, s[32:35], s87 offen offset:1024  lds
    s_add_u32 s86, s86, 128
    s_add_u32 s87, s87, 393216
    s_and_b32 s86, s86, 2047
    s_cselect_b32 s87, s87, 0
    s_waitcnt vmcnt(10)
    s_barrier
    s_add_u32 m0, s88, 118784
    s_nop 0
    s_nop 0
    buffer_load_dwordx4 v4, s[28:31], s86 offen  lds
    buffer_load_dwordx4 v5, s[28:31], s86 offen offset:1024  lds
    s_add_u32 m0, s89, 143360
    s_add_u32 s101, s87, 2048
    buffer_load_dwordx4 v6, s[32:35], s101 offen  lds
    buffer_load_dwordx4 v7, s[32:35], s101 offen offset:1024  lds
    s_add_u32 m0, s88, 120832
    s_add_u32 s101, s86, 32768
    buffer_load_dwordx4 v4, s[28:31], s101 offen  lds
    buffer_load_dwordx4 v5, s[28:31], s101 offen offset:1024  lds
    s_add_u32 m0, s89, 151552
    s_add_u32 s101, s87, 4096
    buffer_load_dwordx4 v6, s[32:35], s101 offen  lds
    buffer_load_dwordx4 v7, s[32:35], s101 offen offset:1024  lds
    s_add_u32 m0, s89, 135168
    s_nop 0
    buffer_load_dwordx4 v6, s[32:35], s87 offen  lds
    buffer_load_dwordx4 v7, s[32:35], s87 offen offset:1024  lds
    s_add_u32 s86, s86, 128
    s_add_u32 s87, s87, 393216
    s_and_b32 s86, s86, 2047
    s_cselect_b32 s87, s87, 0
    s_waitcnt vmcnt(10)
    s_barrier
    s_add_u32 m0, s88, 36864
    s_nop 0
    s_nop 0
    buffer_load_dwordx4 v4, s[28:31], s86 offen  lds
    buffer_load_dwordx4 v5, s[28:31], s86 offen offset:1024  lds
    s_add_u32 m0, s89, 61440
    s_add_u32 s101, s87, 2048
    buffer_load_dwordx4 v6, s[32:35], s101 offen  lds
    buffer_load_dwordx4 v7, s[32:35], s101 offen offset:1024  lds
    s_add_u32 m0, s88, 38912
    s_add_u32 s101, s86, 32768
    buffer_load_dwordx4 v4, s[28:31], s101 offen  lds
    buffer_load_dwordx4 v5, s[28:31], s101 offen offset:1024  lds
    s_add_u32 m0, s89, 69632
    s_add_u32 s101, s87, 4096
    buffer_load_dwordx4 v6, s[32:35], s101 offen  lds
    buffer_load_dwordx4 v7, s[32:35], s101 offen offset:1024  lds
    s_add_u32 m0, s89, 53248
    s_nop 0
    buffer_load_dwordx4 v6, s[32:35], s87 offen  lds
    buffer_load_dwordx4 v7, s[32:35], s87 offen offset:1024  lds
    s_add_u32 s86, s86, 128
    s_add_u32 s87, s87, 393216
    s_and_b32 s86, s86, 2047
    s_cselect_b32 s87, s87, 0
    s_mov_b32 s100, 21504
    buffer_load_dwordx4 v[108:111], v244, s[52:55], s100 offen nt
    s_mov_b32 s100, 28672
    buffer_load_dwordx4 v[80:83], v244, s[48:51], s100 offen nt
    s_mov_b32 s100, 28672
    buffer_load_dwordx4 v[112:115], v244, s[52:55], s100 offen nt
    s_mov_b32 s100, 35840
    buffer_load_dwordx4 v[84:87], v244, s[48:51], s100 offen nt
    s_mov_b32 s100, 35840
    buffer_load_dwordx4 v[116:119], v244, s[52:55], s100 offen nt
    s_mov_b32 s100, 43008
    buffer_load_dwordx4 v[88:91], v244, s[48:51], s100 offen nt
    s_mov_b32 s100, 43008
    buffer_load_dwordx4 v[120:123], v244, s[52:55], s100 offen nt
    s_waitcnt vmcnt(17)
    s_barrier
    s_cmp_lg_u32 s76, 2
    s_cbranch_scc1 Lc4_24
    s_mov_b32 exec_hi, -1
    buffer_load_dword v238, v63, s[40:43], 0 offen
    s_mov_b64 exec, -1
Lc4_24:
    s_cmp_lg_u32 s76, 0
    s_cbranch_scc1 Lpl_25
    s_mov_b32 exec_hi, 0xffff
    buffer_load_dwordx2 v[198:199], v196, s[36:39], 0 offen sc1
    s_mov_b64 exec, -1
Lpl_25:
    s_add_u32 m0, s88, 77824
    s_nop 0
    buffer_load_dwordx4 v4, s[28:31], s86 offen  lds
    buffer_load_dwordx4 v5, s[28:31], s86 offen offset:1024  lds
    s_add_u32 m0, s89, 102400
    s_add_u32 s101, s87, 2048
    buffer_load_dwordx4 v6, s[32:35], s101 offen  lds
    buffer_load_dwordx4 v7, s[32:35], s101 offen offset:1024  lds
    s_add_u32 m0, s88, 79872
    s_add_u32 s101, s86, 32768
    buffer_load_dwordx4 v4, s[28:31], s101 offen  lds
    buffer_load_dwordx4 v5, s[28:31], s101 offen offset:1024  lds
    s_add_u32 m0, s89, 110592
    s_add_u32 s101, s87, 4096
    buffer_load_dwordx4 v6, s[32:35], s101 offen  lds
    buffer_load_dwordx4 v7, s[32:35], s101 offen offset:1024  lds
    s_add_u32 m0, s89, 94208
    s_nop 0
    buffer_load_dwordx4 v6, s[32:35], s87 offen  lds
    buffer_load_dwordx4 v7, s[32:35], s87 offen offset:1024  lds
    s_add_u32 s86, s86, 128
    s_add_u32 s87, s87, 393216
    s_and_b32 s86, s86, 2047
    s_cselect_b32 s87, s87, 0
    s_waitcnt vmcnt(17)
    s_barrier
    s_add_u32 m0, s88, 118784
    s_nop 0
    s_nop 0
    buffer_load_dwordx4 v4, s[28:31], s86 offen  lds
    buffer_load_dwordx4 v5, s[28:31], s86 offen offset:1024  lds
    s_add_u32 m0, s89, 143360
    s_add_u32 s101, s87, 2048
    buffer_load_dwordx4 v6, s[32:35], s101 offen  lds
    buffer_load_dwordx4 v7, s[32:35], s101 offen offset:1024  lds
    s_add_u32 m0, s88, 120832
    s_add_u32 s101, s86, 32768
    buffer_load_dwordx4 v4, s[28:31], s101 offen  lds
    buffer_load_dwordx4 v5, s[28:31], s101 offen offset:1024  lds
    s_add_u32 m0, s89, 151552
    s_add_u32 s101, s87, 4096
    buffer_load_dwordx4 v6, s[32:35], s101 offen  lds
    buffer_load_dwordx4 v7, s[32:35], s101 offen offset:1024  lds
    s_add_u32 m0, s89, 135168
    s_nop 0
    buffer_load_dwordx4 v6, s[32:35], s87 offen  lds
    buffer_load_dwordx4 v7, s[32:35], s87 offen offset:1024  lds
    s_add_u32 s86, s86, 128
    s_add_u32 s87, s87, 393216
    s_and_b32 s86, s86, 2047
    s_cselect_b32 s87, s87, 0
    s_waitcnt vmcnt(10)
    s_cmp_lg_u32 s76, 0
    s_cbranch_scc1 Lpc_26
    s_mov_b32 exec_hi, 0xffff
    s_mov_b32 s85, 0
    s_branch Lpk_27
Lspin_28:
    s_add_u32 s85, s85, 1
    s_cmp_gt_u32 s85, 400000
    s_cbranch_scc1 L_end
    buffer_load_dwordx2 v[198:199], v196, s[36:39], 0 offen sc1
    s_waitcnt vmcnt(0)
Lpk_27:
    v_cmp_ne_u32 vcc, s75, v198
    s_cbranch_vccnz Lspin_28
    v_cmp_ne_u32 vcc, s99, v199
    s_mov_b64 exec, -1
    s_lshr_b32 s78, vcc_lo, 16
    s_cselect_b32 s78, 0, 1
    s_cmp_eq_u32 vcc_hi, 0
    s_cselect_b32 s79, 2, 0
    s_or_b32 s78, s78, s79
    s_and_b32 s78, s78, 3
    v_mov_b32_e64 v198, s78
    v_mov_b32 v199, 163584
    ds_write_b32 v199, v198
    s_waitcnt lgkmcnt(0)
Lpc_26:
    s_barrier
    v_lshrrev_b32 v196, 4, v2
    v_and_b32 v197, 15, v2
    v_lshlrev_b32_e64 v197, 4, v197
    v_lshl_add_u32 v198, v196, 10, v197
    s_lshl_b32 s78, s69, 14
    s_lshl_b32 s79, s76, 8
    s_add_u32 s78, s78, s79
    s_nop 0
    s_add_u32 s78, s78, 65536
    buffer_load_dwordx4 v[20:23], v198, s[36:39], s78 offen sc1
    s_add_u32 s78, s78, 4096
    buffer_load_dwordx4 v[24:27], v198, s[36:39], s78 offen sc1
    s_add_u32 s78, s78, 4096
    buffer_load_dwordx4 v[28:31], v198, s[36:39], s78 offen sc1
    s_add_u32 s78, s78, 4096
    buffer_load_dwordx4 v[32:35], v198, s[36:39], s78 offen sc1
    v_mul_u32_u24 v198, 768, v196
    v_add_u32_e64 v198, v198, v197
    s_mul_i32 s78, s70, 12288
    s_lshl_b32 s79, s76, 8
    s_add_u32 s78, s78, s79
    s_add_u32 s78, s78, 327680
    s_cmp_eq_u32 s76, 3
    s_nop 0
    s_cselect_b32 s78, 0x10000000, s78
    buffer_load_dwordx4 v[36:39], v198, s[36:39], s78 offen sc1
    s_add_u32 s78, s78, 3072
    buffer_load_dwordx4 v[40:43], v198, s[36:39], s78 offen sc1
    s_add_u32 s78, s78, 3072
    buffer_load_dwordx4 v[44:47], v198, s[36:39], s78 offen sc1
    s_add_u32 s78, s78, 3072
    buffer_load_dwordx4 v[48:51], v198, s[36:39], s78 offen sc1
    s_add_u32 m0, s84, 0
    s_mov_b32 s100, 0
    buffer_load_dwordx4 v246, s[40:43], s100 offen  lds
    s_add_u32 m0, s84, 4096
    s_mov_b32 s100, 65536
    buffer_load_dwordx4 v246, s[40:43], s100 offen  lds
    s_waitcnt vmcnt(10)
    s_waitcnt lgkmcnt(0)
    s_barrier
    s_setprio 2
    s_add_u32 m0, s84, 8192
    s_mov_b32 s100, 131072
    buffer_load_dwordx4 v246, s[40:43], s100 offen  lds
    s_waitcnt vmcnt(7)
    v_add_f32 v20, v20, v24
    v_add_f32 v21, v21, v25
    v_add_f32 v22, v22, v26
    v_add_f32 v23, v23, v27
    v_add_f32 v20, v20, v28
    v_add_f32 v21, v21, v29
    v_add_f32 v22, v22, v30
    v_add_f32_e64 v23, v23, v31
    s_add_u32 m0, s84, 12288
    s_mov_b32 s100, 196608
    buffer_load_dwordx4 v246, s[40:43], s100 offen  lds
    v_add_f32 v20, v20, v32
    v_add_f32 v21, v21, v33
    v_add_f32 v22, v22, v34
    v_add_f32 v23, v23, v35
    s_nop 0
    v_permlane32_swap_b32 v20, v22
    v_permlane32_swap_b32 v21, v23
    v_add_f32 v20, v20, v22
    v_add_f32 v21, v21, v23
    v_mov_b32 v22, v20
    v_mov_b32_e64 v23, v21
    s_add_u32 m0, s84, 16384
    s_mov_b32 s100, 262144
    buffer_load_dwordx4 v246, s[40:43], s100 offen  lds
    v_permlane16_swap_b32 v20, v22
    v_permlane16_swap_b32 v21, v23
    v_add_f32 v20, v20, v22
    v_add_f32 v21, v21, v23
    v_mul_f32 v24, 0x3a800000, v20
    v_mul_f32 v26, 0x3a800000, v21
    v_fma_f32 v26, -v24, v24, v26
    v_max_f32_e64 v26, 0, v26
    v_cvt_pk_bf16_f32 v24, v24, v24
    v_and_b32 v24, 0xffff0000, v24
    s_add_u32 m0, s84, 20480
    s_mov_b32 s100, 327680
    buffer_load_dwordx4 v246, s[40:43], s100 offen  lds
    v_cvt_pk_bf16_f32 v26, v26, v26
    v_and_b32 v26, 0xffff0000, v26
    v_add_f32 v26, 0x3727c5ac, v26
    v_cvt_pk_bf16_f32 v26, v26, v26
    v_and_b32 v26, 0xffff0000, v26
    v_sqrt_f32 v26, v26
    s_nop 0
    v_cvt_pk_bf16_f32 v26, v26, v26
    v_and_b32 v26, 0xffff0000, v26
    v_rcp_f32_e64 v25, v26
    v_xor_b32 v26, 0x80000000, v24
    s_add_u32 m0, s84, 24576
    s_mov_b32 s100, 393216
    buffer_load_dwordx4 v246, s[40:43], s100 offen  lds
    v_lshrrev_b32 v27, 16, v26
    v_or_b32 v26, v26, v27
    v_mov_b32 v27, 0
    v_and_b32 v196, 15, v2
    v_lshrrev_b32_e64 v197, 5, v2
    v_lshl_add_u32 v196, v196, 1, v197
    s_lshl_b32 s78, s76, 5
    v_add_u32 v196, s78, v196
    v_lshlrev_b32_e64 v197, 3, v196
    v_add_u32 v197, 159744, v197
    s_add_u32 m0, s84, 28672
    s_mov_b32 s100, 458752
    buffer_load_dwordx4 v246, s[40:43], s100 offen  lds
    v_lshlrev_b32_e64 v196, 2, v196
    v_add_u32 v196, 162304, v196
    ds_write_b64 v197, v[26:27]
    ds_write_b32 v196, v25
    s_waitcnt vmcnt(8)
    v_add_f32 v36, v36, v40
    v_add_f32 v37, v37, v41
    v_add_f32 v38, v38, v42
    v_add_f32 v39, v39, v43
    v_add_f32 v36, v36, v44
    s_add_u32 m0, s84, 32768
    s_mov_b32 s100, 524288
    buffer_load_dwordx4 v246, s[40:43], s100 offen  lds
    v_add_f32 v37, v37, v45
    v_add_f32 v38, v38, v46
    v_add_f32 v39, v39, v47
    v_add_f32 v36, v36, v48
    v_add_f32 v37, v37, v49
    v_add_f32 v38, v38, v50
    v_add_f32 v39, v39, v51
    s_nop 0
    v_permlane32_swap_b32 v36, v38
    v_permlane32_swap_b32 v37, v39
    v_add_f32_e64 v36, v36, v38
    s_add_u32 m0, s84, 36864
    s_mov_b32 s100, 589824
    buffer_load_dwordx4 v246, s[40:43], s100 offen  lds
    v_add_f32 v37, v37, v39
    s_nop 1
    v_permlane16_swap_b32 v36, v37
    v_add_f32 v36, v36, v37
    v_cvt_pk_bf16_f32 v37, v36, v36
    v_and_b32 v37, 0xffff0000, v37
    v_sub_f32_e64 v38, v36, v37
    v_cvt_pk_bf16_f32 v38, v37, v38
    v_mov_b32 v39, 0
    v_and_b32 v196, 15, v2
    v_lshrrev_b32_e64 v197, 4, v2
    s_add_u32 m0, s84, 40960
    s_mov_b32 s100, 655360
    buffer_load_dwordx4 v246, s[40:43], s100 offen  lds
    v_lshl_add_u32 v196, v196, 2, v197
    s_lshl_b32 s78, s76, 9
    s_add_u32 s78, s78, 160768
    v_lshl_add_u32 v196, v196, 3, s78
    v_and_b32 v197, 15, v2
    v_lshlrev_b32_e64 v197, 3, v197
    v_add_u32 v197, 162816, v197
    v_mov_b32 v198, 0x3f803f80
    s_cmp_eq_u32 s76, 3
    s_cselect_b64 vcc, -1, 0
    v_cndmask_b32 v196, v196, v197, vcc
    v_cndmask_b32 v38, v38, v198, vcc
    v_cndmask_b32_e64 v39, v39, v198, vcc
    ds_write_b64 v196, v[38:39]
    s_setprio 0
    s_waitcnt lgkmcnt(0)
    s_barrier
    s_branch L_phend
L_ph4:
    s_add_u32 m0, s88, 77824
    s_nop 0
    s_nop 0
    buffer_load_dwordx4 v4, s[28:31], s86 offen  lds
    buffer_load_dwordx4 v5, s[28:31], s86 offen offset:1024  lds
    s_add_u32 m0, s89, 102400
    s_add_u32 s101, s87, 2048
    buffer_load_dwordx4 v6, s[32:35], s101 offen  lds
    buffer_load_dwordx4 v7, s[32:35], s101 offen offset:1024  lds
    s_add_u32 m0, s88, 79872
    s_add_u32 s101, s86, 32768
    buffer_load_dwordx4 v4, s[28:31], s101 offen  lds
    buffer_load_dwordx4 v5, s[28:31], s101 offen offset:1024  lds
    s_add_u32 m0, s89, 110592
    s_add_u32 s101, s87, 4096
    buffer_load_dwordx4 v6, s[32:35], s101 offen  lds
    buffer_load_dwordx4 v7, s[32:35], s101 offen offset:1024  lds
    s_add_u32 m0, s89, 94208
    s_nop 0
    buffer_load_dwordx4 v6, s[32:35], s87 offen  lds
    buffer_load_dwordx4 v7, s[32:35], s87 offen offset:1024  lds
    s_add_u32 s86, s86, 128
    s_add_u32 s87, s87, 393216
    s_and_b32 s86, s86, 2047
    s_cselect_b32 s87, s87, 0
    buffer_store_dwordx4 v[16:19], v14, s[36:39], s96 offen offset:0 sc1
    s_waitcnt vmcnt(13)
    s_waitcnt lgkmcnt(0)
    s_barrier
    s_add_u32 m0, s88, 118784
    s_nop 0
    buffer_load_dwordx4 v4, s[28:31], s86 offen  lds
    buffer_load_dwordx4 v5, s[28:31], s86 offen offset:1024  lds
    s_add_u32 m0, s89, 143360
    s_add_u32 s101, s87, 2048
    buffer_load_dwordx4 v6, s[32:35], s101 offen  lds
    buffer_load_dwordx4 v7, s[32:35], s101 offen offset:1024  lds
    s_add_u32 m0, s88, 120832
    s_add_u32 s101, s86, 32768
    buffer_load_dwordx4 v4, s[28:31], s101 offen  lds
    buffer_load_dwordx4 v5, s[28:31], s101 offen offset:1024  lds
    s_add_u32 m0, s89, 151552
    s_add_u32 s101, s87, 4096
    buffer_load_dwordx4 v6, s[32:35], s101 offen  lds
    buffer_load_dwordx4 v7, s[32:35], s101 offen offset:1024  lds
    s_add_u32 m0, s89, 135168
    s_nop 0
    buffer_load_dwordx4 v6, s[32:35], s87 offen  lds
    buffer_load_dwordx4 v7, s[32:35], s87 offen offset:1024  lds
    s_add_u32 s86, s86, 128
    s_add_u32 s87, s87, 393216
    s_and_b32 s86, s86, 2047
    s_cselect_b32 s87, s87, 0
    s_waitcnt vmcnt(10)
    s_barrier
    s_cmp_lg_u32 s76, 0
    s_cbranch_scc1 Lfl_29
    s_getreg_b32 s99, hwreg(HW_REG_XCC_ID, 0, 4)
    v_mov_b32 v198, s75
    v_mov_b32 v199, s99
    v_lshlrev_b32_e64 v197, 3, v2
    s_lshl_b32 s78, s77, 7
    s_add_u32 s79, s78, 8781824
    s_add_u32 s78, s78, 4096
    s_lshl_b32 s80, s71, 4
    s_add_u32 s80, s80, s72
    s_lshl_b32 s80, s80, 7
    s_add_u32 s80, s80, 8847360
    s_mov_b64 exec, 0xffff
    buffer_store_dwordx2 v[198:199], v197, s[36:39], s78 offen sc1
    buffer_store_dwordx2 v[198:199], v197, s[36:39], s80 offen sc1
    v_not_b32 v200, v198
    v_mov_b32_e64 v201, 0
    buffer_store_dwordx2 v[200:201], v197, s[36:39], s79 offen sc1
    s_mov_b64 exec, -1
    v_and_b32 v196, 15, v2
    v_lshlrev_b32 v197, 4, v196
    v_add_u32 v197, s69, v197
    s_lshl_b32 s78, s70, 4
    s_lshl_b32 s79, s71, 4
    s_add_u32 s79, s79, 69088
    v_mov_b32 v202, s78
    v_mov_b32 v203, s79
    v_cmp_gt_u32 vcc, 32, v2
    s_nop 1
    v_cndmask_b32 v202, v203, v202, vcc
    v_add_u32 v196, v202, v196
    v_cmp_gt_u32 vcc, 16, v2
    s_nop 1
    v_cndmask_b32 v196, v196, v197, vcc
    v_lshlrev_b32 v196, 7, v196
    v_add_u32 v196, 4096, v196
Lfl_29:
    s_add_u32 m0, s88, 36864
    s_nop 0
    s_nop 0
    buffer_load_dwordx4 v4, s[28:31], s86 offen  lds
    buffer_load_dwordx4 v5, s[28:31], s86 offen offset:1024  lds
    s_add_u32 m0, s89, 61440
    s_add_u32 s101, s87, 2048
    buffer_load_dwordx4 v6, s[32:35], s101 offen  lds
    buffer_load_dwordx4 v7, s[32:35], s101 offen offset:1024  lds
    s_add_u32 m0, s88, 38912
    s_add_u32 s101, s86, 32768
    buffer_load_dwordx4 v4, s[28:31], s101 offen  lds
    buffer_load_dwordx4 v5, s[28:31], s101 offen offset:1024  lds
    s_add_u32 m0, s89, 69632
    s_add_u32 s101, s87, 4096
    buffer_load_dwordx4 v6, s[32:35], s101 offen  lds
    buffer_load_dwordx4 v7, s[32:35], s101 offen offset:1024  lds
    s_add_u32 m0, s89, 53248
    s_nop 0
    buffer_load_dwordx4 v6, s[32:35], s87 offen  lds
    buffer_load_dwordx4 v7, s[32:35], s87 offen offset:1024  lds
    s_add_u32 s86, s86, 128
    s_add_u32 s87, s87, 393216
    s_and_b32 s86, s86, 2047
    s_cselect_b32 s87, s87, 0
    s_waitcnt vmcnt(10)
    s_barrier
    s_add_u32 m0, s88, 77824
    s_nop 0
    s_nop 0
    buffer_load_dwordx4 v4, s[28:31], s86 offen  lds
    buffer_load_dwordx4 v5, s[28:31], s86 offen offset:1024  lds
    s_add_u32 m0, s89, 102400
    s_add_u32 s101, s87, 2048
    buffer_load_dwordx4 v6, s[32:35], s101 offen  lds
    buffer_load_dwordx4 v7, s[32:35], s101 offen offset:1024  lds
    s_add_u32 m0, s88, 79872
    s_add_u32 s101, s86, 32768
    buffer_load_dwordx4 v4, s[28:31], s101 offen  lds
    buffer_load_dwordx4 v5, s[28:31], s101 offen offset:1024  lds
    s_add_u32 m0, s89, 110592
    s_add_u32 s101, s87, 4096
    buffer_load_dwordx4 v6, s[32:35], s101 offen  lds
    buffer_load_dwordx4 v7, s[32:35], s101 offen offset:1024  lds
    s_add_u32 m0, s89, 94208
    s_nop 0
    buffer_load_dwordx4 v6, s[32:35], s87 offen  lds
    buffer_load_dwordx4 v7, s[32:35], s87 offen offset:1024  lds
    s_add_u32 s86, s86, 128
    s_add_u32 s87, s87, 393216
    s_and_b32 s86, s86, 2047
    s_cselect_b32 s87, s87, 0
    s_waitcnt vmcnt(10)
    s_barrier
    s_add_u32 m0, s88, 118784
    s_nop 0
    s_nop 0
    buffer_load_dwordx4 v4, s[28:31], s86 offen  lds
    buffer_load_dwordx4 v5, s[28:31], s86 offen offset:1024  lds
    s_add_u32 m0, s89, 143360
    s_add_u32 s101, s87, 2048
    buffer_load_dwordx4 v6, s[32:35], s101 offen  lds
    buffer_load_dwordx4 v7, s[32:35], s101 offen offset:1024  lds
    s_add_u32 m0, s88, 120832
    s_add_u32 s101, s86, 32768
    buffer_load_dwordx4 v4, s[28:31], s101 offen  lds
    buffer_load_dwordx4 v5, s[28:31], s101 offen offset:1024  lds
    s_add_u32 m0, s89, 151552
    s_add_u32 s101, s87, 4096
    buffer_load_dwordx4 v6, s[32:35], s101 offen  lds
    buffer_load_dwordx4 v7, s[32:35], s101 offen offset:1024  lds
    s_add_u32 m0, s89, 135168
    s_nop 0
    buffer_load_dwordx4 v6, s[32:35], s87 offen  lds
    buffer_load_dwordx4 v7, s[32:35], s87 offen offset:1024  lds
    s_add_u32 s86, s86, 128
    s_add_u32 s87, s87, 393216
    s_and_b32 s86, s86, 2047
    s_cselect_b32 s87, s87, 0
    s_mov_b32 s100, 0
    buffer_load_dwordx4 v[64:67], v244, s[48:51], s100 offen nt
    s_mov_b32 s100, 0
    buffer_load_dwordx4 v[96:99], v244, s[52:55], s100 offen nt
    s_mov_b32 s100, 7168
    buffer_load_dwordx4 v[68:71], v244, s[48:51], s100 offen nt
    s_mov_b32 s100, 7168
    buffer_load_dwordx4 v[100:103], v244, s[52:55], s100 offen nt
    s_mov_b32 s100, 14336
    buffer_load_dwordx4 v[72:75], v244, s[48:51], s100 offen nt
    s_mov_b32 s100, 14336
    buffer_load_dwordx4 v[104:107], v244, s[52:55], s100 offen nt
    s_mov_b32 s100, 21504
    buffer_load_dwordx4 v[76:79], v244, s[48:51], s100 offen nt
    s_waitcnt vmcnt(17)
    s_barrier
    s_add_u32 m0, s88, 36864
    s_nop 0
    s_nop 0
    buffer_load_dwordx4 v4, s[28:31], s86 offen  lds
    buffer_load_dwordx4 v5, s[28:31], s86 offen offset:1024  lds
    s_add_u32 m0, s89, 61440
    s_add_u32 s101, s87, 2048
    buffer_load_dwordx4 v6, s[32:35], s101 offen  lds
    buffer_load_dwordx4 v7, s[32:35], s101 offen offset:1024  lds
    s_add_u32 m0, s88, 38912
    s_add_u32 s101, s86, 32768
    buffer_load_dwordx4 v4, s[28:31], s101 offen  lds
    buffer_load_dwordx4 v5, s[28:31], s101 offen offset:1024  lds
    s_add_u32 m0, s89, 69632
    s_add_u32 s101, s87, 4096
    buffer_load_dwordx4 v6, s[32:35], s101 offen  lds
    buffer_load_dwordx4 v7, s[32:35], s101 offen offset:1024  lds
    s_add_u32 m0, s89, 53248
    s_nop 0
    buffer_load_dwordx4 v6, s[32:35], s87 offen  lds
    buffer_load_dwordx4 v7, s[32:35], s87 offen offset:1024  lds
    s_add_u32 s86, s86, 128
    s_add_u32 s87, s87, 393216
    s_and_b32 s86, s86, 2047
    s_cselect_b32 s87, s87, 0
    s_waitcnt vmcnt(17)
    s_barrier
    s_add_u32 m0, s88, 77824
    s_nop 0
    s_nop 0
    buffer_load_dwordx4 v4, s[28:31], s86 offen  lds
    buffer_load_dwordx4 v5, s[28:31], s86 offen offset:1024  lds
    s_add_u32 m0, s89, 102400
    s_add_u32 s101, s87, 2048
    buffer_load_dwordx4 v6, s[32:35], s101 offen  lds
    buffer_load_dwordx4 v7, s[32:35], s101 offen offset:1024  lds
    s_add_u32 m0, s88, 79872
    s_add_u32 s101, s86, 32768
    buffer_load_dwordx4 v4, s[28:31], s101 offen  lds
    buffer_load_dwordx4 v5, s[28:31], s101 offen offset:1024  lds
    s_add_u32 m0, s89, 110592
    s_add_u32 s101, s87, 4096
    buffer_load_dwordx4 v6, s[32:35], s101 offen  lds
    buffer_load_dwordx4 v7, s[32:35], s101 offen offset:1024  lds
    s_add_u32 m0, s89, 94208
    s_nop 0
    buffer_load_dwordx4 v6, s[32:35], s87 offen  lds
    buffer_load_dwordx4 v7, s[32:35], s87 offen offset:1024  lds
    s_add_u32 s86, s86, 128
    s_add_u32 s87, s87, 393216
    s_and_b32 s86, s86, 2047
    s_cselect_b32 s87, s87, 0
    s_waitcnt vmcnt(10)
    s_barrier
    s_add_u32 m0, s88, 118784
    s_nop 0
    s_nop 0
    buffer_load_dwordx4 v4, s[28:31], s86 offen  lds
    buffer_load_dwordx4 v5, s[28:31], s86 offen offset:1024  lds
    s_add_u32 m0, s89, 143360
    s_add_u32 s101, s87, 2048
    buffer_load_dwordx4 v6, s[32:35], s101 offen  lds
    buffer_load_dwordx4 v7, s[32:35], s101 offen offset:1024  lds
    s_add_u32 m0, s88, 120832
    s_add_u32 s101, s86, 32768
    buffer_load_dwordx4 v4, s[28:31], s101 offen  lds
    buffer_load_dwordx4 v5, s[28:31], s101 offen offset:1024  lds
    s_add_u32 m0, s89, 151552
    s_add_u32 s101, s87, 4096
    buffer_load_dwordx4 v6, s[32:35], s101 offen  lds
    buffer_load_dwordx4 v7, s[32:35], s101 offen offset:1024  lds
    s_add_u32 m0, s89, 135168
    s_nop 0
    buffer_load_dwordx4 v6, s[32:35], s87 offen  lds
    buffer_load_dwordx4 v7, s[32:35], s87 offen offset:1024  lds
    s_add_u32 s86, s86, 128
    s_add_u32 s87, s87, 393216
    s_and_b32 s86, s86, 2047
    s_cselect_b32 s87, s87, 0
    s_waitcnt vmcnt(10)
    s_barrier
    s_add_u32 m0, s88, 36864
    s_nop 0
    s_nop 0
    buffer_load_dwordx4 v4, s[28:31], s86 offen  lds
    buffer_load_dwordx4 v5, s[28:31], s86 offen offset:1024  lds
    s_add_u32 m0, s89, 61440
    s_add_u32 s101, s87, 2048
    buffer_load_dwordx4 v6, s[32:35], s101 offen  lds
    buffer_load_dwordx4 v7, s[32:35], s101 offen offset:1024  lds
    s_add_u32 m0, s88, 38912
    s_add_u32 s101, s86, 32768
    buffer_load_dwordx4 v4, s[28:31], s101 offen  lds
    buffer_load_dwordx4 v5, s[28:31], s101 offen offset:1024  lds
    s_add_u32 m0, s89, 69632
    s_add_u32 s101, s87, 4096
    buffer_load_dwordx4 v6, s[32:35], s101 offen  lds
    buffer_load_dwordx4 v7, s[32:35], s101 offen offset:1024  lds
    s_add_u32 m0, s89, 53248
    s_nop 0
    buffer_load_dwordx4 v6, s[32:35], s87 offen  lds
    buffer_load_dwordx4 v7, s[32:35], s87 offen offset:1024  lds
    s_add_u32 s86, s86, 128
    s_add_u32 s87, s87, 393216
    s_and_b32 s86, s86, 2047
    s_cselect_b32 s87, s87, 0
    s_waitcnt vmcnt(10)
    s_barrier
    s_cmp_lg_u32 s76, 2
    s_cbranch_scc1 Lc4_30
    s_mov_b32 exec_hi, -1
    buffer_load_dword v238, v63, s[40:43], 0 offen
    s_mov_b64 exec, -1
Lc4_30:
    s_cmp_lg_u32 s76, 0
    s_cbranch_scc1 Lpl_31
    s_mov_b32 exec_hi, 0xffff
    buffer_load_dwordx2 v[198:199], v196, s[36:39], 0 offen sc1
    s_mov_b64 exec, -1
Lpl_31:
    s_add_u32 m0, s88, 77824
    s_nop 0
    buffer_load_dwordx4 v4, s[28:31], s86 offen  lds
    buffer_load_dwordx4 v5, s[28:31], s86 offen offset:1024  lds
    s_add_u32 m0, s89, 102400
    s_add_u32 s101, s87, 2048
    buffer_load_dwordx4 v6, s[32:35], s101 offen  lds
    buffer_load_dwordx4 v7, s[32:35], s101 offen offset:1024  lds
    s_add_u32 m0, s88, 79872
    s_add_u32 s101, s86, 32768
    buffer_load_dwordx4 v4, s[28:31], s101 offen  lds
    buffer_load_dwordx4 v5, s[28:31], s101 offen offset:1024  lds
    s_add_u32 m0, s89, 110592
    s_add_u32 s101, s87, 4096
    buffer_load_dwordx4 v6, s[32:35], s101 offen  lds
    buffer_load_dwordx4 v7, s[32:35], s101 offen offset:1024  lds
    s_add_u32 m0, s89, 94208
    s_nop 0
    buffer_load_dwordx4 v6, s[32:35], s87 offen  lds
    buffer_load_dwordx4 v7, s[32:35], s87 offen offset:1024  lds
    s_add_u32 s86, s86, 128
    s_add_u32 s87, s87, 393216
    s_and_b32 s86, s86, 2047
    s_cselect_b32 s87, s87, 0
    s_mov_b32 s100, 21504
    buffer_load_dwordx4 v[108:111], v244, s[52:55], s100 offen nt
    s_mov_b32 s100, 28672
    buffer_load_dwordx4 v[80:83], v244, s[48:51], s100 offen nt
    s_mov_b32 s100, 28672
    buffer_load_dwordx4 v[112:115], v244, s[52:55], s100 offen nt
    s_mov_b32 s100, 35840
    buffer_load_dwordx4 v[84:87], v244, s[48:51], s100 offen nt
    s_mov_b32 s100, 35840
    buffer_load_dwordx4 v[116:119], v244, s[52:55], s100 offen nt
    s_mov_b32 s100, 43008
    buffer_load_dwordx4 v[88:91], v244, s[48:51], s100 offen nt
    s_mov_b32 s100, 43008
    buffer_load_dwordx4 v[120:123], v244, s[52:55], s100 offen nt
    s_waitcnt vmcnt(17)
    s_barrier
    s_add_u32 m0, s88, 118784
    s_nop 0
    s_nop 0
    buffer_load_dwordx4 v4, s[28:31], s86 offen  lds
    buffer_load_dwordx4 v5, s[28:31], s86 offen offset:1024  lds
    s_add_u32 m0, s89, 143360
    s_add_u32 s101, s87, 2048
    buffer_load_dwordx4 v6, s[32:35], s101 offen  lds
    buffer_load_dwordx4 v7, s[32:35], s101 offen offset:1024  lds
    s_add_u32 m0, s88, 120832
    s_add_u32 s101, s86, 32768
    buffer_load_dwordx4 v4, s[28:31], s101 offen  lds
    buffer_load_dwordx4 v5, s[28:31], s101 offen offset:1024  lds
    s_add_u32 m0, s89, 151552
    s_add_u32 s101, s87, 4096
    buffer_load_dwordx4 v6, s[32:35], s101 offen  lds
    buffer_load_dwordx4 v7, s[32:35], s101 offen offset:1024  lds
    s_add_u32 m0, s89, 135168
    s_nop 0
    buffer_load_dwordx4 v6, s[32:35], s87 offen  lds
    buffer_load_dwordx4 v7, s[32:35], s87 offen offset:1024  lds
    s_add_u32 s86, s86, 128
    s_add_u32 s87, s87, 393216
    s_and_b32 s86, s86, 2047
    s_cselect_b32 s87, s87, 0
    s_waitcnt vmcnt(17)
    s_cmp_lg_u32 s76, 0
    s_cbranch_scc1 Lpc_32
    s_mov_b32 exec_hi, 0xffff
    s_mov_b32 s85, 0
    s_branch Lpk_33
Lspin_34:
    s_add_u32 s85, s85, 1
    s_cmp_gt_u32 s85, 400000
    s_cbranch_scc1 L_end
    buffer_load_dwordx2 v[198:199], v196, s[36:39], 0 offen sc1
    s_waitcnt vmcnt(0)
Lpk_33:
    v_cmp_ne_u32 vcc, s75, v198
    s_cbranch_vccnz Lspin_34
    v_cmp_ne_u32 vcc, s99, v199
    s_mov_b64 exec, -1
    s_lshr_b32 s78, vcc_lo, 16
    s_cselect_b32 s78, 0, 1
    s_cmp_eq_u32 vcc_hi, 0
    s_cselect_b32 s79, 2, 0
    s_or_b32 s78, s78, s79
    s_and_b32 s78, s78, 3
    v_mov_b32_e64 v198, s78
    v_mov_b32 v199, 163584
    ds_write_b32 v199, v198
    s_waitcnt lgkmcnt(0)
Lpc_32:
    s_barrier
    v_lshrrev_b32 v196, 4, v2
    v_and_b32 v197, 15, v2
    v_lshlrev_b32_e64 v197, 4, v197
    v_lshl_add_u32 v198, v196, 10, v197
    s_lshl_b32 s78, s69, 14
    s_lshl_b32 s79, s76, 8
    s_add_u32 s78, s78, s79
    s_nop 0
    s_add_u32 s78, s78, 65536
    buffer_load_dwordx4 v[20:23], v198, s[36:39], s78 offen sc1
    s_add_u32 s78, s78, 4096
    buffer_load_dwordx4 v[24:27], v198, s[36:39], s78 offen sc1
    s_add_u32 s78, s78, 4096
    buffer_load_dwordx4 v[28:31], v198, s[36:39], s78 offen sc1
    s_add_u32 s78, s78, 4096
    buffer_load_dwordx4 v[32:35], v198, s[36:39], s78 offen sc1
    v_mul_u32_u24 v198, 768, v196
    v_add_u32_e64 v198, v198, v197
    s_mul_i32 s78, s70, 12288
    s_lshl_b32 s79, s76, 8
    s_add_u32 s78, s78, s79
    s_add_u32 s78, s78, 327680
    s_cmp_eq_u32 s76, 3
    s_nop 0
    s_cselect_b32 s78, 0x10000000, s78
    buffer_load_dwordx4 v[36:39], v198, s[36:39], s78 offen sc1
    s_add_u32 s78, s78, 3072
    buffer_load_dwordx4 v[40:43], v198, s[36:39], s78 offen sc1
    s_add_u32 s78, s78, 3072
    buffer_load_dwordx4 v[44:47], v198, s[36:39], s78 offen sc1
    s_add_u32 s78, s78, 3072
    buffer_load_dwordx4 v[48:51], v198, s[36:39], s78 offen sc1
    s_add_u32 m0, s84, 0
    s_mov_b32 s100, 0
    buffer_load_dwordx4 v246, s[40:43], s100 offen  lds
    s_add_u32 m0, s84, 4096
    s_mov_b32 s100, 65536
    buffer_load_dwordx4 v246, s[40:43], s100 offen  lds
    s_waitcnt vmcnt(10)
    s_waitcnt lgkmcnt(0)
    s_barrier
    s_setprio 2
    s_add_u32 m0, s84, 8192
    s_mov_b32 s100, 131072
    buffer_load_dwordx4 v246, s[40:43], s100 offen  lds
    s_waitcnt vmcnt(7)
    v_add_f32 v20, v20, v24
    v_add_f32 v21, v21, v25
    v_add_f32 v22, v22, v26
    v_add_f32 v23, v23, v27
    v_add_f32 v20, v20, v28
    v_add_f32 v21, v21, v29
    v_add_f32 v22, v22, v30
    v_add_f32_e64 v23, v23, v31
    s_add_u32 m0, s84, 12288
    s_mov_b32 s100, 196608
    buffer_load_dwordx4 v246, s[40:43], s100 offen  lds
    v_add_f32 v20, v20, v32
    v_add_f32 v21, v21, v33
    v_add_f32 v22, v22, v34
    v_add_f32 v23, v23, v35
    s_nop 0
    v_permlane32_swap_b32 v20, v22
    v_permlane32_swap_b32 v21, v23
    v_add_f32 v20, v20, v22
    v_add_f32 v21, v21, v23
    v_mov_b32 v22, v20
    v_mov_b32_e64 v23, v21
    s_add_u32 m0, s84, 16384
    s_mov_b32 s100, 262144
    buffer_load_dwordx4 v246, s[40:43], s100 offen  lds
    v_permlane16_swap_b32 v20, v22
    v_permlane16_swap_b32 v21, v23
    v_add_f32 v20, v20, v22
    v_add_f32 v21, v21, v23
    v_mul_f32 v24, 0x3a800000, v20
    v_mul_f32 v26, 0x3a800000, v21
    v_fma_f32 v26, -v24, v24, v26
    v_max_f32_e64 v26, 0, v26
    v_cvt_pk_bf16_f32 v24, v24, v24
    v_and_b32 v24, 0xffff0000, v24
    s_add_u32 m0, s84, 20480
    s_mov_b32 s100, 327680
    buffer_load_dwordx4 v246, s[40:43], s100 offen  lds
    v_cvt_pk_bf16_f32 v26, v26, v26
    v_and_b32 v26, 0xffff0000, v26
    v_add_f32 v26, 0x3727c5ac, v26
    v_cvt_pk_bf16_f32 v26, v26, v26
    v_and_b32 v26, 0xffff0000, v26
    v_sqrt_f32 v26, v26
    s_nop 0
    v_cvt_pk_bf16_f32 v26, v26, v26
    v_and_b32 v26, 0xffff0000, v26
    v_rcp_f32_e64 v25, v26
    v_xor_b32 v26, 0x80000000, v24
    s_add_u32 m0, s84, 24576
    s_mov_b32 s100, 393216
    buffer_load_dwordx4 v246, s[40:43], s100 offen  lds
    v_lshrrev_b32 v27, 16, v26
    v_or_b32 v26, v26, v27
    v_mov_b32 v27, 0
    v_and_b32 v196, 15, v2
    v_lshrrev_b32_e64 v197, 5, v2
    v_lshl_add_u32 v196, v196, 1, v197
    s_lshl_b32 s78, s76, 5
    v_add_u32 v196, s78, v196
    v_lshlrev_b32_e64 v197, 3, v196
    v_add_u32 v197, 159744, v197
    s_add_u32 m0, s84, 28672
    s_mov_b32 s100, 458752
    buffer_load_dwordx4 v246, s[40:43], s100 offen  lds
    v_lshlrev_b32_e64 v196, 2, v196
    v_add_u32 v196, 162304, v196
    ds_write_b64 v197, v[26:27]
    ds_write_b32 v196, v25
    s_waitcnt vmcnt(8)
    v_add_f32 v36, v36, v40
    v_add_f32 v37, v37, v41
    v_add_f32 v38, v38, v42
    v_add_f32 v39, v39, v43
    v_add_f32 v36, v36, v44
    s_add_u32 m0, s84, 32768
    s_mov_b32 s100, 524288
    buffer_load_dwordx4 v246, s[40:43], s100 offen  lds
    v_add_f32 v37, v37, v45
    v_add_f32 v38, v38, v46
    v_add_f32 v39, v39, v47
    v_add_f32 v36, v36, v48
    v_add_f32 v37, v37, v49
    v_add_f32 v38, v38, v50
    v_add_f32 v39, v39, v51
    s_nop 0
    v_permlane32_swap_b32 v36, v38
    v_permlane32_swap_b32 v37, v39
    v_add_f32_e64 v36, v36, v38
    s_add_u32 m0, s84, 36864
    s_mov_b32 s100, 589824
    buffer_load_dwordx4 v246, s[40:43], s100 offen  lds
    v_add_f32 v37, v37, v39
    s_nop 1
    v_permlane16_swap_b32 v36, v37
    v_add_f32 v36, v36, v37
    v_cvt_pk_bf16_f32 v37, v36, v36
    v_and_b32 v37, 0xffff0000, v37
    v_sub_f32_e64 v38, v36, v37
    v_cvt_pk_bf16_f32 v38, v37, v38
    v_mov_b32 v39, 0
    v_and_b32 v196, 15, v2
    v_lshrrev_b32_e64 v197, 4, v2
    s_add_u32 m0, s84, 40960
    s_mov_b32 s100, 655360
    buffer_load_dwordx4 v246, s[40:43], s100 offen  lds
    v_lshl_add_u32 v196, v196, 2, v197
    s_lshl_b32 s78, s76, 9
    s_add_u32 s78, s78, 160768
    v_lshl_add_u32 v196, v196, 3, s78
    v_and_b32 v197, 15, v2
    v_lshlrev_b32_e64 v197, 3, v197
    v_add_u32 v197, 162816, v197
    v_mov_b32 v198, 0x3f803f80
    s_cmp_eq_u32 s76, 3
    s_cselect_b64 vcc, -1, 0
    v_cndmask_b32 v196, v196, v197, vcc
    v_cndmask_b32 v38, v38, v198, vcc
    v_cndmask_b32_e64 v39, v39, v198, vcc
    ds_write_b64 v196, v[38:39]
    s_setprio 0
    s_waitcnt lgkmcnt(0)
    s_barrier
L_phend:
    s_lshl_b32 s100, s77, 13
    s_add_u32 s100, s100, s89
    s_add_u32 s100, s100, 2097152
    buffer_load_dwordx4 v[252:255], v14, s[36:39], s100 offen offset:0 sc1
    s_lshl_b32 s100, s77, 13
    s_add_u32 s100, s100, s89
    s_nop 0
    s_add_u32 s100, s100, 2097152
    buffer_load_dwordx4 v[252:255], v14, s[36:39], s100 offen offset:1024 sc1
    buffer_load_dwordx4 v[252:255], v14, s[36:39], s96 offen sc1
    s_add_u32 m0, s84, 45056
    s_mov_b32 s100, 720896
    buffer_load_dwordx4 v246, s[40:43], s100 offen  lds
    s_add_u32 m0, s84, 49152
    s_mov_b32 s100, 786432
    buffer_load_dwordx4 v246, s[40:43], s100 offen  lds
    s_add_u32 m0, s84, 53248
    s_mov_b32 s100, 851968
    buffer_load_dwordx4 v246, s[40:43], s100 offen  lds
    s_add_u32 m0, s84, 57344
    s_mov_b32 s100, 917504
    buffer_load_dwordx4 v246, s[40:43], s100 offen  lds
    s_add_u32 m0, s84, 61440
    s_mov_b32 s100, 983040
    buffer_load_dwordx4 v246, s[40:43], s100 offen  lds
    s_add_u32 m0, s84, 65536
    s_mov_b32 s100, 1048576
    buffer_load_dwordx4 v246, s[40:43], s100 offen  lds
    s_add_u32 m0, s84, 69632
    s_mov_b32 s100, 1114112
    buffer_load_dwordx4 v246, s[40:43], s100 offen  lds
    s_add_u32 m0, s84, 73728
    s_mov_b32 s100, 1179648
    buffer_load_dwordx4 v246, s[40:43], s100 offen  lds
    s_add_u32 m0, s84, 77824
    s_mov_b32 s100, 1245184
    buffer_load_dwordx4 v246, s[40:43], s100 offen  lds
    s_add_u32 m0, s84, 81920
    s_mov_b32 s100, 1310720
    buffer_load_dwordx4 v246, s[40:43], s100 offen  lds
    s_add_u32 m0, s84, 86016
    s_mov_b32 s100, 1376256
    buffer_load_dwordx4 v246, s[40:43], s100 offen  lds
    s_add_u32 m0, s84, 90112
    s_mov_b32 s100, 1441792
    buffer_load_dwordx4 v246, s[40:43], s100 offen  lds
    s_add_u32 m0, s84, 94208
    s_mov_b32 s100, 1507328
    buffer_load_dwordx4 v246, s[40:43], s100 offen  lds
    s_add_u32 m0, s84, 98304
    s_mov_b32 s100, 1572864
    buffer_load_dwordx4 v246, s[40:43], s100 offen  lds
    s_add_u32 m0, s84, 102400
    s_mov_b32 s100, 1638400
    buffer_load_dwordx4 v246, s[40:43], s100 offen  lds
    s_add_u32 m0, s84, 106496
    s_mov_b32 s100, 1703936
    buffer_load_dwordx4 v246, s[40:43], s100 offen  lds
    s_mov_b32 s100, 2031616
    buffer_load_dwordx4 v[160:163], v246, s[40:43], s100 offen
    s_mov_b32 s100, 1966080
    buffer_load_dwordx4 v[164:167], v246, s[40:43], s100 offen
    s_mov_b32 s100, 1900544
    buffer_load_dwordx4 v[168:171], v246, s[40:43], s100 offen
    s_mov_b32 s100, 1835008
    buffer_load_dwordx4 v[172:175], v246, s[40:43], s100 offen
    s_mov_b32 s100, 1769472
    buffer_load_dwordx4 v[176:179], v246, s[40:43], s100 offen
    s_mov_b32 s100, 0
    s_nop 0
    buffer_load_dwordx4 v[180:183], v247, s[28:31], s100 offen
    s_mov_b32 s100, 16384
    buffer_load_dwordx4 v[184:187], v248, s[28:31], s100 offen
    s_mov_b32 s100, 32768
    buffer_load_dwordx4 v[188:191], v247, s[28:31], s100 offen
    s_mov_b32 s100, 49152
    buffer_load_dwordx4 v[192:195], v248, s[28:31], s100 offen
    v_lshrrev_b32 v198, 2, v2
    v_and_b32 v199, 7, v198
    v_and_b32 v200, 3, v2
    v_xor_b32 v199, v199, v200
    s_lshr_b32 s78, s76, 1
    s_and_b32 s79, s76, 1
    s_lshl_b32 s80, s79, 2
    s_lshl_b32 s81, s78, 2
    v_xor_b32 v200, s80, v199
    v_xor_b32 v201, s81, v199
    v_lshlrev_b32 v198, 7, v198
    s_lshl_b32 s80, s78, 14
    s_add_u32 s80, s80, 110592
    v_lshl_add_u32 v196, v200, 4, v198
    v_add_u32_e64 v196, s80, v196
    v_lshl_add_u32 v197, v201, 4, v198
    v_add_u32 v197, 143360, v197
    v_mov_b32 v200, 0x3f803f80
    v_mov_b32 v201, 0x3f803f80
    v_mov_b32 v202, 0x3f803f80
    v_mov_b32 v203, 0x3f803f80
    v_lshrrev_b32 v198, 4, v2
    v_and_b32 v199, 15, v2
    v_lshlrev_b32_e64 v199, 4, v199
    v_lshl_add_u32 v198, v198, 13, v199
    s_lshl_b32 s78, s70, 2
    s_add_u32 s78, s78, s76
    s_lshl_b32 s78, s78, 15
    s_lshl_b32 s79, s69, 9
    s_add_u32 s78, s78, s79
    s_add_u32 s78, s78, 2097152
    s_lshl_b32 s79, s77, 10
    s_lshl_b32 s80, s76, 6
    s_add_u32 s79, s79, s80
    s_add_u32 s79, s79, 8389120
    s_lshl_b32 s80, s70, 11
    s_add_u32 s80, s80, 8716288
    v_lshl_add_u32 v60, v2, 7, s80
    s_lshl_b32 s80, s71, 7
    s_add_u32 s80, s80, 8781824
    v_lshl_add_u32 v61, v2, 11, s80
    v_mov_b32 v52, 163584
    ds_read_b32 v52, v52
    s_waitcnt lgkmcnt(0)
    v_readfirstlane_b32 s99, v52
    s_and_b32 s94, s69, 1
    s_and_b32 s96, s75, 1
    v_mov_b32_e64 v54, s96
    s_and_b32 s83, s75, 1
    s_lshl_b32 s83, s83, 16
    s_sub_u32 s83, 0, s83
    s_barrier
    ds_read_b64_tr_b16 v[4:5], v196 offset:0
    ds_read_b64_tr_b16 v[6:7], v196 offset:2048
    ds_read_b64_tr_b16 v[8:9], v196 offset:8
    ds_read_b64_tr_b16 v[10:11], v196 offset:2056
    ds_read_b64_tr_b16 v[12:13], v197 offset:0
    ds_read_b64_tr_b16 v[14:15], v197 offset:2048
    ds_read_b64_tr_b16 v[16:17], v197 offset:8
    ds_read_b64_tr_b16 v[18:19], v197 offset:2056
    ds_read_b64_tr_b16 v[20:21], v196 offset:4096
    ds_read_b64_tr_b16 v[22:23], v196 offset:6144
    ds_read_b64_tr_b16 v[24:25], v196 offset:4104
    ds_read_b64_tr_b16 v[26:27], v196 offset:6152
    ds_read_b64_tr_b16 v[28:29], v197 offset:4096
    ds_read_b64_tr_b16 v[30:31], v197 offset:6144
    ds_read_b64_tr_b16 v[32:33], v197 offset:4104
    ds_read_b64_tr_b16 v[34:35], v197 offset:6152
    s_waitcnt lgkmcnt(8)
    s_nop 0
    v_mfma_f32_16x16x32_bf16 v[204:207], v[4:7], v[12:15], 0
    v_mfma_f32_16x16x32_bf16 v[208:211], v[8:11], v[12:15], 0
    v_mfma_f32_16x16x32_bf16 v[212:215], v[4:7], v[16:19], 0
    v_mfma_f32_16x16x32_bf16 v[216:219], v[8:11], v[16:19], 0
    v_mfma_f32_16x16x32_bf16 v[220:223], v[4:7], v[200:203], 0
    v_mfma_f32_16x16x32_bf16 v[224:227], v[8:11], v[200:203], 0
    ds_read_b64_tr_b16 v[36:37], v196 offset:8192
    ds_read_b64_tr_b16 v[38:39], v196 offset:10240
    ds_read_b64_tr_b16 v[40:41], v196 offset:8200
    ds_read_b64_tr_b16 v[42:43], v196 offset:10248
    ds_read_b64_tr_b16 v[44:45], v197 offset:8192
    ds_read_b64_tr_b16 v[46:47], v197 offset:10240
    ds_read_b64_tr_b16 v[48:49], v197 offset:8200
    ds_read_b64_tr_b16 v[50:51], v197 offset:10248
    s_waitcnt lgkmcnt(8)
    s_nop 0
    v_mfma_f32_16x16x32_bf16 v[204:207], v[20:23], v[28:31], v[204:207]
    v_mfma_f32_16x16x32_bf16 v[208:211], v[24:27], v[28:31], v[208:211]
    v_mfma_f32_16x16x32_bf16 v[212:215], v[20:23], v[32:35], v[212:215]
    v_mfma_f32_16x16x32_bf16 v[216:219], v[24:27], v[32:35], v[216:219]
    v_mfma_f32_16x16x32_bf16 v[220:223], v[20:23], v[200:203], v[220:223]
    v_mfma_f32_16x16x32_bf16 v[224:227], v[24:27], v[200:203], v[224:227]
    ds_read_b64_tr_b16 v[228:229], v196 offset:12288
    ds_read_b64_tr_b16 v[230:231], v196 offset:14336
    ds_read_b64_tr_b16 v[232:233], v196 offset:12296
    ds_read_b64_tr_b16 v[234:235], v196 offset:14344
    ds_read_b64_tr_b16 v[236:237], v197 offset:12288
    ds_read_b64_tr_b16 v[238:239], v197 offset:14336
    ds_read_b64_tr_b16 v[240:241], v197 offset:12296
    ds_read_b64_tr_b16 v[242:243], v197 offset:14344
    s_waitcnt lgkmcnt(8)
    s_nop 0
    v_mfma_f32_16x16x32_bf16 v[204:207], v[36:39], v[44:47], v[204:207]
    v_mfma_f32_16x16x32_bf16 v[208:211], v[40:43], v[44:47], v[208:211]
    v_mfma_f32_16x16x32_bf16 v[212:215], v[36:39], v[48:51], v[212:215]
    v_mfma_f32_16x16x32_bf16 v[216:219], v[40:43], v[48:51], v[216:219]
    v_mfma_f32_16x16x32_bf16 v[220:223], v[36:39], v[200:203], v[220:223]
    v_mfma_f32_16x16x32_bf16 v[224:227], v[40:43], v[200:203], v[224:227]
    s_waitcnt lgkmcnt(0)
    s_nop 0
    v_mfma_f32_16x16x32_bf16 v[204:207], v[228:231], v[236:239], v[204:207]
    v_mfma_f32_16x16x32_bf16 v[208:211], v[232:235], v[236:239], v[208:211]
    v_mfma_f32_16x16x32_bf16 v[212:215], v[228:231], v[240:243], v[212:215]
    v_mfma_f32_16x16x32_bf16 v[216:219], v[232:235], v[240:243], v[216:219]
    v_mfma_f32_16x16x32_bf16 v[220:223], v[228:231], v[200:203], v[220:223]
    v_mfma_f32_16x16x32_bf16 v[224:227], v[232:235], v[200:203], v[224:227]
    s_nop 2
    v_cvt_pk_bf16_f32 v4, v204, v205
    v_cvt_pk_bf16_f32 v5, v206, v207
    v_cvt_pk_bf16_f32 v6, v208, v209
    v_cvt_pk_bf16_f32 v7, v210, v211
    v_add_u32 v4, s94, v4
    v_and_or_b32 v4, v4, -2, v54
    v_add_u32_e64 v5, s94, v5
    v_and_or_b32 v5, v5, -2, v54
    v_add_u32_e64 v6, s94, v6
    v_and_or_b32 v6, v6, -2, v54
    v_add_u32_e64 v7, s94, v7
    v_and_or_b32 v7, v7, -2, v54
    s_bitcmp1_b32 s99, 0
    s_cbranch_scc1 Lls_35
    buffer_store_dwordx4 v[4:7], v198, s[36:39], s78 offen offset:0 sc1
    s_branch Lle_36
Lls_35:
    buffer_store_dwordx4 v[4:7], v198, s[36:39], s78 offen offset:0
Lle_36:
    v_cvt_pk_bf16_f32 v8, v212, v213
    v_cvt_pk_bf16_f32 v9, v214, v215
    v_cvt_pk_bf16_f32 v10, v216, v217
    v_cvt_pk_bf16_f32 v11, v218, v219
    v_add_u32 v8, s94, v8
    v_and_or_b32 v8, v8, -2, v54
    v_add_u32_e64 v9, s94, v9
    v_and_or_b32 v9, v9, -2, v54
    v_add_u32_e64 v10, s94, v10
    v_and_or_b32 v10, v10, -2, v54
    v_add_u32_e64 v11, s94, v11
    v_and_or_b32 v11, v11, -2, v54
    s_bitcmp1_b32 s99, 0
    s_cbranch_scc1 Lls_37
    buffer_store_dwordx4 v[8:11], v198, s[36:39], s78 offen offset:256 sc1
    s_branch Lle_38
Lls_37:
    s_nop 0
    buffer_store_dwordx4 v[8:11], v198, s[36:39], s78 offen offset:256
Lle_38:
    v_cvt_pk_bf16_f32 v12, v220, v221
    v_cvt_pk_bf16_f32 v13, v222, v223
    v_cvt_pk_bf16_f32 v14, v224, v225
    v_cvt_pk_bf16_f32 v15, v226, v227
    s_mov_b32 exec_lo, 0x00010001
    s_mov_b32 exec_hi, 0x00010001
    s_bitcmp1_b32 s99, 0
    s_cbranch_scc1 Lls_39
    buffer_store_dwordx4 v[12:15], v2, s[36:39], s79 offen sc1
    s_branch Lle_40
Lls_39:
    buffer_store_dwordx4 v[12:15], v2, s[36:39], s79 offen
Lle_40:
    s_mov_b64 exec, -1
    v_lshrrev_b32 v196, 3, v2
    v_and_b32 v197, 7, v2
    v_lshlrev_b32_e64 v197, 4, v197
    v_lshl_add_u32 v198, v196, 9, v197
    v_lshl_add_u32 v199, v196, 1, v197
    s_lshl_b32 s78, s77, 13
    s_lshl_b32 s80, s76, 7
    s_add_u32 s78, s78, s80
    s_add_u32 s78, s78, 2097152
    s_add_u32 s79, s78, 4096
    s_lshl_b32 s81, s77, 10
    s_add_u32 s81, s81, s80
    s_add_u32 s81, s81, 8388608
    v_lshrrev_b32 v200, 2, v2
    v_and_b32 v197, 3, v2
    v_lshlrev_b32 v197, 4, v197
    v_lshl_add_u32 v200, v200, 10, v197
    s_lshl_b32 s82, s70, 14
    s_lshl_b32 s80, s76, 6
    s_add_u32 s82, s82, s80
    s_add_u32 s82, s82, 8389120
    v_lshl_add_u32 v201, v196, 1, v197
    s_add_u32 s80, s80, 162944
    v_add_u32 v201, s80, v201
    s_mov_b32 s85, 0
Lspin_41:
    s_add_u32 s85, s85, 1
    s_cmp_gt_u32 s85, 400000
    s_cbranch_scc1 L_end
    buffer_load_dwordx4 v[20:23], v198, s[36:39], s78 offen sc1
    buffer_load_dwordx4 v[24:27], v198, s[36:39], s79 offen sc1
    buffer_load_dwordx4 v[16:19], v200, s[36:39], s82 offen sc1
    s_waitcnt vmcnt(0)
Lchk_42:
    v_bitop3_b32 v28, v20, v24, v54 bitop3:0x7e
    v_bitop3_b32 v29, v21, v25, v54 bitop3:0x7e
    v_bitop3_b32 v30, v22, v26, v54 bitop3:0x7e
    v_bitop3_b32 v31, v23, v27, v54 bitop3:0x7e
    v_or3_b32 v28, v28, v29, v30
    v_cmp_eq_u32 s[90:91], -1, v16
    v_or_b32 v28, v28, v31
    v_and_b32 v28, 1, v28
    v_cmp_ne_u32_e64 vcc, 0, v28
    s_or_b64 vcc, vcc, s[90:91]
    s_cbranch_vccnz Lspin_41
    v_lshl_add_u32 v28, v20, 16, s83
    v_and_b32 v29, 0xffff0000, v20
    v_lshl_add_u32 v36, v24, 16, s83
    v_and_b32 v37, 0xffff0000, v24
    v_pk_add_f32 v[28:29], v[28:29], v[36:37]
    v_lshl_add_u32 v30, v21, 16, s83
    v_and_b32 v31, 0xffff0000, v21
    v_lshl_add_u32 v38, v25, 16, s83
    v_and_b32 v39, 0xffff0000, v25
    v_pk_add_f32 v[30:31], v[30:31], v[38:39]
    v_lshl_add_u32 v32, v22, 16, s83
    v_and_b32 v33, 0xffff0000, v22
    v_lshl_add_u32 v40, v26, 16, s83
    v_and_b32 v41, 0xffff0000, v26
    v_pk_add_f32 v[32:33], v[32:33], v[40:41]
    v_lshl_add_u32 v34, v23, 16, s83
    v_and_b32 v35, 0xffff0000, v23
    v_lshl_add_u32 v42, v27, 16, s83
    v_and_b32 v43, 0xffff0000, v27
    v_pk_add_f32 v[34:35], v[34:35], v[42:43]
    v_permlane32_swap_b32 v28, v32
    v_permlane32_swap_b32 v29, v33
    v_permlane32_swap_b32 v30, v34
    v_permlane32_swap_b32 v31, v35
    v_pk_add_f32 v[28:29], v[28:29], v[32:33]
    v_pk_add_f32 v[30:31], v[30:31], v[34:35]
    s_nop 1
    v_permlane16_swap_b32 v28, v30
    v_permlane16_swap_b32_e64 v29, v31
    v_pk_add_f32 v[28:29], v[28:29], v[30:31]
    s_nop 1
    v_add_f32_dpp v28, v28, v28 row_ror:8 row_mask:0xf bank_mask:0xf
    v_add_f32_dpp v29, v29, v29 row_ror:8 row_mask:0xf bank_mask:0xf
    v_cvt_pk_bf16_f32 v36, v28, v29
    s_mov_b32 exec_lo, 0x00ff00ff
    s_mov_b32 exec_hi, 0x00ff00ff
    s_bitcmp1_b32 s99, 0
    s_cbranch_scc1 Lls_43
    buffer_store_dword v36, v199, s[36:39], s81 offen sc1
    s_branch Lle_44
Lls_43:
    buffer_store_dword v36, v199, s[36:39], s81 offen
Lle_44:
    s_mov_b64 exec, -1
    v_lshlrev_b32 v28, 16, v16
    v_and_b32 v29, 0xffff0000, v16
    v_lshlrev_b32_e64 v30, 16, v17
    v_and_b32 v31, 0xffff0000, v17
    v_lshlrev_b32_e64 v32, 16, v18
    v_and_b32 v33, 0xffff0000, v18
    v_lshlrev_b32_e64 v34, 16, v19
    v_and_b32 v35, 0xffff0000, v19
    v_permlane32_swap_b32 v28, v32
    v_permlane32_swap_b32 v29, v33
    v_permlane32_swap_b32 v30, v34
    v_permlane32_swap_b32 v31, v35
    v_pk_add_f32 v[28:29], v[28:29], v[32:33]
    v_pk_add_f32 v[30:31], v[30:31], v[34:35]
    s_nop 1
    v_permlane16_swap_b32 v28, v30
    v_permlane16_swap_b32_e64 v29, v31
    v_pk_add_f32 v[28:29], v[28:29], v[30:31]
    s_nop 1
    v_add_f32_dpp v38, v28, v28 row_ror:8 row_mask:0xf bank_mask:0x3
    s_nop 1
    v_add_f32_dpp v38, v29, v29 row_ror:8 row_mask:0xf bank_mask:0xc
    s_nop 1
    v_add_f32_dpp v37, v38, v38 row_shr:4 row_mask:0xf bank_mask:0xf
    v_cvt_pk_bf16_f32 v37, v37, v37
    s_mov_b32 exec_lo, 0xf0f0f0f0
    s_mov_b32 exec_hi, 0xf0f0f0f0
    ds_write_b16 v201, v37
    s_mov_b64 exec, -1
    s_waitcnt lgkmcnt(0)
    s_barrier
    s_sleep 4
    v_lshlrev_b32_e64 v4, 4, v2
    s_lshl_b32 s78, s76, 10
    s_add_u32 s78, s78, 110592
    v_add_u32 v5, s78, v4
    s_lshl_b32 s78, s76, 12
    s_add_u32 s78, s78, 131072
    v_add_u32_e64 v6, s78, v4
    ds_write_b128 v5, v[160:163] offset:16384
    ds_write_b128 v5, v[164:167] offset:12288
    ds_write_b128 v5, v[168:171] offset:8192
    ds_write_b128 v5, v[172:175] offset:4096
    ds_write_b128 v5, v[176:179] offset:0
    ds_write_b128 v6, v[180:183] offset:0
    ds_write_b128 v6, v[184:187] offset:1024
    ds_write_b128 v6, v[188:191] offset:2048
    ds_write_b128 v6, v[192:195] offset:3072
    s_waitcnt lgkmcnt(0)
    s_barrier
    s_mov_b32 s100, 50176
    buffer_load_dwordx4 v[92:95], v244, s[48:51], s100 offen nt
    s_mov_b32 s100, 50176
    buffer_load_dwordx4 v[124:127], v244, s[52:55], s100 offen nt
    s_mov_b32 s100, 0
    buffer_load_dwordx4 v[128:131], v245, s[56:59], s100 offen nt
    s_mov_b32 s100, 2048
    buffer_load_dwordx4 v[132:135], v245, s[56:59], s100 offen nt
    s_barrier
    s_cmp_lg_u32 s76, 0
    s_cbranch_scc1 Lfs_45
    s_lshl_b32 s100, s77, 7
    s_add_u32 s100, s100, 8781824
    v_mov_b32 v52, s75
    v_lshlrev_b32 v53, 2, v2
    s_mov_b32 exec_hi, 0
    buffer_store_dword v52, v53, s[36:39], s100 offen sc1
    s_mov_b64 exec, -1
Lfs_45:
    s_lshl_b32 s83, s71, 4
    s_add_u32 s83, s83, s72
    s_lshl_b32 s78, s0, 11
    s_and_b32 s79, s76, 1
    s_lshl_b32 s79, s79, 10
    s_add_u32 s78, s78, s79
    s_add_u32 s78, s78, 655360
    s_mul_i32 s79, s74, 56
    s_add_u32 s79, s79, s73
    s_lshl_b32 s79, s79, 10
    s_add_u32 s79, s79, 1114112
    s_cmp_eq_u32 s76, 1
    s_cselect_b32 s78, s79, s78
    s_cmp_ge_u32 s73, 56
    s_cselect_b32 s78, 0x10000000, s78
    s_lshl_b32 s79, s83, 9
    s_add_u32 s79, s79, 524288
    s_cmp_eq_u32 s76, 0
    s_cselect_b32 s78, s79, s78
    s_cselect_b32 s79, 0, -1
    v_mov_b32 v56, -1
    v_mov_b32 v57, -1
    v_mov_b32 v58, -1
    v_mov_b32 v59, -1
    s_mov_b32 exec_hi, s79
    buffer_store_dwordx4 v[56:59], v4, s[36:39], s78 offen sc1
    s_mov_b32 exec_hi, -1
    s_lshl_b32 s79, s83, 11
    s_add_u32 s79, s79, s84
    s_add_u32 s79, s79, 1572864
    s_cmp_lt_u32 s76, 2
    s_cselect_b32 s94, s79, s78
    s_cmp_lg_u32 s76, 1
    s_cbranch_scc1 Lf2_46
    s_sleep 14
    s_mov_b64 exec, 0xffff
    s_mov_b32 s85, 0
Lspin_47:
    s_add_u32 s85, s85, 1
    s_cmp_gt_u32 s85, 400000
    s_cbranch_scc1 L_end
    buffer_load_dword v52, v61, s[36:39], 0 offen sc1
    s_waitcnt vmcnt(0)
    v_cmp_ne_u32_e64 vcc, s75, v52
    s_cbranch_vccnz Lspin_47
    s_mov_b64 exec, -1
Lf2_46:
    s_barrier
    s_waitcnt vmcnt(0)
    s_mov_b32 s100, 0x05040100
    s_mov_b32 s101, 0x07060302
    v_perm_b32 v7, v68, v64, s100
    v_perm_b32 v68, v68, v64, s101
    v_mov_b32_e64 v64, v7
    v_perm_b32 v7, v69, v65, s100
    v_perm_b32 v69, v69, v65, s101
    v_mov_b32_e64 v65, v7
    v_perm_b32 v7, v70, v66, s100
    v_perm_b32 v70, v70, v66, s101
    v_mov_b32_e64 v66, v7
    v_perm_b32 v7, v71, v67, s100
    v_perm_b32 v71, v71, v67, s101
    v_mov_b32_e64 v67, v7
    v_perm_b32 v7, v100, v96, s100
    v_perm_b32 v100, v100, v96, s101
    v_mov_b32_e64 v96, v7
    v_perm_b32 v7, v101, v97, s100
    v_perm_b32 v101, v101, v97, s101
    v_mov_b32_e64 v97, v7
    v_perm_b32 v7, v102, v98, s100
    v_perm_b32 v102, v102, v98, s101
    v_mov_b32_e64 v98, v7
    v_perm_b32 v7, v103, v99, s100
    v_perm_b32 v103, v103, v99, s101
    v_mov_b32_e64 v99, v7
    v_perm_b32 v7, v76, v72, s100
    v_perm_b32 v76, v76, v72, s101
    v_mov_b32_e64 v72, v7
    v_perm_b32 v7, v77, v73, s100
    v_perm_b32 v77, v77, v73, s101
    v_mov_b32_e64 v73, v7
    v_perm_b32 v7, v78, v74, s100
    v_perm_b32 v78, v78, v74, s101
    v_mov_b32_e64 v74, v7
    v_perm_b32 v7, v79, v75, s100
    v_perm_b32 v79, v79, v75, s101
    v_mov_b32_e64 v75, v7
    v_perm_b32 v7, v108, v104, s100
    v_perm_b32 v108, v108, v104, s101
    v_mov_b32_e64 v104, v7
    v_perm_b32 v7, v109, v105, s100
    v_perm_b32 v109, v109, v105, s101
    v_mov_b32_e64 v105, v7
    v_perm_b32 v7, v110, v106, s100
    v_perm_b32 v110, v110, v106, s101
    v_mov_b32_e64 v106, v7
    v_perm_b32 v7, v111, v107, s100
    v_perm_b32 v111, v111, v107, s101
    v_mov_b32_e64 v107, v7
    v_perm_b32 v7, v84, v80, s100
    v_perm_b32 v84, v84, v80, s101
    v_mov_b32_e64 v80, v7
    v_perm_b32 v7, v85, v81, s100
    v_perm_b32 v85, v85, v81, s101
    v_mov_b32_e64 v81, v7
    v_perm_b32 v7, v86, v82, s100
    v_perm_b32 v86, v86, v82, s101
    v_mov_b32_e64 v82, v7
    v_perm_b32 v7, v87, v83, s100
    v_perm_b32 v87, v87, v83, s101
    v_mov_b32_e64 v83, v7
    v_perm_b32 v7, v116, v112, s100
    v_perm_b32 v116, v116, v112, s101
    v_mov_b32_e64 v112, v7
    v_perm_b32 v7, v117, v113, s100
    v_perm_b32 v117, v117, v113, s101
    v_mov_b32_e64 v113, v7
    v_perm_b32 v7, v118, v114, s100
    v_perm_b32 v118, v118, v114, s101
    v_mov_b32_e64 v114, v7
    v_perm_b32 v7, v119, v115, s100
    v_perm_b32 v119, v119, v115, s101
    v_mov_b32_e64 v115, v7
    v_perm_b32 v7, v92, v88, s100
    v_perm_b32 v92, v92, v88, s101
    v_mov_b32_e64 v88, v7
    v_perm_b32 v7, v93, v89, s100
    v_perm_b32 v93, v93, v89, s101
    v_mov_b32_e64 v89, v7
    v_perm_b32 v7, v94, v90, s100
    v_perm_b32 v94, v94, v90, s101
    v_mov_b32_e64 v90, v7
    v_perm_b32 v7, v95, v91, s100
    v_perm_b32 v95, v95, v91, s101
    v_mov_b32_e64 v91, v7
    v_perm_b32 v7, v124, v120, s100
    v_perm_b32 v124, v124, v120, s101
    v_mov_b32_e64 v120, v7
    v_perm_b32 v7, v125, v121, s100
    v_perm_b32 v125, v125, v121, s101
    v_mov_b32_e64 v121, v7
    v_perm_b32 v7, v126, v122, s100
    v_perm_b32 v126, v126, v122, s101
    v_mov_b32_e64 v122, v7
    v_perm_b32 v7, v127, v123, s100
    v_perm_b32 v127, v127, v123, s101
    v_mov_b32_e64 v123, v7
    v_perm_b32 v7, v132, v128, s100
    v_perm_b32 v132, v132, v128, s101
    v_mov_b32_e64 v128, v7
    v_perm_b32 v7, v133, v129, s100
    v_perm_b32 v133, v133, v129, s101
    v_mov_b32_e64 v129, v7
    v_perm_b32 v7, v134, v130, s100
    v_perm_b32 v134, v134, v130, s101
    v_mov_b32_e64 v130, v7
    v_perm_b32 v7, v135, v131, s100
    v_perm_b32 v135, v135, v131, s101
    v_mov_b32 v131, v7
    v_lshrrev_b32 v8, 3, v2
    v_and_b32 v9, 7, v2
    v_lshlrev_b32 v10, 4, v9
    v_lshl_add_u32 v11, v8, 13, v10
    v_and_b32 v12, 15, v2
    v_lshlrev_b32 v12, 13, v12
    v_lshl_add_u32 v13, v8, 9, v10
    v_lshl_add_u32 v14, v9, 3, v8
    s_lshl_b32 s80, s74, 2
    s_add_u32 s80, s80, s76
    s_lshl_b32 s78, s80, 9
    s_add_u32 s78, s78, 524288
    s_add_u32 s79, s78, 65536
    s_add_u32 s81, s73, s76
    s_and_b32 s81, s81, 3
    s_andn2_b32 s100, s73, 3
    s_or_b32 s81, s81, s100
    s_lshl_b32 s81, s81, 13
    s_lshl_b32 s80, s80, 9
    s_add_u32 s80, s80, s81
    s_add_u32 s80, s80, 655360
    s_lshl_b32 s81, s73, 13
    s_add_u32 s81, s81, 655360
    s_barrier
    buffer_load_dwordx4 v[56:59], v4, s[36:39], s94 offen sc1
    s_mov_b32 s100, 4096
    buffer_load_dwordx4 v[136:139], v245, s[56:59], s100 offen nt
    s_mov_b32 s100, 6144
    buffer_load_dwordx4 v[140:143], v245, s[56:59], s100 offen nt
    s_mov_b32 s100, 8192
    buffer_load_dwordx4 v[144:147], v245, s[56:59], s100 offen nt
    s_mov_b32 s100, 10240
    buffer_load_dwordx4 v[148:151], v245, s[56:59], s100 offen nt
    s_barrier
    s_waitcnt vmcnt(0)
    s_mov_b32 s100, 0x05040100
    s_mov_b32 s101, 0x07060302
    v_perm_b32 v7, v140, v136, s100
    v_perm_b32 v140, v140, v136, s101
    v_mov_b32_e64 v136, v7
    v_perm_b32 v7, v141, v137, s100
    v_perm_b32 v141, v141, v137, s101
    v_mov_b32_e64 v137, v7
    v_perm_b32 v7, v142, v138, s100
    v_perm_b32 v142, v142, v138, s101
    v_mov_b32_e64 v138, v7
    v_perm_b32 v7, v143, v139, s100
    v_perm_b32 v143, v143, v139, s101
    v_mov_b32_e64 v139, v7
    v_perm_b32 v7, v148, v144, s100
    v_perm_b32 v148, v148, v144, s101
    v_mov_b32_e64 v144, v7
    v_perm_b32 v7, v149, v145, s100
    v_perm_b32 v149, v149, v145, s101
    v_mov_b32_e64 v145, v7
    v_perm_b32 v7, v150, v146, s100
    v_perm_b32 v150, v150, v146, s101
    v_mov_b32_e64 v146, v7
    v_perm_b32 v7, v151, v147, s100
    v_perm_b32 v151, v151, v147, s101
    v_mov_b32 v147, v7
    s_barrier
    s_mov_b32 s100, 12288
    buffer_load_dwordx4 v[152:155], v245, s[56:59], s100 offen nt
    s_mov_b32 s100, 14336
    buffer_load_dwordx4 v[156:159], v245, s[56:59], s100 offen nt
    s_sleep 14
    s_mov_b64 exec, 0xffff
    s_mov_b32 s85, 0
Lspin_48:
    s_add_u32 s85, s85, 1
    s_cmp_gt_u32 s85, 400000
    s_cbranch_scc1 L_end
    buffer_load_dwordx2 v[24:25], v12, s[36:39], s78 offen offset:128 sc1
    s_waitcnt vmcnt(0)
    v_cmp_ne_u32_e64 vcc, s75, v25
    s_cbranch_vccnz Lspin_48
    v_max_f32_dpp v24, v24, v24 row_ror:8 row_mask:0xf bank_mask:0xf
    s_nop 1
    v_max_f32_dpp v24, v24, v24 row_ror:4 row_mask:0xf bank_mask:0xf
    s_nop 1
    v_max_f32_dpp v24, v24, v24 row_ror:2 row_mask:0xf bank_mask:0xf
    s_nop 1
    v_max_f32_dpp v24, v24, v24 row_ror:1 row_mask:0xf bank_mask:0xf
    s_nop 0
    v_readfirstlane_b32 s97, v24
    s_mov_b64 exec, -1
    s_nop 0
    v_mov_b32 v24, s97
    s_cmp_ge_u32 s73, 56
    s_cbranch_scc1 L_red
    s_bfe_u32 s79, s97, 0x40007
    s_lshl_b32 s79, s79, 13
    s_add_u32 s78, s78, s79
    v_lshlrev_b32_e64 v25, 4, v8
    s_mov_b32 s85, 0
Lspin_49:
    s_add_u32 s85, s85, 1
    s_cmp_gt_u32 s85, 400000
    s_cbranch_scc1 L_end
    buffer_load_dwordx4 v[20:23], v25, s[36:39], s78 offen sc1
    v_mov_b32 v26, 163360
    ds_write_b32 v26, v24
    v_lshlrev_b32_e64 v15, 3, v14
    s_waitcnt vmcnt(0) lgkmcnt(0)
    v_max3_u32 v16, v20, v21, v22
    v_max_u32 v16, v16, v23
    v_cmp_eq_u32_e64 vcc, -1, v16
    s_cbranch_vccnz Lspin_49
    v_dot2_f32_bf16 v28, v64, v20, 0
    v_dot2_f32_bf16 v29, v68, v20, 0
    v_dot2_f32_bf16 v30, v65, v20, 0
    v_dot2_f32_bf16 v31, v69, v20, 0
    v_dot2_f32_bf16 v32, v66, v20, 0
    v_dot2_f32_bf16 v33, v70, v20, 0
    v_dot2_f32_bf16 v34, v67, v20, 0
    v_dot2_f32_bf16 v35, v71, v20, 0
    v_dot2_f32_bf16 v28, v72, v21, v28
    v_dot2_f32_bf16 v29, v76, v21, v29
    v_dot2_f32_bf16 v30, v73, v21, v30
    v_dot2_f32_bf16 v31, v77, v21, v31
    v_dot2_f32_bf16 v32, v74, v21, v32
    v_dot2_f32_bf16 v33, v78, v21, v33
    v_dot2_f32_bf16 v34, v75, v21, v34
    v_dot2_f32_bf16 v35, v79, v21, v35
    v_dot2_f32_bf16 v28, v80, v22, v28
    v_dot2_f32_bf16 v29, v84, v22, v29
    v_dot2_f32_bf16 v30, v81, v22, v30
    v_dot2_f32_bf16 v31, v85, v22, v31
    v_dot2_f32_bf16 v32, v82, v22, v32
    v_dot2_f32_bf16 v33, v86, v22, v33
    v_dot2_f32_bf16 v34, v83, v22, v34
    v_dot2_f32_bf16 v35, v87, v22, v35
    v_dot2_f32_bf16 v28, v88, v23, v28
    v_dot2_f32_bf16 v29, v92, v23, v29
    v_dot2_f32_bf16 v30, v89, v23, v30
    v_dot2_f32_bf16 v31, v93, v23, v31
    v_dot2_f32_bf16 v32, v90, v23, v32
    v_dot2_f32_bf16 v33, v94, v23, v33
    v_dot2_f32_bf16 v34, v91, v23, v34
    v_dot2_f32_bf16 v35, v95, v23, v35
    v_dot2_f32_bf16 v36, v96, v20, 0
    v_dot2_f32_bf16 v37, v100, v20, 0
    v_dot2_f32_bf16 v38, v97, v20, 0
    v_dot2_f32_bf16 v39, v101, v20, 0
    v_dot2_f32_bf16 v40, v98, v20, 0
    v_dot2_f32_bf16 v41, v102, v20, 0
    v_dot2_f32_bf16 v42, v99, v20, 0
    v_dot2_f32_bf16 v43, v103, v20, 0
    v_dot2_f32_bf16 v36, v104, v21, v36
    v_dot2_f32_bf16 v37, v108, v21, v37
    v_dot2_f32_bf16 v38, v105, v21, v38
    v_dot2_f32_bf16 v39, v109, v21, v39
    v_dot2_f32_bf16 v40, v106, v21, v40
    v_dot2_f32_bf16 v41, v110, v21, v41
    v_dot2_f32_bf16 v42, v107, v21, v42
    v_dot2_f32_bf16 v43, v111, v21, v43
    v_dot2_f32_bf16 v36, v112, v22, v36
    v_dot2_f32_bf16 v37, v116, v22, v37
    v_dot2_f32_bf16 v38, v113, v22, v38
    v_dot2_f32_bf16 v39, v117, v22, v39
    v_dot2_f32_bf16 v40, v114, v22, v40
    v_dot2_f32_bf16 v41, v118, v22, v41
    v_dot2_f32_bf16 v42, v115, v22, v42
    v_dot2_f32_bf16 v43, v119, v22, v43
    v_dot2_f32_bf16 v36, v120, v23, v36
    v_dot2_f32_bf16 v37, v124, v23, v37
    v_dot2_f32_bf16 v38, v121, v23, v38
    v_dot2_f32_bf16 v39, v125, v23, v39
    v_dot2_f32_bf16 v40, v122, v23, v40
    v_dot2_f32_bf16 v41, v126, v23, v41
    v_dot2_f32_bf16 v42, v123, v23, v42
    v_dot2_f32_bf16 v43, v127, v23, v43
    v_permlane32_swap_b32 v28, v32
    v_permlane32_swap_b32 v29, v33
    v_permlane32_swap_b32 v30, v34
    v_permlane32_swap_b32 v31, v35
    v_pk_add_f32 v[28:29], v[28:29], v[32:33]
    v_pk_add_f32 v[30:31], v[30:31], v[34:35]
    s_nop 1
    v_permlane16_swap_b32 v28, v30
    v_permlane16_swap_b32_e64 v29, v31
    v_pk_add_f32 v[28:29], v[28:29], v[30:31]
    s_nop 1
    v_add_f32_dpp v44, v28, v28 row_ror:8 row_mask:0xf bank_mask:0x3
    s_nop 1
    v_add_f32_dpp v44, v29, v29 row_ror:8 row_mask:0xf bank_mask:0xc
    v_permlane32_swap_b32 v36, v40
    v_permlane32_swap_b32 v37, v41
    v_permlane32_swap_b32 v38, v42
    v_permlane32_swap_b32 v39, v43
    v_pk_add_f32 v[36:37], v[36:37], v[40:41]
    v_pk_add_f32 v[38:39], v[38:39], v[42:43]
    s_nop 1
    v_permlane16_swap_b32 v36, v38
    v_permlane16_swap_b32_e64 v37, v39
    v_pk_add_f32 v[36:37], v[36:37], v[38:39]
    s_nop 1
    v_add_f32_dpp v45, v36, v36 row_ror:8 row_mask:0xf bank_mask:0x3
    s_nop 1
    v_add_f32_dpp v45, v37, v37 row_ror:8 row_mask:0xf bank_mask:0xc
    s_bitcmp1_b32 s99, 0
    s_cbranch_scc1 Lls_50
    buffer_store_dwordx2 v[44:45], v15, s[36:39], s80 offen sc1
    s_branch Lle_51
Lls_50:
    buffer_store_dwordx2 v[44:45], v15, s[36:39], s80 offen
Lle_51:
    s_barrier
    s_lshl_b32 s78, s76, 7
    s_add_u32 s78, s78, s81
    s_add_u32 s79, s78, 4096
    v_lshrrev_b32_e64 v26, 5, v2
    v_lshl_add_u32 v26, v9, 1, v26
    s_lshl_b32 s80, s76, 5
    s_add_u32 s80, s80, 163456
    v_lshl_add_u32 v26, v26, 1, s80
    v_lshlrev_b32 v27, 4, v8
    v_add_u32 v27, 163456, v27
    v_lshlrev_b32 v15, 2, v14
    s_mul_i32 s80, s74, 56
    s_add_u32 s80, s80, s73
    s_lshl_b32 s80, s80, 10
    s_lshl_b32 s82, s76, 8
    s_add_u32 s80, s80, s82
    s_add_u32 s80, s80, 1114112
    s_waitcnt vmcnt(0)
    s_mov_b32 s100, 0x05040100
    s_mov_b32 s101, 0x07060302
    v_perm_b32 v7, v156, v152, s100
    v_perm_b32 v156, v156, v152, s101
    v_mov_b32 v152, v7
    v_perm_b32 v7, v157, v153, s100
    v_perm_b32 v157, v157, v153, s101
    v_mov_b32_e64 v153, v7
    v_perm_b32 v7, v158, v154, s100
    v_perm_b32 v158, v158, v154, s101
    v_mov_b32_e64 v154, v7
    v_perm_b32 v7, v159, v155, s100
    v_perm_b32 v159, v159, v155, s101
    v_mov_b32_e64 v155, v7
    s_mov_b32 s85, 0
Lspin_52:
    s_add_u32 s85, s85, 1
    s_cmp_gt_u32 s85, 400000
    s_cbranch_scc1 L_end
    buffer_load_dwordx4 v[16:19], v13, s[36:39], s78 offen sc1
    buffer_load_dwordx4 v[20:23], v13, s[36:39], s79 offen sc1
    s_waitcnt vmcnt(0)
    v_max3_u32 v25, v16, v18, v20
    v_max_u32 v25, v25, v22
    v_cmp_eq_u32_e64 vcc, -1, v25
    s_cbranch_vccnz Lspin_52
    v_pk_add_f32 v[16:17], v[16:17], v[20:21]
    v_pk_add_f32 v[18:19], v[18:19], v[22:23]
    s_nop 1
    v_permlane32_swap_b32 v16, v18
    v_permlane32_swap_b32_e64 v17, v19
    v_pk_add_f32 v[16:17], v[16:17], v[18:19]
    v_mov_b32 v18, v16
    v_mov_b32 v19, v17
    s_nop 0
    v_permlane16_swap_b32 v16, v18
    v_permlane16_swap_b32_e64 v17, v19
    v_pk_add_f32 v[16:17], v[16:17], v[18:19]
    s_nop 1
    s_nop 0
    v_add_f32_dpp v16, v16, v16 row_ror:8 row_mask:0xf bank_mask:0xf
    v_add_f32_dpp v17, v17, v17 row_ror:8 row_mask:0xf bank_mask:0xf
    v_cvt_pk_bf16_f32 v16, v16, v16
    v_and_b32 v16, 0xffff0000, v16
    v_cvt_pk_bf16_f32 v17, v17, v17
    v_and_b32 v17, 0xffff0000, v17
    v_mul_f32 v18, 0xbfb8aa3b, v16
    v_exp_f32 v18, v18
    s_nop 0
    v_add_f32 v18, 1.0, v18
    v_rcp_f32 v18, v18
    s_nop 0
    v_mul_f32 v16, v16, v18
    v_cvt_pk_bf16_f32 v16, v16, v16
    v_and_b32 v16, 0xffff0000, v16
    v_mul_f32_e64 v16, v16, v17
    v_cvt_pk_bf16_f32 v16, v16, v16
    ds_write_b16 v26, v16
    s_waitcnt lgkmcnt(0)
    s_barrier
    ds_read_b128 v[20:23], v27
    s_waitcnt lgkmcnt(0)
    s_nop 0
    v_dot2_f32_bf16 v28, v128, v20, 0
    v_dot2_f32_bf16 v29, v132, v20, 0
    v_dot2_f32_bf16 v30, v129, v20, 0
    v_dot2_f32_bf16 v31, v133, v20, 0
    v_dot2_f32_bf16 v32, v130, v20, 0
    v_dot2_f32_bf16 v33, v134, v20, 0
    v_dot2_f32_bf16 v34, v131, v20, 0
    v_dot2_f32_bf16 v35, v135, v20, 0
    v_dot2_f32_bf16 v28, v136, v21, v28
    v_dot2_f32_bf16 v29, v140, v21, v29
    v_dot2_f32_bf16 v30, v137, v21, v30
    v_dot2_f32_bf16 v31, v141, v21, v31
    v_dot2_f32_bf16 v32, v138, v21, v32
    v_dot2_f32_bf16 v33, v142, v21, v33
    v_dot2_f32_bf16 v34, v139, v21, v34
    v_dot2_f32_bf16 v35, v143, v21, v35
    v_dot2_f32_bf16 v28, v144, v22, v28
    v_dot2_f32_bf16 v29, v148, v22, v29
    v_dot2_f32_bf16 v30, v145, v22, v30
    v_dot2_f32_bf16 v31, v149, v22, v31
    v_dot2_f32_bf16 v32, v146, v22, v32
    v_dot2_f32_bf16 v33, v150, v22, v33
    v_dot2_f32_bf16 v34, v147, v22, v34
    v_dot2_f32_bf16 v35, v151, v22, v35
    v_dot2_f32_bf16 v28, v152, v23, v28
    v_dot2_f32_bf16 v29, v156, v23, v29
    v_dot2_f32_bf16 v30, v153, v23, v30
    v_dot2_f32_bf16 v31, v157, v23, v31
    v_dot2_f32_bf16 v32, v154, v23, v32
    v_dot2_f32_bf16 v33, v158, v23, v33
    v_dot2_f32_bf16 v34, v155, v23, v34
    v_dot2_f32_bf16 v35, v159, v23, v35
    v_permlane32_swap_b32 v28, v32
    v_permlane32_swap_b32 v29, v33
    v_permlane32_swap_b32 v30, v34
    v_permlane32_swap_b32 v31, v35
    v_pk_add_f32 v[28:29], v[28:29], v[32:33]
    v_pk_add_f32 v[30:31], v[30:31], v[34:35]
    s_nop 1
    v_permlane16_swap_b32 v28, v30
    v_permlane16_swap_b32_e64 v29, v31
    v_pk_add_f32 v[28:29], v[28:29], v[30:31]
    s_nop 1
    v_add_f32_dpp v44, v28, v28 row_ror:8 row_mask:0xf bank_mask:0x3
    s_nop 1
    v_add_f32_dpp v44, v29, v29 row_ror:8 row_mask:0xf bank_mask:0xc
    buffer_store_dword v44, v15, s[36:39], s80 offen sc1
    s_barrier
    s_branch L_fin
L_red:
    v_mov_b32 v26, 163360
    ds_write_b32 v26, v24
    s_waitcnt lgkmcnt(0)
    s_barrier
    s_barrier
    s_barrier
    s_cmp_lg_u32 s76, 0
    s_cbranch_scc1 L_fin
    s_sub_u32 s83, s0, 224
    v_lshrrev_b32_e64 v14, 4, v2
    v_lshl_add_u32 v14, v9, 2, v14
    v_lshlrev_b32 v15, 2, v14
    v_lshlrev_b32 v14, 1, v14
    s_bfe_u32 s78, s97, 0x40007
    s_lshl_b32 s78, s78, 13
    s_lshr_b32 s79, s83, 1
    s_lshl_b32 s79, s79, 9
    s_add_u32 s78, s78, s79
    s_and_b32 s79, s83, 1
    s_lshl_b32 s79, s79, 7
    s_add_u32 s78, s78, s79
    s_add_u32 s78, s78, 524544
    s_mov_b32 s85, 0
Lspin_53:
    s_add_u32 s85, s85, 1
    s_cmp_gt_u32 s85, 400000
    s_cbranch_scc1 L_end
    buffer_load_dword v46, v15, s[36:39], s78 offen sc1
    s_waitcnt vmcnt(0)
    v_cmp_eq_u32_e64 vcc, -1, v46
    s_cbranch_vccnz Lspin_53
    v_cvt_pk_bf16_f32 v47, v24, v24
    v_and_b32 v47, 0xffff0000, v47
    v_mul_f32 v47, 0xbfb8aa3b, v47
    v_exp_f32 v47, v47
    s_nop 0
    v_add_f32 v47, 1.0, v47
    v_rcp_f32_e64 v47, v47
    s_nop 0
    v_cvt_pk_bf16_f32 v47, v47, v47
    v_and_b32 v47, 0xffff0000, v47
    v_lshl_add_u32 v13, v8, 10, v10
    s_lshr_b32 s78, s83, 3
    s_mul_i32 s78, s78, 57344
    s_and_b32 s79, s83, 7
    s_lshl_b32 s79, s79, 7
    s_add_u32 s78, s78, s79
    s_add_u32 s78, s78, 1114112
    s_and_b32 s80, s97, 0x7ff
    s_lshl_b32 s80, s80, 11
    s_lshl_b32 s79, s83, 6
    s_add_u32 s80, s80, s79
    s_sleep 24
    s_mov_b32 s85, 0
Lspin_54:
    s_add_u32 s85, s85, 1
    s_cmp_gt_u32 s85, 400000
    s_cbranch_scc1 L_end
    s_add_u32 s79, s78, 0
    buffer_load_dwordx4 v[16:19], v13, s[36:39], s79 offen sc1
    s_add_u32 s79, s78, 8192
    buffer_load_dwordx4 v[20:23], v13, s[36:39], s79 offen sc1
    s_add_u32 s79, s78, 16384
    buffer_load_dwordx4 v[24:27], v13, s[36:39], s79 offen sc1
    s_add_u32 s79, s78, 24576
    buffer_load_dwordx4 v[28:31], v13, s[36:39], s79 offen sc1
    s_add_u32 s79, s78, 32768
    buffer_load_dwordx4 v[32:35], v13, s[36:39], s79 offen sc1
    s_add_u32 s79, s78, 40960
    buffer_load_dwordx4 v[36:39], v13, s[36:39], s79 offen sc1
    s_add_u32 s79, s78, 49152
    buffer_load_dwordx4 v[40:43], v13, s[36:39], s79 offen sc1
    s_waitcnt vmcnt(0)
    v_max_u32 v48, v16, v17
    v_max_u32_e64 v49, v18, v19
    v_max3_u32 v48, v48, v20, v21
    v_max3_u32 v49, v49, v22, v23
    v_max3_u32 v48, v48, v24, v25
    v_max3_u32 v49, v49, v26, v27
    v_max3_u32 v48, v48, v28, v29
    v_max3_u32 v49, v49, v30, v31
    v_max3_u32 v48, v48, v32, v33
    v_max3_u32 v49, v49, v34, v35
    v_max3_u32 v48, v48, v36, v37
    v_max3_u32 v49, v49, v38, v39
    v_max3_u32 v48, v48, v40, v41
    v_max3_u32 v49, v49, v42, v43
    v_max_u32 v48, v48, v49
    v_cmp_eq_u32_e64 vcc, -1, v48
    s_cbranch_vccnz Lspin_54
    v_pk_add_f32 v[16:17], v[16:17], v[20:21]
    v_pk_add_f32 v[24:25], v[24:25], v[28:29]
    v_pk_add_f32 v[32:33], v[32:33], v[36:37]
    v_pk_add_f32 v[16:17], v[16:17], v[24:25]
    v_pk_add_f32 v[32:33], v[32:33], v[40:41]
    v_pk_add_f32 v[16:17], v[16:17], v[32:33]
    v_pk_add_f32 v[18:19], v[18:19], v[22:23]
    v_pk_add_f32 v[26:27], v[26:27], v[30:31]
    v_pk_add_f32 v[34:35], v[34:35], v[38:39]
    v_pk_add_f32 v[18:19], v[18:19], v[26:27]
    v_pk_add_f32 v[34:35], v[34:35], v[42:43]
    v_pk_add_f32 v[18:19], v[18:19], v[34:35]
    s_nop 1
    v_permlane32_swap_b32 v16, v18
    v_permlane32_swap_b32_e64 v17, v19
    v_pk_add_f32 v[16:17], v[16:17], v[18:19]
    s_nop 1
    v_permlane16_swap_b32 v16, v17
    v_add_f32 v16, v16, v17
    s_nop 1
    v_add_f32_dpp v16, v16, v16 row_ror:8 row_mask:0xf bank_mask:0xf
    v_cvt_pk_bf16_f32 v16, v16, v16
    v_and_b32 v16, 0xffff0000, v16
    v_mul_f32_e64 v16, v16, v47
    v_cvt_pk_bf16_f32 v16, v16, v16
    v_and_b32 v16, 0xffff0000, v16
    v_add_f32_e64 v16, v16, v46
    v_cvt_pk_bf16_f32 v16, v16, v16
    s_mov_b32 exec_lo, 0x00ff00ff
    s_mov_b32 exec_hi, 0x00ff00ff
    buffer_store_short v16, v14, s[44:47], s80 offen
    s_mov_b64 exec, -1
    s_cmp_lg_u32 s0, 224
    s_cbranch_scc1 Lep_55
    s_cmp_lg_u32 s76, 0
    s_cbranch_scc1 Lep_55
    v_mov_b32 v196, s75
    v_mov_b32_e64 v197, 0
    s_mov_b64 exec, 1
    buffer_store_dword v196, v197, s[36:39], 0 offen sc1
    s_mov_b64 exec, -1
Lep_55:
    s_branch L_fin
    .p2align 3
L_M:
    s_setprio 1
    s_and_b32 s78, s2, 7
    s_lshr_b32 s79, s2, 3
    s_lshl_b32 s71, s78, 1
    s_and_b32 s72, s79, 1
    s_add_u32 s71, s71, s72
    s_lshr_b32 s72, s79, 1
    s_cmp_gt_u32 s70, 3
    s_cselect_b32 s78, 1, 0
    s_cmp_gt_u32 s70, 11
    s_cselect_b32 s78, 2, s78
    s_sub_u32 s78, s70, s78
    s_cmp_eq_u32 s70, 3
    s_cselect_b32 s78, 14, s78
    s_cmp_eq_u32 s70, 11
    s_cselect_b32 s78, 15, s78
    s_lshl_b32 s0, s78, 4
    s_add_u32 s0, s0, s69
    s_lshr_b32 s73, s0, 2
    s_and_b32 s74, s0, 3
    s_lshl_b32 s77, s70, 4
    s_add_u32 s77, s77, s69
    s_and_b32 s80, s76, 1
    s_lshr_b32 s81, s76, 1
    v_and_b32 v8, 15, v2
    v_lshrrev_b32 v9, 4, v2
    v_lshrrev_b32 v10, 1, v8
    s_lshl_b32 s78, s80, 13
    s_add_u32 s78, s78, 118784
    v_lshlrev_b32 v11, 7, v8
    v_add_u32 v11, s78, v11
    v_add_u32 v12, 0, v9
    v_xor_b32 v12, v12, v10
    v_lshl_add_u32 v4, v12, 4, v11
    v_add_u32 v12, 4, v9
    v_xor_b32 v12, v12, v10
    v_lshl_add_u32 v5, v12, 4, v11
    v_bfe_u32 v10, v2, 2, 2
    v_and_b32_e64 v11, 3, v2
    v_lshl_add_u32 v12, v9, 3, v10
    v_lshlrev_b32_e64 v12, 7, v12
    v_lshl_add_u32 v12, v11, 3, v12
    v_add_u32 v12, 135168, v12
    v_lshrrev_b32 v13, 1, v10
    v_and_b32 v14, 1, v9
    v_lshl_add_u32 v13, v14, 1, v13
    s_lshl_b32 s78, s81, 1
    s_add_u32 s79, s78, 0
    v_xor_b32_e64 v14, s79, v13
    v_lshl_add_u32 v6, v14, 5, v12
    s_add_u32 s79, s78, 1
    v_xor_b32 v14, s79, v13
    v_lshl_add_u32 v7, v14, 5, v12
    v_lshrrev_b32_e64 v13, 5, v2
    v_lshl_add_u32 v13, v13, 3, v10
    v_lshlrev_b32 v13, 6, v13
    v_and_b32 v14, 1, v9
    v_lshl_add_u32 v13, v14, 5, v13
    v_lshl_add_u32 v13, v11, 3, v13
    s_lshl_b32 s78, s81, 11
    s_add_u32 s78, s78, 159744
    v_add_u32 v15, s78, v13
    v_mov_b64 v[128:129], 0
    v_mov_b64 v[130:131], 0
    v_mov_b64 v[132:133], 0
    v_mov_b64 v[134:135], 0
    v_mov_b64 v[136:137], 0
    v_mov_b64 v[138:139], 0
    v_mov_b64 v[140:141], 0
    v_mov_b64 v[142:143], 0
    v_mov_b64 v[144:145], 0
    v_mov_b64 v[146:147], 0
    v_mov_b64 v[148:149], 0
    v_mov_b64 v[150:151], 0
    v_mov_b64 v[152:153], 0
    v_mov_b64 v[154:155], 0
    v_mov_b64 v[156:157], 0
    v_mov_b64 v[158:159], 0
    v_mov_b64 v[160:161], 0
    v_mov_b64 v[162:163], 0
    v_mov_b64 v[164:165], 0
    v_mov_b64 v[166:167], 0
    v_mov_b64 v[168:169], 0
    v_mov_b64 v[170:171], 0
    v_mov_b64 v[172:173], 0
    v_mov_b64 v[174:175], 0
    v_mov_b64 v[176:177], 0
    v_mov_b64 v[178:179], 0
    v_mov_b64 v[180:181], 0
    v_mov_b64 v[182:183], 0
    v_mov_b64 v[184:185], 0
    v_mov_b64 v[186:187], 0
    v_mov_b64 v[188:189], 0
    v_mov_b64 v[190:191], 0
    v_mov_b64 v[192:193], 0
    v_mov_b64 v[194:195], 0
    v_mov_b64 v[196:197], 0
    v_mov_b64 v[198:199], 0
    v_mov_b64 v[200:201], 0
    v_mov_b64 v[202:203], 0
    v_mov_b64 v[204:205], 0
    v_mov_b64 v[206:207], 0
    v_mov_b64 v[208:209], 0
    v_mov_b64 v[210:211], 0
    v_mov_b64 v[212:213], 0
    v_mov_b64 v[214:215], 0
    v_mov_b64 v[216:217], 0
    v_mov_b64 v[218:219], 0
    v_mov_b64 v[220:221], 0
    v_mov_b64 v[222:223], 0
    v_mov_b64 v[104:105], 0
    v_mov_b64 v[106:107], 0
    v_mov_b64 v[108:109], 0
    v_mov_b64 v[110:111], 0
    v_and_b32 v14, 31, v2
    v_lshrrev_b32_e64 v13, 5, v2
    s_lshl_b32 s78, s81, 14
    s_lshl_b32 s79, s80, 13
    s_add_u32 s78, s78, s79
    s_add_u32 s78, s78, 110592
    v_lshl_add_u32 v12, v14, 7, s78
    v_and_b32 v14, 7, v14
    v_xor_b32 v14, v14, v13
    v_xor_b32_e64 v13, 0, v14
    v_lshl_add_u32 v112, v13, 4, v12
    v_xor_b32_e64 v13, 2, v14
    v_lshl_add_u32 v113, v13, 4, v12
    v_xor_b32_e64 v13, 4, v14
    v_lshl_add_u32 v114, v13, 4, v12
    v_xor_b32_e64 v13, 6, v14
    v_lshl_add_u32 v115, v13, 4, v12
    s_add_u32 s79, s79, 143360
    v_lshl_add_u32 v12, v8, 7, s79
    s_lshl_b32 s78, s81, 2
    v_add_u32 v14, s78, v9
    v_and_b32 v13, 7, v8
    v_xor_b32 v14, v14, v13
    v_lshl_add_u32 v116, v14, 4, v12
    s_lshl_b32 s78, s80, 6
    v_add_u32 v10, s78, v8
    v_lshlrev_b32_e64 v11, 3, v10
    v_add_u32 v11, 159744, v11
    s_lshl_b32 s79, s81, 5
    v_add_u32 v12, s79, v8
    v_lshlrev_b32_e64 v12, 3, v12
    v_add_u32 v12, 160768, v12
    v_lshlrev_b32_e64 v13, 2, v10
    v_add_u32 v13, 162304, v13
    v_and_b32 v14, 31, v2
    v_add_u32 v14, s78, v14
    v_lshlrev_b32_e64 v14, 2, v14
    v_add_u32 v14, 162304, v14
    s_waitcnt lgkmcnt(0)
    s_load_dword s75, s[26:27], 0
    s_mov_b32 s36, s26
    s_and_b32 s37, s27, 0xffff
    s_mov_b32 s38, 0x10000000
    s_mov_b32 s39, 0x20000
    s_mov_b32 s64, s14
    s_and_b32 s65, s15, 0xffff
    s_mov_b32 s66, 0x800
    s_mov_b32 s67, 0x20000
    s_mov_b32 s44, s22
    s_and_b32 s45, s23, 0xffff
    s_mov_b32 s46, 0x400000
    s_mov_b32 s47, 0x20000
    s_lshl_b32 s78, s72, 7
    buffer_load_dword v118, off, s[64:67], s78
    s_waitcnt lgkmcnt(0)
    s_mul_i32 s75, s75, 0x9E3779B1
    s_add_u32 s75, s75, 0x7F4A7C15
    s_mov_b32 s84, 0
    s_mov_b32 s82, 2
    s_mov_b32 s83, 0xfffec000
    s_barrier
    s_nop 0
    ds_read_b128 v[16:19], v4 offset:0
    ds_read_b64_tr_b16 v[40:41], v6 offset:8192
    ds_read_b64_tr_b16 v[42:43], v6 offset:8704
    ds_read_b128 v[20:23], v4 offset:2048
    ds_read_b128 v[24:27], v4 offset:4096
    ds_read_b128 v[28:31], v4 offset:6144
    ds_read_b64_tr_b16 v[44:45], v7 offset:8192
    ds_read_b64_tr_b16 v[46:47], v7 offset:8704
    ds_read_b64_tr_b16 v[48:49], v6 offset:16384
    ds_read_b64_tr_b16 v[50:51], v6 offset:16896
    ds_read_b64_tr_b16 v[52:53], v7 offset:16384
    ds_read_b64_tr_b16 v[54:55], v7 offset:16896
    ds_read_b64_tr_b16 v[32:33], v6 offset:0
    ds_read_b64_tr_b16 v[34:35], v6 offset:512
    ds_read_b64_tr_b16 v[36:37], v7 offset:0
    ds_read_b64_tr_b16 v[38:39], v7 offset:512
    ds_read_b64_tr_b16 v[96:97], v15 offset:0
    ds_read_b64_tr_b16 v[98:99], v15 offset:1024
    ds_read_b64_tr_b16 v[100:101], v15 offset:256
    ds_read_b64_tr_b16 v[102:103], v15 offset:1280
    .p2align 3
L_Mloop:
    s_waitcnt lgkmcnt(0)
    s_nop 0
    v_mfma_f32_16x16x32_bf16 v[160:163], v[40:43], v[16:19], v[160:163]
    ds_read_b128 v[56:59], v5 offset:0
    v_mfma_f32_16x16x32_bf16 v[164:167], v[40:43], v[20:23], v[164:167]
    ds_read_b64_tr_b16 v[80:81], v6 offset:12288
    v_mfma_f32_16x16x32_bf16 v[168:171], v[40:43], v[24:27], v[168:171]
    ds_read_b64_tr_b16 v[82:83], v6 offset:12800
    v_mfma_f32_16x16x32_bf16 v[172:175], v[40:43], v[28:31], v[172:175]
    ds_read_b128 v[60:63], v5 offset:2048
    v_mfma_f32_16x16x32_bf16 v[188:191], v[44:47], v[28:31], v[188:191]
    ds_read_b128 v[64:67], v5 offset:4096
    v_mfma_f32_16x16x32_bf16 v[184:187], v[44:47], v[24:27], v[184:187]
    ds_read_b128 v[68:71], v5 offset:6144
    v_mfma_f32_16x16x32_bf16 v[180:183], v[44:47], v[20:23], v[180:183]
    ds_read_b64_tr_b16 v[84:85], v7 offset:12288
    v_mfma_f32_16x16x32_bf16 v[176:179], v[44:47], v[16:19], v[176:179]
    ds_read_b64_tr_b16 v[86:87], v7 offset:12800
    v_mfma_f32_16x16x32_bf16 v[192:195], v[48:51], v[16:19], v[192:195]
    ds_read_b64_tr_b16 v[88:89], v6 offset:20480
    v_mfma_f32_16x16x32_bf16 v[196:199], v[48:51], v[20:23], v[196:199]
    ds_read_b64_tr_b16 v[90:91], v6 offset:20992
    v_mfma_f32_16x16x32_bf16 v[200:203], v[48:51], v[24:27], v[200:203]
    ds_read_b64_tr_b16 v[92:93], v7 offset:20480
    v_mfma_f32_16x16x32_bf16 v[204:207], v[48:51], v[28:31], v[204:207]
    ds_read_b64_tr_b16 v[94:95], v7 offset:20992
    v_mfma_f32_16x16x32_bf16 v[220:223], v[52:55], v[28:31], v[220:223]
    ds_read_b64_tr_b16 v[72:73], v6 offset:4096
    v_mfma_f32_16x16x32_bf16 v[216:219], v[52:55], v[24:27], v[216:219]
    ds_read_b64_tr_b16 v[74:75], v6 offset:4608
    v_mfma_f32_16x16x32_bf16 v[212:215], v[52:55], v[20:23], v[212:215]
    ds_read_b64_tr_b16 v[76:77], v7 offset:4096
    v_mfma_f32_16x16x32_bf16 v[208:211], v[52:55], v[16:19], v[208:211]
    ds_read_b64_tr_b16 v[78:79], v7 offset:4608
    v_mfma_f32_16x16x32_bf16 v[128:131], v[32:35], v[16:19], v[128:131]
    s_add_u32 s84, s84, 1
    s_cmp_eq_u32 s82, 2
    s_cselect_b32 s78, s83, 40960
    s_cselect_b32 s82, -1, s82
    s_add_u32 s82, s82, 1
    v_mfma_f32_16x16x32_bf16 v[132:135], v[32:35], v[20:23], v[132:135]
    v_add_u32 v4, s78, v4
    v_add_u32 v5, s78, v5
    v_mfma_f32_16x16x32_bf16 v[136:139], v[32:35], v[24:27], v[136:139]
    v_add_u32 v6, s78, v6
    v_add_u32 v7, s78, v7
    v_mfma_f32_16x16x32_bf16 v[140:143], v[32:35], v[28:31], v[140:143]
    v_mfma_f32_16x16x32_bf16 v[156:159], v[36:39], v[28:31], v[156:159]
    v_mfma_f32_16x16x32_bf16 v[152:155], v[36:39], v[24:27], v[152:155]
    v_mfma_f32_16x16x32_bf16 v[148:151], v[36:39], v[20:23], v[148:151]
    v_mfma_f32_16x16x32_bf16 v[144:147], v[36:39], v[16:19], v[144:147]
    s_waitcnt vmcnt(0) lgkmcnt(0)
    v_mfma_f32_16x16x32_bf16 v[160:163], v[80:83], v[56:59], v[160:163]
    v_mfma_f32_16x16x32_bf16 v[164:167], v[80:83], v[60:63], v[164:167]
    s_barrier
    s_cmp_eq_u32 s84, 16
    s_cbranch_scc1 L_Mtail
    v_mfma_f32_16x16x32_bf16 v[168:171], v[80:83], v[64:67], v[168:171]
    ds_read_b128 v[16:19], v4 offset:0
    v_mfma_f32_16x16x32_bf16 v[172:175], v[80:83], v[68:71], v[172:175]
    ds_read_b64_tr_b16 v[40:41], v6 offset:8192
    v_mfma_f32_16x16x32_bf16 v[188:191], v[84:87], v[68:71], v[188:191]
    ds_read_b64_tr_b16 v[42:43], v6 offset:8704
    v_mfma_f32_16x16x32_bf16 v[184:187], v[84:87], v[64:67], v[184:187]
    ds_read_b128 v[20:23], v4 offset:2048
    v_mfma_f32_16x16x32_bf16 v[180:183], v[84:87], v[60:63], v[180:183]
    ds_read_b128 v[24:27], v4 offset:4096
    v_mfma_f32_16x16x32_bf16 v[176:179], v[84:87], v[56:59], v[176:179]
    ds_read_b128 v[28:31], v4 offset:6144
    v_mfma_f32_16x16x32_bf16 v[192:195], v[88:91], v[56:59], v[192:195]
    ds_read_b64_tr_b16 v[44:45], v7 offset:8192
    v_mfma_f32_16x16x32_bf16 v[196:199], v[88:91], v[60:63], v[196:199]
    ds_read_b64_tr_b16 v[46:47], v7 offset:8704
    v_mfma_f32_16x16x32_bf16 v[200:203], v[88:91], v[64:67], v[200:203]
    ds_read_b64_tr_b16 v[48:49], v6 offset:16384
    v_mfma_f32_16x16x32_bf16 v[204:207], v[88:91], v[68:71], v[204:207]
    ds_read_b64_tr_b16 v[50:51], v6 offset:16896
    v_mfma_f32_16x16x32_bf16 v[220:223], v[92:95], v[68:71], v[220:223]
    ds_read_b64_tr_b16 v[52:53], v7 offset:16384
    v_mfma_f32_16x16x32_bf16 v[216:219], v[92:95], v[64:67], v[216:219]
    ds_read_b64_tr_b16 v[54:55], v7 offset:16896
    v_mfma_f32_16x16x32_bf16 v[212:215], v[92:95], v[60:63], v[212:215]
    ds_read_b64_tr_b16 v[32:33], v6 offset:0
    v_mfma_f32_16x16x32_bf16 v[208:211], v[92:95], v[56:59], v[208:211]
    ds_read_b64_tr_b16 v[34:35], v6 offset:512
    v_mfma_f32_16x16x32_bf16 v[128:131], v[72:75], v[56:59], v[128:131]
    ds_read_b64_tr_b16 v[36:37], v7 offset:0
    v_mfma_f32_16x16x32_bf16 v[132:135], v[72:75], v[60:63], v[132:135]
    ds_read_b64_tr_b16 v[38:39], v7 offset:512
    v_mfma_f32_16x16x32_bf16 v[136:139], v[72:75], v[64:67], v[136:139]
    v_mfma_f32_16x16x32_bf16 v[140:143], v[72:75], v[68:71], v[140:143]
    v_mfma_f32_16x16x32_bf16 v[156:159], v[76:79], v[68:71], v[156:159]
    v_mfma_f32_16x16x32_bf16 v[152:155], v[76:79], v[64:67], v[152:155]
    v_mfma_f32_16x16x32_bf16 v[148:151], v[76:79], v[60:63], v[148:151]
    v_mfma_f32_16x16x32_bf16 v[144:147], v[76:79], v[56:59], v[144:147]
    s_branch L_Mloop
    .p2align 3
L_Mtail:
    s_mov_b64 exec, 0xffff
    ds_read_b64 v[104:105], v11 offset:0
    ds_read_b64 v[106:107], v11 offset:128
    ds_read_b64 v[108:109], v11 offset:256
    ds_read_b64 v[110:111], v11 offset:384
    s_mov_b64 exec, -1
    s_nop 0
    v_mfma_f32_16x16x32_bf16 v[168:171], v[80:83], v[64:67], v[168:171]
    ds_read_b64 v[20:21], v12 offset:512
    v_mfma_f32_16x16x32_bf16 v[172:175], v[80:83], v[68:71], v[172:175]
    ds_read_b64 v[22:23], v12 offset:640
    v_mfma_f32_16x16x32_bf16 v[188:191], v[84:87], v[68:71], v[188:191]
    ds_read_b64 v[24:25], v12 offset:1024
    v_mfma_f32_16x16x32_bf16 v[184:187], v[84:87], v[64:67], v[184:187]
    ds_read_b64 v[26:27], v12 offset:1152
    v_mfma_f32_16x16x32_bf16 v[180:183], v[84:87], v[60:63], v[180:183]
    ds_read_b64 v[16:17], v12 offset:0
    v_mfma_f32_16x16x32_bf16 v[176:179], v[84:87], v[56:59], v[176:179]
    ds_read_b64 v[18:19], v12 offset:128
    v_mfma_f32_16x16x32_bf16 v[192:195], v[88:91], v[56:59], v[192:195]
    ds_read2_b32 v[32:33], v14 offset0:0 offset1:32
    v_mfma_f32_16x16x32_bf16 v[196:199], v[88:91], v[60:63], v[196:199]
    ds_read_b32 v28, v13 offset:0
    v_mfma_f32_16x16x32_bf16 v[200:203], v[88:91], v[64:67], v[200:203]
    ds_read_b32 v30, v13 offset:64
    v_mfma_f32_16x16x32_bf16 v[204:207], v[88:91], v[68:71], v[204:207]
    ds_read_b32 v44, v13 offset:128
    v_mfma_f32_16x16x32_bf16 v[220:223], v[92:95], v[68:71], v[220:223]
    ds_read_b32 v46, v13 offset:192
    v_mfma_f32_16x16x32_bf16 v[216:219], v[92:95], v[64:67], v[216:219]
    v_mfma_f32_16x16x32_bf16 v[212:215], v[92:95], v[60:63], v[212:215]
    v_mfma_f32_16x16x32_bf16 v[208:211], v[92:95], v[56:59], v[208:211]
    s_waitcnt lgkmcnt(0)
    s_nop 0
    v_mfma_f32_16x16x16_bf16 v[160:163], v[20:21], v[104:105], v[160:163]
    v_mfma_f32_16x16x16_bf16 v[176:179], v[22:23], v[104:105], v[176:179]
    v_mfma_f32_16x16x16_bf16 v[164:167], v[20:21], v[106:107], v[164:167]
    v_mfma_f32_16x16x16_bf16 v[180:183], v[22:23], v[106:107], v[180:183]
    v_mfma_f32_16x16x16_bf16 v[168:171], v[20:21], v[108:109], v[168:171]
    v_mfma_f32_16x16x16_bf16 v[184:187], v[22:23], v[108:109], v[184:187]
    v_mfma_f32_16x16x16_bf16 v[172:175], v[20:21], v[110:111], v[172:175]
    v_mfma_f32_16x16x16_bf16 v[188:191], v[22:23], v[110:111], v[188:191]
    v_mul_f32 v34, 0x3fb8aa3b, v32
    v_mul_f32 v48, 0x3fb8aa3b, v33
    v_mfma_f32_16x16x16_bf16 v[192:195], v[24:25], v[104:105], v[192:195]
    v_mfma_f32_16x16x16_bf16 v[208:211], v[26:27], v[104:105], v[208:211]
    v_mfma_f32_16x16x16_bf16 v[196:199], v[24:25], v[106:107], v[196:199]
    v_cvt_pk_bf16_f32 v160, v160, v161
    v_cvt_pk_bf16_f32 v161, v162, v163
    v_cvt_pk_bf16_f32 v162, v176, v177
    v_cvt_pk_bf16_f32 v163, v178, v179
    v_mfma_f32_16x16x16_bf16 v[212:215], v[26:27], v[106:107], v[212:215]
    v_cvt_pk_bf16_f32 v164, v164, v165
    v_cvt_pk_bf16_f32 v165, v166, v167
    v_cvt_pk_bf16_f32 v166, v180, v181
    v_cvt_pk_bf16_f32 v167, v182, v183
    v_mfma_f32_16x16x16_bf16 v[200:203], v[24:25], v[108:109], v[200:203]
    v_cvt_pk_bf16_f32 v168, v168, v169
    v_cvt_pk_bf16_f32 v169, v170, v171
    v_cvt_pk_bf16_f32 v170, v184, v185
    v_cvt_pk_bf16_f32 v171, v186, v187
    v_mfma_f32_16x16x16_bf16 v[216:219], v[26:27], v[108:109], v[216:219]
    v_cvt_pk_bf16_f32 v172, v172, v173
    v_cvt_pk_bf16_f32 v173, v174, v175
    v_cvt_pk_bf16_f32 v174, v188, v189
    v_cvt_pk_bf16_f32 v175, v190, v191
    v_mfma_f32_16x16x16_bf16 v[204:207], v[24:25], v[110:111], v[204:207]
    v_permlane16_swap_b32 v160, v164
    v_permlane16_swap_b32 v161, v165
    v_permlane16_swap_b32 v162, v166
    v_permlane16_swap_b32 v163, v167
    v_mfma_f32_16x16x16_bf16 v[220:223], v[26:27], v[110:111], v[220:223]
    v_permlane16_swap_b32 v168, v172
    v_permlane16_swap_b32 v169, v173
    v_permlane16_swap_b32 v170, v174
    v_permlane16_swap_b32 v171, v175
    v_mfma_f32_32x32x16_bf16 v[224:239], v[96:99], v[160:163], 0
    v_mfma_f32_32x32x16_bf16 v[224:239], v[100:103], v[164:167], v[224:239]
    v_mfma_f32_32x32x16_bf16 v[240:255], v[96:99], v[168:171], 0
    v_mfma_f32_32x32x16_bf16 v[240:255], v[100:103], v[172:175], v[240:255]
    v_pk_mul_f32 v[192:193], v[192:193], v[28:29] op_sel_hi:[1,0]
    v_pk_mul_f32 v[194:195], v[194:195], v[28:29] op_sel_hi:[1,0]
    v_pk_mul_f32 v[208:209], v[208:209], v[28:29] op_sel_hi:[1,0]
    v_pk_mul_f32 v[210:211], v[210:211], v[28:29] op_sel_hi:[1,0]
    v_cvt_pk_bf16_f32 v192, v192, v193
    v_cvt_pk_bf16_f32 v193, v194, v195
    v_cvt_pk_bf16_f32 v194, v208, v209
    v_cvt_pk_bf16_f32 v195, v210, v211
    v_pk_mul_f32 v[196:197], v[196:197], v[30:31] op_sel_hi:[1,0]
    v_pk_mul_f32 v[198:199], v[198:199], v[30:31] op_sel_hi:[1,0]
    v_pk_mul_f32 v[212:213], v[212:213], v[30:31] op_sel_hi:[1,0]
    v_pk_mul_f32 v[214:215], v[214:215], v[30:31] op_sel_hi:[1,0]
    v_cvt_pk_bf16_f32 v196, v196, v197
    v_cvt_pk_bf16_f32 v197, v198, v199
    v_cvt_pk_bf16_f32 v198, v212, v213
    v_cvt_pk_bf16_f32 v199, v214, v215
    v_pk_mul_f32 v[200:201], v[200:201], v[44:45] op_sel_hi:[1,0]
    v_pk_mul_f32 v[202:203], v[202:203], v[44:45] op_sel_hi:[1,0]
    v_pk_mul_f32 v[216:217], v[216:217], v[44:45] op_sel_hi:[1,0]
    v_pk_mul_f32 v[218:219], v[218:219], v[44:45] op_sel_hi:[1,0]
    v_cvt_pk_bf16_f32 v200, v200, v201
    v_cvt_pk_bf16_f32 v201, v202, v203
    v_cvt_pk_bf16_f32 v202, v216, v217
    v_cvt_pk_bf16_f32 v203, v218, v219
    v_pk_mul_f32 v[204:205], v[204:205], v[46:47] op_sel_hi:[1,0]
    v_pk_mul_f32 v[206:207], v[206:207], v[46:47] op_sel_hi:[1,0]
    v_pk_mul_f32 v[220:221], v[220:221], v[46:47] op_sel_hi:[1,0]
    v_pk_mul_f32 v[222:223], v[222:223], v[46:47] op_sel_hi:[1,0]
    v_cvt_pk_bf16_f32 v204, v204, v205
    v_cvt_pk_bf16_f32 v205, v206, v207
    v_cvt_pk_bf16_f32 v206, v220, v221
    v_cvt_pk_bf16_f32 v207, v222, v223
    v_mfma_f32_16x16x32_bf16 v[128:131], v[72:75], v[56:59], v[128:131]
    v_max3_f32 v36, v224, v225, v226
    v_max3_f32 v38, -v224, -v225, -v226
    v_max3_f32 v36, v36, v227, v228
    v_max3_f32 v38, v38, -v227, -v228
    v_mfma_f32_16x16x32_bf16 v[132:135], v[72:75], v[60:63], v[132:135]
    v_max3_f32 v36, v36, v229, v230
    v_max3_f32 v38, v38, -v229, -v230
    v_max3_f32 v36, v36, v231, v232
    v_max3_f32 v38, v38, -v231, -v232
    v_mfma_f32_16x16x32_bf16 v[136:139], v[72:75], v[64:67], v[136:139]
    v_max3_f32 v36, v36, v233, v234
    v_max3_f32 v38, v38, -v233, -v234
    v_max3_f32 v36, v36, v235, v236
    v_max3_f32 v38, v38, -v235, -v236
    v_mfma_f32_16x16x32_bf16 v[140:143], v[72:75], v[68:71], v[140:143]
    v_max3_f32 v36, v36, v237, v238
    v_max3_f32 v38, v38, -v237, -v238
    v_max_f32_e64 v36, v36, v239
    v_max_f32 v38, v38, -v239
    v_mfma_f32_16x16x32_bf16 v[156:159], v[76:79], v[68:71], v[156:159]
    v_max3_f32 v37, v240, v241, v242
    v_max3_f32 v39, -v240, -v241, -v242
    v_max3_f32 v37, v37, v243, v244
    v_max3_f32 v39, v39, -v243, -v244
    v_mfma_f32_16x16x32_bf16 v[152:155], v[76:79], v[64:67], v[152:155]
    v_max3_f32 v37, v37, v245, v246
    v_max3_f32 v39, v39, -v245, -v246
    v_max3_f32 v37, v37, v247, v248
    v_max3_f32 v39, v39, -v247, -v248
    v_mfma_f32_16x16x32_bf16 v[148:151], v[76:79], v[60:63], v[148:151]
    v_max3_f32 v37, v37, v249, v250
    v_max3_f32 v39, v39, -v249, -v250
    v_max3_f32 v37, v37, v251, v252
    v_max3_f32 v39, v39, -v251, -v252
    v_mfma_f32_16x16x32_bf16 v[144:147], v[76:79], v[56:59], v[144:147]
    v_max3_f32 v37, v37, v253, v254
    v_max3_f32 v39, v39, -v253, -v254
    v_max_f32_e64 v37, v37, v255
    v_max_f32 v39, v39, -v255
    v_permlane32_swap_b32 v36, v38
    s_nop 0
    v_permlane32_swap_b32 v37, v39
    v_max_f32 v36, v36, v38
    v_max_f32_e64 v37, v37, v39
    v_mul_f32 v36, -v36, v34
    v_mul_f32 v37, -v37, v48
    v_mov_b32 v38, v36
    v_mov_b32 v39, v37
    s_nop 0
    v_permlane32_swap_b32 v36, v38
    v_permlane32_swap_b32_e64 v37, v39
    v_pk_fma_f32 v[60:61], v[224:225], v[34:35], v[36:37] op_sel_hi:[1,0,0]
    v_pk_fma_f32 v[62:63], v[226:227], v[34:35], v[36:37] op_sel_hi:[1,0,0]
    v_pk_fma_f32 v[64:65], v[228:229], v[34:35], v[36:37] op_sel_hi:[1,0,0]
    v_pk_fma_f32 v[66:67], v[230:231], v[34:35], v[36:37] op_sel_hi:[1,0,0]
    v_pk_fma_f32 v[68:69], v[232:233], v[34:35], v[36:37] op_sel_hi:[1,0,0]
    v_pk_fma_f32 v[70:71], v[234:235], v[34:35], v[36:37] op_sel_hi:[1,0,0]
    v_pk_fma_f32 v[72:73], v[236:237], v[34:35], v[36:37] op_sel_hi:[1,0,0]
    v_pk_fma_f32 v[74:75], v[238:239], v[34:35], v[36:37] op_sel_hi:[1,0,0]
    v_pk_fma_f32 v[76:77], v[224:225], v[34:35], v[38:39] op_sel_hi:[1,0,0] neg_lo:[1,0,0] neg_hi:[1,0,0]
    v_pk_fma_f32 v[78:79], v[226:227], v[34:35], v[38:39] op_sel_hi:[1,0,0] neg_lo:[1,0,0] neg_hi:[1,0,0]
    v_pk_fma_f32 v[80:81], v[228:229], v[34:35], v[38:39] op_sel_hi:[1,0,0] neg_lo:[1,0,0] neg_hi:[1,0,0]
    v_pk_fma_f32 v[82:83], v[230:231], v[34:35], v[38:39] op_sel_hi:[1,0,0] neg_lo:[1,0,0] neg_hi:[1,0,0]
    v_pk_fma_f32 v[84:85], v[232:233], v[34:35], v[38:39] op_sel_hi:[1,0,0] neg_lo:[1,0,0] neg_hi:[1,0,0]
    v_pk_fma_f32 v[86:87], v[234:235], v[34:35], v[38:39] op_sel_hi:[1,0,0] neg_lo:[1,0,0] neg_hi:[1,0,0]
    v_pk_fma_f32 v[88:89], v[236:237], v[34:35], v[38:39] op_sel_hi:[1,0,0] neg_lo:[1,0,0] neg_hi:[1,0,0]
    v_pk_fma_f32 v[90:91], v[238:239], v[34:35], v[38:39] op_sel_hi:[1,0,0] neg_lo:[1,0,0] neg_hi:[1,0,0]
    v_exp_f32 v60, v60
    v_exp_f32 v61, v61
    v_exp_f32 v62, v62
    v_exp_f32 v63, v63
    v_exp_f32 v64, v64
    v_exp_f32 v65, v65
    v_exp_f32 v66, v66
    v_exp_f32 v67, v67
    v_exp_f32 v68, v68
    v_exp_f32 v69, v69
    v_exp_f32 v70, v70
    v_exp_f32 v71, v71
    v_exp_f32 v72, v72
    v_exp_f32 v73, v73
    v_exp_f32 v74, v74
    v_exp_f32 v75, v75
    v_exp_f32 v76, v76
    v_exp_f32 v77, v77
    v_exp_f32 v78, v78
    v_exp_f32 v79, v79
    v_exp_f32 v80, v80
    v_exp_f32 v81, v81
    v_exp_f32 v82, v82
    v_exp_f32 v83, v83
    v_exp_f32 v84, v84
    v_exp_f32 v85, v85
    v_exp_f32 v86, v86
    v_exp_f32 v87, v87
    v_exp_f32 v88, v88
    v_exp_f32 v89, v89
    v_exp_f32 v90, v90
    v_exp_f32 v91, v91
    v_pk_add_f32 v[40:41], v[60:61], v[62:63]
    v_pk_add_f32 v[42:43], v[76:77], v[78:79]
    v_pk_add_f32 v[40:41], v[40:41], v[64:65]
    v_pk_add_f32 v[42:43], v[42:43], v[80:81]
    v_pk_add_f32 v[40:41], v[40:41], v[66:67]
    v_pk_add_f32 v[42:43], v[42:43], v[82:83]
    v_pk_add_f32 v[40:41], v[40:41], v[68:69]
    v_pk_add_f32 v[42:43], v[42:43], v[84:85]
    v_pk_add_f32 v[40:41], v[40:41], v[70:71]
    v_pk_add_f32 v[42:43], v[42:43], v[86:87]
    v_pk_add_f32 v[40:41], v[40:41], v[72:73]
    v_pk_add_f32 v[42:43], v[42:43], v[88:89]
    v_pk_add_f32 v[40:41], v[40:41], v[74:75]
    v_pk_add_f32 v[42:43], v[42:43], v[90:91]
    v_add_f32 v40, v40, v41
    v_add_f32 v42, v42, v43
    s_nop 1
    v_permlane32_swap_b32 v40, v42
    v_add_f32 v40, v40, v42
    v_rcp_f32 v40, v40
    s_nop 0
    v_mov_b32 v42, v40
    s_nop 1
    v_permlane32_swap_b32 v40, v42
    v_pk_mul_f32 v[60:61], v[60:61], v[40:41] op_sel_hi:[1,0]
    v_pk_mul_f32 v[62:63], v[62:63], v[40:41] op_sel_hi:[1,0]
    v_pk_mul_f32 v[64:65], v[64:65], v[40:41] op_sel_hi:[1,0]
    v_pk_mul_f32 v[66:67], v[66:67], v[40:41] op_sel_hi:[1,0]
    v_cvt_pk_bf16_f32 v160, v60, v61
    v_cvt_pk_bf16_f32 v161, v62, v63
    v_cvt_pk_bf16_f32 v162, v64, v65
    v_cvt_pk_bf16_f32 v163, v66, v67
    v_pk_mul_f32 v[68:69], v[68:69], v[40:41] op_sel_hi:[1,0]
    v_pk_mul_f32 v[70:71], v[70:71], v[40:41] op_sel_hi:[1,0]
    v_pk_mul_f32 v[72:73], v[72:73], v[40:41] op_sel_hi:[1,0]
    v_pk_mul_f32 v[74:75], v[74:75], v[40:41] op_sel_hi:[1,0]
    v_cvt_pk_bf16_f32 v164, v68, v69
    v_cvt_pk_bf16_f32 v165, v70, v71
    v_cvt_pk_bf16_f32 v166, v72, v73
    v_cvt_pk_bf16_f32 v167, v74, v75
    v_pk_mul_f32 v[76:77], v[76:77], v[42:43] op_sel_hi:[1,0]
    v_pk_mul_f32 v[78:79], v[78:79], v[42:43] op_sel_hi:[1,0]
    v_pk_mul_f32 v[80:81], v[80:81], v[42:43] op_sel_hi:[1,0]
    v_pk_mul_f32 v[82:83], v[82:83], v[42:43] op_sel_hi:[1,0]
    v_cvt_pk_bf16_f32 v168, v76, v77
    v_cvt_pk_bf16_f32 v169, v78, v79
    v_cvt_pk_bf16_f32 v170, v80, v81
    v_cvt_pk_bf16_f32 v171, v82, v83
    v_pk_mul_f32 v[84:85], v[84:85], v[42:43] op_sel_hi:[1,0]
    v_pk_mul_f32 v[86:87], v[86:87], v[42:43] op_sel_hi:[1,0]
    v_pk_mul_f32 v[88:89], v[88:89], v[42:43] op_sel_hi:[1,0]
    v_pk_mul_f32 v[90:91], v[90:91], v[42:43] op_sel_hi:[1,0]
    v_cvt_pk_bf16_f32 v172, v84, v85
    v_cvt_pk_bf16_f32 v173, v86, v87
    v_cvt_pk_bf16_f32 v174, v88, v89
    v_cvt_pk_bf16_f32 v175, v90, v91
    v_pk_fma_f32 v[60:61], v[240:241], v[48:49], v[36:37] op_sel:[0,0,1] op_sel_hi:[1,0,1]
    v_pk_fma_f32 v[62:63], v[242:243], v[48:49], v[36:37] op_sel:[0,0,1] op_sel_hi:[1,0,1]
    v_pk_fma_f32 v[64:65], v[244:245], v[48:49], v[36:37] op_sel:[0,0,1] op_sel_hi:[1,0,1]
    v_pk_fma_f32 v[66:67], v[246:247], v[48:49], v[36:37] op_sel:[0,0,1] op_sel_hi:[1,0,1]
    v_pk_fma_f32 v[68:69], v[248:249], v[48:49], v[36:37] op_sel:[0,0,1] op_sel_hi:[1,0,1]
    v_pk_fma_f32 v[70:71], v[250:251], v[48:49], v[36:37] op_sel:[0,0,1] op_sel_hi:[1,0,1]
    v_pk_fma_f32 v[72:73], v[252:253], v[48:49], v[36:37] op_sel:[0,0,1] op_sel_hi:[1,0,1]
    v_pk_fma_f32 v[74:75], v[254:255], v[48:49], v[36:37] op_sel:[0,0,1] op_sel_hi:[1,0,1]
    v_pk_fma_f32 v[76:77], v[240:241], v[48:49], v[38:39] op_sel:[0,0,1] op_sel_hi:[1,0,1] neg_lo:[1,0,0] neg_hi:[1,0,0]
    v_pk_fma_f32 v[78:79], v[242:243], v[48:49], v[38:39] op_sel:[0,0,1] op_sel_hi:[1,0,1] neg_lo:[1,0,0] neg_hi:[1,0,0]
    v_pk_fma_f32 v[80:81], v[244:245], v[48:49], v[38:39] op_sel:[0,0,1] op_sel_hi:[1,0,1] neg_lo:[1,0,0] neg_hi:[1,0,0]
    v_pk_fma_f32 v[82:83], v[246:247], v[48:49], v[38:39] op_sel:[0,0,1] op_sel_hi:[1,0,1] neg_lo:[1,0,0] neg_hi:[1,0,0]
    v_pk_fma_f32 v[84:85], v[248:249], v[48:49], v[38:39] op_sel:[0,0,1] op_sel_hi:[1,0,1] neg_lo:[1,0,0] neg_hi:[1,0,0]
    v_pk_fma_f32 v[86:87], v[250:251], v[48:49], v[38:39] op_sel:[0,0,1] op_sel_hi:[1,0,1] neg_lo:[1,0,0] neg_hi:[1,0,0]
    v_pk_fma_f32 v[88:89], v[252:253], v[48:49], v[38:39] op_sel:[0,0,1] op_sel_hi:[1,0,1] neg_lo:[1,0,0] neg_hi:[1,0,0]
    v_pk_fma_f32 v[90:91], v[254:255], v[48:49], v[38:39] op_sel:[0,0,1] op_sel_hi:[1,0,1] neg_lo:[1,0,0] neg_hi:[1,0,0]
    v_exp_f32 v60, v60
    v_exp_f32 v61, v61
    v_exp_f32 v62, v62
    v_exp_f32 v63, v63
    ds_write_b128 v116, v[192:195] offset:0
    v_exp_f32 v64, v64
    v_exp_f32 v65, v65
    v_exp_f32 v66, v66
    v_exp_f32 v67, v67
    ds_write_b128 v116, v[196:199] offset:2048
    v_exp_f32 v68, v68
    v_exp_f32 v69, v69
    v_exp_f32 v70, v70
    v_exp_f32 v71, v71
    ds_write_b128 v116, v[200:203] offset:4096
    v_exp_f32 v72, v72
    v_exp_f32 v73, v73
    v_exp_f32 v74, v74
    v_exp_f32 v75, v75
    ds_write_b128 v116, v[204:207] offset:6144
    v_exp_f32 v76, v76
    v_exp_f32 v77, v77
    v_exp_f32 v78, v78
    v_exp_f32 v79, v79
    ds_write_b128 v112, v[160:163] offset:0
    v_exp_f32 v80, v80
    v_exp_f32 v81, v81
    v_exp_f32 v82, v82
    v_exp_f32 v83, v83
    ds_write_b128 v113, v[164:167] offset:0
    v_exp_f32 v84, v84
    v_exp_f32 v85, v85
    v_exp_f32 v86, v86
    v_exp_f32 v87, v87
    ds_write_b128 v114, v[168:171] offset:0
    v_exp_f32 v88, v88
    v_exp_f32 v89, v89
    v_exp_f32 v90, v90
    v_exp_f32 v91, v91
    ds_write_b128 v115, v[172:175] offset:0
    v_pk_add_f32 v[40:41], v[60:61], v[62:63]
    v_pk_add_f32 v[42:43], v[76:77], v[78:79]
    v_pk_add_f32 v[40:41], v[40:41], v[64:65]
    v_pk_add_f32 v[42:43], v[42:43], v[80:81]
    v_pk_add_f32 v[40:41], v[40:41], v[66:67]
    v_pk_add_f32 v[42:43], v[42:43], v[82:83]
    v_pk_add_f32 v[40:41], v[40:41], v[68:69]
    v_pk_add_f32 v[42:43], v[42:43], v[84:85]
    v_pk_add_f32 v[40:41], v[40:41], v[70:71]
    v_pk_add_f32 v[42:43], v[42:43], v[86:87]
    v_pk_add_f32 v[40:41], v[40:41], v[72:73]
    v_pk_add_f32 v[42:43], v[42:43], v[88:89]
    v_pk_add_f32 v[40:41], v[40:41], v[74:75]
    v_pk_add_f32 v[42:43], v[42:43], v[90:91]
    v_add_f32 v40, v40, v41
    v_add_f32 v42, v42, v43
    s_nop 1
    v_permlane32_swap_b32 v40, v42
    v_add_f32 v40, v40, v42
    v_rcp_f32 v40, v40
    s_nop 0
    v_mov_b32 v42, v40
    s_nop 1
    v_permlane32_swap_b32 v40, v42
    v_pk_mul_f32 v[60:61], v[60:61], v[40:41] op_sel_hi:[1,0]
    v_pk_mul_f32 v[62:63], v[62:63], v[40:41] op_sel_hi:[1,0]
    v_pk_mul_f32 v[64:65], v[64:65], v[40:41] op_sel_hi:[1,0]
    v_pk_mul_f32 v[66:67], v[66:67], v[40:41] op_sel_hi:[1,0]
    v_cvt_pk_bf16_f32 v176, v60, v61
    v_cvt_pk_bf16_f32 v177, v62, v63
    v_cvt_pk_bf16_f32 v178, v64, v65
    v_cvt_pk_bf16_f32 v179, v66, v67
    ds_write_b128 v112, v[176:179] offset:4096
    v_pk_mul_f32 v[68:69], v[68:69], v[40:41] op_sel_hi:[1,0]
    v_pk_mul_f32 v[70:71], v[70:71], v[40:41] op_sel_hi:[1,0]
    v_pk_mul_f32 v[72:73], v[72:73], v[40:41] op_sel_hi:[1,0]
    v_pk_mul_f32 v[74:75], v[74:75], v[40:41] op_sel_hi:[1,0]
    v_cvt_pk_bf16_f32 v180, v68, v69
    v_cvt_pk_bf16_f32 v181, v70, v71
    v_cvt_pk_bf16_f32 v182, v72, v73
    v_cvt_pk_bf16_f32 v183, v74, v75
    ds_write_b128 v113, v[180:183] offset:4096
    v_pk_mul_f32 v[76:77], v[76:77], v[42:43] op_sel_hi:[1,0]
    v_pk_mul_f32 v[78:79], v[78:79], v[42:43] op_sel_hi:[1,0]
    v_pk_mul_f32 v[80:81], v[80:81], v[42:43] op_sel_hi:[1,0]
    v_pk_mul_f32 v[82:83], v[82:83], v[42:43] op_sel_hi:[1,0]
    v_cvt_pk_bf16_f32 v184, v76, v77
    v_cvt_pk_bf16_f32 v185, v78, v79
    v_cvt_pk_bf16_f32 v186, v80, v81
    v_cvt_pk_bf16_f32 v187, v82, v83
    ds_write_b128 v114, v[184:187] offset:4096
    v_pk_mul_f32 v[84:85], v[84:85], v[42:43] op_sel_hi:[1,0]
    v_pk_mul_f32 v[86:87], v[86:87], v[42:43] op_sel_hi:[1,0]
    v_pk_mul_f32 v[88:89], v[88:89], v[42:43] op_sel_hi:[1,0]
    v_pk_mul_f32 v[90:91], v[90:91], v[42:43] op_sel_hi:[1,0]
    v_cvt_pk_bf16_f32 v188, v84, v85
    v_cvt_pk_bf16_f32 v189, v86, v87
    v_cvt_pk_bf16_f32 v190, v88, v89
    v_cvt_pk_bf16_f32 v191, v90, v91
    ds_write_b128 v115, v[188:191] offset:4096
    s_waitcnt lgkmcnt(0)
    s_barrier
    s_setprio 0
    s_nop 0
    v_mfma_f32_16x16x16_bf16 v[128:131], v[16:17], v[104:105], v[128:131]
    v_mfma_f32_16x16x16_bf16 v[144:147], v[18:19], v[104:105], v[144:147]
    v_mfma_f32_16x16x16_bf16 v[132:135], v[16:17], v[106:107], v[132:135]
    v_mfma_f32_16x16x16_bf16 v[148:151], v[18:19], v[106:107], v[148:151]
    v_mfma_f32_16x16x16_bf16 v[136:139], v[16:17], v[108:109], v[136:139]
    v_mfma_f32_16x16x16_bf16 v[152:155], v[18:19], v[108:109], v[152:155]
    v_mfma_f32_16x16x16_bf16 v[140:143], v[16:17], v[110:111], v[140:143]
    v_mfma_f32_16x16x16_bf16 v[156:159], v[18:19], v[110:111], v[156:159]
    v_lshrrev_b32 v11, 5, v2
    s_lshl_b32 s78, s81, 7
    s_add_u32 s78, s78, 162944
    v_lshl_add_u32 v10, v11, 4, s78
    v_and_b32 v13, 1, v2
    v_cmp_eq_u32 vcc, 1, v13
    v_mov_b32 v13, 162816
    v_and_b32 v12, 31, v2
    v_cndmask_b32 v10, v10, v13, vcc
    v_lshlrev_b32_e64 v12, 4, v12
    v_lshl_add_u32 v11, v11, 10, v12
    v_lshlrev_b32_e64 v14, 4, v2
    v_cvt_pk_bf16_f32 v128, v128, v129
    v_cvt_pk_bf16_f32 v129, v130, v131
    v_cvt_pk_bf16_f32 v130, v144, v145
    v_cvt_pk_bf16_f32 v131, v146, v147
    v_cvt_pk_bf16_f32 v132, v132, v133
    v_cvt_pk_bf16_f32 v133, v134, v135
    v_cvt_pk_bf16_f32 v134, v148, v149
    v_cvt_pk_bf16_f32 v135, v150, v151
    v_cvt_pk_bf16_f32 v136, v136, v137
    v_cvt_pk_bf16_f32 v137, v138, v139
    v_cvt_pk_bf16_f32 v138, v152, v153
    v_cvt_pk_bf16_f32 v139, v154, v155
    v_cvt_pk_bf16_f32 v140, v140, v141
    v_cvt_pk_bf16_f32 v141, v142, v143
    v_cvt_pk_bf16_f32 v142, v156, v157
    v_cvt_pk_bf16_f32 v143, v158, v159
    v_permlane16_swap_b32 v128, v132
    v_permlane16_swap_b32 v129, v133
    v_permlane16_swap_b32 v130, v134
    v_permlane16_swap_b32 v131, v135
    v_permlane16_swap_b32 v136, v140
    v_permlane16_swap_b32 v137, v141
    v_permlane16_swap_b32 v138, v142
    v_permlane16_swap_b32 v139, v143
    v_mfma_f32_32x32x16_bf16 v[224:239], v[96:99], v[128:131], 0
    v_mfma_f32_32x32x16_bf16 v[224:239], v[100:103], v[132:135], v[224:239]
    v_mfma_f32_32x32x16_bf16 v[240:255], v[96:99], v[136:139], 0
    v_mfma_f32_32x32x16_bf16 v[240:255], v[100:103], v[140:143], v[240:255]
    s_lshl_b32 s94, s70, 14
    s_lshl_b32 s79, s81, 13
    s_add_u32 s94, s94, s79
    s_add_u32 s94, s94, 8388608
    s_add_u32 s95, s94, 4096
    s_lshl_b32 s78, s69, 1
    s_add_u32 s78, s78, s80
    s_lshl_b32 s78, s78, 6
    s_lshl_b32 s79, s70, 1
    s_add_u32 s78, s78, s79
    s_add_u32 s78, s78, s81
    s_lshl_b32 s78, s78, 11
    s_add_u32 s96, s78, 4194304
    s_add_u32 s97, s96, 65536
    v_max3_f32 v36, v224, v225, v226
    v_max3_f32 v38, -v224, -v225, -v226
    v_max3_f32 v36, v36, v227, v228
    v_max3_f32 v38, v38, -v227, -v228
    v_max3_f32 v36, v36, v229, v230
    v_max3_f32 v38, v38, -v229, -v230
    v_max3_f32 v36, v36, v231, v232
    v_max3_f32 v38, v38, -v231, -v232
    v_max3_f32 v36, v36, v233, v234
    v_max3_f32 v38, v38, -v233, -v234
    v_max3_f32 v36, v36, v235, v236
    v_max3_f32 v38, v38, -v235, -v236
    v_max3_f32 v36, v36, v237, v238
    v_max3_f32 v38, v38, -v237, -v238
    v_max_f32_e64 v36, v36, v239
    v_max_f32 v38, v38, -v239
    v_max3_f32 v37, v240, v241, v242
    v_max3_f32 v39, -v240, -v241, -v242
    v_max3_f32 v37, v37, v243, v244
    v_max3_f32 v39, v39, -v243, -v244
    v_max3_f32 v37, v37, v245, v246
    v_max3_f32 v39, v39, -v245, -v246
    v_max3_f32 v37, v37, v247, v248
    v_max3_f32 v39, v39, -v247, -v248
    v_max3_f32 v37, v37, v249, v250
    v_max3_f32 v39, v39, -v249, -v250
    v_max3_f32 v37, v37, v251, v252
    v_max3_f32 v39, v39, -v251, -v252
    v_max3_f32 v37, v37, v253, v254
    v_max3_f32 v39, v39, -v253, -v254
    v_max_f32_e64 v37, v37, v255
    v_max_f32 v39, v39, -v255
    v_permlane32_swap_b32 v36, v38
    s_nop 0
    v_permlane32_swap_b32 v37, v39
    v_max_f32 v36, v36, v38
    v_max_f32_e64 v37, v37, v39
    v_mul_f32 v36, -v36, v34
    v_mul_f32 v37, -v37, v48
    v_mov_b32 v38, v36
    v_mov_b32 v39, v37
    s_nop 0
    v_permlane32_swap_b32 v36, v38
    v_permlane32_swap_b32_e64 v37, v39
    v_pk_fma_f32 v[60:61], v[224:225], v[34:35], v[36:37] op_sel_hi:[1,0,0]
    v_pk_fma_f32 v[62:63], v[226:227], v[34:35], v[36:37] op_sel_hi:[1,0,0]
    v_pk_fma_f32 v[64:65], v[228:229], v[34:35], v[36:37] op_sel_hi:[1,0,0]
    v_pk_fma_f32 v[66:67], v[230:231], v[34:35], v[36:37] op_sel_hi:[1,0,0]
    v_pk_fma_f32 v[68:69], v[232:233], v[34:35], v[36:37] op_sel_hi:[1,0,0]
    v_pk_fma_f32 v[70:71], v[234:235], v[34:35], v[36:37] op_sel_hi:[1,0,0]
    v_pk_fma_f32 v[72:73], v[236:237], v[34:35], v[36:37] op_sel_hi:[1,0,0]
    v_pk_fma_f32 v[74:75], v[238:239], v[34:35], v[36:37] op_sel_hi:[1,0,0]
    v_pk_fma_f32 v[76:77], v[224:225], v[34:35], v[38:39] op_sel_hi:[1,0,0] neg_lo:[1,0,0] neg_hi:[1,0,0]
    v_pk_fma_f32 v[78:79], v[226:227], v[34:35], v[38:39] op_sel_hi:[1,0,0] neg_lo:[1,0,0] neg_hi:[1,0,0]
    v_pk_fma_f32 v[80:81], v[228:229], v[34:35], v[38:39] op_sel_hi:[1,0,0] neg_lo:[1,0,0] neg_hi:[1,0,0]
    v_pk_fma_f32 v[82:83], v[230:231], v[34:35], v[38:39] op_sel_hi:[1,0,0] neg_lo:[1,0,0] neg_hi:[1,0,0]
    v_pk_fma_f32 v[84:85], v[232:233], v[34:35], v[38:39] op_sel_hi:[1,0,0] neg_lo:[1,0,0] neg_hi:[1,0,0]
    v_pk_fma_f32 v[86:87], v[234:235], v[34:35], v[38:39] op_sel_hi:[1,0,0] neg_lo:[1,0,0] neg_hi:[1,0,0]
    v_pk_fma_f32 v[88:89], v[236:237], v[34:35], v[38:39] op_sel_hi:[1,0,0] neg_lo:[1,0,0] neg_hi:[1,0,0]
    v_pk_fma_f32 v[90:91], v[238:239], v[34:35], v[38:39] op_sel_hi:[1,0,0] neg_lo:[1,0,0] neg_hi:[1,0,0]
    v_exp_f32 v60, v60
    v_exp_f32 v61, v61
    v_exp_f32 v62, v62
    v_exp_f32 v63, v63
    v_exp_f32 v64, v64
    v_exp_f32 v65, v65
    v_exp_f32 v66, v66
    v_exp_f32 v67, v67
    v_exp_f32 v68, v68
    v_exp_f32 v69, v69
    v_exp_f32 v70, v70
    v_exp_f32 v71, v71
    v_exp_f32 v72, v72
    v_exp_f32 v73, v73
    v_exp_f32 v74, v74
    v_exp_f32 v75, v75
    v_exp_f32 v76, v76
    v_exp_f32 v77, v77
    v_exp_f32 v78, v78
    v_exp_f32 v79, v79
    v_exp_f32 v80, v80
    v_exp_f32 v81, v81
    v_exp_f32 v82, v82
    v_exp_f32 v83, v83
    v_exp_f32 v84, v84
    v_exp_f32 v85, v85
    v_exp_f32 v86, v86
    v_exp_f32 v87, v87
    v_exp_f32 v88, v88
    v_exp_f32 v89, v89
    v_exp_f32 v90, v90
    v_exp_f32 v91, v91
    v_cvt_pk_bf16_f32 v160, v60, v61
    v_cvt_pk_bf16_f32 v161, v62, v63
    v_cvt_pk_bf16_f32 v162, v64, v65
    v_cvt_pk_bf16_f32 v163, v66, v67
    v_cvt_pk_bf16_f32 v164, v68, v69
    v_cvt_pk_bf16_f32 v165, v70, v71
    v_cvt_pk_bf16_f32 v166, v72, v73
    v_cvt_pk_bf16_f32 v167, v74, v75
    v_cvt_pk_bf16_f32 v168, v76, v77
    v_cvt_pk_bf16_f32 v169, v78, v79
    v_cvt_pk_bf16_f32 v170, v80, v81
    v_cvt_pk_bf16_f32 v171, v82, v83
    v_cvt_pk_bf16_f32 v172, v84, v85
    v_cvt_pk_bf16_f32 v173, v86, v87
    v_cvt_pk_bf16_f32 v174, v88, v89
    v_cvt_pk_bf16_f32 v175, v90, v91
    v_pk_fma_f32 v[60:61], v[240:241], v[48:49], v[36:37] op_sel:[0,0,1] op_sel_hi:[1,0,1]
    v_pk_fma_f32 v[62:63], v[242:243], v[48:49], v[36:37] op_sel:[0,0,1] op_sel_hi:[1,0,1]
    v_pk_fma_f32 v[64:65], v[244:245], v[48:49], v[36:37] op_sel:[0,0,1] op_sel_hi:[1,0,1]
    v_pk_fma_f32 v[66:67], v[246:247], v[48:49], v[36:37] op_sel:[0,0,1] op_sel_hi:[1,0,1]
    v_pk_fma_f32 v[68:69], v[248:249], v[48:49], v[36:37] op_sel:[0,0,1] op_sel_hi:[1,0,1]
    v_pk_fma_f32 v[70:71], v[250:251], v[48:49], v[36:37] op_sel:[0,0,1] op_sel_hi:[1,0,1]
    v_pk_fma_f32 v[72:73], v[252:253], v[48:49], v[36:37] op_sel:[0,0,1] op_sel_hi:[1,0,1]
    v_pk_fma_f32 v[74:75], v[254:255], v[48:49], v[36:37] op_sel:[0,0,1] op_sel_hi:[1,0,1]
    v_pk_fma_f32 v[76:77], v[240:241], v[48:49], v[38:39] op_sel:[0,0,1] op_sel_hi:[1,0,1] neg_lo:[1,0,0] neg_hi:[1,0,0]
    v_pk_fma_f32 v[78:79], v[242:243], v[48:49], v[38:39] op_sel:[0,0,1] op_sel_hi:[1,0,1] neg_lo:[1,0,0] neg_hi:[1,0,0]
    v_pk_fma_f32 v[80:81], v[244:245], v[48:49], v[38:39] op_sel:[0,0,1] op_sel_hi:[1,0,1] neg_lo:[1,0,0] neg_hi:[1,0,0]
    v_pk_fma_f32 v[82:83], v[246:247], v[48:49], v[38:39] op_sel:[0,0,1] op_sel_hi:[1,0,1] neg_lo:[1,0,0] neg_hi:[1,0,0]
    v_pk_fma_f32 v[84:85], v[248:249], v[48:49], v[38:39] op_sel:[0,0,1] op_sel_hi:[1,0,1] neg_lo:[1,0,0] neg_hi:[1,0,0]
    v_pk_fma_f32 v[86:87], v[250:251], v[48:49], v[38:39] op_sel:[0,0,1] op_sel_hi:[1,0,1] neg_lo:[1,0,0] neg_hi:[1,0,0]
    v_pk_fma_f32 v[88:89], v[252:253], v[48:49], v[38:39] op_sel:[0,0,1] op_sel_hi:[1,0,1] neg_lo:[1,0,0] neg_hi:[1,0,0]
    v_pk_fma_f32 v[90:91], v[254:255], v[48:49], v[38:39] op_sel:[0,0,1] op_sel_hi:[1,0,1] neg_lo:[1,0,0] neg_hi:[1,0,0]
    v_exp_f32 v60, v60
    v_exp_f32 v61, v61
    v_exp_f32 v62, v62
    v_exp_f32 v63, v63
    v_exp_f32 v64, v64
    v_exp_f32 v65, v65
    v_exp_f32 v66, v66
    v_exp_f32 v67, v67
    v_exp_f32 v68, v68
    v_exp_f32 v69, v69
    v_exp_f32 v70, v70
    v_exp_f32 v71, v71
    v_exp_f32 v72, v72
    v_exp_f32 v73, v73
    v_exp_f32 v74, v74
    v_exp_f32 v75, v75
    v_exp_f32 v76, v76
    v_exp_f32 v77, v77
    v_exp_f32 v78, v78
    v_exp_f32 v79, v79
    v_exp_f32 v80, v80
    v_exp_f32 v81, v81
    v_exp_f32 v82, v82
    v_exp_f32 v83, v83
    v_exp_f32 v84, v84
    v_exp_f32 v85, v85
    v_exp_f32 v86, v86
    v_exp_f32 v87, v87
    v_exp_f32 v88, v88
    v_exp_f32 v89, v89
    v_exp_f32 v90, v90
    v_exp_f32 v91, v91
    v_cvt_pk_bf16_f32 v176, v60, v61
    v_cvt_pk_bf16_f32 v177, v62, v63
    v_cvt_pk_bf16_f32 v178, v64, v65
    v_cvt_pk_bf16_f32 v179, v66, v67
    v_cvt_pk_bf16_f32 v180, v68, v69
    v_cvt_pk_bf16_f32 v181, v70, v71
    v_cvt_pk_bf16_f32 v182, v72, v73
    v_cvt_pk_bf16_f32 v183, v74, v75
    v_cvt_pk_bf16_f32 v184, v76, v77
    v_cvt_pk_bf16_f32 v185, v78, v79
    v_cvt_pk_bf16_f32 v186, v80, v81
    v_cvt_pk_bf16_f32 v187, v82, v83
    v_cvt_pk_bf16_f32 v188, v84, v85
    v_cvt_pk_bf16_f32 v189, v86, v87
    v_cvt_pk_bf16_f32 v190, v88, v89
    v_cvt_pk_bf16_f32 v191, v90, v91
    s_barrier
    s_setprio 1
    ds_read_b128 v[16:19], v10 offset:0
    ds_read_b128 v[20:23], v10 offset:32
    ds_read_b128 v[24:27], v10 offset:64
    ds_read_b128 v[28:31], v10 offset:96
    s_waitcnt lgkmcnt(3)
    v_mfma_f32_32x32x16_bf16 v[224:239], v[16:19], v[160:163], 0
    s_waitcnt lgkmcnt(2)
    v_mfma_f32_32x32x16_bf16 v[224:239], v[20:23], v[164:167], v[224:239]
    s_waitcnt lgkmcnt(1)
    v_mfma_f32_32x32x16_bf16 v[240:255], v[24:27], v[168:171], 0
    s_waitcnt lgkmcnt(0)
    v_mfma_f32_32x32x16_bf16 v[240:255], v[28:31], v[172:175], v[240:255]
    buffer_load_dwordx4 v[96:99], v11, s[36:39], s94 offen offset:0 sc1
    buffer_load_dwordx4 v[100:103], v11, s[36:39], s94 offen offset:2048 sc1
    buffer_load_dwordx4 v[104:107], v11, s[36:39], s95 offen offset:0 sc1
    buffer_load_dwordx4 v[108:111], v11, s[36:39], s95 offen offset:2048 sc1
    v_mfma_f32_32x32x16_bf16 v[192:207], v[16:19], v[176:179], 0
    v_mfma_f32_32x32x16_bf16 v[192:207], v[20:23], v[180:183], v[192:207]
    v_mfma_f32_32x32x16_bf16 v[208:223], v[24:27], v[184:187], 0
    v_mfma_f32_32x32x16_bf16 v[208:223], v[28:31], v[188:191], v[208:223]
    v_rcp_f32 v36, v225
    s_nop 2
    v_rcp_f32_e64 v38, v241
    v_mov_b32 v44, 0x358637bd
    v_fmac_f32 v44, v224, v36
    v_fmac_f32 v44, v240, v38
    v_rcp_f32 v44, v44
    s_nop 0
    v_mul_f32 v36, v36, v44
    v_mul_f32 v38, v38, v44
    v_rcp_f32 v40, v193
    v_rcp_f32 v42, v209
    v_mov_b32 v45, 0x358637bd
    v_fmac_f32 v45, v192, v40
    v_fmac_f32 v45, v208, v42
    v_rcp_f32 v45, v45
    s_nop 0
    v_mul_f32 v40, v40, v45
    v_mul_f32_e64 v42, v42, v45
    s_mov_b32 s85, 0
    s_branch L_kvchk
L_kvspin:
    s_add_u32 s85, s85, 1
    s_cmp_gt_u32 s85, 400000
    s_cbranch_scc1 L_end
    buffer_load_dwordx4 v[96:99], v11, s[36:39], s94 offen offset:0 sc1
    buffer_load_dwordx4 v[100:103], v11, s[36:39], s94 offen offset:2048 sc1
    buffer_load_dwordx4 v[104:107], v11, s[36:39], s95 offen offset:0 sc1
    buffer_load_dwordx4 v[108:111], v11, s[36:39], s95 offen offset:2048 sc1
L_kvchk:
    s_waitcnt vmcnt(0)
    v_mfma_f32_32x32x16_bf16 v[60:75], v[96:99], v[160:163], 0
    v_mfma_f32_32x32x16_bf16 v[60:75], v[100:103], v[164:167], v[60:75]
    v_max3_u32 v13, v96, v97, v98
    v_max3_u32 v10, v99, v100, v101
    v_max3_u32 v13, v13, v102, v103
    v_max3_u32 v10, v10, v104, v105
    v_max3_u32 v13, v13, v106, v107
    v_mfma_f32_32x32x16_bf16 v[76:91], v[104:107], v[168:171], 0
    v_max3_u32 v10, v10, v108, v109
    v_max3_u32 v13, v13, v110, v111
    v_max_u32 v13, v13, v10
    v_cmp_eq_u32_e64 vcc, -1, v13
    s_cbranch_vccnz L_kvspin
    v_mfma_f32_32x32x16_bf16 v[76:91], v[108:111], v[172:175], v[76:91]
    v_mul_f32 v60, v60, v36
    v_mul_f32 v61, v61, v36
    v_mul_f32 v62, v62, v36
    v_mul_f32 v63, v63, v36
    v_mfma_f32_32x32x16_bf16 v[128:143], v[96:99], v[176:179], 0
    v_mul_f32 v64, v64, v36
    v_mul_f32 v65, v65, v36
    v_mul_f32 v66, v66, v36
    v_mul_f32 v67, v67, v36
    v_mfma_f32_32x32x16_bf16 v[128:143], v[100:103], v[180:183], v[128:143]
    v_mul_f32 v68, v68, v36
    v_mul_f32 v69, v69, v36
    v_mul_f32 v70, v70, v36
    v_mul_f32 v71, v71, v36
    v_mfma_f32_32x32x16_bf16 v[144:159], v[104:107], v[184:187], 0
    v_mul_f32 v72, v72, v36
    v_mul_f32 v73, v73, v36
    v_mul_f32 v74, v74, v36
    v_mul_f32 v75, v75, v36
    v_mfma_f32_32x32x16_bf16 v[144:159], v[108:111], v[188:191], v[144:159]
    v_pk_fma_f32 v[60:61], v[76:77], v[38:39], v[60:61] op_sel_hi:[1,0,1]
    v_pk_fma_f32 v[62:63], v[78:79], v[38:39], v[62:63] op_sel_hi:[1,0,1]
    v_pk_fma_f32 v[64:65], v[80:81], v[38:39], v[64:65] op_sel_hi:[1,0,1]
    v_pk_fma_f32 v[66:67], v[82:83], v[38:39], v[66:67] op_sel_hi:[1,0,1]
    v_cvt_pk_bf16_f32 v16, v60, v61
    v_cvt_pk_bf16_f32 v17, v62, v63
    v_cvt_pk_bf16_f32 v18, v64, v65
    v_cvt_pk_bf16_f32 v19, v66, v67
    buffer_store_dwordx4 v[16:19], v14, s[36:39], s96 offen offset:0 sc1
    v_pk_fma_f32 v[68:69], v[84:85], v[38:39], v[68:69] op_sel_hi:[1,0,1]
    v_pk_fma_f32 v[70:71], v[86:87], v[38:39], v[70:71] op_sel_hi:[1,0,1]
    v_pk_fma_f32 v[72:73], v[88:89], v[38:39], v[72:73] op_sel_hi:[1,0,1]
    v_pk_fma_f32 v[74:75], v[90:91], v[38:39], v[74:75] op_sel_hi:[1,0,1]
    v_cvt_pk_bf16_f32 v20, v68, v69
    v_cvt_pk_bf16_f32 v21, v70, v71
    v_cvt_pk_bf16_f32 v22, v72, v73
    v_cvt_pk_bf16_f32 v23, v74, v75
    buffer_store_dwordx4 v[20:23], v14, s[36:39], s96 offen offset:1024 sc1
    v_pk_mul_f32 v[128:129], v[128:129], v[40:41] op_sel_hi:[1,0]
    v_pk_mul_f32 v[130:131], v[130:131], v[40:41] op_sel_hi:[1,0]
    v_pk_mul_f32 v[132:133], v[132:133], v[40:41] op_sel_hi:[1,0]
    v_pk_mul_f32 v[134:135], v[134:135], v[40:41] op_sel_hi:[1,0]
    v_pk_fma_f32 v[128:129], v[144:145], v[42:43], v[128:129] op_sel_hi:[1,0,1]
    v_pk_fma_f32 v[130:131], v[146:147], v[42:43], v[130:131] op_sel_hi:[1,0,1]
    v_pk_fma_f32 v[132:133], v[148:149], v[42:43], v[132:133] op_sel_hi:[1,0,1]
    v_pk_fma_f32 v[134:135], v[150:151], v[42:43], v[134:135] op_sel_hi:[1,0,1]
    v_cvt_pk_bf16_f32 v24, v128, v129
    v_cvt_pk_bf16_f32 v25, v130, v131
    v_cvt_pk_bf16_f32 v26, v132, v133
    v_cvt_pk_bf16_f32 v27, v134, v135
    buffer_store_dwordx4 v[24:27], v14, s[36:39], s97 offen offset:0 sc1
    v_pk_mul_f32 v[136:137], v[136:137], v[40:41] op_sel_hi:[1,0]
    v_pk_mul_f32 v[138:139], v[138:139], v[40:41] op_sel_hi:[1,0]
    v_pk_mul_f32 v[140:141], v[140:141], v[40:41] op_sel_hi:[1,0]
    v_pk_mul_f32 v[142:143], v[142:143], v[40:41] op_sel_hi:[1,0]
    v_pk_fma_f32 v[136:137], v[152:153], v[42:43], v[136:137] op_sel_hi:[1,0,1]
    v_pk_fma_f32 v[138:139], v[154:155], v[42:43], v[138:139] op_sel_hi:[1,0,1]
    v_pk_fma_f32 v[140:141], v[156:157], v[42:43], v[140:141] op_sel_hi:[1,0,1]
    v_pk_fma_f32 v[142:143], v[158:159], v[42:43], v[142:143] op_sel_hi:[1,0,1]
    v_cvt_pk_bf16_f32 v28, v136, v137
    v_cvt_pk_bf16_f32 v29, v138, v139
    v_cvt_pk_bf16_f32 v30, v140, v141
    v_cvt_pk_bf16_f32 v31, v142, v143
    buffer_store_dwordx4 v[28:31], v14, s[36:39], s97 offen offset:1024 sc1
    v_and_b32 v8, 31, v2
    v_lshrrev_b32 v9, 5, v2
    v_lshlrev_b32 v10, 3, v9
    s_lshl_b32 s78, s72, 7
    buffer_load_dwordx2 v[32:33], v10, s[64:67], s78 offen offset:0
    buffer_load_dwordx2 v[34:35], v10, s[64:67], s78 offen offset:16
    buffer_load_dwordx2 v[36:37], v10, s[64:67], s78 offen offset:32
    buffer_load_dwordx2 v[38:39], v10, s[64:67], s78 offen offset:48
    buffer_load_dwordx2 v[40:41], v10, s[64:67], s78 offen offset:64
    buffer_load_dwordx2 v[42:43], v10, s[64:67], s78 offen offset:80
    buffer_load_dwordx2 v[44:45], v10, s[64:67], s78 offen offset:96
    buffer_load_dwordx2 v[46:47], v10, s[64:67], s78 offen offset:112
    buffer_load_dwordx4 v[48:51], v14, s[64:67], 0 offen
    buffer_load_dwordx4 v[52:55], v14, s[64:67], 0 offen offset:1024
    s_barrier
    s_lshl_b32 s78, s76, 12
    s_add_u32 s78, s78, 131072
    v_lshl_add_u32 v6, v8, 7, s78
    v_add_u32_e64 v6, v6, v10
    v_bfe_u32 v11, v8, 1, 3
    v_lshl_add_u32 v6, v11, 4, v6
    v_xor_b32_e64 v112, 0, v6
    ds_read_b64 v[96:97], v112
    v_xor_b32_e64 v113, 16, v6
    ds_read_b64 v[98:99], v113
    v_xor_b32_e64 v114, 32, v6
    ds_read_b64 v[100:101], v114
    v_xor_b32_e64 v115, 48, v6
    ds_read_b64 v[102:103], v115
    v_xor_b32_e64 v116, 64, v6
    ds_read_b64 v[104:105], v116
    v_xor_b32 v117, 80, v6
    ds_read_b64 v[106:107], v117
    v_xor_b32 v118, 96, v6
    ds_read_b64 v[108:109], v118
    v_xor_b32 v119, 112, v6
    ds_read_b64 v[110:111], v119
    v_bfe_u32 v11, v2, 2, 2
    v_lshl_add_u32 v12, v9, 2, v11
    v_lshlrev_b32 v12, 7, v12
    v_lshrrev_b32 v11, 1, v11
    v_lshl_add_u32 v12, v11, 6, v12
    v_bfe_u32 v11, v2, 4, 1
    v_lshl_add_u32 v12, v11, 5, v12
    v_and_b32_e64 v11, 3, v2
    v_lshl_add_u32 v12, v11, 3, v12
    s_lshl_b32 s82, s72, 0
    s_and_b32 s82, s82, 15
    s_lshl_b32 s78, s82, 13
    v_add_u32 v4, s78, v12
    v_xor_b32 v5, 64, v4
    s_lshl_b32 s83, s71, 2
    s_add_u32 s83, s83, s76
    s_lshl_b32 s83, s83, 16
    s_add_u32 s83, s83, 4194304
    s_lshl_b32 s82, s82, 12
    s_add_u32 s88, s82, s83
    s_waitcnt lgkmcnt(0)
    v_lshlrev_b32 v224, 16, v96
    v_and_b32 v225, 0xffff0000, v96
    v_lshlrev_b32_e64 v226, 16, v97
    v_and_b32 v227, 0xffff0000, v97
    v_lshlrev_b32_e64 v228, 16, v98
    v_and_b32 v229, 0xffff0000, v98
    v_lshlrev_b32_e64 v230, 16, v99
    v_and_b32 v231, 0xffff0000, v99
    v_lshlrev_b32_e64 v232, 16, v100
    v_and_b32 v233, 0xffff0000, v100
    v_lshlrev_b32_e64 v234, 16, v101
    v_and_b32 v235, 0xffff0000, v101
    v_lshlrev_b32_e64 v236, 16, v102
    v_and_b32 v237, 0xffff0000, v102
    v_lshlrev_b32_e64 v238, 16, v103
    v_and_b32 v239, 0xffff0000, v103
    v_lshlrev_b32_e64 v240, 16, v104
    v_and_b32 v241, 0xffff0000, v104
    v_lshlrev_b32_e64 v242, 16, v105
    v_and_b32 v243, 0xffff0000, v105
    v_lshlrev_b32_e64 v244, 16, v106
    v_and_b32 v245, 0xffff0000, v106
    v_lshlrev_b32_e64 v246, 16, v107
    v_and_b32 v247, 0xffff0000, v107
    v_lshlrev_b32_e64 v248, 16, v108
    v_and_b32 v249, 0xffff0000, v108
    v_lshlrev_b32_e64 v250, 16, v109
    v_and_b32 v251, 0xffff0000, v109
    v_lshlrev_b32_e64 v252, 16, v110
    v_and_b32 v253, 0xffff0000, v110
    v_lshlrev_b32_e64 v254, 16, v111
    v_and_b32 v255, 0xffff0000, v111
    s_waitcnt vmcnt(0)
    s_barrier
    v_lshlrev_b32_e64 v60, 16, v32
    v_and_b32 v61, 0xffff0000, v32
    v_lshlrev_b32_e64 v62, 16, v33
    v_and_b32 v63, 0xffff0000, v33
    v_lshlrev_b32_e64 v64, 16, v34
    v_and_b32 v65, 0xffff0000, v34
    v_lshlrev_b32_e64 v66, 16, v35
    v_and_b32 v67, 0xffff0000, v35
    v_lshlrev_b32_e64 v68, 16, v36
    v_and_b32 v69, 0xffff0000, v36
    v_lshlrev_b32_e64 v70, 16, v37
    v_and_b32 v71, 0xffff0000, v37
    v_lshlrev_b32_e64 v72, 16, v38
    v_and_b32 v73, 0xffff0000, v38
    v_lshlrev_b32_e64 v74, 16, v39
    v_and_b32 v75, 0xffff0000, v39
    v_lshlrev_b32_e64 v76, 16, v40
    v_and_b32 v77, 0xffff0000, v40
    v_lshlrev_b32_e64 v78, 16, v41
    v_and_b32 v79, 0xffff0000, v41
    v_lshlrev_b32_e64 v80, 16, v42
    v_and_b32 v81, 0xffff0000, v42
    v_lshlrev_b32_e64 v82, 16, v43
    v_and_b32 v83, 0xffff0000, v43
    v_lshlrev_b32_e64 v84, 16, v44
    v_and_b32 v85, 0xffff0000, v44
    v_lshlrev_b32_e64 v86, 16, v45
    v_and_b32 v87, 0xffff0000, v45
    v_lshlrev_b32_e64 v88, 16, v46
    v_and_b32 v89, 0xffff0000, v46
    v_lshlrev_b32_e64 v90, 16, v47
    v_and_b32 v91, 0xffff0000, v47
    s_mov_b32 s78, 0x3f803f80
    v_dot2_f32_bf16 v126, v48, s78, 0
    v_dot2_f32_bf16 v126, v49, s78, v126
    v_dot2_f32_bf16 v126, v50, s78, v126
    v_dot2_f32_bf16 v126, v51, s78, v126
    v_dot2_f32_bf16 v126, v52, s78, v126
    v_dot2_f32_bf16 v126, v53, s78, v126
    v_dot2_f32_bf16 v126, v54, s78, v126
    v_dot2_f32_bf16 v126, v55, s78, v126
    s_nop 2
    v_add_f32_dpp v126, v126, v126 row_ror:8 row_mask:0xf bank_mask:0xf
    s_nop 1
    v_add_f32_dpp v126, v126, v126 row_ror:4 row_mask:0xf bank_mask:0xf
    s_nop 1
    v_add_f32_dpp v126, v126, v126 row_ror:2 row_mask:0xf bank_mask:0xf
    s_nop 1
    v_add_f32_dpp v126, v126, v126 row_ror:1 row_mask:0xf bank_mask:0xf
    v_mov_b32 v127, v126
    s_nop 1
    v_permlane32_swap_b32 v126, v127
    v_add_f32 v126, v126, v127
    v_mov_b32 v127, v126
    s_nop 1
    v_permlane16_swap_b32 v126, v127
    v_add_f32 v126, v126, v127
    v_lshlrev_b32_e64 v12, 4, v8
    v_lshl_add_u32 v12, v9, 14, v12
    s_lshl_b32 s94, s71, 15
    s_lshl_b32 s79, s76, 9
    s_add_u32 s94, s94, s79
    s_add_u32 s94, s94, 1572864
    s_lshl_b32 s95, s72, 11
    s_add_u32 s95, s95, s94
    s_lshl_b32 s78, s76, 5
    v_add_u32 v11, s78, v8
    v_and_b32 v13, 7, v8
    v_xor_b32 v13, v13, v9
    v_lshlrev_b32 v13, 4, v13
    v_lshl_add_u32 v13, v11, 8, v13
    v_lshlrev_b32_e64 v10, 3, v11
    v_add_u32 v10, 159744, v10
    s_lshl_b32 s78, s71, 7
    v_add_u32 v11, s78, v11
    v_mov_b32 v15, 163584
    ds_read_b32 v15, v15
    s_waitcnt lgkmcnt(0)
    v_readfirstlane_b32 s99, v15
    s_mov_b32 s84, 0
    s_barrier
    buffer_load_dwordx4 v[160:163], v14, s[36:39], s88 offen offset:0 sc1
    ds_read_b64_tr_b16 v[128:129], v4 offset:0
    buffer_load_dwordx4 v[164:167], v14, s[36:39], s88 offen offset:1024 sc1
    ds_read_b64_tr_b16 v[130:131], v4 offset:1024
    buffer_load_dwordx4 v[168:171], v14, s[36:39], s88 offen offset:2048 sc1
    ds_read_b64_tr_b16 v[132:133], v5 offset:0
    buffer_load_dwordx4 v[172:175], v14, s[36:39], s88 offen offset:3072 sc1
    s_add_u32 s82, s82, 4096
    s_and_b32 s82, s82, 0xffff
    s_add_u32 s88, s82, s83
    s_nop 0
    ds_read_b64_tr_b16 v[134:135], v5 offset:1024
    buffer_load_dwordx4 v[176:179], v14, s[36:39], s88 offen offset:0 sc1
    ds_read_b64_tr_b16 v[136:137], v4 offset:2048
    buffer_load_dwordx4 v[180:183], v14, s[36:39], s88 offen offset:1024 sc1
    ds_read_b64_tr_b16 v[138:139], v4 offset:3072
    buffer_load_dwordx4 v[184:187], v14, s[36:39], s88 offen offset:2048 sc1
    ds_read_b64_tr_b16 v[140:141], v5 offset:2048
    buffer_load_dwordx4 v[188:191], v14, s[36:39], s88 offen offset:3072 sc1
    s_add_u32 s82, s82, 4096
    s_and_b32 s82, s82, 0xffff
    s_add_u32 s88, s82, s83
    s_nop 0
    ds_read_b64_tr_b16 v[142:143], v5 offset:3072
    buffer_load_dwordx4 v[192:195], v14, s[36:39], s88 offen offset:0 sc1
    buffer_load_dwordx4 v[196:199], v14, s[36:39], s88 offen offset:1024 sc1
    buffer_load_dwordx4 v[200:203], v14, s[36:39], s88 offen offset:2048 sc1
    buffer_load_dwordx4 v[204:207], v14, s[36:39], s88 offen offset:3072 sc1
    s_add_u32 s82, s82, 4096
    s_and_b32 s82, s82, 0xffff
    s_add_u32 s88, s82, s83
    buffer_load_dwordx4 v[208:211], v14, s[36:39], s88 offen offset:0 sc1
    buffer_load_dwordx4 v[212:215], v14, s[36:39], s88 offen offset:1024 sc1
    .p2align 3
L_G2:
    s_add_u32 s84, s84, 1
    s_waitcnt vmcnt(12) lgkmcnt(6)
    v_mfma_f32_32x32x16_bf16 v[224:239], v[128:131], v[160:163], v[224:239]
    ds_read_b64_tr_b16 v[144:145], v4 offset:4096
    ds_read_b64_tr_b16 v[146:147], v4 offset:5120
    buffer_load_dwordx4 v[216:219], v14, s[36:39], s88 offen offset:2048 sc1
    s_waitcnt lgkmcnt(6)
    v_mfma_f32_32x32x16_bf16 v[240:255], v[132:135], v[160:163], v[240:255]
    ds_read_b64_tr_b16 v[148:149], v5 offset:4096
    ds_read_b64_tr_b16 v[150:151], v5 offset:5120
    s_waitcnt lgkmcnt(6)
    v_mfma_f32_32x32x16_bf16 v[224:239], v[136:139], v[164:167], v[224:239]
    ds_read_b64_tr_b16 v[152:153], v4 offset:6144
    ds_read_b64_tr_b16 v[154:155], v4 offset:7168
    buffer_load_dwordx4 v[220:223], v14, s[36:39], s88 offen offset:3072 sc1
    s_add_u32 s82, s82, 4096
    s_and_b32 s82, s82, 0xffff
    s_add_u32 s88, s82, s83
    s_waitcnt lgkmcnt(6)
    v_mfma_f32_32x32x16_bf16 v[240:255], v[140:143], v[164:167], v[240:255]
    ds_read_b64_tr_b16 v[156:157], v5 offset:6144
    ds_read_b64_tr_b16 v[158:159], v5 offset:7168
    v_add_u32 v4, 0x2000, v4
    v_and_b32 v4, 0x1ffff, v4
    v_xor_b32 v5, 64, v4
    s_waitcnt vmcnt(12) lgkmcnt(6)
    v_mfma_f32_32x32x16_bf16 v[224:239], v[144:147], v[168:171], v[224:239]
    ds_read_b64_tr_b16 v[128:129], v4 offset:0
    ds_read_b64_tr_b16 v[130:131], v4 offset:1024
    buffer_load_dwordx4 v[160:163], v14, s[36:39], s88 offen offset:0 sc1
    s_waitcnt lgkmcnt(6)
    v_mfma_f32_32x32x16_bf16 v[240:255], v[148:151], v[168:171], v[240:255]
    ds_read_b64_tr_b16 v[132:133], v5 offset:0
    ds_read_b64_tr_b16 v[134:135], v5 offset:1024
    s_waitcnt lgkmcnt(6)
    v_mfma_f32_32x32x16_bf16 v[224:239], v[152:155], v[172:175], v[224:239]
    ds_read_b64_tr_b16 v[136:137], v4 offset:2048
    ds_read_b64_tr_b16 v[138:139], v4 offset:3072
    buffer_load_dwordx4 v[164:167], v14, s[36:39], s88 offen offset:1024 sc1
    s_waitcnt lgkmcnt(6)
    v_mfma_f32_32x32x16_bf16 v[240:255], v[156:159], v[172:175], v[240:255]
    ds_read_b64_tr_b16 v[140:141], v5 offset:2048
    ds_read_b64_tr_b16 v[142:143], v5 offset:3072
    s_waitcnt vmcnt(12) lgkmcnt(6)
    v_mfma_f32_32x32x16_bf16 v[224:239], v[128:131], v[176:179], v[224:239]
    ds_read_b64_tr_b16 v[144:145], v4 offset:4096
    ds_read_b64_tr_b16 v[146:147], v4 offset:5120
    buffer_load_dwordx4 v[168:171], v14, s[36:39], s88 offen offset:2048 sc1
    s_waitcnt lgkmcnt(6)
    v_mfma_f32_32x32x16_bf16 v[240:255], v[132:135], v[176:179], v[240:255]
    ds_read_b64_tr_b16 v[148:149], v5 offset:4096
    ds_read_b64_tr_b16 v[150:151], v5 offset:5120
    s_waitcnt lgkmcnt(6)
    v_mfma_f32_32x32x16_bf16 v[224:239], v[136:139], v[180:183], v[224:239]
    ds_read_b64_tr_b16 v[152:153], v4 offset:6144
    ds_read_b64_tr_b16 v[154:155], v4 offset:7168
    buffer_load_dwordx4 v[172:175], v14, s[36:39], s88 offen offset:3072 sc1
    s_add_u32 s82, s82, 4096
    s_and_b32 s82, s82, 0xffff
    s_add_u32 s88, s82, s83
    s_waitcnt lgkmcnt(6)
    v_mfma_f32_32x32x16_bf16 v[240:255], v[140:143], v[180:183], v[240:255]
    ds_read_b64_tr_b16 v[156:157], v5 offset:6144
    ds_read_b64_tr_b16 v[158:159], v5 offset:7168
    v_add_u32 v4, 0x2000, v4
    v_and_b32 v4, 0x1ffff, v4
    v_xor_b32 v5, 64, v4
    s_waitcnt vmcnt(12) lgkmcnt(6)
    v_mfma_f32_32x32x16_bf16 v[224:239], v[144:147], v[184:187], v[224:239]
    ds_read_b64_tr_b16 v[128:129], v4 offset:0
    ds_read_b64_tr_b16 v[130:131], v4 offset:1024
    buffer_load_dwordx4 v[176:179], v14, s[36:39], s88 offen offset:0 sc1
    s_waitcnt lgkmcnt(6)
    v_mfma_f32_32x32x16_bf16 v[240:255], v[148:151], v[184:187], v[240:255]
    ds_read_b64_tr_b16 v[132:133], v5 offset:0
    ds_read_b64_tr_b16 v[134:135], v5 offset:1024
    s_waitcnt lgkmcnt(6)
    v_mfma_f32_32x32x16_bf16 v[224:239], v[152:155], v[188:191], v[224:239]
    ds_read_b64_tr_b16 v[136:137], v4 offset:2048
    ds_read_b64_tr_b16 v[138:139], v4 offset:3072
    buffer_load_dwordx4 v[180:183], v14, s[36:39], s88 offen offset:1024 sc1
    s_waitcnt lgkmcnt(6)
    v_mfma_f32_32x32x16_bf16 v[240:255], v[156:159], v[188:191], v[240:255]
    ds_read_b64_tr_b16 v[140:141], v5 offset:2048
    ds_read_b64_tr_b16 v[142:143], v5 offset:3072
    s_waitcnt vmcnt(12) lgkmcnt(6)
    v_mfma_f32_32x32x16_bf16 v[224:239], v[128:131], v[192:195], v[224:239]
    ds_read_b64_tr_b16 v[144:145], v4 offset:4096
    ds_read_b64_tr_b16 v[146:147], v4 offset:5120
    buffer_load_dwordx4 v[184:187], v14, s[36:39], s88 offen offset:2048 sc1
    s_waitcnt lgkmcnt(6)
    v_mfma_f32_32x32x16_bf16 v[240:255], v[132:135], v[192:195], v[240:255]
    ds_read_b64_tr_b16 v[148:149], v5 offset:4096
    ds_read_b64_tr_b16 v[150:151], v5 offset:5120
    s_waitcnt lgkmcnt(6)
    v_mfma_f32_32x32x16_bf16 v[224:239], v[136:139], v[196:199], v[224:239]
    ds_read_b64_tr_b16 v[152:153], v4 offset:6144
    ds_read_b64_tr_b16 v[154:155], v4 offset:7168
    buffer_load_dwordx4 v[188:191], v14, s[36:39], s88 offen offset:3072 sc1
    s_add_u32 s82, s82, 4096
    s_and_b32 s82, s82, 0xffff
    s_add_u32 s88, s82, s83
    s_waitcnt lgkmcnt(6)
    v_mfma_f32_32x32x16_bf16 v[240:255], v[140:143], v[196:199], v[240:255]
    ds_read_b64_tr_b16 v[156:157], v5 offset:6144
    ds_read_b64_tr_b16 v[158:159], v5 offset:7168
    v_add_u32 v4, 0x2000, v4
    v_and_b32 v4, 0x1ffff, v4
    v_xor_b32 v5, 64, v4
    s_waitcnt vmcnt(12) lgkmcnt(6)
    v_mfma_f32_32x32x16_bf16 v[224:239], v[144:147], v[200:203], v[224:239]
    ds_read_b64_tr_b16 v[128:129], v4 offset:0
    ds_read_b64_tr_b16 v[130:131], v4 offset:1024
    buffer_load_dwordx4 v[192:195], v14, s[36:39], s88 offen offset:0 sc1
    s_waitcnt lgkmcnt(6)
    v_mfma_f32_32x32x16_bf16 v[240:255], v[148:151], v[200:203], v[240:255]
    ds_read_b64_tr_b16 v[132:133], v5 offset:0
    ds_read_b64_tr_b16 v[134:135], v5 offset:1024
    s_waitcnt lgkmcnt(6)
    v_mfma_f32_32x32x16_bf16 v[224:239], v[152:155], v[204:207], v[224:239]
    ds_read_b64_tr_b16 v[136:137], v4 offset:2048
    ds_read_b64_tr_b16 v[138:139], v4 offset:3072
    buffer_load_dwordx4 v[196:199], v14, s[36:39], s88 offen offset:1024 sc1
    s_waitcnt lgkmcnt(6)
    v_mfma_f32_32x32x16_bf16 v[240:255], v[156:159], v[204:207], v[240:255]
    ds_read_b64_tr_b16 v[140:141], v5 offset:2048
    ds_read_b64_tr_b16 v[142:143], v5 offset:3072
    s_waitcnt vmcnt(12) lgkmcnt(6)
    v_mfma_f32_32x32x16_bf16 v[224:239], v[128:131], v[208:211], v[224:239]
    ds_read_b64_tr_b16 v[144:145], v4 offset:4096
    ds_read_b64_tr_b16 v[146:147], v4 offset:5120
    buffer_load_dwordx4 v[200:203], v14, s[36:39], s88 offen offset:2048 sc1
    s_waitcnt lgkmcnt(6)
    v_mfma_f32_32x32x16_bf16 v[240:255], v[132:135], v[208:211], v[240:255]
    ds_read_b64_tr_b16 v[148:149], v5 offset:4096
    ds_read_b64_tr_b16 v[150:151], v5 offset:5120
    s_waitcnt lgkmcnt(6)
    v_mfma_f32_32x32x16_bf16 v[224:239], v[136:139], v[212:215], v[224:239]
    ds_read_b64_tr_b16 v[152:153], v4 offset:6144
    ds_read_b64_tr_b16 v[154:155], v4 offset:7168
    buffer_load_dwordx4 v[204:207], v14, s[36:39], s88 offen offset:3072 sc1
    s_add_u32 s82, s82, 4096
    s_and_b32 s82, s82, 0xffff
    s_add_u32 s88, s82, s83
    s_waitcnt lgkmcnt(6)
    v_mfma_f32_32x32x16_bf16 v[240:255], v[140:143], v[212:215], v[240:255]
    ds_read_b64_tr_b16 v[156:157], v5 offset:6144
    ds_read_b64_tr_b16 v[158:159], v5 offset:7168
    v_add_u32 v4, 0x2000, v4
    v_and_b32 v4, 0x1ffff, v4
    v_xor_b32 v5, 64, v4
    s_waitcnt vmcnt(12) lgkmcnt(6)
    v_mfma_f32_32x32x16_bf16 v[224:239], v[144:147], v[216:219], v[224:239]
    ds_read_b64_tr_b16 v[128:129], v4 offset:0
    ds_read_b64_tr_b16 v[130:131], v4 offset:1024
    buffer_load_dwordx4 v[208:211], v14, s[36:39], s88 offen offset:0 sc1
    s_waitcnt lgkmcnt(6)
    v_mfma_f32_32x32x16_bf16 v[240:255], v[148:151], v[216:219], v[240:255]
    ds_read_b64_tr_b16 v[132:133], v5 offset:0
    ds_read_b64_tr_b16 v[134:135], v5 offset:1024
    s_waitcnt lgkmcnt(6)
    v_mfma_f32_32x32x16_bf16 v[224:239], v[152:155], v[220:223], v[224:239]
    ds_read_b64_tr_b16 v[136:137], v4 offset:2048
    ds_read_b64_tr_b16 v[138:139], v4 offset:3072
    buffer_load_dwordx4 v[212:215], v14, s[36:39], s88 offen offset:1024 sc1
    s_waitcnt lgkmcnt(6)
    v_mfma_f32_32x32x16_bf16 v[240:255], v[156:159], v[220:223], v[240:255]
    ds_read_b64_tr_b16 v[140:141], v5 offset:2048
    ds_read_b64_tr_b16 v[142:143], v5 offset:3072
    s_cmp_lt_u32 s84, 3
    s_cbranch_scc1 L_G2
    s_waitcnt vmcnt(12) lgkmcnt(6)
    v_mfma_f32_32x32x16_bf16 v[224:239], v[128:131], v[160:163], v[224:239]
    ds_read_b64_tr_b16 v[144:145], v4 offset:4096
    ds_read_b64_tr_b16 v[146:147], v4 offset:5120
    buffer_load_dwordx4 v[216:219], v14, s[36:39], s88 offen offset:2048 sc1
    s_waitcnt lgkmcnt(6)
    v_mfma_f32_32x32x16_bf16 v[240:255], v[132:135], v[160:163], v[240:255]
    ds_read_b64_tr_b16 v[148:149], v5 offset:4096
    ds_read_b64_tr_b16 v[150:151], v5 offset:5120
    s_waitcnt lgkmcnt(6)
    v_mfma_f32_32x32x16_bf16 v[224:239], v[136:139], v[164:167], v[224:239]
    ds_read_b64_tr_b16 v[152:153], v4 offset:6144
    ds_read_b64_tr_b16 v[154:155], v4 offset:7168
    buffer_load_dwordx4 v[220:223], v14, s[36:39], s88 offen offset:3072 sc1
    s_add_u32 s82, s82, 4096
    s_and_b32 s82, s82, 0xffff
    s_add_u32 s88, s82, s83
    s_waitcnt lgkmcnt(6)
    v_mfma_f32_32x32x16_bf16 v[240:255], v[140:143], v[164:167], v[240:255]
    ds_read_b64_tr_b16 v[156:157], v5 offset:6144
    ds_read_b64_tr_b16 v[158:159], v5 offset:7168
    s_barrier
    v_add_u32 v4, 0x2000, v4
    v_and_b32 v4, 0x1ffff, v4
    v_xor_b32_e64 v5, 64, v4
    s_waitcnt vmcnt(12) lgkmcnt(6)
    v_mfma_f32_32x32x16_bf16 v[224:239], v[144:147], v[168:171], v[224:239]
    ds_read_b64_tr_b16 v[128:129], v4 offset:0
    ds_read_b64_tr_b16 v[130:131], v4 offset:1024
    s_waitcnt lgkmcnt(6)
    v_mfma_f32_32x32x16_bf16 v[240:255], v[148:151], v[168:171], v[240:255]
    ds_read_b64_tr_b16 v[132:133], v5 offset:0
    ds_read_b64_tr_b16 v[134:135], v5 offset:1024
    s_waitcnt lgkmcnt(6)
    v_mfma_f32_32x32x16_bf16 v[224:239], v[152:155], v[172:175], v[224:239]
    ds_read_b64_tr_b16 v[136:137], v4 offset:2048
    ds_read_b64_tr_b16 v[138:139], v4 offset:3072
    s_waitcnt lgkmcnt(6)
    v_mfma_f32_32x32x16_bf16 v[240:255], v[156:159], v[172:175], v[240:255]
    ds_read_b64_tr_b16 v[140:141], v5 offset:2048
    ds_read_b64_tr_b16 v[142:143], v5 offset:3072
    s_waitcnt vmcnt(10) lgkmcnt(6)
    v_mfma_f32_32x32x16_bf16 v[224:239], v[128:131], v[176:179], v[224:239]
    ds_read_b64_tr_b16 v[144:145], v4 offset:4096
    ds_read_b64_tr_b16 v[146:147], v4 offset:5120
    s_waitcnt lgkmcnt(6)
    v_mfma_f32_32x32x16_bf16 v[240:255], v[132:135], v[176:179], v[240:255]
    ds_read_b64_tr_b16 v[148:149], v5 offset:4096
    ds_read_b64_tr_b16 v[150:151], v5 offset:5120
    s_waitcnt lgkmcnt(6)
    v_mfma_f32_32x32x16_bf16 v[224:239], v[136:139], v[180:183], v[224:239]
    ds_read_b64_tr_b16 v[152:153], v4 offset:6144
    ds_read_b64_tr_b16 v[154:155], v4 offset:7168
    s_waitcnt lgkmcnt(6)
    v_mfma_f32_32x32x16_bf16 v[240:255], v[140:143], v[180:183], v[240:255]
    ds_read_b64_tr_b16 v[156:157], v5 offset:6144
    ds_read_b64_tr_b16 v[158:159], v5 offset:7168
    v_add_u32 v4, 0x2000, v4
    v_and_b32 v4, 0x1ffff, v4
    v_xor_b32_e64 v5, 64, v4
    s_waitcnt vmcnt(8) lgkmcnt(6)
    v_mfma_f32_32x32x16_bf16 v[224:239], v[144:147], v[184:187], v[224:239]
    ds_read_b64_tr_b16 v[128:129], v4 offset:0
    ds_read_b64_tr_b16 v[130:131], v4 offset:1024
    s_waitcnt lgkmcnt(6)
    v_mfma_f32_32x32x16_bf16 v[240:255], v[148:151], v[184:187], v[240:255]
    ds_read_b64_tr_b16 v[132:133], v5 offset:0
    ds_read_b64_tr_b16 v[134:135], v5 offset:1024
    s_waitcnt lgkmcnt(6)
    v_mfma_f32_32x32x16_bf16 v[224:239], v[152:155], v[188:191], v[224:239]
    ds_read_b64_tr_b16 v[136:137], v4 offset:2048
    ds_read_b64_tr_b16 v[138:139], v4 offset:3072
    s_waitcnt lgkmcnt(6)
    v_mfma_f32_32x32x16_bf16 v[240:255], v[156:159], v[188:191], v[240:255]
    ds_read_b64_tr_b16 v[140:141], v5 offset:2048
    ds_read_b64_tr_b16 v[142:143], v5 offset:3072
    s_waitcnt vmcnt(6) lgkmcnt(6)
    v_mfma_f32_32x32x16_bf16 v[224:239], v[128:131], v[192:195], v[224:239]
    ds_read_b64_tr_b16 v[144:145], v4 offset:4096
    ds_read_b64_tr_b16 v[146:147], v4 offset:5120
    s_waitcnt lgkmcnt(6)
    v_mfma_f32_32x32x16_bf16 v[240:255], v[132:135], v[192:195], v[240:255]
    ds_read_b64_tr_b16 v[148:149], v5 offset:4096
    ds_read_b64_tr_b16 v[150:151], v5 offset:5120
    s_waitcnt lgkmcnt(6)
    v_mfma_f32_32x32x16_bf16 v[224:239], v[136:139], v[196:199], v[224:239]
    ds_read_b64_tr_b16 v[152:153], v4 offset:6144
    ds_read_b64_tr_b16 v[154:155], v4 offset:7168
    s_waitcnt lgkmcnt(6)
    v_mfma_f32_32x32x16_bf16 v[240:255], v[140:143], v[196:199], v[240:255]
    ds_read_b64_tr_b16 v[156:157], v5 offset:6144
    ds_read_b64_tr_b16 v[158:159], v5 offset:7168
    v_add_u32 v4, 0x2000, v4
    v_and_b32 v4, 0x1ffff, v4
    v_xor_b32_e64 v5, 64, v4
    s_waitcnt vmcnt(4) lgkmcnt(6)
    v_mfma_f32_32x32x16_bf16 v[224:239], v[144:147], v[200:203], v[224:239]
    ds_read_b64_tr_b16 v[128:129], v4 offset:0
    ds_read_b64_tr_b16 v[130:131], v4 offset:1024
    s_waitcnt lgkmcnt(6)
    v_mfma_f32_32x32x16_bf16 v[240:255], v[148:151], v[200:203], v[240:255]
    ds_read_b64_tr_b16 v[132:133], v5 offset:0
    ds_read_b64_tr_b16 v[134:135], v5 offset:1024
    s_waitcnt lgkmcnt(6)
    v_mfma_f32_32x32x16_bf16 v[224:239], v[152:155], v[204:207], v[224:239]
    ds_read_b64_tr_b16 v[136:137], v4 offset:2048
    ds_read_b64_tr_b16 v[138:139], v4 offset:3072
    s_waitcnt lgkmcnt(6)
    v_mfma_f32_32x32x16_bf16 v[240:255], v[156:159], v[204:207], v[240:255]
    ds_read_b64_tr_b16 v[140:141], v5 offset:2048
    ds_read_b64_tr_b16 v[142:143], v5 offset:3072
    s_waitcnt vmcnt(2) lgkmcnt(6)
    v_mfma_f32_32x32x16_bf16 v[224:239], v[128:131], v[208:211], v[224:239]
    ds_read_b64_tr_b16 v[144:145], v4 offset:4096
    ds_read_b64_tr_b16 v[146:147], v4 offset:5120
    s_waitcnt lgkmcnt(6)
    v_mfma_f32_32x32x16_bf16 v[240:255], v[132:135], v[208:211], v[240:255]
    ds_read_b64_tr_b16 v[148:149], v5 offset:4096
    ds_read_b64_tr_b16 v[150:151], v5 offset:5120
    s_waitcnt lgkmcnt(6)
    v_mfma_f32_32x32x16_bf16 v[224:239], v[136:139], v[212:215], v[224:239]
    ds_read_b64_tr_b16 v[152:153], v4 offset:6144
    ds_read_b64_tr_b16 v[154:155], v4 offset:7168
    s_waitcnt lgkmcnt(6)
    v_mfma_f32_32x32x16_bf16 v[240:255], v[140:143], v[212:215], v[240:255]
    ds_read_b64_tr_b16 v[156:157], v5 offset:6144
    ds_read_b64_tr_b16 v[158:159], v5 offset:7168
    s_waitcnt vmcnt(0) lgkmcnt(6)
    v_mfma_f32_32x32x16_bf16 v[224:239], v[144:147], v[216:219], v[224:239]
    s_waitcnt lgkmcnt(4)
    v_mfma_f32_32x32x16_bf16 v[240:255], v[148:151], v[216:219], v[240:255]
    s_waitcnt lgkmcnt(2)
    v_mfma_f32_32x32x16_bf16 v[224:239], v[152:155], v[220:223], v[224:239]
    s_waitcnt lgkmcnt(0)
    v_mfma_f32_32x32x16_bf16 v[240:255], v[156:159], v[220:223], v[240:255]
    s_nop 9
    v_pk_mul_f32 v[18:19], v[224:225], v[224:225]
    v_pk_mul_f32 v[20:21], v[224:225], v[60:61]
    v_pk_add_f32 v[16:17], v[224:225], v[226:227]
    v_pk_fma_f32 v[18:19], v[226:227], v[226:227], v[18:19]
    v_pk_fma_f32 v[20:21], v[226:227], v[62:63], v[20:21]
    v_pk_add_f32 v[16:17], v[16:17], v[228:229]
    v_pk_fma_f32 v[18:19], v[228:229], v[228:229], v[18:19]
    v_pk_fma_f32 v[20:21], v[228:229], v[64:65], v[20:21]
    v_pk_add_f32 v[16:17], v[16:17], v[230:231]
    v_pk_fma_f32 v[18:19], v[230:231], v[230:231], v[18:19]
    v_pk_fma_f32 v[20:21], v[230:231], v[66:67], v[20:21]
    v_pk_add_f32 v[16:17], v[16:17], v[232:233]
    v_pk_fma_f32 v[18:19], v[232:233], v[232:233], v[18:19]
    v_pk_fma_f32 v[20:21], v[232:233], v[68:69], v[20:21]
    v_pk_add_f32 v[16:17], v[16:17], v[234:235]
    v_pk_fma_f32 v[18:19], v[234:235], v[234:235], v[18:19]
    v_pk_fma_f32 v[20:21], v[234:235], v[70:71], v[20:21]
    v_pk_add_f32 v[16:17], v[16:17], v[236:237]
    v_pk_fma_f32 v[18:19], v[236:237], v[236:237], v[18:19]
    v_pk_fma_f32 v[20:21], v[236:237], v[72:73], v[20:21]
    v_pk_add_f32 v[16:17], v[16:17], v[238:239]
    v_pk_fma_f32 v[18:19], v[238:239], v[238:239], v[18:19]
    v_pk_fma_f32 v[20:21], v[238:239], v[74:75], v[20:21]
    v_pk_add_f32 v[16:17], v[16:17], v[240:241]
    v_pk_fma_f32 v[18:19], v[240:241], v[240:241], v[18:19]
    v_pk_fma_f32 v[20:21], v[240:241], v[76:77], v[20:21]
    v_pk_add_f32 v[16:17], v[16:17], v[242:243]
    v_pk_fma_f32 v[18:19], v[242:243], v[242:243], v[18:19]
    v_pk_fma_f32 v[20:21], v[242:243], v[78:79], v[20:21]
    v_pk_add_f32 v[16:17], v[16:17], v[244:245]
    v_pk_fma_f32 v[18:19], v[244:245], v[244:245], v[18:19]
    v_pk_fma_f32 v[20:21], v[244:245], v[80:81], v[20:21]
    v_pk_add_f32 v[16:17], v[16:17], v[246:247]
    v_pk_fma_f32 v[18:19], v[246:247], v[246:247], v[18:19]
    v_pk_fma_f32 v[20:21], v[246:247], v[82:83], v[20:21]
    v_pk_add_f32 v[16:17], v[16:17], v[248:249]
    v_pk_fma_f32 v[18:19], v[248:249], v[248:249], v[18:19]
    v_pk_fma_f32 v[20:21], v[248:249], v[84:85], v[20:21]
    v_pk_add_f32 v[16:17], v[16:17], v[250:251]
    v_pk_fma_f32 v[18:19], v[250:251], v[250:251], v[18:19]
    v_pk_fma_f32 v[20:21], v[250:251], v[86:87], v[20:21]
    v_pk_add_f32 v[16:17], v[16:17], v[252:253]
    v_pk_fma_f32 v[18:19], v[252:253], v[252:253], v[18:19]
    v_pk_fma_f32 v[20:21], v[252:253], v[88:89], v[20:21]
    v_pk_add_f32 v[16:17], v[16:17], v[254:255]
    v_pk_fma_f32 v[18:19], v[254:255], v[254:255], v[18:19]
    v_pk_fma_f32 v[20:21], v[254:255], v[90:91], v[20:21]
    v_mov_b32 v27, s75
    v_add_f32 v24, v16, v17
    v_add_f32 v25, v18, v19
    v_add_f32 v26, v20, v21
    v_mov_b32 v28, v24
    v_mov_b32 v29, v25
    v_mov_b32 v30, v26
    v_permlane32_swap_b32 v24, v28
    v_permlane32_swap_b32 v25, v29
    v_permlane32_swap_b32 v26, v30
    v_pk_add_f32 v[24:25], v[24:25], v[28:29]
    v_add_f32 v26, v26, v30
    s_mov_b32 exec_hi, 0
    s_bitcmp1_b32 s99, 1
    s_cbranch_scc1 Lls_56
    buffer_store_dwordx4 v[24:27], v14, s[36:39], s95 offen sc1
    s_branch Lle_57
Lls_56:
    buffer_store_dwordx4 v[24:27], v14, s[36:39], s95 offen
Lle_57:
    s_mov_b32 exec_hi, -1
    s_add_u32 s79, s94, 4096
    s_add_u32 s80, s94, 8192
    s_add_u32 s81, s94, 12288
    s_barrier
    s_nop 0
    buffer_load_dwordx4 v[64:67], v12, s[36:39], s94 offen offset:0 sc1
    buffer_load_dwordx4 v[68:71], v12, s[36:39], s94 offen offset:2048 sc1
    buffer_load_dwordx4 v[72:75], v12, s[36:39], s79 offen offset:0 sc1
    buffer_load_dwordx4 v[76:79], v12, s[36:39], s79 offen offset:2048 sc1
    buffer_load_dwordx4 v[80:83], v12, s[36:39], s80 offen offset:0 sc1
    buffer_load_dwordx4 v[84:87], v12, s[36:39], s80 offen offset:2048 sc1
    buffer_load_dwordx4 v[88:91], v12, s[36:39], s81 offen offset:0 sc1
    buffer_load_dwordx4 v[92:95], v12, s[36:39], s81 offen offset:2048 sc1
    v_xor_b32_e64 v112, 0, v13
    ds_write_b128 v112, v[224:227]
    v_xor_b32_e64 v113, 32, v13
    ds_write_b128 v113, v[228:231]
    v_xor_b32_e64 v114, 64, v13
    ds_write_b128 v114, v[232:235]
    v_xor_b32 v115, 96, v13
    ds_write_b128 v115, v[236:239]
    v_xor_b32 v116, 128, v13
    ds_write_b128 v116, v[240:243]
    v_xor_b32 v117, 160, v13
    ds_write_b128 v117, v[244:247]
    v_xor_b32 v118, 192, v13
    ds_write_b128 v118, v[248:251]
    v_xor_b32 v119, 224, v13
    ds_write_b128 v119, v[252:255]
    s_mov_b32 s85, 1
    s_branch L_gchk
Lspin_58:
    s_add_u32 s85, s85, 1
    s_cmp_gt_u32 s85, 400000
    s_cbranch_scc1 L_end
    buffer_load_dwordx4 v[64:67], v12, s[36:39], s94 offen offset:0 sc1
    buffer_load_dwordx4 v[68:71], v12, s[36:39], s94 offen offset:2048 sc1
    buffer_load_dwordx4 v[72:75], v12, s[36:39], s79 offen offset:0 sc1
    buffer_load_dwordx4 v[76:79], v12, s[36:39], s79 offen offset:2048 sc1
    buffer_load_dwordx4 v[80:83], v12, s[36:39], s80 offen offset:0 sc1
    buffer_load_dwordx4 v[84:87], v12, s[36:39], s80 offen offset:2048 sc1
    buffer_load_dwordx4 v[88:91], v12, s[36:39], s81 offen offset:0 sc1
    buffer_load_dwordx4 v[92:95], v12, s[36:39], s81 offen offset:2048 sc1
L_gchk:
    s_waitcnt vmcnt(0)
    s_nop 0
    v_max3_u32 v16, v67, v71, v75
    v_max3_u32 v16, v16, v79, v83
    v_max3_u32 v16, v16, v87, v91
    v_max3_u32 v16, v16, v95, s75
    v_min3_u32 v17, v67, v71, v75
    v_min3_u32 v17, v17, v79, v83
    v_min3_u32 v17, v17, v87, v91
    v_min3_u32 v17, v17, v95, s75
    v_cmp_ne_u32 vcc, v16, v17
    s_cbranch_vccnz Lspin_58
    v_pk_add_f32 v[64:65], v[64:65], v[68:69]
    v_add_f32_e64 v66, v66, v70
    v_pk_add_f32 v[72:73], v[72:73], v[76:77]
    v_add_f32_e64 v74, v74, v78
    v_pk_add_f32 v[80:81], v[80:81], v[84:85]
    v_add_f32_e64 v82, v82, v86
    v_pk_add_f32 v[88:89], v[88:89], v[92:93]
    v_add_f32_e64 v90, v90, v94
    v_pk_add_f32 v[64:65], v[64:65], v[72:73]
    v_add_f32_e64 v66, v66, v74
    v_pk_add_f32 v[80:81], v[80:81], v[88:89]
    v_add_f32 v82, v82, v90
    v_add_f32 v24, v64, v80
    v_add_f32 v25, v65, v81
    v_add_f32 v26, v66, v82
    v_mov_b32 v28, v24
    v_mov_b32 v29, v25
    v_mov_b32 v30, v26
    v_permlane32_swap_b32 v24, v28
    v_permlane32_swap_b32 v25, v29
    v_permlane32_swap_b32 v26, v30
    v_pk_add_f32 v[24:25], v[24:25], v[28:29]
    v_add_f32_e64 v26, v26, v30
    v_mul_f32 v36, 0x3a800000, v24
    v_mul_f32 v40, 0x3a800000, v25
    v_fma_f32 v40, -v36, v36, v40
    v_max_f32_e64 v40, 0, v40
    v_cvt_pk_bf16_f32 v36, v36, v36
    v_and_b32 v36, 0xffff0000, v36
    v_cvt_pk_bf16_f32 v40, v40, v40
    v_and_b32 v40, 0xffff0000, v40
    v_add_f32 v40, 0x3727c5ac, v40
    v_cvt_pk_bf16_f32 v40, v40, v40
    v_and_b32 v40, 0xffff0000, v40
    v_sqrt_f32 v40, v40
    s_nop 0
    v_cvt_pk_bf16_f32 v40, v40, v40
    v_and_b32 v40, 0xffff0000, v40
    v_rcp_f32_e64 v38, v40
    v_fma_f32 v42, -v36, v126, v26
    s_mov_b32 s79, 0xfffff800
    v_mul_f32_e64 v42, v42, v38
    v_mul_f32 v39, -v36, v38
    v_and_or_b32 v42, v42, s79, v11
    ds_write_b64 v10, v[38:39]
    s_nop 0
    v_max_f32_dpp v42, v42, v42 row_ror:8 row_mask:0xf bank_mask:0xf
    s_nop 1
    v_max_f32_dpp v42, v42, v42 row_ror:4 row_mask:0xf bank_mask:0xf
    s_nop 1
    v_max_f32_dpp v42, v42, v42 row_ror:2 row_mask:0xf bank_mask:0xf
    s_nop 1
    v_max_f32_dpp v42, v42, v42 row_ror:1 row_mask:0xf bank_mask:0xf
    s_lshl_b32 s78, s76, 3
    s_add_u32 s78, s78, 163328
    v_bfe_u32 v16, v2, 4, 1
    v_lshl_add_u32 v16, v16, 2, s78
    ds_write_b32 v16, v42
    v_mov_b32 v16, 163328
    s_waitcnt lgkmcnt(0)
    s_barrier
    ds_read_b128 v[20:23], v16
    ds_read_b128 v[24:27], v16 offset:16
    s_lshl_b32 s79, s71, 4
    s_add_u32 s79, s79, s72
    s_lshl_b32 s79, s79, 9
    s_add_u32 s79, s79, 524288
    v_lshlrev_b32 v17, 3, v2
    v_lshlrev_b32_e64 v18, 2, v2
    s_waitcnt lgkmcnt(0)
    v_max3_f32 v20, v20, v21, v22
    v_max3_f32 v24, v24, v25, v26
    v_max_f32_e64 v23, v23, v27
    v_max3_f32 v20, v20, v24, v23
    v_mov_b32 v21, s75
    s_cmp_lg_u32 s76, 0
    s_cbranch_scc1 L_nocand
    s_mov_b32 exec_hi, 0
    v_and_b32 v22, 127, v20
    v_and_b32 v23, 7, v20
    v_lshlrev_b32 v23, 4, v23
    v_xor_b32_e64 v23, v23, v17
    v_lshl_add_u32 v23, v22, 8, v23
    v_lshlrev_b32_e64 v22, 3, v22
    ds_read_b64 v[24:25], v23
    v_add_u32 v22, 159744, v22
    ds_read_b64 v[26:27], v22
    s_mov_b32 exec_lo, 0xffff
    buffer_store_dwordx2 v[20:21], v17, s[36:39], s79 offen offset:128 sc1
    s_mov_b32 exec_lo, -1
    s_waitcnt lgkmcnt(0)
    v_fma_f32 v28, v24, v26, v27
    v_fma_f32 v29, v25, v26, v27
    v_cvt_pk_bf16_f32 v30, v28, v29
    buffer_store_dword v30, v18, s[36:39], s79 offen sc1
    v_add_f32 v28, v28, v24
    v_add_f32 v29, v29, v25
    buffer_store_dwordx2 v[28:29], v17, s[36:39], s79 offen offset:256 sc1
    s_mov_b32 exec_hi, -1
L_nocand:
    v_lshrrev_b32 v16, 3, v2
    v_and_b32 v17, 7, v2
    s_lshl_b32 s78, s76, 5
    v_add_u32 v18, s78, v16
    v_lshlrev_b32 v19, 1, v17
    v_xor_b32 v19, v19, v16
    v_lshlrev_b32 v19, 4, v19
    v_lshl_add_u32 v19, v18, 8, v19
    v_xor_b32 v32, 16, v19
    v_lshlrev_b32 v33, 3, v18
    v_add_u32 v33, 159744, v33
    ds_read_b128 v[64:67], v19 offset:0
    ds_read_b128 v[68:71], v32 offset:0
    ds_read_b64 v[96:97], v33 offset:0
    ds_read_b128 v[72:75], v19 offset:2048
    ds_read_b128 v[76:79], v32 offset:2048
    ds_read_b64 v[98:99], v33 offset:64
    ds_read_b128 v[80:83], v19 offset:4096
    ds_read_b128 v[84:87], v32 offset:4096
    ds_read_b64 v[100:101], v33 offset:128
    ds_read_b128 v[88:91], v19 offset:6144
    ds_read_b128 v[92:95], v32 offset:6144
    ds_read_b64 v[102:103], v33 offset:192
    s_lshl_b32 s78, s71, 7
    v_add_u32_e64 v18, s78, v18
    s_lshl_b32 s79, s72, 7
    v_lshl_add_u32 v19, v18, 11, s79
    v_lshl_add_u32 v19, v17, 4, v19
    v_mov_b32 v16, 163360
    s_waitcnt lgkmcnt(0)
    v_add_f32 v96, 1.0, v96
    v_pk_fma_f32 v[64:65], v[64:65], v[96:97], v[96:97] op_sel:[0,0,1] op_sel_hi:[1,0,1]
    v_pk_fma_f32 v[66:67], v[66:67], v[96:97], v[96:97] op_sel:[0,0,1] op_sel_hi:[1,0,1]
    v_pk_fma_f32 v[68:69], v[68:69], v[96:97], v[96:97] op_sel:[0,0,1] op_sel_hi:[1,0,1]
    v_pk_fma_f32 v[70:71], v[70:71], v[96:97], v[96:97] op_sel:[0,0,1] op_sel_hi:[1,0,1]
    v_cvt_pk_bf16_f32 v104, v64, v65
    v_cvt_pk_bf16_f32 v105, v66, v67
    v_cvt_pk_bf16_f32 v106, v68, v69
    v_cvt_pk_bf16_f32 v107, v70, v71
    v_add_f32_e64 v98, 1.0, v98
    v_pk_fma_f32 v[72:73], v[72:73], v[98:99], v[98:99] op_sel:[0,0,1] op_sel_hi:[1,0,1]
    v_pk_fma_f32 v[74:75], v[74:75], v[98:99], v[98:99] op_sel:[0,0,1] op_sel_hi:[1,0,1]
    v_pk_fma_f32 v[76:77], v[76:77], v[98:99], v[98:99] op_sel:[0,0,1] op_sel_hi:[1,0,1]
    v_pk_fma_f32 v[78:79], v[78:79], v[98:99], v[98:99] op_sel:[0,0,1] op_sel_hi:[1,0,1]
    v_cvt_pk_bf16_f32 v108, v72, v73
    v_cvt_pk_bf16_f32 v109, v74, v75
    v_cvt_pk_bf16_f32 v110, v76, v77
    v_cvt_pk_bf16_f32 v111, v78, v79
    v_add_f32_e64 v100, 1.0, v100
    v_pk_fma_f32 v[80:81], v[80:81], v[100:101], v[100:101] op_sel:[0,0,1] op_sel_hi:[1,0,1]
    v_pk_fma_f32 v[82:83], v[82:83], v[100:101], v[100:101] op_sel:[0,0,1] op_sel_hi:[1,0,1]
    v_pk_fma_f32 v[84:85], v[84:85], v[100:101], v[100:101] op_sel:[0,0,1] op_sel_hi:[1,0,1]
    v_pk_fma_f32 v[86:87], v[86:87], v[100:101], v[100:101] op_sel:[0,0,1] op_sel_hi:[1,0,1]
    v_cvt_pk_bf16_f32 v112, v80, v81
    v_cvt_pk_bf16_f32 v113, v82, v83
    v_cvt_pk_bf16_f32 v114, v84, v85
    v_cvt_pk_bf16_f32 v115, v86, v87
    v_add_f32_e64 v102, 1.0, v102
    v_pk_fma_f32 v[88:89], v[88:89], v[102:103], v[102:103] op_sel:[0,0,1] op_sel_hi:[1,0,1]
    v_pk_fma_f32 v[90:91], v[90:91], v[102:103], v[102:103] op_sel:[0,0,1] op_sel_hi:[1,0,1]
    v_pk_fma_f32 v[92:93], v[92:93], v[102:103], v[102:103] op_sel:[0,0,1] op_sel_hi:[1,0,1]
    v_pk_fma_f32 v[94:95], v[94:95], v[102:103], v[102:103] op_sel:[0,0,1] op_sel_hi:[1,0,1]
    v_cvt_pk_bf16_f32 v116, v88, v89
    v_cvt_pk_bf16_f32 v117, v90, v91
    v_cvt_pk_bf16_f32 v118, v92, v93
    v_cvt_pk_bf16_f32 v119, v94, v95
    s_barrier
    ds_read_b32 v17, v16
    s_waitcnt lgkmcnt(0)
    v_and_b32 v17, 0x7ff, v17
    v_sub_u32 v17, v17, v18
    s_barrier
    s_barrier
    s_mov_b32 s78, 0
    v_cmp_ne_u32_e64 vcc, 0, v17
    s_mov_b64 exec, vcc
    s_cbranch_execz Lo_59
    buffer_store_dwordx4 v[104:107], v19, s[44:47], s78 offen sc1
Lo_59:
    s_mov_b64 exec, -1
    s_mov_b32 s78, 16384
    v_cmp_ne_u32 vcc, 8, v17
    s_mov_b64 exec, vcc
    s_cbranch_execz Lo_60
    buffer_store_dwordx4 v[108:111], v19, s[44:47], s78 offen sc1
Lo_60:
    s_mov_b64 exec, -1
    s_mov_b32 s78, 32768
    v_cmp_ne_u32 vcc, 16, v17
    s_mov_b64 exec, vcc
    s_cbranch_execz Lo_61
    buffer_store_dwordx4 v[112:115], v19, s[44:47], s78 offen sc1
Lo_61:
    s_mov_b64 exec, -1
    s_mov_b32 s78, 49152
    v_cmp_ne_u32 vcc, 24, v17
    s_mov_b64 exec, vcc
    s_cbranch_execz Lo_62
    buffer_store_dwordx4 v[116:119], v19, s[44:47], s78 offen sc1
Lo_62:
    s_mov_b64 exec, -1
    s_branch L_fin
L_fin:
L_end:
    s_endpgm
.fill 64, 4, 0xbf800000
s_endpgm
.section .rodata,"a"
.p2align 6
.amdhsa_kernel sequential_preLN__linear_kernel_hedgehog__moe_arch_mod__prompt_kernel
  .amdhsa_next_free_vgpr 256
  .amdhsa_next_free_sgpr 102
  .amdhsa_accum_offset 256
  .amdhsa_group_segment_fixed_size 0
  .amdhsa_kernarg_size 96
  .amdhsa_user_sgpr_count 2
  .amdhsa_user_sgpr_kernarg_segment_ptr 1
  .amdhsa_system_sgpr_workgroup_id_x 1
  .amdhsa_float_denorm_mode_32 3
.end_amdhsa_kernel
```

```asm
; @launch grid=(256,1,1) block=(512,1,1) lds=163840
.amdgcn_target "amdgcn-amd-amdhsa--gfx950"
.text
.globl sequential_preLN__linear_kernel_hedgehog__moe_arch_mod__prompt_kernel
.p2align 8
.type sequential_preLN__linear_kernel_hedgehog__moe_arch_mod__prompt_kernel,@function
sequential_preLN__linear_kernel_hedgehog__moe_arch_mod__prompt_kernel:
    s_cmp_ge_u32 s2, 256
    s_cbranch_scc1 L_end
    s_load_dwordx16 s[4:19], s[0:1], 0
    s_load_dwordx8 s[20:27], s[0:1], 64
    v_lshrrev_b32 v1, 6, v0
    v_and_b32_e64 v2, 63, v0
    v_readfirstlane_b32 s68, v1
    s_lshr_b32 s69, s2, 4
    s_and_b32 s70, s2, 7
    s_lshl_b32 s70, s70, 1
    s_bfe_u32 s78, s2, 0x10003
    s_or_b32 s70, s70, s78
    s_and_b32 s76, s68, 3
    s_cmp_ge_u32 s68, 4
    s_cbranch_scc1 L_M
    v_lshrrev_b32 v196, 3, v2
    v_and_b32 v197, 7, v2
    v_lshrrev_b32_e64 v198, 4, v2
    s_mul_i32 s78, s76, 98304
    s_lshl_b32 s79, s70, 7
    s_add_u32 s78, s78, s79
    s_movk_i32 s79, 6144
    v_mov_b32 v199, s78
    v_mad_u32_u24 v199, v196, s79, v199
    v_and_b32 v200, 2, v196
    v_xor_b32 v200, v200, v197
    v_lshl_add_u32 v6, v200, 4, v199
    v_xor_b32_e64 v7, 64, v6
    v_add_u32 v7, 48128, v7
    s_lshl_b32 s78, s69, 2
    s_add_u32 s78, s78, s76
    s_lshl_b32 s78, s78, 16
    v_lshl_add_u32 v199, v196, 11, s78
    v_xor_b32 v200, v198, v197
    v_lshl_add_u32 v4, v200, 4, v199
    v_xor_b32_e64 v5, 64, v4
    v_add_u32 v5, 15360, v5
    s_lshl_b32 s88, s76, 12
    s_lshl_b32 s89, s76, 11
    s_and_b32 s78, s70, 14
    s_and_b32 s79, s69, 14
    s_add_u32 s78, s78, s79
    s_sub_u32 s78, 32, s78
    s_and_b32 s78, s78, 15
    s_lshl_b32 s86, s78, 7
    s_mul_i32 s87, s78, 393216
    s_mov_b32 s30, 0x400000
    s_mov_b32 s31, 0x20000
    s_mov_b32 s34, 0x600000
    s_mov_b32 s35, 0x20000
    s_waitcnt lgkmcnt(0)
    s_mov_b32 s32, s6
    s_and_b32 s33, s7, 0xffff
    s_mov_b32 s28, s4
    s_and_b32 s29, s5, 0xffff
    s_add_u32 m0, s88, 118784
    s_nop 0
    buffer_load_dwordx4 v4, s[28:31], s86 offen  lds
    buffer_load_dwordx4 v5, s[28:31], s86 offen offset:1024  lds
    s_add_u32 m0, s89, 143360
    s_add_u32 s101, s87, 2048
    buffer_load_dwordx4 v6, s[32:35], s101 offen  lds
    buffer_load_dwordx4 v7, s[32:35], s101 offen offset:1024  lds
    s_add_u32 m0, s88, 120832
    s_add_u32 s101, s86, 32768
    buffer_load_dwordx4 v4, s[28:31], s101 offen  lds
    buffer_load_dwordx4 v5, s[28:31], s101 offen offset:1024  lds
    s_add_u32 m0, s89, 151552
    s_add_u32 s101, s87, 4096
    buffer_load_dwordx4 v6, s[32:35], s101 offen  lds
    buffer_load_dwordx4 v7, s[32:35], s101 offen offset:1024  lds
    s_add_u32 m0, s89, 135168
    s_nop 0
    buffer_load_dwordx4 v6, s[32:35], s87 offen  lds
    buffer_load_dwordx4 v7, s[32:35], s87 offen offset:1024  lds
    s_add_u32 s86, s86, 128
    s_add_u32 s87, s87, 393216
    s_and_b32 s86, s86, 2047
    s_cselect_b32 s87, s87, 0
    s_load_dword s75, s[26:27], 0
    s_mov_b32 s60, s8
    s_and_b32 s61, s9, 0xffff
    s_mov_b32 s62, 0x10000
    s_mov_b32 s63, 0x20000
    v_lshlrev_b32_e64 v14, 4, v2
    s_lshl_b32 s78, s70, 12
    s_lshl_b32 s79, s76, 10
    s_add_u32 s78, s78, s79
    s_add_u32 m0, s79, 159744
    s_nop 0
    buffer_load_dwordx4 v14, s[60:63], s78 offen lds
    s_and_b32 s78, s2, 7
    s_lshr_b32 s79, s2, 3
    s_lshl_b32 s71, s78, 1
    s_and_b32 s72, s79, 1
    s_add_u32 s71, s71, s72
    s_lshr_b32 s72, s79, 1
    s_cmp_gt_u32 s70, 3
    s_cselect_b32 s78, 1, 0
    s_cmp_gt_u32 s70, 11
    s_cselect_b32 s78, 2, s78
    s_sub_u32 s78, s70, s78
    s_cmp_eq_u32 s70, 3
    s_cselect_b32 s78, 14, s78
    s_cmp_eq_u32 s70, 11
    s_cselect_b32 s78, 15, s78
    s_lshl_b32 s0, s78, 4
    s_add_u32 s0, s0, s69
    s_lshr_b32 s73, s0, 2
    s_and_b32 s74, s0, 3
    s_lshl_b32 s77, s70, 4
    s_add_u32 s77, s77, s69
    s_mov_b32 s36, s26
    s_and_b32 s37, s27, 0xffff
    s_mov_b32 s38, 0x10000000
    s_mov_b32 s39, 0x20000
    s_mov_b32 s40, s10
    s_and_b32 s41, s11, 0xffff
    s_mov_b32 s42, 0x200000
    s_mov_b32 s43, 0x20000
    s_mov_b32 s44, s22
    s_and_b32 s45, s23, 0xffff
    s_mov_b32 s46, 0x400000
    s_mov_b32 s47, 0x20000
    s_mov_b32 s48, s16
    s_and_b32 s49, s17, 0xffff
    s_mov_b32 s50, 0x700000
    s_mov_b32 s51, 0x20000
    s_mov_b32 s52, s18
    s_and_b32 s53, s19, 0xffff
    s_mov_b32 s54, 0x700000
    s_mov_b32 s55, 0x20000
    s_mov_b32 s56, s20
    s_and_b32 s57, s21, 0xffff
    s_mov_b32 s58, 0x700000
    s_mov_b32 s59, 0x20000
    v_mov_b32 v16, -1
    v_mov_b32 v17, -1
    v_mov_b32 v18, -1
    v_mov_b32_e64 v19, -1
    s_lshl_b32 s94, s77, 14
    s_lshl_b32 s78, s76, 12
    s_add_u32 s94, s94, s78
    s_add_u32 s94, s94, 4194304
    s_lshl_b32 s96, s77, 10
    s_add_u32 s96, s96, 8388608
    s_cmp_eq_u32 s76, 3
    s_cselect_b32 s96, s96, 0x10000000
    v_and_b32 v196, 15, v2
    v_lshrrev_b32 v197, 1, v196
    v_lshlrev_b32 v199, 7, v196
    v_add_u32 v199, s88, v199
    v_xor_b32_e64 v200, v198, v197
    v_lshl_add_u32 v60, v200, 4, v199
    v_xor_b32_e64 v61, 64, v60
    v_bfe_u32 v196, v2, 2, 2
    v_and_b32_e64 v197, 3, v2
    v_lshl_add_u32 v199, v198, 3, v196
    v_lshlrev_b32_e64 v199, 7, v199
    v_lshl_add_u32 v199, v197, 3, v199
    v_lshrrev_b32 v196, 1, v196
    v_and_b32 v197, 1, v198
    v_lshl_add_u32 v196, v197, 1, v196
    s_mul_i32 s80, s76, 3
    s_add_u32 s78, s80, 0
    s_and_b32 s79, s78, 3
    s_lshr_b32 s78, s78, 2
    s_lshl_b32 s78, s78, 13
    s_add_u32 s78, s78, 16384
    v_xor_b32 v197, s79, v196
    v_lshl_add_u32 v197, v197, 5, v199
    v_add_u32_e64 v240, s78, v197
    s_add_u32 s78, s80, 1
    s_and_b32 s79, s78, 3
    s_lshr_b32 s78, s78, 2
    s_lshl_b32 s78, s78, 13
    s_add_u32 s78, s78, 16384
    v_xor_b32_e64 v197, s79, v196
    v_lshl_add_u32 v197, v197, 5, v199
    v_add_u32_e64 v241, s78, v197
    s_add_u32 s78, s80, 2
    s_and_b32 s79, s78, 3
    s_lshr_b32 s78, s78, 2
    s_lshl_b32 s78, s78, 13
    s_add_u32 s78, s78, 16384
    v_xor_b32_e64 v197, s79, v196
    v_lshl_add_u32 v197, v197, 5, v199
    v_add_u32_e64 v242, s78, v197
    s_and_b32 s82, s70, 1
    s_and_b32 s83, s69, 1
    s_add_u32 m0, s88, 36864
    s_nop 0
    buffer_load_dwordx4 v4, s[28:31], s86 offen  lds
    v_lshrrev_b32 v196, 3, v2
    v_and_b32 v197, 7, v2
    v_lshlrev_b32 v199, 4, v197
    v_mul_u32_u24 v244, 57344, v196
    buffer_load_dwordx4 v5, s[28:31], s86 offen offset:1024  lds
    v_add_u32_e64 v244, v244, v199
    v_lshl_add_u32 v245, v196, 14, v199
    s_lshl_b32 s78, s74, 2
    s_add_u32 s78, s78, s76
    s_add_u32 m0, s89, 61440
    s_add_u32 s101, s87, 2048
    buffer_load_dwordx4 v6, s[32:35], s101 offen  lds
    s_mul_i32 s79, s78, 458752
    s_add_u32 s80, s73, s76
    s_and_b32 s80, s80, 3
    s_andn2_b32 s100, s73, 3
    buffer_load_dwordx4 v7, s[32:35], s101 offen offset:1024  lds
    s_or_b32 s80, s80, s100
    s_lshl_b32 s80, s80, 7
    s_add_u32 s79, s79, s80
    s_cmp_ge_u32 s73, 56
    s_cselect_b32 s79, 0x8000000, s79
    v_add_u32_e64 v244, s79, v244
    s_lshl_b32 s78, s78, 7
    s_add_u32 m0, s88, 38912
    s_add_u32 s101, s86, 32768
    buffer_load_dwordx4 v4, s[28:31], s101 offen  lds
    s_lshl_b32 s80, s73, 17
    s_add_u32 s78, s78, s80
    v_add_u32 v245, s78, v245
    s_lshl_b32 s78, s72, 7
    buffer_load_dwordx4 v5, s[28:31], s101 offen offset:1024  lds
    v_lshl_add_u32 v196, v196, 11, s78
    v_and_b32 v199, 1, v198
    v_lshlrev_b32 v199, 2, v199
    v_xor_b32_e64 v199, v199, v197
    s_add_u32 m0, s89, 69632
    s_add_u32 s101, s87, 4096
    buffer_load_dwordx4 v6, s[32:35], s101 offen  lds
    v_lshl_add_u32 v246, v199, 4, v196
    s_lshl_b32 s78, s71, 2
    s_add_u32 s78, s78, s76
    s_lshl_b32 s78, s78, 16
    v_add_u32 v196, s78, v196
    buffer_load_dwordx4 v7, s[32:35], s101 offen offset:1024  lds
    v_xor_b32_e64 v199, v198, v197
    v_lshl_add_u32 v247, v199, 4, v196
    v_xor_b32 v248, 64, v247
    s_lshl_b32 s78, s76, 14
    s_add_u32 m0, s89, 53248
    s_nop 0
    buffer_load_dwordx4 v6, s[32:35], s87 offen  lds
    v_add_u32_e64 v246, s78, v246
    s_lshl_b32 s84, s76, 10
    s_bfe_u32 s78, s2, 0x40003
    s_lshl_b32 s78, s78, 17
    buffer_load_dwordx4 v7, s[32:35], s87 offen offset:1024  lds
    s_add_u32 s86, s86, 128
    s_add_u32 s87, s87, 393216
    s_and_b32 s86, s86, 2047
    s_cselect_b32 s87, s87, 0
    s_and_b32 s79, s72, 8
    s_add_u32 s79, s79, 3
    s_lshl_b32 s79, s79, 7
    s_add_u32 s78, s78, s79
    v_lshl_add_u32 v63, v2, 11, s78
    s_waitcnt vmcnt(10)
    s_barrier
    s_cmp_lg_u32 s82, 0
    s_cbranch_scc1 Lsx_1
    v_add_u32 v196, 118784, v60
    v_add_u32 v197, 118784, v61
    ds_read_b128 v[20:23], v196 offset:0
    ds_read_b128 v[24:27], v196 offset:2048
    ds_read_b128 v[28:31], v197 offset:0
    ds_read_b128 v[32:35], v197 offset:2048
Lsx_1:
    s_cmp_lg_u32 s83, 0
    s_cbranch_scc1 Lsw_2
    v_add_u32 v198, 118784, v240
    v_add_u32 v199, 118784, v241
    v_add_u32 v200, 118784, v242
    ds_read_b64_tr_b16 v[36:37], v198 offset:0
    ds_read_b64_tr_b16 v[38:39], v198 offset:512
    ds_read_b64_tr_b16 v[40:41], v198 offset:4096
    ds_read_b64_tr_b16 v[42:43], v198 offset:4608
    ds_read_b64_tr_b16 v[44:45], v199 offset:0
    ds_read_b64_tr_b16 v[46:47], v199 offset:512
    ds_read_b64_tr_b16 v[48:49], v199 offset:4096
    ds_read_b64_tr_b16 v[50:51], v199 offset:4608
    ds_read_b64_tr_b16 v[52:53], v200 offset:0
    ds_read_b64_tr_b16 v[54:55], v200 offset:512
    ds_read_b64_tr_b16 v[56:57], v200 offset:4096
    ds_read_b64_tr_b16 v[58:59], v200 offset:4608
Lsw_2:
    s_add_u32 m0, s88, 77824
    s_nop 0
    s_nop 0
    buffer_load_dwordx4 v4, s[28:31], s86 offen  lds
    buffer_load_dwordx4 v5, s[28:31], s86 offen offset:1024  lds
    s_add_u32 m0, s89, 102400
    s_add_u32 s101, s87, 2048
    buffer_load_dwordx4 v6, s[32:35], s101 offen  lds
    buffer_load_dwordx4 v7, s[32:35], s101 offen offset:1024  lds
    s_add_u32 m0, s88, 79872
    s_add_u32 s101, s86, 32768
    buffer_load_dwordx4 v4, s[28:31], s101 offen  lds
    buffer_load_dwordx4 v5, s[28:31], s101 offen offset:1024  lds
    s_add_u32 m0, s89, 110592
    s_add_u32 s101, s87, 4096
    buffer_load_dwordx4 v6, s[32:35], s101 offen  lds
    buffer_load_dwordx4 v7, s[32:35], s101 offen offset:1024  lds
    s_add_u32 m0, s89, 94208
    s_nop 0
    buffer_load_dwordx4 v6, s[32:35], s87 offen  lds
    buffer_load_dwordx4 v7, s[32:35], s87 offen offset:1024  lds
    s_add_u32 s86, s86, 128
    s_add_u32 s87, s87, 393216
    s_and_b32 s86, s86, 2047
    s_cselect_b32 s87, s87, 0
    s_waitcnt lgkmcnt(0)
    s_mul_i32 s75, s75, 0x9E3779B1
    s_add_u32 s75, s75, 0x7F4A7C15
    s_waitcnt vmcnt(10)
    s_waitcnt lgkmcnt(0)
    s_barrier
    s_cmp_lg_u32 s82, 1
    s_cbranch_scc1 Lsx_3
    v_add_u32 v196, 36864, v60
    v_add_u32 v197, 36864, v61
    ds_read_b128 v[20:23], v196 offset:0
    ds_read_b128 v[24:27], v196 offset:2048
    ds_read_b128 v[28:31], v197 offset:0
    ds_read_b128 v[32:35], v197 offset:2048
Lsx_3:
    s_cmp_lg_u32 s83, 1
    s_cbranch_scc1 Lsw_4
    v_add_u32 v198, 36864, v240
    v_add_u32 v199, 36864, v241
    v_add_u32 v200, 36864, v242
    ds_read_b64_tr_b16 v[36:37], v198 offset:0
    ds_read_b64_tr_b16 v[38:39], v198 offset:512
    ds_read_b64_tr_b16 v[40:41], v198 offset:4096
    ds_read_b64_tr_b16 v[42:43], v198 offset:4608
    ds_read_b64_tr_b16 v[44:45], v199 offset:0
    ds_read_b64_tr_b16 v[46:47], v199 offset:512
    ds_read_b64_tr_b16 v[48:49], v199 offset:4096
    ds_read_b64_tr_b16 v[50:51], v199 offset:4608
    ds_read_b64_tr_b16 v[52:53], v200 offset:0
    ds_read_b64_tr_b16 v[54:55], v200 offset:512
    ds_read_b64_tr_b16 v[56:57], v200 offset:4096
    ds_read_b64_tr_b16 v[58:59], v200 offset:4608
Lsw_4:
    s_add_u32 m0, s88, 118784
    s_nop 0
    s_nop 0
    buffer_load_dwordx4 v4, s[28:31], s86 offen  lds
    buffer_load_dwordx4 v5, s[28:31], s86 offen offset:1024  lds
    s_add_u32 m0, s89, 143360
    s_add_u32 s101, s87, 2048
    buffer_load_dwordx4 v6, s[32:35], s101 offen  lds
    buffer_load_dwordx4 v7, s[32:35], s101 offen offset:1024  lds
    s_add_u32 m0, s88, 120832
    s_add_u32 s101, s86, 32768
    buffer_load_dwordx4 v4, s[28:31], s101 offen  lds
    buffer_load_dwordx4 v5, s[28:31], s101 offen offset:1024  lds
    s_add_u32 m0, s89, 151552
    s_add_u32 s101, s87, 4096
    buffer_load_dwordx4 v6, s[32:35], s101 offen  lds
    buffer_load_dwordx4 v7, s[32:35], s101 offen offset:1024  lds
    s_add_u32 m0, s89, 135168
    s_nop 0
    buffer_load_dwordx4 v6, s[32:35], s87 offen  lds
    buffer_load_dwordx4 v7, s[32:35], s87 offen offset:1024  lds
    s_add_u32 s86, s86, 128
    s_add_u32 s87, s87, 393216
    s_and_b32 s86, s86, 2047
    s_cselect_b32 s87, s87, 0
    s_waitcnt vmcnt(10)
    s_waitcnt lgkmcnt(0)
    s_barrier
    s_mul_i32 s100, s69, 52
    s_lshr_b32 s100, s100, 8
    s_mul_i32 s100, s100, 5
    s_sub_u32 s100, s69, s100
    s_cmp_eq_u32 s100, 1
    s_cbranch_scc1 L_ph1
    s_cmp_eq_u32 s100, 2
    s_cbranch_scc1 L_ph2
    s_cmp_eq_u32 s100, 3
    s_cbranch_scc1 L_ph3
    s_cmp_eq_u32 s100, 4
    s_cbranch_scc1 L_ph4
    s_setprio 2
    s_add_u32 m0, s88, 36864
    s_nop 0
    s_nop 0
    buffer_load_dwordx4 v4, s[28:31], s86 offen  lds
    v_mov_b32 v200, 0x3f803f80
    v_mov_b32 v201, 0x3f803f80
    buffer_load_dwordx4 v5, s[28:31], s86 offen offset:1024  lds
    v_mov_b32 v202, 0x3f803f80
    v_mov_b32 v203, 0x3f803f80
    s_nop 1
    s_nop 0
    v_mfma_f32_16x16x32_bf16 v[204:207], v[200:203], v[20:23], 0
    s_add_u32 m0, s89, 61440
    s_add_u32 s101, s87, 2048
    buffer_load_dwordx4 v6, s[32:35], s101 offen  lds
    v_mfma_f32_16x16x32_bf16 v[212:215], v[20:23], v[20:23], 0
    v_mfma_f32_16x16x32_bf16 v[208:211], v[200:203], v[24:27], 0
    v_mfma_f32_16x16x32_bf16 v[216:219], v[24:27], v[24:27], 0
    buffer_load_dwordx4 v7, s[32:35], s101 offen offset:1024  lds
    v_mfma_f32_16x16x32_bf16 v[220:223], v[200:203], v[36:39], 0
    v_mfma_f32_16x16x32_bf16 v[224:227], v[200:203], v[44:47], 0
    v_mfma_f32_16x16x32_bf16 v[228:231], v[200:203], v[52:55], 0
    s_add_u32 m0, s88, 38912
    s_add_u32 s101, s86, 32768
    buffer_load_dwordx4 v4, s[28:31], s101 offen  lds
    v_mfma_f32_16x16x32_bf16 v[204:207], v[200:203], v[28:31], v[204:207]
    v_mfma_f32_16x16x32_bf16 v[212:215], v[28:31], v[28:31], v[212:215]
    v_mfma_f32_16x16x32_bf16 v[208:211], v[200:203], v[32:35], v[208:211]
    buffer_load_dwordx4 v5, s[28:31], s101 offen offset:1024  lds
    v_mfma_f32_16x16x32_bf16 v[216:219], v[32:35], v[32:35], v[216:219]
    v_mfma_f32_16x16x32_bf16 v[220:223], v[200:203], v[40:43], v[220:223]
    v_mfma_f32_16x16x32_bf16 v[224:227], v[200:203], v[48:51], v[224:227]
    s_add_u32 m0, s89, 69632
    s_add_u32 s101, s87, 4096
    buffer_load_dwordx4 v6, s[32:35], s101 offen  lds
    v_mfma_f32_16x16x32_bf16 v[228:231], v[200:203], v[56:59], v[228:231]
    v_and_b32_e64 v196, 3, v2
    v_cmp_eq_u32 s[90:91], 1, v196
    buffer_load_dwordx4 v7, s[32:35], s101 offen offset:1024  lds
    v_cmp_eq_u32 s[92:93], 2, v196
    v_cmp_eq_u32_e64 vcc, 3, v196
    v_cndmask_b32 v212, v212, v213, s[90:91]
    s_add_u32 m0, s89, 53248
    s_nop 0
    buffer_load_dwordx4 v6, s[32:35], s87 offen  lds
    v_cndmask_b32 v212, v212, v214, s[92:93]
    v_cndmask_b32 v205, v212, v215, vcc
    buffer_load_dwordx4 v7, s[32:35], s87 offen offset:1024  lds
    s_add_u32 s86, s86, 128
    s_add_u32 s87, s87, 393216
    s_and_b32 s86, s86, 2047
    s_cselect_b32 s87, s87, 0
    v_cndmask_b32 v216, v216, v217, s[90:91]
    v_cndmask_b32 v216, v216, v218, s[92:93]
    v_cndmask_b32_e64 v209, v216, v219, vcc
    s_mov_b32 s100, 0
    buffer_load_dwordx4 v[64:67], v244, s[48:51], s100 offen nt
    v_lshrrev_b32_e64 v196, 4, v2
    v_cmp_eq_u32 s[90:91], 1, v196
    v_cmp_eq_u32 vcc, 2, v196
    s_mov_b32 s100, 0
    buffer_load_dwordx4 v[96:99], v244, s[52:55], s100 offen nt
    v_cndmask_b32 v220, v220, v224, s[90:91]
    v_cndmask_b32_e64 v220, v220, v228, vcc
    s_mul_i32 s78, s77, 768
    s_mov_b32 s100, 7168
    buffer_load_dwordx4 v[68:71], v244, s[48:51], s100 offen nt
    s_mul_i32 s79, s76, 192
    s_add_u32 s78, s78, s79
    s_add_u32 s78, s78, 327680
    s_mov_b32 s100, 7168
    buffer_load_dwordx4 v[100:103], v244, s[52:55], s100 offen nt
    v_lshlrev_b32 v197, 2, v2
    s_mov_b32 exec_hi, 0xffff
    buffer_store_dword v220, v197, s[36:39], s78 offen sc1
    s_mov_b32 exec_hi, -1
    s_lshl_b32 s78, s69, 4
    s_mov_b32 s100, 14336
    buffer_load_dwordx4 v[72:75], v244, s[48:51], s100 offen nt
    s_add_u32 s78, s78, s70
    s_lshl_b32 s78, s78, 10
    s_lshl_b32 s79, s76, 8
    s_mov_b32 s100, 14336
    buffer_load_dwordx4 v[104:107], v244, s[52:55], s100 offen nt
    s_add_u32 s78, s78, s79
    s_add_u32 s78, s78, 65536
    v_and_b32_e64 v198, 15, v2
    s_mov_b32 s100, 21504
    buffer_load_dwordx4 v[76:79], v244, s[48:51], s100 offen nt
    v_lshlrev_b32_e64 v198, 3, v198
    s_mov_b32 exec_lo, 0x00f0000f
    s_mov_b32 exec_hi, 0xf0000f00
    buffer_store_dwordx2 v[204:205], v198, s[36:39], s78 offen offset:0 sc1
    s_mov_b64 exec, -1
    s_mov_b32 exec_lo, 0x00f0000f
    s_mov_b32 exec_hi, 0xf0000f00
    buffer_store_dwordx2 v[208:209], v198, s[36:39], s78 offen offset:128 sc1
    s_mov_b64 exec, -1
    s_setprio 0
    s_waitcnt vmcnt(20)
    s_waitcnt lgkmcnt(0)
    s_barrier
    s_add_u32 m0, s88, 77824
    s_nop 0
    s_nop 0
    buffer_load_dwordx4 v4, s[28:31], s86 offen  lds
    buffer_load_dwordx4 v5, s[28:31], s86 offen offset:1024  lds
    s_add_u32 m0, s89, 102400
    s_add_u32 s101, s87, 2048
    buffer_load_dwordx4 v6, s[32:35], s101 offen  lds
    buffer_load_dwordx4 v7, s[32:35], s101 offen offset:1024  lds
    s_add_u32 m0, s88, 79872
    s_add_u32 s101, s86, 32768
    buffer_load_dwordx4 v4, s[28:31], s101 offen  lds
    buffer_load_dwordx4 v5, s[28:31], s101 offen offset:1024  lds
    s_add_u32 m0, s89, 110592
    s_add_u32 s101, s87, 4096
    buffer_load_dwordx4 v6, s[32:35], s101 offen  lds
    buffer_load_dwordx4 v7, s[32:35], s101 offen offset:1024  lds
    s_add_u32 m0, s89, 94208
    s_nop 0
    buffer_load_dwordx4 v6, s[32:35], s87 offen  lds
    buffer_load_dwordx4 v7, s[32:35], s87 offen offset:1024  lds
    s_add_u32 s86, s86, 128
    s_add_u32 s87, s87, 393216
    s_and_b32 s86, s86, 2047
    s_cselect_b32 s87, s87, 0
    buffer_store_dwordx4 v[16:19], v14, s[36:39], s96 offen offset:0 sc1
    s_waitcnt vmcnt(21)
    s_waitcnt lgkmcnt(0)
    s_barrier
    s_add_u32 m0, s88, 118784
    s_nop 0
    buffer_load_dwordx4 v4, s[28:31], s86 offen  lds
    buffer_load_dwordx4 v5, s[28:31], s86 offen offset:1024  lds
    s_add_u32 m0, s89, 143360
    s_add_u32 s101, s87, 2048
    buffer_load_dwordx4 v6, s[32:35], s101 offen  lds
    buffer_load_dwordx4 v7, s[32:35], s101 offen offset:1024  lds
    s_add_u32 m0, s88, 120832
    s_add_u32 s101, s86, 32768
    buffer_load_dwordx4 v4, s[28:31], s101 offen  lds
    buffer_load_dwordx4 v5, s[28:31], s101 offen offset:1024  lds
    s_add_u32 m0, s89, 151552
    s_add_u32 s101, s87, 4096
    buffer_load_dwordx4 v6, s[32:35], s101 offen  lds
    buffer_load_dwordx4 v7, s[32:35], s101 offen offset:1024  lds
    s_add_u32 m0, s89, 135168
    s_nop 0
    buffer_load_dwordx4 v6, s[32:35], s87 offen  lds
    buffer_load_dwordx4 v7, s[32:35], s87 offen offset:1024  lds
    s_add_u32 s86, s86, 128
    s_add_u32 s87, s87, 393216
    s_and_b32 s86, s86, 2047
    s_cselect_b32 s87, s87, 0
    s_waitcnt vmcnt(10)
    s_barrier
    s_cmp_lg_u32 s76, 0
    s_cbranch_scc1 Lfl_5
    s_getreg_b32 s99, hwreg(HW_REG_XCC_ID, 0, 4)
    v_mov_b32 v198, s75
    v_mov_b32 v199, s99
    v_lshlrev_b32_e64 v197, 3, v2
    s_lshl_b32 s78, s77, 7
    s_add_u32 s79, s78, 8781824
    s_add_u32 s78, s78, 4096
    s_lshl_b32 s80, s71, 4
    s_add_u32 s80, s80, s72
    s_lshl_b32 s80, s80, 7
    s_add_u32 s80, s80, 8847360
    s_mov_b64 exec, 0xffff
    buffer_store_dwordx2 v[198:199], v197, s[36:39], s78 offen sc1
    buffer_store_dwordx2 v[198:199], v197, s[36:39], s80 offen sc1
    v_not_b32 v200, v198
    v_mov_b32_e64 v201, 0
    buffer_store_dwordx2 v[200:201], v197, s[36:39], s79 offen sc1
    s_mov_b64 exec, -1
    v_and_b32 v196, 15, v2
    v_lshlrev_b32 v197, 4, v196
    v_add_u32 v197, s69, v197
    s_lshl_b32 s78, s70, 4
    s_lshl_b32 s79, s71, 4
    s_add_u32 s79, s79, 69088
    v_mov_b32 v202, s78
    v_mov_b32 v203, s79
    v_cmp_gt_u32 vcc, 32, v2
    s_nop 1
    v_cndmask_b32 v202, v203, v202, vcc
    v_add_u32 v196, v202, v196
    v_cmp_gt_u32 vcc, 16, v2
    s_nop 1
    v_cndmask_b32 v196, v196, v197, vcc
    v_lshlrev_b32 v196, 7, v196
    v_add_u32 v196, 4096, v196
Lfl_5:
    s_add_u32 m0, s88, 36864
    s_nop 0
    s_nop 0
    buffer_load_dwordx4 v4, s[28:31], s86 offen  lds
    buffer_load_dwordx4 v5, s[28:31], s86 offen offset:1024  lds
    s_add_u32 m0, s89, 61440
    s_add_u32 s101, s87, 2048
    buffer_load_dwordx4 v6, s[32:35], s101 offen  lds
    buffer_load_dwordx4 v7, s[32:35], s101 offen offset:1024  lds
    s_add_u32 m0, s88, 38912
    s_add_u32 s101, s86, 32768
    buffer_load_dwordx4 v4, s[28:31], s101 offen  lds
    buffer_load_dwordx4 v5, s[28:31], s101 offen offset:1024  lds
    s_add_u32 m0, s89, 69632
    s_add_u32 s101, s87, 4096
    buffer_load_dwordx4 v6, s[32:35], s101 offen  lds
    buffer_load_dwordx4 v7, s[32:35], s101 offen offset:1024  lds
    s_add_u32 m0, s89, 53248
    s_nop 0
    buffer_load_dwordx4 v6, s[32:35], s87 offen  lds
    buffer_load_dwordx4 v7, s[32:35], s87 offen offset:1024  lds
    s_add_u32 s86, s86, 128
    s_add_u32 s87, s87, 393216
    s_and_b32 s86, s86, 2047
    s_cselect_b32 s87, s87, 0
    s_waitcnt vmcnt(10)
    s_barrier
    s_add_u32 m0, s88, 77824
    s_nop 0
    s_nop 0
    buffer_load_dwordx4 v4, s[28:31], s86 offen  lds
    buffer_load_dwordx4 v5, s[28:31], s86 offen offset:1024  lds
    s_add_u32 m0, s89, 102400
    s_add_u32 s101, s87, 2048
    buffer_load_dwordx4 v6, s[32:35], s101 offen  lds
    buffer_load_dwordx4 v7, s[32:35], s101 offen offset:1024  lds
    s_add_u32 m0, s88, 79872
    s_add_u32 s101, s86, 32768
    buffer_load_dwordx4 v4, s[28:31], s101 offen  lds
    buffer_load_dwordx4 v5, s[28:31], s101 offen offset:1024  lds
    s_add_u32 m0, s89, 110592
    s_add_u32 s101, s87, 4096
    buffer_load_dwordx4 v6, s[32:35], s101 offen  lds
    buffer_load_dwordx4 v7, s[32:35], s101 offen offset:1024  lds
    s_add_u32 m0, s89, 94208
    s_nop 0
    buffer_load_dwordx4 v6, s[32:35], s87 offen  lds
    buffer_load_dwordx4 v7, s[32:35], s87 offen offset:1024  lds
    s_add_u32 s86, s86, 128
    s_add_u32 s87, s87, 393216
    s_and_b32 s86, s86, 2047
    s_cselect_b32 s87, s87, 0
    s_waitcnt vmcnt(10)
    s_barrier
    s_add_u32 m0, s88, 118784
    s_nop 0
    s_nop 0
    buffer_load_dwordx4 v4, s[28:31], s86 offen  lds
    buffer_load_dwordx4 v5, s[28:31], s86 offen offset:1024  lds
    s_add_u32 m0, s89, 143360
    s_add_u32 s101, s87, 2048
    buffer_load_dwordx4 v6, s[32:35], s101 offen  lds
    buffer_load_dwordx4 v7, s[32:35], s101 offen offset:1024  lds
    s_add_u32 m0, s88, 120832
    s_add_u32 s101, s86, 32768
    buffer_load_dwordx4 v4, s[28:31], s101 offen  lds
    buffer_load_dwordx4 v5, s[28:31], s101 offen offset:1024  lds
    s_add_u32 m0, s89, 151552
    s_add_u32 s101, s87, 4096
    buffer_load_dwordx4 v6, s[32:35], s101 offen  lds
    buffer_load_dwordx4 v7, s[32:35], s101 offen offset:1024  lds
    s_add_u32 m0, s89, 135168
    s_nop 0
    buffer_load_dwordx4 v6, s[32:35], s87 offen  lds
    buffer_load_dwordx4 v7, s[32:35], s87 offen offset:1024  lds
    s_add_u32 s86, s86, 128
    s_add_u32 s87, s87, 393216
    s_and_b32 s86, s86, 2047
    s_cselect_b32 s87, s87, 0
    s_mov_b32 s100, 21504
    buffer_load_dwordx4 v[108:111], v244, s[52:55], s100 offen nt
    s_mov_b32 s100, 28672
    buffer_load_dwordx4 v[80:83], v244, s[48:51], s100 offen nt
    s_mov_b32 s100, 28672
    buffer_load_dwordx4 v[112:115], v244, s[52:55], s100 offen nt
    s_mov_b32 s100, 35840
    buffer_load_dwordx4 v[84:87], v244, s[48:51], s100 offen nt
    s_mov_b32 s100, 35840
    buffer_load_dwordx4 v[116:119], v244, s[52:55], s100 offen nt
    s_mov_b32 s100, 43008
    buffer_load_dwordx4 v[88:91], v244, s[48:51], s100 offen nt
    s_mov_b32 s100, 43008
    buffer_load_dwordx4 v[120:123], v244, s[52:55], s100 offen nt
    s_waitcnt vmcnt(17)
    s_barrier
    s_add_u32 m0, s88, 36864
    s_nop 0
    s_nop 0
    buffer_load_dwordx4 v4, s[28:31], s86 offen  lds
    buffer_load_dwordx4 v5, s[28:31], s86 offen offset:1024  lds
    s_add_u32 m0, s89, 61440
    s_add_u32 s101, s87, 2048
    buffer_load_dwordx4 v6, s[32:35], s101 offen  lds
    buffer_load_dwordx4 v7, s[32:35], s101 offen offset:1024  lds
    s_add_u32 m0, s88, 38912
    s_add_u32 s101, s86, 32768
    buffer_load_dwordx4 v4, s[28:31], s101 offen  lds
    buffer_load_dwordx4 v5, s[28:31], s101 offen offset:1024  lds
    s_add_u32 m0, s89, 69632
    s_add_u32 s101, s87, 4096
    buffer_load_dwordx4 v6, s[32:35], s101 offen  lds
    buffer_load_dwordx4 v7, s[32:35], s101 offen offset:1024  lds
    s_add_u32 m0, s89, 53248
    s_nop 0
    buffer_load_dwordx4 v6, s[32:35], s87 offen  lds
    buffer_load_dwordx4 v7, s[32:35], s87 offen offset:1024  lds
    s_add_u32 s86, s86, 128
    s_add_u32 s87, s87, 393216
    s_and_b32 s86, s86, 2047
    s_cselect_b32 s87, s87, 0
    s_waitcnt vmcnt(17)
    s_barrier
    s_add_u32 m0, s88, 77824
    s_nop 0
    s_nop 0
    buffer_load_dwordx4 v4, s[28:31], s86 offen  lds
    buffer_load_dwordx4 v5, s[28:31], s86 offen offset:1024  lds
    s_add_u32 m0, s89, 102400
    s_add_u32 s101, s87, 2048
    buffer_load_dwordx4 v6, s[32:35], s101 offen  lds
    buffer_load_dwordx4 v7, s[32:35], s101 offen offset:1024  lds
    s_add_u32 m0, s88, 79872
    s_add_u32 s101, s86, 32768
    buffer_load_dwordx4 v4, s[28:31], s101 offen  lds
    buffer_load_dwordx4 v5, s[28:31], s101 offen offset:1024  lds
    s_add_u32 m0, s89, 110592
    s_add_u32 s101, s87, 4096
    buffer_load_dwordx4 v6, s[32:35], s101 offen  lds
    buffer_load_dwordx4 v7, s[32:35], s101 offen offset:1024  lds
    s_add_u32 m0, s89, 94208
    s_nop 0
    buffer_load_dwordx4 v6, s[32:35], s87 offen  lds
    buffer_load_dwordx4 v7, s[32:35], s87 offen offset:1024  lds
    s_add_u32 s86, s86, 128
    s_add_u32 s87, s87, 393216
    s_and_b32 s86, s86, 2047
    s_cselect_b32 s87, s87, 0
    s_waitcnt vmcnt(10)
    s_barrier
    s_add_u32 m0, s88, 118784
    s_nop 0
    s_nop 0
    buffer_load_dwordx4 v4, s[28:31], s86 offen  lds
    buffer_load_dwordx4 v5, s[28:31], s86 offen offset:1024  lds
    s_add_u32 m0, s89, 143360
    s_add_u32 s101, s87, 2048
    buffer_load_dwordx4 v6, s[32:35], s101 offen  lds
    buffer_load_dwordx4 v7, s[32:35], s101 offen offset:1024  lds
    s_add_u32 m0, s88, 120832
    s_add_u32 s101, s86, 32768
    buffer_load_dwordx4 v4, s[28:31], s101 offen  lds
    buffer_load_dwordx4 v5, s[28:31], s101 offen offset:1024  lds
    s_add_u32 m0, s89, 151552
    s_add_u32 s101, s87, 4096
    buffer_load_dwordx4 v6, s[32:35], s101 offen  lds
    buffer_load_dwordx4 v7, s[32:35], s101 offen offset:1024  lds
    s_add_u32 m0, s89, 135168
    s_nop 0
    buffer_load_dwordx4 v6, s[32:35], s87 offen  lds
    buffer_load_dwordx4 v7, s[32:35], s87 offen offset:1024  lds
    s_add_u32 s86, s86, 128
    s_add_u32 s87, s87, 393216
    s_and_b32 s86, s86, 2047
    s_cselect_b32 s87, s87, 0
    s_waitcnt vmcnt(10)
    s_barrier
    s_add_u32 m0, s88, 36864
    s_nop 0
    s_nop 0
    buffer_load_dwordx4 v4, s[28:31], s86 offen  lds
    buffer_load_dwordx4 v5, s[28:31], s86 offen offset:1024  lds
    s_add_u32 m0, s89, 61440
    s_add_u32 s101, s87, 2048
    buffer_load_dwordx4 v6, s[32:35], s101 offen  lds
    buffer_load_dwordx4 v7, s[32:35], s101 offen offset:1024  lds
    s_add_u32 m0, s88, 38912
    s_add_u32 s101, s86, 32768
    buffer_load_dwordx4 v4, s[28:31], s101 offen  lds
    buffer_load_dwordx4 v5, s[28:31], s101 offen offset:1024  lds
    s_add_u32 m0, s89, 69632
    s_add_u32 s101, s87, 4096
    buffer_load_dwordx4 v6, s[32:35], s101 offen  lds
    buffer_load_dwordx4 v7, s[32:35], s101 offen offset:1024  lds
    s_add_u32 m0, s89, 53248
    s_nop 0
    buffer_load_dwordx4 v6, s[32:35], s87 offen  lds
    buffer_load_dwordx4 v7, s[32:35], s87 offen offset:1024  lds
    s_add_u32 s86, s86, 128
    s_add_u32 s87, s87, 393216
    s_and_b32 s86, s86, 2047
    s_cselect_b32 s87, s87, 0
    s_waitcnt vmcnt(10)
    s_barrier
    s_cmp_lg_u32 s76, 0
    s_cbranch_scc1 Lpl_6
    s_mov_b32 exec_hi, 0xffff
    buffer_load_dwordx2 v[198:199], v196, s[36:39], 0 offen sc1
    s_mov_b64 exec, -1
Lpl_6:
    s_add_u32 m0, s88, 77824
    s_nop 0
    buffer_load_dwordx4 v4, s[28:31], s86 offen  lds
    buffer_load_dwordx4 v5, s[28:31], s86 offen offset:1024  lds
    s_add_u32 m0, s89, 102400
    s_add_u32 s101, s87, 2048
    buffer_load_dwordx4 v6, s[32:35], s101 offen  lds
    buffer_load_dwordx4 v7, s[32:35], s101 offen offset:1024  lds
    s_add_u32 m0, s88, 79872
    s_add_u32 s101, s86, 32768
    buffer_load_dwordx4 v4, s[28:31], s101 offen  lds
    buffer_load_dwordx4 v5, s[28:31], s101 offen offset:1024  lds
    s_add_u32 m0, s89, 110592
    s_add_u32 s101, s87, 4096
    buffer_load_dwordx4 v6, s[32:35], s101 offen  lds
    buffer_load_dwordx4 v7, s[32:35], s101 offen offset:1024  lds
    s_add_u32 m0, s89, 94208
    s_nop 0
    buffer_load_dwordx4 v6, s[32:35], s87 offen  lds
    buffer_load_dwordx4 v7, s[32:35], s87 offen offset:1024  lds
    s_add_u32 s86, s86, 128
    s_add_u32 s87, s87, 393216
    s_and_b32 s86, s86, 2047
    s_cselect_b32 s87, s87, 0
    s_waitcnt vmcnt(10)
    s_barrier
    s_cmp_lg_u32 s76, 2
    s_cbranch_scc1 Lc4_7
    s_mov_b32 exec_hi, -1
    buffer_load_dword v238, v63, s[40:43], 0 offen
    s_mov_b64 exec, -1
Lc4_7:
    s_add_u32 m0, s88, 118784
    s_nop 0
    s_nop 0
    buffer_load_dwordx4 v4, s[28:31], s86 offen  lds
    buffer_load_dwordx4 v5, s[28:31], s86 offen offset:1024  lds
    s_add_u32 m0, s89, 143360
    s_add_u32 s101, s87, 2048
    buffer_load_dwordx4 v6, s[32:35], s101 offen  lds
    buffer_load_dwordx4 v7, s[32:35], s101 offen offset:1024  lds
    s_add_u32 m0, s88, 120832
    s_add_u32 s101, s86, 32768
    buffer_load_dwordx4 v4, s[28:31], s101 offen  lds
    buffer_load_dwordx4 v5, s[28:31], s101 offen offset:1024  lds
    s_add_u32 m0, s89, 151552
    s_add_u32 s101, s87, 4096
    buffer_load_dwordx4 v6, s[32:35], s101 offen  lds
    buffer_load_dwordx4 v7, s[32:35], s101 offen offset:1024  lds
    s_add_u32 m0, s89, 135168
    s_nop 0
    buffer_load_dwordx4 v6, s[32:35], s87 offen  lds
    buffer_load_dwordx4 v7, s[32:35], s87 offen offset:1024  lds
    s_add_u32 s86, s86, 128
    s_add_u32 s87, s87, 393216
    s_and_b32 s86, s86, 2047
    s_cselect_b32 s87, s87, 0
    s_waitcnt vmcnt(10)
    s_cmp_lg_u32 s76, 0
    s_cbranch_scc1 Lpc_8
    s_mov_b32 exec_hi, 0xffff
    s_mov_b32 s85, 0
    s_branch Lpk_9
Lspin_10:
    s_add_u32 s85, s85, 1
    s_cmp_gt_u32 s85, 400000
    s_cbranch_scc1 L_end
    buffer_load_dwordx2 v[198:199], v196, s[36:39], 0 offen sc1
    s_waitcnt vmcnt(0)
Lpk_9:
    v_cmp_ne_u32 vcc, s75, v198
    s_cbranch_vccnz Lspin_10
    v_cmp_ne_u32 vcc, s99, v199
    s_mov_b64 exec, -1
    s_lshr_b32 s78, vcc_lo, 16
    s_cselect_b32 s78, 0, 1
    s_cmp_eq_u32 vcc_hi, 0
    s_cselect_b32 s79, 2, 0
    s_or_b32 s78, s78, s79
    s_and_b32 s78, s78, 3
    v_mov_b32_e64 v198, s78
    v_mov_b32 v199, 163584
    ds_write_b32 v199, v198
    s_waitcnt lgkmcnt(0)
Lpc_8:
    s_barrier
    v_lshrrev_b32 v196, 4, v2
    v_and_b32 v197, 15, v2
    v_lshlrev_b32_e64 v197, 4, v197
    v_lshl_add_u32 v198, v196, 10, v197
    s_lshl_b32 s78, s69, 14
    s_lshl_b32 s79, s76, 8
    s_add_u32 s78, s78, s79
    s_nop 0
    s_add_u32 s78, s78, 65536
    buffer_load_dwordx4 v[20:23], v198, s[36:39], s78 offen sc1
    s_add_u32 s78, s78, 4096
    buffer_load_dwordx4 v[24:27], v198, s[36:39], s78 offen sc1
    s_add_u32 s78, s78, 4096
    buffer_load_dwordx4 v[28:31], v198, s[36:39], s78 offen sc1
    s_add_u32 s78, s78, 4096
    buffer_load_dwordx4 v[32:35], v198, s[36:39], s78 offen sc1
    v_mul_u32_u24 v198, 768, v196
    v_add_u32_e64 v198, v198, v197
    s_mul_i32 s78, s70, 12288
    s_lshl_b32 s79, s76, 8
    s_add_u32 s78, s78, s79
    s_add_u32 s78, s78, 327680
    s_cmp_eq_u32 s76, 3
    s_nop 0
    s_cselect_b32 s78, 0x10000000, s78
    buffer_load_dwordx4 v[36:39], v198, s[36:39], s78 offen sc1
    s_add_u32 s78, s78, 3072
    buffer_load_dwordx4 v[40:43], v198, s[36:39], s78 offen sc1
    s_add_u32 s78, s78, 3072
    buffer_load_dwordx4 v[44:47], v198, s[36:39], s78 offen sc1
    s_add_u32 s78, s78, 3072
    buffer_load_dwordx4 v[48:51], v198, s[36:39], s78 offen sc1
    s_add_u32 m0, s84, 0
    s_mov_b32 s100, 0
    buffer_load_dwordx4 v246, s[40:43], s100 offen  lds
    s_add_u32 m0, s84, 4096
    s_mov_b32 s100, 65536
    buffer_load_dwordx4 v246, s[40:43], s100 offen  lds
    s_add_u32 m0, s84, 8192
    s_mov_b32 s100, 131072
    buffer_load_dwordx4 v246, s[40:43], s100 offen  lds
    s_add_u32 m0, s84, 12288
    s_mov_b32 s100, 196608
    buffer_load_dwordx4 v246, s[40:43], s100 offen  lds
    s_waitcnt vmcnt(12)
    s_waitcnt lgkmcnt(0)
    s_barrier
    s_setprio 2
    s_add_u32 m0, s84, 16384
    s_mov_b32 s100, 262144
    buffer_load_dwordx4 v246, s[40:43], s100 offen  lds
    s_waitcnt vmcnt(9)
    v_add_f32 v20, v20, v24
    v_add_f32 v21, v21, v25
    v_add_f32 v22, v22, v26
    v_add_f32 v23, v23, v27
    v_add_f32 v20, v20, v28
    v_add_f32_e64 v21, v21, v29
    s_add_u32 m0, s84, 20480
    s_mov_b32 s100, 327680
    buffer_load_dwordx4 v246, s[40:43], s100 offen  lds
    v_add_f32 v22, v22, v30
    v_add_f32 v23, v23, v31
    v_add_f32 v20, v20, v32
    v_add_f32 v21, v21, v33
    v_add_f32 v22, v22, v34
    v_add_f32 v23, v23, v35
    s_nop 0
    v_permlane32_swap_b32 v20, v22
    s_add_u32 m0, s84, 24576
    s_mov_b32 s100, 393216
    buffer_load_dwordx4 v246, s[40:43], s100 offen  lds
    v_permlane32_swap_b32 v21, v23
    v_add_f32 v20, v20, v22
    v_add_f32 v21, v21, v23
    v_mov_b32 v22, v20
    v_mov_b32 v23, v21
    s_nop 0
    v_permlane16_swap_b32 v20, v22
    v_permlane16_swap_b32 v21, v23
    v_add_f32_e64 v20, v20, v22
    s_add_u32 m0, s84, 28672
    s_mov_b32 s100, 458752
    buffer_load_dwordx4 v246, s[40:43], s100 offen  lds
    v_add_f32_e64 v21, v21, v23
    v_mul_f32 v24, 0x3a800000, v20
    v_mul_f32 v26, 0x3a800000, v21
    v_fma_f32 v26, -v24, v24, v26
    v_max_f32_e64 v26, 0, v26
    v_cvt_pk_bf16_f32 v24, v24, v24
    v_and_b32 v24, 0xffff0000, v24
    s_add_u32 m0, s84, 32768
    s_mov_b32 s100, 524288
    buffer_load_dwordx4 v246, s[40:43], s100 offen  lds
    v_cvt_pk_bf16_f32 v26, v26, v26
    v_and_b32 v26, 0xffff0000, v26
    v_add_f32 v26, 0x3727c5ac, v26
    v_cvt_pk_bf16_f32 v26, v26, v26
    v_and_b32 v26, 0xffff0000, v26
    v_sqrt_f32 v26, v26
    s_nop 0
    v_cvt_pk_bf16_f32 v26, v26, v26
    v_and_b32 v26, 0xffff0000, v26
    s_add_u32 m0, s84, 36864
    s_mov_b32 s100, 589824
    buffer_load_dwordx4 v246, s[40:43], s100 offen  lds
    v_rcp_f32_e64 v25, v26
    v_xor_b32 v26, 0x80000000, v24
    v_lshrrev_b32 v27, 16, v26
    v_or_b32 v26, v26, v27
    v_mov_b32 v27, 0
    v_and_b32 v196, 15, v2
    v_lshrrev_b32_e64 v197, 5, v2
    s_add_u32 m0, s84, 40960
    s_mov_b32 s100, 655360
    buffer_load_dwordx4 v246, s[40:43], s100 offen  lds
    v_lshl_add_u32 v196, v196, 1, v197
    s_lshl_b32 s78, s76, 5
    v_add_u32 v196, s78, v196
    v_lshlrev_b32_e64 v197, 3, v196
    v_add_u32 v197, 159744, v197
    v_lshlrev_b32_e64 v196, 2, v196
    v_add_u32 v196, 162304, v196
    s_add_u32 m0, s84, 45056
    s_mov_b32 s100, 720896
    buffer_load_dwordx4 v246, s[40:43], s100 offen  lds
    ds_write_b64 v197, v[26:27]
    ds_write_b32 v196, v25
    s_waitcnt vmcnt(12)
    v_add_f32 v36, v36, v40
    v_add_f32 v37, v37, v41
    v_add_f32 v38, v38, v42
    v_add_f32 v39, v39, v43
    v_add_f32 v36, v36, v44
    s_add_u32 m0, s84, 49152
    s_mov_b32 s100, 786432
    buffer_load_dwordx4 v246, s[40:43], s100 offen  lds
    v_add_f32 v37, v37, v45
    v_add_f32 v38, v38, v46
    v_add_f32 v39, v39, v47
    v_add_f32 v36, v36, v48
    v_add_f32 v37, v37, v49
    v_add_f32 v38, v38, v50
    v_add_f32_e64 v39, v39, v51
    s_add_u32 m0, s84, 53248
    s_mov_b32 s100, 851968
    buffer_load_dwordx4 v246, s[40:43], s100 offen  lds
    v_permlane32_swap_b32 v36, v38
    v_permlane32_swap_b32 v37, v39
    v_add_f32 v36, v36, v38
    v_add_f32 v37, v37, v39
    s_nop 1
    v_permlane16_swap_b32 v36, v37
    v_add_f32_e64 v36, v36, v37
    v_cvt_pk_bf16_f32 v37, v36, v36
    v_and_b32 v37, 0xffff0000, v37
    s_add_u32 m0, s84, 57344
    s_mov_b32 s100, 917504
    buffer_load_dwordx4 v246, s[40:43], s100 offen  lds
    v_sub_f32_e64 v38, v36, v37
    v_cvt_pk_bf16_f32 v38, v37, v38
    v_mov_b32 v39, 0
    v_and_b32 v196, 15, v2
    v_lshrrev_b32_e64 v197, 4, v2
    v_lshl_add_u32 v196, v196, 2, v197
    s_lshl_b32 s78, s76, 9
    s_add_u32 m0, s84, 61440
    s_mov_b32 s100, 983040
    buffer_load_dwordx4 v246, s[40:43], s100 offen  lds
    s_add_u32 s78, s78, 160768
    v_lshl_add_u32 v196, v196, 3, s78
    v_and_b32 v197, 15, v2
    v_lshlrev_b32_e64 v197, 3, v197
    v_add_u32 v197, 162816, v197
    v_mov_b32 v198, 0x3f803f80
    s_cmp_eq_u32 s76, 3
    s_cselect_b64 vcc, -1, 0
    v_cndmask_b32 v196, v196, v197, vcc
    v_cndmask_b32 v38, v38, v198, vcc
    v_cndmask_b32_e64 v39, v39, v198, vcc
    ds_write_b64 v196, v[38:39]
    s_setprio 0
    s_waitcnt lgkmcnt(0)
    s_barrier
    s_branch L_phend
L_ph1:
    s_setprio 2
    s_add_u32 m0, s88, 36864
    s_nop 0
    buffer_load_dwordx4 v4, s[28:31], s86 offen  lds
    v_mov_b32 v200, 0x3f803f80
    v_mov_b32 v201, 0x3f803f80
    v_mov_b32 v202, 0x3f803f80
    v_mov_b32 v203, 0x3f803f80
    buffer_load_dwordx4 v5, s[28:31], s86 offen offset:1024  lds
    s_nop 0
    s_nop 0
    v_mfma_f32_16x16x32_bf16 v[204:207], v[200:203], v[20:23], 0
    v_mfma_f32_16x16x32_bf16 v[212:215], v[20:23], v[20:23], 0
    v_mfma_f32_16x16x32_bf16 v[208:211], v[200:203], v[24:27], 0
    v_mfma_f32_16x16x32_bf16 v[216:219], v[24:27], v[24:27], 0
    v_mfma_f32_16x16x32_bf16 v[220:223], v[200:203], v[36:39], 0
    s_add_u32 m0, s89, 61440
    s_add_u32 s101, s87, 2048
    buffer_load_dwordx4 v6, s[32:35], s101 offen  lds
    v_mfma_f32_16x16x32_bf16 v[224:227], v[200:203], v[44:47], 0
    v_mfma_f32_16x16x32_bf16 v[228:231], v[200:203], v[52:55], 0
    v_mfma_f32_16x16x32_bf16 v[204:207], v[200:203], v[28:31], v[204:207]
    v_mfma_f32_16x16x32_bf16 v[212:215], v[28:31], v[28:31], v[212:215]
    v_mfma_f32_16x16x32_bf16 v[208:211], v[200:203], v[32:35], v[208:211]
    buffer_load_dwordx4 v7, s[32:35], s101 offen offset:1024  lds
    v_mfma_f32_16x16x32_bf16 v[216:219], v[32:35], v[32:35], v[216:219]
    v_mfma_f32_16x16x32_bf16 v[220:223], v[200:203], v[40:43], v[220:223]
    v_mfma_f32_16x16x32_bf16 v[224:227], v[200:203], v[48:51], v[224:227]
    v_mfma_f32_16x16x32_bf16 v[228:231], v[200:203], v[56:59], v[228:231]
    v_and_b32_e64 v196, 3, v2
    s_add_u32 m0, s88, 38912
    s_add_u32 s101, s86, 32768
    buffer_load_dwordx4 v4, s[28:31], s101 offen  lds
    v_cmp_eq_u32 s[90:91], 1, v196
    v_cmp_eq_u32 s[92:93], 2, v196
    v_cmp_eq_u32_e64 vcc, 3, v196
    v_cndmask_b32 v212, v212, v213, s[90:91]
    v_cndmask_b32 v212, v212, v214, s[92:93]
    buffer_load_dwordx4 v5, s[28:31], s101 offen offset:1024  lds
    v_cndmask_b32_e64 v205, v212, v215, vcc
    v_cndmask_b32 v216, v216, v217, s[90:91]
    v_cndmask_b32 v216, v216, v218, s[92:93]
    v_cndmask_b32 v209, v216, v219, vcc
    v_lshrrev_b32 v196, 4, v2
    s_add_u32 m0, s89, 69632
    s_add_u32 s101, s87, 4096
    buffer_load_dwordx4 v6, s[32:35], s101 offen  lds
    v_cmp_eq_u32 s[90:91], 1, v196
    v_cmp_eq_u32 vcc, 2, v196
    s_nop 0
    v_cndmask_b32 v220, v220, v224, s[90:91]
    v_cndmask_b32_e64 v220, v220, v228, vcc
    s_mul_i32 s78, s77, 768
    buffer_load_dwordx4 v7, s[32:35], s101 offen offset:1024  lds
    s_mul_i32 s79, s76, 192
    s_add_u32 s78, s78, s79
    s_add_u32 s78, s78, 327680
    v_lshlrev_b32 v197, 2, v2
    s_mov_b32 exec_hi, 0xffff
    buffer_store_dword v220, v197, s[36:39], s78 offen sc1
    s_mov_b32 exec_hi, -1
    s_add_u32 m0, s89, 53248
    s_nop 0
    buffer_load_dwordx4 v6, s[32:35], s87 offen  lds
    s_lshl_b32 s78, s69, 4
    s_add_u32 s78, s78, s70
    s_lshl_b32 s78, s78, 10
    s_lshl_b32 s79, s76, 8
    s_add_u32 s78, s78, s79
    buffer_load_dwordx4 v7, s[32:35], s87 offen offset:1024  lds
    s_add_u32 s86, s86, 128
    s_add_u32 s87, s87, 393216
    s_and_b32 s86, s86, 2047
    s_cselect_b32 s87, s87, 0
    s_add_u32 s78, s78, 65536
    v_and_b32 v198, 15, v2
    v_lshlrev_b32 v198, 3, v198
    s_mov_b32 exec_lo, 0x00f0000f
    s_mov_b32 exec_hi, 0xf0000f00
    buffer_store_dwordx2 v[204:205], v198, s[36:39], s78 offen offset:0 sc1
    s_mov_b64 exec, -1
    s_mov_b32 exec_lo, 0x00f0000f
    s_mov_b32 exec_hi, 0xf0000f00
    buffer_store_dwordx2 v[208:209], v198, s[36:39], s78 offen offset:128 sc1
    s_mov_b64 exec, -1
    s_setprio 0
    s_waitcnt vmcnt(13)
    s_waitcnt lgkmcnt(0)
    s_barrier
    s_add_u32 m0, s88, 77824
    s_nop 0
    s_nop 0
    buffer_load_dwordx4 v4, s[28:31], s86 offen  lds
    buffer_load_dwordx4 v5, s[28:31], s86 offen offset:1024  lds
    s_add_u32 m0, s89, 102400
    s_add_u32 s101, s87, 2048
    buffer_load_dwordx4 v6, s[32:35], s101 offen  lds
    buffer_load_dwordx4 v7, s[32:35], s101 offen offset:1024  lds
    s_add_u32 m0, s88, 79872
    s_add_u32 s101, s86, 32768
    buffer_load_dwordx4 v4, s[28:31], s101 offen  lds
    buffer_load_dwordx4 v5, s[28:31], s101 offen offset:1024  lds
    s_add_u32 m0, s89, 110592
    s_add_u32 s101, s87, 4096
    buffer_load_dwordx4 v6, s[32:35], s101 offen  lds
    buffer_load_dwordx4 v7, s[32:35], s101 offen offset:1024  lds
    s_add_u32 m0, s89, 94208
    s_nop 0
    buffer_load_dwordx4 v6, s[32:35], s87 offen  lds
    buffer_load_dwordx4 v7, s[32:35], s87 offen offset:1024  lds
    s_add_u32 s86, s86, 128
    s_add_u32 s87, s87, 393216
    s_and_b32 s86, s86, 2047
    s_cselect_b32 s87, s87, 0
    buffer_store_dwordx4 v[16:19], v14, s[36:39], s96 offen offset:0 sc1
    s_mov_b32 s100, 0
    buffer_load_dwordx4 v[64:67], v244, s[48:51], s100 offen nt
    s_mov_b32 s100, 0
    buffer_load_dwordx4 v[96:99], v244, s[52:55], s100 offen nt
    s_mov_b32 s100, 7168
    buffer_load_dwordx4 v[68:71], v244, s[48:51], s100 offen nt
    s_mov_b32 s100, 7168
    buffer_load_dwordx4 v[100:103], v244, s[52:55], s100 offen nt
    s_mov_b32 s100, 14336
    buffer_load_dwordx4 v[72:75], v244, s[48:51], s100 offen nt
    s_mov_b32 s100, 14336
    buffer_load_dwordx4 v[104:107], v244, s[52:55], s100 offen nt
    s_mov_b32 s100, 21504
    buffer_load_dwordx4 v[76:79], v244, s[48:51], s100 offen nt
    s_waitcnt vmcnt(20)
    s_waitcnt lgkmcnt(0)
    s_barrier
    s_add_u32 m0, s88, 118784
    s_nop 0
    buffer_load_dwordx4 v4, s[28:31], s86 offen  lds
    buffer_load_dwordx4 v5, s[28:31], s86 offen offset:1024  lds
    s_add_u32 m0, s89, 143360
    s_add_u32 s101, s87, 2048
    buffer_load_dwordx4 v6, s[32:35], s101 offen  lds
    buffer_load_dwordx4 v7, s[32:35], s101 offen offset:1024  lds
    s_add_u32 m0, s88, 120832
    s_add_u32 s101, s86, 32768
    buffer_load_dwordx4 v4, s[28:31], s101 offen  lds
    buffer_load_dwordx4 v5, s[28:31], s101 offen offset:1024  lds
    s_add_u32 m0, s89, 151552
    s_add_u32 s101, s87, 4096
    buffer_load_dwordx4 v6, s[32:35], s101 offen  lds
    buffer_load_dwordx4 v7, s[32:35], s101 offen offset:1024  lds
    s_add_u32 m0, s89, 135168
    s_nop 0
    buffer_load_dwordx4 v6, s[32:35], s87 offen  lds
    buffer_load_dwordx4 v7, s[32:35], s87 offen offset:1024  lds
    s_add_u32 s86, s86, 128
    s_add_u32 s87, s87, 393216
    s_and_b32 s86, s86, 2047
    s_cselect_b32 s87, s87, 0
    s_waitcnt vmcnt(17)
    s_barrier
    s_cmp_lg_u32 s76, 0
    s_cbranch_scc1 Lfl_11
    s_getreg_b32 s99, hwreg(HW_REG_XCC_ID, 0, 4)
    v_mov_b32 v198, s75
    v_mov_b32 v199, s99
    v_lshlrev_b32_e64 v197, 3, v2
    s_lshl_b32 s78, s77, 7
    s_add_u32 s79, s78, 8781824
    s_add_u32 s78, s78, 4096
    s_lshl_b32 s80, s71, 4
    s_add_u32 s80, s80, s72
    s_lshl_b32 s80, s80, 7
    s_add_u32 s80, s80, 8847360
    s_mov_b64 exec, 0xffff
    buffer_store_dwordx2 v[198:199], v197, s[36:39], s78 offen sc1
    buffer_store_dwordx2 v[198:199], v197, s[36:39], s80 offen sc1
    v_not_b32 v200, v198
    v_mov_b32_e64 v201, 0
    buffer_store_dwordx2 v[200:201], v197, s[36:39], s79 offen sc1
    s_mov_b64 exec, -1
    v_and_b32 v196, 15, v2
    v_lshlrev_b32 v197, 4, v196
    v_add_u32 v197, s69, v197
    s_lshl_b32 s78, s70, 4
    s_lshl_b32 s79, s71, 4
    s_add_u32 s79, s79, 69088
    v_mov_b32 v202, s78
    v_mov_b32 v203, s79
    v_cmp_gt_u32 vcc, 32, v2
    s_nop 1
    v_cndmask_b32 v202, v203, v202, vcc
    v_add_u32 v196, v202, v196
    v_cmp_gt_u32 vcc, 16, v2
    s_nop 1
    v_cndmask_b32 v196, v196, v197, vcc
    v_lshlrev_b32 v196, 7, v196
    v_add_u32 v196, 4096, v196
Lfl_11:
    s_add_u32 m0, s88, 36864
    s_nop 0
    s_nop 0
    buffer_load_dwordx4 v4, s[28:31], s86 offen  lds
    buffer_load_dwordx4 v5, s[28:31], s86 offen offset:1024  lds
    s_add_u32 m0, s89, 61440
    s_add_u32 s101, s87, 2048
    buffer_load_dwordx4 v6, s[32:35], s101 offen  lds
    buffer_load_dwordx4 v7, s[32:35], s101 offen offset:1024  lds
    s_add_u32 m0, s88, 38912
    s_add_u32 s101, s86, 32768
    buffer_load_dwordx4 v4, s[28:31], s101 offen  lds
    buffer_load_dwordx4 v5, s[28:31], s101 offen offset:1024  lds
    s_add_u32 m0, s89, 69632
    s_add_u32 s101, s87, 4096
    buffer_load_dwordx4 v6, s[32:35], s101 offen  lds
    buffer_load_dwordx4 v7, s[32:35], s101 offen offset:1024  lds
    s_add_u32 m0, s89, 53248
    s_nop 0
    buffer_load_dwordx4 v6, s[32:35], s87 offen  lds
    buffer_load_dwordx4 v7, s[32:35], s87 offen offset:1024  lds
    s_add_u32 s86, s86, 128
    s_add_u32 s87, s87, 393216
    s_and_b32 s86, s86, 2047
    s_cselect_b32 s87, s87, 0
    s_waitcnt vmcnt(10)
    s_barrier
    s_add_u32 m0, s88, 77824
    s_nop 0
    s_nop 0
    buffer_load_dwordx4 v4, s[28:31], s86 offen  lds
    buffer_load_dwordx4 v5, s[28:31], s86 offen offset:1024  lds
    s_add_u32 m0, s89, 102400
    s_add_u32 s101, s87, 2048
    buffer_load_dwordx4 v6, s[32:35], s101 offen  lds
    buffer_load_dwordx4 v7, s[32:35], s101 offen offset:1024  lds
    s_add_u32 m0, s88, 79872
    s_add_u32 s101, s86, 32768
    buffer_load_dwordx4 v4, s[28:31], s101 offen  lds
    buffer_load_dwordx4 v5, s[28:31], s101 offen offset:1024  lds
    s_add_u32 m0, s89, 110592
    s_add_u32 s101, s87, 4096
    buffer_load_dwordx4 v6, s[32:35], s101 offen  lds
    buffer_load_dwordx4 v7, s[32:35], s101 offen offset:1024  lds
    s_add_u32 m0, s89, 94208
    s_nop 0
    buffer_load_dwordx4 v6, s[32:35], s87 offen  lds
    buffer_load_dwordx4 v7, s[32:35], s87 offen offset:1024  lds
    s_add_u32 s86, s86, 128
    s_add_u32 s87, s87, 393216
    s_and_b32 s86, s86, 2047
    s_cselect_b32 s87, s87, 0
    s_waitcnt vmcnt(10)
    s_barrier
    s_add_u32 m0, s88, 118784
    s_nop 0
    s_nop 0
    buffer_load_dwordx4 v4, s[28:31], s86 offen  lds
    buffer_load_dwordx4 v5, s[28:31], s86 offen offset:1024  lds
    s_add_u32 m0, s89, 143360
    s_add_u32 s101, s87, 2048
    buffer_load_dwordx4 v6, s[32:35], s101 offen  lds
    buffer_load_dwordx4 v7, s[32:35], s101 offen offset:1024  lds
    s_add_u32 m0, s88, 120832
    s_add_u32 s101, s86, 32768
    buffer_load_dwordx4 v4, s[28:31], s101 offen  lds
    buffer_load_dwordx4 v5, s[28:31], s101 offen offset:1024  lds
    s_add_u32 m0, s89, 151552
    s_add_u32 s101, s87, 4096
    buffer_load_dwordx4 v6, s[32:35], s101 offen  lds
    buffer_load_dwordx4 v7, s[32:35], s101 offen offset:1024  lds
    s_add_u32 m0, s89, 135168
    s_nop 0
    buffer_load_dwordx4 v6, s[32:35], s87 offen  lds
    buffer_load_dwordx4 v7, s[32:35], s87 offen offset:1024  lds
    s_add_u32 s86, s86, 128
    s_add_u32 s87, s87, 393216
    s_and_b32 s86, s86, 2047
    s_cselect_b32 s87, s87, 0
    s_waitcnt vmcnt(10)
    s_barrier
    s_add_u32 m0, s88, 36864
    s_nop 0
    s_nop 0
    buffer_load_dwordx4 v4, s[28:31], s86 offen  lds
    buffer_load_dwordx4 v5, s[28:31], s86 offen offset:1024  lds
    s_add_u32 m0, s89, 61440
    s_add_u32 s101, s87, 2048
    buffer_load_dwordx4 v6, s[32:35], s101 offen  lds
    buffer_load_dwordx4 v7, s[32:35], s101 offen offset:1024  lds
    s_add_u32 m0, s88, 38912
    s_add_u32 s101, s86, 32768
    buffer_load_dwordx4 v4, s[28:31], s101 offen  lds
    buffer_load_dwordx4 v5, s[28:31], s101 offen offset:1024  lds
    s_add_u32 m0, s89, 69632
    s_add_u32 s101, s87, 4096
    buffer_load_dwordx4 v6, s[32:35], s101 offen  lds
    buffer_load_dwordx4 v7, s[32:35], s101 offen offset:1024  lds
    s_add_u32 m0, s89, 53248
    s_nop 0
    buffer_load_dwordx4 v6, s[32:35], s87 offen  lds
    buffer_load_dwordx4 v7, s[32:35], s87 offen offset:1024  lds
    s_add_u32 s86, s86, 128
    s_add_u32 s87, s87, 393216
    s_and_b32 s86, s86, 2047
    s_cselect_b32 s87, s87, 0
    s_mov_b32 s100, 21504
    buffer_load_dwordx4 v[108:111], v244, s[52:55], s100 offen nt
    s_mov_b32 s100, 28672
    buffer_load_dwordx4 v[80:83], v244, s[48:51], s100 offen nt
    s_mov_b32 s100, 28672
    buffer_load_dwordx4 v[112:115], v244, s[52:55], s100 offen nt
    s_mov_b32 s100, 35840
    buffer_load_dwordx4 v[84:87], v244, s[48:51], s100 offen nt
    s_mov_b32 s100, 35840
    buffer_load_dwordx4 v[116:119], v244, s[52:55], s100 offen nt
    s_mov_b32 s100, 43008
    buffer_load_dwordx4 v[88:91], v244, s[48:51], s100 offen nt
    s_mov_b32 s100, 43008
    buffer_load_dwordx4 v[120:123], v244, s[52:55], s100 offen nt
    s_waitcnt vmcnt(17)
    s_barrier
    s_add_u32 m0, s88, 77824
    s_nop 0
    s_nop 0
    buffer_load_dwordx4 v4, s[28:31], s86 offen  lds
    buffer_load_dwordx4 v5, s[28:31], s86 offen offset:1024  lds
    s_add_u32 m0, s89, 102400
    s_add_u32 s101, s87, 2048
    buffer_load_dwordx4 v6, s[32:35], s101 offen  lds
    buffer_load_dwordx4 v7, s[32:35], s101 offen offset:1024  lds
    s_add_u32 m0, s88, 79872
    s_add_u32 s101, s86, 32768
    buffer_load_dwordx4 v4, s[28:31], s101 offen  lds
    buffer_load_dwordx4 v5, s[28:31], s101 offen offset:1024  lds
    s_add_u32 m0, s89, 110592
    s_add_u32 s101, s87, 4096
    buffer_load_dwordx4 v6, s[32:35], s101 offen  lds
    buffer_load_dwordx4 v7, s[32:35], s101 offen offset:1024  lds
    s_add_u32 m0, s89, 94208
    s_nop 0
    buffer_load_dwordx4 v6, s[32:35], s87 offen  lds
    buffer_load_dwordx4 v7, s[32:35], s87 offen offset:1024  lds
    s_add_u32 s86, s86, 128
    s_add_u32 s87, s87, 393216
    s_and_b32 s86, s86, 2047
    s_cselect_b32 s87, s87, 0
    s_waitcnt vmcnt(17)
    s_barrier
    s_add_u32 m0, s88, 118784
    s_nop 0
    s_nop 0
    buffer_load_dwordx4 v4, s[28:31], s86 offen  lds
    buffer_load_dwordx4 v5, s[28:31], s86 offen offset:1024  lds
    s_add_u32 m0, s89, 143360
    s_add_u32 s101, s87, 2048
    buffer_load_dwordx4 v6, s[32:35], s101 offen  lds
    buffer_load_dwordx4 v7, s[32:35], s101 offen offset:1024  lds
    s_add_u32 m0, s88, 120832
    s_add_u32 s101, s86, 32768
    buffer_load_dwordx4 v4, s[28:31], s101 offen  lds
    buffer_load_dwordx4 v5, s[28:31], s101 offen offset:1024  lds
    s_add_u32 m0, s89, 151552
    s_add_u32 s101, s87, 4096
    buffer_load_dwordx4 v6, s[32:35], s101 offen  lds
    buffer_load_dwordx4 v7, s[32:35], s101 offen offset:1024  lds
    s_add_u32 m0, s89, 135168
    s_nop 0
    buffer_load_dwordx4 v6, s[32:35], s87 offen  lds
    buffer_load_dwordx4 v7, s[32:35], s87 offen offset:1024  lds
    s_add_u32 s86, s86, 128
    s_add_u32 s87, s87, 393216
    s_and_b32 s86, s86, 2047
    s_cselect_b32 s87, s87, 0
    s_waitcnt vmcnt(10)
    s_barrier
    s_add_u32 m0, s88, 36864
    s_nop 0
    s_nop 0
    buffer_load_dwordx4 v4, s[28:31], s86 offen  lds
    buffer_load_dwordx4 v5, s[28:31], s86 offen offset:1024  lds
    s_add_u32 m0, s89, 61440
    s_add_u32 s101, s87, 2048
    buffer_load_dwordx4 v6, s[32:35], s101 offen  lds
    buffer_load_dwordx4 v7, s[32:35], s101 offen offset:1024  lds
    s_add_u32 m0, s88, 38912
    s_add_u32 s101, s86, 32768
    buffer_load_dwordx4 v4, s[28:31], s101 offen  lds
    buffer_load_dwordx4 v5, s[28:31], s101 offen offset:1024  lds
    s_add_u32 m0, s89, 69632
    s_add_u32 s101, s87, 4096
    buffer_load_dwordx4 v6, s[32:35], s101 offen  lds
    buffer_load_dwordx4 v7, s[32:35], s101 offen offset:1024  lds
    s_add_u32 m0, s89, 53248
    s_nop 0
    buffer_load_dwordx4 v6, s[32:35], s87 offen  lds
    buffer_load_dwordx4 v7, s[32:35], s87 offen offset:1024  lds
    s_add_u32 s86, s86, 128
    s_add_u32 s87, s87, 393216
    s_and_b32 s86, s86, 2047
    s_cselect_b32 s87, s87, 0
    s_waitcnt vmcnt(10)
    s_barrier
    s_cmp_lg_u32 s76, 0
    s_cbranch_scc1 Lpl_12
    s_mov_b32 exec_hi, 0xffff
    buffer_load_dwordx2 v[198:199], v196, s[36:39], 0 offen sc1
    s_mov_b64 exec, -1
Lpl_12:
    s_add_u32 m0, s88, 77824
    s_nop 0
    buffer_load_dwordx4 v4, s[28:31], s86 offen  lds
    buffer_load_dwordx4 v5, s[28:31], s86 offen offset:1024  lds
    s_add_u32 m0, s89, 102400
    s_add_u32 s101, s87, 2048
    buffer_load_dwordx4 v6, s[32:35], s101 offen  lds
    buffer_load_dwordx4 v7, s[32:35], s101 offen offset:1024  lds
    s_add_u32 m0, s88, 79872
    s_add_u32 s101, s86, 32768
    buffer_load_dwordx4 v4, s[28:31], s101 offen  lds
    buffer_load_dwordx4 v5, s[28:31], s101 offen offset:1024  lds
    s_add_u32 m0, s89, 110592
    s_add_u32 s101, s87, 4096
    buffer_load_dwordx4 v6, s[32:35], s101 offen  lds
    buffer_load_dwordx4 v7, s[32:35], s101 offen offset:1024  lds
    s_add_u32 m0, s89, 94208
    s_nop 0
    buffer_load_dwordx4 v6, s[32:35], s87 offen  lds
    buffer_load_dwordx4 v7, s[32:35], s87 offen offset:1024  lds
    s_add_u32 s86, s86, 128
    s_add_u32 s87, s87, 393216
    s_and_b32 s86, s86, 2047
    s_cselect_b32 s87, s87, 0
    s_waitcnt vmcnt(10)
    s_barrier
    s_cmp_lg_u32 s76, 2
    s_cbranch_scc1 Lc4_13
    s_mov_b32 exec_hi, -1
    buffer_load_dword v238, v63, s[40:43], 0 offen
    s_mov_b64 exec, -1
Lc4_13:
    s_add_u32 m0, s88, 118784
    s_nop 0
    s_nop 0
    buffer_load_dwordx4 v4, s[28:31], s86 offen  lds
    buffer_load_dwordx4 v5, s[28:31], s86 offen offset:1024  lds
    s_add_u32 m0, s89, 143360
    s_add_u32 s101, s87, 2048
    buffer_load_dwordx4 v6, s[32:35], s101 offen  lds
    buffer_load_dwordx4 v7, s[32:35], s101 offen offset:1024  lds
    s_add_u32 m0, s88, 120832
    s_add_u32 s101, s86, 32768
    buffer_load_dwordx4 v4, s[28:31], s101 offen  lds
    buffer_load_dwordx4 v5, s[28:31], s101 offen offset:1024  lds
    s_add_u32 m0, s89, 151552
    s_add_u32 s101, s87, 4096
    buffer_load_dwordx4 v6, s[32:35], s101 offen  lds
    buffer_load_dwordx4 v7, s[32:35], s101 offen offset:1024  lds
    s_add_u32 m0, s89, 135168
    s_nop 0
    buffer_load_dwordx4 v6, s[32:35], s87 offen  lds
    buffer_load_dwordx4 v7, s[32:35], s87 offen offset:1024  lds
    s_add_u32 s86, s86, 128
    s_add_u32 s87, s87, 393216
    s_and_b32 s86, s86, 2047
    s_cselect_b32 s87, s87, 0
    s_waitcnt vmcnt(10)
    s_cmp_lg_u32 s76, 0
    s_cbranch_scc1 Lpc_14
    s_mov_b32 exec_hi, 0xffff
    s_mov_b32 s85, 0
    s_branch Lpk_15
Lspin_16:
    s_add_u32 s85, s85, 1
    s_cmp_gt_u32 s85, 400000
    s_cbranch_scc1 L_end
    buffer_load_dwordx2 v[198:199], v196, s[36:39], 0 offen sc1
    s_waitcnt vmcnt(0)
Lpk_15:
    v_cmp_ne_u32 vcc, s75, v198
    s_cbranch_vccnz Lspin_16
    v_cmp_ne_u32 vcc, s99, v199
    s_mov_b64 exec, -1
    s_lshr_b32 s78, vcc_lo, 16
    s_cselect_b32 s78, 0, 1
    s_cmp_eq_u32 vcc_hi, 0
    s_cselect_b32 s79, 2, 0
    s_or_b32 s78, s78, s79
    s_and_b32 s78, s78, 3
    v_mov_b32_e64 v198, s78
    v_mov_b32 v199, 163584
    ds_write_b32 v199, v198
    s_waitcnt lgkmcnt(0)
Lpc_14:
    s_barrier
    v_lshrrev_b32 v196, 4, v2
    v_and_b32 v197, 15, v2
    v_lshlrev_b32_e64 v197, 4, v197
    v_lshl_add_u32 v198, v196, 10, v197
    s_lshl_b32 s78, s69, 14
    s_lshl_b32 s79, s76, 8
    s_add_u32 s78, s78, s79
    s_nop 0
    s_add_u32 s78, s78, 65536
    buffer_load_dwordx4 v[20:23], v198, s[36:39], s78 offen sc1
    s_add_u32 s78, s78, 4096
    buffer_load_dwordx4 v[24:27], v198, s[36:39], s78 offen sc1
    s_add_u32 s78, s78, 4096
    buffer_load_dwordx4 v[28:31], v198, s[36:39], s78 offen sc1
    s_add_u32 s78, s78, 4096
    buffer_load_dwordx4 v[32:35], v198, s[36:39], s78 offen sc1
    v_mul_u32_u24 v198, 768, v196
    v_add_u32_e64 v198, v198, v197
    s_mul_i32 s78, s70, 12288
    s_lshl_b32 s79, s76, 8
    s_add_u32 s78, s78, s79
    s_add_u32 s78, s78, 327680
    s_cmp_eq_u32 s76, 3
    s_nop 0
    s_cselect_b32 s78, 0x10000000, s78
    buffer_load_dwordx4 v[36:39], v198, s[36:39], s78 offen sc1
    s_add_u32 s78, s78, 3072
    buffer_load_dwordx4 v[40:43], v198, s[36:39], s78 offen sc1
    s_add_u32 s78, s78, 3072
    buffer_load_dwordx4 v[44:47], v198, s[36:39], s78 offen sc1
    s_add_u32 s78, s78, 3072
    buffer_load_dwordx4 v[48:51], v198, s[36:39], s78 offen sc1
    s_add_u32 m0, s84, 0
    s_mov_b32 s100, 0
    buffer_load_dwordx4 v246, s[40:43], s100 offen  lds
    s_add_u32 m0, s84, 4096
    s_mov_b32 s100, 65536
    buffer_load_dwordx4 v246, s[40:43], s100 offen  lds
    s_add_u32 m0, s84, 8192
    s_mov_b32 s100, 131072
    buffer_load_dwordx4 v246, s[40:43], s100 offen  lds
    s_add_u32 m0, s84, 12288
    s_mov_b32 s100, 196608
    buffer_load_dwordx4 v246, s[40:43], s100 offen  lds
    s_waitcnt vmcnt(12)
    s_waitcnt lgkmcnt(0)
    s_barrier
    s_setprio 2
    s_add_u32 m0, s84, 16384
    s_mov_b32 s100, 262144
    buffer_load_dwordx4 v246, s[40:43], s100 offen  lds
    s_waitcnt vmcnt(9)
    v_add_f32 v20, v20, v24
    v_add_f32 v21, v21, v25
    v_add_f32 v22, v22, v26
    v_add_f32 v23, v23, v27
    v_add_f32 v20, v20, v28
    v_add_f32_e64 v21, v21, v29
    s_add_u32 m0, s84, 20480
    s_mov_b32 s100, 327680
    buffer_load_dwordx4 v246, s[40:43], s100 offen  lds
    v_add_f32 v22, v22, v30
    v_add_f32 v23, v23, v31
    v_add_f32 v20, v20, v32
    v_add_f32 v21, v21, v33
    v_add_f32 v22, v22, v34
    v_add_f32 v23, v23, v35
    s_nop 0
    v_permlane32_swap_b32 v20, v22
    s_add_u32 m0, s84, 24576
    s_mov_b32 s100, 393216
    buffer_load_dwordx4 v246, s[40:43], s100 offen  lds
    v_permlane32_swap_b32 v21, v23
    v_add_f32 v20, v20, v22
    v_add_f32 v21, v21, v23
    v_mov_b32 v22, v20
    v_mov_b32 v23, v21
    s_nop 0
    v_permlane16_swap_b32 v20, v22
    v_permlane16_swap_b32 v21, v23
    v_add_f32_e64 v20, v20, v22
    s_add_u32 m0, s84, 28672
    s_mov_b32 s100, 458752
    buffer_load_dwordx4 v246, s[40:43], s100 offen  lds
    v_add_f32_e64 v21, v21, v23
    v_mul_f32 v24, 0x3a800000, v20
    v_mul_f32 v26, 0x3a800000, v21
    v_fma_f32 v26, -v24, v24, v26
    v_max_f32_e64 v26, 0, v26
    v_cvt_pk_bf16_f32 v24, v24, v24
    v_and_b32 v24, 0xffff0000, v24
    s_add_u32 m0, s84, 32768
    s_mov_b32 s100, 524288
    buffer_load_dwordx4 v246, s[40:43], s100 offen  lds
    v_cvt_pk_bf16_f32 v26, v26, v26
    v_and_b32 v26, 0xffff0000, v26
    v_add_f32 v26, 0x3727c5ac, v26
    v_cvt_pk_bf16_f32 v26, v26, v26
    v_and_b32 v26, 0xffff0000, v26
    v_sqrt_f32 v26, v26
    s_nop 0
    v_cvt_pk_bf16_f32 v26, v26, v26
    v_and_b32 v26, 0xffff0000, v26
    s_add_u32 m0, s84, 36864
    s_mov_b32 s100, 589824
    buffer_load_dwordx4 v246, s[40:43], s100 offen  lds
    v_rcp_f32_e64 v25, v26
    v_xor_b32 v26, 0x80000000, v24
    v_lshrrev_b32 v27, 16, v26
    v_or_b32 v26, v26, v27
    v_mov_b32 v27, 0
    v_and_b32 v196, 15, v2
    v_lshrrev_b32_e64 v197, 5, v2
    s_add_u32 m0, s84, 40960
    s_mov_b32 s100, 655360
    buffer_load_dwordx4 v246, s[40:43], s100 offen  lds
    v_lshl_add_u32 v196, v196, 1, v197
    s_lshl_b32 s78, s76, 5
    v_add_u32 v196, s78, v196
    v_lshlrev_b32_e64 v197, 3, v196
    v_add_u32 v197, 159744, v197
    v_lshlrev_b32_e64 v196, 2, v196
    v_add_u32 v196, 162304, v196
    s_add_u32 m0, s84, 45056
    s_mov_b32 s100, 720896
    buffer_load_dwordx4 v246, s[40:43], s100 offen  lds
    ds_write_b64 v197, v[26:27]
    ds_write_b32 v196, v25
    s_waitcnt vmcnt(12)
    v_add_f32 v36, v36, v40
    v_add_f32 v37, v37, v41
    v_add_f32 v38, v38, v42
    v_add_f32 v39, v39, v43
    v_add_f32 v36, v36, v44
    s_add_u32 m0, s84, 49152
    s_mov_b32 s100, 786432
    buffer_load_dwordx4 v246, s[40:43], s100 offen  lds
    v_add_f32 v37, v37, v45
    v_add_f32 v38, v38, v46
    v_add_f32 v39, v39, v47
    v_add_f32 v36, v36, v48
    v_add_f32 v37, v37, v49
    v_add_f32 v38, v38, v50
    v_add_f32_e64 v39, v39, v51
    s_add_u32 m0, s84, 53248
    s_mov_b32 s100, 851968
    buffer_load_dwordx4 v246, s[40:43], s100 offen  lds
    v_permlane32_swap_b32 v36, v38
    v_permlane32_swap_b32 v37, v39
    v_add_f32 v36, v36, v38
    v_add_f32 v37, v37, v39
    s_nop 1
    v_permlane16_swap_b32 v36, v37
    v_add_f32_e64 v36, v36, v37
    v_cvt_pk_bf16_f32 v37, v36, v36
    v_and_b32 v37, 0xffff0000, v37
    s_add_u32 m0, s84, 57344
    s_mov_b32 s100, 917504
    buffer_load_dwordx4 v246, s[40:43], s100 offen  lds
    v_sub_f32_e64 v38, v36, v37
    v_cvt_pk_bf16_f32 v38, v37, v38
    v_mov_b32 v39, 0
    v_and_b32 v196, 15, v2
    v_lshrrev_b32_e64 v197, 4, v2
    v_lshl_add_u32 v196, v196, 2, v197
    s_lshl_b32 s78, s76, 9
    s_add_u32 m0, s84, 61440
    s_mov_b32 s100, 983040
    buffer_load_dwordx4 v246, s[40:43], s100 offen  lds
    s_add_u32 s78, s78, 160768
    v_lshl_add_u32 v196, v196, 3, s78
    v_and_b32 v197, 15, v2
    v_lshlrev_b32_e64 v197, 3, v197
    v_add_u32 v197, 162816, v197
    v_mov_b32 v198, 0x3f803f80
    s_cmp_eq_u32 s76, 3
    s_cselect_b64 vcc, -1, 0
    v_cndmask_b32 v196, v196, v197, vcc
    v_cndmask_b32 v38, v38, v198, vcc
    v_cndmask_b32_e64 v39, v39, v198, vcc
    ds_write_b64 v196, v[38:39]
    s_setprio 0
    s_waitcnt lgkmcnt(0)
    s_barrier
    s_branch L_phend
L_ph2:
    s_setprio 2
    s_add_u32 m0, s88, 36864
    s_nop 0
    buffer_load_dwordx4 v4, s[28:31], s86 offen  lds
    v_mov_b32 v200, 0x3f803f80
    v_mov_b32 v201, 0x3f803f80
    v_mov_b32 v202, 0x3f803f80
    v_mov_b32 v203, 0x3f803f80
    buffer_load_dwordx4 v5, s[28:31], s86 offen offset:1024  lds
    s_nop 0
    s_nop 0
    v_mfma_f32_16x16x32_bf16 v[204:207], v[200:203], v[20:23], 0
    v_mfma_f32_16x16x32_bf16 v[212:215], v[20:23], v[20:23], 0
    v_mfma_f32_16x16x32_bf16 v[208:211], v[200:203], v[24:27], 0
    v_mfma_f32_16x16x32_bf16 v[216:219], v[24:27], v[24:27], 0
    v_mfma_f32_16x16x32_bf16 v[220:223], v[200:203], v[36:39], 0
    s_add_u32 m0, s89, 61440
    s_add_u32 s101, s87, 2048
    buffer_load_dwordx4 v6, s[32:35], s101 offen  lds
    v_mfma_f32_16x16x32_bf16 v[224:227], v[200:203], v[44:47], 0
    v_mfma_f32_16x16x32_bf16 v[228:231], v[200:203], v[52:55], 0
    v_mfma_f32_16x16x32_bf16 v[204:207], v[200:203], v[28:31], v[204:207]
    v_mfma_f32_16x16x32_bf16 v[212:215], v[28:31], v[28:31], v[212:215]
    v_mfma_f32_16x16x32_bf16 v[208:211], v[200:203], v[32:35], v[208:211]
    buffer_load_dwordx4 v7, s[32:35], s101 offen offset:1024  lds
    v_mfma_f32_16x16x32_bf16 v[216:219], v[32:35], v[32:35], v[216:219]
    v_mfma_f32_16x16x32_bf16 v[220:223], v[200:203], v[40:43], v[220:223]
    v_mfma_f32_16x16x32_bf16 v[224:227], v[200:203], v[48:51], v[224:227]
    v_mfma_f32_16x16x32_bf16 v[228:231], v[200:203], v[56:59], v[228:231]
    v_and_b32_e64 v196, 3, v2
    s_add_u32 m0, s88, 38912
    s_add_u32 s101, s86, 32768
    buffer_load_dwordx4 v4, s[28:31], s101 offen  lds
    v_cmp_eq_u32 s[90:91], 1, v196
    v_cmp_eq_u32 s[92:93], 2, v196
    v_cmp_eq_u32_e64 vcc, 3, v196
    v_cndmask_b32 v212, v212, v213, s[90:91]
    v_cndmask_b32 v212, v212, v214, s[92:93]
    buffer_load_dwordx4 v5, s[28:31], s101 offen offset:1024  lds
    v_cndmask_b32_e64 v205, v212, v215, vcc
    v_cndmask_b32 v216, v216, v217, s[90:91]
    v_cndmask_b32 v216, v216, v218, s[92:93]
    v_cndmask_b32 v209, v216, v219, vcc
    v_lshrrev_b32 v196, 4, v2
    s_add_u32 m0, s89, 69632
    s_add_u32 s101, s87, 4096
    buffer_load_dwordx4 v6, s[32:35], s101 offen  lds
    v_cmp_eq_u32 s[90:91], 1, v196
    v_cmp_eq_u32 vcc, 2, v196
    s_nop 0
    v_cndmask_b32 v220, v220, v224, s[90:91]
    v_cndmask_b32_e64 v220, v220, v228, vcc
    s_mul_i32 s78, s77, 768
    buffer_load_dwordx4 v7, s[32:35], s101 offen offset:1024  lds
    s_mul_i32 s79, s76, 192
    s_add_u32 s78, s78, s79
    s_add_u32 s78, s78, 327680
    v_lshlrev_b32 v197, 2, v2
    s_mov_b32 exec_hi, 0xffff
    buffer_store_dword v220, v197, s[36:39], s78 offen sc1
    s_mov_b32 exec_hi, -1
    s_add_u32 m0, s89, 53248
    s_nop 0
    buffer_load_dwordx4 v6, s[32:35], s87 offen  lds
    s_lshl_b32 s78, s69, 4
    s_add_u32 s78, s78, s70
    s_lshl_b32 s78, s78, 10
    s_lshl_b32 s79, s76, 8
    s_add_u32 s78, s78, s79
    buffer_load_dwordx4 v7, s[32:35], s87 offen offset:1024  lds
    s_add_u32 s86, s86, 128
    s_add_u32 s87, s87, 393216
    s_and_b32 s86, s86, 2047
    s_cselect_b32 s87, s87, 0
    s_add_u32 s78, s78, 65536
    v_and_b32 v198, 15, v2
    v_lshlrev_b32 v198, 3, v198
    s_mov_b32 exec_lo, 0x00f0000f
    s_mov_b32 exec_hi, 0xf0000f00
    buffer_store_dwordx2 v[204:205], v198, s[36:39], s78 offen offset:0 sc1
    s_mov_b64 exec, -1
    s_mov_b32 exec_lo, 0x00f0000f
    s_mov_b32 exec_hi, 0xf0000f00
    buffer_store_dwordx2 v[208:209], v198, s[36:39], s78 offen offset:128 sc1
    s_mov_b64 exec, -1
    s_setprio 0
    s_waitcnt vmcnt(13)
    s_waitcnt lgkmcnt(0)
    s_barrier
    s_add_u32 m0, s88, 77824
    s_nop 0
    s_nop 0
    buffer_load_dwordx4 v4, s[28:31], s86 offen  lds
    buffer_load_dwordx4 v5, s[28:31], s86 offen offset:1024  lds
    s_add_u32 m0, s89, 102400
    s_add_u32 s101, s87, 2048
    buffer_load_dwordx4 v6, s[32:35], s101 offen  lds
    buffer_load_dwordx4 v7, s[32:35], s101 offen offset:1024  lds
    s_add_u32 m0, s88, 79872
    s_add_u32 s101, s86, 32768
    buffer_load_dwordx4 v4, s[28:31], s101 offen  lds
    buffer_load_dwordx4 v5, s[28:31], s101 offen offset:1024  lds
    s_add_u32 m0, s89, 110592
    s_add_u32 s101, s87, 4096
    buffer_load_dwordx4 v6, s[32:35], s101 offen  lds
    buffer_load_dwordx4 v7, s[32:35], s101 offen offset:1024  lds
    s_add_u32 m0, s89, 94208
    s_nop 0
    buffer_load_dwordx4 v6, s[32:35], s87 offen  lds
    buffer_load_dwordx4 v7, s[32:35], s87 offen offset:1024  lds
    s_add_u32 s86, s86, 128
    s_add_u32 s87, s87, 393216
    s_and_b32 s86, s86, 2047
    s_cselect_b32 s87, s87, 0
    buffer_store_dwordx4 v[16:19], v14, s[36:39], s96 offen offset:0 sc1
    s_waitcnt vmcnt(13)
    s_waitcnt lgkmcnt(0)
    s_barrier
    s_add_u32 m0, s88, 118784
    s_nop 0
    buffer_load_dwordx4 v4, s[28:31], s86 offen  lds
    buffer_load_dwordx4 v5, s[28:31], s86 offen offset:1024  lds
    s_add_u32 m0, s89, 143360
    s_add_u32 s101, s87, 2048
    buffer_load_dwordx4 v6, s[32:35], s101 offen  lds
    buffer_load_dwordx4 v7, s[32:35], s101 offen offset:1024  lds
    s_add_u32 m0, s88, 120832
    s_add_u32 s101, s86, 32768
    buffer_load_dwordx4 v4, s[28:31], s101 offen  lds
    buffer_load_dwordx4 v5, s[28:31], s101 offen offset:1024  lds
    s_add_u32 m0, s89, 151552
    s_add_u32 s101, s87, 4096
    buffer_load_dwordx4 v6, s[32:35], s101 offen  lds
    buffer_load_dwordx4 v7, s[32:35], s101 offen offset:1024  lds
    s_add_u32 m0, s89, 135168
    s_nop 0
    buffer_load_dwordx4 v6, s[32:35], s87 offen  lds
    buffer_load_dwordx4 v7, s[32:35], s87 offen offset:1024  lds
    s_add_u32 s86, s86, 128
    s_add_u32 s87, s87, 393216
    s_and_b32 s86, s86, 2047
    s_cselect_b32 s87, s87, 0
    s_mov_b32 s100, 0
    buffer_load_dwordx4 v[64:67], v244, s[48:51], s100 offen nt
    s_mov_b32 s100, 0
    buffer_load_dwordx4 v[96:99], v244, s[52:55], s100 offen nt
    s_mov_b32 s100, 7168
    buffer_load_dwordx4 v[68:71], v244, s[48:51], s100 offen nt
    s_mov_b32 s100, 7168
    buffer_load_dwordx4 v[100:103], v244, s[52:55], s100 offen nt
    s_mov_b32 s100, 14336
    buffer_load_dwordx4 v[72:75], v244, s[48:51], s100 offen nt
    s_mov_b32 s100, 14336
    buffer_load_dwordx4 v[104:107], v244, s[52:55], s100 offen nt
    s_mov_b32 s100, 21504
    buffer_load_dwordx4 v[76:79], v244, s[48:51], s100 offen nt
    s_waitcnt vmcnt(17)
    s_barrier
    s_cmp_lg_u32 s76, 0
    s_cbranch_scc1 Lfl_17
    s_getreg_b32 s99, hwreg(HW_REG_XCC_ID, 0, 4)
    v_mov_b32 v198, s75
    v_mov_b32 v199, s99
    v_lshlrev_b32_e64 v197, 3, v2
    s_lshl_b32 s78, s77, 7
    s_add_u32 s79, s78, 8781824
    s_add_u32 s78, s78, 4096
    s_lshl_b32 s80, s71, 4
    s_add_u32 s80, s80, s72
    s_lshl_b32 s80, s80, 7
    s_add_u32 s80, s80, 8847360
    s_mov_b64 exec, 0xffff
    buffer_store_dwordx2 v[198:199], v197, s[36:39], s78 offen sc1
    buffer_store_dwordx2 v[198:199], v197, s[36:39], s80 offen sc1
    v_not_b32 v200, v198
    v_mov_b32_e64 v201, 0
    buffer_store_dwordx2 v[200:201], v197, s[36:39], s79 offen sc1
    s_mov_b64 exec, -1
    v_and_b32 v196, 15, v2
    v_lshlrev_b32 v197, 4, v196
    v_add_u32 v197, s69, v197
    s_lshl_b32 s78, s70, 4
    s_lshl_b32 s79, s71, 4
    s_add_u32 s79, s79, 69088
    v_mov_b32 v202, s78
    v_mov_b32 v203, s79
    v_cmp_gt_u32 vcc, 32, v2
    s_nop 1
    v_cndmask_b32 v202, v203, v202, vcc
    v_add_u32 v196, v202, v196
    v_cmp_gt_u32 vcc, 16, v2
    s_nop 1
    v_cndmask_b32 v196, v196, v197, vcc
    v_lshlrev_b32 v196, 7, v196
    v_add_u32 v196, 4096, v196
Lfl_17:
    s_add_u32 m0, s88, 36864
    s_nop 0
    s_nop 0
    buffer_load_dwordx4 v4, s[28:31], s86 offen  lds
    buffer_load_dwordx4 v5, s[28:31], s86 offen offset:1024  lds
    s_add_u32 m0, s89, 61440
    s_add_u32 s101, s87, 2048
    buffer_load_dwordx4 v6, s[32:35], s101 offen  lds
    buffer_load_dwordx4 v7, s[32:35], s101 offen offset:1024  lds
    s_add_u32 m0, s88, 38912
    s_add_u32 s101, s86, 32768
    buffer_load_dwordx4 v4, s[28:31], s101 offen  lds
    buffer_load_dwordx4 v5, s[28:31], s101 offen offset:1024  lds
    s_add_u32 m0, s89, 69632
    s_add_u32 s101, s87, 4096
    buffer_load_dwordx4 v6, s[32:35], s101 offen  lds
    buffer_load_dwordx4 v7, s[32:35], s101 offen offset:1024  lds
    s_add_u32 m0, s89, 53248
    s_nop 0
    buffer_load_dwordx4 v6, s[32:35], s87 offen  lds
    buffer_load_dwordx4 v7, s[32:35], s87 offen offset:1024  lds
    s_add_u32 s86, s86, 128
    s_add_u32 s87, s87, 393216
    s_and_b32 s86, s86, 2047
    s_cselect_b32 s87, s87, 0
    s_waitcnt vmcnt(17)
    s_barrier
    s_add_u32 m0, s88, 77824
    s_nop 0
    s_nop 0
    buffer_load_dwordx4 v4, s[28:31], s86 offen  lds
    buffer_load_dwordx4 v5, s[28:31], s86 offen offset:1024  lds
    s_add_u32 m0, s89, 102400
    s_add_u32 s101, s87, 2048
    buffer_load_dwordx4 v6, s[32:35], s101 offen  lds
    buffer_load_dwordx4 v7, s[32:35], s101 offen offset:1024  lds
    s_add_u32 m0, s88, 79872
    s_add_u32 s101, s86, 32768
    buffer_load_dwordx4 v4, s[28:31], s101 offen  lds
    buffer_load_dwordx4 v5, s[28:31], s101 offen offset:1024  lds
    s_add_u32 m0, s89, 110592
    s_add_u32 s101, s87, 4096
    buffer_load_dwordx4 v6, s[32:35], s101 offen  lds
    buffer_load_dwordx4 v7, s[32:35], s101 offen offset:1024  lds
    s_add_u32 m0, s89, 94208
    s_nop 0
    buffer_load_dwordx4 v6, s[32:35], s87 offen  lds
    buffer_load_dwordx4 v7, s[32:35], s87 offen offset:1024  lds
    s_add_u32 s86, s86, 128
    s_add_u32 s87, s87, 393216
    s_and_b32 s86, s86, 2047
    s_cselect_b32 s87, s87, 0
    s_waitcnt vmcnt(10)
    s_barrier
    s_add_u32 m0, s88, 118784
    s_nop 0
    s_nop 0
    buffer_load_dwordx4 v4, s[28:31], s86 offen  lds
    buffer_load_dwordx4 v5, s[28:31], s86 offen offset:1024  lds
    s_add_u32 m0, s89, 143360
    s_add_u32 s101, s87, 2048
    buffer_load_dwordx4 v6, s[32:35], s101 offen  lds
    buffer_load_dwordx4 v7, s[32:35], s101 offen offset:1024  lds
    s_add_u32 m0, s88, 120832
    s_add_u32 s101, s86, 32768
    buffer_load_dwordx4 v4, s[28:31], s101 offen  lds
    buffer_load_dwordx4 v5, s[28:31], s101 offen offset:1024  lds
    s_add_u32 m0, s89, 151552
    s_add_u32 s101, s87, 4096
    buffer_load_dwordx4 v6, s[32:35], s101 offen  lds
    buffer_load_dwordx4 v7, s[32:35], s101 offen offset:1024  lds
    s_add_u32 m0, s89, 135168
    s_nop 0
    buffer_load_dwordx4 v6, s[32:35], s87 offen  lds
    buffer_load_dwordx4 v7, s[32:35], s87 offen offset:1024  lds
    s_add_u32 s86, s86, 128
    s_add_u32 s87, s87, 393216
    s_and_b32 s86, s86, 2047
    s_cselect_b32 s87, s87, 0
    s_waitcnt vmcnt(10)
    s_barrier
    s_add_u32 m0, s88, 36864
    s_nop 0
    s_nop 0
    buffer_load_dwordx4 v4, s[28:31], s86 offen  lds
    buffer_load_dwordx4 v5, s[28:31], s86 offen offset:1024  lds
    s_add_u32 m0, s89, 61440
    s_add_u32 s101, s87, 2048
    buffer_load_dwordx4 v6, s[32:35], s101 offen  lds
    buffer_load_dwordx4 v7, s[32:35], s101 offen offset:1024  lds
    s_add_u32 m0, s88, 38912
    s_add_u32 s101, s86, 32768
    buffer_load_dwordx4 v4, s[28:31], s101 offen  lds
    buffer_load_dwordx4 v5, s[28:31], s101 offen offset:1024  lds
    s_add_u32 m0, s89, 69632
    s_add_u32 s101, s87, 4096
    buffer_load_dwordx4 v6, s[32:35], s101 offen  lds
    buffer_load_dwordx4 v7, s[32:35], s101 offen offset:1024  lds
    s_add_u32 m0, s89, 53248
    s_nop 0
    buffer_load_dwordx4 v6, s[32:35], s87 offen  lds
    buffer_load_dwordx4 v7, s[32:35], s87 offen offset:1024  lds
    s_add_u32 s86, s86, 128
    s_add_u32 s87, s87, 393216
    s_and_b32 s86, s86, 2047
    s_cselect_b32 s87, s87, 0
    s_waitcnt vmcnt(10)
    s_barrier
    s_add_u32 m0, s88, 77824
    s_nop 0
    s_nop 0
    buffer_load_dwordx4 v4, s[28:31], s86 offen  lds
    buffer_load_dwordx4 v5, s[28:31], s86 offen offset:1024  lds
    s_add_u32 m0, s89, 102400
    s_add_u32 s101, s87, 2048
    buffer_load_dwordx4 v6, s[32:35], s101 offen  lds
    buffer_load_dwordx4 v7, s[32:35], s101 offen offset:1024  lds
    s_add_u32 m0, s88, 79872
    s_add_u32 s101, s86, 32768
    buffer_load_dwordx4 v4, s[28:31], s101 offen  lds
    buffer_load_dwordx4 v5, s[28:31], s101 offen offset:1024  lds
    s_add_u32 m0, s89, 110592
    s_add_u32 s101, s87, 4096
    buffer_load_dwordx4 v6, s[32:35], s101 offen  lds
    buffer_load_dwordx4 v7, s[32:35], s101 offen offset:1024  lds
    s_add_u32 m0, s89, 94208
    s_nop 0
    buffer_load_dwordx4 v6, s[32:35], s87 offen  lds
    buffer_load_dwordx4 v7, s[32:35], s87 offen offset:1024  lds
    s_add_u32 s86, s86, 128
    s_add_u32 s87, s87, 393216
    s_and_b32 s86, s86, 2047
    s_cselect_b32 s87, s87, 0
    s_mov_b32 s100, 21504
    buffer_load_dwordx4 v[108:111], v244, s[52:55], s100 offen nt
    s_mov_b32 s100, 28672
    buffer_load_dwordx4 v[80:83], v244, s[48:51], s100 offen nt
    s_mov_b32 s100, 28672
    buffer_load_dwordx4 v[112:115], v244, s[52:55], s100 offen nt
    s_mov_b32 s100, 35840
    buffer_load_dwordx4 v[84:87], v244, s[48:51], s100 offen nt
    s_mov_b32 s100, 35840
    buffer_load_dwordx4 v[116:119], v244, s[52:55], s100 offen nt
    s_mov_b32 s100, 43008
    buffer_load_dwordx4 v[88:91], v244, s[48:51], s100 offen nt
    s_mov_b32 s100, 43008
    buffer_load_dwordx4 v[120:123], v244, s[52:55], s100 offen nt
    s_waitcnt vmcnt(17)
    s_barrier
    s_add_u32 m0, s88, 118784
    s_nop 0
    s_nop 0
    buffer_load_dwordx4 v4, s[28:31], s86 offen  lds
    buffer_load_dwordx4 v5, s[28:31], s86 offen offset:1024  lds
    s_add_u32 m0, s89, 143360
    s_add_u32 s101, s87, 2048
    buffer_load_dwordx4 v6, s[32:35], s101 offen  lds
    buffer_load_dwordx4 v7, s[32:35], s101 offen offset:1024  lds
    s_add_u32 m0, s88, 120832
    s_add_u32 s101, s86, 32768
    buffer_load_dwordx4 v4, s[28:31], s101 offen  lds
    buffer_load_dwordx4 v5, s[28:31], s101 offen offset:1024  lds
    s_add_u32 m0, s89, 151552
    s_add_u32 s101, s87, 4096
    buffer_load_dwordx4 v6, s[32:35], s101 offen  lds
    buffer_load_dwordx4 v7, s[32:35], s101 offen offset:1024  lds
    s_add_u32 m0, s89, 135168
    s_nop 0
    buffer_load_dwordx4 v6, s[32:35], s87 offen  lds
    buffer_load_dwordx4 v7, s[32:35], s87 offen offset:1024  lds
    s_add_u32 s86, s86, 128
    s_add_u32 s87, s87, 393216
    s_and_b32 s86, s86, 2047
    s_cselect_b32 s87, s87, 0
    s_waitcnt vmcnt(17)
    s_barrier
    s_add_u32 m0, s88, 36864
    s_nop 0
    s_nop 0
    buffer_load_dwordx4 v4, s[28:31], s86 offen  lds
    buffer_load_dwordx4 v5, s[28:31], s86 offen offset:1024  lds
    s_add_u32 m0, s89, 61440
    s_add_u32 s101, s87, 2048
    buffer_load_dwordx4 v6, s[32:35], s101 offen  lds
    buffer_load_dwordx4 v7, s[32:35], s101 offen offset:1024  lds
    s_add_u32 m0, s88, 38912
    s_add_u32 s101, s86, 32768
    buffer_load_dwordx4 v4, s[28:31], s101 offen  lds
    buffer_load_dwordx4 v5, s[28:31], s101 offen offset:1024  lds
    s_add_u32 m0, s89, 69632
    s_add_u32 s101, s87, 4096
    buffer_load_dwordx4 v6, s[32:35], s101 offen  lds
    buffer_load_dwordx4 v7, s[32:35], s101 offen offset:1024  lds
    s_add_u32 m0, s89, 53248
    s_nop 0
    buffer_load_dwordx4 v6, s[32:35], s87 offen  lds
    buffer_load_dwordx4 v7, s[32:35], s87 offen offset:1024  lds
    s_add_u32 s86, s86, 128
    s_add_u32 s87, s87, 393216
    s_and_b32 s86, s86, 2047
    s_cselect_b32 s87, s87, 0
    s_waitcnt vmcnt(10)
    s_barrier
    s_cmp_lg_u32 s76, 0
    s_cbranch_scc1 Lpl_18
    s_mov_b32 exec_hi, 0xffff
    buffer_load_dwordx2 v[198:199], v196, s[36:39], 0 offen sc1
    s_mov_b64 exec, -1
Lpl_18:
    s_add_u32 m0, s88, 77824
    s_nop 0
    buffer_load_dwordx4 v4, s[28:31], s86 offen  lds
    buffer_load_dwordx4 v5, s[28:31], s86 offen offset:1024  lds
    s_add_u32 m0, s89, 102400
    s_add_u32 s101, s87, 2048
    buffer_load_dwordx4 v6, s[32:35], s101 offen  lds
    buffer_load_dwordx4 v7, s[32:35], s101 offen offset:1024  lds
    s_add_u32 m0, s88, 79872
    s_add_u32 s101, s86, 32768
    buffer_load_dwordx4 v4, s[28:31], s101 offen  lds
    buffer_load_dwordx4 v5, s[28:31], s101 offen offset:1024  lds
    s_add_u32 m0, s89, 110592
    s_add_u32 s101, s87, 4096
    buffer_load_dwordx4 v6, s[32:35], s101 offen  lds
    buffer_load_dwordx4 v7, s[32:35], s101 offen offset:1024  lds
    s_add_u32 m0, s89, 94208
    s_nop 0
    buffer_load_dwordx4 v6, s[32:35], s87 offen  lds
    buffer_load_dwordx4 v7, s[32:35], s87 offen offset:1024  lds
    s_add_u32 s86, s86, 128
    s_add_u32 s87, s87, 393216
    s_and_b32 s86, s86, 2047
    s_cselect_b32 s87, s87, 0
    s_waitcnt vmcnt(10)
    s_barrier
    s_cmp_lg_u32 s76, 2
    s_cbranch_scc1 Lc4_19
    s_mov_b32 exec_hi, -1
    buffer_load_dword v238, v63, s[40:43], 0 offen
    s_mov_b64 exec, -1
Lc4_19:
    s_add_u32 m0, s88, 118784
    s_nop 0
    s_nop 0
    buffer_load_dwordx4 v4, s[28:31], s86 offen  lds
    buffer_load_dwordx4 v5, s[28:31], s86 offen offset:1024  lds
    s_add_u32 m0, s89, 143360
    s_add_u32 s101, s87, 2048
    buffer_load_dwordx4 v6, s[32:35], s101 offen  lds
    buffer_load_dwordx4 v7, s[32:35], s101 offen offset:1024  lds
    s_add_u32 m0, s88, 120832
    s_add_u32 s101, s86, 32768
    buffer_load_dwordx4 v4, s[28:31], s101 offen  lds
    buffer_load_dwordx4 v5, s[28:31], s101 offen offset:1024  lds
    s_add_u32 m0, s89, 151552
    s_add_u32 s101, s87, 4096
    buffer_load_dwordx4 v6, s[32:35], s101 offen  lds
    buffer_load_dwordx4 v7, s[32:35], s101 offen offset:1024  lds
    s_add_u32 m0, s89, 135168
    s_nop 0
    buffer_load_dwordx4 v6, s[32:35], s87 offen  lds
    buffer_load_dwordx4 v7, s[32:35], s87 offen offset:1024  lds
    s_add_u32 s86, s86, 128
    s_add_u32 s87, s87, 393216
    s_and_b32 s86, s86, 2047
    s_cselect_b32 s87, s87, 0
    s_waitcnt vmcnt(10)
    s_cmp_lg_u32 s76, 0
    s_cbranch_scc1 Lpc_20
    s_mov_b32 exec_hi, 0xffff
    s_mov_b32 s85, 0
    s_branch Lpk_21
Lspin_22:
    s_add_u32 s85, s85, 1
    s_cmp_gt_u32 s85, 400000
    s_cbranch_scc1 L_end
    buffer_load_dwordx2 v[198:199], v196, s[36:39], 0 offen sc1
    s_waitcnt vmcnt(0)
Lpk_21:
    v_cmp_ne_u32 vcc, s75, v198
    s_cbranch_vccnz Lspin_22
    v_cmp_ne_u32 vcc, s99, v199
    s_mov_b64 exec, -1
    s_lshr_b32 s78, vcc_lo, 16
    s_cselect_b32 s78, 0, 1
    s_cmp_eq_u32 vcc_hi, 0
    s_cselect_b32 s79, 2, 0
    s_or_b32 s78, s78, s79
    s_and_b32 s78, s78, 3
    v_mov_b32_e64 v198, s78
    v_mov_b32 v199, 163584
    ds_write_b32 v199, v198
    s_waitcnt lgkmcnt(0)
Lpc_20:
    s_barrier
    v_lshrrev_b32 v196, 4, v2
    v_and_b32 v197, 15, v2
    v_lshlrev_b32_e64 v197, 4, v197
    v_lshl_add_u32 v198, v196, 10, v197
    s_lshl_b32 s78, s69, 14
    s_lshl_b32 s79, s76, 8
    s_add_u32 s78, s78, s79
    s_nop 0
    s_add_u32 s78, s78, 65536
    buffer_load_dwordx4 v[20:23], v198, s[36:39], s78 offen sc1
    s_add_u32 s78, s78, 4096
    buffer_load_dwordx4 v[24:27], v198, s[36:39], s78 offen sc1
    s_add_u32 s78, s78, 4096
    buffer_load_dwordx4 v[28:31], v198, s[36:39], s78 offen sc1
    s_add_u32 s78, s78, 4096
    buffer_load_dwordx4 v[32:35], v198, s[36:39], s78 offen sc1
    v_mul_u32_u24 v198, 768, v196
    v_add_u32_e64 v198, v198, v197
    s_mul_i32 s78, s70, 12288
    s_lshl_b32 s79, s76, 8
    s_add_u32 s78, s78, s79
    s_add_u32 s78, s78, 327680
    s_cmp_eq_u32 s76, 3
    s_nop 0
    s_cselect_b32 s78, 0x10000000, s78
    buffer_load_dwordx4 v[36:39], v198, s[36:39], s78 offen sc1
    s_add_u32 s78, s78, 3072
    buffer_load_dwordx4 v[40:43], v198, s[36:39], s78 offen sc1
    s_add_u32 s78, s78, 3072
    buffer_load_dwordx4 v[44:47], v198, s[36:39], s78 offen sc1
    s_add_u32 s78, s78, 3072
    buffer_load_dwordx4 v[48:51], v198, s[36:39], s78 offen sc1
    s_add_u32 m0, s84, 0
    s_mov_b32 s100, 0
    buffer_load_dwordx4 v246, s[40:43], s100 offen  lds
    s_add_u32 m0, s84, 4096
    s_mov_b32 s100, 65536
    buffer_load_dwordx4 v246, s[40:43], s100 offen  lds
    s_add_u32 m0, s84, 8192
    s_mov_b32 s100, 131072
    buffer_load_dwordx4 v246, s[40:43], s100 offen  lds
    s_add_u32 m0, s84, 12288
    s_mov_b32 s100, 196608
    buffer_load_dwordx4 v246, s[40:43], s100 offen  lds
    s_waitcnt vmcnt(12)
    s_waitcnt lgkmcnt(0)
    s_barrier
    s_setprio 2
    s_add_u32 m0, s84, 16384
    s_mov_b32 s100, 262144
    buffer_load_dwordx4 v246, s[40:43], s100 offen  lds
    s_waitcnt vmcnt(9)
    v_add_f32 v20, v20, v24
    v_add_f32 v21, v21, v25
    v_add_f32 v22, v22, v26
    v_add_f32 v23, v23, v27
    v_add_f32 v20, v20, v28
    v_add_f32_e64 v21, v21, v29
    s_add_u32 m0, s84, 20480
    s_mov_b32 s100, 327680
    buffer_load_dwordx4 v246, s[40:43], s100 offen  lds
    v_add_f32 v22, v22, v30
    v_add_f32 v23, v23, v31
    v_add_f32 v20, v20, v32
    v_add_f32 v21, v21, v33
    v_add_f32 v22, v22, v34
    v_add_f32 v23, v23, v35
    s_nop 0
    v_permlane32_swap_b32 v20, v22
    s_add_u32 m0, s84, 24576
    s_mov_b32 s100, 393216
    buffer_load_dwordx4 v246, s[40:43], s100 offen  lds
    v_permlane32_swap_b32 v21, v23
    v_add_f32 v20, v20, v22
    v_add_f32 v21, v21, v23
    v_mov_b32 v22, v20
    v_mov_b32 v23, v21
    s_nop 0
    v_permlane16_swap_b32 v20, v22
    v_permlane16_swap_b32 v21, v23
    v_add_f32_e64 v20, v20, v22
    s_add_u32 m0, s84, 28672
    s_mov_b32 s100, 458752
    buffer_load_dwordx4 v246, s[40:43], s100 offen  lds
    v_add_f32_e64 v21, v21, v23
    v_mul_f32 v24, 0x3a800000, v20
    v_mul_f32 v26, 0x3a800000, v21
    v_fma_f32 v26, -v24, v24, v26
    v_max_f32_e64 v26, 0, v26
    v_cvt_pk_bf16_f32 v24, v24, v24
    v_and_b32 v24, 0xffff0000, v24
    s_add_u32 m0, s84, 32768
    s_mov_b32 s100, 524288
    buffer_load_dwordx4 v246, s[40:43], s100 offen  lds
    v_cvt_pk_bf16_f32 v26, v26, v26
    v_and_b32 v26, 0xffff0000, v26
    v_add_f32 v26, 0x3727c5ac, v26
    v_cvt_pk_bf16_f32 v26, v26, v26
    v_and_b32 v26, 0xffff0000, v26
    v_sqrt_f32 v26, v26
    s_nop 0
    v_cvt_pk_bf16_f32 v26, v26, v26
    v_and_b32 v26, 0xffff0000, v26
    s_add_u32 m0, s84, 36864
    s_mov_b32 s100, 589824
    buffer_load_dwordx4 v246, s[40:43], s100 offen  lds
    v_rcp_f32_e64 v25, v26
    v_xor_b32 v26, 0x80000000, v24
    v_lshrrev_b32 v27, 16, v26
    v_or_b32 v26, v26, v27
    v_mov_b32 v27, 0
    v_and_b32 v196, 15, v2
    v_lshrrev_b32_e64 v197, 5, v2
    s_add_u32 m0, s84, 40960
    s_mov_b32 s100, 655360
    buffer_load_dwordx4 v246, s[40:43], s100 offen  lds
    v_lshl_add_u32 v196, v196, 1, v197
    s_lshl_b32 s78, s76, 5
    v_add_u32 v196, s78, v196
    v_lshlrev_b32_e64 v197, 3, v196
    v_add_u32 v197, 159744, v197
    v_lshlrev_b32_e64 v196, 2, v196
    v_add_u32 v196, 162304, v196
    s_add_u32 m0, s84, 45056
    s_mov_b32 s100, 720896
    buffer_load_dwordx4 v246, s[40:43], s100 offen  lds
    ds_write_b64 v197, v[26:27]
    ds_write_b32 v196, v25
    s_waitcnt vmcnt(12)
    v_add_f32 v36, v36, v40
    v_add_f32 v37, v37, v41
    v_add_f32 v38, v38, v42
    v_add_f32 v39, v39, v43
    v_add_f32 v36, v36, v44
    s_add_u32 m0, s84, 49152
    s_mov_b32 s100, 786432
    buffer_load_dwordx4 v246, s[40:43], s100 offen  lds
    v_add_f32 v37, v37, v45
    v_add_f32 v38, v38, v46
    v_add_f32 v39, v39, v47
    v_add_f32 v36, v36, v48
    v_add_f32 v37, v37, v49
    v_add_f32 v38, v38, v50
    v_add_f32_e64 v39, v39, v51
    s_add_u32 m0, s84, 53248
    s_mov_b32 s100, 851968
    buffer_load_dwordx4 v246, s[40:43], s100 offen  lds
    v_permlane32_swap_b32 v36, v38
    v_permlane32_swap_b32 v37, v39
    v_add_f32 v36, v36, v38
    v_add_f32 v37, v37, v39
    s_nop 1
    v_permlane16_swap_b32 v36, v37
    v_add_f32_e64 v36, v36, v37
    v_cvt_pk_bf16_f32 v37, v36, v36
    v_and_b32 v37, 0xffff0000, v37
    s_add_u32 m0, s84, 57344
    s_mov_b32 s100, 917504
    buffer_load_dwordx4 v246, s[40:43], s100 offen  lds
    v_sub_f32_e64 v38, v36, v37
    v_cvt_pk_bf16_f32 v38, v37, v38
    v_mov_b32 v39, 0
    v_and_b32 v196, 15, v2
    v_lshrrev_b32_e64 v197, 4, v2
    v_lshl_add_u32 v196, v196, 2, v197
    s_lshl_b32 s78, s76, 9
    s_add_u32 m0, s84, 61440
    s_mov_b32 s100, 983040
    buffer_load_dwordx4 v246, s[40:43], s100 offen  lds
    s_add_u32 s78, s78, 160768
    v_lshl_add_u32 v196, v196, 3, s78
    v_and_b32 v197, 15, v2
    v_lshlrev_b32_e64 v197, 3, v197
    v_add_u32 v197, 162816, v197
    v_mov_b32 v198, 0x3f803f80
    s_cmp_eq_u32 s76, 3
    s_cselect_b64 vcc, -1, 0
    v_cndmask_b32 v196, v196, v197, vcc
    v_cndmask_b32 v38, v38, v198, vcc
    v_cndmask_b32_e64 v39, v39, v198, vcc
    ds_write_b64 v196, v[38:39]
    s_setprio 0
    s_waitcnt lgkmcnt(0)
    s_barrier
    s_branch L_phend
L_ph3:
    s_setprio 2
    s_add_u32 m0, s88, 36864
    s_nop 0
    buffer_load_dwordx4 v4, s[28:31], s86 offen  lds
    v_mov_b32 v200, 0x3f803f80
    v_mov_b32 v201, 0x3f803f80
    v_mov_b32 v202, 0x3f803f80
    v_mov_b32 v203, 0x3f803f80
    buffer_load_dwordx4 v5, s[28:31], s86 offen offset:1024  lds
    s_nop 0
    s_nop 0
    v_mfma_f32_16x16x32_bf16 v[204:207], v[200:203], v[20:23], 0
    v_mfma_f32_16x16x32_bf16 v[212:215], v[20:23], v[20:23], 0
    v_mfma_f32_16x16x32_bf16 v[208:211], v[200:203], v[24:27], 0
    v_mfma_f32_16x16x32_bf16 v[216:219], v[24:27], v[24:27], 0
    v_mfma_f32_16x16x32_bf16 v[220:223], v[200:203], v[36:39], 0
    s_add_u32 m0, s89, 61440
    s_add_u32 s101, s87, 2048
    buffer_load_dwordx4 v6, s[32:35], s101 offen  lds
    v_mfma_f32_16x16x32_bf16 v[224:227], v[200:203], v[44:47], 0
    v_mfma_f32_16x16x32_bf16 v[228:231], v[200:203], v[52:55], 0
    v_mfma_f32_16x16x32_bf16 v[204:207], v[200:203], v[28:31], v[204:207]
    v_mfma_f32_16x16x32_bf16 v[212:215], v[28:31], v[28:31], v[212:215]
    v_mfma_f32_16x16x32_bf16 v[208:211], v[200:203], v[32:35], v[208:211]
    buffer_load_dwordx4 v7, s[32:35], s101 offen offset:1024  lds
    v_mfma_f32_16x16x32_bf16 v[216:219], v[32:35], v[32:35], v[216:219]
    v_mfma_f32_16x16x32_bf16 v[220:223], v[200:203], v[40:43], v[220:223]
    v_mfma_f32_16x16x32_bf16 v[224:227], v[200:203], v[48:51], v[224:227]
    v_mfma_f32_16x16x32_bf16 v[228:231], v[200:203], v[56:59], v[228:231]
    v_and_b32_e64 v196, 3, v2
    s_add_u32 m0, s88, 38912
    s_add_u32 s101, s86, 32768
    buffer_load_dwordx4 v4, s[28:31], s101 offen  lds
    v_cmp_eq_u32 s[90:91], 1, v196
    v_cmp_eq_u32 s[92:93], 2, v196
    v_cmp_eq_u32_e64 vcc, 3, v196
    v_cndmask_b32 v212, v212, v213, s[90:91]
    v_cndmask_b32 v212, v212, v214, s[92:93]
    buffer_load_dwordx4 v5, s[28:31], s101 offen offset:1024  lds
    v_cndmask_b32_e64 v205, v212, v215, vcc
    v_cndmask_b32 v216, v216, v217, s[90:91]
    v_cndmask_b32 v216, v216, v218, s[92:93]
    v_cndmask_b32 v209, v216, v219, vcc
    v_lshrrev_b32 v196, 4, v2
    s_add_u32 m0, s89, 69632
    s_add_u32 s101, s87, 4096
    buffer_load_dwordx4 v6, s[32:35], s101 offen  lds
    v_cmp_eq_u32 s[90:91], 1, v196
    v_cmp_eq_u32 vcc, 2, v196
    s_nop 0
    v_cndmask_b32 v220, v220, v224, s[90:91]
    v_cndmask_b32_e64 v220, v220, v228, vcc
    s_mul_i32 s78, s77, 768
    buffer_load_dwordx4 v7, s[32:35], s101 offen offset:1024  lds
    s_mul_i32 s79, s76, 192
    s_add_u32 s78, s78, s79
    s_add_u32 s78, s78, 327680
    v_lshlrev_b32 v197, 2, v2
    s_mov_b32 exec_hi, 0xffff
    buffer_store_dword v220, v197, s[36:39], s78 offen sc1
    s_mov_b32 exec_hi, -1
    s_add_u32 m0, s89, 53248
    s_nop 0
    buffer_load_dwordx4 v6, s[32:35], s87 offen  lds
    s_lshl_b32 s78, s69, 4
    s_add_u32 s78, s78, s70
    s_lshl_b32 s78, s78, 10
    s_lshl_b32 s79, s76, 8
    s_add_u32 s78, s78, s79
    buffer_load_dwordx4 v7, s[32:35], s87 offen offset:1024  lds
    s_add_u32 s86, s86, 128
    s_add_u32 s87, s87, 393216
    s_and_b32 s86, s86, 2047
    s_cselect_b32 s87, s87, 0
    s_add_u32 s78, s78, 65536
    v_and_b32 v198, 15, v2
    v_lshlrev_b32 v198, 3, v198
    s_mov_b32 exec_lo, 0x00f0000f
    s_mov_b32 exec_hi, 0xf0000f00
    buffer_store_dwordx2 v[204:205], v198, s[36:39], s78 offen offset:0 sc1
    s_mov_b64 exec, -1
    s_mov_b32 exec_lo, 0x00f0000f
    s_mov_b32 exec_hi, 0xf0000f00
    buffer_store_dwordx2 v[208:209], v198, s[36:39], s78 offen offset:128 sc1
    s_mov_b64 exec, -1
    s_setprio 0
    s_waitcnt vmcnt(13)
    s_waitcnt lgkmcnt(0)
    s_barrier
    s_add_u32 m0, s88, 77824
    s_nop 0
    s_nop 0
    buffer_load_dwordx4 v4, s[28:31], s86 offen  lds
    buffer_load_dwordx4 v5, s[28:31], s86 offen offset:1024  lds
    s_add_u32 m0, s89, 102400
    s_add_u32 s101, s87, 2048
    buffer_load_dwordx4 v6, s[32:35], s101 offen  lds
    buffer_load_dwordx4 v7, s[32:35], s101 offen offset:1024  lds
    s_add_u32 m0, s88, 79872
    s_add_u32 s101, s86, 32768
    buffer_load_dwordx4 v4, s[28:31], s101 offen  lds
    buffer_load_dwordx4 v5, s[28:31], s101 offen offset:1024  lds
    s_add_u32 m0, s89, 110592
    s_add_u32 s101, s87, 4096
    buffer_load_dwordx4 v6, s[32:35], s101 offen  lds
    buffer_load_dwordx4 v7, s[32:35], s101 offen offset:1024  lds
    s_add_u32 m0, s89, 94208
    s_nop 0
    buffer_load_dwordx4 v6, s[32:35], s87 offen  lds
    buffer_load_dwordx4 v7, s[32:35], s87 offen offset:1024  lds
    s_add_u32 s86, s86, 128
    s_add_u32 s87, s87, 393216
    s_and_b32 s86, s86, 2047
    s_cselect_b32 s87, s87, 0
    buffer_store_dwordx4 v[16:19], v14, s[36:39], s96 offen offset:0 sc1
    s_waitcnt vmcnt(13)
    s_waitcnt lgkmcnt(0)
    s_barrier
    s_add_u32 m0, s88, 118784
    s_nop 0
    buffer_load_dwordx4 v4, s[28:31], s86 offen  lds
    buffer_load_dwordx4 v5, s[28:31], s86 offen offset:1024  lds
    s_add_u32 m0, s89, 143360
    s_add_u32 s101, s87, 2048
    buffer_load_dwordx4 v6, s[32:35], s101 offen  lds
    buffer_load_dwordx4 v7, s[32:35], s101 offen offset:1024  lds
    s_add_u32 m0, s88, 120832
    s_add_u32 s101, s86, 32768
    buffer_load_dwordx4 v4, s[28:31], s101 offen  lds
    buffer_load_dwordx4 v5, s[28:31], s101 offen offset:1024  lds
    s_add_u32 m0, s89, 151552
    s_add_u32 s101, s87, 4096
    buffer_load_dwordx4 v6, s[32:35], s101 offen  lds
    buffer_load_dwordx4 v7, s[32:35], s101 offen offset:1024  lds
    s_add_u32 m0, s89, 135168
    s_nop 0
    buffer_load_dwordx4 v6, s[32:35], s87 offen  lds
    buffer_load_dwordx4 v7, s[32:35], s87 offen offset:1024  lds
    s_add_u32 s86, s86, 128
    s_add_u32 s87, s87, 393216
    s_and_b32 s86, s86, 2047
    s_cselect_b32 s87, s87, 0
    s_waitcnt vmcnt(10)
    s_barrier
    s_cmp_lg_u32 s76, 0
    s_cbranch_scc1 Lfl_23
    s_getreg_b32 s99, hwreg(HW_REG_XCC_ID, 0, 4)
    v_mov_b32 v198, s75
    v_mov_b32 v199, s99
    v_lshlrev_b32_e64 v197, 3, v2
    s_lshl_b32 s78, s77, 7
    s_add_u32 s79, s78, 8781824
    s_add_u32 s78, s78, 4096
    s_lshl_b32 s80, s71, 4
    s_add_u32 s80, s80, s72
    s_lshl_b32 s80, s80, 7
    s_add_u32 s80, s80, 8847360
    s_mov_b64 exec, 0xffff
    buffer_store_dwordx2 v[198:199], v197, s[36:39], s78 offen sc1
    buffer_store_dwordx2 v[198:199], v197, s[36:39], s80 offen sc1
    v_not_b32 v200, v198
    v_mov_b32_e64 v201, 0
    buffer_store_dwordx2 v[200:201], v197, s[36:39], s79 offen sc1
    s_mov_b64 exec, -1
    v_and_b32 v196, 15, v2
    v_lshlrev_b32 v197, 4, v196
    v_add_u32 v197, s69, v197
    s_lshl_b32 s78, s70, 4
    s_lshl_b32 s79, s71, 4
    s_add_u32 s79, s79, 69088
    v_mov_b32 v202, s78
    v_mov_b32 v203, s79
    v_cmp_gt_u32 vcc, 32, v2
    s_nop 1
    v_cndmask_b32 v202, v203, v202, vcc
    v_add_u32 v196, v202, v196
    v_cmp_gt_u32 vcc, 16, v2
    s_nop 1
    v_cndmask_b32 v196, v196, v197, vcc
    v_lshlrev_b32 v196, 7, v196
    v_add_u32 v196, 4096, v196
Lfl_23:
    s_add_u32 m0, s88, 36864
    s_nop 0
    s_nop 0
    buffer_load_dwordx4 v4, s[28:31], s86 offen  lds
    buffer_load_dwordx4 v5, s[28:31], s86 offen offset:1024  lds
    s_add_u32 m0, s89, 61440
    s_add_u32 s101, s87, 2048
    buffer_load_dwordx4 v6, s[32:35], s101 offen  lds
    buffer_load_dwordx4 v7, s[32:35], s101 offen offset:1024  lds
    s_add_u32 m0, s88, 38912
    s_add_u32 s101, s86, 32768
    buffer_load_dwordx4 v4, s[28:31], s101 offen  lds
    buffer_load_dwordx4 v5, s[28:31], s101 offen offset:1024  lds
    s_add_u32 m0, s89, 69632
    s_add_u32 s101, s87, 4096
    buffer_load_dwordx4 v6, s[32:35], s101 offen  lds
    buffer_load_dwordx4 v7, s[32:35], s101 offen offset:1024  lds
    s_add_u32 m0, s89, 53248
    s_nop 0
    buffer_load_dwordx4 v6, s[32:35], s87 offen  lds
    buffer_load_dwordx4 v7, s[32:35], s87 offen offset:1024  lds
    s_add_u32 s86, s86, 128
    s_add_u32 s87, s87, 393216
    s_and_b32 s86, s86, 2047
    s_cselect_b32 s87, s87, 0
    s_mov_b32 s100, 0
    buffer_load_dwordx4 v[64:67], v244, s[48:51], s100 offen nt
    s_mov_b32 s100, 0
    buffer_load_dwordx4 v[96:99], v244, s[52:55], s100 offen nt
    s_mov_b32 s100, 7168
    buffer_load_dwordx4 v[68:71], v244, s[48:51], s100 offen nt
    s_mov_b32 s100, 7168
    buffer_load_dwordx4 v[100:103], v244, s[52:55], s100 offen nt
    s_mov_b32 s100, 14336
    buffer_load_dwordx4 v[72:75], v244, s[48:51], s100 offen nt
    s_mov_b32 s100, 14336
    buffer_load_dwordx4 v[104:107], v244, s[52:55], s100 offen nt
    s_mov_b32 s100, 21504
    buffer_load_dwordx4 v[76:79], v244, s[48:51], s100 offen nt
    s_waitcnt vmcnt(17)
    s_barrier
    s_add_u32 m0, s88, 77824
    s_nop 0
    s_nop 0
    buffer_load_dwordx4 v4, s[28:31], s86 offen  lds
    buffer_load_dwordx4 v5, s[28:31], s86 offen offset:1024  lds
    s_add_u32 m0, s89, 102400
    s_add_u32 s101, s87, 2048
    buffer_load_dwordx4 v6, s[32:35], s101 offen  lds
    buffer_load_dwordx4 v7, s[32:35], s101 offen offset:1024  lds
    s_add_u32 m0, s88, 79872
    s_add_u32 s101, s86, 32768
    buffer_load_dwordx4 v4, s[28:31], s101 offen  lds
    buffer_load_dwordx4 v5, s[28:31], s101 offen offset:1024  lds
    s_add_u32 m0, s89, 110592
    s_add_u32 s101, s87, 4096
    buffer_load_dwordx4 v6, s[32:35], s101 offen  lds
    buffer_load_dwordx4 v7, s[32:35], s101 offen offset:1024  lds
    s_add_u32 m0, s89, 94208
    s_nop 0
    buffer_load_dwordx4 v6, s[32:35], s87 offen  lds
    buffer_load_dwordx4 v7, s[32:35], s87 offen offset:1024  lds
    s_add_u32 s86, s86, 128
    s_add_u32 s87, s87, 393216
    s_and_b32 s86, s86, 2047
    s_cselect_b32 s87, s87, 0
    s_waitcnt vmcnt(17)
    s_barrier
    s_add_u32 m0, s88, 118784
    s_nop 0
    s_nop 0
    buffer_load_dwordx4 v4, s[28:31], s86 offen  lds
    buffer_load_dwordx4 v5, s[28:31], s86 offen offset:1024  lds
    s_add_u32 m0, s89, 143360
    s_add_u32 s101, s87, 2048
    buffer_load_dwordx4 v6, s[32:35], s101 offen  lds
    buffer_load_dwordx4 v7, s[32:35], s101 offen offset:1024  lds
    s_add_u32 m0, s88, 120832
    s_add_u32 s101, s86, 32768
    buffer_load_dwordx4 v4, s[28:31], s101 offen  lds
    buffer_load_dwordx4 v5, s[28:31], s101 offen offset:1024  lds
    s_add_u32 m0, s89, 151552
    s_add_u32 s101, s87, 4096
    buffer_load_dwordx4 v6, s[32:35], s101 offen  lds
    buffer_load_dwordx4 v7, s[32:35], s101 offen offset:1024  lds
    s_add_u32 m0, s89, 135168
    s_nop 0
    buffer_load_dwordx4 v6, s[32:35], s87 offen  lds
    buffer_load_dwordx4 v7, s[32:35], s87 offen offset:1024  lds
    s_add_u32 s86, s86, 128
    s_add_u32 s87, s87, 393216
    s_and_b32 s86, s86, 2047
    s_cselect_b32 s87, s87, 0
    s_waitcnt vmcnt(10)
    s_barrier
    s_add_u32 m0, s88, 36864
    s_nop 0
    s_nop 0
    buffer_load_dwordx4 v4, s[28:31], s86 offen  lds
    buffer_load_dwordx4 v5, s[28:31], s86 offen offset:1024  lds
    s_add_u32 m0, s89, 61440
    s_add_u32 s101, s87, 2048
    buffer_load_dwordx4 v6, s[32:35], s101 offen  lds
    buffer_load_dwordx4 v7, s[32:35], s101 offen offset:1024  lds
    s_add_u32 m0, s88, 38912
    s_add_u32 s101, s86, 32768
    buffer_load_dwordx4 v4, s[28:31], s101 offen  lds
    buffer_load_dwordx4 v5, s[28:31], s101 offen offset:1024  lds
    s_add_u32 m0, s89, 69632
    s_add_u32 s101, s87, 4096
    buffer_load_dwordx4 v6, s[32:35], s101 offen  lds
    buffer_load_dwordx4 v7, s[32:35], s101 offen offset:1024  lds
    s_add_u32 m0, s89, 53248
    s_nop 0
    buffer_load_dwordx4 v6, s[32:35], s87 offen  lds
    buffer_load_dwordx4 v7, s[32:35], s87 offen offset:1024  lds
    s_add_u32 s86, s86, 128
    s_add_u32 s87, s87, 393216
    s_and_b32 s86, s86, 2047
    s_cselect_b32 s87, s87, 0
    s_waitcnt vmcnt(10)
    s_barrier
    s_add_u32 m0, s88, 77824
    s_nop 0
    s_nop 0
    buffer_load_dwordx4 v4, s[28:31], s86 offen  lds
    buffer_load_dwordx4 v5, s[28:31], s86 offen offset:1024  lds
    s_add_u32 m0, s89, 102400
    s_add_u32 s101, s87, 2048
    buffer_load_dwordx4 v6, s[32:35], s101 offen  lds
    buffer_load_dwordx4 v7, s[32:35], s101 offen offset:1024  lds
    s_add_u32 m0, s88, 79872
    s_add_u32 s101, s86, 32768
    buffer_load_dwordx4 v4, s[28:31], s101 offen  lds
    buffer_load_dwordx4 v5, s[28:31], s101 offen offset:1024  lds
    s_add_u32 m0, s89, 110592
    s_add_u32 s101, s87, 4096
    buffer_load_dwordx4 v6, s[32:35], s101 offen  lds
    buffer_load_dwordx4 v7, s[32:35], s101 offen offset:1024  lds
    s_add_u32 m0, s89, 94208
    s_nop 0
    buffer_load_dwordx4 v6, s[32:35], s87 offen  lds
    buffer_load_dwordx4 v7, s[32:35], s87 offen offset:1024  lds
    s_add_u32 s86, s86, 128
    s_add_u32 s87, s87, 393216
    s_and_b32 s86, s86, 2047
    s_cselect_b32 s87, s87, 0
    s_waitcnt vmcnt(10)
    s_barrier
    s_add_u32 m0, s88, 118784
    s_nop 0
    s_nop 0
    buffer_load_dwordx4 v4, s[28:31], s86 offen  lds
    buffer_load_dwordx4 v5, s[28:31], s86 offen offset:1024  lds
    s_add_u32 m0, s89, 143360
    s_add_u32 s101, s87, 2048
    buffer_load_dwordx4 v6, s[32:35], s101 offen  lds
    buffer_load_dwordx4 v7, s[32:35], s101 offen offset:1024  lds
    s_add_u32 m0, s88, 120832
    s_add_u32 s101, s86, 32768
    buffer_load_dwordx4 v4, s[28:31], s101 offen  lds
    buffer_load_dwordx4 v5, s[28:31], s101 offen offset:1024  lds
    s_add_u32 m0, s89, 151552
    s_add_u32 s101, s87, 4096
    buffer_load_dwordx4 v6, s[32:35], s101 offen  lds
    buffer_load_dwordx4 v7, s[32:35], s101 offen offset:1024  lds
    s_add_u32 m0, s89, 135168
    s_nop 0
    buffer_load_dwordx4 v6, s[32:35], s87 offen  lds
    buffer_load_dwordx4 v7, s[32:35], s87 offen offset:1024  lds
    s_add_u32 s86, s86, 128
    s_add_u32 s87, s87, 393216
    s_and_b32 s86, s86, 2047
    s_cselect_b32 s87, s87, 0
    s_mov_b32 s100, 21504
    buffer_load_dwordx4 v[108:111], v244, s[52:55], s100 offen nt
    s_mov_b32 s100, 28672
    buffer_load_dwordx4 v[80:83], v244, s[48:51], s100 offen nt
    s_mov_b32 s100, 28672
    buffer_load_dwordx4 v[112:115], v244, s[52:55], s100 offen nt
    s_mov_b32 s100, 35840
    buffer_load_dwordx4 v[84:87], v244, s[48:51], s100 offen nt
    s_mov_b32 s100, 35840
    buffer_load_dwordx4 v[116:119], v244, s[52:55], s100 offen nt
    s_mov_b32 s100, 43008
    buffer_load_dwordx4 v[88:91], v244, s[48:51], s100 offen nt
    s_mov_b32 s100, 43008
    buffer_load_dwordx4 v[120:123], v244, s[52:55], s100 offen nt
    s_waitcnt vmcnt(17)
    s_barrier
    s_add_u32 m0, s88, 36864
    s_nop 0
    s_nop 0
    buffer_load_dwordx4 v4, s[28:31], s86 offen  lds
    buffer_load_dwordx4 v5, s[28:31], s86 offen offset:1024  lds
    s_add_u32 m0, s89, 61440
    s_add_u32 s101, s87, 2048
    buffer_load_dwordx4 v6, s[32:35], s101 offen  lds
    buffer_load_dwordx4 v7, s[32:35], s101 offen offset:1024  lds
    s_add_u32 m0, s88, 38912
    s_add_u32 s101, s86, 32768
    buffer_load_dwordx4 v4, s[28:31], s101 offen  lds
    buffer_load_dwordx4 v5, s[28:31], s101 offen offset:1024  lds
    s_add_u32 m0, s89, 69632
    s_add_u32 s101, s87, 4096
    buffer_load_dwordx4 v6, s[32:35], s101 offen  lds
    buffer_load_dwordx4 v7, s[32:35], s101 offen offset:1024  lds
    s_add_u32 m0, s89, 53248
    s_nop 0
    buffer_load_dwordx4 v6, s[32:35], s87 offen  lds
    buffer_load_dwordx4 v7, s[32:35], s87 offen offset:1024  lds
    s_add_u32 s86, s86, 128
    s_add_u32 s87, s87, 393216
    s_and_b32 s86, s86, 2047
    s_cselect_b32 s87, s87, 0
    s_waitcnt vmcnt(17)
    s_barrier
    s_cmp_lg_u32 s76, 0
    s_cbranch_scc1 Lpl_24
    s_mov_b32 exec_hi, 0xffff
    buffer_load_dwordx2 v[198:199], v196, s[36:39], 0 offen sc1
    s_mov_b64 exec, -1
Lpl_24:
    s_add_u32 m0, s88, 77824
    s_nop 0
    buffer_load_dwordx4 v4, s[28:31], s86 offen  lds
    buffer_load_dwordx4 v5, s[28:31], s86 offen offset:1024  lds
    s_add_u32 m0, s89, 102400
    s_add_u32 s101, s87, 2048
    buffer_load_dwordx4 v6, s[32:35], s101 offen  lds
    buffer_load_dwordx4 v7, s[32:35], s101 offen offset:1024  lds
    s_add_u32 m0, s88, 79872
    s_add_u32 s101, s86, 32768
    buffer_load_dwordx4 v4, s[28:31], s101 offen  lds
    buffer_load_dwordx4 v5, s[28:31], s101 offen offset:1024  lds
    s_add_u32 m0, s89, 110592
    s_add_u32 s101, s87, 4096
    buffer_load_dwordx4 v6, s[32:35], s101 offen  lds
    buffer_load_dwordx4 v7, s[32:35], s101 offen offset:1024  lds
    s_add_u32 m0, s89, 94208
    s_nop 0
    buffer_load_dwordx4 v6, s[32:35], s87 offen  lds
    buffer_load_dwordx4 v7, s[32:35], s87 offen offset:1024  lds
    s_add_u32 s86, s86, 128
    s_add_u32 s87, s87, 393216
    s_and_b32 s86, s86, 2047
    s_cselect_b32 s87, s87, 0
    s_waitcnt vmcnt(10)
    s_barrier
    s_cmp_lg_u32 s76, 2
    s_cbranch_scc1 Lc4_25
    s_mov_b32 exec_hi, -1
    buffer_load_dword v238, v63, s[40:43], 0 offen
    s_mov_b64 exec, -1
Lc4_25:
    s_add_u32 m0, s88, 118784
    s_nop 0
    s_nop 0
    buffer_load_dwordx4 v4, s[28:31], s86 offen  lds
    buffer_load_dwordx4 v5, s[28:31], s86 offen offset:1024  lds
    s_add_u32 m0, s89, 143360
    s_add_u32 s101, s87, 2048
    buffer_load_dwordx4 v6, s[32:35], s101 offen  lds
    buffer_load_dwordx4 v7, s[32:35], s101 offen offset:1024  lds
    s_add_u32 m0, s88, 120832
    s_add_u32 s101, s86, 32768
    buffer_load_dwordx4 v4, s[28:31], s101 offen  lds
    buffer_load_dwordx4 v5, s[28:31], s101 offen offset:1024  lds
    s_add_u32 m0, s89, 151552
    s_add_u32 s101, s87, 4096
    buffer_load_dwordx4 v6, s[32:35], s101 offen  lds
    buffer_load_dwordx4 v7, s[32:35], s101 offen offset:1024  lds
    s_add_u32 m0, s89, 135168
    s_nop 0
    buffer_load_dwordx4 v6, s[32:35], s87 offen  lds
    buffer_load_dwordx4 v7, s[32:35], s87 offen offset:1024  lds
    s_add_u32 s86, s86, 128
    s_add_u32 s87, s87, 393216
    s_and_b32 s86, s86, 2047
    s_cselect_b32 s87, s87, 0
    s_waitcnt vmcnt(10)
    s_cmp_lg_u32 s76, 0
    s_cbranch_scc1 Lpc_26
    s_mov_b32 exec_hi, 0xffff
    s_mov_b32 s85, 0
    s_branch Lpk_27
Lspin_28:
    s_add_u32 s85, s85, 1
    s_cmp_gt_u32 s85, 400000
    s_cbranch_scc1 L_end
    buffer_load_dwordx2 v[198:199], v196, s[36:39], 0 offen sc1
    s_waitcnt vmcnt(0)
Lpk_27:
    v_cmp_ne_u32 vcc, s75, v198
    s_cbranch_vccnz Lspin_28
    v_cmp_ne_u32 vcc, s99, v199
    s_mov_b64 exec, -1
    s_lshr_b32 s78, vcc_lo, 16
    s_cselect_b32 s78, 0, 1
    s_cmp_eq_u32 vcc_hi, 0
    s_cselect_b32 s79, 2, 0
    s_or_b32 s78, s78, s79
    s_and_b32 s78, s78, 3
    v_mov_b32_e64 v198, s78
    v_mov_b32 v199, 163584
    ds_write_b32 v199, v198
    s_waitcnt lgkmcnt(0)
Lpc_26:
    s_barrier
    v_lshrrev_b32 v196, 4, v2
    v_and_b32 v197, 15, v2
    v_lshlrev_b32_e64 v197, 4, v197
    v_lshl_add_u32 v198, v196, 10, v197
    s_lshl_b32 s78, s69, 14
    s_lshl_b32 s79, s76, 8
    s_add_u32 s78, s78, s79
    s_nop 0
    s_add_u32 s78, s78, 65536
    buffer_load_dwordx4 v[20:23], v198, s[36:39], s78 offen sc1
    s_add_u32 s78, s78, 4096
    buffer_load_dwordx4 v[24:27], v198, s[36:39], s78 offen sc1
    s_add_u32 s78, s78, 4096
    buffer_load_dwordx4 v[28:31], v198, s[36:39], s78 offen sc1
    s_add_u32 s78, s78, 4096
    buffer_load_dwordx4 v[32:35], v198, s[36:39], s78 offen sc1
    v_mul_u32_u24 v198, 768, v196
    v_add_u32_e64 v198, v198, v197
    s_mul_i32 s78, s70, 12288
    s_lshl_b32 s79, s76, 8
    s_add_u32 s78, s78, s79
    s_add_u32 s78, s78, 327680
    s_cmp_eq_u32 s76, 3
    s_nop 0
    s_cselect_b32 s78, 0x10000000, s78
    buffer_load_dwordx4 v[36:39], v198, s[36:39], s78 offen sc1
    s_add_u32 s78, s78, 3072
    buffer_load_dwordx4 v[40:43], v198, s[36:39], s78 offen sc1
    s_add_u32 s78, s78, 3072
    buffer_load_dwordx4 v[44:47], v198, s[36:39], s78 offen sc1
    s_add_u32 s78, s78, 3072
    buffer_load_dwordx4 v[48:51], v198, s[36:39], s78 offen sc1
    s_add_u32 m0, s84, 0
    s_mov_b32 s100, 0
    buffer_load_dwordx4 v246, s[40:43], s100 offen  lds
    s_add_u32 m0, s84, 4096
    s_mov_b32 s100, 65536
    buffer_load_dwordx4 v246, s[40:43], s100 offen  lds
    s_add_u32 m0, s84, 8192
    s_mov_b32 s100, 131072
    buffer_load_dwordx4 v246, s[40:43], s100 offen  lds
    s_add_u32 m0, s84, 12288
    s_mov_b32 s100, 196608
    buffer_load_dwordx4 v246, s[40:43], s100 offen  lds
    s_waitcnt vmcnt(12)
    s_waitcnt lgkmcnt(0)
    s_barrier
    s_setprio 2
    s_add_u32 m0, s84, 16384
    s_mov_b32 s100, 262144
    buffer_load_dwordx4 v246, s[40:43], s100 offen  lds
    s_waitcnt vmcnt(9)
    v_add_f32 v20, v20, v24
    v_add_f32 v21, v21, v25
    v_add_f32 v22, v22, v26
    v_add_f32 v23, v23, v27
    v_add_f32 v20, v20, v28
    v_add_f32_e64 v21, v21, v29
    s_add_u32 m0, s84, 20480
    s_mov_b32 s100, 327680
    buffer_load_dwordx4 v246, s[40:43], s100 offen  lds
    v_add_f32 v22, v22, v30
    v_add_f32 v23, v23, v31
    v_add_f32 v20, v20, v32
    v_add_f32 v21, v21, v33
    v_add_f32 v22, v22, v34
    v_add_f32 v23, v23, v35
    s_nop 0
    v_permlane32_swap_b32 v20, v22
    s_add_u32 m0, s84, 24576
    s_mov_b32 s100, 393216
    buffer_load_dwordx4 v246, s[40:43], s100 offen  lds
    v_permlane32_swap_b32 v21, v23
    v_add_f32 v20, v20, v22
    v_add_f32 v21, v21, v23
    v_mov_b32 v22, v20
    v_mov_b32 v23, v21
    s_nop 0
    v_permlane16_swap_b32 v20, v22
    v_permlane16_swap_b32 v21, v23
    v_add_f32_e64 v20, v20, v22
    s_add_u32 m0, s84, 28672
    s_mov_b32 s100, 458752
    buffer_load_dwordx4 v246, s[40:43], s100 offen  lds
    v_add_f32_e64 v21, v21, v23
    v_mul_f32 v24, 0x3a800000, v20
    v_mul_f32 v26, 0x3a800000, v21
    v_fma_f32 v26, -v24, v24, v26
    v_max_f32_e64 v26, 0, v26
    v_cvt_pk_bf16_f32 v24, v24, v24
    v_and_b32 v24, 0xffff0000, v24
    s_add_u32 m0, s84, 32768
    s_mov_b32 s100, 524288
    buffer_load_dwordx4 v246, s[40:43], s100 offen  lds
    v_cvt_pk_bf16_f32 v26, v26, v26
    v_and_b32 v26, 0xffff0000, v26
    v_add_f32 v26, 0x3727c5ac, v26
    v_cvt_pk_bf16_f32 v26, v26, v26
    v_and_b32 v26, 0xffff0000, v26
    v_sqrt_f32 v26, v26
    s_nop 0
    v_cvt_pk_bf16_f32 v26, v26, v26
    v_and_b32 v26, 0xffff0000, v26
    s_add_u32 m0, s84, 36864
    s_mov_b32 s100, 589824
    buffer_load_dwordx4 v246, s[40:43], s100 offen  lds
    v_rcp_f32_e64 v25, v26
    v_xor_b32 v26, 0x80000000, v24
    v_lshrrev_b32 v27, 16, v26
    v_or_b32 v26, v26, v27
    v_mov_b32 v27, 0
    v_and_b32 v196, 15, v2
    v_lshrrev_b32_e64 v197, 5, v2
    s_add_u32 m0, s84, 40960
    s_mov_b32 s100, 655360
    buffer_load_dwordx4 v246, s[40:43], s100 offen  lds
    v_lshl_add_u32 v196, v196, 1, v197
    s_lshl_b32 s78, s76, 5
    v_add_u32 v196, s78, v196
    v_lshlrev_b32_e64 v197, 3, v196
    v_add_u32 v197, 159744, v197
    v_lshlrev_b32_e64 v196, 2, v196
    v_add_u32 v196, 162304, v196
    s_add_u32 m0, s84, 45056
    s_mov_b32 s100, 720896
    buffer_load_dwordx4 v246, s[40:43], s100 offen  lds
    ds_write_b64 v197, v[26:27]
    ds_write_b32 v196, v25
    s_waitcnt vmcnt(12)
    v_add_f32 v36, v36, v40
    v_add_f32 v37, v37, v41
    v_add_f32 v38, v38, v42
    v_add_f32 v39, v39, v43
    v_add_f32 v36, v36, v44
    s_add_u32 m0, s84, 49152
    s_mov_b32 s100, 786432
    buffer_load_dwordx4 v246, s[40:43], s100 offen  lds
    v_add_f32 v37, v37, v45
    v_add_f32 v38, v38, v46
    v_add_f32 v39, v39, v47
    v_add_f32 v36, v36, v48
    v_add_f32 v37, v37, v49
    v_add_f32 v38, v38, v50
    v_add_f32_e64 v39, v39, v51
    s_add_u32 m0, s84, 53248
    s_mov_b32 s100, 851968
    buffer_load_dwordx4 v246, s[40:43], s100 offen  lds
    v_permlane32_swap_b32 v36, v38
    v_permlane32_swap_b32 v37, v39
    v_add_f32 v36, v36, v38
    v_add_f32 v37, v37, v39
    s_nop 1
    v_permlane16_swap_b32 v36, v37
    v_add_f32_e64 v36, v36, v37
    v_cvt_pk_bf16_f32 v37, v36, v36
    v_and_b32 v37, 0xffff0000, v37
    s_add_u32 m0, s84, 57344
    s_mov_b32 s100, 917504
    buffer_load_dwordx4 v246, s[40:43], s100 offen  lds
    v_sub_f32_e64 v38, v36, v37
    v_cvt_pk_bf16_f32 v38, v37, v38
    v_mov_b32 v39, 0
    v_and_b32 v196, 15, v2
    v_lshrrev_b32_e64 v197, 4, v2
    v_lshl_add_u32 v196, v196, 2, v197
    s_lshl_b32 s78, s76, 9
    s_add_u32 m0, s84, 61440
    s_mov_b32 s100, 983040
    buffer_load_dwordx4 v246, s[40:43], s100 offen  lds
    s_add_u32 s78, s78, 160768
    v_lshl_add_u32 v196, v196, 3, s78
    v_and_b32 v197, 15, v2
    v_lshlrev_b32_e64 v197, 3, v197
    v_add_u32 v197, 162816, v197
    v_mov_b32 v198, 0x3f803f80
    s_cmp_eq_u32 s76, 3
    s_cselect_b64 vcc, -1, 0
    v_cndmask_b32 v196, v196, v197, vcc
    v_cndmask_b32 v38, v38, v198, vcc
    v_cndmask_b32_e64 v39, v39, v198, vcc
    ds_write_b64 v196, v[38:39]
    s_setprio 0
    s_waitcnt lgkmcnt(0)
    s_barrier
    s_branch L_phend
L_ph4:
    s_setprio 2
    s_add_u32 m0, s88, 36864
    s_nop 0
    buffer_load_dwordx4 v4, s[28:31], s86 offen  lds
    v_mov_b32 v200, 0x3f803f80
    v_mov_b32 v201, 0x3f803f80
    v_mov_b32 v202, 0x3f803f80
    v_mov_b32 v203, 0x3f803f80
    buffer_load_dwordx4 v5, s[28:31], s86 offen offset:1024  lds
    s_nop 0
    s_nop 0
    v_mfma_f32_16x16x32_bf16 v[204:207], v[200:203], v[20:23], 0
    v_mfma_f32_16x16x32_bf16 v[212:215], v[20:23], v[20:23], 0
    v_mfma_f32_16x16x32_bf16 v[208:211], v[200:203], v[24:27], 0
    v_mfma_f32_16x16x32_bf16 v[216:219], v[24:27], v[24:27], 0
    v_mfma_f32_16x16x32_bf16 v[220:223], v[200:203], v[36:39], 0
    s_add_u32 m0, s89, 61440
    s_add_u32 s101, s87, 2048
    buffer_load_dwordx4 v6, s[32:35], s101 offen  lds
    v_mfma_f32_16x16x32_bf16 v[224:227], v[200:203], v[44:47], 0
    v_mfma_f32_16x16x32_bf16 v[228:231], v[200:203], v[52:55], 0
    v_mfma_f32_16x16x32_bf16 v[204:207], v[200:203], v[28:31], v[204:207]
    v_mfma_f32_16x16x32_bf16 v[212:215], v[28:31], v[28:31], v[212:215]
    v_mfma_f32_16x16x32_bf16 v[208:211], v[200:203], v[32:35], v[208:211]
    buffer_load_dwordx4 v7, s[32:35], s101 offen offset:1024  lds
    v_mfma_f32_16x16x32_bf16 v[216:219], v[32:35], v[32:35], v[216:219]
    v_mfma_f32_16x16x32_bf16 v[220:223], v[200:203], v[40:43], v[220:223]
    v_mfma_f32_16x16x32_bf16 v[224:227], v[200:203], v[48:51], v[224:227]
    v_mfma_f32_16x16x32_bf16 v[228:231], v[200:203], v[56:59], v[228:231]
    v_and_b32_e64 v196, 3, v2
    s_add_u32 m0, s88, 38912
    s_add_u32 s101, s86, 32768
    buffer_load_dwordx4 v4, s[28:31], s101 offen  lds
    v_cmp_eq_u32 s[90:91], 1, v196
    v_cmp_eq_u32 s[92:93], 2, v196
    v_cmp_eq_u32_e64 vcc, 3, v196
    v_cndmask_b32 v212, v212, v213, s[90:91]
    v_cndmask_b32 v212, v212, v214, s[92:93]
    buffer_load_dwordx4 v5, s[28:31], s101 offen offset:1024  lds
    v_cndmask_b32_e64 v205, v212, v215, vcc
    v_cndmask_b32 v216, v216, v217, s[90:91]
    v_cndmask_b32 v216, v216, v218, s[92:93]
    v_cndmask_b32 v209, v216, v219, vcc
    v_lshrrev_b32 v196, 4, v2
    s_add_u32 m0, s89, 69632
    s_add_u32 s101, s87, 4096
    buffer_load_dwordx4 v6, s[32:35], s101 offen  lds
    v_cmp_eq_u32 s[90:91], 1, v196
    v_cmp_eq_u32 vcc, 2, v196
    s_nop 0
    v_cndmask_b32 v220, v220, v224, s[90:91]
    v_cndmask_b32_e64 v220, v220, v228, vcc
    s_mul_i32 s78, s77, 768
    buffer_load_dwordx4 v7, s[32:35], s101 offen offset:1024  lds
    s_mul_i32 s79, s76, 192
    s_add_u32 s78, s78, s79
    s_add_u32 s78, s78, 327680
    v_lshlrev_b32 v197, 2, v2
    s_mov_b32 exec_hi, 0xffff
    buffer_store_dword v220, v197, s[36:39], s78 offen sc1
    s_mov_b32 exec_hi, -1
    s_add_u32 m0, s89, 53248
    s_nop 0
    buffer_load_dwordx4 v6, s[32:35], s87 offen  lds
    s_lshl_b32 s78, s69, 4
    s_add_u32 s78, s78, s70
    s_lshl_b32 s78, s78, 10
    s_lshl_b32 s79, s76, 8
    s_add_u32 s78, s78, s79
    buffer_load_dwordx4 v7, s[32:35], s87 offen offset:1024  lds
    s_add_u32 s86, s86, 128
    s_add_u32 s87, s87, 393216
    s_and_b32 s86, s86, 2047
    s_cselect_b32 s87, s87, 0
    s_add_u32 s78, s78, 65536
    v_and_b32 v198, 15, v2
    v_lshlrev_b32 v198, 3, v198
    s_mov_b32 exec_lo, 0x00f0000f
    s_mov_b32 exec_hi, 0xf0000f00
    buffer_store_dwordx2 v[204:205], v198, s[36:39], s78 offen offset:0 sc1
    s_mov_b64 exec, -1
    s_mov_b32 exec_lo, 0x00f0000f
    s_mov_b32 exec_hi, 0xf0000f00
    buffer_store_dwordx2 v[208:209], v198, s[36:39], s78 offen offset:128 sc1
    s_mov_b64 exec, -1
    s_setprio 0
    s_waitcnt vmcnt(13)
    s_waitcnt lgkmcnt(0)
    s_barrier
    s_add_u32 m0, s88, 77824
    s_nop 0
    s_nop 0
    buffer_load_dwordx4 v4, s[28:31], s86 offen  lds
    buffer_load_dwordx4 v5, s[28:31], s86 offen offset:1024  lds
    s_add_u32 m0, s89, 102400
    s_add_u32 s101, s87, 2048
    buffer_load_dwordx4 v6, s[32:35], s101 offen  lds
    buffer_load_dwordx4 v7, s[32:35], s101 offen offset:1024  lds
    s_add_u32 m0, s88, 79872
    s_add_u32 s101, s86, 32768
    buffer_load_dwordx4 v4, s[28:31], s101 offen  lds
    buffer_load_dwordx4 v5, s[28:31], s101 offen offset:1024  lds
    s_add_u32 m0, s89, 110592
    s_add_u32 s101, s87, 4096
    buffer_load_dwordx4 v6, s[32:35], s101 offen  lds
    buffer_load_dwordx4 v7, s[32:35], s101 offen offset:1024  lds
    s_add_u32 m0, s89, 94208
    s_nop 0
    buffer_load_dwordx4 v6, s[32:35], s87 offen  lds
    buffer_load_dwordx4 v7, s[32:35], s87 offen offset:1024  lds
    s_add_u32 s86, s86, 128
    s_add_u32 s87, s87, 393216
    s_and_b32 s86, s86, 2047
    s_cselect_b32 s87, s87, 0
    buffer_store_dwordx4 v[16:19], v14, s[36:39], s96 offen offset:0 sc1
    s_waitcnt vmcnt(13)
    s_waitcnt lgkmcnt(0)
    s_barrier
    s_add_u32 m0, s88, 118784
    s_nop 0
    buffer_load_dwordx4 v4, s[28:31], s86 offen  lds
    buffer_load_dwordx4 v5, s[28:31], s86 offen offset:1024  lds
    s_add_u32 m0, s89, 143360
    s_add_u32 s101, s87, 2048
    buffer_load_dwordx4 v6, s[32:35], s101 offen  lds
    buffer_load_dwordx4 v7, s[32:35], s101 offen offset:1024  lds
    s_add_u32 m0, s88, 120832
    s_add_u32 s101, s86, 32768
    buffer_load_dwordx4 v4, s[28:31], s101 offen  lds
    buffer_load_dwordx4 v5, s[28:31], s101 offen offset:1024  lds
    s_add_u32 m0, s89, 151552
    s_add_u32 s101, s87, 4096
    buffer_load_dwordx4 v6, s[32:35], s101 offen  lds
    buffer_load_dwordx4 v7, s[32:35], s101 offen offset:1024  lds
    s_add_u32 m0, s89, 135168
    s_nop 0
    buffer_load_dwordx4 v6, s[32:35], s87 offen  lds
    buffer_load_dwordx4 v7, s[32:35], s87 offen offset:1024  lds
    s_add_u32 s86, s86, 128
    s_add_u32 s87, s87, 393216
    s_and_b32 s86, s86, 2047
    s_cselect_b32 s87, s87, 0
    s_waitcnt vmcnt(10)
    s_barrier
    s_cmp_lg_u32 s76, 0
    s_cbranch_scc1 Lfl_29
    s_getreg_b32 s99, hwreg(HW_REG_XCC_ID, 0, 4)
    v_mov_b32 v198, s75
    v_mov_b32 v199, s99
    v_lshlrev_b32_e64 v197, 3, v2
    s_lshl_b32 s78, s77, 7
    s_add_u32 s79, s78, 8781824
    s_add_u32 s78, s78, 4096
    s_lshl_b32 s80, s71, 4
    s_add_u32 s80, s80, s72
    s_lshl_b32 s80, s80, 7
    s_add_u32 s80, s80, 8847360
    s_mov_b64 exec, 0xffff
    buffer_store_dwordx2 v[198:199], v197, s[36:39], s78 offen sc1
    buffer_store_dwordx2 v[198:199], v197, s[36:39], s80 offen sc1
    v_not_b32 v200, v198
    v_mov_b32_e64 v201, 0
    buffer_store_dwordx2 v[200:201], v197, s[36:39], s79 offen sc1
    s_mov_b64 exec, -1
    v_and_b32 v196, 15, v2
    v_lshlrev_b32 v197, 4, v196
    v_add_u32 v197, s69, v197
    s_lshl_b32 s78, s70, 4
    s_lshl_b32 s79, s71, 4
    s_add_u32 s79, s79, 69088
    v_mov_b32 v202, s78
    v_mov_b32 v203, s79
    v_cmp_gt_u32 vcc, 32, v2
    s_nop 1
    v_cndmask_b32 v202, v203, v202, vcc
    v_add_u32 v196, v202, v196
    v_cmp_gt_u32 vcc, 16, v2
    s_nop 1
    v_cndmask_b32 v196, v196, v197, vcc
    v_lshlrev_b32 v196, 7, v196
    v_add_u32 v196, 4096, v196
Lfl_29:
    s_add_u32 m0, s88, 36864
    s_nop 0
    s_nop 0
    buffer_load_dwordx4 v4, s[28:31], s86 offen  lds
    buffer_load_dwordx4 v5, s[28:31], s86 offen offset:1024  lds
    s_add_u32 m0, s89, 61440
    s_add_u32 s101, s87, 2048
    buffer_load_dwordx4 v6, s[32:35], s101 offen  lds
    buffer_load_dwordx4 v7, s[32:35], s101 offen offset:1024  lds
    s_add_u32 m0, s88, 38912
    s_add_u32 s101, s86, 32768
    buffer_load_dwordx4 v4, s[28:31], s101 offen  lds
    buffer_load_dwordx4 v5, s[28:31], s101 offen offset:1024  lds
    s_add_u32 m0, s89, 69632
    s_add_u32 s101, s87, 4096
    buffer_load_dwordx4 v6, s[32:35], s101 offen  lds
    buffer_load_dwordx4 v7, s[32:35], s101 offen offset:1024  lds
    s_add_u32 m0, s89, 53248
    s_nop 0
    buffer_load_dwordx4 v6, s[32:35], s87 offen  lds
    buffer_load_dwordx4 v7, s[32:35], s87 offen offset:1024  lds
    s_add_u32 s86, s86, 128
    s_add_u32 s87, s87, 393216
    s_and_b32 s86, s86, 2047
    s_cselect_b32 s87, s87, 0
    s_waitcnt vmcnt(10)
    s_barrier
    s_add_u32 m0, s88, 77824
    s_nop 0
    s_nop 0
    buffer_load_dwordx4 v4, s[28:31], s86 offen  lds
    buffer_load_dwordx4 v5, s[28:31], s86 offen offset:1024  lds
    s_add_u32 m0, s89, 102400
    s_add_u32 s101, s87, 2048
    buffer_load_dwordx4 v6, s[32:35], s101 offen  lds
    buffer_load_dwordx4 v7, s[32:35], s101 offen offset:1024  lds
    s_add_u32 m0, s88, 79872
    s_add_u32 s101, s86, 32768
    buffer_load_dwordx4 v4, s[28:31], s101 offen  lds
    buffer_load_dwordx4 v5, s[28:31], s101 offen offset:1024  lds
    s_add_u32 m0, s89, 110592
    s_add_u32 s101, s87, 4096
    buffer_load_dwordx4 v6, s[32:35], s101 offen  lds
    buffer_load_dwordx4 v7, s[32:35], s101 offen offset:1024  lds
    s_add_u32 m0, s89, 94208
    s_nop 0
    buffer_load_dwordx4 v6, s[32:35], s87 offen  lds
    buffer_load_dwordx4 v7, s[32:35], s87 offen offset:1024  lds
    s_add_u32 s86, s86, 128
    s_add_u32 s87, s87, 393216
    s_and_b32 s86, s86, 2047
    s_cselect_b32 s87, s87, 0
    s_mov_b32 s100, 0
    buffer_load_dwordx4 v[64:67], v244, s[48:51], s100 offen nt
    s_mov_b32 s100, 0
    buffer_load_dwordx4 v[96:99], v244, s[52:55], s100 offen nt
    s_mov_b32 s100, 7168
    buffer_load_dwordx4 v[68:71], v244, s[48:51], s100 offen nt
    s_mov_b32 s100, 7168
    buffer_load_dwordx4 v[100:103], v244, s[52:55], s100 offen nt
    s_mov_b32 s100, 14336
    buffer_load_dwordx4 v[72:75], v244, s[48:51], s100 offen nt
    s_mov_b32 s100, 14336
    buffer_load_dwordx4 v[104:107], v244, s[52:55], s100 offen nt
    s_mov_b32 s100, 21504
    buffer_load_dwordx4 v[76:79], v244, s[48:51], s100 offen nt
    s_waitcnt vmcnt(17)
    s_barrier
    s_add_u32 m0, s88, 118784
    s_nop 0
    s_nop 0
    buffer_load_dwordx4 v4, s[28:31], s86 offen  lds
    buffer_load_dwordx4 v5, s[28:31], s86 offen offset:1024  lds
    s_add_u32 m0, s89, 143360
    s_add_u32 s101, s87, 2048
    buffer_load_dwordx4 v6, s[32:35], s101 offen  lds
    buffer_load_dwordx4 v7, s[32:35], s101 offen offset:1024  lds
    s_add_u32 m0, s88, 120832
    s_add_u32 s101, s86, 32768
    buffer_load_dwordx4 v4, s[28:31], s101 offen  lds
    buffer_load_dwordx4 v5, s[28:31], s101 offen offset:1024  lds
    s_add_u32 m0, s89, 151552
    s_add_u32 s101, s87, 4096
    buffer_load_dwordx4 v6, s[32:35], s101 offen  lds
    buffer_load_dwordx4 v7, s[32:35], s101 offen offset:1024  lds
    s_add_u32 m0, s89, 135168
    s_nop 0
    buffer_load_dwordx4 v6, s[32:35], s87 offen  lds
    buffer_load_dwordx4 v7, s[32:35], s87 offen offset:1024  lds
    s_add_u32 s86, s86, 128
    s_add_u32 s87, s87, 393216
    s_and_b32 s86, s86, 2047
    s_cselect_b32 s87, s87, 0
    s_waitcnt vmcnt(17)
    s_barrier
    s_add_u32 m0, s88, 36864
    s_nop 0
    s_nop 0
    buffer_load_dwordx4 v4, s[28:31], s86 offen  lds
    buffer_load_dwordx4 v5, s[28:31], s86 offen offset:1024  lds
    s_add_u32 m0, s89, 61440
    s_add_u32 s101, s87, 2048
    buffer_load_dwordx4 v6, s[32:35], s101 offen  lds
    buffer_load_dwordx4 v7, s[32:35], s101 offen offset:1024  lds
    s_add_u32 m0, s88, 38912
    s_add_u32 s101, s86, 32768
    buffer_load_dwordx4 v4, s[28:31], s101 offen  lds
    buffer_load_dwordx4 v5, s[28:31], s101 offen offset:1024  lds
    s_add_u32 m0, s89, 69632
    s_add_u32 s101, s87, 4096
    buffer_load_dwordx4 v6, s[32:35], s101 offen  lds
    buffer_load_dwordx4 v7, s[32:35], s101 offen offset:1024  lds
    s_add_u32 m0, s89, 53248
    s_nop 0
    buffer_load_dwordx4 v6, s[32:35], s87 offen  lds
    buffer_load_dwordx4 v7, s[32:35], s87 offen offset:1024  lds
    s_add_u32 s86, s86, 128
    s_add_u32 s87, s87, 393216
    s_and_b32 s86, s86, 2047
    s_cselect_b32 s87, s87, 0
    s_waitcnt vmcnt(10)
    s_barrier
    s_add_u32 m0, s88, 77824
    s_nop 0
    s_nop 0
    buffer_load_dwordx4 v4, s[28:31], s86 offen  lds
    buffer_load_dwordx4 v5, s[28:31], s86 offen offset:1024  lds
    s_add_u32 m0, s89, 102400
    s_add_u32 s101, s87, 2048
    buffer_load_dwordx4 v6, s[32:35], s101 offen  lds
    buffer_load_dwordx4 v7, s[32:35], s101 offen offset:1024  lds
    s_add_u32 m0, s88, 79872
    s_add_u32 s101, s86, 32768
    buffer_load_dwordx4 v4, s[28:31], s101 offen  lds
    buffer_load_dwordx4 v5, s[28:31], s101 offen offset:1024  lds
    s_add_u32 m0, s89, 110592
    s_add_u32 s101, s87, 4096
    buffer_load_dwordx4 v6, s[32:35], s101 offen  lds
    buffer_load_dwordx4 v7, s[32:35], s101 offen offset:1024  lds
    s_add_u32 m0, s89, 94208
    s_nop 0
    buffer_load_dwordx4 v6, s[32:35], s87 offen  lds
    buffer_load_dwordx4 v7, s[32:35], s87 offen offset:1024  lds
    s_add_u32 s86, s86, 128
    s_add_u32 s87, s87, 393216
    s_and_b32 s86, s86, 2047
    s_cselect_b32 s87, s87, 0
    s_waitcnt vmcnt(10)
    s_barrier
    s_add_u32 m0, s88, 118784
    s_nop 0
    s_nop 0
    buffer_load_dwordx4 v4, s[28:31], s86 offen  lds
    buffer_load_dwordx4 v5, s[28:31], s86 offen offset:1024  lds
    s_add_u32 m0, s89, 143360
    s_add_u32 s101, s87, 2048
    buffer_load_dwordx4 v6, s[32:35], s101 offen  lds
    buffer_load_dwordx4 v7, s[32:35], s101 offen offset:1024  lds
    s_add_u32 m0, s88, 120832
    s_add_u32 s101, s86, 32768
    buffer_load_dwordx4 v4, s[28:31], s101 offen  lds
    buffer_load_dwordx4 v5, s[28:31], s101 offen offset:1024  lds
    s_add_u32 m0, s89, 151552
    s_add_u32 s101, s87, 4096
    buffer_load_dwordx4 v6, s[32:35], s101 offen  lds
    buffer_load_dwordx4 v7, s[32:35], s101 offen offset:1024  lds
    s_add_u32 m0, s89, 135168
    s_nop 0
    buffer_load_dwordx4 v6, s[32:35], s87 offen  lds
    buffer_load_dwordx4 v7, s[32:35], s87 offen offset:1024  lds
    s_add_u32 s86, s86, 128
    s_add_u32 s87, s87, 393216
    s_and_b32 s86, s86, 2047
    s_cselect_b32 s87, s87, 0
    s_waitcnt vmcnt(10)
    s_barrier
    s_add_u32 m0, s88, 36864
    s_nop 0
    s_nop 0
    buffer_load_dwordx4 v4, s[28:31], s86 offen  lds
    buffer_load_dwordx4 v5, s[28:31], s86 offen offset:1024  lds
    s_add_u32 m0, s89, 61440
    s_add_u32 s101, s87, 2048
    buffer_load_dwordx4 v6, s[32:35], s101 offen  lds
    buffer_load_dwordx4 v7, s[32:35], s101 offen offset:1024  lds
    s_add_u32 m0, s88, 38912
    s_add_u32 s101, s86, 32768
    buffer_load_dwordx4 v4, s[28:31], s101 offen  lds
    buffer_load_dwordx4 v5, s[28:31], s101 offen offset:1024  lds
    s_add_u32 m0, s89, 69632
    s_add_u32 s101, s87, 4096
    buffer_load_dwordx4 v6, s[32:35], s101 offen  lds
    buffer_load_dwordx4 v7, s[32:35], s101 offen offset:1024  lds
    s_add_u32 m0, s89, 53248
    s_nop 0
    buffer_load_dwordx4 v6, s[32:35], s87 offen  lds
    buffer_load_dwordx4 v7, s[32:35], s87 offen offset:1024  lds
    s_add_u32 s86, s86, 128
    s_add_u32 s87, s87, 393216
    s_and_b32 s86, s86, 2047
    s_cselect_b32 s87, s87, 0
    s_mov_b32 s100, 21504
    buffer_load_dwordx4 v[108:111], v244, s[52:55], s100 offen nt
    s_mov_b32 s100, 28672
    buffer_load_dwordx4 v[80:83], v244, s[48:51], s100 offen nt
    s_mov_b32 s100, 28672
    buffer_load_dwordx4 v[112:115], v244, s[52:55], s100 offen nt
    s_mov_b32 s100, 35840
    buffer_load_dwordx4 v[84:87], v244, s[48:51], s100 offen nt
    s_mov_b32 s100, 35840
    buffer_load_dwordx4 v[116:119], v244, s[52:55], s100 offen nt
    s_mov_b32 s100, 43008
    buffer_load_dwordx4 v[88:91], v244, s[48:51], s100 offen nt
    s_mov_b32 s100, 43008
    buffer_load_dwordx4 v[120:123], v244, s[52:55], s100 offen nt
    s_waitcnt vmcnt(17)
    s_barrier
    s_cmp_lg_u32 s76, 0
    s_cbranch_scc1 Lpl_30
    s_mov_b32 exec_hi, 0xffff
    buffer_load_dwordx2 v[198:199], v196, s[36:39], 0 offen sc1
    s_mov_b64 exec, -1
Lpl_30:
    s_add_u32 m0, s88, 77824
    s_nop 0
    buffer_load_dwordx4 v4, s[28:31], s86 offen  lds
    buffer_load_dwordx4 v5, s[28:31], s86 offen offset:1024  lds
    s_add_u32 m0, s89, 102400
    s_add_u32 s101, s87, 2048
    buffer_load_dwordx4 v6, s[32:35], s101 offen  lds
    buffer_load_dwordx4 v7, s[32:35], s101 offen offset:1024  lds
    s_add_u32 m0, s88, 79872
    s_add_u32 s101, s86, 32768
    buffer_load_dwordx4 v4, s[28:31], s101 offen  lds
    buffer_load_dwordx4 v5, s[28:31], s101 offen offset:1024  lds
    s_add_u32 m0, s89, 110592
    s_add_u32 s101, s87, 4096
    buffer_load_dwordx4 v6, s[32:35], s101 offen  lds
    buffer_load_dwordx4 v7, s[32:35], s101 offen offset:1024  lds
    s_add_u32 m0, s89, 94208
    s_nop 0
    buffer_load_dwordx4 v6, s[32:35], s87 offen  lds
    buffer_load_dwordx4 v7, s[32:35], s87 offen offset:1024  lds
    s_add_u32 s86, s86, 128
    s_add_u32 s87, s87, 393216
    s_and_b32 s86, s86, 2047
    s_cselect_b32 s87, s87, 0
    s_waitcnt vmcnt(17)
    s_barrier
    s_cmp_lg_u32 s76, 2
    s_cbranch_scc1 Lc4_31
    s_mov_b32 exec_hi, -1
    buffer_load_dword v238, v63, s[40:43], 0 offen
    s_mov_b64 exec, -1
Lc4_31:
    s_add_u32 m0, s88, 118784
    s_nop 0
    s_nop 0
    buffer_load_dwordx4 v4, s[28:31], s86 offen  lds
    buffer_load_dwordx4 v5, s[28:31], s86 offen offset:1024  lds
    s_add_u32 m0, s89, 143360
    s_add_u32 s101, s87, 2048
    buffer_load_dwordx4 v6, s[32:35], s101 offen  lds
    buffer_load_dwordx4 v7, s[32:35], s101 offen offset:1024  lds
    s_add_u32 m0, s88, 120832
    s_add_u32 s101, s86, 32768
    buffer_load_dwordx4 v4, s[28:31], s101 offen  lds
    buffer_load_dwordx4 v5, s[28:31], s101 offen offset:1024  lds
    s_add_u32 m0, s89, 151552
    s_add_u32 s101, s87, 4096
    buffer_load_dwordx4 v6, s[32:35], s101 offen  lds
    buffer_load_dwordx4 v7, s[32:35], s101 offen offset:1024  lds
    s_add_u32 m0, s89, 135168
    s_nop 0
    buffer_load_dwordx4 v6, s[32:35], s87 offen  lds
    buffer_load_dwordx4 v7, s[32:35], s87 offen offset:1024  lds
    s_add_u32 s86, s86, 128
    s_add_u32 s87, s87, 393216
    s_and_b32 s86, s86, 2047
    s_cselect_b32 s87, s87, 0
    s_waitcnt vmcnt(10)
    s_cmp_lg_u32 s76, 0
    s_cbranch_scc1 Lpc_32
    s_mov_b32 exec_hi, 0xffff
    s_mov_b32 s85, 0
    s_branch Lpk_33
Lspin_34:
    s_add_u32 s85, s85, 1
    s_cmp_gt_u32 s85, 400000
    s_cbranch_scc1 L_end
    buffer_load_dwordx2 v[198:199], v196, s[36:39], 0 offen sc1
    s_waitcnt vmcnt(0)
Lpk_33:
    v_cmp_ne_u32 vcc, s75, v198
    s_cbranch_vccnz Lspin_34
    v_cmp_ne_u32 vcc, s99, v199
    s_mov_b64 exec, -1
    s_lshr_b32 s78, vcc_lo, 16
    s_cselect_b32 s78, 0, 1
    s_cmp_eq_u32 vcc_hi, 0
    s_cselect_b32 s79, 2, 0
    s_or_b32 s78, s78, s79
    s_and_b32 s78, s78, 3
    v_mov_b32_e64 v198, s78
    v_mov_b32 v199, 163584
    ds_write_b32 v199, v198
    s_waitcnt lgkmcnt(0)
Lpc_32:
    s_barrier
    v_lshrrev_b32 v196, 4, v2
    v_and_b32 v197, 15, v2
    v_lshlrev_b32_e64 v197, 4, v197
    v_lshl_add_u32 v198, v196, 10, v197
    s_lshl_b32 s78, s69, 14
    s_lshl_b32 s79, s76, 8
    s_add_u32 s78, s78, s79
    s_nop 0
    s_add_u32 s78, s78, 65536
    buffer_load_dwordx4 v[20:23], v198, s[36:39], s78 offen sc1
    s_add_u32 s78, s78, 4096
    buffer_load_dwordx4 v[24:27], v198, s[36:39], s78 offen sc1
    s_add_u32 s78, s78, 4096
    buffer_load_dwordx4 v[28:31], v198, s[36:39], s78 offen sc1
    s_add_u32 s78, s78, 4096
    buffer_load_dwordx4 v[32:35], v198, s[36:39], s78 offen sc1
    v_mul_u32_u24 v198, 768, v196
    v_add_u32_e64 v198, v198, v197
    s_mul_i32 s78, s70, 12288
    s_lshl_b32 s79, s76, 8
    s_add_u32 s78, s78, s79
    s_add_u32 s78, s78, 327680
    s_cmp_eq_u32 s76, 3
    s_nop 0
    s_cselect_b32 s78, 0x10000000, s78
    buffer_load_dwordx4 v[36:39], v198, s[36:39], s78 offen sc1
    s_add_u32 s78, s78, 3072
    buffer_load_dwordx4 v[40:43], v198, s[36:39], s78 offen sc1
    s_add_u32 s78, s78, 3072
    buffer_load_dwordx4 v[44:47], v198, s[36:39], s78 offen sc1
    s_add_u32 s78, s78, 3072
    buffer_load_dwordx4 v[48:51], v198, s[36:39], s78 offen sc1
    s_add_u32 m0, s84, 0
    s_mov_b32 s100, 0
    buffer_load_dwordx4 v246, s[40:43], s100 offen  lds
    s_add_u32 m0, s84, 4096
    s_mov_b32 s100, 65536
    buffer_load_dwordx4 v246, s[40:43], s100 offen  lds
    s_add_u32 m0, s84, 8192
    s_mov_b32 s100, 131072
    buffer_load_dwordx4 v246, s[40:43], s100 offen  lds
    s_add_u32 m0, s84, 12288
    s_mov_b32 s100, 196608
    buffer_load_dwordx4 v246, s[40:43], s100 offen  lds
    s_waitcnt vmcnt(12)
    s_waitcnt lgkmcnt(0)
    s_barrier
    s_setprio 2
    s_add_u32 m0, s84, 16384
    s_mov_b32 s100, 262144
    buffer_load_dwordx4 v246, s[40:43], s100 offen  lds
    s_waitcnt vmcnt(9)
    v_add_f32 v20, v20, v24
    v_add_f32 v21, v21, v25
    v_add_f32 v22, v22, v26
    v_add_f32 v23, v23, v27
    v_add_f32 v20, v20, v28
    v_add_f32_e64 v21, v21, v29
    s_add_u32 m0, s84, 20480
    s_mov_b32 s100, 327680
    buffer_load_dwordx4 v246, s[40:43], s100 offen  lds
    v_add_f32 v22, v22, v30
    v_add_f32 v23, v23, v31
    v_add_f32 v20, v20, v32
    v_add_f32 v21, v21, v33
    v_add_f32 v22, v22, v34
    v_add_f32 v23, v23, v35
    s_nop 0
    v_permlane32_swap_b32 v20, v22
    s_add_u32 m0, s84, 24576
    s_mov_b32 s100, 393216
    buffer_load_dwordx4 v246, s[40:43], s100 offen  lds
    v_permlane32_swap_b32 v21, v23
    v_add_f32 v20, v20, v22
    v_add_f32 v21, v21, v23
    v_mov_b32 v22, v20
    v_mov_b32 v23, v21
    s_nop 0
    v_permlane16_swap_b32 v20, v22
    v_permlane16_swap_b32 v21, v23
    v_add_f32_e64 v20, v20, v22
    s_add_u32 m0, s84, 28672
    s_mov_b32 s100, 458752
    buffer_load_dwordx4 v246, s[40:43], s100 offen  lds
    v_add_f32_e64 v21, v21, v23
    v_mul_f32 v24, 0x3a800000, v20
    v_mul_f32 v26, 0x3a800000, v21
    v_fma_f32 v26, -v24, v24, v26
    v_max_f32_e64 v26, 0, v26
    v_cvt_pk_bf16_f32 v24, v24, v24
    v_and_b32 v24, 0xffff0000, v24
    s_add_u32 m0, s84, 32768
    s_mov_b32 s100, 524288
    buffer_load_dwordx4 v246, s[40:43], s100 offen  lds
    v_cvt_pk_bf16_f32 v26, v26, v26
    v_and_b32 v26, 0xffff0000, v26
    v_add_f32 v26, 0x3727c5ac, v26
    v_cvt_pk_bf16_f32 v26, v26, v26
    v_and_b32 v26, 0xffff0000, v26
    v_sqrt_f32 v26, v26
    s_nop 0
    v_cvt_pk_bf16_f32 v26, v26, v26
    v_and_b32 v26, 0xffff0000, v26
    s_add_u32 m0, s84, 36864
    s_mov_b32 s100, 589824
    buffer_load_dwordx4 v246, s[40:43], s100 offen  lds
    v_rcp_f32_e64 v25, v26
    v_xor_b32 v26, 0x80000000, v24
    v_lshrrev_b32 v27, 16, v26
    v_or_b32 v26, v26, v27
    v_mov_b32 v27, 0
    v_and_b32 v196, 15, v2
    v_lshrrev_b32_e64 v197, 5, v2
    s_add_u32 m0, s84, 40960
    s_mov_b32 s100, 655360
    buffer_load_dwordx4 v246, s[40:43], s100 offen  lds
    v_lshl_add_u32 v196, v196, 1, v197
    s_lshl_b32 s78, s76, 5
    v_add_u32 v196, s78, v196
    v_lshlrev_b32_e64 v197, 3, v196
    v_add_u32 v197, 159744, v197
    v_lshlrev_b32_e64 v196, 2, v196
    v_add_u32 v196, 162304, v196
    s_add_u32 m0, s84, 45056
    s_mov_b32 s100, 720896
    buffer_load_dwordx4 v246, s[40:43], s100 offen  lds
    ds_write_b64 v197, v[26:27]
    ds_write_b32 v196, v25
    s_waitcnt vmcnt(12)
    v_add_f32 v36, v36, v40
    v_add_f32 v37, v37, v41
    v_add_f32 v38, v38, v42
    v_add_f32 v39, v39, v43
    v_add_f32 v36, v36, v44
    s_add_u32 m0, s84, 49152
    s_mov_b32 s100, 786432
    buffer_load_dwordx4 v246, s[40:43], s100 offen  lds
    v_add_f32 v37, v37, v45
    v_add_f32 v38, v38, v46
    v_add_f32 v39, v39, v47
    v_add_f32 v36, v36, v48
    v_add_f32 v37, v37, v49
    v_add_f32 v38, v38, v50
    v_add_f32_e64 v39, v39, v51
    s_add_u32 m0, s84, 53248
    s_mov_b32 s100, 851968
    buffer_load_dwordx4 v246, s[40:43], s100 offen  lds
    v_permlane32_swap_b32 v36, v38
    v_permlane32_swap_b32 v37, v39
    v_add_f32 v36, v36, v38
    v_add_f32 v37, v37, v39
    s_nop 1
    v_permlane16_swap_b32 v36, v37
    v_add_f32_e64 v36, v36, v37
    v_cvt_pk_bf16_f32 v37, v36, v36
    v_and_b32 v37, 0xffff0000, v37
    s_add_u32 m0, s84, 57344
    s_mov_b32 s100, 917504
    buffer_load_dwordx4 v246, s[40:43], s100 offen  lds
    v_sub_f32_e64 v38, v36, v37
    v_cvt_pk_bf16_f32 v38, v37, v38
    v_mov_b32 v39, 0
    v_and_b32 v196, 15, v2
    v_lshrrev_b32_e64 v197, 4, v2
    v_lshl_add_u32 v196, v196, 2, v197
    s_lshl_b32 s78, s76, 9
    s_add_u32 m0, s84, 61440
    s_mov_b32 s100, 983040
    buffer_load_dwordx4 v246, s[40:43], s100 offen  lds
    s_add_u32 s78, s78, 160768
    v_lshl_add_u32 v196, v196, 3, s78
    v_and_b32 v197, 15, v2
    v_lshlrev_b32_e64 v197, 3, v197
    v_add_u32 v197, 162816, v197
    v_mov_b32 v198, 0x3f803f80
    s_cmp_eq_u32 s76, 3
    s_cselect_b64 vcc, -1, 0
    v_cndmask_b32 v196, v196, v197, vcc
    v_cndmask_b32 v38, v38, v198, vcc
    v_cndmask_b32_e64 v39, v39, v198, vcc
    ds_write_b64 v196, v[38:39]
    s_setprio 0
    s_waitcnt lgkmcnt(0)
    s_barrier
L_phend:
    s_nop 0
    s_add_u32 m0, s84, 65536
    s_mov_b32 s100, 1048576
    buffer_load_dwordx4 v246, s[40:43], s100 offen  lds
    s_add_u32 m0, s84, 69632
    s_mov_b32 s100, 1114112
    buffer_load_dwordx4 v246, s[40:43], s100 offen  lds
    s_add_u32 m0, s84, 73728
    s_mov_b32 s100, 1179648
    buffer_load_dwordx4 v246, s[40:43], s100 offen  lds
    s_add_u32 m0, s84, 77824
    s_mov_b32 s100, 1245184
    buffer_load_dwordx4 v246, s[40:43], s100 offen  lds
    s_add_u32 m0, s84, 81920
    s_mov_b32 s100, 1310720
    buffer_load_dwordx4 v246, s[40:43], s100 offen  lds
    s_add_u32 m0, s84, 86016
    s_mov_b32 s100, 1376256
    buffer_load_dwordx4 v246, s[40:43], s100 offen  lds
    s_add_u32 m0, s84, 90112
    s_mov_b32 s100, 1441792
    buffer_load_dwordx4 v246, s[40:43], s100 offen  lds
    s_add_u32 m0, s84, 94208
    s_mov_b32 s100, 1507328
    buffer_load_dwordx4 v246, s[40:43], s100 offen  lds
    s_add_u32 m0, s84, 98304
    s_mov_b32 s100, 1572864
    buffer_load_dwordx4 v246, s[40:43], s100 offen  lds
    s_add_u32 m0, s84, 102400
    s_mov_b32 s100, 1638400
    buffer_load_dwordx4 v246, s[40:43], s100 offen  lds
    s_add_u32 m0, s84, 106496
    s_mov_b32 s100, 1703936
    buffer_load_dwordx4 v246, s[40:43], s100 offen  lds
    s_mov_b32 s100, 2031616
    buffer_load_dwordx4 v[160:163], v246, s[40:43], s100 offen
    s_mov_b32 s100, 1966080
    buffer_load_dwordx4 v[164:167], v246, s[40:43], s100 offen
    s_mov_b32 s100, 1900544
    buffer_load_dwordx4 v[168:171], v246, s[40:43], s100 offen
    s_mov_b32 s100, 1835008
    buffer_load_dwordx4 v[172:175], v246, s[40:43], s100 offen
    s_mov_b32 s100, 1769472
    buffer_load_dwordx4 v[176:179], v246, s[40:43], s100 offen
    s_mov_b32 s100, 0
    s_nop 0
    buffer_load_dwordx4 v[180:183], v247, s[28:31], s100 offen
    s_mov_b32 s100, 16384
    buffer_load_dwordx4 v[184:187], v248, s[28:31], s100 offen
    s_mov_b32 s100, 32768
    buffer_load_dwordx4 v[188:191], v247, s[28:31], s100 offen
    s_mov_b32 s100, 49152
    buffer_load_dwordx4 v[192:195], v248, s[28:31], s100 offen
    s_lshl_b32 s100, s77, 13
    s_add_u32 s100, s100, s89
    s_add_u32 s100, s100, 2097152
    buffer_load_dwordx4 v[252:255], v14, s[36:39], s100 offen offset:0 sc1
    s_lshl_b32 s100, s77, 13
    s_add_u32 s100, s100, s89
    s_add_u32 s100, s100, 2097152
    buffer_load_dwordx4 v[252:255], v14, s[36:39], s100 offen offset:1024 sc1
    buffer_load_dwordx4 v[252:255], v14, s[36:39], s96 offen sc1
    v_lshrrev_b32 v198, 2, v2
    v_and_b32 v199, 7, v198
    v_and_b32 v200, 3, v2
    v_xor_b32 v199, v199, v200
    s_lshr_b32 s78, s76, 1
    s_and_b32 s79, s76, 1
    s_lshl_b32 s80, s79, 2
    s_lshl_b32 s81, s78, 2
    v_xor_b32 v200, s80, v199
    v_xor_b32 v201, s81, v199
    v_lshlrev_b32 v198, 7, v198
    s_lshl_b32 s80, s78, 14
    s_add_u32 s80, s80, 110592
    v_lshl_add_u32 v196, v200, 4, v198
    v_add_u32_e64 v196, s80, v196
    v_lshl_add_u32 v197, v201, 4, v198
    v_add_u32 v197, 143360, v197
    v_mov_b32 v200, 0x3f803f80
    v_mov_b32 v201, 0x3f803f80
    v_mov_b32 v202, 0x3f803f80
    v_mov_b32 v203, 0x3f803f80
    v_lshrrev_b32 v198, 4, v2
    v_and_b32 v199, 15, v2
    v_lshlrev_b32_e64 v199, 4, v199
    v_lshl_add_u32 v198, v198, 13, v199
    s_lshl_b32 s78, s70, 2
    s_add_u32 s78, s78, s76
    s_lshl_b32 s78, s78, 15
    s_lshl_b32 s79, s69, 9
    s_add_u32 s78, s78, s79
    s_add_u32 s78, s78, 2097152
    s_lshl_b32 s79, s77, 10
    s_lshl_b32 s80, s76, 6
    s_add_u32 s79, s79, s80
    s_add_u32 s79, s79, 8389120
    s_lshl_b32 s80, s70, 11
    s_add_u32 s80, s80, 8716288
    v_lshl_add_u32 v60, v2, 7, s80
    s_lshl_b32 s80, s71, 7
    s_add_u32 s80, s80, 8781824
    v_lshl_add_u32 v61, v2, 11, s80
    v_mov_b32 v52, 163584
    ds_read_b32 v52, v52
    s_waitcnt lgkmcnt(0)
    v_readfirstlane_b32 s99, v52
    s_and_b32 s94, s69, 1
    s_mul_i32 s94, s94, 0x00010001
    s_mov_b32 s95, 0xfffefffe
    s_and_b32 s96, s75, 0x00010001
    v_mov_b32 v54, s96
    s_and_b32 s83, s75, 1
    s_lshl_b32 s83, s83, 16
    s_sub_u32 s83, 0, s83
    s_barrier
    ds_read_b64_tr_b16 v[4:5], v196 offset:0
    ds_read_b64_tr_b16 v[6:7], v196 offset:2048
    ds_read_b64_tr_b16 v[8:9], v196 offset:8
    ds_read_b64_tr_b16 v[10:11], v196 offset:2056
    ds_read_b64_tr_b16 v[12:13], v197 offset:0
    ds_read_b64_tr_b16 v[14:15], v197 offset:2048
    ds_read_b64_tr_b16 v[16:17], v197 offset:8
    ds_read_b64_tr_b16 v[18:19], v197 offset:2056
    ds_read_b64_tr_b16 v[20:21], v196 offset:4096
    ds_read_b64_tr_b16 v[22:23], v196 offset:6144
    ds_read_b64_tr_b16 v[24:25], v196 offset:4104
    ds_read_b64_tr_b16 v[26:27], v196 offset:6152
    ds_read_b64_tr_b16 v[28:29], v197 offset:4096
    ds_read_b64_tr_b16 v[30:31], v197 offset:6144
    ds_read_b64_tr_b16 v[32:33], v197 offset:4104
    ds_read_b64_tr_b16 v[34:35], v197 offset:6152
    s_waitcnt lgkmcnt(8)
    s_nop 0
    v_mfma_f32_16x16x32_bf16 v[204:207], v[4:7], v[12:15], 0
    v_mfma_f32_16x16x32_bf16 v[208:211], v[8:11], v[12:15], 0
    v_mfma_f32_16x16x32_bf16 v[212:215], v[4:7], v[16:19], 0
    v_mfma_f32_16x16x32_bf16 v[216:219], v[8:11], v[16:19], 0
    v_mfma_f32_16x16x32_bf16 v[220:223], v[4:7], v[200:203], 0
    v_mfma_f32_16x16x32_bf16 v[224:227], v[8:11], v[200:203], 0
    ds_read_b64_tr_b16 v[36:37], v196 offset:8192
    ds_read_b64_tr_b16 v[38:39], v196 offset:10240
    ds_read_b64_tr_b16 v[40:41], v196 offset:8200
    ds_read_b64_tr_b16 v[42:43], v196 offset:10248
    ds_read_b64_tr_b16 v[44:45], v197 offset:8192
    ds_read_b64_tr_b16 v[46:47], v197 offset:10240
    ds_read_b64_tr_b16 v[48:49], v197 offset:8200
    ds_read_b64_tr_b16 v[50:51], v197 offset:10248
    s_waitcnt lgkmcnt(8)
    s_nop 0
    v_mfma_f32_16x16x32_bf16 v[204:207], v[20:23], v[28:31], v[204:207]
    v_mfma_f32_16x16x32_bf16 v[208:211], v[24:27], v[28:31], v[208:211]
    v_mfma_f32_16x16x32_bf16 v[212:215], v[20:23], v[32:35], v[212:215]
    v_mfma_f32_16x16x32_bf16 v[216:219], v[24:27], v[32:35], v[216:219]
    v_mfma_f32_16x16x32_bf16 v[220:223], v[20:23], v[200:203], v[220:223]
    v_mfma_f32_16x16x32_bf16 v[224:227], v[24:27], v[200:203], v[224:227]
    ds_read_b64_tr_b16 v[228:229], v196 offset:12288
    ds_read_b64_tr_b16 v[230:231], v196 offset:14336
    ds_read_b64_tr_b16 v[232:233], v196 offset:12296
    ds_read_b64_tr_b16 v[234:235], v196 offset:14344
    ds_read_b64_tr_b16 v[236:237], v197 offset:12288
    ds_read_b64_tr_b16 v[238:239], v197 offset:14336
    ds_read_b64_tr_b16 v[240:241], v197 offset:12296
    ds_read_b64_tr_b16 v[242:243], v197 offset:14344
    s_waitcnt lgkmcnt(8)
    s_nop 0
    v_mfma_f32_16x16x32_bf16 v[204:207], v[36:39], v[44:47], v[204:207]
    v_mfma_f32_16x16x32_bf16 v[208:211], v[40:43], v[44:47], v[208:211]
    v_mfma_f32_16x16x32_bf16 v[212:215], v[36:39], v[48:51], v[212:215]
    v_mfma_f32_16x16x32_bf16 v[216:219], v[40:43], v[48:51], v[216:219]
    v_mfma_f32_16x16x32_bf16 v[220:223], v[36:39], v[200:203], v[220:223]
    v_mfma_f32_16x16x32_bf16 v[224:227], v[40:43], v[200:203], v[224:227]
    s_waitcnt lgkmcnt(0)
    s_nop 0
    v_mfma_f32_16x16x32_bf16 v[204:207], v[228:231], v[236:239], v[204:207]
    v_mfma_f32_16x16x32_bf16 v[208:211], v[232:235], v[236:239], v[208:211]
    v_mfma_f32_16x16x32_bf16 v[212:215], v[228:231], v[240:243], v[212:215]
    v_mfma_f32_16x16x32_bf16 v[216:219], v[232:235], v[240:243], v[216:219]
    v_mfma_f32_16x16x32_bf16 v[220:223], v[228:231], v[200:203], v[220:223]
    v_mfma_f32_16x16x32_bf16 v[224:227], v[232:235], v[200:203], v[224:227]
    s_nop 2
    v_cvt_pk_bf16_f32 v4, v204, v205
    v_cvt_pk_bf16_f32 v5, v206, v207
    v_cvt_pk_bf16_f32 v6, v208, v209
    v_cvt_pk_bf16_f32 v7, v210, v211
    v_add_u32 v4, s94, v4
    v_and_or_b32 v4, v4, s95, v54
    v_add_u32_e64 v5, s94, v5
    v_and_or_b32 v5, v5, s95, v54
    v_add_u32_e64 v6, s94, v6
    v_and_or_b32 v6, v6, s95, v54
    v_add_u32_e64 v7, s94, v7
    v_and_or_b32 v7, v7, s95, v54
    s_bitcmp1_b32 s99, 0
    s_cbranch_scc1 Lls_35
    buffer_store_dwordx4 v[4:7], v198, s[36:39], s78 offen offset:0 sc1
    s_branch Lle_36
Lls_35:
    buffer_store_dwordx4 v[4:7], v198, s[36:39], s78 offen offset:0
Lle_36:
    v_cvt_pk_bf16_f32 v8, v212, v213
    v_cvt_pk_bf16_f32 v9, v214, v215
    v_cvt_pk_bf16_f32 v10, v216, v217
    v_cvt_pk_bf16_f32 v11, v218, v219
    v_add_u32 v8, s94, v8
    v_and_or_b32 v8, v8, s95, v54
    v_add_u32_e64 v9, s94, v9
    v_and_or_b32 v9, v9, s95, v54
    v_add_u32_e64 v10, s94, v10
    v_and_or_b32 v10, v10, s95, v54
    v_add_u32_e64 v11, s94, v11
    v_and_or_b32 v11, v11, s95, v54
    s_bitcmp1_b32 s99, 0
    s_cbranch_scc1 Lls_37
    buffer_store_dwordx4 v[8:11], v198, s[36:39], s78 offen offset:256 sc1
    s_branch Lle_38
Lls_37:
    s_nop 0
    buffer_store_dwordx4 v[8:11], v198, s[36:39], s78 offen offset:256
Lle_38:
    v_cvt_pk_bf16_f32 v12, v220, v221
    v_cvt_pk_bf16_f32 v13, v222, v223
    v_cvt_pk_bf16_f32 v14, v224, v225
    v_cvt_pk_bf16_f32 v15, v226, v227
    s_mov_b32 exec_lo, 0x00010001
    s_mov_b32 exec_hi, 0x00010001
    s_bitcmp1_b32 s99, 0
    s_cbranch_scc1 Lls_39
    buffer_store_dwordx4 v[12:15], v2, s[36:39], s79 offen sc1
    s_branch Lle_40
Lls_39:
    buffer_store_dwordx4 v[12:15], v2, s[36:39], s79 offen
Lle_40:
    s_mov_b64 exec, -1
    v_lshrrev_b32 v196, 3, v2
    v_and_b32 v197, 7, v2
    v_lshlrev_b32_e64 v197, 4, v197
    v_lshl_add_u32 v198, v196, 9, v197
    v_lshl_add_u32 v199, v196, 1, v197
    s_lshl_b32 s78, s77, 13
    s_lshl_b32 s80, s76, 7
    s_add_u32 s78, s78, s80
    s_add_u32 s78, s78, 2097152
    s_add_u32 s79, s78, 4096
    s_lshl_b32 s81, s77, 10
    s_add_u32 s81, s81, s80
    s_add_u32 s81, s81, 8388608
    v_lshrrev_b32 v200, 2, v2
    v_and_b32 v197, 3, v2
    v_lshlrev_b32 v197, 4, v197
    v_lshl_add_u32 v200, v200, 10, v197
    s_lshl_b32 s82, s70, 14
    s_lshl_b32 s80, s76, 6
    s_add_u32 s82, s82, s80
    s_add_u32 s82, s82, 8389120
    v_lshl_add_u32 v201, v196, 1, v197
    s_add_u32 s80, s80, 162944
    v_add_u32 v201, s80, v201
    s_mov_b32 s85, 0
Lspin_41:
    s_add_u32 s85, s85, 1
    s_cmp_gt_u32 s85, 400000
    s_cbranch_scc1 L_end
    buffer_load_dwordx4 v[20:23], v198, s[36:39], s78 offen sc1
    buffer_load_dwordx4 v[24:27], v198, s[36:39], s79 offen sc1
    buffer_load_dwordx4 v[16:19], v200, s[36:39], s82 offen sc1
    s_waitcnt vmcnt(0)
Lchk_42:
    v_bitop3_b32 v28, v20, v24, v54 bitop3:0x7e
    v_bitop3_b32 v29, v21, v25, v54 bitop3:0x7e
    v_bitop3_b32 v30, v22, v26, v54 bitop3:0x7e
    v_bitop3_b32 v31, v23, v27, v54 bitop3:0x7e
    v_or3_b32 v28, v28, v29, v30
    v_cmp_eq_u32 s[90:91], -1, v16
    v_or_b32_e64 v28, v28, v31
    v_and_b32 v28, 0x00010001, v28
    v_cmp_ne_u32_e64 vcc, 0, v28
    s_or_b64 vcc, vcc, s[90:91]
    s_cbranch_vccnz Lspin_41
    v_lshl_add_u32 v28, v20, 16, s83
    v_and_b32 v29, 0xfffe0000, v20
    v_lshl_add_u32 v36, v24, 16, s83
    v_and_b32 v37, 0xfffe0000, v24
    v_pk_add_f32 v[28:29], v[28:29], v[36:37]
    v_lshl_add_u32 v30, v21, 16, s83
    v_and_b32 v31, 0xfffe0000, v21
    v_lshl_add_u32 v38, v25, 16, s83
    v_and_b32 v39, 0xfffe0000, v25
    v_pk_add_f32 v[30:31], v[30:31], v[38:39]
    v_lshl_add_u32 v32, v22, 16, s83
    v_and_b32 v33, 0xfffe0000, v22
    v_lshl_add_u32 v40, v26, 16, s83
    v_and_b32 v41, 0xfffe0000, v26
    v_pk_add_f32 v[32:33], v[32:33], v[40:41]
    v_lshl_add_u32 v34, v23, 16, s83
    v_and_b32 v35, 0xfffe0000, v23
    v_lshl_add_u32 v42, v27, 16, s83
    v_and_b32 v43, 0xfffe0000, v27
    v_pk_add_f32 v[34:35], v[34:35], v[42:43]
    v_permlane32_swap_b32 v28, v32
    v_permlane32_swap_b32 v29, v33
    v_permlane32_swap_b32 v30, v34
    v_permlane32_swap_b32 v31, v35
    v_pk_add_f32 v[28:29], v[28:29], v[32:33]
    v_pk_add_f32 v[30:31], v[30:31], v[34:35]
    s_nop 1
    v_permlane16_swap_b32 v28, v30
    v_permlane16_swap_b32_e64 v29, v31
    v_pk_add_f32 v[28:29], v[28:29], v[30:31]
    s_nop 1
    v_add_f32_dpp v28, v28, v28 row_ror:8 row_mask:0xf bank_mask:0xf
    v_add_f32_dpp v29, v29, v29 row_ror:8 row_mask:0xf bank_mask:0xf
    v_cvt_pk_bf16_f32 v36, v28, v29
    s_mov_b32 exec_lo, 0x00ff00ff
    s_mov_b32 exec_hi, 0x00ff00ff
    s_bitcmp1_b32 s99, 0
    s_cbranch_scc1 Lls_43
    buffer_store_dword v36, v199, s[36:39], s81 offen sc1
    s_branch Lle_44
Lls_43:
    buffer_store_dword v36, v199, s[36:39], s81 offen
Lle_44:
    s_mov_b64 exec, -1
    v_lshlrev_b32 v28, 16, v16
    v_and_b32 v29, 0xffff0000, v16
    v_lshlrev_b32_e64 v30, 16, v17
    v_and_b32 v31, 0xffff0000, v17
    v_lshlrev_b32_e64 v32, 16, v18
    v_and_b32 v33, 0xffff0000, v18
    v_lshlrev_b32_e64 v34, 16, v19
    v_and_b32 v35, 0xffff0000, v19
    v_permlane32_swap_b32 v28, v32
    v_permlane32_swap_b32 v29, v33
    v_permlane32_swap_b32 v30, v34
    v_permlane32_swap_b32 v31, v35
    v_pk_add_f32 v[28:29], v[28:29], v[32:33]
    v_pk_add_f32 v[30:31], v[30:31], v[34:35]
    s_nop 1
    v_permlane16_swap_b32 v28, v30
    v_permlane16_swap_b32_e64 v29, v31
    v_pk_add_f32 v[28:29], v[28:29], v[30:31]
    s_nop 1
    v_add_f32_dpp v38, v28, v28 row_ror:8 row_mask:0xf bank_mask:0x3
    s_nop 1
    v_add_f32_dpp v38, v29, v29 row_ror:8 row_mask:0xf bank_mask:0xc
    s_nop 1
    v_add_f32_dpp v37, v38, v38 row_shr:4 row_mask:0xf bank_mask:0xf
    v_cvt_pk_bf16_f32 v37, v37, v37
    s_mov_b32 exec_lo, 0xf0f0f0f0
    s_mov_b32 exec_hi, 0xf0f0f0f0
    ds_write_b16 v201, v37
    s_mov_b64 exec, -1
    s_waitcnt lgkmcnt(0)
    s_barrier
    s_sleep 4
    v_lshlrev_b32_e64 v4, 4, v2
    s_lshl_b32 s78, s76, 10
    s_add_u32 s78, s78, 110592
    v_add_u32 v5, s78, v4
    s_lshl_b32 s78, s76, 12
    s_add_u32 s78, s78, 131072
    v_add_u32_e64 v6, s78, v4
    ds_write_b128 v5, v[160:163] offset:16384
    ds_write_b128 v5, v[164:167] offset:12288
    ds_write_b128 v5, v[168:171] offset:8192
    ds_write_b128 v5, v[172:175] offset:4096
    ds_write_b128 v5, v[176:179] offset:0
    ds_write_b128 v6, v[180:183] offset:0
    ds_write_b128 v6, v[184:187] offset:1024
    ds_write_b128 v6, v[188:191] offset:2048
    ds_write_b128 v6, v[192:195] offset:3072
    s_waitcnt lgkmcnt(0)
    s_barrier
    s_mov_b32 s100, 50176
    buffer_load_dwordx4 v[92:95], v244, s[48:51], s100 offen nt
    s_mov_b32 s100, 50176
    buffer_load_dwordx4 v[124:127], v244, s[52:55], s100 offen nt
    s_mov_b32 s100, 0
    buffer_load_dwordx4 v[128:131], v245, s[56:59], s100 offen nt
    s_mov_b32 s100, 2048
    buffer_load_dwordx4 v[132:135], v245, s[56:59], s100 offen nt
    s_barrier
    s_cmp_lg_u32 s76, 0
    s_cbranch_scc1 Lfs_45
    s_lshl_b32 s100, s77, 7
    s_add_u32 s100, s100, 8781824
    v_mov_b32 v52, s75
    v_lshlrev_b32 v53, 2, v2
    s_mov_b32 exec_hi, 0
    buffer_store_dword v52, v53, s[36:39], s100 offen sc1
    s_mov_b64 exec, -1
Lfs_45:
    s_lshl_b32 s83, s71, 4
    s_add_u32 s83, s83, s72
    s_lshl_b32 s78, s0, 11
    s_and_b32 s79, s76, 1
    s_lshl_b32 s79, s79, 10
    s_add_u32 s78, s78, s79
    s_add_u32 s78, s78, 655360
    s_mul_i32 s79, s74, 56
    s_add_u32 s79, s79, s73
    s_lshl_b32 s79, s79, 10
    s_add_u32 s79, s79, 1114112
    s_cmp_eq_u32 s76, 1
    s_cselect_b32 s78, s79, s78
    s_cmp_ge_u32 s73, 56
    s_cselect_b32 s78, 0x10000000, s78
    s_lshl_b32 s79, s83, 9
    s_add_u32 s79, s79, 524288
    s_cmp_eq_u32 s76, 0
    s_cselect_b32 s78, s79, s78
    s_cselect_b32 s79, 0, -1
    v_mov_b32 v56, -1
    v_mov_b32 v57, -1
    v_mov_b32 v58, -1
    v_mov_b32 v59, -1
    s_mov_b32 exec_hi, s79
    buffer_store_dwordx4 v[56:59], v4, s[36:39], s78 offen sc1
    s_mov_b32 exec_hi, -1
    s_lshl_b32 s79, s83, 11
    s_add_u32 s79, s79, s84
    s_add_u32 s79, s79, 1572864
    s_cmp_lt_u32 s76, 2
    s_cselect_b32 s94, s79, s78
    s_cmp_lg_u32 s76, 1
    s_cbranch_scc1 Lf2_46
    s_sleep 20
    s_mov_b64 exec, 0xffff
    s_mov_b32 s85, 0
Lspin_47:
    s_add_u32 s85, s85, 1
    s_cmp_gt_u32 s85, 400000
    s_cbranch_scc1 L_end
    buffer_load_dword v52, v61, s[36:39], 0 offen sc1
    s_waitcnt vmcnt(0)
    v_cmp_ne_u32_e64 vcc, s75, v52
    s_cbranch_vccnz Lspin_47
    s_mov_b64 exec, -1
Lf2_46:
    s_barrier
    s_waitcnt vmcnt(0)
    s_mov_b32 s100, 0x05040100
    s_mov_b32 s101, 0x07060302
    v_perm_b32 v7, v68, v64, s100
    v_perm_b32 v68, v68, v64, s101
    v_mov_b32_e64 v64, v7
    v_perm_b32 v7, v69, v65, s100
    v_perm_b32 v69, v69, v65, s101
    v_mov_b32_e64 v65, v7
    v_perm_b32 v7, v70, v66, s100
    v_perm_b32 v70, v70, v66, s101
    v_mov_b32_e64 v66, v7
    v_perm_b32 v7, v71, v67, s100
    v_perm_b32 v71, v71, v67, s101
    v_mov_b32_e64 v67, v7
    v_perm_b32 v7, v100, v96, s100
    v_perm_b32 v100, v100, v96, s101
    v_mov_b32_e64 v96, v7
    v_perm_b32 v7, v101, v97, s100
    v_perm_b32 v101, v101, v97, s101
    v_mov_b32_e64 v97, v7
    v_perm_b32 v7, v102, v98, s100
    v_perm_b32 v102, v102, v98, s101
    v_mov_b32_e64 v98, v7
    v_perm_b32 v7, v103, v99, s100
    v_perm_b32 v103, v103, v99, s101
    v_mov_b32_e64 v99, v7
    v_perm_b32 v7, v76, v72, s100
    v_perm_b32 v76, v76, v72, s101
    v_mov_b32_e64 v72, v7
    v_perm_b32 v7, v77, v73, s100
    v_perm_b32 v77, v77, v73, s101
    v_mov_b32_e64 v73, v7
    v_perm_b32 v7, v78, v74, s100
    v_perm_b32 v78, v78, v74, s101
    v_mov_b32_e64 v74, v7
    v_perm_b32 v7, v79, v75, s100
    v_perm_b32 v79, v79, v75, s101
    v_mov_b32_e64 v75, v7
    v_perm_b32 v7, v108, v104, s100
    v_perm_b32 v108, v108, v104, s101
    v_mov_b32_e64 v104, v7
    v_perm_b32 v7, v109, v105, s100
    v_perm_b32 v109, v109, v105, s101
    v_mov_b32_e64 v105, v7
    v_perm_b32 v7, v110, v106, s100
    v_perm_b32 v110, v110, v106, s101
    v_mov_b32_e64 v106, v7
    v_perm_b32 v7, v111, v107, s100
    v_perm_b32 v111, v111, v107, s101
    v_mov_b32_e64 v107, v7
    v_perm_b32 v7, v84, v80, s100
    v_perm_b32 v84, v84, v80, s101
    v_mov_b32_e64 v80, v7
    v_perm_b32 v7, v85, v81, s100
    v_perm_b32 v85, v85, v81, s101
    v_mov_b32_e64 v81, v7
    v_perm_b32 v7, v86, v82, s100
    v_perm_b32 v86, v86, v82, s101
    v_mov_b32_e64 v82, v7
    v_perm_b32 v7, v87, v83, s100
    v_perm_b32 v87, v87, v83, s101
    v_mov_b32_e64 v83, v7
    v_perm_b32 v7, v116, v112, s100
    v_perm_b32 v116, v116, v112, s101
    v_mov_b32_e64 v112, v7
    v_perm_b32 v7, v117, v113, s100
    v_perm_b32 v117, v117, v113, s101
    v_mov_b32_e64 v113, v7
    v_perm_b32 v7, v118, v114, s100
    v_perm_b32 v118, v118, v114, s101
    v_mov_b32_e64 v114, v7
    v_perm_b32 v7, v119, v115, s100
    v_perm_b32 v119, v119, v115, s101
    v_mov_b32_e64 v115, v7
    v_perm_b32 v7, v92, v88, s100
    v_perm_b32 v92, v92, v88, s101
    v_mov_b32_e64 v88, v7
    v_perm_b32 v7, v93, v89, s100
    v_perm_b32 v93, v93, v89, s101
    v_mov_b32_e64 v89, v7
    v_perm_b32 v7, v94, v90, s100
    v_perm_b32 v94, v94, v90, s101
    v_mov_b32_e64 v90, v7
    v_perm_b32 v7, v95, v91, s100
    v_perm_b32 v95, v95, v91, s101
    v_mov_b32_e64 v91, v7
    v_perm_b32 v7, v124, v120, s100
    v_perm_b32 v124, v124, v120, s101
    v_mov_b32_e64 v120, v7
    v_perm_b32 v7, v125, v121, s100
    v_perm_b32 v125, v125, v121, s101
    v_mov_b32_e64 v121, v7
    v_perm_b32 v7, v126, v122, s100
    v_perm_b32 v126, v126, v122, s101
    v_mov_b32_e64 v122, v7
    v_perm_b32 v7, v127, v123, s100
    v_perm_b32 v127, v127, v123, s101
    v_mov_b32_e64 v123, v7
    v_perm_b32 v7, v132, v128, s100
    v_perm_b32 v132, v132, v128, s101
    v_mov_b32_e64 v128, v7
    v_perm_b32 v7, v133, v129, s100
    v_perm_b32 v133, v133, v129, s101
    v_mov_b32_e64 v129, v7
    v_perm_b32 v7, v134, v130, s100
    v_perm_b32 v134, v134, v130, s101
    v_mov_b32_e64 v130, v7
    v_perm_b32 v7, v135, v131, s100
    v_perm_b32 v135, v135, v131, s101
    v_mov_b32 v131, v7
    v_lshrrev_b32 v8, 3, v2
    v_and_b32 v9, 7, v2
    v_lshlrev_b32 v10, 4, v9
    v_lshl_add_u32 v11, v8, 13, v10
    v_and_b32 v12, 15, v2
    v_lshlrev_b32 v12, 13, v12
    v_lshl_add_u32 v13, v8, 9, v10
    v_lshl_add_u32 v14, v9, 3, v8
    s_lshl_b32 s80, s74, 2
    s_add_u32 s80, s80, s76
    s_lshl_b32 s78, s80, 9
    s_add_u32 s78, s78, 524288
    s_add_u32 s79, s78, 65536
    s_add_u32 s81, s73, s76
    s_and_b32 s81, s81, 3
    s_andn2_b32 s100, s73, 3
    s_or_b32 s81, s81, s100
    s_lshl_b32 s81, s81, 13
    s_lshl_b32 s80, s80, 9
    s_add_u32 s80, s80, s81
    s_add_u32 s80, s80, 655360
    s_lshl_b32 s81, s73, 13
    s_add_u32 s81, s81, 655360
    s_barrier
    buffer_load_dwordx4 v[56:59], v4, s[36:39], s94 offen sc1
    s_mov_b32 s100, 4096
    buffer_load_dwordx4 v[136:139], v245, s[56:59], s100 offen nt
    s_mov_b32 s100, 6144
    buffer_load_dwordx4 v[140:143], v245, s[56:59], s100 offen nt
    s_mov_b32 s100, 8192
    buffer_load_dwordx4 v[144:147], v245, s[56:59], s100 offen nt
    s_mov_b32 s100, 10240
    buffer_load_dwordx4 v[148:151], v245, s[56:59], s100 offen nt
    s_barrier
    s_waitcnt vmcnt(0)
    s_mov_b32 s100, 0x05040100
    s_mov_b32 s101, 0x07060302
    v_perm_b32 v7, v140, v136, s100
    v_perm_b32 v140, v140, v136, s101
    v_mov_b32_e64 v136, v7
    v_perm_b32 v7, v141, v137, s100
    v_perm_b32 v141, v141, v137, s101
    v_mov_b32_e64 v137, v7
    v_perm_b32 v7, v142, v138, s100
    v_perm_b32 v142, v142, v138, s101
    v_mov_b32_e64 v138, v7
    v_perm_b32 v7, v143, v139, s100
    v_perm_b32 v143, v143, v139, s101
    v_mov_b32_e64 v139, v7
    v_perm_b32 v7, v148, v144, s100
    v_perm_b32 v148, v148, v144, s101
    v_mov_b32_e64 v144, v7
    v_perm_b32 v7, v149, v145, s100
    v_perm_b32 v149, v149, v145, s101
    v_mov_b32_e64 v145, v7
    v_perm_b32 v7, v150, v146, s100
    v_perm_b32 v150, v150, v146, s101
    v_mov_b32_e64 v146, v7
    v_perm_b32 v7, v151, v147, s100
    v_perm_b32 v151, v151, v147, s101
    v_mov_b32 v147, v7
    s_barrier
    s_mov_b32 s100, 12288
    buffer_load_dwordx4 v[152:155], v245, s[56:59], s100 offen nt
    s_mov_b32 s100, 14336
    buffer_load_dwordx4 v[156:159], v245, s[56:59], s100 offen nt
    s_sleep 20
    s_mov_b64 exec, 0xffff
    s_mov_b32 s85, 0
Lspin_48:
    s_add_u32 s85, s85, 1
    s_cmp_gt_u32 s85, 400000
    s_cbranch_scc1 L_end
    buffer_load_dwordx2 v[24:25], v12, s[36:39], s78 offen offset:128 sc1
    s_waitcnt vmcnt(0)
    v_cmp_ne_u32_e64 vcc, s75, v25
    s_cbranch_vccnz Lspin_48
    v_max_f32_dpp v24, v24, v24 row_ror:8 row_mask:0xf bank_mask:0xf
    s_nop 1
    v_max_f32_dpp v24, v24, v24 row_ror:4 row_mask:0xf bank_mask:0xf
    s_nop 1
    v_max_f32_dpp v24, v24, v24 row_ror:2 row_mask:0xf bank_mask:0xf
    s_nop 1
    v_max_f32_dpp v24, v24, v24 row_ror:1 row_mask:0xf bank_mask:0xf
    s_nop 0
    v_readfirstlane_b32 s97, v24
    s_mov_b64 exec, -1
    s_nop 0
    v_mov_b32 v24, s97
    s_cmp_ge_u32 s73, 56
    s_cbranch_scc1 L_red
    s_bfe_u32 s79, s97, 0x40007
    s_lshl_b32 s79, s79, 13
    s_add_u32 s78, s78, s79
    v_lshlrev_b32_e64 v25, 4, v8
    s_mov_b32 s85, 0
Lspin_49:
    s_add_u32 s85, s85, 1
    s_cmp_gt_u32 s85, 400000
    s_cbranch_scc1 L_end
    buffer_load_dwordx4 v[20:23], v25, s[36:39], s78 offen sc1
    v_mov_b32 v26, 163360
    ds_write_b32 v26, v24
    v_lshlrev_b32_e64 v15, 3, v14
    s_waitcnt vmcnt(0) lgkmcnt(0)
    v_max3_u32 v16, v20, v21, v22
    v_max_u32 v16, v16, v23
    v_cmp_eq_u32_e64 vcc, -1, v16
    s_cbranch_vccnz Lspin_49
    v_dot2_f32_bf16 v28, v64, v20, 0
    v_dot2_f32_bf16 v29, v68, v20, 0
    v_dot2_f32_bf16 v30, v65, v20, 0
    v_dot2_f32_bf16 v31, v69, v20, 0
    v_dot2_f32_bf16 v32, v66, v20, 0
    v_dot2_f32_bf16 v33, v70, v20, 0
    v_dot2_f32_bf16 v34, v67, v20, 0
    v_dot2_f32_bf16 v35, v71, v20, 0
    v_dot2_f32_bf16 v28, v72, v21, v28
    v_dot2_f32_bf16 v29, v76, v21, v29
    v_dot2_f32_bf16 v30, v73, v21, v30
    v_dot2_f32_bf16 v31, v77, v21, v31
    v_dot2_f32_bf16 v32, v74, v21, v32
    v_dot2_f32_bf16 v33, v78, v21, v33
    v_dot2_f32_bf16 v34, v75, v21, v34
    v_dot2_f32_bf16 v35, v79, v21, v35
    v_dot2_f32_bf16 v28, v80, v22, v28
    v_dot2_f32_bf16 v29, v84, v22, v29
    v_dot2_f32_bf16 v30, v81, v22, v30
    v_dot2_f32_bf16 v31, v85, v22, v31
    v_dot2_f32_bf16 v32, v82, v22, v32
    v_dot2_f32_bf16 v33, v86, v22, v33
    v_dot2_f32_bf16 v34, v83, v22, v34
    v_dot2_f32_bf16 v35, v87, v22, v35
    v_dot2_f32_bf16 v28, v88, v23, v28
    v_dot2_f32_bf16 v29, v92, v23, v29
    v_dot2_f32_bf16 v30, v89, v23, v30
    v_dot2_f32_bf16 v31, v93, v23, v31
    v_dot2_f32_bf16 v32, v90, v23, v32
    v_dot2_f32_bf16 v33, v94, v23, v33
    v_dot2_f32_bf16 v34, v91, v23, v34
    v_dot2_f32_bf16 v35, v95, v23, v35
    v_dot2_f32_bf16 v36, v96, v20, 0
    v_dot2_f32_bf16 v37, v100, v20, 0
    v_dot2_f32_bf16 v38, v97, v20, 0
    v_dot2_f32_bf16 v39, v101, v20, 0
    v_dot2_f32_bf16 v40, v98, v20, 0
    v_dot2_f32_bf16 v41, v102, v20, 0
    v_dot2_f32_bf16 v42, v99, v20, 0
    v_dot2_f32_bf16 v43, v103, v20, 0
    v_dot2_f32_bf16 v36, v104, v21, v36
    v_dot2_f32_bf16 v37, v108, v21, v37
    v_dot2_f32_bf16 v38, v105, v21, v38
    v_dot2_f32_bf16 v39, v109, v21, v39
    v_dot2_f32_bf16 v40, v106, v21, v40
    v_dot2_f32_bf16 v41, v110, v21, v41
    v_dot2_f32_bf16 v42, v107, v21, v42
    v_dot2_f32_bf16 v43, v111, v21, v43
    v_dot2_f32_bf16 v36, v112, v22, v36
    v_dot2_f32_bf16 v37, v116, v22, v37
    v_dot2_f32_bf16 v38, v113, v22, v38
    v_dot2_f32_bf16 v39, v117, v22, v39
    v_dot2_f32_bf16 v40, v114, v22, v40
    v_dot2_f32_bf16 v41, v118, v22, v41
    v_dot2_f32_bf16 v42, v115, v22, v42
    v_dot2_f32_bf16 v43, v119, v22, v43
    v_dot2_f32_bf16 v36, v120, v23, v36
    v_dot2_f32_bf16 v37, v124, v23, v37
    v_dot2_f32_bf16 v38, v121, v23, v38
    v_dot2_f32_bf16 v39, v125, v23, v39
    v_dot2_f32_bf16 v40, v122, v23, v40
    v_dot2_f32_bf16 v41, v126, v23, v41
    v_dot2_f32_bf16 v42, v123, v23, v42
    v_dot2_f32_bf16 v43, v127, v23, v43
    v_permlane32_swap_b32 v28, v32
    v_permlane32_swap_b32 v29, v33
    v_permlane32_swap_b32 v30, v34
    v_permlane32_swap_b32 v31, v35
    v_pk_add_f32 v[28:29], v[28:29], v[32:33]
    v_pk_add_f32 v[30:31], v[30:31], v[34:35]
    s_nop 1
    v_permlane16_swap_b32 v28, v30
    v_permlane16_swap_b32_e64 v29, v31
    v_pk_add_f32 v[28:29], v[28:29], v[30:31]
    s_nop 1
    v_add_f32_dpp v44, v28, v28 row_ror:8 row_mask:0xf bank_mask:0x3
    s_nop 1
    v_add_f32_dpp v44, v29, v29 row_ror:8 row_mask:0xf bank_mask:0xc
    v_permlane32_swap_b32 v36, v40
    v_permlane32_swap_b32 v37, v41
    v_permlane32_swap_b32 v38, v42
    v_permlane32_swap_b32 v39, v43
    v_pk_add_f32 v[36:37], v[36:37], v[40:41]
    v_pk_add_f32 v[38:39], v[38:39], v[42:43]
    s_nop 1
    v_permlane16_swap_b32 v36, v38
    v_permlane16_swap_b32_e64 v37, v39
    v_pk_add_f32 v[36:37], v[36:37], v[38:39]
    s_nop 1
    v_add_f32_dpp v45, v36, v36 row_ror:8 row_mask:0xf bank_mask:0x3
    s_nop 1
    v_add_f32_dpp v45, v37, v37 row_ror:8 row_mask:0xf bank_mask:0xc
    s_bitcmp1_b32 s99, 0
    s_cbranch_scc1 Lls_50
    buffer_store_dwordx2 v[44:45], v15, s[36:39], s80 offen sc1
    s_branch Lle_51
Lls_50:
    buffer_store_dwordx2 v[44:45], v15, s[36:39], s80 offen
Lle_51:
    s_mov_b32 s95, s80
    s_barrier
    s_lshl_b32 s78, s76, 7
    s_add_u32 s78, s78, s81
    s_add_u32 s79, s78, 4096
    v_lshrrev_b32 v26, 5, v2
    v_lshl_add_u32 v26, v9, 1, v26
    s_lshl_b32 s80, s76, 5
    s_add_u32 s80, s80, 163456
    v_lshl_add_u32 v26, v26, 1, s80
    v_lshlrev_b32 v27, 4, v8
    v_add_u32 v27, 163456, v27
    v_lshlrev_b32 v15, 2, v14
    s_mul_i32 s80, s74, 56
    s_add_u32 s80, s80, s73
    s_lshl_b32 s80, s80, 10
    s_lshl_b32 s82, s76, 8
    s_add_u32 s80, s80, s82
    s_add_u32 s80, s80, 1114112
    s_waitcnt vmcnt(0)
    s_mov_b32 s100, 0x05040100
    s_mov_b32 s101, 0x07060302
    v_perm_b32 v7, v156, v152, s100
    v_perm_b32 v156, v156, v152, s101
    v_mov_b32 v152, v7
    v_perm_b32 v7, v157, v153, s100
    v_perm_b32 v157, v157, v153, s101
    v_mov_b32_e64 v153, v7
    v_perm_b32 v7, v158, v154, s100
    v_perm_b32 v158, v158, v154, s101
    v_mov_b32_e64 v154, v7
    v_perm_b32 v7, v159, v155, s100
    v_perm_b32 v159, v159, v155, s101
    v_mov_b32_e64 v155, v7
    s_mov_b32 s85, 0
Lspin_52:
    s_add_u32 s85, s85, 1
    s_cmp_gt_u32 s85, 400000
    s_cbranch_scc1 L_end
    buffer_load_dwordx4 v[16:19], v13, s[36:39], s78 offen sc1
    buffer_load_dwordx4 v[20:23], v13, s[36:39], s79 offen sc1
    s_waitcnt vmcnt(0)
    v_max3_u32 v25, v16, v18, v20
    v_max_u32 v25, v25, v22
    v_cmp_eq_u32_e64 vcc, -1, v25
    s_cbranch_vccnz Lspin_52
    v_pk_add_f32 v[16:17], v[16:17], v[20:21]
    v_pk_add_f32 v[18:19], v[18:19], v[22:23]
    s_nop 1
    v_permlane32_swap_b32 v16, v18
    v_permlane32_swap_b32_e64 v17, v19
    v_pk_add_f32 v[16:17], v[16:17], v[18:19]
    v_mov_b32 v18, v16
    v_mov_b32 v19, v17
    s_nop 0
    v_permlane16_swap_b32 v16, v18
    v_permlane16_swap_b32_e64 v17, v19
    v_pk_add_f32 v[16:17], v[16:17], v[18:19]
    s_nop 1
    s_nop 0
    v_add_f32_dpp v16, v16, v16 row_ror:8 row_mask:0xf bank_mask:0xf
    v_add_f32_dpp v17, v17, v17 row_ror:8 row_mask:0xf bank_mask:0xf
    v_cvt_pk_bf16_f32 v16, v16, v16
    v_and_b32 v16, 0xffff0000, v16
    v_cvt_pk_bf16_f32 v17, v17, v17
    v_and_b32 v17, 0xffff0000, v17
    v_mul_f32 v18, 0xbfb8aa3b, v16
    v_exp_f32 v18, v18
    s_nop 0
    v_add_f32 v18, 1.0, v18
    v_rcp_f32 v18, v18
    s_nop 0
    v_mul_f32 v16, v16, v18
    v_cvt_pk_bf16_f32 v16, v16, v16
    v_and_b32 v16, 0xffff0000, v16
    v_mul_f32_e64 v16, v16, v17
    v_cvt_pk_bf16_f32 v16, v16, v16
    ds_write_b16 v26, v16
    s_waitcnt lgkmcnt(0)
    s_barrier
    ds_read_b128 v[20:23], v27
    s_waitcnt lgkmcnt(0)
    s_nop 0
    v_dot2_f32_bf16 v28, v128, v20, 0
    v_dot2_f32_bf16 v29, v132, v20, 0
    v_dot2_f32_bf16 v30, v129, v20, 0
    v_dot2_f32_bf16 v31, v133, v20, 0
    v_dot2_f32_bf16 v32, v130, v20, 0
    v_dot2_f32_bf16 v33, v134, v20, 0
    v_dot2_f32_bf16 v34, v131, v20, 0
    v_dot2_f32_bf16 v35, v135, v20, 0
    v_dot2_f32_bf16 v28, v136, v21, v28
    v_dot2_f32_bf16 v29, v140, v21, v29
    v_dot2_f32_bf16 v30, v137, v21, v30
    v_dot2_f32_bf16 v31, v141, v21, v31
    v_dot2_f32_bf16 v32, v138, v21, v32
    v_dot2_f32_bf16 v33, v142, v21, v33
    v_dot2_f32_bf16 v34, v139, v21, v34
    v_dot2_f32_bf16 v35, v143, v21, v35
    v_dot2_f32_bf16 v28, v144, v22, v28
    v_dot2_f32_bf16 v29, v148, v22, v29
    v_dot2_f32_bf16 v30, v145, v22, v30
    v_dot2_f32_bf16 v31, v149, v22, v31
    v_dot2_f32_bf16 v32, v146, v22, v32
    v_dot2_f32_bf16 v33, v150, v22, v33
    v_dot2_f32_bf16 v34, v147, v22, v34
    v_dot2_f32_bf16 v35, v151, v22, v35
    v_dot2_f32_bf16 v28, v152, v23, v28
    v_dot2_f32_bf16 v29, v156, v23, v29
    v_dot2_f32_bf16 v30, v153, v23, v30
    v_dot2_f32_bf16 v31, v157, v23, v31
    v_dot2_f32_bf16 v32, v154, v23, v32
    v_dot2_f32_bf16 v33, v158, v23, v33
    v_dot2_f32_bf16 v34, v155, v23, v34
    v_dot2_f32_bf16 v35, v159, v23, v35
    v_permlane32_swap_b32 v28, v32
    v_permlane32_swap_b32 v29, v33
    v_permlane32_swap_b32 v30, v34
    v_permlane32_swap_b32 v31, v35
    v_pk_add_f32 v[28:29], v[28:29], v[32:33]
    v_pk_add_f32 v[30:31], v[30:31], v[34:35]
    s_nop 1
    v_permlane16_swap_b32 v28, v30
    v_permlane16_swap_b32_e64 v29, v31
    v_pk_add_f32 v[28:29], v[28:29], v[30:31]
    s_nop 1
    v_add_f32_dpp v46, v28, v28 row_ror:8 row_mask:0xf bank_mask:0x3
    s_nop 1
    v_add_f32_dpp v46, v29, v29 row_ror:8 row_mask:0xf bank_mask:0xc
    buffer_store_dword v46, v15, s[36:39], s80 offen sc1
    s_barrier
    s_branch L_fin
L_red:
    v_mov_b32 v26, 163360
    ds_write_b32 v26, v24
    s_waitcnt lgkmcnt(0)
    s_barrier
    s_barrier
    s_barrier
    s_cmp_lg_u32 s76, 0
    s_cbranch_scc1 L_fin
    s_sub_u32 s83, s0, 224
    v_lshrrev_b32_e64 v14, 4, v2
    v_lshl_add_u32 v14, v9, 2, v14
    v_lshlrev_b32 v15, 2, v14
    v_lshlrev_b32 v14, 1, v14
    s_bfe_u32 s78, s97, 0x40007
    s_lshl_b32 s78, s78, 13
    s_lshr_b32 s79, s83, 1
    s_lshl_b32 s79, s79, 9
    s_add_u32 s78, s78, s79
    s_and_b32 s79, s83, 1
    s_lshl_b32 s79, s79, 7
    s_add_u32 s78, s78, s79
    s_add_u32 s78, s78, 524544
    s_mov_b32 s85, 0
Lspin_53:
    s_add_u32 s85, s85, 1
    s_cmp_gt_u32 s85, 400000
    s_cbranch_scc1 L_end
    buffer_load_dword v46, v15, s[36:39], s78 offen sc1
    s_waitcnt vmcnt(0)
    v_cmp_eq_u32_e64 vcc, -1, v46
    s_cbranch_vccnz Lspin_53
    v_cvt_pk_bf16_f32 v47, v24, v24
    v_and_b32 v47, 0xffff0000, v47
    v_mul_f32 v47, 0xbfb8aa3b, v47
    v_exp_f32 v47, v47
    s_nop 0
    v_add_f32 v47, 1.0, v47
    v_rcp_f32_e64 v47, v47
    s_nop 0
    v_cvt_pk_bf16_f32 v47, v47, v47
    v_and_b32 v47, 0xffff0000, v47
    v_lshl_add_u32 v13, v8, 10, v10
    s_lshr_b32 s78, s83, 3
    s_mul_i32 s78, s78, 57344
    s_and_b32 s79, s83, 7
    s_lshl_b32 s79, s79, 7
    s_add_u32 s78, s78, s79
    s_add_u32 s78, s78, 1114112
    s_and_b32 s80, s97, 0x7ff
    s_lshl_b32 s80, s80, 11
    s_lshl_b32 s79, s83, 6
    s_add_u32 s80, s80, s79
    s_sleep 32
    s_mov_b32 s85, 0
Lspin_54:
    s_add_u32 s85, s85, 1
    s_cmp_gt_u32 s85, 400000
    s_cbranch_scc1 L_end
    s_add_u32 s79, s78, 0
    buffer_load_dwordx4 v[16:19], v13, s[36:39], s79 offen sc1
    s_add_u32 s79, s78, 8192
    buffer_load_dwordx4 v[20:23], v13, s[36:39], s79 offen sc1
    s_add_u32 s79, s78, 16384
    buffer_load_dwordx4 v[24:27], v13, s[36:39], s79 offen sc1
    s_add_u32 s79, s78, 24576
    buffer_load_dwordx4 v[28:31], v13, s[36:39], s79 offen sc1
    s_add_u32 s79, s78, 32768
    buffer_load_dwordx4 v[32:35], v13, s[36:39], s79 offen sc1
    s_add_u32 s79, s78, 40960
    buffer_load_dwordx4 v[36:39], v13, s[36:39], s79 offen sc1
    s_add_u32 s79, s78, 49152
    buffer_load_dwordx4 v[40:43], v13, s[36:39], s79 offen sc1
    s_waitcnt vmcnt(0)
    v_max_u32 v48, v16, v17
    v_max_u32_e64 v49, v18, v19
    v_max3_u32 v48, v48, v20, v21
    v_max3_u32 v49, v49, v22, v23
    v_max3_u32 v48, v48, v24, v25
    v_max3_u32 v49, v49, v26, v27
    v_max3_u32 v48, v48, v28, v29
    v_max3_u32 v49, v49, v30, v31
    v_max3_u32 v48, v48, v32, v33
    v_max3_u32 v49, v49, v34, v35
    v_max3_u32 v48, v48, v36, v37
    v_max3_u32 v49, v49, v38, v39
    v_max3_u32 v48, v48, v40, v41
    v_max3_u32 v49, v49, v42, v43
    v_max_u32 v48, v48, v49
    v_cmp_eq_u32_e64 vcc, -1, v48
    s_cbranch_vccnz Lspin_54
    v_pk_add_f32 v[16:17], v[16:17], v[20:21]
    v_pk_add_f32 v[24:25], v[24:25], v[28:29]
    v_pk_add_f32 v[32:33], v[32:33], v[36:37]
    v_pk_add_f32 v[16:17], v[16:17], v[24:25]
    v_pk_add_f32 v[32:33], v[32:33], v[40:41]
    v_pk_add_f32 v[16:17], v[16:17], v[32:33]
    v_pk_add_f32 v[18:19], v[18:19], v[22:23]
    v_pk_add_f32 v[26:27], v[26:27], v[30:31]
    v_pk_add_f32 v[34:35], v[34:35], v[38:39]
    v_pk_add_f32 v[18:19], v[18:19], v[26:27]
    v_pk_add_f32 v[34:35], v[34:35], v[42:43]
    v_pk_add_f32 v[18:19], v[18:19], v[34:35]
    s_nop 1
    v_permlane32_swap_b32 v16, v18
    v_permlane32_swap_b32_e64 v17, v19
    v_pk_add_f32 v[16:17], v[16:17], v[18:19]
    s_nop 1
    v_permlane16_swap_b32 v16, v17
    v_add_f32 v16, v16, v17
    s_nop 1
    v_add_f32_dpp v16, v16, v16 row_ror:8 row_mask:0xf bank_mask:0xf
    v_cvt_pk_bf16_f32 v16, v16, v16
    v_and_b32 v16, 0xffff0000, v16
    v_mul_f32_e64 v16, v16, v47
    v_cvt_pk_bf16_f32 v16, v16, v16
    v_and_b32 v16, 0xffff0000, v16
    v_add_f32_e64 v16, v16, v46
    v_cvt_pk_bf16_f32 v16, v16, v16
    s_mov_b32 exec_lo, 0x00ff00ff
    s_mov_b32 exec_hi, 0x00ff00ff
    buffer_store_short v16, v14, s[44:47], s80 offen
    s_mov_b64 exec, -1
    s_cmp_lg_u32 s0, 224
    s_cbranch_scc1 Lep_55
    s_cmp_lg_u32 s76, 0
    s_cbranch_scc1 Lep_55
    v_mov_b32 v196, s75
    v_mov_b32_e64 v197, 0
    s_mov_b64 exec, 1
    buffer_store_dword v196, v197, s[36:39], 0 offen sc1
    s_mov_b64 exec, -1
Lep_55:
    s_branch L_fin
    .p2align 3
L_M:
    s_setprio 1
    s_and_b32 s78, s2, 7
    s_lshr_b32 s79, s2, 3
    s_lshl_b32 s71, s78, 1
    s_and_b32 s72, s79, 1
    s_add_u32 s71, s71, s72
    s_lshr_b32 s72, s79, 1
    s_cmp_gt_u32 s70, 3
    s_cselect_b32 s78, 1, 0
    s_cmp_gt_u32 s70, 11
    s_cselect_b32 s78, 2, s78
    s_sub_u32 s78, s70, s78
    s_cmp_eq_u32 s70, 3
    s_cselect_b32 s78, 14, s78
    s_cmp_eq_u32 s70, 11
    s_cselect_b32 s78, 15, s78
    s_lshl_b32 s0, s78, 4
    s_add_u32 s0, s0, s69
    s_lshr_b32 s73, s0, 2
    s_and_b32 s74, s0, 3
    s_lshl_b32 s77, s70, 4
    s_add_u32 s77, s77, s69
    s_and_b32 s80, s76, 1
    s_lshr_b32 s81, s76, 1
    v_and_b32 v8, 15, v2
    v_lshrrev_b32 v9, 4, v2
    v_lshrrev_b32 v10, 1, v8
    s_lshl_b32 s78, s80, 13
    s_add_u32 s78, s78, 118784
    v_lshlrev_b32 v11, 7, v8
    v_add_u32 v11, s78, v11
    v_add_u32 v12, 0, v9
    v_xor_b32 v12, v12, v10
    v_lshl_add_u32 v4, v12, 4, v11
    v_add_u32 v12, 4, v9
    v_xor_b32 v12, v12, v10
    v_lshl_add_u32 v5, v12, 4, v11
    v_bfe_u32 v10, v2, 2, 2
    v_and_b32_e64 v11, 3, v2
    v_lshl_add_u32 v12, v9, 3, v10
    v_lshlrev_b32_e64 v12, 7, v12
    v_lshl_add_u32 v12, v11, 3, v12
    v_add_u32 v12, 135168, v12
    v_lshrrev_b32 v13, 1, v10
    v_and_b32 v14, 1, v9
    v_lshl_add_u32 v13, v14, 1, v13
    s_lshl_b32 s78, s81, 1
    s_add_u32 s79, s78, 0
    v_xor_b32_e64 v14, s79, v13
    v_lshl_add_u32 v6, v14, 5, v12
    s_add_u32 s79, s78, 1
    v_xor_b32 v14, s79, v13
    v_lshl_add_u32 v7, v14, 5, v12
    v_lshrrev_b32_e64 v13, 5, v2
    v_lshl_add_u32 v13, v13, 3, v10
    v_lshlrev_b32 v13, 6, v13
    v_and_b32 v14, 1, v9
    v_lshl_add_u32 v13, v14, 5, v13
    v_lshl_add_u32 v13, v11, 3, v13
    s_lshl_b32 s78, s81, 11
    s_add_u32 s78, s78, 159744
    v_add_u32 v15, s78, v13
    v_mov_b64 v[128:129], 0
    v_mov_b64 v[130:131], 0
    v_mov_b64 v[132:133], 0
    v_mov_b64 v[134:135], 0
    v_mov_b64 v[136:137], 0
    v_mov_b64 v[138:139], 0
    v_mov_b64 v[140:141], 0
    v_mov_b64 v[142:143], 0
    v_mov_b64 v[144:145], 0
    v_mov_b64 v[146:147], 0
    v_mov_b64 v[148:149], 0
    v_mov_b64 v[150:151], 0
    v_mov_b64 v[152:153], 0
    v_mov_b64 v[154:155], 0
    v_mov_b64 v[156:157], 0
    v_mov_b64 v[158:159], 0
    v_mov_b64 v[160:161], 0
    v_mov_b64 v[162:163], 0
    v_mov_b64 v[164:165], 0
    v_mov_b64 v[166:167], 0
    v_mov_b64 v[168:169], 0
    v_mov_b64 v[170:171], 0
    v_mov_b64 v[172:173], 0
    v_mov_b64 v[174:175], 0
    v_mov_b64 v[176:177], 0
    v_mov_b64 v[178:179], 0
    v_mov_b64 v[180:181], 0
    v_mov_b64 v[182:183], 0
    v_mov_b64 v[184:185], 0
    v_mov_b64 v[186:187], 0
    v_mov_b64 v[188:189], 0
    v_mov_b64 v[190:191], 0
    v_mov_b64 v[192:193], 0
    v_mov_b64 v[194:195], 0
    v_mov_b64 v[196:197], 0
    v_mov_b64 v[198:199], 0
    v_mov_b64 v[200:201], 0
    v_mov_b64 v[202:203], 0
    v_mov_b64 v[204:205], 0
    v_mov_b64 v[206:207], 0
    v_mov_b64 v[208:209], 0
    v_mov_b64 v[210:211], 0
    v_mov_b64 v[212:213], 0
    v_mov_b64 v[214:215], 0
    v_mov_b64 v[216:217], 0
    v_mov_b64 v[218:219], 0
    v_mov_b64 v[220:221], 0
    v_mov_b64 v[222:223], 0
    v_mov_b64 v[104:105], 0
    v_mov_b64 v[106:107], 0
    v_mov_b64 v[108:109], 0
    v_mov_b64 v[110:111], 0
    v_and_b32 v14, 31, v2
    v_lshrrev_b32_e64 v13, 5, v2
    s_lshl_b32 s78, s81, 14
    s_lshl_b32 s79, s80, 13
    s_add_u32 s78, s78, s79
    s_add_u32 s78, s78, 110592
    v_lshl_add_u32 v12, v14, 7, s78
    v_and_b32 v14, 7, v14
    v_xor_b32 v14, v14, v13
    v_xor_b32_e64 v13, 0, v14
    v_lshl_add_u32 v112, v13, 4, v12
    v_xor_b32_e64 v13, 2, v14
    v_lshl_add_u32 v113, v13, 4, v12
    v_xor_b32_e64 v13, 4, v14
    v_lshl_add_u32 v114, v13, 4, v12
    v_xor_b32_e64 v13, 6, v14
    v_lshl_add_u32 v115, v13, 4, v12
    s_add_u32 s79, s79, 143360
    v_lshl_add_u32 v12, v8, 7, s79
    s_lshl_b32 s78, s81, 2
    v_add_u32 v14, s78, v9
    v_and_b32 v13, 7, v8
    v_xor_b32 v14, v14, v13
    v_lshl_add_u32 v116, v14, 4, v12
    s_lshl_b32 s78, s80, 6
    v_add_u32 v10, s78, v8
    v_lshlrev_b32_e64 v11, 3, v10
    v_add_u32 v11, 159744, v11
    s_lshl_b32 s79, s81, 5
    v_add_u32 v12, s79, v8
    v_lshlrev_b32_e64 v12, 3, v12
    v_add_u32 v12, 160768, v12
    v_lshlrev_b32_e64 v13, 2, v10
    v_add_u32 v13, 162304, v13
    v_and_b32 v14, 31, v2
    v_add_u32 v14, s78, v14
    v_lshlrev_b32_e64 v14, 2, v14
    v_add_u32 v14, 162304, v14
    s_waitcnt lgkmcnt(0)
    s_load_dword s75, s[26:27], 0
    s_mov_b32 s36, s26
    s_and_b32 s37, s27, 0xffff
    s_mov_b32 s38, 0x10000000
    s_mov_b32 s39, 0x20000
    s_mov_b32 s64, s14
    s_and_b32 s65, s15, 0xffff
    s_mov_b32 s66, 0x800
    s_mov_b32 s67, 0x20000
    s_mov_b32 s44, s22
    s_and_b32 s45, s23, 0xffff
    s_mov_b32 s46, 0x400000
    s_mov_b32 s47, 0x20000
    s_lshl_b32 s78, s72, 7
    buffer_load_dword v118, off, s[64:67], s78
    s_waitcnt lgkmcnt(0)
    s_mul_i32 s75, s75, 0x9E3779B1
    s_add_u32 s75, s75, 0x7F4A7C15
    s_mov_b32 s84, 0
    s_mov_b32 s82, 2
    s_mov_b32 s83, 0xfffec000
    s_barrier
    s_nop 0
    ds_read_b128 v[16:19], v4 offset:0
    ds_read_b64_tr_b16 v[40:41], v6 offset:8192
    ds_read_b64_tr_b16 v[42:43], v6 offset:8704
    ds_read_b128 v[20:23], v4 offset:2048
    ds_read_b128 v[24:27], v4 offset:4096
    ds_read_b128 v[28:31], v4 offset:6144
    ds_read_b64_tr_b16 v[44:45], v7 offset:8192
    ds_read_b64_tr_b16 v[46:47], v7 offset:8704
    ds_read_b64_tr_b16 v[48:49], v6 offset:16384
    ds_read_b64_tr_b16 v[50:51], v6 offset:16896
    ds_read_b64_tr_b16 v[52:53], v7 offset:16384
    ds_read_b64_tr_b16 v[54:55], v7 offset:16896
    ds_read_b64_tr_b16 v[32:33], v6 offset:0
    ds_read_b64_tr_b16 v[34:35], v6 offset:512
    ds_read_b64_tr_b16 v[36:37], v7 offset:0
    ds_read_b64_tr_b16 v[38:39], v7 offset:512
    ds_read_b64_tr_b16 v[96:97], v15 offset:0
    ds_read_b64_tr_b16 v[98:99], v15 offset:1024
    ds_read_b64_tr_b16 v[100:101], v15 offset:256
    ds_read_b64_tr_b16 v[102:103], v15 offset:1280
    .p2align 3
L_Mloop:
    s_waitcnt lgkmcnt(0)
    s_nop 0
    v_mfma_f32_16x16x32_bf16 v[160:163], v[40:43], v[16:19], v[160:163]
    ds_read_b128 v[56:59], v5 offset:0
    v_mfma_f32_16x16x32_bf16 v[164:167], v[40:43], v[20:23], v[164:167]
    ds_read_b64_tr_b16 v[80:81], v6 offset:12288
    v_mfma_f32_16x16x32_bf16 v[168:171], v[40:43], v[24:27], v[168:171]
    ds_read_b64_tr_b16 v[82:83], v6 offset:12800
    v_mfma_f32_16x16x32_bf16 v[172:175], v[40:43], v[28:31], v[172:175]
    ds_read_b128 v[60:63], v5 offset:2048
    v_mfma_f32_16x16x32_bf16 v[188:191], v[44:47], v[28:31], v[188:191]
    ds_read_b128 v[64:67], v5 offset:4096
    v_mfma_f32_16x16x32_bf16 v[184:187], v[44:47], v[24:27], v[184:187]
    ds_read_b128 v[68:71], v5 offset:6144
    v_mfma_f32_16x16x32_bf16 v[180:183], v[44:47], v[20:23], v[180:183]
    ds_read_b64_tr_b16 v[84:85], v7 offset:12288
    v_mfma_f32_16x16x32_bf16 v[176:179], v[44:47], v[16:19], v[176:179]
    ds_read_b64_tr_b16 v[86:87], v7 offset:12800
    v_mfma_f32_16x16x32_bf16 v[192:195], v[48:51], v[16:19], v[192:195]
    ds_read_b64_tr_b16 v[88:89], v6 offset:20480
    v_mfma_f32_16x16x32_bf16 v[196:199], v[48:51], v[20:23], v[196:199]
    ds_read_b64_tr_b16 v[90:91], v6 offset:20992
    v_mfma_f32_16x16x32_bf16 v[200:203], v[48:51], v[24:27], v[200:203]
    ds_read_b64_tr_b16 v[92:93], v7 offset:20480
    v_mfma_f32_16x16x32_bf16 v[204:207], v[48:51], v[28:31], v[204:207]
    ds_read_b64_tr_b16 v[94:95], v7 offset:20992
    v_mfma_f32_16x16x32_bf16 v[220:223], v[52:55], v[28:31], v[220:223]
    ds_read_b64_tr_b16 v[72:73], v6 offset:4096
    v_mfma_f32_16x16x32_bf16 v[216:219], v[52:55], v[24:27], v[216:219]
    ds_read_b64_tr_b16 v[74:75], v6 offset:4608
    v_mfma_f32_16x16x32_bf16 v[212:215], v[52:55], v[20:23], v[212:215]
    ds_read_b64_tr_b16 v[76:77], v7 offset:4096
    v_mfma_f32_16x16x32_bf16 v[208:211], v[52:55], v[16:19], v[208:211]
    ds_read_b64_tr_b16 v[78:79], v7 offset:4608
    v_mfma_f32_16x16x32_bf16 v[128:131], v[32:35], v[16:19], v[128:131]
    s_add_u32 s84, s84, 1
    s_cmp_eq_u32 s82, 2
    s_cselect_b32 s78, s83, 40960
    s_cselect_b32 s82, -1, s82
    s_add_u32 s82, s82, 1
    v_mfma_f32_16x16x32_bf16 v[132:135], v[32:35], v[20:23], v[132:135]
    v_add_u32 v4, s78, v4
    v_add_u32 v5, s78, v5
    v_mfma_f32_16x16x32_bf16 v[136:139], v[32:35], v[24:27], v[136:139]
    v_add_u32 v6, s78, v6
    v_add_u32 v7, s78, v7
    v_mfma_f32_16x16x32_bf16 v[140:143], v[32:35], v[28:31], v[140:143]
    v_mfma_f32_16x16x32_bf16 v[156:159], v[36:39], v[28:31], v[156:159]
    v_mfma_f32_16x16x32_bf16 v[152:155], v[36:39], v[24:27], v[152:155]
    v_mfma_f32_16x16x32_bf16 v[148:151], v[36:39], v[20:23], v[148:151]
    v_mfma_f32_16x16x32_bf16 v[144:147], v[36:39], v[16:19], v[144:147]
    s_waitcnt vmcnt(0) lgkmcnt(0)
    v_mfma_f32_16x16x32_bf16 v[160:163], v[80:83], v[56:59], v[160:163]
    v_mfma_f32_16x16x32_bf16 v[164:167], v[80:83], v[60:63], v[164:167]
    s_barrier
    s_cmp_eq_u32 s84, 16
    s_cbranch_scc1 L_Mtail
    v_mfma_f32_16x16x32_bf16 v[168:171], v[80:83], v[64:67], v[168:171]
    ds_read_b128 v[16:19], v4 offset:0
    v_mfma_f32_16x16x32_bf16 v[172:175], v[80:83], v[68:71], v[172:175]
    ds_read_b64_tr_b16 v[40:41], v6 offset:8192
    v_mfma_f32_16x16x32_bf16 v[188:191], v[84:87], v[68:71], v[188:191]
    ds_read_b64_tr_b16 v[42:43], v6 offset:8704
    v_mfma_f32_16x16x32_bf16 v[184:187], v[84:87], v[64:67], v[184:187]
    ds_read_b128 v[20:23], v4 offset:2048
    v_mfma_f32_16x16x32_bf16 v[180:183], v[84:87], v[60:63], v[180:183]
    ds_read_b128 v[24:27], v4 offset:4096
    v_mfma_f32_16x16x32_bf16 v[176:179], v[84:87], v[56:59], v[176:179]
    ds_read_b128 v[28:31], v4 offset:6144
    v_mfma_f32_16x16x32_bf16 v[192:195], v[88:91], v[56:59], v[192:195]
    ds_read_b64_tr_b16 v[44:45], v7 offset:8192
    v_mfma_f32_16x16x32_bf16 v[196:199], v[88:91], v[60:63], v[196:199]
    ds_read_b64_tr_b16 v[46:47], v7 offset:8704
    v_mfma_f32_16x16x32_bf16 v[200:203], v[88:91], v[64:67], v[200:203]
    ds_read_b64_tr_b16 v[48:49], v6 offset:16384
    v_mfma_f32_16x16x32_bf16 v[204:207], v[88:91], v[68:71], v[204:207]
    ds_read_b64_tr_b16 v[50:51], v6 offset:16896
    v_mfma_f32_16x16x32_bf16 v[220:223], v[92:95], v[68:71], v[220:223]
    ds_read_b64_tr_b16 v[52:53], v7 offset:16384
    v_mfma_f32_16x16x32_bf16 v[216:219], v[92:95], v[64:67], v[216:219]
    ds_read_b64_tr_b16 v[54:55], v7 offset:16896
    v_mfma_f32_16x16x32_bf16 v[212:215], v[92:95], v[60:63], v[212:215]
    ds_read_b64_tr_b16 v[32:33], v6 offset:0
    v_mfma_f32_16x16x32_bf16 v[208:211], v[92:95], v[56:59], v[208:211]
    ds_read_b64_tr_b16 v[34:35], v6 offset:512
    v_mfma_f32_16x16x32_bf16 v[128:131], v[72:75], v[56:59], v[128:131]
    ds_read_b64_tr_b16 v[36:37], v7 offset:0
    v_mfma_f32_16x16x32_bf16 v[132:135], v[72:75], v[60:63], v[132:135]
    ds_read_b64_tr_b16 v[38:39], v7 offset:512
    v_mfma_f32_16x16x32_bf16 v[136:139], v[72:75], v[64:67], v[136:139]
    v_mfma_f32_16x16x32_bf16 v[140:143], v[72:75], v[68:71], v[140:143]
    v_mfma_f32_16x16x32_bf16 v[156:159], v[76:79], v[68:71], v[156:159]
    v_mfma_f32_16x16x32_bf16 v[152:155], v[76:79], v[64:67], v[152:155]
    v_mfma_f32_16x16x32_bf16 v[148:151], v[76:79], v[60:63], v[148:151]
    v_mfma_f32_16x16x32_bf16 v[144:147], v[76:79], v[56:59], v[144:147]
    s_branch L_Mloop
    .p2align 3
L_Mtail:
    s_mov_b64 exec, 0xffff
    ds_read_b64 v[104:105], v11 offset:0
    ds_read_b64 v[106:107], v11 offset:128
    ds_read_b64 v[108:109], v11 offset:256
    ds_read_b64 v[110:111], v11 offset:384
    s_mov_b64 exec, -1
    s_nop 0
    v_mfma_f32_16x16x32_bf16 v[168:171], v[80:83], v[64:67], v[168:171]
    ds_read_b64 v[20:21], v12 offset:512
    v_mfma_f32_16x16x32_bf16 v[172:175], v[80:83], v[68:71], v[172:175]
    ds_read_b64 v[22:23], v12 offset:640
    v_mfma_f32_16x16x32_bf16 v[188:191], v[84:87], v[68:71], v[188:191]
    ds_read_b64 v[24:25], v12 offset:1024
    v_mfma_f32_16x16x32_bf16 v[184:187], v[84:87], v[64:67], v[184:187]
    ds_read_b64 v[26:27], v12 offset:1152
    v_mfma_f32_16x16x32_bf16 v[180:183], v[84:87], v[60:63], v[180:183]
    ds_read_b64 v[16:17], v12 offset:0
    v_mfma_f32_16x16x32_bf16 v[176:179], v[84:87], v[56:59], v[176:179]
    ds_read_b64 v[18:19], v12 offset:128
    v_mfma_f32_16x16x32_bf16 v[192:195], v[88:91], v[56:59], v[192:195]
    ds_read2_b32 v[32:33], v14 offset0:0 offset1:32
    v_mfma_f32_16x16x32_bf16 v[196:199], v[88:91], v[60:63], v[196:199]
    ds_read_b32 v28, v13 offset:0
    v_mfma_f32_16x16x32_bf16 v[200:203], v[88:91], v[64:67], v[200:203]
    ds_read_b32 v30, v13 offset:64
    v_mfma_f32_16x16x32_bf16 v[204:207], v[88:91], v[68:71], v[204:207]
    ds_read_b32 v44, v13 offset:128
    v_mfma_f32_16x16x32_bf16 v[220:223], v[92:95], v[68:71], v[220:223]
    ds_read_b32 v46, v13 offset:192
    v_mfma_f32_16x16x32_bf16 v[216:219], v[92:95], v[64:67], v[216:219]
    v_mfma_f32_16x16x32_bf16 v[212:215], v[92:95], v[60:63], v[212:215]
    v_mfma_f32_16x16x32_bf16 v[208:211], v[92:95], v[56:59], v[208:211]
    s_waitcnt lgkmcnt(0)
    s_nop 0
    v_mfma_f32_16x16x16_bf16 v[160:163], v[20:21], v[104:105], v[160:163]
    v_mfma_f32_16x16x16_bf16 v[176:179], v[22:23], v[104:105], v[176:179]
    v_mfma_f32_16x16x16_bf16 v[164:167], v[20:21], v[106:107], v[164:167]
    v_mfma_f32_16x16x16_bf16 v[180:183], v[22:23], v[106:107], v[180:183]
    v_mfma_f32_16x16x16_bf16 v[168:171], v[20:21], v[108:109], v[168:171]
    v_mfma_f32_16x16x16_bf16 v[184:187], v[22:23], v[108:109], v[184:187]
    v_mfma_f32_16x16x16_bf16 v[172:175], v[20:21], v[110:111], v[172:175]
    v_mfma_f32_16x16x16_bf16 v[188:191], v[22:23], v[110:111], v[188:191]
    v_mul_f32 v34, 0x3fb8aa3b, v32
    v_mul_f32 v48, 0x3fb8aa3b, v33
    v_mfma_f32_16x16x16_bf16 v[192:195], v[24:25], v[104:105], v[192:195]
    v_mfma_f32_16x16x16_bf16 v[208:211], v[26:27], v[104:105], v[208:211]
    v_mfma_f32_16x16x16_bf16 v[196:199], v[24:25], v[106:107], v[196:199]
    v_cvt_pk_bf16_f32 v160, v160, v161
    v_cvt_pk_bf16_f32 v161, v162, v163
    v_cvt_pk_bf16_f32 v162, v176, v177
    v_cvt_pk_bf16_f32 v163, v178, v179
    v_mfma_f32_16x16x16_bf16 v[212:215], v[26:27], v[106:107], v[212:215]
    v_cvt_pk_bf16_f32 v164, v164, v165
    v_cvt_pk_bf16_f32 v165, v166, v167
    v_cvt_pk_bf16_f32 v166, v180, v181
    v_cvt_pk_bf16_f32 v167, v182, v183
    v_mfma_f32_16x16x16_bf16 v[200:203], v[24:25], v[108:109], v[200:203]
    v_cvt_pk_bf16_f32 v168, v168, v169
    v_cvt_pk_bf16_f32 v169, v170, v171
    v_cvt_pk_bf16_f32 v170, v184, v185
    v_cvt_pk_bf16_f32 v171, v186, v187
    v_mfma_f32_16x16x16_bf16 v[216:219], v[26:27], v[108:109], v[216:219]
    v_cvt_pk_bf16_f32 v172, v172, v173
    v_cvt_pk_bf16_f32 v173, v174, v175
    v_cvt_pk_bf16_f32 v174, v188, v189
    v_cvt_pk_bf16_f32 v175, v190, v191
    v_mfma_f32_16x16x16_bf16 v[204:207], v[24:25], v[110:111], v[204:207]
    v_permlane16_swap_b32 v160, v164
    v_permlane16_swap_b32 v161, v165
    v_permlane16_swap_b32 v162, v166
    v_permlane16_swap_b32 v163, v167
    v_mfma_f32_16x16x16_bf16 v[220:223], v[26:27], v[110:111], v[220:223]
    v_permlane16_swap_b32 v168, v172
    v_permlane16_swap_b32 v169, v173
    v_permlane16_swap_b32 v170, v174
    v_permlane16_swap_b32 v171, v175
    v_mfma_f32_32x32x16_bf16 v[224:239], v[96:99], v[160:163], 0
    v_mfma_f32_32x32x16_bf16 v[224:239], v[100:103], v[164:167], v[224:239]
    v_mfma_f32_32x32x16_bf16 v[240:255], v[96:99], v[168:171], 0
    v_mfma_f32_32x32x16_bf16 v[240:255], v[100:103], v[172:175], v[240:255]
    v_pk_mul_f32 v[192:193], v[192:193], v[28:29] op_sel_hi:[1,0]
    v_pk_mul_f32 v[194:195], v[194:195], v[28:29] op_sel_hi:[1,0]
    v_pk_mul_f32 v[208:209], v[208:209], v[28:29] op_sel_hi:[1,0]
    v_pk_mul_f32 v[210:211], v[210:211], v[28:29] op_sel_hi:[1,0]
    v_cvt_pk_bf16_f32 v192, v192, v193
    v_cvt_pk_bf16_f32 v193, v194, v195
    v_cvt_pk_bf16_f32 v194, v208, v209
    v_cvt_pk_bf16_f32 v195, v210, v211
    v_pk_mul_f32 v[196:197], v[196:197], v[30:31] op_sel_hi:[1,0]
    v_pk_mul_f32 v[198:199], v[198:199], v[30:31] op_sel_hi:[1,0]
    v_pk_mul_f32 v[212:213], v[212:213], v[30:31] op_sel_hi:[1,0]
    v_pk_mul_f32 v[214:215], v[214:215], v[30:31] op_sel_hi:[1,0]
    v_cvt_pk_bf16_f32 v196, v196, v197
    v_cvt_pk_bf16_f32 v197, v198, v199
    v_cvt_pk_bf16_f32 v198, v212, v213
    v_cvt_pk_bf16_f32 v199, v214, v215
    v_pk_mul_f32 v[200:201], v[200:201], v[44:45] op_sel_hi:[1,0]
    v_pk_mul_f32 v[202:203], v[202:203], v[44:45] op_sel_hi:[1,0]
    v_pk_mul_f32 v[216:217], v[216:217], v[44:45] op_sel_hi:[1,0]
    v_pk_mul_f32 v[218:219], v[218:219], v[44:45] op_sel_hi:[1,0]
    v_cvt_pk_bf16_f32 v200, v200, v201
    v_cvt_pk_bf16_f32 v201, v202, v203
    v_cvt_pk_bf16_f32 v202, v216, v217
    v_cvt_pk_bf16_f32 v203, v218, v219
    v_pk_mul_f32 v[204:205], v[204:205], v[46:47] op_sel_hi:[1,0]
    v_pk_mul_f32 v[206:207], v[206:207], v[46:47] op_sel_hi:[1,0]
    v_pk_mul_f32 v[220:221], v[220:221], v[46:47] op_sel_hi:[1,0]
    v_pk_mul_f32 v[222:223], v[222:223], v[46:47] op_sel_hi:[1,0]
    v_cvt_pk_bf16_f32 v204, v204, v205
    v_cvt_pk_bf16_f32 v205, v206, v207
    v_cvt_pk_bf16_f32 v206, v220, v221
    v_cvt_pk_bf16_f32 v207, v222, v223
    v_mfma_f32_16x16x32_bf16 v[128:131], v[72:75], v[56:59], v[128:131]
    v_max3_f32 v36, v224, v225, v226
    v_max3_f32 v38, -v224, -v225, -v226
    v_max3_f32 v36, v36, v227, v228
    v_max3_f32 v38, v38, -v227, -v228
    v_mfma_f32_16x16x32_bf16 v[132:135], v[72:75], v[60:63], v[132:135]
    v_max3_f32 v36, v36, v229, v230
    v_max3_f32 v38, v38, -v229, -v230
    v_max3_f32 v36, v36, v231, v232
    v_max3_f32 v38, v38, -v231, -v232
    v_mfma_f32_16x16x32_bf16 v[136:139], v[72:75], v[64:67], v[136:139]
    v_max3_f32 v36, v36, v233, v234
    v_max3_f32 v38, v38, -v233, -v234
    v_max3_f32 v36, v36, v235, v236
    v_max3_f32 v38, v38, -v235, -v236
    v_mfma_f32_16x16x32_bf16 v[140:143], v[72:75], v[68:71], v[140:143]
    v_max3_f32 v36, v36, v237, v238
    v_max3_f32 v38, v38, -v237, -v238
    v_max_f32_e64 v36, v36, v239
    v_max_f32 v38, v38, -v239
    v_mfma_f32_16x16x32_bf16 v[156:159], v[76:79], v[68:71], v[156:159]
    v_max3_f32 v37, v240, v241, v242
    v_max3_f32 v39, -v240, -v241, -v242
    v_max3_f32 v37, v37, v243, v244
    v_max3_f32 v39, v39, -v243, -v244
    v_mfma_f32_16x16x32_bf16 v[152:155], v[76:79], v[64:67], v[152:155]
    v_max3_f32 v37, v37, v245, v246
    v_max3_f32 v39, v39, -v245, -v246
    v_max3_f32 v37, v37, v247, v248
    v_max3_f32 v39, v39, -v247, -v248
    v_mfma_f32_16x16x32_bf16 v[148:151], v[76:79], v[60:63], v[148:151]
    v_max3_f32 v37, v37, v249, v250
    v_max3_f32 v39, v39, -v249, -v250
    v_max3_f32 v37, v37, v251, v252
    v_max3_f32 v39, v39, -v251, -v252
    v_mfma_f32_16x16x32_bf16 v[144:147], v[76:79], v[56:59], v[144:147]
    v_max3_f32 v37, v37, v253, v254
    v_max3_f32 v39, v39, -v253, -v254
    v_max_f32_e64 v37, v37, v255
    v_max_f32 v39, v39, -v255
    v_permlane32_swap_b32 v36, v38
    s_nop 0
    v_permlane32_swap_b32 v37, v39
    v_max_f32 v36, v36, v38
    v_max_f32_e64 v37, v37, v39
    v_mul_f32 v36, -v36, v34
    v_mul_f32 v37, -v37, v48
    v_mov_b32 v38, v36
    v_mov_b32 v39, v37
    s_nop 0
    v_permlane32_swap_b32 v36, v38
    v_permlane32_swap_b32_e64 v37, v39
    v_pk_fma_f32 v[60:61], v[224:225], v[34:35], v[36:37] op_sel_hi:[1,0,0]
    v_pk_fma_f32 v[62:63], v[226:227], v[34:35], v[36:37] op_sel_hi:[1,0,0]
    v_pk_fma_f32 v[64:65], v[228:229], v[34:35], v[36:37] op_sel_hi:[1,0,0]
    v_pk_fma_f32 v[66:67], v[230:231], v[34:35], v[36:37] op_sel_hi:[1,0,0]
    v_pk_fma_f32 v[68:69], v[232:233], v[34:35], v[36:37] op_sel_hi:[1,0,0]
    v_pk_fma_f32 v[70:71], v[234:235], v[34:35], v[36:37] op_sel_hi:[1,0,0]
    v_pk_fma_f32 v[72:73], v[236:237], v[34:35], v[36:37] op_sel_hi:[1,0,0]
    v_pk_fma_f32 v[74:75], v[238:239], v[34:35], v[36:37] op_sel_hi:[1,0,0]
    v_pk_fma_f32 v[76:77], v[224:225], v[34:35], v[38:39] op_sel_hi:[1,0,0] neg_lo:[1,0,0] neg_hi:[1,0,0]
    v_pk_fma_f32 v[78:79], v[226:227], v[34:35], v[38:39] op_sel_hi:[1,0,0] neg_lo:[1,0,0] neg_hi:[1,0,0]
    v_pk_fma_f32 v[80:81], v[228:229], v[34:35], v[38:39] op_sel_hi:[1,0,0] neg_lo:[1,0,0] neg_hi:[1,0,0]
    v_pk_fma_f32 v[82:83], v[230:231], v[34:35], v[38:39] op_sel_hi:[1,0,0] neg_lo:[1,0,0] neg_hi:[1,0,0]
    v_pk_fma_f32 v[84:85], v[232:233], v[34:35], v[38:39] op_sel_hi:[1,0,0] neg_lo:[1,0,0] neg_hi:[1,0,0]
    v_pk_fma_f32 v[86:87], v[234:235], v[34:35], v[38:39] op_sel_hi:[1,0,0] neg_lo:[1,0,0] neg_hi:[1,0,0]
    v_pk_fma_f32 v[88:89], v[236:237], v[34:35], v[38:39] op_sel_hi:[1,0,0] neg_lo:[1,0,0] neg_hi:[1,0,0]
    v_pk_fma_f32 v[90:91], v[238:239], v[34:35], v[38:39] op_sel_hi:[1,0,0] neg_lo:[1,0,0] neg_hi:[1,0,0]
    v_exp_f32 v60, v60
    v_exp_f32 v61, v61
    v_exp_f32 v62, v62
    v_exp_f32 v63, v63
    v_exp_f32 v64, v64
    v_exp_f32 v65, v65
    v_exp_f32 v66, v66
    v_exp_f32 v67, v67
    v_exp_f32 v68, v68
    v_exp_f32 v69, v69
    v_exp_f32 v70, v70
    v_exp_f32 v71, v71
    v_exp_f32 v72, v72
    v_exp_f32 v73, v73
    v_exp_f32 v74, v74
    v_exp_f32 v75, v75
    v_exp_f32 v76, v76
    v_exp_f32 v77, v77
    v_exp_f32 v78, v78
    v_exp_f32 v79, v79
    v_exp_f32 v80, v80
    v_exp_f32 v81, v81
    v_exp_f32 v82, v82
    v_exp_f32 v83, v83
    v_exp_f32 v84, v84
    v_exp_f32 v85, v85
    v_exp_f32 v86, v86
    v_exp_f32 v87, v87
    v_exp_f32 v88, v88
    v_exp_f32 v89, v89
    v_exp_f32 v90, v90
    v_exp_f32 v91, v91
    v_pk_add_f32 v[40:41], v[60:61], v[62:63]
    v_pk_add_f32 v[42:43], v[76:77], v[78:79]
    v_pk_add_f32 v[40:41], v[40:41], v[64:65]
    v_pk_add_f32 v[42:43], v[42:43], v[80:81]
    v_pk_add_f32 v[40:41], v[40:41], v[66:67]
    v_pk_add_f32 v[42:43], v[42:43], v[82:83]
    v_pk_add_f32 v[40:41], v[40:41], v[68:69]
    v_pk_add_f32 v[42:43], v[42:43], v[84:85]
    v_pk_add_f32 v[40:41], v[40:41], v[70:71]
    v_pk_add_f32 v[42:43], v[42:43], v[86:87]
    v_pk_add_f32 v[40:41], v[40:41], v[72:73]
    v_pk_add_f32 v[42:43], v[42:43], v[88:89]
    v_pk_add_f32 v[40:41], v[40:41], v[74:75]
    v_pk_add_f32 v[42:43], v[42:43], v[90:91]
    v_add_f32 v40, v40, v41
    v_add_f32 v42, v42, v43
    s_nop 1
    v_permlane32_swap_b32 v40, v42
    v_add_f32 v40, v40, v42
    v_rcp_f32 v40, v40
    s_nop 0
    v_mov_b32 v42, v40
    s_nop 1
    v_permlane32_swap_b32 v40, v42
    v_pk_mul_f32 v[60:61], v[60:61], v[40:41] op_sel_hi:[1,0]
    v_pk_mul_f32 v[62:63], v[62:63], v[40:41] op_sel_hi:[1,0]
    v_pk_mul_f32 v[64:65], v[64:65], v[40:41] op_sel_hi:[1,0]
    v_pk_mul_f32 v[66:67], v[66:67], v[40:41] op_sel_hi:[1,0]
    v_cvt_pk_bf16_f32 v160, v60, v61
    v_cvt_pk_bf16_f32 v161, v62, v63
    v_cvt_pk_bf16_f32 v162, v64, v65
    v_cvt_pk_bf16_f32 v163, v66, v67
    v_pk_mul_f32 v[68:69], v[68:69], v[40:41] op_sel_hi:[1,0]
    v_pk_mul_f32 v[70:71], v[70:71], v[40:41] op_sel_hi:[1,0]
    v_pk_mul_f32 v[72:73], v[72:73], v[40:41] op_sel_hi:[1,0]
    v_pk_mul_f32 v[74:75], v[74:75], v[40:41] op_sel_hi:[1,0]
    v_cvt_pk_bf16_f32 v164, v68, v69
    v_cvt_pk_bf16_f32 v165, v70, v71
    v_cvt_pk_bf16_f32 v166, v72, v73
    v_cvt_pk_bf16_f32 v167, v74, v75
    v_pk_mul_f32 v[76:77], v[76:77], v[42:43] op_sel_hi:[1,0]
    v_pk_mul_f32 v[78:79], v[78:79], v[42:43] op_sel_hi:[1,0]
    v_pk_mul_f32 v[80:81], v[80:81], v[42:43] op_sel_hi:[1,0]
    v_pk_mul_f32 v[82:83], v[82:83], v[42:43] op_sel_hi:[1,0]
    v_cvt_pk_bf16_f32 v168, v76, v77
    v_cvt_pk_bf16_f32 v169, v78, v79
    v_cvt_pk_bf16_f32 v170, v80, v81
    v_cvt_pk_bf16_f32 v171, v82, v83
    v_pk_mul_f32 v[84:85], v[84:85], v[42:43] op_sel_hi:[1,0]
    v_pk_mul_f32 v[86:87], v[86:87], v[42:43] op_sel_hi:[1,0]
    v_pk_mul_f32 v[88:89], v[88:89], v[42:43] op_sel_hi:[1,0]
    v_pk_mul_f32 v[90:91], v[90:91], v[42:43] op_sel_hi:[1,0]
    v_cvt_pk_bf16_f32 v172, v84, v85
    v_cvt_pk_bf16_f32 v173, v86, v87
    v_cvt_pk_bf16_f32 v174, v88, v89
    v_cvt_pk_bf16_f32 v175, v90, v91
    v_pk_fma_f32 v[60:61], v[240:241], v[48:49], v[36:37] op_sel:[0,0,1] op_sel_hi:[1,0,1]
    v_pk_fma_f32 v[62:63], v[242:243], v[48:49], v[36:37] op_sel:[0,0,1] op_sel_hi:[1,0,1]
    v_pk_fma_f32 v[64:65], v[244:245], v[48:49], v[36:37] op_sel:[0,0,1] op_sel_hi:[1,0,1]
    v_pk_fma_f32 v[66:67], v[246:247], v[48:49], v[36:37] op_sel:[0,0,1] op_sel_hi:[1,0,1]
    v_pk_fma_f32 v[68:69], v[248:249], v[48:49], v[36:37] op_sel:[0,0,1] op_sel_hi:[1,0,1]
    v_pk_fma_f32 v[70:71], v[250:251], v[48:49], v[36:37] op_sel:[0,0,1] op_sel_hi:[1,0,1]
    v_pk_fma_f32 v[72:73], v[252:253], v[48:49], v[36:37] op_sel:[0,0,1] op_sel_hi:[1,0,1]
    v_pk_fma_f32 v[74:75], v[254:255], v[48:49], v[36:37] op_sel:[0,0,1] op_sel_hi:[1,0,1]
    v_pk_fma_f32 v[76:77], v[240:241], v[48:49], v[38:39] op_sel:[0,0,1] op_sel_hi:[1,0,1] neg_lo:[1,0,0] neg_hi:[1,0,0]
    v_pk_fma_f32 v[78:79], v[242:243], v[48:49], v[38:39] op_sel:[0,0,1] op_sel_hi:[1,0,1] neg_lo:[1,0,0] neg_hi:[1,0,0]
    v_pk_fma_f32 v[80:81], v[244:245], v[48:49], v[38:39] op_sel:[0,0,1] op_sel_hi:[1,0,1] neg_lo:[1,0,0] neg_hi:[1,0,0]
    v_pk_fma_f32 v[82:83], v[246:247], v[48:49], v[38:39] op_sel:[0,0,1] op_sel_hi:[1,0,1] neg_lo:[1,0,0] neg_hi:[1,0,0]
    v_pk_fma_f32 v[84:85], v[248:249], v[48:49], v[38:39] op_sel:[0,0,1] op_sel_hi:[1,0,1] neg_lo:[1,0,0] neg_hi:[1,0,0]
    v_pk_fma_f32 v[86:87], v[250:251], v[48:49], v[38:39] op_sel:[0,0,1] op_sel_hi:[1,0,1] neg_lo:[1,0,0] neg_hi:[1,0,0]
    v_pk_fma_f32 v[88:89], v[252:253], v[48:49], v[38:39] op_sel:[0,0,1] op_sel_hi:[1,0,1] neg_lo:[1,0,0] neg_hi:[1,0,0]
    v_pk_fma_f32 v[90:91], v[254:255], v[48:49], v[38:39] op_sel:[0,0,1] op_sel_hi:[1,0,1] neg_lo:[1,0,0] neg_hi:[1,0,0]
    v_exp_f32 v60, v60
    v_exp_f32 v61, v61
    v_exp_f32 v62, v62
    v_exp_f32 v63, v63
    ds_write_b128 v116, v[192:195] offset:0
    v_exp_f32 v64, v64
    v_exp_f32 v65, v65
    v_exp_f32 v66, v66
    v_exp_f32 v67, v67
    ds_write_b128 v116, v[196:199] offset:2048
    v_exp_f32 v68, v68
    v_exp_f32 v69, v69
    v_exp_f32 v70, v70
    v_exp_f32 v71, v71
    ds_write_b128 v116, v[200:203] offset:4096
    v_exp_f32 v72, v72
    v_exp_f32 v73, v73
    v_exp_f32 v74, v74
    v_exp_f32 v75, v75
    ds_write_b128 v116, v[204:207] offset:6144
    v_exp_f32 v76, v76
    v_exp_f32 v77, v77
    v_exp_f32 v78, v78
    v_exp_f32 v79, v79
    ds_write_b128 v112, v[160:163] offset:0
    v_exp_f32 v80, v80
    v_exp_f32 v81, v81
    v_exp_f32 v82, v82
    v_exp_f32 v83, v83
    ds_write_b128 v113, v[164:167] offset:0
    v_exp_f32 v84, v84
    v_exp_f32 v85, v85
    v_exp_f32 v86, v86
    v_exp_f32 v87, v87
    ds_write_b128 v114, v[168:171] offset:0
    v_exp_f32 v88, v88
    v_exp_f32 v89, v89
    v_exp_f32 v90, v90
    v_exp_f32 v91, v91
    ds_write_b128 v115, v[172:175] offset:0
    v_pk_add_f32 v[40:41], v[60:61], v[62:63]
    v_pk_add_f32 v[42:43], v[76:77], v[78:79]
    v_pk_add_f32 v[40:41], v[40:41], v[64:65]
    v_pk_add_f32 v[42:43], v[42:43], v[80:81]
    v_pk_add_f32 v[40:41], v[40:41], v[66:67]
    v_pk_add_f32 v[42:43], v[42:43], v[82:83]
    v_pk_add_f32 v[40:41], v[40:41], v[68:69]
    v_pk_add_f32 v[42:43], v[42:43], v[84:85]
    v_pk_add_f32 v[40:41], v[40:41], v[70:71]
    v_pk_add_f32 v[42:43], v[42:43], v[86:87]
    v_pk_add_f32 v[40:41], v[40:41], v[72:73]
    v_pk_add_f32 v[42:43], v[42:43], v[88:89]
    v_pk_add_f32 v[40:41], v[40:41], v[74:75]
    v_pk_add_f32 v[42:43], v[42:43], v[90:91]
    v_add_f32 v40, v40, v41
    v_add_f32 v42, v42, v43
    s_nop 1
    v_permlane32_swap_b32 v40, v42
    v_add_f32 v40, v40, v42
    v_rcp_f32 v40, v40
    s_nop 0
    v_mov_b32 v42, v40
    s_nop 1
    v_permlane32_swap_b32 v40, v42
    v_pk_mul_f32 v[60:61], v[60:61], v[40:41] op_sel_hi:[1,0]
    v_pk_mul_f32 v[62:63], v[62:63], v[40:41] op_sel_hi:[1,0]
    v_pk_mul_f32 v[64:65], v[64:65], v[40:41] op_sel_hi:[1,0]
    v_pk_mul_f32 v[66:67], v[66:67], v[40:41] op_sel_hi:[1,0]
    v_cvt_pk_bf16_f32 v176, v60, v61
    v_cvt_pk_bf16_f32 v177, v62, v63
    v_cvt_pk_bf16_f32 v178, v64, v65
    v_cvt_pk_bf16_f32 v179, v66, v67
    ds_write_b128 v112, v[176:179] offset:4096
    v_pk_mul_f32 v[68:69], v[68:69], v[40:41] op_sel_hi:[1,0]
    v_pk_mul_f32 v[70:71], v[70:71], v[40:41] op_sel_hi:[1,0]
    v_pk_mul_f32 v[72:73], v[72:73], v[40:41] op_sel_hi:[1,0]
    v_pk_mul_f32 v[74:75], v[74:75], v[40:41] op_sel_hi:[1,0]
    v_cvt_pk_bf16_f32 v180, v68, v69
    v_cvt_pk_bf16_f32 v181, v70, v71
    v_cvt_pk_bf16_f32 v182, v72, v73
    v_cvt_pk_bf16_f32 v183, v74, v75
    ds_write_b128 v113, v[180:183] offset:4096
    v_pk_mul_f32 v[76:77], v[76:77], v[42:43] op_sel_hi:[1,0]
    v_pk_mul_f32 v[78:79], v[78:79], v[42:43] op_sel_hi:[1,0]
    v_pk_mul_f32 v[80:81], v[80:81], v[42:43] op_sel_hi:[1,0]
    v_pk_mul_f32 v[82:83], v[82:83], v[42:43] op_sel_hi:[1,0]
    v_cvt_pk_bf16_f32 v184, v76, v77
    v_cvt_pk_bf16_f32 v185, v78, v79
    v_cvt_pk_bf16_f32 v186, v80, v81
    v_cvt_pk_bf16_f32 v187, v82, v83
    ds_write_b128 v114, v[184:187] offset:4096
    v_pk_mul_f32 v[84:85], v[84:85], v[42:43] op_sel_hi:[1,0]
    v_pk_mul_f32 v[86:87], v[86:87], v[42:43] op_sel_hi:[1,0]
    v_pk_mul_f32 v[88:89], v[88:89], v[42:43] op_sel_hi:[1,0]
    v_pk_mul_f32 v[90:91], v[90:91], v[42:43] op_sel_hi:[1,0]
    v_cvt_pk_bf16_f32 v188, v84, v85
    v_cvt_pk_bf16_f32 v189, v86, v87
    v_cvt_pk_bf16_f32 v190, v88, v89
    v_cvt_pk_bf16_f32 v191, v90, v91
    ds_write_b128 v115, v[188:191] offset:4096
    s_waitcnt lgkmcnt(0)
    s_barrier
    s_setprio 0
    s_nop 0
    v_mfma_f32_16x16x16_bf16 v[128:131], v[16:17], v[104:105], v[128:131]
    v_mfma_f32_16x16x16_bf16 v[144:147], v[18:19], v[104:105], v[144:147]
    v_mfma_f32_16x16x16_bf16 v[132:135], v[16:17], v[106:107], v[132:135]
    v_mfma_f32_16x16x16_bf16 v[148:151], v[18:19], v[106:107], v[148:151]
    v_mfma_f32_16x16x16_bf16 v[136:139], v[16:17], v[108:109], v[136:139]
    v_mfma_f32_16x16x16_bf16 v[152:155], v[18:19], v[108:109], v[152:155]
    v_mfma_f32_16x16x16_bf16 v[140:143], v[16:17], v[110:111], v[140:143]
    v_mfma_f32_16x16x16_bf16 v[156:159], v[18:19], v[110:111], v[156:159]
    v_lshrrev_b32 v11, 5, v2
    s_lshl_b32 s78, s81, 7
    s_add_u32 s78, s78, 162944
    v_lshl_add_u32 v10, v11, 4, s78
    v_and_b32 v13, 1, v2
    v_cmp_eq_u32 vcc, 1, v13
    v_mov_b32 v13, 162816
    v_and_b32 v12, 31, v2
    v_cndmask_b32 v10, v10, v13, vcc
    v_lshlrev_b32_e64 v12, 4, v12
    v_lshl_add_u32 v11, v11, 10, v12
    v_lshlrev_b32_e64 v14, 4, v2
    v_cvt_pk_bf16_f32 v128, v128, v129
    v_cvt_pk_bf16_f32 v129, v130, v131
    v_cvt_pk_bf16_f32 v130, v144, v145
    v_cvt_pk_bf16_f32 v131, v146, v147
    v_cvt_pk_bf16_f32 v132, v132, v133
    v_cvt_pk_bf16_f32 v133, v134, v135
    v_cvt_pk_bf16_f32 v134, v148, v149
    v_cvt_pk_bf16_f32 v135, v150, v151
    v_cvt_pk_bf16_f32 v136, v136, v137
    v_cvt_pk_bf16_f32 v137, v138, v139
    v_cvt_pk_bf16_f32 v138, v152, v153
    v_cvt_pk_bf16_f32 v139, v154, v155
    v_cvt_pk_bf16_f32 v140, v140, v141
    v_cvt_pk_bf16_f32 v141, v142, v143
    v_cvt_pk_bf16_f32 v142, v156, v157
    v_cvt_pk_bf16_f32 v143, v158, v159
    v_permlane16_swap_b32 v128, v132
    v_permlane16_swap_b32 v129, v133
    v_permlane16_swap_b32 v130, v134
    v_permlane16_swap_b32 v131, v135
    v_permlane16_swap_b32 v136, v140
    v_permlane16_swap_b32 v137, v141
    v_permlane16_swap_b32 v138, v142
    v_permlane16_swap_b32 v139, v143
    v_mfma_f32_32x32x16_bf16 v[224:239], v[96:99], v[128:131], 0
    v_mfma_f32_32x32x16_bf16 v[224:239], v[100:103], v[132:135], v[224:239]
    v_mfma_f32_32x32x16_bf16 v[240:255], v[96:99], v[136:139], 0
    v_mfma_f32_32x32x16_bf16 v[240:255], v[100:103], v[140:143], v[240:255]
    s_lshl_b32 s94, s70, 14
    s_lshl_b32 s79, s81, 13
    s_add_u32 s94, s94, s79
    s_add_u32 s94, s94, 8388608
    s_add_u32 s95, s94, 4096
    s_lshl_b32 s78, s69, 1
    s_add_u32 s78, s78, s80
    s_lshl_b32 s78, s78, 6
    s_lshl_b32 s79, s70, 1
    s_add_u32 s78, s78, s79
    s_add_u32 s78, s78, s81
    s_lshl_b32 s78, s78, 11
    s_add_u32 s96, s78, 4194304
    s_add_u32 s97, s96, 65536
    v_max3_f32 v36, v224, v225, v226
    v_max3_f32 v38, -v224, -v225, -v226
    v_max3_f32 v36, v36, v227, v228
    v_max3_f32 v38, v38, -v227, -v228
    v_max3_f32 v36, v36, v229, v230
    v_max3_f32 v38, v38, -v229, -v230
    v_max3_f32 v36, v36, v231, v232
    v_max3_f32 v38, v38, -v231, -v232
    v_max3_f32 v36, v36, v233, v234
    v_max3_f32 v38, v38, -v233, -v234
    v_max3_f32 v36, v36, v235, v236
    v_max3_f32 v38, v38, -v235, -v236
    v_max3_f32 v36, v36, v237, v238
    v_max3_f32 v38, v38, -v237, -v238
    v_max_f32_e64 v36, v36, v239
    v_max_f32 v38, v38, -v239
    v_max3_f32 v37, v240, v241, v242
    v_max3_f32 v39, -v240, -v241, -v242
    v_max3_f32 v37, v37, v243, v244
    v_max3_f32 v39, v39, -v243, -v244
    v_max3_f32 v37, v37, v245, v246
    v_max3_f32 v39, v39, -v245, -v246
    v_max3_f32 v37, v37, v247, v248
    v_max3_f32 v39, v39, -v247, -v248
    v_max3_f32 v37, v37, v249, v250
    v_max3_f32 v39, v39, -v249, -v250
    v_max3_f32 v37, v37, v251, v252
    v_max3_f32 v39, v39, -v251, -v252
    v_max3_f32 v37, v37, v253, v254
    v_max3_f32 v39, v39, -v253, -v254
    v_max_f32_e64 v37, v37, v255
    v_max_f32 v39, v39, -v255
    v_permlane32_swap_b32 v36, v38
    s_nop 0
    v_permlane32_swap_b32 v37, v39
    v_max_f32 v36, v36, v38
    v_max_f32_e64 v37, v37, v39
    v_mul_f32 v36, -v36, v34
    v_mul_f32 v37, -v37, v48
    v_mov_b32 v38, v36
    v_mov_b32 v39, v37
    s_nop 0
    v_permlane32_swap_b32 v36, v38
    v_permlane32_swap_b32_e64 v37, v39
    v_pk_fma_f32 v[60:61], v[224:225], v[34:35], v[36:37] op_sel_hi:[1,0,0]
    v_pk_fma_f32 v[62:63], v[226:227], v[34:35], v[36:37] op_sel_hi:[1,0,0]
    v_pk_fma_f32 v[64:65], v[228:229], v[34:35], v[36:37] op_sel_hi:[1,0,0]
    v_pk_fma_f32 v[66:67], v[230:231], v[34:35], v[36:37] op_sel_hi:[1,0,0]
    v_pk_fma_f32 v[68:69], v[232:233], v[34:35], v[36:37] op_sel_hi:[1,0,0]
    v_pk_fma_f32 v[70:71], v[234:235], v[34:35], v[36:37] op_sel_hi:[1,0,0]
    v_pk_fma_f32 v[72:73], v[236:237], v[34:35], v[36:37] op_sel_hi:[1,0,0]
    v_pk_fma_f32 v[74:75], v[238:239], v[34:35], v[36:37] op_sel_hi:[1,0,0]
    v_pk_fma_f32 v[76:77], v[224:225], v[34:35], v[38:39] op_sel_hi:[1,0,0] neg_lo:[1,0,0] neg_hi:[1,0,0]
    v_pk_fma_f32 v[78:79], v[226:227], v[34:35], v[38:39] op_sel_hi:[1,0,0] neg_lo:[1,0,0] neg_hi:[1,0,0]
    v_pk_fma_f32 v[80:81], v[228:229], v[34:35], v[38:39] op_sel_hi:[1,0,0] neg_lo:[1,0,0] neg_hi:[1,0,0]
    v_pk_fma_f32 v[82:83], v[230:231], v[34:35], v[38:39] op_sel_hi:[1,0,0] neg_lo:[1,0,0] neg_hi:[1,0,0]
    v_pk_fma_f32 v[84:85], v[232:233], v[34:35], v[38:39] op_sel_hi:[1,0,0] neg_lo:[1,0,0] neg_hi:[1,0,0]
    v_pk_fma_f32 v[86:87], v[234:235], v[34:35], v[38:39] op_sel_hi:[1,0,0] neg_lo:[1,0,0] neg_hi:[1,0,0]
    v_pk_fma_f32 v[88:89], v[236:237], v[34:35], v[38:39] op_sel_hi:[1,0,0] neg_lo:[1,0,0] neg_hi:[1,0,0]
    v_pk_fma_f32 v[90:91], v[238:239], v[34:35], v[38:39] op_sel_hi:[1,0,0] neg_lo:[1,0,0] neg_hi:[1,0,0]
    v_exp_f32 v60, v60
    v_exp_f32 v61, v61
    v_exp_f32 v62, v62
    v_exp_f32 v63, v63
    v_exp_f32 v64, v64
    v_exp_f32 v65, v65
    v_exp_f32 v66, v66
    v_exp_f32 v67, v67
    v_exp_f32 v68, v68
    v_exp_f32 v69, v69
    v_exp_f32 v70, v70
    v_exp_f32 v71, v71
    v_exp_f32 v72, v72
    v_exp_f32 v73, v73
    v_exp_f32 v74, v74
    v_exp_f32 v75, v75
    v_exp_f32 v76, v76
    v_exp_f32 v77, v77
    v_exp_f32 v78, v78
    v_exp_f32 v79, v79
    v_exp_f32 v80, v80
    v_exp_f32 v81, v81
    v_exp_f32 v82, v82
    v_exp_f32 v83, v83
    v_exp_f32 v84, v84
    v_exp_f32 v85, v85
    v_exp_f32 v86, v86
    v_exp_f32 v87, v87
    v_exp_f32 v88, v88
    v_exp_f32 v89, v89
    v_exp_f32 v90, v90
    v_exp_f32 v91, v91
    v_cvt_pk_bf16_f32 v160, v60, v61
    v_cvt_pk_bf16_f32 v161, v62, v63
    v_cvt_pk_bf16_f32 v162, v64, v65
    v_cvt_pk_bf16_f32 v163, v66, v67
    v_cvt_pk_bf16_f32 v164, v68, v69
    v_cvt_pk_bf16_f32 v165, v70, v71
    v_cvt_pk_bf16_f32 v166, v72, v73
    v_cvt_pk_bf16_f32 v167, v74, v75
    v_cvt_pk_bf16_f32 v168, v76, v77
    v_cvt_pk_bf16_f32 v169, v78, v79
    v_cvt_pk_bf16_f32 v170, v80, v81
    v_cvt_pk_bf16_f32 v171, v82, v83
    v_cvt_pk_bf16_f32 v172, v84, v85
    v_cvt_pk_bf16_f32 v173, v86, v87
    v_cvt_pk_bf16_f32 v174, v88, v89
    v_cvt_pk_bf16_f32 v175, v90, v91
    v_pk_fma_f32 v[60:61], v[240:241], v[48:49], v[36:37] op_sel:[0,0,1] op_sel_hi:[1,0,1]
    v_pk_fma_f32 v[62:63], v[242:243], v[48:49], v[36:37] op_sel:[0,0,1] op_sel_hi:[1,0,1]
    v_pk_fma_f32 v[64:65], v[244:245], v[48:49], v[36:37] op_sel:[0,0,1] op_sel_hi:[1,0,1]
    v_pk_fma_f32 v[66:67], v[246:247], v[48:49], v[36:37] op_sel:[0,0,1] op_sel_hi:[1,0,1]
    v_pk_fma_f32 v[68:69], v[248:249], v[48:49], v[36:37] op_sel:[0,0,1] op_sel_hi:[1,0,1]
    v_pk_fma_f32 v[70:71], v[250:251], v[48:49], v[36:37] op_sel:[0,0,1] op_sel_hi:[1,0,1]
    v_pk_fma_f32 v[72:73], v[252:253], v[48:49], v[36:37] op_sel:[0,0,1] op_sel_hi:[1,0,1]
    v_pk_fma_f32 v[74:75], v[254:255], v[48:49], v[36:37] op_sel:[0,0,1] op_sel_hi:[1,0,1]
    v_pk_fma_f32 v[76:77], v[240:241], v[48:49], v[38:39] op_sel:[0,0,1] op_sel_hi:[1,0,1] neg_lo:[1,0,0] neg_hi:[1,0,0]
    v_pk_fma_f32 v[78:79], v[242:243], v[48:49], v[38:39] op_sel:[0,0,1] op_sel_hi:[1,0,1] neg_lo:[1,0,0] neg_hi:[1,0,0]
    v_pk_fma_f32 v[80:81], v[244:245], v[48:49], v[38:39] op_sel:[0,0,1] op_sel_hi:[1,0,1] neg_lo:[1,0,0] neg_hi:[1,0,0]
    v_pk_fma_f32 v[82:83], v[246:247], v[48:49], v[38:39] op_sel:[0,0,1] op_sel_hi:[1,0,1] neg_lo:[1,0,0] neg_hi:[1,0,0]
    v_pk_fma_f32 v[84:85], v[248:249], v[48:49], v[38:39] op_sel:[0,0,1] op_sel_hi:[1,0,1] neg_lo:[1,0,0] neg_hi:[1,0,0]
    v_pk_fma_f32 v[86:87], v[250:251], v[48:49], v[38:39] op_sel:[0,0,1] op_sel_hi:[1,0,1] neg_lo:[1,0,0] neg_hi:[1,0,0]
    v_pk_fma_f32 v[88:89], v[252:253], v[48:49], v[38:39] op_sel:[0,0,1] op_sel_hi:[1,0,1] neg_lo:[1,0,0] neg_hi:[1,0,0]
    v_pk_fma_f32 v[90:91], v[254:255], v[48:49], v[38:39] op_sel:[0,0,1] op_sel_hi:[1,0,1] neg_lo:[1,0,0] neg_hi:[1,0,0]
    v_exp_f32 v60, v60
    v_exp_f32 v61, v61
    v_exp_f32 v62, v62
    v_exp_f32 v63, v63
    v_exp_f32 v64, v64
    v_exp_f32 v65, v65
    v_exp_f32 v66, v66
    v_exp_f32 v67, v67
    v_exp_f32 v68, v68
    v_exp_f32 v69, v69
    v_exp_f32 v70, v70
    v_exp_f32 v71, v71
    v_exp_f32 v72, v72
    v_exp_f32 v73, v73
    v_exp_f32 v74, v74
    v_exp_f32 v75, v75
    v_exp_f32 v76, v76
    v_exp_f32 v77, v77
    v_exp_f32 v78, v78
    v_exp_f32 v79, v79
    v_exp_f32 v80, v80
    v_exp_f32 v81, v81
    v_exp_f32 v82, v82
    v_exp_f32 v83, v83
    v_exp_f32 v84, v84
    v_exp_f32 v85, v85
    v_exp_f32 v86, v86
    v_exp_f32 v87, v87
    v_exp_f32 v88, v88
    v_exp_f32 v89, v89
    v_exp_f32 v90, v90
    v_exp_f32 v91, v91
    v_cvt_pk_bf16_f32 v176, v60, v61
    v_cvt_pk_bf16_f32 v177, v62, v63
    v_cvt_pk_bf16_f32 v178, v64, v65
    v_cvt_pk_bf16_f32 v179, v66, v67
    v_cvt_pk_bf16_f32 v180, v68, v69
    v_cvt_pk_bf16_f32 v181, v70, v71
    v_cvt_pk_bf16_f32 v182, v72, v73
    v_cvt_pk_bf16_f32 v183, v74, v75
    v_cvt_pk_bf16_f32 v184, v76, v77
    v_cvt_pk_bf16_f32 v185, v78, v79
    v_cvt_pk_bf16_f32 v186, v80, v81
    v_cvt_pk_bf16_f32 v187, v82, v83
    v_cvt_pk_bf16_f32 v188, v84, v85
    v_cvt_pk_bf16_f32 v189, v86, v87
    v_cvt_pk_bf16_f32 v190, v88, v89
    v_cvt_pk_bf16_f32 v191, v90, v91
    s_barrier
    s_setprio 1
    ds_read_b128 v[16:19], v10 offset:0
    ds_read_b128 v[20:23], v10 offset:32
    ds_read_b128 v[24:27], v10 offset:64
    ds_read_b128 v[28:31], v10 offset:96
    s_waitcnt lgkmcnt(3)
    v_mfma_f32_32x32x16_bf16 v[224:239], v[16:19], v[160:163], 0
    s_waitcnt lgkmcnt(2)
    v_mfma_f32_32x32x16_bf16 v[224:239], v[20:23], v[164:167], v[224:239]
    s_waitcnt lgkmcnt(1)
    v_mfma_f32_32x32x16_bf16 v[240:255], v[24:27], v[168:171], 0
    s_waitcnt lgkmcnt(0)
    v_mfma_f32_32x32x16_bf16 v[240:255], v[28:31], v[172:175], v[240:255]
    buffer_load_dwordx4 v[96:99], v11, s[36:39], s94 offen offset:0 sc1
    buffer_load_dwordx4 v[100:103], v11, s[36:39], s94 offen offset:2048 sc1
    buffer_load_dwordx4 v[104:107], v11, s[36:39], s95 offen offset:0 sc1
    buffer_load_dwordx4 v[108:111], v11, s[36:39], s95 offen offset:2048 sc1
    v_mfma_f32_32x32x16_bf16 v[192:207], v[16:19], v[176:179], 0
    v_mfma_f32_32x32x16_bf16 v[192:207], v[20:23], v[180:183], v[192:207]
    v_mfma_f32_32x32x16_bf16 v[208:223], v[24:27], v[184:187], 0
    v_mfma_f32_32x32x16_bf16 v[208:223], v[28:31], v[188:191], v[208:223]
    v_rcp_f32 v36, v225
    s_nop 2
    v_rcp_f32_e64 v38, v241
    v_mov_b32 v44, 0x358637bd
    v_fmac_f32 v44, v224, v36
    v_fmac_f32 v44, v240, v38
    v_rcp_f32 v44, v44
    s_nop 0
    v_mul_f32 v36, v36, v44
    v_mul_f32 v38, v38, v44
    v_rcp_f32 v40, v193
    v_rcp_f32 v42, v209
    v_mov_b32 v45, 0x358637bd
    v_fmac_f32 v45, v192, v40
    v_fmac_f32 v45, v208, v42
    v_rcp_f32 v45, v45
    s_nop 0
    v_mul_f32 v40, v40, v45
    v_mul_f32_e64 v42, v42, v45
    s_mov_b32 s85, 0
    s_branch L_kvchk
L_kvspin:
    s_add_u32 s85, s85, 1
    s_cmp_gt_u32 s85, 400000
    s_cbranch_scc1 L_end
    buffer_load_dwordx4 v[96:99], v11, s[36:39], s94 offen offset:0 sc1
    buffer_load_dwordx4 v[100:103], v11, s[36:39], s94 offen offset:2048 sc1
    buffer_load_dwordx4 v[104:107], v11, s[36:39], s95 offen offset:0 sc1
    buffer_load_dwordx4 v[108:111], v11, s[36:39], s95 offen offset:2048 sc1
L_kvchk:
    s_waitcnt vmcnt(0)
    v_mfma_f32_32x32x16_bf16 v[60:75], v[96:99], v[160:163], 0
    v_mfma_f32_32x32x16_bf16 v[60:75], v[100:103], v[164:167], v[60:75]
    v_max3_u32 v13, v96, v97, v98
    v_max3_u32 v10, v99, v100, v101
    v_max3_u32 v13, v13, v102, v103
    v_max3_u32 v10, v10, v104, v105
    v_max3_u32 v13, v13, v106, v107
    v_mfma_f32_32x32x16_bf16 v[76:91], v[104:107], v[168:171], 0
    v_max3_u32 v10, v10, v108, v109
    v_max3_u32 v13, v13, v110, v111
    v_max_u32 v13, v13, v10
    v_cmp_eq_u32_e64 vcc, -1, v13
    s_cbranch_vccnz L_kvspin
    v_mfma_f32_32x32x16_bf16 v[76:91], v[108:111], v[172:175], v[76:91]
    v_mul_f32 v60, v60, v36
    v_mul_f32 v61, v61, v36
    v_mul_f32 v62, v62, v36
    v_mul_f32 v63, v63, v36
    v_mfma_f32_32x32x16_bf16 v[128:143], v[96:99], v[176:179], 0
    v_mul_f32 v64, v64, v36
    v_mul_f32 v65, v65, v36
    v_mul_f32 v66, v66, v36
    v_mul_f32 v67, v67, v36
    v_mfma_f32_32x32x16_bf16 v[128:143], v[100:103], v[180:183], v[128:143]
    v_mul_f32 v68, v68, v36
    v_mul_f32 v69, v69, v36
    v_mul_f32 v70, v70, v36
    v_mul_f32 v71, v71, v36
    v_mfma_f32_32x32x16_bf16 v[144:159], v[104:107], v[184:187], 0
    v_mul_f32 v72, v72, v36
    v_mul_f32 v73, v73, v36
    v_mul_f32 v74, v74, v36
    v_mul_f32 v75, v75, v36
    v_mfma_f32_32x32x16_bf16 v[144:159], v[108:111], v[188:191], v[144:159]
    v_pk_fma_f32 v[60:61], v[76:77], v[38:39], v[60:61] op_sel_hi:[1,0,1]
    v_pk_fma_f32 v[62:63], v[78:79], v[38:39], v[62:63] op_sel_hi:[1,0,1]
    v_pk_fma_f32 v[64:65], v[80:81], v[38:39], v[64:65] op_sel_hi:[1,0,1]
    v_pk_fma_f32 v[66:67], v[82:83], v[38:39], v[66:67] op_sel_hi:[1,0,1]
    v_cvt_pk_bf16_f32 v16, v60, v61
    v_cvt_pk_bf16_f32 v17, v62, v63
    v_cvt_pk_bf16_f32 v18, v64, v65
    v_cvt_pk_bf16_f32 v19, v66, v67
    buffer_store_dwordx4 v[16:19], v14, s[36:39], s96 offen offset:0 sc1
    v_pk_fma_f32 v[68:69], v[84:85], v[38:39], v[68:69] op_sel_hi:[1,0,1]
    v_pk_fma_f32 v[70:71], v[86:87], v[38:39], v[70:71] op_sel_hi:[1,0,1]
    v_pk_fma_f32 v[72:73], v[88:89], v[38:39], v[72:73] op_sel_hi:[1,0,1]
    v_pk_fma_f32 v[74:75], v[90:91], v[38:39], v[74:75] op_sel_hi:[1,0,1]
    v_cvt_pk_bf16_f32 v20, v68, v69
    v_cvt_pk_bf16_f32 v21, v70, v71
    v_cvt_pk_bf16_f32 v22, v72, v73
    v_cvt_pk_bf16_f32 v23, v74, v75
    buffer_store_dwordx4 v[20:23], v14, s[36:39], s96 offen offset:1024 sc1
    v_pk_mul_f32 v[128:129], v[128:129], v[40:41] op_sel_hi:[1,0]
    v_pk_mul_f32 v[130:131], v[130:131], v[40:41] op_sel_hi:[1,0]
    v_pk_mul_f32 v[132:133], v[132:133], v[40:41] op_sel_hi:[1,0]
    v_pk_mul_f32 v[134:135], v[134:135], v[40:41] op_sel_hi:[1,0]
    v_pk_fma_f32 v[128:129], v[144:145], v[42:43], v[128:129] op_sel_hi:[1,0,1]
    v_pk_fma_f32 v[130:131], v[146:147], v[42:43], v[130:131] op_sel_hi:[1,0,1]
    v_pk_fma_f32 v[132:133], v[148:149], v[42:43], v[132:133] op_sel_hi:[1,0,1]
    v_pk_fma_f32 v[134:135], v[150:151], v[42:43], v[134:135] op_sel_hi:[1,0,1]
    v_cvt_pk_bf16_f32 v24, v128, v129
    v_cvt_pk_bf16_f32 v25, v130, v131
    v_cvt_pk_bf16_f32 v26, v132, v133
    v_cvt_pk_bf16_f32 v27, v134, v135
    buffer_store_dwordx4 v[24:27], v14, s[36:39], s97 offen offset:0 sc1
    v_pk_mul_f32 v[136:137], v[136:137], v[40:41] op_sel_hi:[1,0]
    v_pk_mul_f32 v[138:139], v[138:139], v[40:41] op_sel_hi:[1,0]
    v_pk_mul_f32 v[140:141], v[140:141], v[40:41] op_sel_hi:[1,0]
    v_pk_mul_f32 v[142:143], v[142:143], v[40:41] op_sel_hi:[1,0]
    v_pk_fma_f32 v[136:137], v[152:153], v[42:43], v[136:137] op_sel_hi:[1,0,1]
    v_pk_fma_f32 v[138:139], v[154:155], v[42:43], v[138:139] op_sel_hi:[1,0,1]
    v_pk_fma_f32 v[140:141], v[156:157], v[42:43], v[140:141] op_sel_hi:[1,0,1]
    v_pk_fma_f32 v[142:143], v[158:159], v[42:43], v[142:143] op_sel_hi:[1,0,1]
    v_cvt_pk_bf16_f32 v28, v136, v137
    v_cvt_pk_bf16_f32 v29, v138, v139
    v_cvt_pk_bf16_f32 v30, v140, v141
    v_cvt_pk_bf16_f32 v31, v142, v143
    buffer_store_dwordx4 v[28:31], v14, s[36:39], s97 offen offset:1024 sc1
    v_and_b32 v8, 31, v2
    v_lshrrev_b32 v9, 5, v2
    v_lshlrev_b32 v10, 3, v9
    s_lshl_b32 s78, s72, 7
    buffer_load_dwordx2 v[32:33], v10, s[64:67], s78 offen offset:0
    buffer_load_dwordx2 v[34:35], v10, s[64:67], s78 offen offset:16
    buffer_load_dwordx2 v[36:37], v10, s[64:67], s78 offen offset:32
    buffer_load_dwordx2 v[38:39], v10, s[64:67], s78 offen offset:48
    buffer_load_dwordx2 v[40:41], v10, s[64:67], s78 offen offset:64
    buffer_load_dwordx2 v[42:43], v10, s[64:67], s78 offen offset:80
    buffer_load_dwordx2 v[44:45], v10, s[64:67], s78 offen offset:96
    buffer_load_dwordx2 v[46:47], v10, s[64:67], s78 offen offset:112
    buffer_load_dwordx4 v[48:51], v14, s[64:67], 0 offen
    buffer_load_dwordx4 v[52:55], v14, s[64:67], 0 offen offset:1024
    s_barrier
    s_lshl_b32 s78, s76, 12
    s_add_u32 s78, s78, 131072
    v_lshl_add_u32 v6, v8, 7, s78
    v_add_u32_e64 v6, v6, v10
    v_bfe_u32 v11, v8, 1, 3
    v_lshl_add_u32 v6, v11, 4, v6
    v_xor_b32_e64 v112, 0, v6
    ds_read_b64 v[96:97], v112
    v_xor_b32_e64 v113, 16, v6
    ds_read_b64 v[98:99], v113
    v_xor_b32_e64 v114, 32, v6
    ds_read_b64 v[100:101], v114
    v_xor_b32_e64 v115, 48, v6
    ds_read_b64 v[102:103], v115
    v_xor_b32_e64 v116, 64, v6
    ds_read_b64 v[104:105], v116
    v_xor_b32 v117, 80, v6
    ds_read_b64 v[106:107], v117
    v_xor_b32 v118, 96, v6
    ds_read_b64 v[108:109], v118
    v_xor_b32 v119, 112, v6
    ds_read_b64 v[110:111], v119
    v_bfe_u32 v11, v2, 2, 2
    v_lshl_add_u32 v12, v9, 2, v11
    v_lshlrev_b32 v12, 7, v12
    v_lshrrev_b32 v11, 1, v11
    v_lshl_add_u32 v12, v11, 6, v12
    v_bfe_u32 v11, v2, 4, 1
    v_lshl_add_u32 v12, v11, 5, v12
    v_and_b32_e64 v11, 3, v2
    v_lshl_add_u32 v12, v11, 3, v12
    s_lshl_b32 s82, s72, 0
    s_and_b32 s82, s82, 15
    s_lshl_b32 s78, s82, 13
    v_add_u32 v4, s78, v12
    v_xor_b32 v5, 64, v4
    s_lshl_b32 s83, s71, 2
    s_add_u32 s83, s83, s76
    s_lshl_b32 s83, s83, 16
    s_add_u32 s83, s83, 4194304
    s_lshl_b32 s82, s82, 12
    s_add_u32 s88, s82, s83
    s_waitcnt lgkmcnt(0)
    v_lshlrev_b32 v224, 16, v96
    v_and_b32 v225, 0xffff0000, v96
    v_lshlrev_b32_e64 v226, 16, v97
    v_and_b32 v227, 0xffff0000, v97
    v_lshlrev_b32_e64 v228, 16, v98
    v_and_b32 v229, 0xffff0000, v98
    v_lshlrev_b32_e64 v230, 16, v99
    v_and_b32 v231, 0xffff0000, v99
    v_lshlrev_b32_e64 v232, 16, v100
    v_and_b32 v233, 0xffff0000, v100
    v_lshlrev_b32_e64 v234, 16, v101
    v_and_b32 v235, 0xffff0000, v101
    v_lshlrev_b32_e64 v236, 16, v102
    v_and_b32 v237, 0xffff0000, v102
    v_lshlrev_b32_e64 v238, 16, v103
    v_and_b32 v239, 0xffff0000, v103
    v_lshlrev_b32_e64 v240, 16, v104
    v_and_b32 v241, 0xffff0000, v104
    v_lshlrev_b32_e64 v242, 16, v105
    v_and_b32 v243, 0xffff0000, v105
    v_lshlrev_b32_e64 v244, 16, v106
    v_and_b32 v245, 0xffff0000, v106
    v_lshlrev_b32_e64 v246, 16, v107
    v_and_b32 v247, 0xffff0000, v107
    v_lshlrev_b32_e64 v248, 16, v108
    v_and_b32 v249, 0xffff0000, v108
    v_lshlrev_b32_e64 v250, 16, v109
    v_and_b32 v251, 0xffff0000, v109
    v_lshlrev_b32_e64 v252, 16, v110
    v_and_b32 v253, 0xffff0000, v110
    v_lshlrev_b32_e64 v254, 16, v111
    v_and_b32 v255, 0xffff0000, v111
    s_waitcnt vmcnt(0)
    s_barrier
    v_lshlrev_b32_e64 v60, 16, v32
    v_and_b32 v61, 0xffff0000, v32
    v_lshlrev_b32_e64 v62, 16, v33
    v_and_b32 v63, 0xffff0000, v33
    v_lshlrev_b32_e64 v64, 16, v34
    v_and_b32 v65, 0xffff0000, v34
    v_lshlrev_b32_e64 v66, 16, v35
    v_and_b32 v67, 0xffff0000, v35
    v_lshlrev_b32_e64 v68, 16, v36
    v_and_b32 v69, 0xffff0000, v36
    v_lshlrev_b32_e64 v70, 16, v37
    v_and_b32 v71, 0xffff0000, v37
    v_lshlrev_b32_e64 v72, 16, v38
    v_and_b32 v73, 0xffff0000, v38
    v_lshlrev_b32_e64 v74, 16, v39
    v_and_b32 v75, 0xffff0000, v39
    v_lshlrev_b32_e64 v76, 16, v40
    v_and_b32 v77, 0xffff0000, v40
    v_lshlrev_b32_e64 v78, 16, v41
    v_and_b32 v79, 0xffff0000, v41
    v_lshlrev_b32_e64 v80, 16, v42
    v_and_b32 v81, 0xffff0000, v42
    v_lshlrev_b32_e64 v82, 16, v43
    v_and_b32 v83, 0xffff0000, v43
    v_lshlrev_b32_e64 v84, 16, v44
    v_and_b32 v85, 0xffff0000, v44
    v_lshlrev_b32_e64 v86, 16, v45
    v_and_b32 v87, 0xffff0000, v45
    v_lshlrev_b32_e64 v88, 16, v46
    v_and_b32 v89, 0xffff0000, v46
    v_lshlrev_b32_e64 v90, 16, v47
    v_and_b32 v91, 0xffff0000, v47
    s_mov_b32 s78, 0x3f803f80
    v_dot2_f32_bf16 v126, v48, s78, 0
    v_dot2_f32_bf16 v126, v49, s78, v126
    v_dot2_f32_bf16 v126, v50, s78, v126
    v_dot2_f32_bf16 v126, v51, s78, v126
    v_dot2_f32_bf16 v126, v52, s78, v126
    v_dot2_f32_bf16 v126, v53, s78, v126
    v_dot2_f32_bf16 v126, v54, s78, v126
    v_dot2_f32_bf16 v126, v55, s78, v126
    s_nop 2
    v_add_f32_dpp v126, v126, v126 row_ror:8 row_mask:0xf bank_mask:0xf
    s_nop 1
    v_add_f32_dpp v126, v126, v126 row_ror:4 row_mask:0xf bank_mask:0xf
    s_nop 1
    v_add_f32_dpp v126, v126, v126 row_ror:2 row_mask:0xf bank_mask:0xf
    s_nop 1
    v_add_f32_dpp v126, v126, v126 row_ror:1 row_mask:0xf bank_mask:0xf
    v_mov_b32 v127, v126
    s_nop 1
    v_permlane32_swap_b32 v126, v127
    v_add_f32 v126, v126, v127
    v_mov_b32 v127, v126
    s_nop 1
    v_permlane16_swap_b32 v126, v127
    v_add_f32 v126, v126, v127
    v_lshlrev_b32_e64 v12, 4, v8
    v_lshl_add_u32 v12, v9, 14, v12
    s_lshl_b32 s94, s71, 15
    s_lshl_b32 s79, s76, 9
    s_add_u32 s94, s94, s79
    s_add_u32 s94, s94, 1572864
    s_lshl_b32 s95, s72, 11
    s_add_u32 s95, s95, s94
    s_lshl_b32 s78, s76, 5
    v_add_u32 v11, s78, v8
    v_and_b32 v13, 7, v8
    v_xor_b32 v13, v13, v9
    v_lshlrev_b32 v13, 4, v13
    v_lshl_add_u32 v13, v11, 8, v13
    v_lshlrev_b32_e64 v10, 3, v11
    v_add_u32 v10, 159744, v10
    s_lshl_b32 s78, s71, 7
    v_add_u32 v11, s78, v11
    v_mov_b32 v15, 163584
    ds_read_b32 v15, v15
    s_waitcnt lgkmcnt(0)
    v_readfirstlane_b32 s99, v15
    s_mov_b32 s84, 0
    s_barrier
    buffer_load_dwordx4 v[160:163], v14, s[36:39], s88 offen offset:0 sc1
    ds_read_b64_tr_b16 v[128:129], v4 offset:0
    buffer_load_dwordx4 v[164:167], v14, s[36:39], s88 offen offset:1024 sc1
    ds_read_b64_tr_b16 v[130:131], v4 offset:1024
    buffer_load_dwordx4 v[168:171], v14, s[36:39], s88 offen offset:2048 sc1
    ds_read_b64_tr_b16 v[132:133], v5 offset:0
    buffer_load_dwordx4 v[172:175], v14, s[36:39], s88 offen offset:3072 sc1
    s_add_u32 s82, s82, 4096
    s_and_b32 s82, s82, 0xffff
    s_add_u32 s88, s82, s83
    s_nop 0
    ds_read_b64_tr_b16 v[134:135], v5 offset:1024
    buffer_load_dwordx4 v[176:179], v14, s[36:39], s88 offen offset:0 sc1
    ds_read_b64_tr_b16 v[136:137], v4 offset:2048
    buffer_load_dwordx4 v[180:183], v14, s[36:39], s88 offen offset:1024 sc1
    ds_read_b64_tr_b16 v[138:139], v4 offset:3072
    buffer_load_dwordx4 v[184:187], v14, s[36:39], s88 offen offset:2048 sc1
    ds_read_b64_tr_b16 v[140:141], v5 offset:2048
    buffer_load_dwordx4 v[188:191], v14, s[36:39], s88 offen offset:3072 sc1
    s_add_u32 s82, s82, 4096
    s_and_b32 s82, s82, 0xffff
    s_add_u32 s88, s82, s83
    s_nop 0
    ds_read_b64_tr_b16 v[142:143], v5 offset:3072
    buffer_load_dwordx4 v[192:195], v14, s[36:39], s88 offen offset:0 sc1
    buffer_load_dwordx4 v[196:199], v14, s[36:39], s88 offen offset:1024 sc1
    buffer_load_dwordx4 v[200:203], v14, s[36:39], s88 offen offset:2048 sc1
    buffer_load_dwordx4 v[204:207], v14, s[36:39], s88 offen offset:3072 sc1
    s_add_u32 s82, s82, 4096
    s_and_b32 s82, s82, 0xffff
    s_add_u32 s88, s82, s83
    buffer_load_dwordx4 v[208:211], v14, s[36:39], s88 offen offset:0 sc1
    buffer_load_dwordx4 v[212:215], v14, s[36:39], s88 offen offset:1024 sc1
    .p2align 3
L_G2:
    s_add_u32 s84, s84, 1
    s_waitcnt vmcnt(12) lgkmcnt(6)
    v_mfma_f32_32x32x16_bf16 v[224:239], v[128:131], v[160:163], v[224:239]
    ds_read_b64_tr_b16 v[144:145], v4 offset:4096
    ds_read_b64_tr_b16 v[146:147], v4 offset:5120
    buffer_load_dwordx4 v[216:219], v14, s[36:39], s88 offen offset:2048 sc1
    s_waitcnt lgkmcnt(6)
    v_mfma_f32_32x32x16_bf16 v[240:255], v[132:135], v[160:163], v[240:255]
    ds_read_b64_tr_b16 v[148:149], v5 offset:4096
    ds_read_b64_tr_b16 v[150:151], v5 offset:5120
    s_waitcnt lgkmcnt(6)
    v_mfma_f32_32x32x16_bf16 v[224:239], v[136:139], v[164:167], v[224:239]
    ds_read_b64_tr_b16 v[152:153], v4 offset:6144
    ds_read_b64_tr_b16 v[154:155], v4 offset:7168
    buffer_load_dwordx4 v[220:223], v14, s[36:39], s88 offen offset:3072 sc1
    s_add_u32 s82, s82, 4096
    s_and_b32 s82, s82, 0xffff
    s_add_u32 s88, s82, s83
    s_waitcnt lgkmcnt(6)
    v_mfma_f32_32x32x16_bf16 v[240:255], v[140:143], v[164:167], v[240:255]
    ds_read_b64_tr_b16 v[156:157], v5 offset:6144
    ds_read_b64_tr_b16 v[158:159], v5 offset:7168
    v_add_u32 v4, 0x2000, v4
    v_and_b32 v4, 0x1ffff, v4
    v_xor_b32 v5, 64, v4
    s_waitcnt vmcnt(12) lgkmcnt(6)
    v_mfma_f32_32x32x16_bf16 v[224:239], v[144:147], v[168:171], v[224:239]
    ds_read_b64_tr_b16 v[128:129], v4 offset:0
    ds_read_b64_tr_b16 v[130:131], v4 offset:1024
    buffer_load_dwordx4 v[160:163], v14, s[36:39], s88 offen offset:0 sc1
    s_waitcnt lgkmcnt(6)
    v_mfma_f32_32x32x16_bf16 v[240:255], v[148:151], v[168:171], v[240:255]
    ds_read_b64_tr_b16 v[132:133], v5 offset:0
    ds_read_b64_tr_b16 v[134:135], v5 offset:1024
    s_waitcnt lgkmcnt(6)
    v_mfma_f32_32x32x16_bf16 v[224:239], v[152:155], v[172:175], v[224:239]
    ds_read_b64_tr_b16 v[136:137], v4 offset:2048
    ds_read_b64_tr_b16 v[138:139], v4 offset:3072
    buffer_load_dwordx4 v[164:167], v14, s[36:39], s88 offen offset:1024 sc1
    s_waitcnt lgkmcnt(6)
    v_mfma_f32_32x32x16_bf16 v[240:255], v[156:159], v[172:175], v[240:255]
    ds_read_b64_tr_b16 v[140:141], v5 offset:2048
    ds_read_b64_tr_b16 v[142:143], v5 offset:3072
    s_waitcnt vmcnt(12) lgkmcnt(6)
    v_mfma_f32_32x32x16_bf16 v[224:239], v[128:131], v[176:179], v[224:239]
    ds_read_b64_tr_b16 v[144:145], v4 offset:4096
    ds_read_b64_tr_b16 v[146:147], v4 offset:5120
    buffer_load_dwordx4 v[168:171], v14, s[36:39], s88 offen offset:2048 sc1
    s_waitcnt lgkmcnt(6)
    v_mfma_f32_32x32x16_bf16 v[240:255], v[132:135], v[176:179], v[240:255]
    ds_read_b64_tr_b16 v[148:149], v5 offset:4096
    ds_read_b64_tr_b16 v[150:151], v5 offset:5120
    s_waitcnt lgkmcnt(6)
    v_mfma_f32_32x32x16_bf16 v[224:239], v[136:139], v[180:183], v[224:239]
    ds_read_b64_tr_b16 v[152:153], v4 offset:6144
    ds_read_b64_tr_b16 v[154:155], v4 offset:7168
    buffer_load_dwordx4 v[172:175], v14, s[36:39], s88 offen offset:3072 sc1
    s_add_u32 s82, s82, 4096
    s_and_b32 s82, s82, 0xffff
    s_add_u32 s88, s82, s83
    s_waitcnt lgkmcnt(6)
    v_mfma_f32_32x32x16_bf16 v[240:255], v[140:143], v[180:183], v[240:255]
    ds_read_b64_tr_b16 v[156:157], v5 offset:6144
    ds_read_b64_tr_b16 v[158:159], v5 offset:7168
    v_add_u32 v4, 0x2000, v4
    v_and_b32 v4, 0x1ffff, v4
    v_xor_b32 v5, 64, v4
    s_waitcnt vmcnt(12) lgkmcnt(6)
    v_mfma_f32_32x32x16_bf16 v[224:239], v[144:147], v[184:187], v[224:239]
    ds_read_b64_tr_b16 v[128:129], v4 offset:0
    ds_read_b64_tr_b16 v[130:131], v4 offset:1024
    buffer_load_dwordx4 v[176:179], v14, s[36:39], s88 offen offset:0 sc1
    s_waitcnt lgkmcnt(6)
    v_mfma_f32_32x32x16_bf16 v[240:255], v[148:151], v[184:187], v[240:255]
    ds_read_b64_tr_b16 v[132:133], v5 offset:0
    ds_read_b64_tr_b16 v[134:135], v5 offset:1024
    s_waitcnt lgkmcnt(6)
    v_mfma_f32_32x32x16_bf16 v[224:239], v[152:155], v[188:191], v[224:239]
    ds_read_b64_tr_b16 v[136:137], v4 offset:2048
    ds_read_b64_tr_b16 v[138:139], v4 offset:3072
    buffer_load_dwordx4 v[180:183], v14, s[36:39], s88 offen offset:1024 sc1
    s_waitcnt lgkmcnt(6)
    v_mfma_f32_32x32x16_bf16 v[240:255], v[156:159], v[188:191], v[240:255]
    ds_read_b64_tr_b16 v[140:141], v5 offset:2048
    ds_read_b64_tr_b16 v[142:143], v5 offset:3072
    s_waitcnt vmcnt(12) lgkmcnt(6)
    v_mfma_f32_32x32x16_bf16 v[224:239], v[128:131], v[192:195], v[224:239]
    ds_read_b64_tr_b16 v[144:145], v4 offset:4096
    ds_read_b64_tr_b16 v[146:147], v4 offset:5120
    buffer_load_dwordx4 v[184:187], v14, s[36:39], s88 offen offset:2048 sc1
    s_waitcnt lgkmcnt(6)
    v_mfma_f32_32x32x16_bf16 v[240:255], v[132:135], v[192:195], v[240:255]
    ds_read_b64_tr_b16 v[148:149], v5 offset:4096
    ds_read_b64_tr_b16 v[150:151], v5 offset:5120
    s_waitcnt lgkmcnt(6)
    v_mfma_f32_32x32x16_bf16 v[224:239], v[136:139], v[196:199], v[224:239]
    ds_read_b64_tr_b16 v[152:153], v4 offset:6144
    ds_read_b64_tr_b16 v[154:155], v4 offset:7168
    buffer_load_dwordx4 v[188:191], v14, s[36:39], s88 offen offset:3072 sc1
    s_add_u32 s82, s82, 4096
    s_and_b32 s82, s82, 0xffff
    s_add_u32 s88, s82, s83
    s_waitcnt lgkmcnt(6)
    v_mfma_f32_32x32x16_bf16 v[240:255], v[140:143], v[196:199], v[240:255]
    ds_read_b64_tr_b16 v[156:157], v5 offset:6144
    ds_read_b64_tr_b16 v[158:159], v5 offset:7168
    v_add_u32 v4, 0x2000, v4
    v_and_b32 v4, 0x1ffff, v4
    v_xor_b32 v5, 64, v4
    s_waitcnt vmcnt(12) lgkmcnt(6)
    v_mfma_f32_32x32x16_bf16 v[224:239], v[144:147], v[200:203], v[224:239]
    ds_read_b64_tr_b16 v[128:129], v4 offset:0
    ds_read_b64_tr_b16 v[130:131], v4 offset:1024
    buffer_load_dwordx4 v[192:195], v14, s[36:39], s88 offen offset:0 sc1
    s_waitcnt lgkmcnt(6)
    v_mfma_f32_32x32x16_bf16 v[240:255], v[148:151], v[200:203], v[240:255]
    ds_read_b64_tr_b16 v[132:133], v5 offset:0
    ds_read_b64_tr_b16 v[134:135], v5 offset:1024
    s_waitcnt lgkmcnt(6)
    v_mfma_f32_32x32x16_bf16 v[224:239], v[152:155], v[204:207], v[224:239]
    ds_read_b64_tr_b16 v[136:137], v4 offset:2048
    ds_read_b64_tr_b16 v[138:139], v4 offset:3072
    buffer_load_dwordx4 v[196:199], v14, s[36:39], s88 offen offset:1024 sc1
    s_waitcnt lgkmcnt(6)
    v_mfma_f32_32x32x16_bf16 v[240:255], v[156:159], v[204:207], v[240:255]
    ds_read_b64_tr_b16 v[140:141], v5 offset:2048
    ds_read_b64_tr_b16 v[142:143], v5 offset:3072
    s_waitcnt vmcnt(12) lgkmcnt(6)
    v_mfma_f32_32x32x16_bf16 v[224:239], v[128:131], v[208:211], v[224:239]
    ds_read_b64_tr_b16 v[144:145], v4 offset:4096
    ds_read_b64_tr_b16 v[146:147], v4 offset:5120
    buffer_load_dwordx4 v[200:203], v14, s[36:39], s88 offen offset:2048 sc1
    s_waitcnt lgkmcnt(6)
    v_mfma_f32_32x32x16_bf16 v[240:255], v[132:135], v[208:211], v[240:255]
    ds_read_b64_tr_b16 v[148:149], v5 offset:4096
    ds_read_b64_tr_b16 v[150:151], v5 offset:5120
    s_waitcnt lgkmcnt(6)
    v_mfma_f32_32x32x16_bf16 v[224:239], v[136:139], v[212:215], v[224:239]
    ds_read_b64_tr_b16 v[152:153], v4 offset:6144
    ds_read_b64_tr_b16 v[154:155], v4 offset:7168
    buffer_load_dwordx4 v[204:207], v14, s[36:39], s88 offen offset:3072 sc1
    s_add_u32 s82, s82, 4096
    s_and_b32 s82, s82, 0xffff
    s_add_u32 s88, s82, s83
    s_waitcnt lgkmcnt(6)
    v_mfma_f32_32x32x16_bf16 v[240:255], v[140:143], v[212:215], v[240:255]
    ds_read_b64_tr_b16 v[156:157], v5 offset:6144
    ds_read_b64_tr_b16 v[158:159], v5 offset:7168
    v_add_u32 v4, 0x2000, v4
    v_and_b32 v4, 0x1ffff, v4
    v_xor_b32 v5, 64, v4
    s_waitcnt vmcnt(12) lgkmcnt(6)
    v_mfma_f32_32x32x16_bf16 v[224:239], v[144:147], v[216:219], v[224:239]
    ds_read_b64_tr_b16 v[128:129], v4 offset:0
    ds_read_b64_tr_b16 v[130:131], v4 offset:1024
    buffer_load_dwordx4 v[208:211], v14, s[36:39], s88 offen offset:0 sc1
    s_waitcnt lgkmcnt(6)
    v_mfma_f32_32x32x16_bf16 v[240:255], v[148:151], v[216:219], v[240:255]
    ds_read_b64_tr_b16 v[132:133], v5 offset:0
    ds_read_b64_tr_b16 v[134:135], v5 offset:1024
    s_waitcnt lgkmcnt(6)
    v_mfma_f32_32x32x16_bf16 v[224:239], v[152:155], v[220:223], v[224:239]
    ds_read_b64_tr_b16 v[136:137], v4 offset:2048
    ds_read_b64_tr_b16 v[138:139], v4 offset:3072
    buffer_load_dwordx4 v[212:215], v14, s[36:39], s88 offen offset:1024 sc1
    s_waitcnt lgkmcnt(6)
    v_mfma_f32_32x32x16_bf16 v[240:255], v[156:159], v[220:223], v[240:255]
    ds_read_b64_tr_b16 v[140:141], v5 offset:2048
    ds_read_b64_tr_b16 v[142:143], v5 offset:3072
    s_cmp_lt_u32 s84, 3
    s_cbranch_scc1 L_G2
    s_waitcnt vmcnt(12) lgkmcnt(6)
    v_mfma_f32_32x32x16_bf16 v[224:239], v[128:131], v[160:163], v[224:239]
    ds_read_b64_tr_b16 v[144:145], v4 offset:4096
    ds_read_b64_tr_b16 v[146:147], v4 offset:5120
    buffer_load_dwordx4 v[216:219], v14, s[36:39], s88 offen offset:2048 sc1
    s_waitcnt lgkmcnt(6)
    v_mfma_f32_32x32x16_bf16 v[240:255], v[132:135], v[160:163], v[240:255]
    ds_read_b64_tr_b16 v[148:149], v5 offset:4096
    ds_read_b64_tr_b16 v[150:151], v5 offset:5120
    s_waitcnt lgkmcnt(6)
    v_mfma_f32_32x32x16_bf16 v[224:239], v[136:139], v[164:167], v[224:239]
    ds_read_b64_tr_b16 v[152:153], v4 offset:6144
    ds_read_b64_tr_b16 v[154:155], v4 offset:7168
    buffer_load_dwordx4 v[220:223], v14, s[36:39], s88 offen offset:3072 sc1
    s_add_u32 s82, s82, 4096
    s_and_b32 s82, s82, 0xffff
    s_add_u32 s88, s82, s83
    s_waitcnt lgkmcnt(6)
    v_mfma_f32_32x32x16_bf16 v[240:255], v[140:143], v[164:167], v[240:255]
    ds_read_b64_tr_b16 v[156:157], v5 offset:6144
    ds_read_b64_tr_b16 v[158:159], v5 offset:7168
    s_barrier
    v_add_u32 v4, 0x2000, v4
    v_and_b32 v4, 0x1ffff, v4
    v_xor_b32_e64 v5, 64, v4
    s_waitcnt vmcnt(12) lgkmcnt(6)
    v_mfma_f32_32x32x16_bf16 v[224:239], v[144:147], v[168:171], v[224:239]
    ds_read_b64_tr_b16 v[128:129], v4 offset:0
    ds_read_b64_tr_b16 v[130:131], v4 offset:1024
    s_waitcnt lgkmcnt(6)
    v_mfma_f32_32x32x16_bf16 v[240:255], v[148:151], v[168:171], v[240:255]
    ds_read_b64_tr_b16 v[132:133], v5 offset:0
    ds_read_b64_tr_b16 v[134:135], v5 offset:1024
    s_waitcnt lgkmcnt(6)
    v_mfma_f32_32x32x16_bf16 v[224:239], v[152:155], v[172:175], v[224:239]
    ds_read_b64_tr_b16 v[136:137], v4 offset:2048
    ds_read_b64_tr_b16 v[138:139], v4 offset:3072
    s_waitcnt lgkmcnt(6)
    v_mfma_f32_32x32x16_bf16 v[240:255], v[156:159], v[172:175], v[240:255]
    ds_read_b64_tr_b16 v[140:141], v5 offset:2048
    ds_read_b64_tr_b16 v[142:143], v5 offset:3072
    s_waitcnt vmcnt(10) lgkmcnt(6)
    v_mfma_f32_32x32x16_bf16 v[224:239], v[128:131], v[176:179], v[224:239]
    ds_read_b64_tr_b16 v[144:145], v4 offset:4096
    ds_read_b64_tr_b16 v[146:147], v4 offset:5120
    s_waitcnt lgkmcnt(6)
    v_mfma_f32_32x32x16_bf16 v[240:255], v[132:135], v[176:179], v[240:255]
    ds_read_b64_tr_b16 v[148:149], v5 offset:4096
    ds_read_b64_tr_b16 v[150:151], v5 offset:5120
    s_waitcnt lgkmcnt(6)
    v_mfma_f32_32x32x16_bf16 v[224:239], v[136:139], v[180:183], v[224:239]
    ds_read_b64_tr_b16 v[152:153], v4 offset:6144
    ds_read_b64_tr_b16 v[154:155], v4 offset:7168
    s_waitcnt lgkmcnt(6)
    v_mfma_f32_32x32x16_bf16 v[240:255], v[140:143], v[180:183], v[240:255]
    ds_read_b64_tr_b16 v[156:157], v5 offset:6144
    ds_read_b64_tr_b16 v[158:159], v5 offset:7168
    v_add_u32 v4, 0x2000, v4
    v_and_b32 v4, 0x1ffff, v4
    v_xor_b32_e64 v5, 64, v4
    s_waitcnt vmcnt(8) lgkmcnt(6)
    v_mfma_f32_32x32x16_bf16 v[224:239], v[144:147], v[184:187], v[224:239]
    ds_read_b64_tr_b16 v[128:129], v4 offset:0
    ds_read_b64_tr_b16 v[130:131], v4 offset:1024
    s_waitcnt lgkmcnt(6)
    v_mfma_f32_32x32x16_bf16 v[240:255], v[148:151], v[184:187], v[240:255]
    ds_read_b64_tr_b16 v[132:133], v5 offset:0
    ds_read_b64_tr_b16 v[134:135], v5 offset:1024
    s_waitcnt lgkmcnt(6)
    v_mfma_f32_32x32x16_bf16 v[224:239], v[152:155], v[188:191], v[224:239]
    ds_read_b64_tr_b16 v[136:137], v4 offset:2048
    ds_read_b64_tr_b16 v[138:139], v4 offset:3072
    s_waitcnt lgkmcnt(6)
    v_mfma_f32_32x32x16_bf16 v[240:255], v[156:159], v[188:191], v[240:255]
    ds_read_b64_tr_b16 v[140:141], v5 offset:2048
    ds_read_b64_tr_b16 v[142:143], v5 offset:3072
    s_waitcnt vmcnt(6) lgkmcnt(6)
    v_mfma_f32_32x32x16_bf16 v[224:239], v[128:131], v[192:195], v[224:239]
    ds_read_b64_tr_b16 v[144:145], v4 offset:4096
    ds_read_b64_tr_b16 v[146:147], v4 offset:5120
    s_waitcnt lgkmcnt(6)
    v_mfma_f32_32x32x16_bf16 v[240:255], v[132:135], v[192:195], v[240:255]
    ds_read_b64_tr_b16 v[148:149], v5 offset:4096
    ds_read_b64_tr_b16 v[150:151], v5 offset:5120
    s_waitcnt lgkmcnt(6)
    v_mfma_f32_32x32x16_bf16 v[224:239], v[136:139], v[196:199], v[224:239]
    ds_read_b64_tr_b16 v[152:153], v4 offset:6144
    ds_read_b64_tr_b16 v[154:155], v4 offset:7168
    s_waitcnt lgkmcnt(6)
    v_mfma_f32_32x32x16_bf16 v[240:255], v[140:143], v[196:199], v[240:255]
    ds_read_b64_tr_b16 v[156:157], v5 offset:6144
    ds_read_b64_tr_b16 v[158:159], v5 offset:7168
    v_add_u32 v4, 0x2000, v4
    v_and_b32 v4, 0x1ffff, v4
    v_xor_b32_e64 v5, 64, v4
    s_waitcnt vmcnt(4) lgkmcnt(6)
    v_mfma_f32_32x32x16_bf16 v[224:239], v[144:147], v[200:203], v[224:239]
    ds_read_b64_tr_b16 v[128:129], v4 offset:0
    ds_read_b64_tr_b16 v[130:131], v4 offset:1024
    s_waitcnt lgkmcnt(6)
    v_mfma_f32_32x32x16_bf16 v[240:255], v[148:151], v[200:203], v[240:255]
    ds_read_b64_tr_b16 v[132:133], v5 offset:0
    ds_read_b64_tr_b16 v[134:135], v5 offset:1024
    s_waitcnt lgkmcnt(6)
    v_mfma_f32_32x32x16_bf16 v[224:239], v[152:155], v[204:207], v[224:239]
    ds_read_b64_tr_b16 v[136:137], v4 offset:2048
    ds_read_b64_tr_b16 v[138:139], v4 offset:3072
    s_waitcnt lgkmcnt(6)
    v_mfma_f32_32x32x16_bf16 v[240:255], v[156:159], v[204:207], v[240:255]
    ds_read_b64_tr_b16 v[140:141], v5 offset:2048
    ds_read_b64_tr_b16 v[142:143], v5 offset:3072
    s_waitcnt vmcnt(2) lgkmcnt(6)
    v_mfma_f32_32x32x16_bf16 v[224:239], v[128:131], v[208:211], v[224:239]
    ds_read_b64_tr_b16 v[144:145], v4 offset:4096
    ds_read_b64_tr_b16 v[146:147], v4 offset:5120
    s_waitcnt lgkmcnt(6)
    v_mfma_f32_32x32x16_bf16 v[240:255], v[132:135], v[208:211], v[240:255]
    ds_read_b64_tr_b16 v[148:149], v5 offset:4096
    ds_read_b64_tr_b16 v[150:151], v5 offset:5120
    s_waitcnt lgkmcnt(6)
    v_mfma_f32_32x32x16_bf16 v[224:239], v[136:139], v[212:215], v[224:239]
    ds_read_b64_tr_b16 v[152:153], v4 offset:6144
    ds_read_b64_tr_b16 v[154:155], v4 offset:7168
    s_waitcnt lgkmcnt(6)
    v_mfma_f32_32x32x16_bf16 v[240:255], v[140:143], v[212:215], v[240:255]
    ds_read_b64_tr_b16 v[156:157], v5 offset:6144
    ds_read_b64_tr_b16 v[158:159], v5 offset:7168
    s_waitcnt vmcnt(0) lgkmcnt(6)
    v_mfma_f32_32x32x16_bf16 v[224:239], v[144:147], v[216:219], v[224:239]
    s_waitcnt lgkmcnt(4)
    v_mfma_f32_32x32x16_bf16 v[240:255], v[148:151], v[216:219], v[240:255]
    s_waitcnt lgkmcnt(2)
    v_mfma_f32_32x32x16_bf16 v[224:239], v[152:155], v[220:223], v[224:239]
    s_waitcnt lgkmcnt(0)
    v_mfma_f32_32x32x16_bf16 v[240:255], v[156:159], v[220:223], v[240:255]
    s_nop 9
    v_pk_mul_f32 v[18:19], v[224:225], v[224:225]
    v_pk_mul_f32 v[20:21], v[224:225], v[60:61]
    v_pk_add_f32 v[16:17], v[224:225], v[226:227]
    v_pk_fma_f32 v[18:19], v[226:227], v[226:227], v[18:19]
    v_pk_fma_f32 v[20:21], v[226:227], v[62:63], v[20:21]
    v_pk_add_f32 v[16:17], v[16:17], v[228:229]
    v_pk_fma_f32 v[18:19], v[228:229], v[228:229], v[18:19]
    v_pk_fma_f32 v[20:21], v[228:229], v[64:65], v[20:21]
    v_pk_add_f32 v[16:17], v[16:17], v[230:231]
    v_pk_fma_f32 v[18:19], v[230:231], v[230:231], v[18:19]
    v_pk_fma_f32 v[20:21], v[230:231], v[66:67], v[20:21]
    v_pk_add_f32 v[16:17], v[16:17], v[232:233]
    v_pk_fma_f32 v[18:19], v[232:233], v[232:233], v[18:19]
    v_pk_fma_f32 v[20:21], v[232:233], v[68:69], v[20:21]
    v_pk_add_f32 v[16:17], v[16:17], v[234:235]
    v_pk_fma_f32 v[18:19], v[234:235], v[234:235], v[18:19]
    v_pk_fma_f32 v[20:21], v[234:235], v[70:71], v[20:21]
    v_pk_add_f32 v[16:17], v[16:17], v[236:237]
    v_pk_fma_f32 v[18:19], v[236:237], v[236:237], v[18:19]
    v_pk_fma_f32 v[20:21], v[236:237], v[72:73], v[20:21]
    v_pk_add_f32 v[16:17], v[16:17], v[238:239]
    v_pk_fma_f32 v[18:19], v[238:239], v[238:239], v[18:19]
    v_pk_fma_f32 v[20:21], v[238:239], v[74:75], v[20:21]
    v_pk_add_f32 v[16:17], v[16:17], v[240:241]
    v_pk_fma_f32 v[18:19], v[240:241], v[240:241], v[18:19]
    v_pk_fma_f32 v[20:21], v[240:241], v[76:77], v[20:21]
    v_pk_add_f32 v[16:17], v[16:17], v[242:243]
    v_pk_fma_f32 v[18:19], v[242:243], v[242:243], v[18:19]
    v_pk_fma_f32 v[20:21], v[242:243], v[78:79], v[20:21]
    v_pk_add_f32 v[16:17], v[16:17], v[244:245]
    v_pk_fma_f32 v[18:19], v[244:245], v[244:245], v[18:19]
    v_pk_fma_f32 v[20:21], v[244:245], v[80:81], v[20:21]
    v_pk_add_f32 v[16:17], v[16:17], v[246:247]
    v_pk_fma_f32 v[18:19], v[246:247], v[246:247], v[18:19]
    v_pk_fma_f32 v[20:21], v[246:247], v[82:83], v[20:21]
    v_pk_add_f32 v[16:17], v[16:17], v[248:249]
    v_pk_fma_f32 v[18:19], v[248:249], v[248:249], v[18:19]
    v_pk_fma_f32 v[20:21], v[248:249], v[84:85], v[20:21]
    v_pk_add_f32 v[16:17], v[16:17], v[250:251]
    v_pk_fma_f32 v[18:19], v[250:251], v[250:251], v[18:19]
    v_pk_fma_f32 v[20:21], v[250:251], v[86:87], v[20:21]
    v_pk_add_f32 v[16:17], v[16:17], v[252:253]
    v_pk_fma_f32 v[18:19], v[252:253], v[252:253], v[18:19]
    v_pk_fma_f32 v[20:21], v[252:253], v[88:89], v[20:21]
    v_pk_add_f32 v[16:17], v[16:17], v[254:255]
    v_pk_fma_f32 v[18:19], v[254:255], v[254:255], v[18:19]
    v_pk_fma_f32 v[20:21], v[254:255], v[90:91], v[20:21]
    v_mov_b32 v27, s75
    v_add_f32 v24, v16, v17
    v_add_f32 v25, v18, v19
    v_add_f32 v26, v20, v21
    v_mov_b32 v28, v24
    v_mov_b32 v29, v25
    v_mov_b32 v30, v26
    v_permlane32_swap_b32 v24, v28
    v_permlane32_swap_b32 v25, v29
    v_permlane32_swap_b32 v26, v30
    v_pk_add_f32 v[24:25], v[24:25], v[28:29]
    v_add_f32 v26, v26, v30
    s_mov_b32 exec_hi, 0
    s_bitcmp1_b32 s99, 1
    s_cbranch_scc1 Lls_56
    buffer_store_dwordx4 v[24:27], v14, s[36:39], s95 offen sc1
    s_branch Lle_57
Lls_56:
    buffer_store_dwordx4 v[24:27], v14, s[36:39], s95 offen
Lle_57:
    s_mov_b32 exec_hi, -1
    s_add_u32 s79, s94, 4096
    s_add_u32 s80, s94, 8192
    s_add_u32 s81, s94, 12288
    s_barrier
    s_nop 0
    buffer_load_dwordx4 v[64:67], v12, s[36:39], s94 offen offset:0 sc1
    buffer_load_dwordx4 v[68:71], v12, s[36:39], s94 offen offset:2048 sc1
    buffer_load_dwordx4 v[72:75], v12, s[36:39], s79 offen offset:0 sc1
    buffer_load_dwordx4 v[76:79], v12, s[36:39], s79 offen offset:2048 sc1
    buffer_load_dwordx4 v[80:83], v12, s[36:39], s80 offen offset:0 sc1
    buffer_load_dwordx4 v[84:87], v12, s[36:39], s80 offen offset:2048 sc1
    buffer_load_dwordx4 v[88:91], v12, s[36:39], s81 offen offset:0 sc1
    buffer_load_dwordx4 v[92:95], v12, s[36:39], s81 offen offset:2048 sc1
    v_xor_b32_e64 v112, 0, v13
    ds_write_b128 v112, v[224:227]
    v_xor_b32_e64 v113, 32, v13
    ds_write_b128 v113, v[228:231]
    v_xor_b32_e64 v114, 64, v13
    ds_write_b128 v114, v[232:235]
    v_xor_b32 v115, 96, v13
    ds_write_b128 v115, v[236:239]
    v_xor_b32 v116, 128, v13
    ds_write_b128 v116, v[240:243]
    v_xor_b32 v117, 160, v13
    ds_write_b128 v117, v[244:247]
    v_xor_b32 v118, 192, v13
    ds_write_b128 v118, v[248:251]
    v_xor_b32 v119, 224, v13
    ds_write_b128 v119, v[252:255]
    s_mov_b32 s85, 1
    s_branch L_gchk
Lspin_58:
    s_add_u32 s85, s85, 1
    s_cmp_gt_u32 s85, 400000
    s_cbranch_scc1 L_end
    buffer_load_dwordx4 v[64:67], v12, s[36:39], s94 offen offset:0 sc1
    buffer_load_dwordx4 v[68:71], v12, s[36:39], s94 offen offset:2048 sc1
    buffer_load_dwordx4 v[72:75], v12, s[36:39], s79 offen offset:0 sc1
    buffer_load_dwordx4 v[76:79], v12, s[36:39], s79 offen offset:2048 sc1
    buffer_load_dwordx4 v[80:83], v12, s[36:39], s80 offen offset:0 sc1
    buffer_load_dwordx4 v[84:87], v12, s[36:39], s80 offen offset:2048 sc1
    buffer_load_dwordx4 v[88:91], v12, s[36:39], s81 offen offset:0 sc1
    buffer_load_dwordx4 v[92:95], v12, s[36:39], s81 offen offset:2048 sc1
L_gchk:
    s_waitcnt vmcnt(0)
    s_nop 0
    v_max3_u32 v16, v67, v71, v75
    v_max3_u32 v16, v16, v79, v83
    v_max3_u32 v16, v16, v87, v91
    v_max3_u32 v16, v16, v95, s75
    v_min3_u32 v17, v67, v71, v75
    v_min3_u32 v17, v17, v79, v83
    v_min3_u32 v17, v17, v87, v91
    v_min3_u32 v17, v17, v95, s75
    v_cmp_ne_u32 vcc, v16, v17
    s_cbranch_vccnz Lspin_58
    v_pk_add_f32 v[64:65], v[64:65], v[68:69]
    v_add_f32_e64 v66, v66, v70
    v_pk_add_f32 v[72:73], v[72:73], v[76:77]
    v_add_f32_e64 v74, v74, v78
    v_pk_add_f32 v[80:81], v[80:81], v[84:85]
    v_add_f32_e64 v82, v82, v86
    v_pk_add_f32 v[88:89], v[88:89], v[92:93]
    v_add_f32_e64 v90, v90, v94
    v_pk_add_f32 v[64:65], v[64:65], v[72:73]
    v_add_f32_e64 v66, v66, v74
    v_pk_add_f32 v[80:81], v[80:81], v[88:89]
    v_add_f32 v82, v82, v90
    v_add_f32 v24, v64, v80
    v_add_f32 v25, v65, v81
    v_add_f32 v26, v66, v82
    v_mov_b32 v28, v24
    v_mov_b32 v29, v25
    v_mov_b32 v30, v26
    v_permlane32_swap_b32 v24, v28
    v_permlane32_swap_b32 v25, v29
    v_permlane32_swap_b32 v26, v30
    v_pk_add_f32 v[24:25], v[24:25], v[28:29]
    v_add_f32_e64 v26, v26, v30
    v_mul_f32 v36, 0x3a800000, v24
    v_mul_f32 v40, 0x3a800000, v25
    v_fma_f32 v40, -v36, v36, v40
    v_max_f32_e64 v40, 0, v40
    v_cvt_pk_bf16_f32 v36, v36, v36
    v_and_b32 v36, 0xffff0000, v36
    v_cvt_pk_bf16_f32 v40, v40, v40
    v_and_b32 v40, 0xffff0000, v40
    v_add_f32 v40, 0x3727c5ac, v40
    v_cvt_pk_bf16_f32 v40, v40, v40
    v_and_b32 v40, 0xffff0000, v40
    v_sqrt_f32 v40, v40
    s_nop 0
    v_cvt_pk_bf16_f32 v40, v40, v40
    v_and_b32 v40, 0xffff0000, v40
    v_rcp_f32_e64 v38, v40
    v_fma_f32 v42, -v36, v126, v26
    s_mov_b32 s79, 0xfffff800
    v_mul_f32_e64 v42, v42, v38
    v_mul_f32 v39, -v36, v38
    v_and_or_b32 v42, v42, s79, v11
    ds_write_b64 v10, v[38:39]
    s_nop 0
    v_max_f32_dpp v42, v42, v42 row_ror:8 row_mask:0xf bank_mask:0xf
    s_nop 1
    v_max_f32_dpp v42, v42, v42 row_ror:4 row_mask:0xf bank_mask:0xf
    s_nop 1
    v_max_f32_dpp v42, v42, v42 row_ror:2 row_mask:0xf bank_mask:0xf
    s_nop 1
    v_max_f32_dpp v42, v42, v42 row_ror:1 row_mask:0xf bank_mask:0xf
    s_lshl_b32 s78, s76, 3
    s_add_u32 s78, s78, 163328
    v_bfe_u32 v16, v2, 4, 1
    v_lshl_add_u32 v16, v16, 2, s78
    ds_write_b32 v16, v42
    v_mov_b32 v16, 163328
    s_waitcnt lgkmcnt(0)
    s_barrier
    ds_read_b128 v[20:23], v16
    ds_read_b128 v[24:27], v16 offset:16
    s_lshl_b32 s79, s71, 4
    s_add_u32 s79, s79, s72
    s_lshl_b32 s79, s79, 9
    s_add_u32 s79, s79, 524288
    v_lshlrev_b32 v17, 3, v2
    v_lshlrev_b32_e64 v18, 2, v2
    s_waitcnt lgkmcnt(0)
    v_max3_f32 v20, v20, v21, v22
    v_max3_f32 v24, v24, v25, v26
    v_max_f32_e64 v23, v23, v27
    v_max3_f32 v20, v20, v24, v23
    v_mov_b32 v21, s75
    s_cmp_lg_u32 s76, 0
    s_cbranch_scc1 L_nocand
    s_mov_b32 exec_hi, 0
    v_and_b32 v22, 127, v20
    v_and_b32 v23, 7, v20
    v_lshlrev_b32 v23, 4, v23
    v_xor_b32_e64 v23, v23, v17
    v_lshl_add_u32 v23, v22, 8, v23
    v_lshlrev_b32_e64 v22, 3, v22
    ds_read_b64 v[24:25], v23
    v_add_u32 v22, 159744, v22
    ds_read_b64 v[26:27], v22
    s_mov_b32 exec_lo, 0xffff
    buffer_store_dwordx2 v[20:21], v17, s[36:39], s79 offen offset:128 sc1
    s_mov_b32 exec_lo, -1
    s_waitcnt lgkmcnt(0)
    v_fma_f32 v28, v24, v26, v27
    v_fma_f32 v29, v25, v26, v27
    v_cvt_pk_bf16_f32 v30, v28, v29
    buffer_store_dword v30, v18, s[36:39], s79 offen sc1
    v_add_f32 v28, v28, v24
    v_add_f32 v29, v29, v25
    buffer_store_dwordx2 v[28:29], v17, s[36:39], s79 offen offset:256 sc1
    s_mov_b32 exec_hi, -1
L_nocand:
    v_lshrrev_b32 v16, 3, v2
    v_and_b32 v17, 7, v2
    s_lshl_b32 s78, s76, 5
    v_add_u32 v18, s78, v16
    v_lshlrev_b32 v19, 1, v17
    v_xor_b32 v19, v19, v16
    v_lshlrev_b32 v19, 4, v19
    v_lshl_add_u32 v19, v18, 8, v19
    v_xor_b32 v32, 16, v19
    v_lshlrev_b32 v33, 3, v18
    v_add_u32 v33, 159744, v33
    ds_read_b128 v[64:67], v19 offset:0
    ds_read_b128 v[68:71], v32 offset:0
    ds_read_b64 v[96:97], v33 offset:0
    ds_read_b128 v[72:75], v19 offset:2048
    ds_read_b128 v[76:79], v32 offset:2048
    ds_read_b64 v[98:99], v33 offset:64
    ds_read_b128 v[80:83], v19 offset:4096
    ds_read_b128 v[84:87], v32 offset:4096
    ds_read_b64 v[100:101], v33 offset:128
    ds_read_b128 v[88:91], v19 offset:6144
    ds_read_b128 v[92:95], v32 offset:6144
    ds_read_b64 v[102:103], v33 offset:192
    s_lshl_b32 s78, s71, 7
    v_add_u32_e64 v18, s78, v18
    s_lshl_b32 s79, s72, 7
    v_lshl_add_u32 v19, v18, 11, s79
    v_lshl_add_u32 v19, v17, 4, v19
    v_mov_b32 v16, 163360
    s_waitcnt lgkmcnt(0)
    v_add_f32 v96, 1.0, v96
    v_pk_fma_f32 v[64:65], v[64:65], v[96:97], v[96:97] op_sel:[0,0,1] op_sel_hi:[1,0,1]
    v_pk_fma_f32 v[66:67], v[66:67], v[96:97], v[96:97] op_sel:[0,0,1] op_sel_hi:[1,0,1]
    v_pk_fma_f32 v[68:69], v[68:69], v[96:97], v[96:97] op_sel:[0,0,1] op_sel_hi:[1,0,1]
    v_pk_fma_f32 v[70:71], v[70:71], v[96:97], v[96:97] op_sel:[0,0,1] op_sel_hi:[1,0,1]
    v_cvt_pk_bf16_f32 v104, v64, v65
    v_cvt_pk_bf16_f32 v105, v66, v67
    v_cvt_pk_bf16_f32 v106, v68, v69
    v_cvt_pk_bf16_f32 v107, v70, v71
    v_add_f32_e64 v98, 1.0, v98
    v_pk_fma_f32 v[72:73], v[72:73], v[98:99], v[98:99] op_sel:[0,0,1] op_sel_hi:[1,0,1]
    v_pk_fma_f32 v[74:75], v[74:75], v[98:99], v[98:99] op_sel:[0,0,1] op_sel_hi:[1,0,1]
    v_pk_fma_f32 v[76:77], v[76:77], v[98:99], v[98:99] op_sel:[0,0,1] op_sel_hi:[1,0,1]
    v_pk_fma_f32 v[78:79], v[78:79], v[98:99], v[98:99] op_sel:[0,0,1] op_sel_hi:[1,0,1]
    v_cvt_pk_bf16_f32 v108, v72, v73
    v_cvt_pk_bf16_f32 v109, v74, v75
    v_cvt_pk_bf16_f32 v110, v76, v77
    v_cvt_pk_bf16_f32 v111, v78, v79
    v_add_f32_e64 v100, 1.0, v100
    v_pk_fma_f32 v[80:81], v[80:81], v[100:101], v[100:101] op_sel:[0,0,1] op_sel_hi:[1,0,1]
    v_pk_fma_f32 v[82:83], v[82:83], v[100:101], v[100:101] op_sel:[0,0,1] op_sel_hi:[1,0,1]
    v_pk_fma_f32 v[84:85], v[84:85], v[100:101], v[100:101] op_sel:[0,0,1] op_sel_hi:[1,0,1]
    v_pk_fma_f32 v[86:87], v[86:87], v[100:101], v[100:101] op_sel:[0,0,1] op_sel_hi:[1,0,1]
    v_cvt_pk_bf16_f32 v112, v80, v81
    v_cvt_pk_bf16_f32 v113, v82, v83
    v_cvt_pk_bf16_f32 v114, v84, v85
    v_cvt_pk_bf16_f32 v115, v86, v87
    v_add_f32_e64 v102, 1.0, v102
    v_pk_fma_f32 v[88:89], v[88:89], v[102:103], v[102:103] op_sel:[0,0,1] op_sel_hi:[1,0,1]
    v_pk_fma_f32 v[90:91], v[90:91], v[102:103], v[102:103] op_sel:[0,0,1] op_sel_hi:[1,0,1]
    v_pk_fma_f32 v[92:93], v[92:93], v[102:103], v[102:103] op_sel:[0,0,1] op_sel_hi:[1,0,1]
    v_pk_fma_f32 v[94:95], v[94:95], v[102:103], v[102:103] op_sel:[0,0,1] op_sel_hi:[1,0,1]
    v_cvt_pk_bf16_f32 v116, v88, v89
    v_cvt_pk_bf16_f32 v117, v90, v91
    v_cvt_pk_bf16_f32 v118, v92, v93
    v_cvt_pk_bf16_f32 v119, v94, v95
    s_barrier
    ds_read_b32 v17, v16
    s_waitcnt lgkmcnt(0)
    v_and_b32 v17, 0x7ff, v17
    v_sub_u32 v17, v17, v18
    s_barrier
    s_barrier
    s_mov_b32 s78, 0
    v_cmp_ne_u32_e64 vcc, 0, v17
    s_mov_b64 exec, vcc
    s_cbranch_execz Lo_59
    buffer_store_dwordx4 v[104:107], v19, s[44:47], s78 offen sc1
Lo_59:
    s_mov_b64 exec, -1
    s_mov_b32 s78, 16384
    v_cmp_ne_u32 vcc, 8, v17
    s_mov_b64 exec, vcc
    s_cbranch_execz Lo_60
    buffer_store_dwordx4 v[108:111], v19, s[44:47], s78 offen sc1
Lo_60:
    s_mov_b64 exec, -1
    s_mov_b32 s78, 32768
    v_cmp_ne_u32 vcc, 16, v17
    s_mov_b64 exec, vcc
    s_cbranch_execz Lo_61
    buffer_store_dwordx4 v[112:115], v19, s[44:47], s78 offen sc1
Lo_61:
    s_mov_b64 exec, -1
    s_mov_b32 s78, 49152
    v_cmp_ne_u32 vcc, 24, v17
    s_mov_b64 exec, vcc
    s_cbranch_execz Lo_62
    buffer_store_dwordx4 v[116:119], v19, s[44:47], s78 offen sc1
Lo_62:
    s_mov_b64 exec, -1
    s_branch L_fin
L_fin:
L_end:
    s_endpgm
.fill 64, 4, 0xbf800000
s_endpgm
.section .rodata,"a"
.p2align 6
.amdhsa_kernel sequential_preLN__linear_kernel_hedgehog__moe_arch_mod__prompt_kernel
  .amdhsa_next_free_vgpr 256
  .amdhsa_next_free_sgpr 102
  .amdhsa_accum_offset 256
  .amdhsa_group_segment_fixed_size 0
  .amdhsa_kernarg_size 96
  .amdhsa_user_sgpr_count 2
  .amdhsa_user_sgpr_kernarg_segment_ptr 1
  .amdhsa_system_sgpr_workgroup_id_x 1
  .amdhsa_float_denorm_mode_32 3
.end_amdhsa_kernel
```

```asm
; @launch grid=(256,1,1) block=(512,1,1) lds=163840
.amdgcn_target "amdgcn-amd-amdhsa--gfx950"
.text
.globl sequential_preLN__linear_kernel_hedgehog__moe_arch_mod__prompt_kernel
.p2align 8
.type sequential_preLN__linear_kernel_hedgehog__moe_arch_mod__prompt_kernel,@function
sequential_preLN__linear_kernel_hedgehog__moe_arch_mod__prompt_kernel:
    s_cmp_ge_u32 s2, 256
    s_cbranch_scc1 L_end
    s_load_dwordx16 s[4:19], s[0:1], 0
    s_load_dwordx8 s[20:27], s[0:1], 64
    v_lshrrev_b32 v1, 6, v0
    v_and_b32_e64 v2, 63, v0
    v_readfirstlane_b32 s68, v1
    s_lshr_b32 s69, s2, 4
    s_and_b32 s70, s2, 7
    s_lshl_b32 s70, s70, 1
    s_bfe_u32 s78, s2, 0x10003
    s_or_b32 s70, s70, s78
    s_and_b32 s76, s68, 3
    s_cmp_ge_u32 s68, 4
    s_cbranch_scc1 L_M
    v_lshrrev_b32 v196, 3, v2
    v_and_b32 v197, 7, v2
    v_lshrrev_b32_e64 v198, 4, v2
    s_and_b32 s80, s69, 0
    s_lshl_b32 s89, s76, 11
    s_lshl_b32 s66, s80, 10
    s_or_b32 s66, s66, s89
    s_xor_b32 s67, s66, 1024
    s_lshl_b32 s79, s70, 7
    s_movk_i32 s78, 6144
    v_mov_b32_e64 v199, s79
    v_mad_u32_u24 v199, v196, s78, v199
    s_lshl_b32 s80, s80, 2
    v_and_b32 v200, 2, v196
    v_xor_b32 v200, v200, v197
    v_xor_b32 v200, s80, v200
    v_lshl_add_u32 v199, v200, 4, v199
    s_mul_i32 s78, s66, 48
    s_mul_i32 s79, s67, 48
    v_add_u32 v6, s78, v199
    v_xor_b32 v199, 64, v199
    v_add_u32_e64 v7, s79, v199
    s_and_b32 s80, s70, 0
    s_lshl_b32 s88, s76, 12
    s_lshl_b32 s64, s80, 10
    s_or_b32 s64, s64, s88
    s_xor_b32 s65, s64, 1024
    s_lshl_b32 s80, s80, 2
    s_lshl_b32 s78, s69, 14
    s_add_u32 s78, s78, s64
    s_lshl_b32 s78, s78, 4
    v_lshl_add_u32 v199, v196, 11, s78
    v_xor_b32 v200, v198, v197
    v_xor_b32 v200, s80, v200
    v_lshl_add_u32 v4, v200, 4, v199
    v_xor_b32 v5, 16448, v4
    s_and_b32 s78, s70, 14
    s_and_b32 s79, s69, 14
    s_add_u32 s78, s78, s79
    s_sub_u32 s78, 32, s78
    s_and_b32 s78, s78, 15
    s_lshl_b32 s86, s78, 7
    s_mul_i32 s87, s78, 393216
    s_mov_b32 s30, 0x400000
    s_mov_b32 s31, 0x20000
    s_mov_b32 s34, 0x600000
    s_mov_b32 s35, 0x20000
    s_waitcnt lgkmcnt(0)
    s_mov_b32 s32, s6
    s_and_b32 s33, s7, 0xffff
    s_mov_b32 s28, s4
    s_and_b32 s29, s5, 0xffff
    s_add_u32 m0, s64, 118784
    s_nop 0
    buffer_load_dwordx4 v4, s[28:31], s86 offen offset:0  lds
    s_add_u32 m0, s66, 141312
    s_nop 0
    s_nop 0
    buffer_load_dwordx4 v6, s[32:35], s87 offen offset:2048  lds
    s_add_u32 m0, s64, 120832
    s_add_u32 s101, s86, 32768
    buffer_load_dwordx4 v4, s[28:31], s101 offen offset:0  lds
    s_add_u32 m0, s66, 151552
    s_add_u32 s101, s87, 4096
    buffer_load_dwordx4 v6, s[32:35], s101 offen offset:0  lds
    s_add_u32 m0, s66, 135168
    s_nop 0
    buffer_load_dwordx4 v6, s[32:35], s87 offen offset:0  lds
    s_add_u32 m0, s65, 118784
    s_nop 0
    buffer_load_dwordx4 v5, s[28:31], s86 offen offset:0  lds
    s_add_u32 m0, s67, 141312
    s_nop 0
    s_nop 0
    buffer_load_dwordx4 v7, s[32:35], s87 offen offset:2048  lds
    s_add_u32 m0, s65, 120832
    s_add_u32 s101, s86, 32768
    buffer_load_dwordx4 v5, s[28:31], s101 offen offset:0  lds
    s_add_u32 m0, s67, 151552
    s_add_u32 s101, s87, 4096
    buffer_load_dwordx4 v7, s[32:35], s101 offen offset:0  lds
    s_add_u32 m0, s67, 135168
    s_nop 0
    buffer_load_dwordx4 v7, s[32:35], s87 offen offset:0  lds
    s_add_u32 s86, s86, 128
    s_add_u32 s87, s87, 393216
    s_and_b32 s86, s86, 2047
    s_cselect_b32 s87, s87, 0
    s_load_dword s75, s[26:27], 0
    s_mov_b32 s60, s8
    s_and_b32 s61, s9, 0xffff
    s_mov_b32 s62, 0x10000
    s_mov_b32 s63, 0x20000
    v_lshlrev_b32_e64 v14, 4, v2
    s_lshl_b32 s78, s70, 12
    s_lshl_b32 s79, s76, 10
    s_add_u32 s78, s78, s79
    s_add_u32 m0, s79, 159744
    s_nop 0
    buffer_load_dwordx4 v14, s[60:63], s78 offen lds
    s_and_b32 s78, s2, 7
    s_lshr_b32 s79, s2, 3
    s_lshl_b32 s71, s78, 1
    s_and_b32 s72, s79, 1
    s_add_u32 s71, s71, s72
    s_lshr_b32 s72, s79, 1
    s_cmp_gt_u32 s70, 3
    s_cselect_b32 s78, 1, 0
    s_cmp_gt_u32 s70, 11
    s_cselect_b32 s78, 2, s78
    s_sub_u32 s78, s70, s78
    s_cmp_eq_u32 s70, 3
    s_cselect_b32 s78, 14, s78
    s_cmp_eq_u32 s70, 11
    s_cselect_b32 s78, 15, s78
    s_lshl_b32 s0, s78, 4
    s_add_u32 s0, s0, s69
    s_lshr_b32 s73, s0, 2
    s_and_b32 s74, s0, 3
    s_lshl_b32 s77, s70, 4
    s_add_u32 s77, s77, s69
    s_mov_b32 s36, s26
    s_and_b32 s37, s27, 0xffff
    s_mov_b32 s38, 0x10000000
    s_mov_b32 s39, 0x20000
    s_mov_b32 s40, s10
    s_and_b32 s41, s11, 0xffff
    s_mov_b32 s42, 0x200000
    s_mov_b32 s43, 0x20000
    s_mov_b32 s44, s22
    s_and_b32 s45, s23, 0xffff
    s_mov_b32 s46, 0x400000
    s_mov_b32 s47, 0x20000
    s_mov_b32 s48, s16
    s_and_b32 s49, s17, 0xffff
    s_mov_b32 s50, 0x700000
    s_mov_b32 s51, 0x20000
    s_mov_b32 s52, s18
    s_and_b32 s53, s19, 0xffff
    s_mov_b32 s54, 0x700000
    s_mov_b32 s55, 0x20000
    s_mov_b32 s56, s20
    s_and_b32 s57, s21, 0xffff
    s_mov_b32 s58, 0x700000
    s_mov_b32 s59, 0x20000
    v_mov_b32 v16, -1
    v_mov_b32 v17, -1
    v_mov_b32 v18, -1
    v_mov_b32_e64 v19, -1
    s_lshl_b32 s94, s77, 14
    s_lshl_b32 s78, s76, 12
    s_add_u32 s94, s94, s78
    s_add_u32 s94, s94, 4194304
    s_lshl_b32 s96, s77, 10
    s_add_u32 s96, s96, 8388608
    s_cmp_eq_u32 s76, 3
    s_cselect_b32 s96, s96, 0x10000000
    v_and_b32 v196, 15, v2
    v_lshrrev_b32 v197, 1, v196
    v_lshlrev_b32 v199, 7, v196
    v_add_u32 v199, s88, v199
    v_xor_b32_e64 v200, v198, v197
    v_lshl_add_u32 v60, v200, 4, v199
    v_xor_b32_e64 v61, 64, v60
    v_bfe_u32 v196, v2, 2, 2
    v_and_b32_e64 v197, 3, v2
    v_lshl_add_u32 v199, v198, 3, v196
    v_lshlrev_b32_e64 v199, 7, v199
    v_lshl_add_u32 v199, v197, 3, v199
    v_lshrrev_b32 v196, 1, v196
    v_and_b32 v197, 1, v198
    v_lshl_add_u32 v196, v197, 1, v196
    s_mul_i32 s80, s76, 3
    s_add_u32 s78, s80, 0
    s_and_b32 s79, s78, 3
    s_lshr_b32 s78, s78, 2
    s_lshl_b32 s78, s78, 13
    s_add_u32 s78, s78, 16384
    v_xor_b32 v197, s79, v196
    v_lshl_add_u32 v197, v197, 5, v199
    v_add_u32_e64 v240, s78, v197
    s_add_u32 s78, s80, 1
    s_and_b32 s79, s78, 3
    s_lshr_b32 s78, s78, 2
    s_lshl_b32 s78, s78, 13
    s_add_u32 s78, s78, 16384
    v_xor_b32_e64 v197, s79, v196
    v_lshl_add_u32 v197, v197, 5, v199
    v_add_u32_e64 v241, s78, v197
    s_add_u32 s78, s80, 2
    s_and_b32 s79, s78, 3
    s_lshr_b32 s78, s78, 2
    s_lshl_b32 s78, s78, 13
    s_add_u32 s78, s78, 16384
    v_xor_b32_e64 v197, s79, v196
    v_lshl_add_u32 v197, v197, 5, v199
    v_add_u32_e64 v242, s78, v197
    s_and_b32 s82, s70, 1
    s_and_b32 s83, s69, 1
    s_add_u32 m0, s64, 36864
    s_nop 0
    buffer_load_dwordx4 v4, s[28:31], s86 offen offset:0  lds
    v_lshrrev_b32 v196, 3, v2
    v_and_b32 v197, 7, v2
    v_lshlrev_b32 v199, 4, v197
    v_mul_u32_u24 v244, 57344, v196
    s_add_u32 m0, s66, 59392
    s_nop 0
    buffer_load_dwordx4 v6, s[32:35], s87 offen offset:2048  lds
    v_add_u32 v244, v244, v199
    v_lshl_add_u32 v245, v196, 14, v199
    s_lshl_b32 s78, s74, 2
    s_add_u32 s78, s78, s76
    s_add_u32 m0, s64, 38912
    s_add_u32 s101, s86, 32768
    buffer_load_dwordx4 v4, s[28:31], s101 offen offset:0  lds
    s_mul_i32 s79, s78, 458752
    s_add_u32 s80, s73, s76
    s_and_b32 s80, s80, 3
    s_andn2_b32 s100, s73, 3
    s_add_u32 m0, s66, 69632
    s_add_u32 s101, s87, 4096
    buffer_load_dwordx4 v6, s[32:35], s101 offen offset:0  lds
    s_or_b32 s80, s80, s100
    s_lshl_b32 s80, s80, 7
    s_add_u32 s79, s79, s80
    s_cmp_ge_u32 s73, 56
    s_cselect_b32 s79, 0x8000000, s79
    v_add_u32_e64 v244, s79, v244
    s_lshl_b32 s78, s78, 7
    s_add_u32 m0, s66, 53248
    s_nop 0
    buffer_load_dwordx4 v6, s[32:35], s87 offen offset:0  lds
    s_lshl_b32 s80, s73, 17
    s_add_u32 s78, s78, s80
    v_add_u32_e64 v245, s78, v245
    s_lshl_b32 s78, s72, 7
    s_add_u32 m0, s65, 36864
    s_nop 0
    buffer_load_dwordx4 v5, s[28:31], s86 offen offset:0  lds
    v_lshl_add_u32 v196, v196, 11, s78
    v_and_b32 v199, 1, v198
    v_lshlrev_b32 v199, 2, v199
    v_xor_b32 v199, v199, v197
    s_add_u32 m0, s67, 59392
    s_nop 0
    buffer_load_dwordx4 v7, s[32:35], s87 offen offset:2048  lds
    v_lshl_add_u32 v246, v199, 4, v196
    s_lshl_b32 s78, s71, 2
    s_add_u32 s78, s78, s76
    s_lshl_b32 s78, s78, 16
    v_add_u32_e64 v196, s78, v196
    s_add_u32 m0, s65, 38912
    s_add_u32 s101, s86, 32768
    buffer_load_dwordx4 v5, s[28:31], s101 offen offset:0  lds
    v_xor_b32_e64 v199, v198, v197
    v_lshl_add_u32 v247, v199, 4, v196
    v_xor_b32 v248, 64, v247
    s_lshl_b32 s78, s76, 14
    s_add_u32 m0, s67, 69632
    s_add_u32 s101, s87, 4096
    buffer_load_dwordx4 v7, s[32:35], s101 offen offset:0  lds
    v_add_u32 v246, s78, v246
    s_lshl_b32 s84, s76, 10
    s_bfe_u32 s78, s2, 0x40003
    s_lshl_b32 s78, s78, 17
    s_add_u32 m0, s67, 53248
    s_nop 0
    buffer_load_dwordx4 v7, s[32:35], s87 offen offset:0  lds
    s_add_u32 s86, s86, 128
    s_add_u32 s87, s87, 393216
    s_and_b32 s86, s86, 2047
    s_cselect_b32 s87, s87, 0
    s_and_b32 s79, s72, 8
    s_add_u32 s79, s79, 3
    s_lshl_b32 s79, s79, 7
    s_add_u32 s78, s78, s79
    v_lshl_add_u32 v63, v2, 11, s78
    s_waitcnt vmcnt(10)
    s_barrier
    s_cmp_lg_u32 s82, 0
    s_cbranch_scc1 Lsx_1
    s_nop 0
    v_add_u32 v196, 118784, v60
    v_add_u32 v197, 118784, v61
    ds_read_b128 v[20:23], v196 offset:0
    ds_read_b128 v[24:27], v196 offset:2048
    ds_read_b128 v[28:31], v197 offset:0
    ds_read_b128 v[32:35], v197 offset:2048
Lsx_1:
    s_cmp_lg_u32 s83, 0
    s_cbranch_scc1 Lsw_2
    v_add_u32 v198, 118784, v240
    v_add_u32 v199, 118784, v241
    v_add_u32 v200, 118784, v242
    ds_read_b64_tr_b16 v[36:37], v198 offset:0
    ds_read_b64_tr_b16 v[38:39], v198 offset:512
    ds_read_b64_tr_b16 v[40:41], v198 offset:4096
    ds_read_b64_tr_b16 v[42:43], v198 offset:4608
    ds_read_b64_tr_b16 v[44:45], v199 offset:0
    ds_read_b64_tr_b16 v[46:47], v199 offset:512
    ds_read_b64_tr_b16 v[48:49], v199 offset:4096
    ds_read_b64_tr_b16 v[50:51], v199 offset:4608
    ds_read_b64_tr_b16 v[52:53], v200 offset:0
    ds_read_b64_tr_b16 v[54:55], v200 offset:512
    ds_read_b64_tr_b16 v[56:57], v200 offset:4096
    ds_read_b64_tr_b16 v[58:59], v200 offset:4608
Lsw_2:
    s_add_u32 m0, s64, 77824
    s_nop 0
    buffer_load_dwordx4 v4, s[28:31], s86 offen offset:0  lds
    s_add_u32 m0, s66, 100352
    s_nop 0
    buffer_load_dwordx4 v6, s[32:35], s87 offen offset:2048  lds
    s_add_u32 m0, s64, 79872
    s_add_u32 s101, s86, 32768
    buffer_load_dwordx4 v4, s[28:31], s101 offen offset:0  lds
    s_add_u32 m0, s66, 110592
    s_add_u32 s101, s87, 4096
    buffer_load_dwordx4 v6, s[32:35], s101 offen offset:0  lds
    s_add_u32 m0, s66, 94208
    s_nop 0
    buffer_load_dwordx4 v6, s[32:35], s87 offen offset:0  lds
    s_add_u32 m0, s65, 77824
    s_nop 0
    buffer_load_dwordx4 v5, s[28:31], s86 offen offset:0  lds
    s_add_u32 m0, s67, 100352
    s_nop 0
    s_nop 0
    buffer_load_dwordx4 v7, s[32:35], s87 offen offset:2048  lds
    s_add_u32 m0, s65, 79872
    s_add_u32 s101, s86, 32768
    buffer_load_dwordx4 v5, s[28:31], s101 offen offset:0  lds
    s_add_u32 m0, s67, 110592
    s_add_u32 s101, s87, 4096
    buffer_load_dwordx4 v7, s[32:35], s101 offen offset:0  lds
    s_add_u32 m0, s67, 94208
    s_nop 0
    buffer_load_dwordx4 v7, s[32:35], s87 offen offset:0  lds
    s_add_u32 s86, s86, 128
    s_add_u32 s87, s87, 393216
    s_and_b32 s86, s86, 2047
    s_cselect_b32 s87, s87, 0
    s_waitcnt lgkmcnt(0)
    s_mul_i32 s75, s75, 0x9E3779B1
    s_add_u32 s75, s75, 0x7F4A7C15
    s_waitcnt vmcnt(10)
    s_waitcnt lgkmcnt(0)
    s_barrier
    s_cmp_lg_u32 s82, 1
    s_cbranch_scc1 Lsx_3
    v_add_u32 v196, 36864, v60
    v_add_u32 v197, 36864, v61
    ds_read_b128 v[20:23], v196 offset:0
    ds_read_b128 v[24:27], v196 offset:2048
    ds_read_b128 v[28:31], v197 offset:0
    ds_read_b128 v[32:35], v197 offset:2048
Lsx_3:
    s_cmp_lg_u32 s83, 1
    s_cbranch_scc1 Lsw_4
    v_add_u32 v198, 36864, v240
    v_add_u32 v199, 36864, v241
    v_add_u32 v200, 36864, v242
    ds_read_b64_tr_b16 v[36:37], v198 offset:0
    ds_read_b64_tr_b16 v[38:39], v198 offset:512
    ds_read_b64_tr_b16 v[40:41], v198 offset:4096
    ds_read_b64_tr_b16 v[42:43], v198 offset:4608
    ds_read_b64_tr_b16 v[44:45], v199 offset:0
    ds_read_b64_tr_b16 v[46:47], v199 offset:512
    ds_read_b64_tr_b16 v[48:49], v199 offset:4096
    ds_read_b64_tr_b16 v[50:51], v199 offset:4608
    ds_read_b64_tr_b16 v[52:53], v200 offset:0
    ds_read_b64_tr_b16 v[54:55], v200 offset:512
    ds_read_b64_tr_b16 v[56:57], v200 offset:4096
    ds_read_b64_tr_b16 v[58:59], v200 offset:4608
Lsw_4:
    s_add_u32 m0, s64, 118784
    s_nop 0
    buffer_load_dwordx4 v4, s[28:31], s86 offen offset:0  lds
    s_add_u32 m0, s66, 141312
    s_nop 0
    buffer_load_dwordx4 v6, s[32:35], s87 offen offset:2048  lds
    s_add_u32 m0, s64, 120832
    s_add_u32 s101, s86, 32768
    buffer_load_dwordx4 v4, s[28:31], s101 offen offset:0  lds
    s_add_u32 m0, s66, 151552
    s_add_u32 s101, s87, 4096
    buffer_load_dwordx4 v6, s[32:35], s101 offen offset:0  lds
    s_add_u32 m0, s66, 135168
    s_nop 0
    buffer_load_dwordx4 v6, s[32:35], s87 offen offset:0  lds
    s_add_u32 m0, s65, 118784
    s_nop 0
    buffer_load_dwordx4 v5, s[28:31], s86 offen offset:0  lds
    s_add_u32 m0, s67, 141312
    s_nop 0
    s_nop 0
    buffer_load_dwordx4 v7, s[32:35], s87 offen offset:2048  lds
    s_add_u32 m0, s65, 120832
    s_add_u32 s101, s86, 32768
    buffer_load_dwordx4 v5, s[28:31], s101 offen offset:0  lds
    s_add_u32 m0, s67, 151552
    s_add_u32 s101, s87, 4096
    buffer_load_dwordx4 v7, s[32:35], s101 offen offset:0  lds
    s_add_u32 m0, s67, 135168
    s_nop 0
    buffer_load_dwordx4 v7, s[32:35], s87 offen offset:0  lds
    s_add_u32 s86, s86, 128
    s_add_u32 s87, s87, 393216
    s_and_b32 s86, s86, 2047
    s_cselect_b32 s87, s87, 0
    s_waitcnt vmcnt(10)
    s_waitcnt lgkmcnt(0)
    s_barrier
    s_mul_i32 s100, s69, 52
    s_lshr_b32 s100, s100, 8
    s_mul_i32 s100, s100, 5
    s_sub_u32 s100, s69, s100
    s_cmp_eq_u32 s100, 1
    s_cbranch_scc1 L_ph1
    s_cmp_eq_u32 s100, 2
    s_cbranch_scc1 L_ph2
    s_cmp_eq_u32 s100, 3
    s_cbranch_scc1 L_ph3
    s_cmp_eq_u32 s100, 4
    s_cbranch_scc1 L_ph4
    s_add_u32 m0, s64, 36864
    s_nop 0
    buffer_load_dwordx4 v4, s[28:31], s86 offen offset:0  lds
    s_add_u32 m0, s66, 59392
    s_nop 0
    s_nop 0
    buffer_load_dwordx4 v6, s[32:35], s87 offen offset:2048  lds
    s_add_u32 m0, s64, 38912
    s_add_u32 s101, s86, 32768
    buffer_load_dwordx4 v4, s[28:31], s101 offen offset:0  lds
    s_add_u32 m0, s66, 69632
    s_add_u32 s101, s87, 4096
    buffer_load_dwordx4 v6, s[32:35], s101 offen offset:0  lds
    s_add_u32 m0, s66, 53248
    s_nop 0
    buffer_load_dwordx4 v6, s[32:35], s87 offen offset:0  lds
    s_add_u32 m0, s65, 36864
    s_nop 0
    buffer_load_dwordx4 v5, s[28:31], s86 offen offset:0  lds
    s_add_u32 m0, s67, 59392
    s_nop 0
    s_nop 0
    buffer_load_dwordx4 v7, s[32:35], s87 offen offset:2048  lds
    s_add_u32 m0, s65, 38912
    s_add_u32 s101, s86, 32768
    buffer_load_dwordx4 v5, s[28:31], s101 offen offset:0  lds
    s_add_u32 m0, s67, 69632
    s_add_u32 s101, s87, 4096
    buffer_load_dwordx4 v7, s[32:35], s101 offen offset:0  lds
    s_add_u32 m0, s67, 53248
    s_nop 0
    buffer_load_dwordx4 v7, s[32:35], s87 offen offset:0  lds
    s_add_u32 s86, s86, 128
    s_add_u32 s87, s87, 393216
    s_and_b32 s86, s86, 2047
    s_cselect_b32 s87, s87, 0
    s_mov_b32 s100, 0
    buffer_load_dwordx4 v[64:67], v244, s[48:51], s100 offen nt
    s_mov_b32 s100, 0
    buffer_load_dwordx4 v[96:99], v244, s[52:55], s100 offen nt
    s_mov_b32 s100, 7168
    buffer_load_dwordx4 v[68:71], v244, s[48:51], s100 offen nt
    s_mov_b32 s100, 7168
    buffer_load_dwordx4 v[100:103], v244, s[52:55], s100 offen nt
    s_mov_b32 s100, 14336
    buffer_load_dwordx4 v[72:75], v244, s[48:51], s100 offen nt
    s_mov_b32 s100, 14336
    buffer_load_dwordx4 v[104:107], v244, s[52:55], s100 offen nt
    s_mov_b32 s100, 21504
    buffer_load_dwordx4 v[76:79], v244, s[48:51], s100 offen nt
    s_waitcnt vmcnt(17)
    s_waitcnt lgkmcnt(0)
    s_barrier
    s_setprio 2
    s_add_u32 m0, s64, 77824
    s_nop 0
    s_nop 0
    buffer_load_dwordx4 v4, s[28:31], s86 offen offset:0  lds
    v_mov_b32 v200, 0x3f803f80
    v_mov_b32 v201, 0x3f803f80
    v_mov_b32 v202, 0x3f803f80
    v_mov_b32 v203, 0x3f803f80
    s_add_u32 m0, s66, 100352
    s_nop 0
    s_nop 0
    buffer_load_dwordx4 v6, s[32:35], s87 offen offset:2048  lds
    v_mfma_f32_16x16x32_bf16 v[204:207], v[200:203], v[20:23], 0
    v_mfma_f32_16x16x32_bf16 v[212:215], v[20:23], v[20:23], 0
    v_mfma_f32_16x16x32_bf16 v[208:211], v[200:203], v[24:27], 0
    v_mfma_f32_16x16x32_bf16 v[216:219], v[24:27], v[24:27], 0
    s_add_u32 m0, s64, 79872
    s_add_u32 s101, s86, 32768
    buffer_load_dwordx4 v4, s[28:31], s101 offen offset:0  lds
    v_mfma_f32_16x16x32_bf16 v[220:223], v[200:203], v[36:39], 0
    v_mfma_f32_16x16x32_bf16 v[224:227], v[200:203], v[44:47], 0
    v_mfma_f32_16x16x32_bf16 v[228:231], v[200:203], v[52:55], 0
    v_mfma_f32_16x16x32_bf16 v[204:207], v[200:203], v[28:31], v[204:207]
    v_mfma_f32_16x16x32_bf16 v[212:215], v[28:31], v[28:31], v[212:215]
    s_add_u32 m0, s66, 110592
    s_add_u32 s101, s87, 4096
    buffer_load_dwordx4 v6, s[32:35], s101 offen offset:0  lds
    v_mfma_f32_16x16x32_bf16 v[208:211], v[200:203], v[32:35], v[208:211]
    v_mfma_f32_16x16x32_bf16 v[216:219], v[32:35], v[32:35], v[216:219]
    v_mfma_f32_16x16x32_bf16 v[220:223], v[200:203], v[40:43], v[220:223]
    v_mfma_f32_16x16x32_bf16 v[224:227], v[200:203], v[48:51], v[224:227]
    s_add_u32 m0, s66, 94208
    s_nop 0
    buffer_load_dwordx4 v6, s[32:35], s87 offen offset:0  lds
    v_mfma_f32_16x16x32_bf16 v[228:231], v[200:203], v[56:59], v[228:231]
    v_and_b32 v196, 3, v2
    v_cmp_eq_u32 s[90:91], 1, v196
    v_cmp_eq_u32 s[92:93], 2, v196
    v_cmp_eq_u32_e64 vcc, 3, v196
    s_add_u32 m0, s65, 77824
    s_nop 0
    buffer_load_dwordx4 v5, s[28:31], s86 offen offset:0  lds
    v_cndmask_b32 v212, v212, v213, s[90:91]
    v_cndmask_b32 v212, v212, v214, s[92:93]
    v_cndmask_b32 v205, v212, v215, vcc
    v_cndmask_b32 v216, v216, v217, s[90:91]
    s_add_u32 m0, s67, 100352
    s_nop 0
    buffer_load_dwordx4 v7, s[32:35], s87 offen offset:2048  lds
    v_cndmask_b32 v216, v216, v218, s[92:93]
    v_cndmask_b32 v209, v216, v219, vcc
    v_lshrrev_b32_e64 v196, 4, v2
    v_cmp_eq_u32 s[90:91], 1, v196
    v_cmp_eq_u32_e64 vcc, 2, v196
    s_add_u32 m0, s65, 79872
    s_add_u32 s101, s86, 32768
    buffer_load_dwordx4 v5, s[28:31], s101 offen offset:0  lds
    v_cndmask_b32 v220, v220, v224, s[90:91]
    v_cndmask_b32_e64 v220, v220, v228, vcc
    s_mul_i32 s78, s77, 768
    s_mul_i32 s79, s76, 192
    s_add_u32 m0, s67, 110592
    s_add_u32 s101, s87, 4096
    buffer_load_dwordx4 v7, s[32:35], s101 offen offset:0  lds
    s_add_u32 s78, s78, s79
    s_add_u32 s78, s78, 327680
    v_lshlrev_b32 v197, 2, v2
    s_mov_b32 exec_hi, 0xffff
    buffer_store_dword v220, v197, s[36:39], s78 offen sc1
    s_mov_b32 exec_hi, -1
    s_lshl_b32 s78, s69, 4
    s_add_u32 m0, s67, 94208
    s_nop 0
    buffer_load_dwordx4 v7, s[32:35], s87 offen offset:0  lds
    s_add_u32 s86, s86, 128
    s_add_u32 s87, s87, 393216
    s_and_b32 s86, s86, 2047
    s_cselect_b32 s87, s87, 0
    s_add_u32 s78, s78, s70
    s_lshl_b32 s78, s78, 10
    s_lshl_b32 s79, s76, 8
    s_add_u32 s78, s78, s79
    buffer_store_dwordx4 v[16:19], v14, s[36:39], s96 offen offset:0 sc1
    s_add_u32 s78, s78, 65536
    v_and_b32 v198, 15, v2
    v_lshlrev_b32 v198, 3, v198
    s_mov_b32 exec_lo, 0x00f0000f
    s_mov_b32 exec_hi, 0xf0000f00
    buffer_store_dwordx2 v[204:205], v198, s[36:39], s78 offen offset:0 sc1
    s_mov_b64 exec, -1
    s_mov_b32 exec_lo, 0x00f0000f
    s_mov_b32 exec_hi, 0xf0000f00
    buffer_store_dwordx2 v[208:209], v198, s[36:39], s78 offen offset:128 sc1
    s_mov_b64 exec, -1
    s_setprio 0
    s_waitcnt vmcnt(21)
    s_waitcnt lgkmcnt(0)
    s_barrier
    s_add_u32 m0, s64, 118784
    s_nop 0
    buffer_load_dwordx4 v4, s[28:31], s86 offen offset:0  lds
    s_add_u32 m0, s66, 141312
    s_nop 0
    buffer_load_dwordx4 v6, s[32:35], s87 offen offset:2048  lds
    s_add_u32 m0, s64, 120832
    s_add_u32 s101, s86, 32768
    buffer_load_dwordx4 v4, s[28:31], s101 offen offset:0  lds
    s_add_u32 m0, s66, 151552
    s_add_u32 s101, s87, 4096
    buffer_load_dwordx4 v6, s[32:35], s101 offen offset:0  lds
    s_add_u32 m0, s66, 135168
    s_nop 0
    buffer_load_dwordx4 v6, s[32:35], s87 offen offset:0  lds
    s_add_u32 m0, s65, 118784
    s_nop 0
    buffer_load_dwordx4 v5, s[28:31], s86 offen offset:0  lds
    s_add_u32 m0, s67, 141312
    s_nop 0
    s_nop 0
    buffer_load_dwordx4 v7, s[32:35], s87 offen offset:2048  lds
    s_add_u32 m0, s65, 120832
    s_add_u32 s101, s86, 32768
    buffer_load_dwordx4 v5, s[28:31], s101 offen offset:0  lds
    s_add_u32 m0, s67, 151552
    s_add_u32 s101, s87, 4096
    buffer_load_dwordx4 v7, s[32:35], s101 offen offset:0  lds
    s_add_u32 m0, s67, 135168
    s_nop 0
    buffer_load_dwordx4 v7, s[32:35], s87 offen offset:0  lds
    s_add_u32 s86, s86, 128
    s_add_u32 s87, s87, 393216
    s_and_b32 s86, s86, 2047
    s_cselect_b32 s87, s87, 0
    s_waitcnt vmcnt(10)
    s_barrier
    s_cmp_lg_u32 s76, 0
    s_cbranch_scc1 Lfl_5
    s_getreg_b32 s99, hwreg(HW_REG_XCC_ID, 0, 4)
    v_mov_b32 v198, s75
    v_mov_b32 v199, s99
    v_lshlrev_b32 v197, 3, v2
    s_lshl_b32 s78, s77, 7
    s_lshl_b32 s79, s77, 9
    s_add_u32 s79, s79, 8912896
    s_add_u32 s78, s78, 4096
    s_lshl_b32 s80, s71, 4
    s_add_u32 s80, s80, s72
    s_lshl_b32 s80, s80, 7
    s_add_u32 s80, s80, 8847360
    s_mov_b64 exec, 0xffff
    buffer_store_dwordx2 v[198:199], v197, s[36:39], s78 offen sc1
    buffer_store_dwordx2 v[198:199], v197, s[36:39], s80 offen sc1
    s_mov_b64 exec, -1
    v_not_b32 v200, v198
    v_mov_b32 v201, 0
    buffer_store_dwordx2 v[200:201], v197, s[36:39], s79 offen sc1
    v_and_b32 v196, 15, v2
    v_lshlrev_b32 v197, 4, v196
    v_add_u32_e64 v197, s69, v197
    s_lshl_b32 s78, s70, 4
    s_lshl_b32 s79, s71, 4
    s_add_u32 s79, s79, 69088
    v_mov_b32 v202, s78
    v_mov_b32 v203, s79
    v_cmp_gt_u32 vcc, 32, v2
    s_nop 1
    v_cndmask_b32 v202, v203, v202, vcc
    v_add_u32 v196, v202, v196
    v_cmp_gt_u32 vcc, 16, v2
    s_nop 1
    v_cndmask_b32 v196, v196, v197, vcc
    v_lshlrev_b32 v196, 7, v196
    v_add_u32 v196, 4096, v196
Lfl_5:
    s_add_u32 m0, s64, 36864
    s_nop 0
    buffer_load_dwordx4 v4, s[28:31], s86 offen offset:0  lds
    s_add_u32 m0, s66, 59392
    s_nop 0
    buffer_load_dwordx4 v6, s[32:35], s87 offen offset:2048  lds
    s_add_u32 m0, s64, 38912
    s_add_u32 s101, s86, 32768
    buffer_load_dwordx4 v4, s[28:31], s101 offen offset:0  lds
    s_add_u32 m0, s66, 69632
    s_add_u32 s101, s87, 4096
    buffer_load_dwordx4 v6, s[32:35], s101 offen offset:0  lds
    s_add_u32 m0, s66, 53248
    s_nop 0
    buffer_load_dwordx4 v6, s[32:35], s87 offen offset:0  lds
    s_add_u32 m0, s65, 36864
    s_nop 0
    buffer_load_dwordx4 v5, s[28:31], s86 offen offset:0  lds
    s_add_u32 m0, s67, 59392
    s_nop 0
    s_nop 0
    buffer_load_dwordx4 v7, s[32:35], s87 offen offset:2048  lds
    s_add_u32 m0, s65, 38912
    s_add_u32 s101, s86, 32768
    buffer_load_dwordx4 v5, s[28:31], s101 offen offset:0  lds
    s_add_u32 m0, s67, 69632
    s_add_u32 s101, s87, 4096
    buffer_load_dwordx4 v7, s[32:35], s101 offen offset:0  lds
    s_add_u32 m0, s67, 53248
    s_nop 0
    buffer_load_dwordx4 v7, s[32:35], s87 offen offset:0  lds
    s_add_u32 s86, s86, 128
    s_add_u32 s87, s87, 393216
    s_and_b32 s86, s86, 2047
    s_cselect_b32 s87, s87, 0
    s_waitcnt vmcnt(10)
    s_barrier
    s_add_u32 m0, s64, 77824
    s_nop 0
    buffer_load_dwordx4 v4, s[28:31], s86 offen offset:0  lds
    s_add_u32 m0, s66, 100352
    s_nop 0
    buffer_load_dwordx4 v6, s[32:35], s87 offen offset:2048  lds
    s_add_u32 m0, s64, 79872
    s_add_u32 s101, s86, 32768
    buffer_load_dwordx4 v4, s[28:31], s101 offen offset:0  lds
    s_add_u32 m0, s66, 110592
    s_add_u32 s101, s87, 4096
    buffer_load_dwordx4 v6, s[32:35], s101 offen offset:0  lds
    s_add_u32 m0, s66, 94208
    s_nop 0
    buffer_load_dwordx4 v6, s[32:35], s87 offen offset:0  lds
    s_add_u32 m0, s65, 77824
    s_nop 0
    buffer_load_dwordx4 v5, s[28:31], s86 offen offset:0  lds
    s_add_u32 m0, s67, 100352
    s_nop 0
    s_nop 0
    buffer_load_dwordx4 v7, s[32:35], s87 offen offset:2048  lds
    s_add_u32 m0, s65, 79872
    s_add_u32 s101, s86, 32768
    buffer_load_dwordx4 v5, s[28:31], s101 offen offset:0  lds
    s_add_u32 m0, s67, 110592
    s_add_u32 s101, s87, 4096
    buffer_load_dwordx4 v7, s[32:35], s101 offen offset:0  lds
    s_add_u32 m0, s67, 94208
    s_nop 0
    buffer_load_dwordx4 v7, s[32:35], s87 offen offset:0  lds
    s_add_u32 s86, s86, 128
    s_add_u32 s87, s87, 393216
    s_and_b32 s86, s86, 2047
    s_cselect_b32 s87, s87, 0
    s_waitcnt vmcnt(10)
    s_barrier
    s_add_u32 m0, s64, 118784
    s_nop 0
    buffer_load_dwordx4 v4, s[28:31], s86 offen offset:0  lds
    s_add_u32 m0, s66, 141312
    s_nop 0
    buffer_load_dwordx4 v6, s[32:35], s87 offen offset:2048  lds
    s_add_u32 m0, s64, 120832
    s_add_u32 s101, s86, 32768
    buffer_load_dwordx4 v4, s[28:31], s101 offen offset:0  lds
    s_add_u32 m0, s66, 151552
    s_add_u32 s101, s87, 4096
    buffer_load_dwordx4 v6, s[32:35], s101 offen offset:0  lds
    s_add_u32 m0, s66, 135168
    s_nop 0
    buffer_load_dwordx4 v6, s[32:35], s87 offen offset:0  lds
    s_add_u32 m0, s65, 118784
    s_nop 0
    buffer_load_dwordx4 v5, s[28:31], s86 offen offset:0  lds
    s_add_u32 m0, s67, 141312
    s_nop 0
    s_nop 0
    buffer_load_dwordx4 v7, s[32:35], s87 offen offset:2048  lds
    s_add_u32 m0, s65, 120832
    s_add_u32 s101, s86, 32768
    buffer_load_dwordx4 v5, s[28:31], s101 offen offset:0  lds
    s_add_u32 m0, s67, 151552
    s_add_u32 s101, s87, 4096
    buffer_load_dwordx4 v7, s[32:35], s101 offen offset:0  lds
    s_add_u32 m0, s67, 135168
    s_nop 0
    buffer_load_dwordx4 v7, s[32:35], s87 offen offset:0  lds
    s_add_u32 s86, s86, 128
    s_add_u32 s87, s87, 393216
    s_and_b32 s86, s86, 2047
    s_cselect_b32 s87, s87, 0
    s_mov_b32 s100, 21504
    buffer_load_dwordx4 v[108:111], v244, s[52:55], s100 offen nt
    s_mov_b32 s100, 28672
    buffer_load_dwordx4 v[80:83], v244, s[48:51], s100 offen nt
    s_mov_b32 s100, 28672
    buffer_load_dwordx4 v[112:115], v244, s[52:55], s100 offen nt
    s_mov_b32 s100, 35840
    buffer_load_dwordx4 v[84:87], v244, s[48:51], s100 offen nt
    s_mov_b32 s100, 35840
    buffer_load_dwordx4 v[116:119], v244, s[52:55], s100 offen nt
    s_mov_b32 s100, 43008
    buffer_load_dwordx4 v[88:91], v244, s[48:51], s100 offen nt
    s_mov_b32 s100, 43008
    buffer_load_dwordx4 v[120:123], v244, s[52:55], s100 offen nt
    s_waitcnt vmcnt(17)
    s_barrier
    s_add_u32 m0, s64, 36864
    s_nop 0
    buffer_load_dwordx4 v4, s[28:31], s86 offen offset:0  lds
    s_add_u32 m0, s66, 59392
    s_nop 0
    buffer_load_dwordx4 v6, s[32:35], s87 offen offset:2048  lds
    s_add_u32 m0, s64, 38912
    s_add_u32 s101, s86, 32768
    buffer_load_dwordx4 v4, s[28:31], s101 offen offset:0  lds
    s_add_u32 m0, s66, 69632
    s_add_u32 s101, s87, 4096
    buffer_load_dwordx4 v6, s[32:35], s101 offen offset:0  lds
    s_add_u32 m0, s66, 53248
    s_nop 0
    buffer_load_dwordx4 v6, s[32:35], s87 offen offset:0  lds
    s_add_u32 m0, s65, 36864
    s_nop 0
    buffer_load_dwordx4 v5, s[28:31], s86 offen offset:0  lds
    s_add_u32 m0, s67, 59392
    s_nop 0
    s_nop 0
    buffer_load_dwordx4 v7, s[32:35], s87 offen offset:2048  lds
    s_add_u32 m0, s65, 38912
    s_add_u32 s101, s86, 32768
    buffer_load_dwordx4 v5, s[28:31], s101 offen offset:0  lds
    s_add_u32 m0, s67, 69632
    s_add_u32 s101, s87, 4096
    buffer_load_dwordx4 v7, s[32:35], s101 offen offset:0  lds
    s_add_u32 m0, s67, 53248
    s_nop 0
    buffer_load_dwordx4 v7, s[32:35], s87 offen offset:0  lds
    s_add_u32 s86, s86, 128
    s_add_u32 s87, s87, 393216
    s_and_b32 s86, s86, 2047
    s_cselect_b32 s87, s87, 0
    s_waitcnt vmcnt(17)
    s_barrier
    s_add_u32 m0, s64, 77824
    s_nop 0
    buffer_load_dwordx4 v4, s[28:31], s86 offen offset:0  lds
    s_add_u32 m0, s66, 100352
    s_nop 0
    buffer_load_dwordx4 v6, s[32:35], s87 offen offset:2048  lds
    s_add_u32 m0, s64, 79872
    s_add_u32 s101, s86, 32768
    buffer_load_dwordx4 v4, s[28:31], s101 offen offset:0  lds
    s_add_u32 m0, s66, 110592
    s_add_u32 s101, s87, 4096
    buffer_load_dwordx4 v6, s[32:35], s101 offen offset:0  lds
    s_add_u32 m0, s66, 94208
    s_nop 0
    buffer_load_dwordx4 v6, s[32:35], s87 offen offset:0  lds
    s_add_u32 m0, s65, 77824
    s_nop 0
    buffer_load_dwordx4 v5, s[28:31], s86 offen offset:0  lds
    s_add_u32 m0, s67, 100352
    s_nop 0
    s_nop 0
    buffer_load_dwordx4 v7, s[32:35], s87 offen offset:2048  lds
    s_add_u32 m0, s65, 79872
    s_add_u32 s101, s86, 32768
    buffer_load_dwordx4 v5, s[28:31], s101 offen offset:0  lds
    s_add_u32 m0, s67, 110592
    s_add_u32 s101, s87, 4096
    buffer_load_dwordx4 v7, s[32:35], s101 offen offset:0  lds
    s_add_u32 m0, s67, 94208
    s_nop 0
    buffer_load_dwordx4 v7, s[32:35], s87 offen offset:0  lds
    s_add_u32 s86, s86, 128
    s_add_u32 s87, s87, 393216
    s_and_b32 s86, s86, 2047
    s_cselect_b32 s87, s87, 0
    s_waitcnt vmcnt(10)
    s_barrier
    s_add_u32 m0, s64, 118784
    s_nop 0
    buffer_load_dwordx4 v4, s[28:31], s86 offen offset:0  lds
    s_add_u32 m0, s66, 141312
    s_nop 0
    buffer_load_dwordx4 v6, s[32:35], s87 offen offset:2048  lds
    s_add_u32 m0, s64, 120832
    s_add_u32 s101, s86, 32768
    buffer_load_dwordx4 v4, s[28:31], s101 offen offset:0  lds
    s_add_u32 m0, s66, 151552
    s_add_u32 s101, s87, 4096
    buffer_load_dwordx4 v6, s[32:35], s101 offen offset:0  lds
    s_add_u32 m0, s66, 135168
    s_nop 0
    buffer_load_dwordx4 v6, s[32:35], s87 offen offset:0  lds
    s_add_u32 m0, s65, 118784
    s_nop 0
    buffer_load_dwordx4 v5, s[28:31], s86 offen offset:0  lds
    s_add_u32 m0, s67, 141312
    s_nop 0
    s_nop 0
    buffer_load_dwordx4 v7, s[32:35], s87 offen offset:2048  lds
    s_add_u32 m0, s65, 120832
    s_add_u32 s101, s86, 32768
    buffer_load_dwordx4 v5, s[28:31], s101 offen offset:0  lds
    s_add_u32 m0, s67, 151552
    s_add_u32 s101, s87, 4096
    buffer_load_dwordx4 v7, s[32:35], s101 offen offset:0  lds
    s_add_u32 m0, s67, 135168
    s_nop 0
    buffer_load_dwordx4 v7, s[32:35], s87 offen offset:0  lds
    s_add_u32 s86, s86, 128
    s_add_u32 s87, s87, 393216
    s_and_b32 s86, s86, 2047
    s_cselect_b32 s87, s87, 0
    s_waitcnt vmcnt(10)
    s_barrier
    s_add_u32 m0, s64, 36864
    s_nop 0
    buffer_load_dwordx4 v4, s[28:31], s86 offen offset:0  lds
    s_add_u32 m0, s66, 59392
    s_nop 0
    buffer_load_dwordx4 v6, s[32:35], s87 offen offset:2048  lds
    s_add_u32 m0, s64, 38912
    s_add_u32 s101, s86, 32768
    buffer_load_dwordx4 v4, s[28:31], s101 offen offset:0  lds
    s_add_u32 m0, s66, 69632
    s_add_u32 s101, s87, 4096
    buffer_load_dwordx4 v6, s[32:35], s101 offen offset:0  lds
    s_add_u32 m0, s66, 53248
    s_nop 0
    buffer_load_dwordx4 v6, s[32:35], s87 offen offset:0  lds
    s_add_u32 m0, s65, 36864
    s_nop 0
    buffer_load_dwordx4 v5, s[28:31], s86 offen offset:0  lds
    s_add_u32 m0, s67, 59392
    s_nop 0
    s_nop 0
    buffer_load_dwordx4 v7, s[32:35], s87 offen offset:2048  lds
    s_add_u32 m0, s65, 38912
    s_add_u32 s101, s86, 32768
    buffer_load_dwordx4 v5, s[28:31], s101 offen offset:0  lds
    s_add_u32 m0, s67, 69632
    s_add_u32 s101, s87, 4096
    buffer_load_dwordx4 v7, s[32:35], s101 offen offset:0  lds
    s_add_u32 m0, s67, 53248
    s_nop 0
    buffer_load_dwordx4 v7, s[32:35], s87 offen offset:0  lds
    s_add_u32 s86, s86, 128
    s_add_u32 s87, s87, 393216
    s_and_b32 s86, s86, 2047
    s_cselect_b32 s87, s87, 0
    s_waitcnt vmcnt(10)
    s_barrier
    s_cmp_lg_u32 s76, 0
    s_cbranch_scc1 Lpl_6
    s_mov_b32 exec_hi, 0xffff
    buffer_load_dwordx2 v[198:199], v196, s[36:39], 0 offen sc1
    s_mov_b64 exec, -1
Lpl_6:
    s_add_u32 m0, s64, 77824
    s_nop 0
    buffer_load_dwordx4 v4, s[28:31], s86 offen offset:0  lds
    s_add_u32 m0, s66, 100352
    s_nop 0
    s_nop 0
    buffer_load_dwordx4 v6, s[32:35], s87 offen offset:2048  lds
    s_add_u32 m0, s64, 79872
    s_add_u32 s101, s86, 32768
    buffer_load_dwordx4 v4, s[28:31], s101 offen offset:0  lds
    s_add_u32 m0, s66, 110592
    s_add_u32 s101, s87, 4096
    buffer_load_dwordx4 v6, s[32:35], s101 offen offset:0  lds
    s_add_u32 m0, s66, 94208
    s_nop 0
    buffer_load_dwordx4 v6, s[32:35], s87 offen offset:0  lds
    s_add_u32 m0, s65, 77824
    s_nop 0
    buffer_load_dwordx4 v5, s[28:31], s86 offen offset:0  lds
    s_add_u32 m0, s67, 100352
    s_nop 0
    s_nop 0
    buffer_load_dwordx4 v7, s[32:35], s87 offen offset:2048  lds
    s_add_u32 m0, s65, 79872
    s_add_u32 s101, s86, 32768
    buffer_load_dwordx4 v5, s[28:31], s101 offen offset:0  lds
    s_add_u32 m0, s67, 110592
    s_add_u32 s101, s87, 4096
    buffer_load_dwordx4 v7, s[32:35], s101 offen offset:0  lds
    s_add_u32 m0, s67, 94208
    s_nop 0
    buffer_load_dwordx4 v7, s[32:35], s87 offen offset:0  lds
    s_add_u32 s86, s86, 128
    s_add_u32 s87, s87, 393216
    s_and_b32 s86, s86, 2047
    s_cselect_b32 s87, s87, 0
    s_waitcnt vmcnt(10)
    s_barrier
    s_cmp_lg_u32 s76, 2
    s_cbranch_scc1 Lc4_7
    s_mov_b32 exec_hi, -1
    buffer_load_dword v238, v63, s[40:43], 0 offen
    s_mov_b64 exec, -1
Lc4_7:
    s_add_u32 m0, s64, 118784
    s_nop 0
    buffer_load_dwordx4 v4, s[28:31], s86 offen offset:0  lds
    s_add_u32 m0, s66, 141312
    s_nop 0
    buffer_load_dwordx4 v6, s[32:35], s87 offen offset:2048  lds
    s_add_u32 m0, s64, 120832
    s_add_u32 s101, s86, 32768
    buffer_load_dwordx4 v4, s[28:31], s101 offen offset:0  lds
    s_add_u32 m0, s66, 151552
    s_add_u32 s101, s87, 4096
    buffer_load_dwordx4 v6, s[32:35], s101 offen offset:0  lds
    s_add_u32 m0, s66, 135168
    s_nop 0
    buffer_load_dwordx4 v6, s[32:35], s87 offen offset:0  lds
    s_add_u32 m0, s65, 118784
    s_nop 0
    buffer_load_dwordx4 v5, s[28:31], s86 offen offset:0  lds
    s_add_u32 m0, s67, 141312
    s_nop 0
    s_nop 0
    buffer_load_dwordx4 v7, s[32:35], s87 offen offset:2048  lds
    s_add_u32 m0, s65, 120832
    s_add_u32 s101, s86, 32768
    buffer_load_dwordx4 v5, s[28:31], s101 offen offset:0  lds
    s_add_u32 m0, s67, 151552
    s_add_u32 s101, s87, 4096
    buffer_load_dwordx4 v7, s[32:35], s101 offen offset:0  lds
    s_add_u32 m0, s67, 135168
    s_nop 0
    buffer_load_dwordx4 v7, s[32:35], s87 offen offset:0  lds
    s_add_u32 s86, s86, 128
    s_add_u32 s87, s87, 393216
    s_and_b32 s86, s86, 2047
    s_cselect_b32 s87, s87, 0
    s_waitcnt vmcnt(10)
    s_cmp_lg_u32 s76, 0
    s_cbranch_scc1 Lpc_8
    s_mov_b32 exec_hi, 0xffff
    s_mov_b32 s85, 0
    s_branch Lpk_9
Lspin_10:
    s_add_u32 s85, s85, 1
    s_cmp_gt_u32 s85, 400000
    s_cbranch_scc1 L_end
    buffer_load_dwordx2 v[198:199], v196, s[36:39], 0 offen sc1
    s_waitcnt vmcnt(0)
Lpk_9:
    v_cmp_ne_u32 vcc, s75, v198
    s_cbranch_vccnz Lspin_10
    v_cmp_ne_u32 vcc, s99, v199
    s_mov_b64 exec, -1
    s_lshr_b32 s78, vcc_lo, 16
    s_cselect_b32 s78, 0, 1
    s_cmp_eq_u32 vcc_hi, 0
    s_cselect_b32 s79, 2, 0
    s_or_b32 s78, s78, s79
    s_and_b32 s78, s78, 3
    v_mov_b32_e64 v198, s78
    v_mov_b32 v199, 163584
    ds_write_b32 v199, v198
    s_waitcnt lgkmcnt(0)
Lpc_8:
    s_barrier
    v_lshrrev_b32 v196, 4, v2
    v_and_b32 v197, 15, v2
    v_lshlrev_b32_e64 v197, 4, v197
    v_lshl_add_u32 v198, v196, 10, v197
    s_lshl_b32 s78, s69, 14
    s_lshl_b32 s79, s76, 8
    s_add_u32 s78, s78, s79
    s_nop 0
    s_add_u32 s78, s78, 65536
    buffer_load_dwordx4 v[20:23], v198, s[36:39], s78 offen sc1
    s_add_u32 s78, s78, 4096
    buffer_load_dwordx4 v[24:27], v198, s[36:39], s78 offen sc1
    s_add_u32 s78, s78, 4096
    buffer_load_dwordx4 v[28:31], v198, s[36:39], s78 offen sc1
    s_add_u32 s78, s78, 4096
    buffer_load_dwordx4 v[32:35], v198, s[36:39], s78 offen sc1
    v_mul_u32_u24 v198, 768, v196
    v_add_u32_e64 v198, v198, v197
    s_mul_i32 s78, s70, 12288
    s_lshl_b32 s79, s76, 8
    s_add_u32 s78, s78, s79
    s_add_u32 s78, s78, 327680
    s_cmp_eq_u32 s76, 3
    s_nop 0
    s_cselect_b32 s78, 0x10000000, s78
    buffer_load_dwordx4 v[36:39], v198, s[36:39], s78 offen sc1
    s_add_u32 s78, s78, 3072
    buffer_load_dwordx4 v[40:43], v198, s[36:39], s78 offen sc1
    s_add_u32 s78, s78, 3072
    buffer_load_dwordx4 v[44:47], v198, s[36:39], s78 offen sc1
    s_add_u32 s78, s78, 3072
    buffer_load_dwordx4 v[48:51], v198, s[36:39], s78 offen sc1
    s_add_u32 m0, s84, 0
    s_mov_b32 s100, 0
    buffer_load_dwordx4 v246, s[40:43], s100 offen  lds
    s_add_u32 m0, s84, 4096
    s_mov_b32 s100, 65536
    buffer_load_dwordx4 v246, s[40:43], s100 offen  lds
    s_add_u32 m0, s84, 8192
    s_mov_b32 s100, 131072
    buffer_load_dwordx4 v246, s[40:43], s100 offen  lds
    s_add_u32 m0, s84, 12288
    s_mov_b32 s100, 196608
    buffer_load_dwordx4 v246, s[40:43], s100 offen  lds
    s_waitcnt vmcnt(12)
    s_waitcnt lgkmcnt(0)
    s_barrier
    s_setprio 2
    s_add_u32 m0, s84, 16384
    s_mov_b32 s100, 262144
    buffer_load_dwordx4 v246, s[40:43], s100 offen  lds
    s_waitcnt vmcnt(9)
    v_add_f32 v20, v20, v24
    v_add_f32 v21, v21, v25
    v_add_f32 v22, v22, v26
    v_add_f32 v23, v23, v27
    v_add_f32 v20, v20, v28
    v_add_f32_e64 v21, v21, v29
    s_add_u32 m0, s84, 20480
    s_mov_b32 s100, 327680
    buffer_load_dwordx4 v246, s[40:43], s100 offen  lds
    v_add_f32 v22, v22, v30
    v_add_f32 v23, v23, v31
    v_add_f32 v20, v20, v32
    v_add_f32 v21, v21, v33
    v_add_f32 v22, v22, v34
    v_add_f32 v23, v23, v35
    s_nop 0
    v_permlane32_swap_b32 v20, v22
    s_add_u32 m0, s84, 24576
    s_mov_b32 s100, 393216
    buffer_load_dwordx4 v246, s[40:43], s100 offen  lds
    v_permlane32_swap_b32 v21, v23
    v_add_f32 v20, v20, v22
    v_add_f32 v21, v21, v23
    v_mov_b32 v22, v20
    v_mov_b32 v23, v21
    s_nop 0
    v_permlane16_swap_b32 v20, v22
    v_permlane16_swap_b32 v21, v23
    v_add_f32_e64 v20, v20, v22
    s_add_u32 m0, s84, 28672
    s_mov_b32 s100, 458752
    buffer_load_dwordx4 v246, s[40:43], s100 offen  lds
    v_add_f32_e64 v21, v21, v23
    v_mul_f32 v24, 0x3a800000, v20
    v_mul_f32 v26, 0x3a800000, v21
    v_fma_f32 v26, -v24, v24, v26
    v_max_f32_e64 v26, 0, v26
    v_cvt_pk_bf16_f32 v24, v24, v24
    v_and_b32 v24, 0xffff0000, v24
    s_add_u32 m0, s84, 32768
    s_mov_b32 s100, 524288
    buffer_load_dwordx4 v246, s[40:43], s100 offen  lds
    v_cvt_pk_bf16_f32 v26, v26, v26
    v_and_b32 v26, 0xffff0000, v26
    v_add_f32 v26, 0x3727c5ac, v26
    v_cvt_pk_bf16_f32 v26, v26, v26
    v_and_b32 v26, 0xffff0000, v26
    v_sqrt_f32 v26, v26
    s_nop 0
    v_cvt_pk_bf16_f32 v26, v26, v26
    v_and_b32 v26, 0xffff0000, v26
    s_add_u32 m0, s84, 36864
    s_mov_b32 s100, 589824
    buffer_load_dwordx4 v246, s[40:43], s100 offen  lds
    v_rcp_f32_e64 v25, v26
    v_xor_b32 v26, 0x80000000, v24
    v_lshrrev_b32 v27, 16, v26
    v_or_b32 v26, v26, v27
    v_mov_b32 v27, 0
    v_and_b32 v196, 15, v2
    v_lshrrev_b32_e64 v197, 5, v2
    s_add_u32 m0, s84, 40960
    s_mov_b32 s100, 655360
    buffer_load_dwordx4 v246, s[40:43], s100 offen  lds
    v_lshl_add_u32 v196, v196, 1, v197
    s_lshl_b32 s78, s76, 5
    v_add_u32 v196, s78, v196
    v_lshlrev_b32_e64 v197, 3, v196
    v_add_u32 v197, 159744, v197
    v_lshlrev_b32_e64 v196, 2, v196
    v_add_u32 v196, 162304, v196
    s_add_u32 m0, s84, 45056
    s_mov_b32 s100, 720896
    buffer_load_dwordx4 v246, s[40:43], s100 offen  lds
    ds_write_b64 v197, v[26:27]
    ds_write_b32 v196, v25
    s_waitcnt vmcnt(12)
    v_add_f32 v36, v36, v40
    v_add_f32 v37, v37, v41
    v_add_f32 v38, v38, v42
    v_add_f32 v39, v39, v43
    v_add_f32 v36, v36, v44
    s_add_u32 m0, s84, 49152
    s_mov_b32 s100, 786432
    buffer_load_dwordx4 v246, s[40:43], s100 offen  lds
    v_add_f32 v37, v37, v45
    v_add_f32 v38, v38, v46
    v_add_f32 v39, v39, v47
    v_add_f32 v36, v36, v48
    v_add_f32 v37, v37, v49
    v_add_f32 v38, v38, v50
    v_add_f32_e64 v39, v39, v51
    s_add_u32 m0, s84, 53248
    s_mov_b32 s100, 851968
    buffer_load_dwordx4 v246, s[40:43], s100 offen  lds
    v_permlane32_swap_b32 v36, v38
    v_permlane32_swap_b32 v37, v39
    v_add_f32 v36, v36, v38
    v_add_f32 v37, v37, v39
    s_nop 1
    v_permlane16_swap_b32 v36, v37
    v_add_f32_e64 v36, v36, v37
    v_cvt_pk_bf16_f32 v37, v36, v36
    v_and_b32 v37, 0xffff0000, v37
    s_add_u32 m0, s84, 57344
    s_mov_b32 s100, 917504
    buffer_load_dwordx4 v246, s[40:43], s100 offen  lds
    v_sub_f32_e64 v38, v36, v37
    v_cvt_pk_bf16_f32 v38, v37, v38
    v_mov_b32 v39, 0
    v_and_b32 v196, 15, v2
    v_lshrrev_b32_e64 v197, 4, v2
    v_lshl_add_u32 v196, v196, 2, v197
    s_lshl_b32 s78, s76, 9
    s_add_u32 m0, s84, 61440
    s_mov_b32 s100, 983040
    buffer_load_dwordx4 v246, s[40:43], s100 offen  lds
    s_add_u32 s78, s78, 160768
    v_lshl_add_u32 v196, v196, 3, s78
    v_and_b32 v197, 15, v2
    v_lshlrev_b32_e64 v197, 3, v197
    v_add_u32 v197, 162816, v197
    v_mov_b32 v198, 0x3f803f80
    s_cmp_eq_u32 s76, 3
    s_cselect_b64 vcc, -1, 0
    v_cndmask_b32 v196, v196, v197, vcc
    v_cndmask_b32 v38, v38, v198, vcc
    v_cndmask_b32_e64 v39, v39, v198, vcc
    ds_write_b64 v196, v[38:39]
    s_setprio 0
    s_waitcnt lgkmcnt(0)
    s_barrier
    s_branch L_phend
L_ph1:
    s_add_u32 m0, s64, 36864
    s_nop 0
    buffer_load_dwordx4 v4, s[28:31], s86 offen offset:0  lds
    s_add_u32 m0, s66, 59392
    s_nop 0
    buffer_load_dwordx4 v6, s[32:35], s87 offen offset:2048  lds
    s_add_u32 m0, s64, 38912
    s_add_u32 s101, s86, 32768
    buffer_load_dwordx4 v4, s[28:31], s101 offen offset:0  lds
    s_add_u32 m0, s66, 69632
    s_add_u32 s101, s87, 4096
    buffer_load_dwordx4 v6, s[32:35], s101 offen offset:0  lds
    s_add_u32 m0, s66, 53248
    s_nop 0
    buffer_load_dwordx4 v6, s[32:35], s87 offen offset:0  lds
    s_add_u32 m0, s65, 36864
    s_nop 0
    buffer_load_dwordx4 v5, s[28:31], s86 offen offset:0  lds
    s_add_u32 m0, s67, 59392
    s_nop 0
    s_nop 0
    buffer_load_dwordx4 v7, s[32:35], s87 offen offset:2048  lds
    s_add_u32 m0, s65, 38912
    s_add_u32 s101, s86, 32768
    buffer_load_dwordx4 v5, s[28:31], s101 offen offset:0  lds
    s_add_u32 m0, s67, 69632
    s_add_u32 s101, s87, 4096
    buffer_load_dwordx4 v7, s[32:35], s101 offen offset:0  lds
    s_add_u32 m0, s67, 53248
    s_nop 0
    buffer_load_dwordx4 v7, s[32:35], s87 offen offset:0  lds
    s_add_u32 s86, s86, 128
    s_add_u32 s87, s87, 393216
    s_and_b32 s86, s86, 2047
    s_cselect_b32 s87, s87, 0
    s_waitcnt vmcnt(10)
    s_waitcnt lgkmcnt(0)
    s_barrier
    s_setprio 2
    s_add_u32 m0, s64, 77824
    s_nop 0
    buffer_load_dwordx4 v4, s[28:31], s86 offen offset:0  lds
    v_mov_b32 v200, 0x3f803f80
    v_mov_b32 v201, 0x3f803f80
    s_add_u32 m0, s66, 100352
    s_nop 0
    buffer_load_dwordx4 v6, s[32:35], s87 offen offset:2048  lds
    v_mov_b32 v202, 0x3f803f80
    v_mov_b32 v203, 0x3f803f80
    s_nop 1
    s_nop 0
    v_mfma_f32_16x16x32_bf16 v[204:207], v[200:203], v[20:23], 0
    s_add_u32 m0, s64, 79872
    s_add_u32 s101, s86, 32768
    buffer_load_dwordx4 v4, s[28:31], s101 offen offset:0  lds
    v_mfma_f32_16x16x32_bf16 v[212:215], v[20:23], v[20:23], 0
    v_mfma_f32_16x16x32_bf16 v[208:211], v[200:203], v[24:27], 0
    v_mfma_f32_16x16x32_bf16 v[216:219], v[24:27], v[24:27], 0
    s_add_u32 m0, s66, 110592
    s_add_u32 s101, s87, 4096
    buffer_load_dwordx4 v6, s[32:35], s101 offen offset:0  lds
    v_mfma_f32_16x16x32_bf16 v[220:223], v[200:203], v[36:39], 0
    v_mfma_f32_16x16x32_bf16 v[224:227], v[200:203], v[44:47], 0
    s_add_u32 m0, s66, 94208
    s_nop 0
    buffer_load_dwordx4 v6, s[32:35], s87 offen offset:0  lds
    v_mfma_f32_16x16x32_bf16 v[228:231], v[200:203], v[52:55], 0
    v_mfma_f32_16x16x32_bf16 v[204:207], v[200:203], v[28:31], v[204:207]
    v_mfma_f32_16x16x32_bf16 v[212:215], v[28:31], v[28:31], v[212:215]
    s_add_u32 m0, s65, 77824
    s_nop 0
    buffer_load_dwordx4 v5, s[28:31], s86 offen offset:0  lds
    v_mfma_f32_16x16x32_bf16 v[208:211], v[200:203], v[32:35], v[208:211]
    v_mfma_f32_16x16x32_bf16 v[216:219], v[32:35], v[32:35], v[216:219]
    v_mfma_f32_16x16x32_bf16 v[220:223], v[200:203], v[40:43], v[220:223]
    s_add_u32 m0, s67, 100352
    s_nop 0
    buffer_load_dwordx4 v7, s[32:35], s87 offen offset:2048  lds
    v_mfma_f32_16x16x32_bf16 v[224:227], v[200:203], v[48:51], v[224:227]
    v_mfma_f32_16x16x32_bf16 v[228:231], v[200:203], v[56:59], v[228:231]
    v_and_b32 v196, 3, v2
    s_add_u32 m0, s65, 79872
    s_add_u32 s101, s86, 32768
    buffer_load_dwordx4 v5, s[28:31], s101 offen offset:0  lds
    v_cmp_eq_u32 s[90:91], 1, v196
    v_cmp_eq_u32 s[92:93], 2, v196
    s_add_u32 m0, s67, 110592
    s_add_u32 s101, s87, 4096
    buffer_load_dwordx4 v7, s[32:35], s101 offen offset:0  lds
    v_cmp_eq_u32_e64 vcc, 3, v196
    v_cndmask_b32 v212, v212, v213, s[90:91]
    v_cndmask_b32 v212, v212, v214, s[92:93]
    s_add_u32 m0, s67, 94208
    s_nop 0
    buffer_load_dwordx4 v7, s[32:35], s87 offen offset:0  lds
    s_add_u32 s86, s86, 128
    s_add_u32 s87, s87, 393216
    s_and_b32 s86, s86, 2047
    s_cselect_b32 s87, s87, 0
    v_cndmask_b32_e64 v205, v212, v215, vcc
    v_cndmask_b32 v216, v216, v217, s[90:91]
    v_cndmask_b32 v216, v216, v218, s[92:93]
    buffer_store_dwordx4 v[16:19], v14, s[36:39], s96 offen offset:0 sc1
    v_cndmask_b32 v209, v216, v219, vcc
    v_lshrrev_b32_e64 v196, 4, v2
    s_mov_b32 s100, 0
    buffer_load_dwordx4 v[64:67], v244, s[48:51], s100 offen nt
    v_cmp_eq_u32 s[90:91], 1, v196
    v_cmp_eq_u32 vcc, 2, v196
    s_nop 0
    v_cndmask_b32 v220, v220, v224, s[90:91]
    s_mov_b32 s100, 0
    buffer_load_dwordx4 v[96:99], v244, s[52:55], s100 offen nt
    v_cndmask_b32 v220, v220, v228, vcc
    s_mul_i32 s78, s77, 768
    s_mul_i32 s79, s76, 192
    s_mov_b32 s100, 7168
    buffer_load_dwordx4 v[68:71], v244, s[48:51], s100 offen nt
    s_add_u32 s78, s78, s79
    s_add_u32 s78, s78, 327680
    v_lshlrev_b32 v197, 2, v2
    s_mov_b32 s100, 7168
    buffer_load_dwordx4 v[100:103], v244, s[52:55], s100 offen nt
    s_mov_b32 exec_hi, 0xffff
    buffer_store_dword v220, v197, s[36:39], s78 offen sc1
    s_mov_b32 exec_hi, -1
    s_lshl_b32 s78, s69, 4
    s_mov_b32 s100, 14336
    buffer_load_dwordx4 v[72:75], v244, s[48:51], s100 offen nt
    s_add_u32 s78, s78, s70
    s_lshl_b32 s78, s78, 10
    s_lshl_b32 s79, s76, 8
    s_mov_b32 s100, 14336
    buffer_load_dwordx4 v[104:107], v244, s[52:55], s100 offen nt
    s_add_u32 s78, s78, s79
    s_add_u32 s78, s78, 65536
    v_and_b32_e64 v198, 15, v2
    s_mov_b32 s100, 21504
    buffer_load_dwordx4 v[76:79], v244, s[48:51], s100 offen nt
    v_lshlrev_b32_e64 v198, 3, v198
    s_mov_b32 exec_lo, 0x00f0000f
    s_mov_b32 exec_hi, 0xf0000f00
    buffer_store_dwordx2 v[204:205], v198, s[36:39], s78 offen offset:0 sc1
    s_mov_b64 exec, -1
    s_mov_b32 exec_lo, 0x00f0000f
    s_mov_b32 exec_hi, 0xf0000f00
    buffer_store_dwordx2 v[208:209], v198, s[36:39], s78 offen offset:128 sc1
    s_mov_b64 exec, -1
    s_setprio 0
    s_waitcnt vmcnt(21)
    s_waitcnt lgkmcnt(0)
    s_barrier
    s_add_u32 m0, s64, 118784
    s_nop 0
    buffer_load_dwordx4 v4, s[28:31], s86 offen offset:0  lds
    s_add_u32 m0, s66, 141312
    s_nop 0
    buffer_load_dwordx4 v6, s[32:35], s87 offen offset:2048  lds
    s_add_u32 m0, s64, 120832
    s_add_u32 s101, s86, 32768
    buffer_load_dwordx4 v4, s[28:31], s101 offen offset:0  lds
    s_add_u32 m0, s66, 151552
    s_add_u32 s101, s87, 4096
    buffer_load_dwordx4 v6, s[32:35], s101 offen offset:0  lds
    s_add_u32 m0, s66, 135168
    s_nop 0
    buffer_load_dwordx4 v6, s[32:35], s87 offen offset:0  lds
    s_add_u32 m0, s65, 118784
    s_nop 0
    buffer_load_dwordx4 v5, s[28:31], s86 offen offset:0  lds
    s_add_u32 m0, s67, 141312
    s_nop 0
    s_nop 0
    buffer_load_dwordx4 v7, s[32:35], s87 offen offset:2048  lds
    s_add_u32 m0, s65, 120832
    s_add_u32 s101, s86, 32768
    buffer_load_dwordx4 v5, s[28:31], s101 offen offset:0  lds
    s_add_u32 m0, s67, 151552
    s_add_u32 s101, s87, 4096
    buffer_load_dwordx4 v7, s[32:35], s101 offen offset:0  lds
    s_add_u32 m0, s67, 135168
    s_nop 0
    buffer_load_dwordx4 v7, s[32:35], s87 offen offset:0  lds
    s_add_u32 s86, s86, 128
    s_add_u32 s87, s87, 393216
    s_and_b32 s86, s86, 2047
    s_cselect_b32 s87, s87, 0
    s_waitcnt vmcnt(10)
    s_barrier
    s_cmp_lg_u32 s76, 0
    s_cbranch_scc1 Lfl_11
    s_getreg_b32 s99, hwreg(HW_REG_XCC_ID, 0, 4)
    v_mov_b32 v198, s75
    v_mov_b32 v199, s99
    v_lshlrev_b32 v197, 3, v2
    s_lshl_b32 s78, s77, 7
    s_lshl_b32 s79, s77, 9
    s_add_u32 s79, s79, 8912896
    s_add_u32 s78, s78, 4096
    s_lshl_b32 s80, s71, 4
    s_add_u32 s80, s80, s72
    s_lshl_b32 s80, s80, 7
    s_add_u32 s80, s80, 8847360
    s_mov_b64 exec, 0xffff
    buffer_store_dwordx2 v[198:199], v197, s[36:39], s78 offen sc1
    buffer_store_dwordx2 v[198:199], v197, s[36:39], s80 offen sc1
    s_mov_b64 exec, -1
    v_not_b32 v200, v198
    v_mov_b32 v201, 0
    buffer_store_dwordx2 v[200:201], v197, s[36:39], s79 offen sc1
    v_and_b32 v196, 15, v2
    v_lshlrev_b32 v197, 4, v196
    v_add_u32_e64 v197, s69, v197
    s_lshl_b32 s78, s70, 4
    s_lshl_b32 s79, s71, 4
    s_add_u32 s79, s79, 69088
    v_mov_b32 v202, s78
    v_mov_b32 v203, s79
    v_cmp_gt_u32 vcc, 32, v2
    s_nop 1
    v_cndmask_b32 v202, v203, v202, vcc
    v_add_u32 v196, v202, v196
    v_cmp_gt_u32 vcc, 16, v2
    s_nop 1
    v_cndmask_b32 v196, v196, v197, vcc
    v_lshlrev_b32 v196, 7, v196
    v_add_u32 v196, 4096, v196
Lfl_11:
    s_add_u32 m0, s64, 36864
    s_nop 0
    buffer_load_dwordx4 v4, s[28:31], s86 offen offset:0  lds
    s_add_u32 m0, s66, 59392
    s_nop 0
    buffer_load_dwordx4 v6, s[32:35], s87 offen offset:2048  lds
    s_add_u32 m0, s64, 38912
    s_add_u32 s101, s86, 32768
    buffer_load_dwordx4 v4, s[28:31], s101 offen offset:0  lds
    s_add_u32 m0, s66, 69632
    s_add_u32 s101, s87, 4096
    buffer_load_dwordx4 v6, s[32:35], s101 offen offset:0  lds
    s_add_u32 m0, s66, 53248
    s_nop 0
    buffer_load_dwordx4 v6, s[32:35], s87 offen offset:0  lds
    s_add_u32 m0, s65, 36864
    s_nop 0
    buffer_load_dwordx4 v5, s[28:31], s86 offen offset:0  lds
    s_add_u32 m0, s67, 59392
    s_nop 0
    s_nop 0
    buffer_load_dwordx4 v7, s[32:35], s87 offen offset:2048  lds
    s_add_u32 m0, s65, 38912
    s_add_u32 s101, s86, 32768
    buffer_load_dwordx4 v5, s[28:31], s101 offen offset:0  lds
    s_add_u32 m0, s67, 69632
    s_add_u32 s101, s87, 4096
    buffer_load_dwordx4 v7, s[32:35], s101 offen offset:0  lds
    s_add_u32 m0, s67, 53248
    s_nop 0
    buffer_load_dwordx4 v7, s[32:35], s87 offen offset:0  lds
    s_add_u32 s86, s86, 128
    s_add_u32 s87, s87, 393216
    s_and_b32 s86, s86, 2047
    s_cselect_b32 s87, s87, 0
    s_waitcnt vmcnt(10)
    s_barrier
    s_add_u32 m0, s64, 77824
    s_nop 0
    buffer_load_dwordx4 v4, s[28:31], s86 offen offset:0  lds
    s_add_u32 m0, s66, 100352
    s_nop 0
    buffer_load_dwordx4 v6, s[32:35], s87 offen offset:2048  lds
    s_add_u32 m0, s64, 79872
    s_add_u32 s101, s86, 32768
    buffer_load_dwordx4 v4, s[28:31], s101 offen offset:0  lds
    s_add_u32 m0, s66, 110592
    s_add_u32 s101, s87, 4096
    buffer_load_dwordx4 v6, s[32:35], s101 offen offset:0  lds
    s_add_u32 m0, s66, 94208
    s_nop 0
    buffer_load_dwordx4 v6, s[32:35], s87 offen offset:0  lds
    s_add_u32 m0, s65, 77824
    s_nop 0
    buffer_load_dwordx4 v5, s[28:31], s86 offen offset:0  lds
    s_add_u32 m0, s67, 100352
    s_nop 0
    s_nop 0
    buffer_load_dwordx4 v7, s[32:35], s87 offen offset:2048  lds
    s_add_u32 m0, s65, 79872
    s_add_u32 s101, s86, 32768
    buffer_load_dwordx4 v5, s[28:31], s101 offen offset:0  lds
    s_add_u32 m0, s67, 110592
    s_add_u32 s101, s87, 4096
    buffer_load_dwordx4 v7, s[32:35], s101 offen offset:0  lds
    s_add_u32 m0, s67, 94208
    s_nop 0
    buffer_load_dwordx4 v7, s[32:35], s87 offen offset:0  lds
    s_add_u32 s86, s86, 128
    s_add_u32 s87, s87, 393216
    s_and_b32 s86, s86, 2047
    s_cselect_b32 s87, s87, 0
    s_waitcnt vmcnt(10)
    s_barrier
    s_add_u32 m0, s64, 118784
    s_nop 0
    buffer_load_dwordx4 v4, s[28:31], s86 offen offset:0  lds
    s_add_u32 m0, s66, 141312
    s_nop 0
    buffer_load_dwordx4 v6, s[32:35], s87 offen offset:2048  lds
    s_add_u32 m0, s64, 120832
    s_add_u32 s101, s86, 32768
    buffer_load_dwordx4 v4, s[28:31], s101 offen offset:0  lds
    s_add_u32 m0, s66, 151552
    s_add_u32 s101, s87, 4096
    buffer_load_dwordx4 v6, s[32:35], s101 offen offset:0  lds
    s_add_u32 m0, s66, 135168
    s_nop 0
    buffer_load_dwordx4 v6, s[32:35], s87 offen offset:0  lds
    s_add_u32 m0, s65, 118784
    s_nop 0
    buffer_load_dwordx4 v5, s[28:31], s86 offen offset:0  lds
    s_add_u32 m0, s67, 141312
    s_nop 0
    s_nop 0
    buffer_load_dwordx4 v7, s[32:35], s87 offen offset:2048  lds
    s_add_u32 m0, s65, 120832
    s_add_u32 s101, s86, 32768
    buffer_load_dwordx4 v5, s[28:31], s101 offen offset:0  lds
    s_add_u32 m0, s67, 151552
    s_add_u32 s101, s87, 4096
    buffer_load_dwordx4 v7, s[32:35], s101 offen offset:0  lds
    s_add_u32 m0, s67, 135168
    s_nop 0
    buffer_load_dwordx4 v7, s[32:35], s87 offen offset:0  lds
    s_add_u32 s86, s86, 128
    s_add_u32 s87, s87, 393216
    s_and_b32 s86, s86, 2047
    s_cselect_b32 s87, s87, 0
    s_waitcnt vmcnt(10)
    s_barrier
    s_add_u32 m0, s64, 36864
    s_nop 0
    buffer_load_dwordx4 v4, s[28:31], s86 offen offset:0  lds
    s_add_u32 m0, s66, 59392
    s_nop 0
    buffer_load_dwordx4 v6, s[32:35], s87 offen offset:2048  lds
    s_add_u32 m0, s64, 38912
    s_add_u32 s101, s86, 32768
    buffer_load_dwordx4 v4, s[28:31], s101 offen offset:0  lds
    s_add_u32 m0, s66, 69632
    s_add_u32 s101, s87, 4096
    buffer_load_dwordx4 v6, s[32:35], s101 offen offset:0  lds
    s_add_u32 m0, s66, 53248
    s_nop 0
    buffer_load_dwordx4 v6, s[32:35], s87 offen offset:0  lds
    s_add_u32 m0, s65, 36864
    s_nop 0
    buffer_load_dwordx4 v5, s[28:31], s86 offen offset:0  lds
    s_add_u32 m0, s67, 59392
    s_nop 0
    s_nop 0
    buffer_load_dwordx4 v7, s[32:35], s87 offen offset:2048  lds
    s_add_u32 m0, s65, 38912
    s_add_u32 s101, s86, 32768
    buffer_load_dwordx4 v5, s[28:31], s101 offen offset:0  lds
    s_add_u32 m0, s67, 69632
    s_add_u32 s101, s87, 4096
    buffer_load_dwordx4 v7, s[32:35], s101 offen offset:0  lds
    s_add_u32 m0, s67, 53248
    s_nop 0
    buffer_load_dwordx4 v7, s[32:35], s87 offen offset:0  lds
    s_add_u32 s86, s86, 128
    s_add_u32 s87, s87, 393216
    s_and_b32 s86, s86, 2047
    s_cselect_b32 s87, s87, 0
    s_mov_b32 s100, 21504
    buffer_load_dwordx4 v[108:111], v244, s[52:55], s100 offen nt
    s_mov_b32 s100, 28672
    buffer_load_dwordx4 v[80:83], v244, s[48:51], s100 offen nt
    s_mov_b32 s100, 28672
    buffer_load_dwordx4 v[112:115], v244, s[52:55], s100 offen nt
    s_mov_b32 s100, 35840
    buffer_load_dwordx4 v[84:87], v244, s[48:51], s100 offen nt
    s_mov_b32 s100, 35840
    buffer_load_dwordx4 v[116:119], v244, s[52:55], s100 offen nt
    s_mov_b32 s100, 43008
    buffer_load_dwordx4 v[88:91], v244, s[48:51], s100 offen nt
    s_mov_b32 s100, 43008
    buffer_load_dwordx4 v[120:123], v244, s[52:55], s100 offen nt
    s_waitcnt vmcnt(17)
    s_barrier
    s_add_u32 m0, s64, 77824
    s_nop 0
    buffer_load_dwordx4 v4, s[28:31], s86 offen offset:0  lds
    s_add_u32 m0, s66, 100352
    s_nop 0
    buffer_load_dwordx4 v6, s[32:35], s87 offen offset:2048  lds
    s_add_u32 m0, s64, 79872
    s_add_u32 s101, s86, 32768
    buffer_load_dwordx4 v4, s[28:31], s101 offen offset:0  lds
    s_add_u32 m0, s66, 110592
    s_add_u32 s101, s87, 4096
    buffer_load_dwordx4 v6, s[32:35], s101 offen offset:0  lds
    s_add_u32 m0, s66, 94208
    s_nop 0
    buffer_load_dwordx4 v6, s[32:35], s87 offen offset:0  lds
    s_add_u32 m0, s65, 77824
    s_nop 0
    buffer_load_dwordx4 v5, s[28:31], s86 offen offset:0  lds
    s_add_u32 m0, s67, 100352
    s_nop 0
    s_nop 0
    buffer_load_dwordx4 v7, s[32:35], s87 offen offset:2048  lds
    s_add_u32 m0, s65, 79872
    s_add_u32 s101, s86, 32768
    buffer_load_dwordx4 v5, s[28:31], s101 offen offset:0  lds
    s_add_u32 m0, s67, 110592
    s_add_u32 s101, s87, 4096
    buffer_load_dwordx4 v7, s[32:35], s101 offen offset:0  lds
    s_add_u32 m0, s67, 94208
    s_nop 0
    buffer_load_dwordx4 v7, s[32:35], s87 offen offset:0  lds
    s_add_u32 s86, s86, 128
    s_add_u32 s87, s87, 393216
    s_and_b32 s86, s86, 2047
    s_cselect_b32 s87, s87, 0
    s_waitcnt vmcnt(17)
    s_barrier
    s_add_u32 m0, s64, 118784
    s_nop 0
    buffer_load_dwordx4 v4, s[28:31], s86 offen offset:0  lds
    s_add_u32 m0, s66, 141312
    s_nop 0
    buffer_load_dwordx4 v6, s[32:35], s87 offen offset:2048  lds
    s_add_u32 m0, s64, 120832
    s_add_u32 s101, s86, 32768
    buffer_load_dwordx4 v4, s[28:31], s101 offen offset:0  lds
    s_add_u32 m0, s66, 151552
    s_add_u32 s101, s87, 4096
    buffer_load_dwordx4 v6, s[32:35], s101 offen offset:0  lds
    s_add_u32 m0, s66, 135168
    s_nop 0
    buffer_load_dwordx4 v6, s[32:35], s87 offen offset:0  lds
    s_add_u32 m0, s65, 118784
    s_nop 0
    buffer_load_dwordx4 v5, s[28:31], s86 offen offset:0  lds
    s_add_u32 m0, s67, 141312
    s_nop 0
    s_nop 0
    buffer_load_dwordx4 v7, s[32:35], s87 offen offset:2048  lds
    s_add_u32 m0, s65, 120832
    s_add_u32 s101, s86, 32768
    buffer_load_dwordx4 v5, s[28:31], s101 offen offset:0  lds
    s_add_u32 m0, s67, 151552
    s_add_u32 s101, s87, 4096
    buffer_load_dwordx4 v7, s[32:35], s101 offen offset:0  lds
    s_add_u32 m0, s67, 135168
    s_nop 0
    buffer_load_dwordx4 v7, s[32:35], s87 offen offset:0  lds
    s_add_u32 s86, s86, 128
    s_add_u32 s87, s87, 393216
    s_and_b32 s86, s86, 2047
    s_cselect_b32 s87, s87, 0
    s_waitcnt vmcnt(10)
    s_barrier
    s_add_u32 m0, s64, 36864
    s_nop 0
    buffer_load_dwordx4 v4, s[28:31], s86 offen offset:0  lds
    s_add_u32 m0, s66, 59392
    s_nop 0
    buffer_load_dwordx4 v6, s[32:35], s87 offen offset:2048  lds
    s_add_u32 m0, s64, 38912
    s_add_u32 s101, s86, 32768
    buffer_load_dwordx4 v4, s[28:31], s101 offen offset:0  lds
    s_add_u32 m0, s66, 69632
    s_add_u32 s101, s87, 4096
    buffer_load_dwordx4 v6, s[32:35], s101 offen offset:0  lds
    s_add_u32 m0, s66, 53248
    s_nop 0
    buffer_load_dwordx4 v6, s[32:35], s87 offen offset:0  lds
    s_add_u32 m0, s65, 36864
    s_nop 0
    buffer_load_dwordx4 v5, s[28:31], s86 offen offset:0  lds
    s_add_u32 m0, s67, 59392
    s_nop 0
    s_nop 0
    buffer_load_dwordx4 v7, s[32:35], s87 offen offset:2048  lds
    s_add_u32 m0, s65, 38912
    s_add_u32 s101, s86, 32768
    buffer_load_dwordx4 v5, s[28:31], s101 offen offset:0  lds
    s_add_u32 m0, s67, 69632
    s_add_u32 s101, s87, 4096
    buffer_load_dwordx4 v7, s[32:35], s101 offen offset:0  lds
    s_add_u32 m0, s67, 53248
    s_nop 0
    buffer_load_dwordx4 v7, s[32:35], s87 offen offset:0  lds
    s_add_u32 s86, s86, 128
    s_add_u32 s87, s87, 393216
    s_and_b32 s86, s86, 2047
    s_cselect_b32 s87, s87, 0
    s_waitcnt vmcnt(10)
    s_barrier
    s_cmp_lg_u32 s76, 0
    s_cbranch_scc1 Lpl_12
    s_mov_b32 exec_hi, 0xffff
    buffer_load_dwordx2 v[198:199], v196, s[36:39], 0 offen sc1
    s_mov_b64 exec, -1
Lpl_12:
    s_add_u32 m0, s64, 77824
    s_nop 0
    buffer_load_dwordx4 v4, s[28:31], s86 offen offset:0  lds
    s_add_u32 m0, s66, 100352
    s_nop 0
    s_nop 0
    buffer_load_dwordx4 v6, s[32:35], s87 offen offset:2048  lds
    s_add_u32 m0, s64, 79872
    s_add_u32 s101, s86, 32768
    buffer_load_dwordx4 v4, s[28:31], s101 offen offset:0  lds
    s_add_u32 m0, s66, 110592
    s_add_u32 s101, s87, 4096
    buffer_load_dwordx4 v6, s[32:35], s101 offen offset:0  lds
    s_add_u32 m0, s66, 94208
    s_nop 0
    buffer_load_dwordx4 v6, s[32:35], s87 offen offset:0  lds
    s_add_u32 m0, s65, 77824
    s_nop 0
    buffer_load_dwordx4 v5, s[28:31], s86 offen offset:0  lds
    s_add_u32 m0, s67, 100352
    s_nop 0
    s_nop 0
    buffer_load_dwordx4 v7, s[32:35], s87 offen offset:2048  lds
    s_add_u32 m0, s65, 79872
    s_add_u32 s101, s86, 32768
    buffer_load_dwordx4 v5, s[28:31], s101 offen offset:0  lds
    s_add_u32 m0, s67, 110592
    s_add_u32 s101, s87, 4096
    buffer_load_dwordx4 v7, s[32:35], s101 offen offset:0  lds
    s_add_u32 m0, s67, 94208
    s_nop 0
    buffer_load_dwordx4 v7, s[32:35], s87 offen offset:0  lds
    s_add_u32 s86, s86, 128
    s_add_u32 s87, s87, 393216
    s_and_b32 s86, s86, 2047
    s_cselect_b32 s87, s87, 0
    s_waitcnt vmcnt(10)
    s_barrier
    s_cmp_lg_u32 s76, 2
    s_cbranch_scc1 Lc4_13
    s_mov_b32 exec_hi, -1
    buffer_load_dword v238, v63, s[40:43], 0 offen
    s_mov_b64 exec, -1
Lc4_13:
    s_add_u32 m0, s64, 118784
    s_nop 0
    buffer_load_dwordx4 v4, s[28:31], s86 offen offset:0  lds
    s_add_u32 m0, s66, 141312
    s_nop 0
    buffer_load_dwordx4 v6, s[32:35], s87 offen offset:2048  lds
    s_add_u32 m0, s64, 120832
    s_add_u32 s101, s86, 32768
    buffer_load_dwordx4 v4, s[28:31], s101 offen offset:0  lds
    s_add_u32 m0, s66, 151552
    s_add_u32 s101, s87, 4096
    buffer_load_dwordx4 v6, s[32:35], s101 offen offset:0  lds
    s_add_u32 m0, s66, 135168
    s_nop 0
    buffer_load_dwordx4 v6, s[32:35], s87 offen offset:0  lds
    s_add_u32 m0, s65, 118784
    s_nop 0
    buffer_load_dwordx4 v5, s[28:31], s86 offen offset:0  lds
    s_add_u32 m0, s67, 141312
    s_nop 0
    s_nop 0
    buffer_load_dwordx4 v7, s[32:35], s87 offen offset:2048  lds
    s_add_u32 m0, s65, 120832
    s_add_u32 s101, s86, 32768
    buffer_load_dwordx4 v5, s[28:31], s101 offen offset:0  lds
    s_add_u32 m0, s67, 151552
    s_add_u32 s101, s87, 4096
    buffer_load_dwordx4 v7, s[32:35], s101 offen offset:0  lds
    s_add_u32 m0, s67, 135168
    s_nop 0
    buffer_load_dwordx4 v7, s[32:35], s87 offen offset:0  lds
    s_add_u32 s86, s86, 128
    s_add_u32 s87, s87, 393216
    s_and_b32 s86, s86, 2047
    s_cselect_b32 s87, s87, 0
    s_waitcnt vmcnt(10)
    s_cmp_lg_u32 s76, 0
    s_cbranch_scc1 Lpc_14
    s_mov_b32 exec_hi, 0xffff
    s_mov_b32 s85, 0
    s_branch Lpk_15
Lspin_16:
    s_add_u32 s85, s85, 1
    s_cmp_gt_u32 s85, 400000
    s_cbranch_scc1 L_end
    buffer_load_dwordx2 v[198:199], v196, s[36:39], 0 offen sc1
    s_waitcnt vmcnt(0)
Lpk_15:
    v_cmp_ne_u32 vcc, s75, v198
    s_cbranch_vccnz Lspin_16
    v_cmp_ne_u32 vcc, s99, v199
    s_mov_b64 exec, -1
    s_lshr_b32 s78, vcc_lo, 16
    s_cselect_b32 s78, 0, 1
    s_cmp_eq_u32 vcc_hi, 0
    s_cselect_b32 s79, 2, 0
    s_or_b32 s78, s78, s79
    s_and_b32 s78, s78, 3
    v_mov_b32_e64 v198, s78
    v_mov_b32 v199, 163584
    ds_write_b32 v199, v198
    s_waitcnt lgkmcnt(0)
Lpc_14:
    s_barrier
    v_lshrrev_b32 v196, 4, v2
    v_and_b32 v197, 15, v2
    v_lshlrev_b32_e64 v197, 4, v197
    v_lshl_add_u32 v198, v196, 10, v197
    s_lshl_b32 s78, s69, 14
    s_lshl_b32 s79, s76, 8
    s_add_u32 s78, s78, s79
    s_nop 0
    s_add_u32 s78, s78, 65536
    buffer_load_dwordx4 v[20:23], v198, s[36:39], s78 offen sc1
    s_add_u32 s78, s78, 4096
    buffer_load_dwordx4 v[24:27], v198, s[36:39], s78 offen sc1
    s_add_u32 s78, s78, 4096
    buffer_load_dwordx4 v[28:31], v198, s[36:39], s78 offen sc1
    s_add_u32 s78, s78, 4096
    buffer_load_dwordx4 v[32:35], v198, s[36:39], s78 offen sc1
    v_mul_u32_u24 v198, 768, v196
    v_add_u32_e64 v198, v198, v197
    s_mul_i32 s78, s70, 12288
    s_lshl_b32 s79, s76, 8
    s_add_u32 s78, s78, s79
    s_add_u32 s78, s78, 327680
    s_cmp_eq_u32 s76, 3
    s_nop 0
    s_cselect_b32 s78, 0x10000000, s78
    buffer_load_dwordx4 v[36:39], v198, s[36:39], s78 offen sc1
    s_add_u32 s78, s78, 3072
    buffer_load_dwordx4 v[40:43], v198, s[36:39], s78 offen sc1
    s_add_u32 s78, s78, 3072
    buffer_load_dwordx4 v[44:47], v198, s[36:39], s78 offen sc1
    s_add_u32 s78, s78, 3072
    buffer_load_dwordx4 v[48:51], v198, s[36:39], s78 offen sc1
    s_add_u32 m0, s84, 0
    s_mov_b32 s100, 0
    buffer_load_dwordx4 v246, s[40:43], s100 offen  lds
    s_add_u32 m0, s84, 4096
    s_mov_b32 s100, 65536
    buffer_load_dwordx4 v246, s[40:43], s100 offen  lds
    s_add_u32 m0, s84, 8192
    s_mov_b32 s100, 131072
    buffer_load_dwordx4 v246, s[40:43], s100 offen  lds
    s_add_u32 m0, s84, 12288
    s_mov_b32 s100, 196608
    buffer_load_dwordx4 v246, s[40:43], s100 offen  lds
    s_waitcnt vmcnt(12)
    s_waitcnt lgkmcnt(0)
    s_barrier
    s_setprio 2
    s_add_u32 m0, s84, 16384
    s_mov_b32 s100, 262144
    buffer_load_dwordx4 v246, s[40:43], s100 offen  lds
    s_waitcnt vmcnt(9)
    v_add_f32 v20, v20, v24
    v_add_f32 v21, v21, v25
    v_add_f32 v22, v22, v26
    v_add_f32 v23, v23, v27
    v_add_f32 v20, v20, v28
    v_add_f32_e64 v21, v21, v29
    s_add_u32 m0, s84, 20480
    s_mov_b32 s100, 327680
    buffer_load_dwordx4 v246, s[40:43], s100 offen  lds
    v_add_f32 v22, v22, v30
    v_add_f32 v23, v23, v31
    v_add_f32 v20, v20, v32
    v_add_f32 v21, v21, v33
    v_add_f32 v22, v22, v34
    v_add_f32 v23, v23, v35
    s_nop 0
    v_permlane32_swap_b32 v20, v22
    s_add_u32 m0, s84, 24576
    s_mov_b32 s100, 393216
    buffer_load_dwordx4 v246, s[40:43], s100 offen  lds
    v_permlane32_swap_b32 v21, v23
    v_add_f32 v20, v20, v22
    v_add_f32 v21, v21, v23
    v_mov_b32 v22, v20
    v_mov_b32 v23, v21
    s_nop 0
    v_permlane16_swap_b32 v20, v22
    v_permlane16_swap_b32 v21, v23
    v_add_f32_e64 v20, v20, v22
    s_add_u32 m0, s84, 28672
    s_mov_b32 s100, 458752
    buffer_load_dwordx4 v246, s[40:43], s100 offen  lds
    v_add_f32_e64 v21, v21, v23
    v_mul_f32 v24, 0x3a800000, v20
    v_mul_f32 v26, 0x3a800000, v21
    v_fma_f32 v26, -v24, v24, v26
    v_max_f32_e64 v26, 0, v26
    v_cvt_pk_bf16_f32 v24, v24, v24
    v_and_b32 v24, 0xffff0000, v24
    s_add_u32 m0, s84, 32768
    s_mov_b32 s100, 524288
    buffer_load_dwordx4 v246, s[40:43], s100 offen  lds
    v_cvt_pk_bf16_f32 v26, v26, v26
    v_and_b32 v26, 0xffff0000, v26
    v_add_f32 v26, 0x3727c5ac, v26
    v_cvt_pk_bf16_f32 v26, v26, v26
    v_and_b32 v26, 0xffff0000, v26
    v_sqrt_f32 v26, v26
    s_nop 0
    v_cvt_pk_bf16_f32 v26, v26, v26
    v_and_b32 v26, 0xffff0000, v26
    s_add_u32 m0, s84, 36864
    s_mov_b32 s100, 589824
    buffer_load_dwordx4 v246, s[40:43], s100 offen  lds
    v_rcp_f32_e64 v25, v26
    v_xor_b32 v26, 0x80000000, v24
    v_lshrrev_b32 v27, 16, v26
    v_or_b32 v26, v26, v27
    v_mov_b32 v27, 0
    v_and_b32 v196, 15, v2
    v_lshrrev_b32_e64 v197, 5, v2
    s_add_u32 m0, s84, 40960
    s_mov_b32 s100, 655360
    buffer_load_dwordx4 v246, s[40:43], s100 offen  lds
    v_lshl_add_u32 v196, v196, 1, v197
    s_lshl_b32 s78, s76, 5
    v_add_u32 v196, s78, v196
    v_lshlrev_b32_e64 v197, 3, v196
    v_add_u32 v197, 159744, v197
    v_lshlrev_b32_e64 v196, 2, v196
    v_add_u32 v196, 162304, v196
    s_add_u32 m0, s84, 45056
    s_mov_b32 s100, 720896
    buffer_load_dwordx4 v246, s[40:43], s100 offen  lds
    ds_write_b64 v197, v[26:27]
    ds_write_b32 v196, v25
    s_waitcnt vmcnt(12)
    v_add_f32 v36, v36, v40
    v_add_f32 v37, v37, v41
    v_add_f32 v38, v38, v42
    v_add_f32 v39, v39, v43
    v_add_f32 v36, v36, v44
    s_add_u32 m0, s84, 49152
    s_mov_b32 s100, 786432
    buffer_load_dwordx4 v246, s[40:43], s100 offen  lds
    v_add_f32 v37, v37, v45
    v_add_f32 v38, v38, v46
    v_add_f32 v39, v39, v47
    v_add_f32 v36, v36, v48
    v_add_f32 v37, v37, v49
    v_add_f32 v38, v38, v50
    v_add_f32_e64 v39, v39, v51
    s_add_u32 m0, s84, 53248
    s_mov_b32 s100, 851968
    buffer_load_dwordx4 v246, s[40:43], s100 offen  lds
    v_permlane32_swap_b32 v36, v38
    v_permlane32_swap_b32 v37, v39
    v_add_f32 v36, v36, v38
    v_add_f32 v37, v37, v39
    s_nop 1
    v_permlane16_swap_b32 v36, v37
    v_add_f32_e64 v36, v36, v37
    v_cvt_pk_bf16_f32 v37, v36, v36
    v_and_b32 v37, 0xffff0000, v37
    s_add_u32 m0, s84, 57344
    s_mov_b32 s100, 917504
    buffer_load_dwordx4 v246, s[40:43], s100 offen  lds
    v_sub_f32_e64 v38, v36, v37
    v_cvt_pk_bf16_f32 v38, v37, v38
    v_mov_b32 v39, 0
    v_and_b32 v196, 15, v2
    v_lshrrev_b32_e64 v197, 4, v2
    v_lshl_add_u32 v196, v196, 2, v197
    s_lshl_b32 s78, s76, 9
    s_add_u32 m0, s84, 61440
    s_mov_b32 s100, 983040
    buffer_load_dwordx4 v246, s[40:43], s100 offen  lds
    s_add_u32 s78, s78, 160768
    v_lshl_add_u32 v196, v196, 3, s78
    v_and_b32 v197, 15, v2
    v_lshlrev_b32_e64 v197, 3, v197
    v_add_u32 v197, 162816, v197
    v_mov_b32 v198, 0x3f803f80
    s_cmp_eq_u32 s76, 3
    s_cselect_b64 vcc, -1, 0
    v_cndmask_b32 v196, v196, v197, vcc
    v_cndmask_b32 v38, v38, v198, vcc
    v_cndmask_b32_e64 v39, v39, v198, vcc
    ds_write_b64 v196, v[38:39]
    s_setprio 0
    s_waitcnt lgkmcnt(0)
    s_barrier
    s_branch L_phend
L_ph2:
    s_add_u32 m0, s64, 36864
    s_nop 0
    buffer_load_dwordx4 v4, s[28:31], s86 offen offset:0  lds
    s_add_u32 m0, s66, 59392
    s_nop 0
    buffer_load_dwordx4 v6, s[32:35], s87 offen offset:2048  lds
    s_add_u32 m0, s64, 38912
    s_add_u32 s101, s86, 32768
    buffer_load_dwordx4 v4, s[28:31], s101 offen offset:0  lds
    s_add_u32 m0, s66, 69632
    s_add_u32 s101, s87, 4096
    buffer_load_dwordx4 v6, s[32:35], s101 offen offset:0  lds
    s_add_u32 m0, s66, 53248
    s_nop 0
    buffer_load_dwordx4 v6, s[32:35], s87 offen offset:0  lds
    s_add_u32 m0, s65, 36864
    s_nop 0
    buffer_load_dwordx4 v5, s[28:31], s86 offen offset:0  lds
    s_add_u32 m0, s67, 59392
    s_nop 0
    s_nop 0
    buffer_load_dwordx4 v7, s[32:35], s87 offen offset:2048  lds
    s_add_u32 m0, s65, 38912
    s_add_u32 s101, s86, 32768
    buffer_load_dwordx4 v5, s[28:31], s101 offen offset:0  lds
    s_add_u32 m0, s67, 69632
    s_add_u32 s101, s87, 4096
    buffer_load_dwordx4 v7, s[32:35], s101 offen offset:0  lds
    s_add_u32 m0, s67, 53248
    s_nop 0
    buffer_load_dwordx4 v7, s[32:35], s87 offen offset:0  lds
    s_add_u32 s86, s86, 128
    s_add_u32 s87, s87, 393216
    s_and_b32 s86, s86, 2047
    s_cselect_b32 s87, s87, 0
    s_waitcnt vmcnt(10)
    s_waitcnt lgkmcnt(0)
    s_barrier
    s_setprio 2
    s_add_u32 m0, s64, 77824
    s_nop 0
    s_nop 0
    buffer_load_dwordx4 v4, s[28:31], s86 offen offset:0  lds
    v_mov_b32 v200, 0x3f803f80
    v_mov_b32 v201, 0x3f803f80
    v_mov_b32 v202, 0x3f803f80
    v_mov_b32 v203, 0x3f803f80
    s_add_u32 m0, s66, 100352
    s_nop 0
    s_nop 0
    buffer_load_dwordx4 v6, s[32:35], s87 offen offset:2048  lds
    v_mfma_f32_16x16x32_bf16 v[204:207], v[200:203], v[20:23], 0
    v_mfma_f32_16x16x32_bf16 v[212:215], v[20:23], v[20:23], 0
    v_mfma_f32_16x16x32_bf16 v[208:211], v[200:203], v[24:27], 0
    v_mfma_f32_16x16x32_bf16 v[216:219], v[24:27], v[24:27], 0
    s_add_u32 m0, s64, 79872
    s_add_u32 s101, s86, 32768
    buffer_load_dwordx4 v4, s[28:31], s101 offen offset:0  lds
    v_mfma_f32_16x16x32_bf16 v[220:223], v[200:203], v[36:39], 0
    v_mfma_f32_16x16x32_bf16 v[224:227], v[200:203], v[44:47], 0
    v_mfma_f32_16x16x32_bf16 v[228:231], v[200:203], v[52:55], 0
    v_mfma_f32_16x16x32_bf16 v[204:207], v[200:203], v[28:31], v[204:207]
    v_mfma_f32_16x16x32_bf16 v[212:215], v[28:31], v[28:31], v[212:215]
    s_add_u32 m0, s66, 110592
    s_add_u32 s101, s87, 4096
    buffer_load_dwordx4 v6, s[32:35], s101 offen offset:0  lds
    v_mfma_f32_16x16x32_bf16 v[208:211], v[200:203], v[32:35], v[208:211]
    v_mfma_f32_16x16x32_bf16 v[216:219], v[32:35], v[32:35], v[216:219]
    v_mfma_f32_16x16x32_bf16 v[220:223], v[200:203], v[40:43], v[220:223]
    v_mfma_f32_16x16x32_bf16 v[224:227], v[200:203], v[48:51], v[224:227]
    s_add_u32 m0, s66, 94208
    s_nop 0
    buffer_load_dwordx4 v6, s[32:35], s87 offen offset:0  lds
    v_mfma_f32_16x16x32_bf16 v[228:231], v[200:203], v[56:59], v[228:231]
    v_and_b32 v196, 3, v2
    v_cmp_eq_u32 s[90:91], 1, v196
    v_cmp_eq_u32 s[92:93], 2, v196
    v_cmp_eq_u32_e64 vcc, 3, v196
    s_add_u32 m0, s65, 77824
    s_nop 0
    buffer_load_dwordx4 v5, s[28:31], s86 offen offset:0  lds
    v_cndmask_b32 v212, v212, v213, s[90:91]
    v_cndmask_b32 v212, v212, v214, s[92:93]
    v_cndmask_b32 v205, v212, v215, vcc
    v_cndmask_b32 v216, v216, v217, s[90:91]
    s_add_u32 m0, s67, 100352
    s_nop 0
    buffer_load_dwordx4 v7, s[32:35], s87 offen offset:2048  lds
    v_cndmask_b32 v216, v216, v218, s[92:93]
    v_cndmask_b32 v209, v216, v219, vcc
    v_lshrrev_b32_e64 v196, 4, v2
    v_cmp_eq_u32 s[90:91], 1, v196
    v_cmp_eq_u32_e64 vcc, 2, v196
    s_add_u32 m0, s65, 79872
    s_add_u32 s101, s86, 32768
    buffer_load_dwordx4 v5, s[28:31], s101 offen offset:0  lds
    v_cndmask_b32 v220, v220, v224, s[90:91]
    v_cndmask_b32_e64 v220, v220, v228, vcc
    s_mul_i32 s78, s77, 768
    s_mul_i32 s79, s76, 192
    s_add_u32 m0, s67, 110592
    s_add_u32 s101, s87, 4096
    buffer_load_dwordx4 v7, s[32:35], s101 offen offset:0  lds
    s_add_u32 s78, s78, s79
    s_add_u32 s78, s78, 327680
    v_lshlrev_b32 v197, 2, v2
    s_mov_b32 exec_hi, 0xffff
    buffer_store_dword v220, v197, s[36:39], s78 offen sc1
    s_mov_b32 exec_hi, -1
    s_lshl_b32 s78, s69, 4
    s_add_u32 m0, s67, 94208
    s_nop 0
    buffer_load_dwordx4 v7, s[32:35], s87 offen offset:0  lds
    s_add_u32 s86, s86, 128
    s_add_u32 s87, s87, 393216
    s_and_b32 s86, s86, 2047
    s_cselect_b32 s87, s87, 0
    s_add_u32 s78, s78, s70
    s_lshl_b32 s78, s78, 10
    s_lshl_b32 s79, s76, 8
    s_add_u32 s78, s78, s79
    buffer_store_dwordx4 v[16:19], v14, s[36:39], s96 offen offset:0 sc1
    s_add_u32 s78, s78, 65536
    v_and_b32 v198, 15, v2
    v_lshlrev_b32 v198, 3, v198
    s_mov_b32 exec_lo, 0x00f0000f
    s_mov_b32 exec_hi, 0xf0000f00
    buffer_store_dwordx2 v[204:205], v198, s[36:39], s78 offen offset:0 sc1
    s_mov_b64 exec, -1
    s_mov_b32 exec_lo, 0x00f0000f
    s_mov_b32 exec_hi, 0xf0000f00
    buffer_store_dwordx2 v[208:209], v198, s[36:39], s78 offen offset:128 sc1
    s_mov_b64 exec, -1
    s_setprio 0
    s_waitcnt vmcnt(14)
    s_waitcnt lgkmcnt(0)
    s_barrier
    s_add_u32 m0, s64, 118784
    s_nop 0
    buffer_load_dwordx4 v4, s[28:31], s86 offen offset:0  lds
    s_add_u32 m0, s66, 141312
    s_nop 0
    buffer_load_dwordx4 v6, s[32:35], s87 offen offset:2048  lds
    s_add_u32 m0, s64, 120832
    s_add_u32 s101, s86, 32768
    buffer_load_dwordx4 v4, s[28:31], s101 offen offset:0  lds
    s_add_u32 m0, s66, 151552
    s_add_u32 s101, s87, 4096
    buffer_load_dwordx4 v6, s[32:35], s101 offen offset:0  lds
    s_add_u32 m0, s66, 135168
    s_nop 0
    buffer_load_dwordx4 v6, s[32:35], s87 offen offset:0  lds
    s_add_u32 m0, s65, 118784
    s_nop 0
    buffer_load_dwordx4 v5, s[28:31], s86 offen offset:0  lds
    s_add_u32 m0, s67, 141312
    s_nop 0
    s_nop 0
    buffer_load_dwordx4 v7, s[32:35], s87 offen offset:2048  lds
    s_add_u32 m0, s65, 120832
    s_add_u32 s101, s86, 32768
    buffer_load_dwordx4 v5, s[28:31], s101 offen offset:0  lds
    s_add_u32 m0, s67, 151552
    s_add_u32 s101, s87, 4096
    buffer_load_dwordx4 v7, s[32:35], s101 offen offset:0  lds
    s_add_u32 m0, s67, 135168
    s_nop 0
    buffer_load_dwordx4 v7, s[32:35], s87 offen offset:0  lds
    s_add_u32 s86, s86, 128
    s_add_u32 s87, s87, 393216
    s_and_b32 s86, s86, 2047
    s_cselect_b32 s87, s87, 0
    s_mov_b32 s100, 0
    buffer_load_dwordx4 v[64:67], v244, s[48:51], s100 offen nt
    s_mov_b32 s100, 0
    buffer_load_dwordx4 v[96:99], v244, s[52:55], s100 offen nt
    s_mov_b32 s100, 7168
    buffer_load_dwordx4 v[68:71], v244, s[48:51], s100 offen nt
    s_mov_b32 s100, 7168
    buffer_load_dwordx4 v[100:103], v244, s[52:55], s100 offen nt
    s_mov_b32 s100, 14336
    buffer_load_dwordx4 v[72:75], v244, s[48:51], s100 offen nt
    s_mov_b32 s100, 14336
    buffer_load_dwordx4 v[104:107], v244, s[52:55], s100 offen nt
    s_mov_b32 s100, 21504
    buffer_load_dwordx4 v[76:79], v244, s[48:51], s100 offen nt
    s_waitcnt vmcnt(17)
    s_barrier
    s_cmp_lg_u32 s76, 0
    s_cbranch_scc1 Lfl_17
    s_getreg_b32 s99, hwreg(HW_REG_XCC_ID, 0, 4)
    v_mov_b32 v198, s75
    v_mov_b32 v199, s99
    v_lshlrev_b32 v197, 3, v2
    s_lshl_b32 s78, s77, 7
    s_lshl_b32 s79, s77, 9
    s_add_u32 s79, s79, 8912896
    s_add_u32 s78, s78, 4096
    s_lshl_b32 s80, s71, 4
    s_add_u32 s80, s80, s72
    s_lshl_b32 s80, s80, 7
    s_add_u32 s80, s80, 8847360
    s_mov_b64 exec, 0xffff
    buffer_store_dwordx2 v[198:199], v197, s[36:39], s78 offen sc1
    buffer_store_dwordx2 v[198:199], v197, s[36:39], s80 offen sc1
    s_mov_b64 exec, -1
    v_not_b32 v200, v198
    v_mov_b32 v201, 0
    buffer_store_dwordx2 v[200:201], v197, s[36:39], s79 offen sc1
    v_and_b32 v196, 15, v2
    v_lshlrev_b32 v197, 4, v196
    v_add_u32_e64 v197, s69, v197
    s_lshl_b32 s78, s70, 4
    s_lshl_b32 s79, s71, 4
    s_add_u32 s79, s79, 69088
    v_mov_b32 v202, s78
    v_mov_b32 v203, s79
    v_cmp_gt_u32 vcc, 32, v2
    s_nop 1
    v_cndmask_b32 v202, v203, v202, vcc
    v_add_u32 v196, v202, v196
    v_cmp_gt_u32 vcc, 16, v2
    s_nop 1
    v_cndmask_b32 v196, v196, v197, vcc
    v_lshlrev_b32 v196, 7, v196
    v_add_u32 v196, 4096, v196
Lfl_17:
    s_add_u32 m0, s64, 36864
    s_nop 0
    buffer_load_dwordx4 v4, s[28:31], s86 offen offset:0  lds
    s_add_u32 m0, s66, 59392
    s_nop 0
    buffer_load_dwordx4 v6, s[32:35], s87 offen offset:2048  lds
    s_add_u32 m0, s64, 38912
    s_add_u32 s101, s86, 32768
    buffer_load_dwordx4 v4, s[28:31], s101 offen offset:0  lds
    s_add_u32 m0, s66, 69632
    s_add_u32 s101, s87, 4096
    buffer_load_dwordx4 v6, s[32:35], s101 offen offset:0  lds
    s_add_u32 m0, s66, 53248
    s_nop 0
    buffer_load_dwordx4 v6, s[32:35], s87 offen offset:0  lds
    s_add_u32 m0, s65, 36864
    s_nop 0
    buffer_load_dwordx4 v5, s[28:31], s86 offen offset:0  lds
    s_add_u32 m0, s67, 59392
    s_nop 0
    s_nop 0
    buffer_load_dwordx4 v7, s[32:35], s87 offen offset:2048  lds
    s_add_u32 m0, s65, 38912
    s_add_u32 s101, s86, 32768
    buffer_load_dwordx4 v5, s[28:31], s101 offen offset:0  lds
    s_add_u32 m0, s67, 69632
    s_add_u32 s101, s87, 4096
    buffer_load_dwordx4 v7, s[32:35], s101 offen offset:0  lds
    s_add_u32 m0, s67, 53248
    s_nop 0
    buffer_load_dwordx4 v7, s[32:35], s87 offen offset:0  lds
    s_add_u32 s86, s86, 128
    s_add_u32 s87, s87, 393216
    s_and_b32 s86, s86, 2047
    s_cselect_b32 s87, s87, 0
    s_waitcnt vmcnt(17)
    s_barrier
    s_add_u32 m0, s64, 77824
    s_nop 0
    buffer_load_dwordx4 v4, s[28:31], s86 offen offset:0  lds
    s_add_u32 m0, s66, 100352
    s_nop 0
    buffer_load_dwordx4 v6, s[32:35], s87 offen offset:2048  lds
    s_add_u32 m0, s64, 79872
    s_add_u32 s101, s86, 32768
    buffer_load_dwordx4 v4, s[28:31], s101 offen offset:0  lds
    s_add_u32 m0, s66, 110592
    s_add_u32 s101, s87, 4096
    buffer_load_dwordx4 v6, s[32:35], s101 offen offset:0  lds
    s_add_u32 m0, s66, 94208
    s_nop 0
    buffer_load_dwordx4 v6, s[32:35], s87 offen offset:0  lds
    s_add_u32 m0, s65, 77824
    s_nop 0
    buffer_load_dwordx4 v5, s[28:31], s86 offen offset:0  lds
    s_add_u32 m0, s67, 100352
    s_nop 0
    s_nop 0
    buffer_load_dwordx4 v7, s[32:35], s87 offen offset:2048  lds
    s_add_u32 m0, s65, 79872
    s_add_u32 s101, s86, 32768
    buffer_load_dwordx4 v5, s[28:31], s101 offen offset:0  lds
    s_add_u32 m0, s67, 110592
    s_add_u32 s101, s87, 4096
    buffer_load_dwordx4 v7, s[32:35], s101 offen offset:0  lds
    s_add_u32 m0, s67, 94208
    s_nop 0
    buffer_load_dwordx4 v7, s[32:35], s87 offen offset:0  lds
    s_add_u32 s86, s86, 128
    s_add_u32 s87, s87, 393216
    s_and_b32 s86, s86, 2047
    s_cselect_b32 s87, s87, 0
    s_waitcnt vmcnt(10)
    s_barrier
    s_add_u32 m0, s64, 118784
    s_nop 0
    buffer_load_dwordx4 v4, s[28:31], s86 offen offset:0  lds
    s_add_u32 m0, s66, 141312
    s_nop 0
    buffer_load_dwordx4 v6, s[32:35], s87 offen offset:2048  lds
    s_add_u32 m0, s64, 120832
    s_add_u32 s101, s86, 32768
    buffer_load_dwordx4 v4, s[28:31], s101 offen offset:0  lds
    s_add_u32 m0, s66, 151552
    s_add_u32 s101, s87, 4096
    buffer_load_dwordx4 v6, s[32:35], s101 offen offset:0  lds
    s_add_u32 m0, s66, 135168
    s_nop 0
    buffer_load_dwordx4 v6, s[32:35], s87 offen offset:0  lds
    s_add_u32 m0, s65, 118784
    s_nop 0
    buffer_load_dwordx4 v5, s[28:31], s86 offen offset:0  lds
    s_add_u32 m0, s67, 141312
    s_nop 0
    s_nop 0
    buffer_load_dwordx4 v7, s[32:35], s87 offen offset:2048  lds
    s_add_u32 m0, s65, 120832
    s_add_u32 s101, s86, 32768
    buffer_load_dwordx4 v5, s[28:31], s101 offen offset:0  lds
    s_add_u32 m0, s67, 151552
    s_add_u32 s101, s87, 4096
    buffer_load_dwordx4 v7, s[32:35], s101 offen offset:0  lds
    s_add_u32 m0, s67, 135168
    s_nop 0
    buffer_load_dwordx4 v7, s[32:35], s87 offen offset:0  lds
    s_add_u32 s86, s86, 128
    s_add_u32 s87, s87, 393216
    s_and_b32 s86, s86, 2047
    s_cselect_b32 s87, s87, 0
    s_waitcnt vmcnt(10)
    s_barrier
    s_add_u32 m0, s64, 36864
    s_nop 0
    buffer_load_dwordx4 v4, s[28:31], s86 offen offset:0  lds
    s_add_u32 m0, s66, 59392
    s_nop 0
    buffer_load_dwordx4 v6, s[32:35], s87 offen offset:2048  lds
    s_add_u32 m0, s64, 38912
    s_add_u32 s101, s86, 32768
    buffer_load_dwordx4 v4, s[28:31], s101 offen offset:0  lds
    s_add_u32 m0, s66, 69632
    s_add_u32 s101, s87, 4096
    buffer_load_dwordx4 v6, s[32:35], s101 offen offset:0  lds
    s_add_u32 m0, s66, 53248
    s_nop 0
    buffer_load_dwordx4 v6, s[32:35], s87 offen offset:0  lds
    s_add_u32 m0, s65, 36864
    s_nop 0
    buffer_load_dwordx4 v5, s[28:31], s86 offen offset:0  lds
    s_add_u32 m0, s67, 59392
    s_nop 0
    s_nop 0
    buffer_load_dwordx4 v7, s[32:35], s87 offen offset:2048  lds
    s_add_u32 m0, s65, 38912
    s_add_u32 s101, s86, 32768
    buffer_load_dwordx4 v5, s[28:31], s101 offen offset:0  lds
    s_add_u32 m0, s67, 69632
    s_add_u32 s101, s87, 4096
    buffer_load_dwordx4 v7, s[32:35], s101 offen offset:0  lds
    s_add_u32 m0, s67, 53248
    s_nop 0
    buffer_load_dwordx4 v7, s[32:35], s87 offen offset:0  lds
    s_add_u32 s86, s86, 128
    s_add_u32 s87, s87, 393216
    s_and_b32 s86, s86, 2047
    s_cselect_b32 s87, s87, 0
    s_waitcnt vmcnt(10)
    s_barrier
    s_add_u32 m0, s64, 77824
    s_nop 0
    buffer_load_dwordx4 v4, s[28:31], s86 offen offset:0  lds
    s_add_u32 m0, s66, 100352
    s_nop 0
    buffer_load_dwordx4 v6, s[32:35], s87 offen offset:2048  lds
    s_add_u32 m0, s64, 79872
    s_add_u32 s101, s86, 32768
    buffer_load_dwordx4 v4, s[28:31], s101 offen offset:0  lds
    s_add_u32 m0, s66, 110592
    s_add_u32 s101, s87, 4096
    buffer_load_dwordx4 v6, s[32:35], s101 offen offset:0  lds
    s_add_u32 m0, s66, 94208
    s_nop 0
    buffer_load_dwordx4 v6, s[32:35], s87 offen offset:0  lds
    s_add_u32 m0, s65, 77824
    s_nop 0
    buffer_load_dwordx4 v5, s[28:31], s86 offen offset:0  lds
    s_add_u32 m0, s67, 100352
    s_nop 0
    s_nop 0
    buffer_load_dwordx4 v7, s[32:35], s87 offen offset:2048  lds
    s_add_u32 m0, s65, 79872
    s_add_u32 s101, s86, 32768
    buffer_load_dwordx4 v5, s[28:31], s101 offen offset:0  lds
    s_add_u32 m0, s67, 110592
    s_add_u32 s101, s87, 4096
    buffer_load_dwordx4 v7, s[32:35], s101 offen offset:0  lds
    s_add_u32 m0, s67, 94208
    s_nop 0
    buffer_load_dwordx4 v7, s[32:35], s87 offen offset:0  lds
    s_add_u32 s86, s86, 128
    s_add_u32 s87, s87, 393216
    s_and_b32 s86, s86, 2047
    s_cselect_b32 s87, s87, 0
    s_mov_b32 s100, 21504
    buffer_load_dwordx4 v[108:111], v244, s[52:55], s100 offen nt
    s_mov_b32 s100, 28672
    buffer_load_dwordx4 v[80:83], v244, s[48:51], s100 offen nt
    s_mov_b32 s100, 28672
    buffer_load_dwordx4 v[112:115], v244, s[52:55], s100 offen nt
    s_mov_b32 s100, 35840
    buffer_load_dwordx4 v[84:87], v244, s[48:51], s100 offen nt
    s_mov_b32 s100, 35840
    buffer_load_dwordx4 v[116:119], v244, s[52:55], s100 offen nt
    s_mov_b32 s100, 43008
    buffer_load_dwordx4 v[88:91], v244, s[48:51], s100 offen nt
    s_mov_b32 s100, 43008
    buffer_load_dwordx4 v[120:123], v244, s[52:55], s100 offen nt
    s_waitcnt vmcnt(17)
    s_barrier
    s_add_u32 m0, s64, 118784
    s_nop 0
    buffer_load_dwordx4 v4, s[28:31], s86 offen offset:0  lds
    s_add_u32 m0, s66, 141312
    s_nop 0
    buffer_load_dwordx4 v6, s[32:35], s87 offen offset:2048  lds
    s_add_u32 m0, s64, 120832
    s_add_u32 s101, s86, 32768
    buffer_load_dwordx4 v4, s[28:31], s101 offen offset:0  lds
    s_add_u32 m0, s66, 151552
    s_add_u32 s101, s87, 4096
    buffer_load_dwordx4 v6, s[32:35], s101 offen offset:0  lds
    s_add_u32 m0, s66, 135168
    s_nop 0
    buffer_load_dwordx4 v6, s[32:35], s87 offen offset:0  lds
    s_add_u32 m0, s65, 118784
    s_nop 0
    buffer_load_dwordx4 v5, s[28:31], s86 offen offset:0  lds
    s_add_u32 m0, s67, 141312
    s_nop 0
    s_nop 0
    buffer_load_dwordx4 v7, s[32:35], s87 offen offset:2048  lds
    s_add_u32 m0, s65, 120832
    s_add_u32 s101, s86, 32768
    buffer_load_dwordx4 v5, s[28:31], s101 offen offset:0  lds
    s_add_u32 m0, s67, 151552
    s_add_u32 s101, s87, 4096
    buffer_load_dwordx4 v7, s[32:35], s101 offen offset:0  lds
    s_add_u32 m0, s67, 135168
    s_nop 0
    buffer_load_dwordx4 v7, s[32:35], s87 offen offset:0  lds
    s_add_u32 s86, s86, 128
    s_add_u32 s87, s87, 393216
    s_and_b32 s86, s86, 2047
    s_cselect_b32 s87, s87, 0
    s_waitcnt vmcnt(17)
    s_barrier
    s_add_u32 m0, s64, 36864
    s_nop 0
    buffer_load_dwordx4 v4, s[28:31], s86 offen offset:0  lds
    s_add_u32 m0, s66, 59392
    s_nop 0
    buffer_load_dwordx4 v6, s[32:35], s87 offen offset:2048  lds
    s_add_u32 m0, s64, 38912
    s_add_u32 s101, s86, 32768
    buffer_load_dwordx4 v4, s[28:31], s101 offen offset:0  lds
    s_add_u32 m0, s66, 69632
    s_add_u32 s101, s87, 4096
    buffer_load_dwordx4 v6, s[32:35], s101 offen offset:0  lds
    s_add_u32 m0, s66, 53248
    s_nop 0
    buffer_load_dwordx4 v6, s[32:35], s87 offen offset:0  lds
    s_add_u32 m0, s65, 36864
    s_nop 0
    buffer_load_dwordx4 v5, s[28:31], s86 offen offset:0  lds
    s_add_u32 m0, s67, 59392
    s_nop 0
    s_nop 0
    buffer_load_dwordx4 v7, s[32:35], s87 offen offset:2048  lds
    s_add_u32 m0, s65, 38912
    s_add_u32 s101, s86, 32768
    buffer_load_dwordx4 v5, s[28:31], s101 offen offset:0  lds
    s_add_u32 m0, s67, 69632
    s_add_u32 s101, s87, 4096
    buffer_load_dwordx4 v7, s[32:35], s101 offen offset:0  lds
    s_add_u32 m0, s67, 53248
    s_nop 0
    buffer_load_dwordx4 v7, s[32:35], s87 offen offset:0  lds
    s_add_u32 s86, s86, 128
    s_add_u32 s87, s87, 393216
    s_and_b32 s86, s86, 2047
    s_cselect_b32 s87, s87, 0
    s_waitcnt vmcnt(10)
    s_barrier
    s_cmp_lg_u32 s76, 0
    s_cbranch_scc1 Lpl_18
    s_mov_b32 exec_hi, 0xffff
    buffer_load_dwordx2 v[198:199], v196, s[36:39], 0 offen sc1
    s_mov_b64 exec, -1
Lpl_18:
    s_add_u32 m0, s64, 77824
    s_nop 0
    buffer_load_dwordx4 v4, s[28:31], s86 offen offset:0  lds
    s_add_u32 m0, s66, 100352
    s_nop 0
    s_nop 0
    buffer_load_dwordx4 v6, s[32:35], s87 offen offset:2048  lds
    s_add_u32 m0, s64, 79872
    s_add_u32 s101, s86, 32768
    buffer_load_dwordx4 v4, s[28:31], s101 offen offset:0  lds
    s_add_u32 m0, s66, 110592
    s_add_u32 s101, s87, 4096
    buffer_load_dwordx4 v6, s[32:35], s101 offen offset:0  lds
    s_add_u32 m0, s66, 94208
    s_nop 0
    buffer_load_dwordx4 v6, s[32:35], s87 offen offset:0  lds
    s_add_u32 m0, s65, 77824
    s_nop 0
    buffer_load_dwordx4 v5, s[28:31], s86 offen offset:0  lds
    s_add_u32 m0, s67, 100352
    s_nop 0
    s_nop 0
    buffer_load_dwordx4 v7, s[32:35], s87 offen offset:2048  lds
    s_add_u32 m0, s65, 79872
    s_add_u32 s101, s86, 32768
    buffer_load_dwordx4 v5, s[28:31], s101 offen offset:0  lds
    s_add_u32 m0, s67, 110592
    s_add_u32 s101, s87, 4096
    buffer_load_dwordx4 v7, s[32:35], s101 offen offset:0  lds
    s_add_u32 m0, s67, 94208
    s_nop 0
    buffer_load_dwordx4 v7, s[32:35], s87 offen offset:0  lds
    s_add_u32 s86, s86, 128
    s_add_u32 s87, s87, 393216
    s_and_b32 s86, s86, 2047
    s_cselect_b32 s87, s87, 0
    s_waitcnt vmcnt(10)
    s_barrier
    s_cmp_lg_u32 s76, 2
    s_cbranch_scc1 Lc4_19
    s_mov_b32 exec_hi, -1
    buffer_load_dword v238, v63, s[40:43], 0 offen
    s_mov_b64 exec, -1
Lc4_19:
    s_add_u32 m0, s64, 118784
    s_nop 0
    buffer_load_dwordx4 v4, s[28:31], s86 offen offset:0  lds
    s_add_u32 m0, s66, 141312
    s_nop 0
    buffer_load_dwordx4 v6, s[32:35], s87 offen offset:2048  lds
    s_add_u32 m0, s64, 120832
    s_add_u32 s101, s86, 32768
    buffer_load_dwordx4 v4, s[28:31], s101 offen offset:0  lds
    s_add_u32 m0, s66, 151552
    s_add_u32 s101, s87, 4096
    buffer_load_dwordx4 v6, s[32:35], s101 offen offset:0  lds
    s_add_u32 m0, s66, 135168
    s_nop 0
    buffer_load_dwordx4 v6, s[32:35], s87 offen offset:0  lds
    s_add_u32 m0, s65, 118784
    s_nop 0
    buffer_load_dwordx4 v5, s[28:31], s86 offen offset:0  lds
    s_add_u32 m0, s67, 141312
    s_nop 0
    s_nop 0
    buffer_load_dwordx4 v7, s[32:35], s87 offen offset:2048  lds
    s_add_u32 m0, s65, 120832
    s_add_u32 s101, s86, 32768
    buffer_load_dwordx4 v5, s[28:31], s101 offen offset:0  lds
    s_add_u32 m0, s67, 151552
    s_add_u32 s101, s87, 4096
    buffer_load_dwordx4 v7, s[32:35], s101 offen offset:0  lds
    s_add_u32 m0, s67, 135168
    s_nop 0
    buffer_load_dwordx4 v7, s[32:35], s87 offen offset:0  lds
    s_add_u32 s86, s86, 128
    s_add_u32 s87, s87, 393216
    s_and_b32 s86, s86, 2047
    s_cselect_b32 s87, s87, 0
    s_waitcnt vmcnt(10)
    s_cmp_lg_u32 s76, 0
    s_cbranch_scc1 Lpc_20
    s_mov_b32 exec_hi, 0xffff
    s_mov_b32 s85, 0
    s_branch Lpk_21
Lspin_22:
    s_add_u32 s85, s85, 1
    s_cmp_gt_u32 s85, 400000
    s_cbranch_scc1 L_end
    buffer_load_dwordx2 v[198:199], v196, s[36:39], 0 offen sc1
    s_waitcnt vmcnt(0)
Lpk_21:
    v_cmp_ne_u32 vcc, s75, v198
    s_cbranch_vccnz Lspin_22
    v_cmp_ne_u32 vcc, s99, v199
    s_mov_b64 exec, -1
    s_lshr_b32 s78, vcc_lo, 16
    s_cselect_b32 s78, 0, 1
    s_cmp_eq_u32 vcc_hi, 0
    s_cselect_b32 s79, 2, 0
    s_or_b32 s78, s78, s79
    s_and_b32 s78, s78, 3
    v_mov_b32_e64 v198, s78
    v_mov_b32 v199, 163584
    ds_write_b32 v199, v198
    s_waitcnt lgkmcnt(0)
Lpc_20:
    s_barrier
    v_lshrrev_b32 v196, 4, v2
    v_and_b32 v197, 15, v2
    v_lshlrev_b32_e64 v197, 4, v197
    v_lshl_add_u32 v198, v196, 10, v197
    s_lshl_b32 s78, s69, 14
    s_lshl_b32 s79, s76, 8
    s_add_u32 s78, s78, s79
    s_nop 0
    s_add_u32 s78, s78, 65536
    buffer_load_dwordx4 v[20:23], v198, s[36:39], s78 offen sc1
    s_add_u32 s78, s78, 4096
    buffer_load_dwordx4 v[24:27], v198, s[36:39], s78 offen sc1
    s_add_u32 s78, s78, 4096
    buffer_load_dwordx4 v[28:31], v198, s[36:39], s78 offen sc1
    s_add_u32 s78, s78, 4096
    buffer_load_dwordx4 v[32:35], v198, s[36:39], s78 offen sc1
    v_mul_u32_u24 v198, 768, v196
    v_add_u32_e64 v198, v198, v197
    s_mul_i32 s78, s70, 12288
    s_lshl_b32 s79, s76, 8
    s_add_u32 s78, s78, s79
    s_add_u32 s78, s78, 327680
    s_cmp_eq_u32 s76, 3
    s_nop 0
    s_cselect_b32 s78, 0x10000000, s78
    buffer_load_dwordx4 v[36:39], v198, s[36:39], s78 offen sc1
    s_add_u32 s78, s78, 3072
    buffer_load_dwordx4 v[40:43], v198, s[36:39], s78 offen sc1
    s_add_u32 s78, s78, 3072
    buffer_load_dwordx4 v[44:47], v198, s[36:39], s78 offen sc1
    s_add_u32 s78, s78, 3072
    buffer_load_dwordx4 v[48:51], v198, s[36:39], s78 offen sc1
    s_add_u32 m0, s84, 0
    s_mov_b32 s100, 0
    buffer_load_dwordx4 v246, s[40:43], s100 offen  lds
    s_add_u32 m0, s84, 4096
    s_mov_b32 s100, 65536
    buffer_load_dwordx4 v246, s[40:43], s100 offen  lds
    s_add_u32 m0, s84, 8192
    s_mov_b32 s100, 131072
    buffer_load_dwordx4 v246, s[40:43], s100 offen  lds
    s_add_u32 m0, s84, 12288
    s_mov_b32 s100, 196608
    buffer_load_dwordx4 v246, s[40:43], s100 offen  lds
    s_waitcnt vmcnt(12)
    s_waitcnt lgkmcnt(0)
    s_barrier
    s_setprio 2
    s_add_u32 m0, s84, 16384
    s_mov_b32 s100, 262144
    buffer_load_dwordx4 v246, s[40:43], s100 offen  lds
    s_waitcnt vmcnt(9)
    v_add_f32 v20, v20, v24
    v_add_f32 v21, v21, v25
    v_add_f32 v22, v22, v26
    v_add_f32 v23, v23, v27
    v_add_f32 v20, v20, v28
    v_add_f32_e64 v21, v21, v29
    s_add_u32 m0, s84, 20480
    s_mov_b32 s100, 327680
    buffer_load_dwordx4 v246, s[40:43], s100 offen  lds
    v_add_f32 v22, v22, v30
    v_add_f32 v23, v23, v31
    v_add_f32 v20, v20, v32
    v_add_f32 v21, v21, v33
    v_add_f32 v22, v22, v34
    v_add_f32 v23, v23, v35
    s_nop 0
    v_permlane32_swap_b32 v20, v22
    s_add_u32 m0, s84, 24576
    s_mov_b32 s100, 393216
    buffer_load_dwordx4 v246, s[40:43], s100 offen  lds
    v_permlane32_swap_b32 v21, v23
    v_add_f32 v20, v20, v22
    v_add_f32 v21, v21, v23
    v_mov_b32 v22, v20
    v_mov_b32 v23, v21
    s_nop 0
    v_permlane16_swap_b32 v20, v22
    v_permlane16_swap_b32 v21, v23
    v_add_f32_e64 v20, v20, v22
    s_add_u32 m0, s84, 28672
    s_mov_b32 s100, 458752
    buffer_load_dwordx4 v246, s[40:43], s100 offen  lds
    v_add_f32_e64 v21, v21, v23
    v_mul_f32 v24, 0x3a800000, v20
    v_mul_f32 v26, 0x3a800000, v21
    v_fma_f32 v26, -v24, v24, v26
    v_max_f32_e64 v26, 0, v26
    v_cvt_pk_bf16_f32 v24, v24, v24
    v_and_b32 v24, 0xffff0000, v24
    s_add_u32 m0, s84, 32768
    s_mov_b32 s100, 524288
    buffer_load_dwordx4 v246, s[40:43], s100 offen  lds
    v_cvt_pk_bf16_f32 v26, v26, v26
    v_and_b32 v26, 0xffff0000, v26
    v_add_f32 v26, 0x3727c5ac, v26
    v_cvt_pk_bf16_f32 v26, v26, v26
    v_and_b32 v26, 0xffff0000, v26
    v_sqrt_f32 v26, v26
    s_nop 0
    v_cvt_pk_bf16_f32 v26, v26, v26
    v_and_b32 v26, 0xffff0000, v26
    s_add_u32 m0, s84, 36864
    s_mov_b32 s100, 589824
    buffer_load_dwordx4 v246, s[40:43], s100 offen  lds
    v_rcp_f32_e64 v25, v26
    v_xor_b32 v26, 0x80000000, v24
    v_lshrrev_b32 v27, 16, v26
    v_or_b32 v26, v26, v27
    v_mov_b32 v27, 0
    v_and_b32 v196, 15, v2
    v_lshrrev_b32_e64 v197, 5, v2
    s_add_u32 m0, s84, 40960
    s_mov_b32 s100, 655360
    buffer_load_dwordx4 v246, s[40:43], s100 offen  lds
    v_lshl_add_u32 v196, v196, 1, v197
    s_lshl_b32 s78, s76, 5
    v_add_u32 v196, s78, v196
    v_lshlrev_b32_e64 v197, 3, v196
    v_add_u32 v197, 159744, v197
    v_lshlrev_b32_e64 v196, 2, v196
    v_add_u32 v196, 162304, v196
    s_add_u32 m0, s84, 45056
    s_mov_b32 s100, 720896
    buffer_load_dwordx4 v246, s[40:43], s100 offen  lds
    ds_write_b64 v197, v[26:27]
    ds_write_b32 v196, v25
    s_waitcnt vmcnt(12)
    v_add_f32 v36, v36, v40
    v_add_f32 v37, v37, v41
    v_add_f32 v38, v38, v42
    v_add_f32 v39, v39, v43
    v_add_f32 v36, v36, v44
    s_add_u32 m0, s84, 49152
    s_mov_b32 s100, 786432
    buffer_load_dwordx4 v246, s[40:43], s100 offen  lds
    v_add_f32 v37, v37, v45
    v_add_f32 v38, v38, v46
    v_add_f32 v39, v39, v47
    v_add_f32 v36, v36, v48
    v_add_f32 v37, v37, v49
    v_add_f32 v38, v38, v50
    v_add_f32_e64 v39, v39, v51
    s_add_u32 m0, s84, 53248
    s_mov_b32 s100, 851968
    buffer_load_dwordx4 v246, s[40:43], s100 offen  lds
    v_permlane32_swap_b32 v36, v38
    v_permlane32_swap_b32 v37, v39
    v_add_f32 v36, v36, v38
    v_add_f32 v37, v37, v39
    s_nop 1
    v_permlane16_swap_b32 v36, v37
    v_add_f32_e64 v36, v36, v37
    v_cvt_pk_bf16_f32 v37, v36, v36
    v_and_b32 v37, 0xffff0000, v37
    s_add_u32 m0, s84, 57344
    s_mov_b32 s100, 917504
    buffer_load_dwordx4 v246, s[40:43], s100 offen  lds
    v_sub_f32_e64 v38, v36, v37
    v_cvt_pk_bf16_f32 v38, v37, v38
    v_mov_b32 v39, 0
    v_and_b32 v196, 15, v2
    v_lshrrev_b32_e64 v197, 4, v2
    v_lshl_add_u32 v196, v196, 2, v197
    s_lshl_b32 s78, s76, 9
    s_add_u32 m0, s84, 61440
    s_mov_b32 s100, 983040
    buffer_load_dwordx4 v246, s[40:43], s100 offen  lds
    s_add_u32 s78, s78, 160768
    v_lshl_add_u32 v196, v196, 3, s78
    v_and_b32 v197, 15, v2
    v_lshlrev_b32_e64 v197, 3, v197
    v_add_u32 v197, 162816, v197
    v_mov_b32 v198, 0x3f803f80
    s_cmp_eq_u32 s76, 3
    s_cselect_b64 vcc, -1, 0
    v_cndmask_b32 v196, v196, v197, vcc
    v_cndmask_b32 v38, v38, v198, vcc
    v_cndmask_b32_e64 v39, v39, v198, vcc
    ds_write_b64 v196, v[38:39]
    s_setprio 0
    s_waitcnt lgkmcnt(0)
    s_barrier
    s_branch L_phend
L_ph3:
    s_add_u32 m0, s64, 36864
    s_nop 0
    buffer_load_dwordx4 v4, s[28:31], s86 offen offset:0  lds
    s_add_u32 m0, s66, 59392
    s_nop 0
    buffer_load_dwordx4 v6, s[32:35], s87 offen offset:2048  lds
    s_add_u32 m0, s64, 38912
    s_add_u32 s101, s86, 32768
    buffer_load_dwordx4 v4, s[28:31], s101 offen offset:0  lds
    s_add_u32 m0, s66, 69632
    s_add_u32 s101, s87, 4096
    buffer_load_dwordx4 v6, s[32:35], s101 offen offset:0  lds
    s_add_u32 m0, s66, 53248
    s_nop 0
    buffer_load_dwordx4 v6, s[32:35], s87 offen offset:0  lds
    s_add_u32 m0, s65, 36864
    s_nop 0
    buffer_load_dwordx4 v5, s[28:31], s86 offen offset:0  lds
    s_add_u32 m0, s67, 59392
    s_nop 0
    s_nop 0
    buffer_load_dwordx4 v7, s[32:35], s87 offen offset:2048  lds
    s_add_u32 m0, s65, 38912
    s_add_u32 s101, s86, 32768
    buffer_load_dwordx4 v5, s[28:31], s101 offen offset:0  lds
    s_add_u32 m0, s67, 69632
    s_add_u32 s101, s87, 4096
    buffer_load_dwordx4 v7, s[32:35], s101 offen offset:0  lds
    s_add_u32 m0, s67, 53248
    s_nop 0
    buffer_load_dwordx4 v7, s[32:35], s87 offen offset:0  lds
    s_add_u32 s86, s86, 128
    s_add_u32 s87, s87, 393216
    s_and_b32 s86, s86, 2047
    s_cselect_b32 s87, s87, 0
    s_waitcnt vmcnt(10)
    s_waitcnt lgkmcnt(0)
    s_barrier
    s_setprio 2
    s_add_u32 m0, s64, 77824
    s_nop 0
    s_nop 0
    buffer_load_dwordx4 v4, s[28:31], s86 offen offset:0  lds
    v_mov_b32 v200, 0x3f803f80
    v_mov_b32 v201, 0x3f803f80
    v_mov_b32 v202, 0x3f803f80
    v_mov_b32 v203, 0x3f803f80
    s_add_u32 m0, s66, 100352
    s_nop 0
    s_nop 0
    buffer_load_dwordx4 v6, s[32:35], s87 offen offset:2048  lds
    v_mfma_f32_16x16x32_bf16 v[204:207], v[200:203], v[20:23], 0
    v_mfma_f32_16x16x32_bf16 v[212:215], v[20:23], v[20:23], 0
    v_mfma_f32_16x16x32_bf16 v[208:211], v[200:203], v[24:27], 0
    v_mfma_f32_16x16x32_bf16 v[216:219], v[24:27], v[24:27], 0
    s_add_u32 m0, s64, 79872
    s_add_u32 s101, s86, 32768
    buffer_load_dwordx4 v4, s[28:31], s101 offen offset:0  lds
    v_mfma_f32_16x16x32_bf16 v[220:223], v[200:203], v[36:39], 0
    v_mfma_f32_16x16x32_bf16 v[224:227], v[200:203], v[44:47], 0
    v_mfma_f32_16x16x32_bf16 v[228:231], v[200:203], v[52:55], 0
    v_mfma_f32_16x16x32_bf16 v[204:207], v[200:203], v[28:31], v[204:207]
    v_mfma_f32_16x16x32_bf16 v[212:215], v[28:31], v[28:31], v[212:215]
    s_add_u32 m0, s66, 110592
    s_add_u32 s101, s87, 4096
    buffer_load_dwordx4 v6, s[32:35], s101 offen offset:0  lds
    v_mfma_f32_16x16x32_bf16 v[208:211], v[200:203], v[32:35], v[208:211]
    v_mfma_f32_16x16x32_bf16 v[216:219], v[32:35], v[32:35], v[216:219]
    v_mfma_f32_16x16x32_bf16 v[220:223], v[200:203], v[40:43], v[220:223]
    v_mfma_f32_16x16x32_bf16 v[224:227], v[200:203], v[48:51], v[224:227]
    s_add_u32 m0, s66, 94208
    s_nop 0
    buffer_load_dwordx4 v6, s[32:35], s87 offen offset:0  lds
    v_mfma_f32_16x16x32_bf16 v[228:231], v[200:203], v[56:59], v[228:231]
    v_and_b32 v196, 3, v2
    v_cmp_eq_u32 s[90:91], 1, v196
    v_cmp_eq_u32 s[92:93], 2, v196
    v_cmp_eq_u32_e64 vcc, 3, v196
    s_add_u32 m0, s65, 77824
    s_nop 0
    buffer_load_dwordx4 v5, s[28:31], s86 offen offset:0  lds
    v_cndmask_b32 v212, v212, v213, s[90:91]
    v_cndmask_b32 v212, v212, v214, s[92:93]
    v_cndmask_b32 v205, v212, v215, vcc
    v_cndmask_b32 v216, v216, v217, s[90:91]
    s_add_u32 m0, s67, 100352
    s_nop 0
    buffer_load_dwordx4 v7, s[32:35], s87 offen offset:2048  lds
    v_cndmask_b32 v216, v216, v218, s[92:93]
    v_cndmask_b32 v209, v216, v219, vcc
    v_lshrrev_b32_e64 v196, 4, v2
    v_cmp_eq_u32 s[90:91], 1, v196
    v_cmp_eq_u32_e64 vcc, 2, v196
    s_add_u32 m0, s65, 79872
    s_add_u32 s101, s86, 32768
    buffer_load_dwordx4 v5, s[28:31], s101 offen offset:0  lds
    v_cndmask_b32 v220, v220, v224, s[90:91]
    v_cndmask_b32_e64 v220, v220, v228, vcc
    s_mul_i32 s78, s77, 768
    s_mul_i32 s79, s76, 192
    s_add_u32 m0, s67, 110592
    s_add_u32 s101, s87, 4096
    buffer_load_dwordx4 v7, s[32:35], s101 offen offset:0  lds
    s_add_u32 s78, s78, s79
    s_add_u32 s78, s78, 327680
    v_lshlrev_b32 v197, 2, v2
    s_mov_b32 exec_hi, 0xffff
    buffer_store_dword v220, v197, s[36:39], s78 offen sc1
    s_mov_b32 exec_hi, -1
    s_lshl_b32 s78, s69, 4
    s_add_u32 m0, s67, 94208
    s_nop 0
    buffer_load_dwordx4 v7, s[32:35], s87 offen offset:0  lds
    s_add_u32 s86, s86, 128
    s_add_u32 s87, s87, 393216
    s_and_b32 s86, s86, 2047
    s_cselect_b32 s87, s87, 0
    s_add_u32 s78, s78, s70
    s_lshl_b32 s78, s78, 10
    s_lshl_b32 s79, s76, 8
    s_add_u32 s78, s78, s79
    buffer_store_dwordx4 v[16:19], v14, s[36:39], s96 offen offset:0 sc1
    s_add_u32 s78, s78, 65536
    v_and_b32 v198, 15, v2
    v_lshlrev_b32 v198, 3, v198
    s_mov_b32 exec_lo, 0x00f0000f
    s_mov_b32 exec_hi, 0xf0000f00
    buffer_store_dwordx2 v[204:205], v198, s[36:39], s78 offen offset:0 sc1
    s_mov_b64 exec, -1
    s_mov_b32 exec_lo, 0x00f0000f
    s_mov_b32 exec_hi, 0xf0000f00
    buffer_store_dwordx2 v[208:209], v198, s[36:39], s78 offen offset:128 sc1
    s_mov_b64 exec, -1
    s_setprio 0
    s_waitcnt vmcnt(14)
    s_waitcnt lgkmcnt(0)
    s_barrier
    s_add_u32 m0, s64, 118784
    s_nop 0
    buffer_load_dwordx4 v4, s[28:31], s86 offen offset:0  lds
    s_add_u32 m0, s66, 141312
    s_nop 0
    buffer_load_dwordx4 v6, s[32:35], s87 offen offset:2048  lds
    s_add_u32 m0, s64, 120832
    s_add_u32 s101, s86, 32768
    buffer_load_dwordx4 v4, s[28:31], s101 offen offset:0  lds
    s_add_u32 m0, s66, 151552
    s_add_u32 s101, s87, 4096
    buffer_load_dwordx4 v6, s[32:35], s101 offen offset:0  lds
    s_add_u32 m0, s66, 135168
    s_nop 0
    buffer_load_dwordx4 v6, s[32:35], s87 offen offset:0  lds
    s_add_u32 m0, s65, 118784
    s_nop 0
    buffer_load_dwordx4 v5, s[28:31], s86 offen offset:0  lds
    s_add_u32 m0, s67, 141312
    s_nop 0
    s_nop 0
    buffer_load_dwordx4 v7, s[32:35], s87 offen offset:2048  lds
    s_add_u32 m0, s65, 120832
    s_add_u32 s101, s86, 32768
    buffer_load_dwordx4 v5, s[28:31], s101 offen offset:0  lds
    s_add_u32 m0, s67, 151552
    s_add_u32 s101, s87, 4096
    buffer_load_dwordx4 v7, s[32:35], s101 offen offset:0  lds
    s_add_u32 m0, s67, 135168
    s_nop 0
    buffer_load_dwordx4 v7, s[32:35], s87 offen offset:0  lds
    s_add_u32 s86, s86, 128
    s_add_u32 s87, s87, 393216
    s_and_b32 s86, s86, 2047
    s_cselect_b32 s87, s87, 0
    s_waitcnt vmcnt(10)
    s_barrier
    s_cmp_lg_u32 s76, 0
    s_cbranch_scc1 Lfl_23
    s_getreg_b32 s99, hwreg(HW_REG_XCC_ID, 0, 4)
    v_mov_b32 v198, s75
    v_mov_b32 v199, s99
    v_lshlrev_b32 v197, 3, v2
    s_lshl_b32 s78, s77, 7
    s_lshl_b32 s79, s77, 9
    s_add_u32 s79, s79, 8912896
    s_add_u32 s78, s78, 4096
    s_lshl_b32 s80, s71, 4
    s_add_u32 s80, s80, s72
    s_lshl_b32 s80, s80, 7
    s_add_u32 s80, s80, 8847360
    s_mov_b64 exec, 0xffff
    buffer_store_dwordx2 v[198:199], v197, s[36:39], s78 offen sc1
    buffer_store_dwordx2 v[198:199], v197, s[36:39], s80 offen sc1
    s_mov_b64 exec, -1
    v_not_b32 v200, v198
    v_mov_b32 v201, 0
    buffer_store_dwordx2 v[200:201], v197, s[36:39], s79 offen sc1
    v_and_b32 v196, 15, v2
    v_lshlrev_b32 v197, 4, v196
    v_add_u32_e64 v197, s69, v197
    s_lshl_b32 s78, s70, 4
    s_lshl_b32 s79, s71, 4
    s_add_u32 s79, s79, 69088
    v_mov_b32 v202, s78
    v_mov_b32 v203, s79
    v_cmp_gt_u32 vcc, 32, v2
    s_nop 1
    v_cndmask_b32 v202, v203, v202, vcc
    v_add_u32 v196, v202, v196
    v_cmp_gt_u32 vcc, 16, v2
    s_nop 1
    v_cndmask_b32 v196, v196, v197, vcc
    v_lshlrev_b32 v196, 7, v196
    v_add_u32 v196, 4096, v196
Lfl_23:
    s_add_u32 m0, s64, 36864
    s_nop 0
    buffer_load_dwordx4 v4, s[28:31], s86 offen offset:0  lds
    s_add_u32 m0, s66, 59392
    s_nop 0
    buffer_load_dwordx4 v6, s[32:35], s87 offen offset:2048  lds
    s_add_u32 m0, s64, 38912
    s_add_u32 s101, s86, 32768
    buffer_load_dwordx4 v4, s[28:31], s101 offen offset:0  lds
    s_add_u32 m0, s66, 69632
    s_add_u32 s101, s87, 4096
    buffer_load_dwordx4 v6, s[32:35], s101 offen offset:0  lds
    s_add_u32 m0, s66, 53248
    s_nop 0
    buffer_load_dwordx4 v6, s[32:35], s87 offen offset:0  lds
    s_add_u32 m0, s65, 36864
    s_nop 0
    buffer_load_dwordx4 v5, s[28:31], s86 offen offset:0  lds
    s_add_u32 m0, s67, 59392
    s_nop 0
    s_nop 0
    buffer_load_dwordx4 v7, s[32:35], s87 offen offset:2048  lds
    s_add_u32 m0, s65, 38912
    s_add_u32 s101, s86, 32768
    buffer_load_dwordx4 v5, s[28:31], s101 offen offset:0  lds
    s_add_u32 m0, s67, 69632
    s_add_u32 s101, s87, 4096
    buffer_load_dwordx4 v7, s[32:35], s101 offen offset:0  lds
    s_add_u32 m0, s67, 53248
    s_nop 0
    buffer_load_dwordx4 v7, s[32:35], s87 offen offset:0  lds
    s_add_u32 s86, s86, 128
    s_add_u32 s87, s87, 393216
    s_and_b32 s86, s86, 2047
    s_cselect_b32 s87, s87, 0
    s_mov_b32 s100, 0
    buffer_load_dwordx4 v[64:67], v244, s[48:51], s100 offen nt
    s_mov_b32 s100, 0
    buffer_load_dwordx4 v[96:99], v244, s[52:55], s100 offen nt
    s_mov_b32 s100, 7168
    buffer_load_dwordx4 v[68:71], v244, s[48:51], s100 offen nt
    s_mov_b32 s100, 7168
    buffer_load_dwordx4 v[100:103], v244, s[52:55], s100 offen nt
    s_mov_b32 s100, 14336
    buffer_load_dwordx4 v[72:75], v244, s[48:51], s100 offen nt
    s_mov_b32 s100, 14336
    buffer_load_dwordx4 v[104:107], v244, s[52:55], s100 offen nt
    s_mov_b32 s100, 21504
    buffer_load_dwordx4 v[76:79], v244, s[48:51], s100 offen nt
    s_waitcnt vmcnt(17)
    s_barrier
    s_add_u32 m0, s64, 77824
    s_nop 0
    buffer_load_dwordx4 v4, s[28:31], s86 offen offset:0  lds
    s_add_u32 m0, s66, 100352
    s_nop 0
    buffer_load_dwordx4 v6, s[32:35], s87 offen offset:2048  lds
    s_add_u32 m0, s64, 79872
    s_add_u32 s101, s86, 32768
    buffer_load_dwordx4 v4, s[28:31], s101 offen offset:0  lds
    s_add_u32 m0, s66, 110592
    s_add_u32 s101, s87, 4096
    buffer_load_dwordx4 v6, s[32:35], s101 offen offset:0  lds
    s_add_u32 m0, s66, 94208
    s_nop 0
    buffer_load_dwordx4 v6, s[32:35], s87 offen offset:0  lds
    s_add_u32 m0, s65, 77824
    s_nop 0
    buffer_load_dwordx4 v5, s[28:31], s86 offen offset:0  lds
    s_add_u32 m0, s67, 100352
    s_nop 0
    s_nop 0
    buffer_load_dwordx4 v7, s[32:35], s87 offen offset:2048  lds
    s_add_u32 m0, s65, 79872
    s_add_u32 s101, s86, 32768
    buffer_load_dwordx4 v5, s[28:31], s101 offen offset:0  lds
    s_add_u32 m0, s67, 110592
    s_add_u32 s101, s87, 4096
    buffer_load_dwordx4 v7, s[32:35], s101 offen offset:0  lds
    s_add_u32 m0, s67, 94208
    s_nop 0
    buffer_load_dwordx4 v7, s[32:35], s87 offen offset:0  lds
    s_add_u32 s86, s86, 128
    s_add_u32 s87, s87, 393216
    s_and_b32 s86, s86, 2047
    s_cselect_b32 s87, s87, 0
    s_waitcnt vmcnt(17)
    s_barrier
    s_add_u32 m0, s64, 118784
    s_nop 0
    buffer_load_dwordx4 v4, s[28:31], s86 offen offset:0  lds
    s_add_u32 m0, s66, 141312
    s_nop 0
    buffer_load_dwordx4 v6, s[32:35], s87 offen offset:2048  lds
    s_add_u32 m0, s64, 120832
    s_add_u32 s101, s86, 32768
    buffer_load_dwordx4 v4, s[28:31], s101 offen offset:0  lds
    s_add_u32 m0, s66, 151552
    s_add_u32 s101, s87, 4096
    buffer_load_dwordx4 v6, s[32:35], s101 offen offset:0  lds
    s_add_u32 m0, s66, 135168
    s_nop 0
    buffer_load_dwordx4 v6, s[32:35], s87 offen offset:0  lds
    s_add_u32 m0, s65, 118784
    s_nop 0
    buffer_load_dwordx4 v5, s[28:31], s86 offen offset:0  lds
    s_add_u32 m0, s67, 141312
    s_nop 0
    s_nop 0
    buffer_load_dwordx4 v7, s[32:35], s87 offen offset:2048  lds
    s_add_u32 m0, s65, 120832
    s_add_u32 s101, s86, 32768
    buffer_load_dwordx4 v5, s[28:31], s101 offen offset:0  lds
    s_add_u32 m0, s67, 151552
    s_add_u32 s101, s87, 4096
    buffer_load_dwordx4 v7, s[32:35], s101 offen offset:0  lds
    s_add_u32 m0, s67, 135168
    s_nop 0
    buffer_load_dwordx4 v7, s[32:35], s87 offen offset:0  lds
    s_add_u32 s86, s86, 128
    s_add_u32 s87, s87, 393216
    s_and_b32 s86, s86, 2047
    s_cselect_b32 s87, s87, 0
    s_waitcnt vmcnt(10)
    s_barrier
    s_add_u32 m0, s64, 36864
    s_nop 0
    buffer_load_dwordx4 v4, s[28:31], s86 offen offset:0  lds
    s_add_u32 m0, s66, 59392
    s_nop 0
    buffer_load_dwordx4 v6, s[32:35], s87 offen offset:2048  lds
    s_add_u32 m0, s64, 38912
    s_add_u32 s101, s86, 32768
    buffer_load_dwordx4 v4, s[28:31], s101 offen offset:0  lds
    s_add_u32 m0, s66, 69632
    s_add_u32 s101, s87, 4096
    buffer_load_dwordx4 v6, s[32:35], s101 offen offset:0  lds
    s_add_u32 m0, s66, 53248
    s_nop 0
    buffer_load_dwordx4 v6, s[32:35], s87 offen offset:0  lds
    s_add_u32 m0, s65, 36864
    s_nop 0
    buffer_load_dwordx4 v5, s[28:31], s86 offen offset:0  lds
    s_add_u32 m0, s67, 59392
    s_nop 0
    s_nop 0
    buffer_load_dwordx4 v7, s[32:35], s87 offen offset:2048  lds
    s_add_u32 m0, s65, 38912
    s_add_u32 s101, s86, 32768
    buffer_load_dwordx4 v5, s[28:31], s101 offen offset:0  lds
    s_add_u32 m0, s67, 69632
    s_add_u32 s101, s87, 4096
    buffer_load_dwordx4 v7, s[32:35], s101 offen offset:0  lds
    s_add_u32 m0, s67, 53248
    s_nop 0
    buffer_load_dwordx4 v7, s[32:35], s87 offen offset:0  lds
    s_add_u32 s86, s86, 128
    s_add_u32 s87, s87, 393216
    s_and_b32 s86, s86, 2047
    s_cselect_b32 s87, s87, 0
    s_waitcnt vmcnt(10)
    s_barrier
    s_add_u32 m0, s64, 77824
    s_nop 0
    buffer_load_dwordx4 v4, s[28:31], s86 offen offset:0  lds
    s_add_u32 m0, s66, 100352
    s_nop 0
    buffer_load_dwordx4 v6, s[32:35], s87 offen offset:2048  lds
    s_add_u32 m0, s64, 79872
    s_add_u32 s101, s86, 32768
    buffer_load_dwordx4 v4, s[28:31], s101 offen offset:0  lds
    s_add_u32 m0, s66, 110592
    s_add_u32 s101, s87, 4096
    buffer_load_dwordx4 v6, s[32:35], s101 offen offset:0  lds
    s_add_u32 m0, s66, 94208
    s_nop 0
    buffer_load_dwordx4 v6, s[32:35], s87 offen offset:0  lds
    s_add_u32 m0, s65, 77824
    s_nop 0
    buffer_load_dwordx4 v5, s[28:31], s86 offen offset:0  lds
    s_add_u32 m0, s67, 100352
    s_nop 0
    s_nop 0
    buffer_load_dwordx4 v7, s[32:35], s87 offen offset:2048  lds
    s_add_u32 m0, s65, 79872
    s_add_u32 s101, s86, 32768
    buffer_load_dwordx4 v5, s[28:31], s101 offen offset:0  lds
    s_add_u32 m0, s67, 110592
    s_add_u32 s101, s87, 4096
    buffer_load_dwordx4 v7, s[32:35], s101 offen offset:0  lds
    s_add_u32 m0, s67, 94208
    s_nop 0
    buffer_load_dwordx4 v7, s[32:35], s87 offen offset:0  lds
    s_add_u32 s86, s86, 128
    s_add_u32 s87, s87, 393216
    s_and_b32 s86, s86, 2047
    s_cselect_b32 s87, s87, 0
    s_waitcnt vmcnt(10)
    s_barrier
    s_add_u32 m0, s64, 118784
    s_nop 0
    buffer_load_dwordx4 v4, s[28:31], s86 offen offset:0  lds
    s_add_u32 m0, s66, 141312
    s_nop 0
    buffer_load_dwordx4 v6, s[32:35], s87 offen offset:2048  lds
    s_add_u32 m0, s64, 120832
    s_add_u32 s101, s86, 32768
    buffer_load_dwordx4 v4, s[28:31], s101 offen offset:0  lds
    s_add_u32 m0, s66, 151552
    s_add_u32 s101, s87, 4096
    buffer_load_dwordx4 v6, s[32:35], s101 offen offset:0  lds
    s_add_u32 m0, s66, 135168
    s_nop 0
    buffer_load_dwordx4 v6, s[32:35], s87 offen offset:0  lds
    s_add_u32 m0, s65, 118784
    s_nop 0
    buffer_load_dwordx4 v5, s[28:31], s86 offen offset:0  lds
    s_add_u32 m0, s67, 141312
    s_nop 0
    s_nop 0
    buffer_load_dwordx4 v7, s[32:35], s87 offen offset:2048  lds
    s_add_u32 m0, s65, 120832
    s_add_u32 s101, s86, 32768
    buffer_load_dwordx4 v5, s[28:31], s101 offen offset:0  lds
    s_add_u32 m0, s67, 151552
    s_add_u32 s101, s87, 4096
    buffer_load_dwordx4 v7, s[32:35], s101 offen offset:0  lds
    s_add_u32 m0, s67, 135168
    s_nop 0
    buffer_load_dwordx4 v7, s[32:35], s87 offen offset:0  lds
    s_add_u32 s86, s86, 128
    s_add_u32 s87, s87, 393216
    s_and_b32 s86, s86, 2047
    s_cselect_b32 s87, s87, 0
    s_mov_b32 s100, 21504
    buffer_load_dwordx4 v[108:111], v244, s[52:55], s100 offen nt
    s_mov_b32 s100, 28672
    buffer_load_dwordx4 v[80:83], v244, s[48:51], s100 offen nt
    s_mov_b32 s100, 28672
    buffer_load_dwordx4 v[112:115], v244, s[52:55], s100 offen nt
    s_mov_b32 s100, 35840
    buffer_load_dwordx4 v[84:87], v244, s[48:51], s100 offen nt
    s_mov_b32 s100, 35840
    buffer_load_dwordx4 v[116:119], v244, s[52:55], s100 offen nt
    s_mov_b32 s100, 43008
    buffer_load_dwordx4 v[88:91], v244, s[48:51], s100 offen nt
    s_mov_b32 s100, 43008
    buffer_load_dwordx4 v[120:123], v244, s[52:55], s100 offen nt
    s_waitcnt vmcnt(17)
    s_barrier
    s_add_u32 m0, s64, 36864
    s_nop 0
    buffer_load_dwordx4 v4, s[28:31], s86 offen offset:0  lds
    s_add_u32 m0, s66, 59392
    s_nop 0
    buffer_load_dwordx4 v6, s[32:35], s87 offen offset:2048  lds
    s_add_u32 m0, s64, 38912
    s_add_u32 s101, s86, 32768
    buffer_load_dwordx4 v4, s[28:31], s101 offen offset:0  lds
    s_add_u32 m0, s66, 69632
    s_add_u32 s101, s87, 4096
    buffer_load_dwordx4 v6, s[32:35], s101 offen offset:0  lds
    s_add_u32 m0, s66, 53248
    s_nop 0
    buffer_load_dwordx4 v6, s[32:35], s87 offen offset:0  lds
    s_add_u32 m0, s65, 36864
    s_nop 0
    buffer_load_dwordx4 v5, s[28:31], s86 offen offset:0  lds
    s_add_u32 m0, s67, 59392
    s_nop 0
    s_nop 0
    buffer_load_dwordx4 v7, s[32:35], s87 offen offset:2048  lds
    s_add_u32 m0, s65, 38912
    s_add_u32 s101, s86, 32768
    buffer_load_dwordx4 v5, s[28:31], s101 offen offset:0  lds
    s_add_u32 m0, s67, 69632
    s_add_u32 s101, s87, 4096
    buffer_load_dwordx4 v7, s[32:35], s101 offen offset:0  lds
    s_add_u32 m0, s67, 53248
    s_nop 0
    buffer_load_dwordx4 v7, s[32:35], s87 offen offset:0  lds
    s_add_u32 s86, s86, 128
    s_add_u32 s87, s87, 393216
    s_and_b32 s86, s86, 2047
    s_cselect_b32 s87, s87, 0
    s_waitcnt vmcnt(17)
    s_barrier
    s_cmp_lg_u32 s76, 0
    s_cbranch_scc1 Lpl_24
    s_mov_b32 exec_hi, 0xffff
    buffer_load_dwordx2 v[198:199], v196, s[36:39], 0 offen sc1
    s_mov_b64 exec, -1
Lpl_24:
    s_add_u32 m0, s64, 77824
    s_nop 0
    buffer_load_dwordx4 v4, s[28:31], s86 offen offset:0  lds
    s_add_u32 m0, s66, 100352
    s_nop 0
    s_nop 0
    buffer_load_dwordx4 v6, s[32:35], s87 offen offset:2048  lds
    s_add_u32 m0, s64, 79872
    s_add_u32 s101, s86, 32768
    buffer_load_dwordx4 v4, s[28:31], s101 offen offset:0  lds
    s_add_u32 m0, s66, 110592
    s_add_u32 s101, s87, 4096
    buffer_load_dwordx4 v6, s[32:35], s101 offen offset:0  lds
    s_add_u32 m0, s66, 94208
    s_nop 0
    buffer_load_dwordx4 v6, s[32:35], s87 offen offset:0  lds
    s_add_u32 m0, s65, 77824
    s_nop 0
    buffer_load_dwordx4 v5, s[28:31], s86 offen offset:0  lds
    s_add_u32 m0, s67, 100352
    s_nop 0
    s_nop 0
    buffer_load_dwordx4 v7, s[32:35], s87 offen offset:2048  lds
    s_add_u32 m0, s65, 79872
    s_add_u32 s101, s86, 32768
    buffer_load_dwordx4 v5, s[28:31], s101 offen offset:0  lds
    s_add_u32 m0, s67, 110592
    s_add_u32 s101, s87, 4096
    buffer_load_dwordx4 v7, s[32:35], s101 offen offset:0  lds
    s_add_u32 m0, s67, 94208
    s_nop 0
    buffer_load_dwordx4 v7, s[32:35], s87 offen offset:0  lds
    s_add_u32 s86, s86, 128
    s_add_u32 s87, s87, 393216
    s_and_b32 s86, s86, 2047
    s_cselect_b32 s87, s87, 0
    s_waitcnt vmcnt(10)
    s_barrier
    s_cmp_lg_u32 s76, 2
    s_cbranch_scc1 Lc4_25
    s_mov_b32 exec_hi, -1
    buffer_load_dword v238, v63, s[40:43], 0 offen
    s_mov_b64 exec, -1
Lc4_25:
    s_add_u32 m0, s64, 118784
    s_nop 0
    buffer_load_dwordx4 v4, s[28:31], s86 offen offset:0  lds
    s_add_u32 m0, s66, 141312
    s_nop 0
    buffer_load_dwordx4 v6, s[32:35], s87 offen offset:2048  lds
    s_add_u32 m0, s64, 120832
    s_add_u32 s101, s86, 32768
    buffer_load_dwordx4 v4, s[28:31], s101 offen offset:0  lds
    s_add_u32 m0, s66, 151552
    s_add_u32 s101, s87, 4096
    buffer_load_dwordx4 v6, s[32:35], s101 offen offset:0  lds
    s_add_u32 m0, s66, 135168
    s_nop 0
    buffer_load_dwordx4 v6, s[32:35], s87 offen offset:0  lds
    s_add_u32 m0, s65, 118784
    s_nop 0
    buffer_load_dwordx4 v5, s[28:31], s86 offen offset:0  lds
    s_add_u32 m0, s67, 141312
    s_nop 0
    s_nop 0
    buffer_load_dwordx4 v7, s[32:35], s87 offen offset:2048  lds
    s_add_u32 m0, s65, 120832
    s_add_u32 s101, s86, 32768
    buffer_load_dwordx4 v5, s[28:31], s101 offen offset:0  lds
    s_add_u32 m0, s67, 151552
    s_add_u32 s101, s87, 4096
    buffer_load_dwordx4 v7, s[32:35], s101 offen offset:0  lds
    s_add_u32 m0, s67, 135168
    s_nop 0
    buffer_load_dwordx4 v7, s[32:35], s87 offen offset:0  lds
    s_add_u32 s86, s86, 128
    s_add_u32 s87, s87, 393216
    s_and_b32 s86, s86, 2047
    s_cselect_b32 s87, s87, 0
    s_waitcnt vmcnt(10)
    s_cmp_lg_u32 s76, 0
    s_cbranch_scc1 Lpc_26
    s_mov_b32 exec_hi, 0xffff
    s_mov_b32 s85, 0
    s_branch Lpk_27
Lspin_28:
    s_add_u32 s85, s85, 1
    s_cmp_gt_u32 s85, 400000
    s_cbranch_scc1 L_end
    buffer_load_dwordx2 v[198:199], v196, s[36:39], 0 offen sc1
    s_waitcnt vmcnt(0)
Lpk_27:
    v_cmp_ne_u32 vcc, s75, v198
    s_cbranch_vccnz Lspin_28
    v_cmp_ne_u32 vcc, s99, v199
    s_mov_b64 exec, -1
    s_lshr_b32 s78, vcc_lo, 16
    s_cselect_b32 s78, 0, 1
    s_cmp_eq_u32 vcc_hi, 0
    s_cselect_b32 s79, 2, 0
    s_or_b32 s78, s78, s79
    s_and_b32 s78, s78, 3
    v_mov_b32_e64 v198, s78
    v_mov_b32 v199, 163584
    ds_write_b32 v199, v198
    s_waitcnt lgkmcnt(0)
Lpc_26:
    s_barrier
    v_lshrrev_b32 v196, 4, v2
    v_and_b32 v197, 15, v2
    v_lshlrev_b32_e64 v197, 4, v197
    v_lshl_add_u32 v198, v196, 10, v197
    s_lshl_b32 s78, s69, 14
    s_lshl_b32 s79, s76, 8
    s_add_u32 s78, s78, s79
    s_nop 0
    s_add_u32 s78, s78, 65536
    buffer_load_dwordx4 v[20:23], v198, s[36:39], s78 offen sc1
    s_add_u32 s78, s78, 4096
    buffer_load_dwordx4 v[24:27], v198, s[36:39], s78 offen sc1
    s_add_u32 s78, s78, 4096
    buffer_load_dwordx4 v[28:31], v198, s[36:39], s78 offen sc1
    s_add_u32 s78, s78, 4096
    buffer_load_dwordx4 v[32:35], v198, s[36:39], s78 offen sc1
    v_mul_u32_u24 v198, 768, v196
    v_add_u32_e64 v198, v198, v197
    s_mul_i32 s78, s70, 12288
    s_lshl_b32 s79, s76, 8
    s_add_u32 s78, s78, s79
    s_add_u32 s78, s78, 327680
    s_cmp_eq_u32 s76, 3
    s_nop 0
    s_cselect_b32 s78, 0x10000000, s78
    buffer_load_dwordx4 v[36:39], v198, s[36:39], s78 offen sc1
    s_add_u32 s78, s78, 3072
    buffer_load_dwordx4 v[40:43], v198, s[36:39], s78 offen sc1
    s_add_u32 s78, s78, 3072
    buffer_load_dwordx4 v[44:47], v198, s[36:39], s78 offen sc1
    s_add_u32 s78, s78, 3072
    buffer_load_dwordx4 v[48:51], v198, s[36:39], s78 offen sc1
    s_add_u32 m0, s84, 0
    s_mov_b32 s100, 0
    buffer_load_dwordx4 v246, s[40:43], s100 offen  lds
    s_add_u32 m0, s84, 4096
    s_mov_b32 s100, 65536
    buffer_load_dwordx4 v246, s[40:43], s100 offen  lds
    s_add_u32 m0, s84, 8192
    s_mov_b32 s100, 131072
    buffer_load_dwordx4 v246, s[40:43], s100 offen  lds
    s_add_u32 m0, s84, 12288
    s_mov_b32 s100, 196608
    buffer_load_dwordx4 v246, s[40:43], s100 offen  lds
    s_waitcnt vmcnt(12)
    s_waitcnt lgkmcnt(0)
    s_barrier
    s_setprio 2
    s_add_u32 m0, s84, 16384
    s_mov_b32 s100, 262144
    buffer_load_dwordx4 v246, s[40:43], s100 offen  lds
    s_waitcnt vmcnt(9)
    v_add_f32 v20, v20, v24
    v_add_f32 v21, v21, v25
    v_add_f32 v22, v22, v26
    v_add_f32 v23, v23, v27
    v_add_f32 v20, v20, v28
    v_add_f32_e64 v21, v21, v29
    s_add_u32 m0, s84, 20480
    s_mov_b32 s100, 327680
    buffer_load_dwordx4 v246, s[40:43], s100 offen  lds
    v_add_f32 v22, v22, v30
    v_add_f32 v23, v23, v31
    v_add_f32 v20, v20, v32
    v_add_f32 v21, v21, v33
    v_add_f32 v22, v22, v34
    v_add_f32 v23, v23, v35
    s_nop 0
    v_permlane32_swap_b32 v20, v22
    s_add_u32 m0, s84, 24576
    s_mov_b32 s100, 393216
    buffer_load_dwordx4 v246, s[40:43], s100 offen  lds
    v_permlane32_swap_b32 v21, v23
    v_add_f32 v20, v20, v22
    v_add_f32 v21, v21, v23
    v_mov_b32 v22, v20
    v_mov_b32 v23, v21
    s_nop 0
    v_permlane16_swap_b32 v20, v22
    v_permlane16_swap_b32 v21, v23
    v_add_f32_e64 v20, v20, v22
    s_add_u32 m0, s84, 28672
    s_mov_b32 s100, 458752
    buffer_load_dwordx4 v246, s[40:43], s100 offen  lds
    v_add_f32_e64 v21, v21, v23
    v_mul_f32 v24, 0x3a800000, v20
    v_mul_f32 v26, 0x3a800000, v21
    v_fma_f32 v26, -v24, v24, v26
    v_max_f32_e64 v26, 0, v26
    v_cvt_pk_bf16_f32 v24, v24, v24
    v_and_b32 v24, 0xffff0000, v24
    s_add_u32 m0, s84, 32768
    s_mov_b32 s100, 524288
    buffer_load_dwordx4 v246, s[40:43], s100 offen  lds
    v_cvt_pk_bf16_f32 v26, v26, v26
    v_and_b32 v26, 0xffff0000, v26
    v_add_f32 v26, 0x3727c5ac, v26
    v_cvt_pk_bf16_f32 v26, v26, v26
    v_and_b32 v26, 0xffff0000, v26
    v_sqrt_f32 v26, v26
    s_nop 0
    v_cvt_pk_bf16_f32 v26, v26, v26
    v_and_b32 v26, 0xffff0000, v26
    s_add_u32 m0, s84, 36864
    s_mov_b32 s100, 589824
    buffer_load_dwordx4 v246, s[40:43], s100 offen  lds
    v_rcp_f32_e64 v25, v26
    v_xor_b32 v26, 0x80000000, v24
    v_lshrrev_b32 v27, 16, v26
    v_or_b32 v26, v26, v27
    v_mov_b32 v27, 0
    v_and_b32 v196, 15, v2
    v_lshrrev_b32_e64 v197, 5, v2
    s_add_u32 m0, s84, 40960
    s_mov_b32 s100, 655360
    buffer_load_dwordx4 v246, s[40:43], s100 offen  lds
    v_lshl_add_u32 v196, v196, 1, v197
    s_lshl_b32 s78, s76, 5
    v_add_u32 v196, s78, v196
    v_lshlrev_b32_e64 v197, 3, v196
    v_add_u32 v197, 159744, v197
    v_lshlrev_b32_e64 v196, 2, v196
    v_add_u32 v196, 162304, v196
    s_add_u32 m0, s84, 45056
    s_mov_b32 s100, 720896
    buffer_load_dwordx4 v246, s[40:43], s100 offen  lds
    ds_write_b64 v197, v[26:27]
    ds_write_b32 v196, v25
    s_waitcnt vmcnt(12)
    v_add_f32 v36, v36, v40
    v_add_f32 v37, v37, v41
    v_add_f32 v38, v38, v42
    v_add_f32 v39, v39, v43
    v_add_f32 v36, v36, v44
    s_add_u32 m0, s84, 49152
    s_mov_b32 s100, 786432
    buffer_load_dwordx4 v246, s[40:43], s100 offen  lds
    v_add_f32 v37, v37, v45
    v_add_f32 v38, v38, v46
    v_add_f32 v39, v39, v47
    v_add_f32 v36, v36, v48
    v_add_f32 v37, v37, v49
    v_add_f32 v38, v38, v50
    v_add_f32_e64 v39, v39, v51
    s_add_u32 m0, s84, 53248
    s_mov_b32 s100, 851968
    buffer_load_dwordx4 v246, s[40:43], s100 offen  lds
    v_permlane32_swap_b32 v36, v38
    v_permlane32_swap_b32 v37, v39
    v_add_f32 v36, v36, v38
    v_add_f32 v37, v37, v39
    s_nop 1
    v_permlane16_swap_b32 v36, v37
    v_add_f32_e64 v36, v36, v37
    v_cvt_pk_bf16_f32 v37, v36, v36
    v_and_b32 v37, 0xffff0000, v37
    s_add_u32 m0, s84, 57344
    s_mov_b32 s100, 917504
    buffer_load_dwordx4 v246, s[40:43], s100 offen  lds
    v_sub_f32_e64 v38, v36, v37
    v_cvt_pk_bf16_f32 v38, v37, v38
    v_mov_b32 v39, 0
    v_and_b32 v196, 15, v2
    v_lshrrev_b32_e64 v197, 4, v2
    v_lshl_add_u32 v196, v196, 2, v197
    s_lshl_b32 s78, s76, 9
    s_add_u32 m0, s84, 61440
    s_mov_b32 s100, 983040
    buffer_load_dwordx4 v246, s[40:43], s100 offen  lds
    s_add_u32 s78, s78, 160768
    v_lshl_add_u32 v196, v196, 3, s78
    v_and_b32 v197, 15, v2
    v_lshlrev_b32_e64 v197, 3, v197
    v_add_u32 v197, 162816, v197
    v_mov_b32 v198, 0x3f803f80
    s_cmp_eq_u32 s76, 3
    s_cselect_b64 vcc, -1, 0
    v_cndmask_b32 v196, v196, v197, vcc
    v_cndmask_b32 v38, v38, v198, vcc
    v_cndmask_b32_e64 v39, v39, v198, vcc
    ds_write_b64 v196, v[38:39]
    s_setprio 0
    s_waitcnt lgkmcnt(0)
    s_barrier
    s_branch L_phend
L_ph4:
    s_add_u32 m0, s64, 36864
    s_nop 0
    buffer_load_dwordx4 v4, s[28:31], s86 offen offset:0  lds
    s_add_u32 m0, s66, 59392
    s_nop 0
    buffer_load_dwordx4 v6, s[32:35], s87 offen offset:2048  lds
    s_add_u32 m0, s64, 38912
    s_add_u32 s101, s86, 32768
    buffer_load_dwordx4 v4, s[28:31], s101 offen offset:0  lds
    s_add_u32 m0, s66, 69632
    s_add_u32 s101, s87, 4096
    buffer_load_dwordx4 v6, s[32:35], s101 offen offset:0  lds
    s_add_u32 m0, s66, 53248
    s_nop 0
    buffer_load_dwordx4 v6, s[32:35], s87 offen offset:0  lds
    s_add_u32 m0, s65, 36864
    s_nop 0
    buffer_load_dwordx4 v5, s[28:31], s86 offen offset:0  lds
    s_add_u32 m0, s67, 59392
    s_nop 0
    s_nop 0
    buffer_load_dwordx4 v7, s[32:35], s87 offen offset:2048  lds
    s_add_u32 m0, s65, 38912
    s_add_u32 s101, s86, 32768
    buffer_load_dwordx4 v5, s[28:31], s101 offen offset:0  lds
    s_add_u32 m0, s67, 69632
    s_add_u32 s101, s87, 4096
    buffer_load_dwordx4 v7, s[32:35], s101 offen offset:0  lds
    s_add_u32 m0, s67, 53248
    s_nop 0
    buffer_load_dwordx4 v7, s[32:35], s87 offen offset:0  lds
    s_add_u32 s86, s86, 128
    s_add_u32 s87, s87, 393216
    s_and_b32 s86, s86, 2047
    s_cselect_b32 s87, s87, 0
    s_waitcnt vmcnt(10)
    s_waitcnt lgkmcnt(0)
    s_barrier
    s_setprio 2
    s_add_u32 m0, s64, 77824
    s_nop 0
    s_nop 0
    buffer_load_dwordx4 v4, s[28:31], s86 offen offset:0  lds
    v_mov_b32 v200, 0x3f803f80
    v_mov_b32 v201, 0x3f803f80
    v_mov_b32 v202, 0x3f803f80
    v_mov_b32 v203, 0x3f803f80
    s_add_u32 m0, s66, 100352
    s_nop 0
    s_nop 0
    buffer_load_dwordx4 v6, s[32:35], s87 offen offset:2048  lds
    v_mfma_f32_16x16x32_bf16 v[204:207], v[200:203], v[20:23], 0
    v_mfma_f32_16x16x32_bf16 v[212:215], v[20:23], v[20:23], 0
    v_mfma_f32_16x16x32_bf16 v[208:211], v[200:203], v[24:27], 0
    v_mfma_f32_16x16x32_bf16 v[216:219], v[24:27], v[24:27], 0
    s_add_u32 m0, s64, 79872
    s_add_u32 s101, s86, 32768
    buffer_load_dwordx4 v4, s[28:31], s101 offen offset:0  lds
    v_mfma_f32_16x16x32_bf16 v[220:223], v[200:203], v[36:39], 0
    v_mfma_f32_16x16x32_bf16 v[224:227], v[200:203], v[44:47], 0
    v_mfma_f32_16x16x32_bf16 v[228:231], v[200:203], v[52:55], 0
    v_mfma_f32_16x16x32_bf16 v[204:207], v[200:203], v[28:31], v[204:207]
    v_mfma_f32_16x16x32_bf16 v[212:215], v[28:31], v[28:31], v[212:215]
    s_add_u32 m0, s66, 110592
    s_add_u32 s101, s87, 4096
    buffer_load_dwordx4 v6, s[32:35], s101 offen offset:0  lds
    v_mfma_f32_16x16x32_bf16 v[208:211], v[200:203], v[32:35], v[208:211]
    v_mfma_f32_16x16x32_bf16 v[216:219], v[32:35], v[32:35], v[216:219]
    v_mfma_f32_16x16x32_bf16 v[220:223], v[200:203], v[40:43], v[220:223]
    v_mfma_f32_16x16x32_bf16 v[224:227], v[200:203], v[48:51], v[224:227]
    s_add_u32 m0, s66, 94208
    s_nop 0
    buffer_load_dwordx4 v6, s[32:35], s87 offen offset:0  lds
    v_mfma_f32_16x16x32_bf16 v[228:231], v[200:203], v[56:59], v[228:231]
    v_and_b32 v196, 3, v2
    v_cmp_eq_u32 s[90:91], 1, v196
    v_cmp_eq_u32 s[92:93], 2, v196
    v_cmp_eq_u32_e64 vcc, 3, v196
    s_add_u32 m0, s65, 77824
    s_nop 0
    buffer_load_dwordx4 v5, s[28:31], s86 offen offset:0  lds
    v_cndmask_b32 v212, v212, v213, s[90:91]
    v_cndmask_b32 v212, v212, v214, s[92:93]
    v_cndmask_b32 v205, v212, v215, vcc
    v_cndmask_b32 v216, v216, v217, s[90:91]
    s_add_u32 m0, s67, 100352
    s_nop 0
    buffer_load_dwordx4 v7, s[32:35], s87 offen offset:2048  lds
    v_cndmask_b32 v216, v216, v218, s[92:93]
    v_cndmask_b32 v209, v216, v219, vcc
    v_lshrrev_b32_e64 v196, 4, v2
    v_cmp_eq_u32 s[90:91], 1, v196
    v_cmp_eq_u32_e64 vcc, 2, v196
    s_add_u32 m0, s65, 79872
    s_add_u32 s101, s86, 32768
    buffer_load_dwordx4 v5, s[28:31], s101 offen offset:0  lds
    v_cndmask_b32 v220, v220, v224, s[90:91]
    v_cndmask_b32_e64 v220, v220, v228, vcc
    s_mul_i32 s78, s77, 768
    s_mul_i32 s79, s76, 192
    s_add_u32 m0, s67, 110592
    s_add_u32 s101, s87, 4096
    buffer_load_dwordx4 v7, s[32:35], s101 offen offset:0  lds
    s_add_u32 s78, s78, s79
    s_add_u32 s78, s78, 327680
    v_lshlrev_b32 v197, 2, v2
    s_mov_b32 exec_hi, 0xffff
    buffer_store_dword v220, v197, s[36:39], s78 offen sc1
    s_mov_b32 exec_hi, -1
    s_lshl_b32 s78, s69, 4
    s_add_u32 m0, s67, 94208
    s_nop 0
    buffer_load_dwordx4 v7, s[32:35], s87 offen offset:0  lds
    s_add_u32 s86, s86, 128
    s_add_u32 s87, s87, 393216
    s_and_b32 s86, s86, 2047
    s_cselect_b32 s87, s87, 0
    s_add_u32 s78, s78, s70
    s_lshl_b32 s78, s78, 10
    s_lshl_b32 s79, s76, 8
    s_add_u32 s78, s78, s79
    buffer_store_dwordx4 v[16:19], v14, s[36:39], s96 offen offset:0 sc1
    s_add_u32 s78, s78, 65536
    v_and_b32 v198, 15, v2
    v_lshlrev_b32 v198, 3, v198
    s_mov_b32 exec_lo, 0x00f0000f
    s_mov_b32 exec_hi, 0xf0000f00
    buffer_store_dwordx2 v[204:205], v198, s[36:39], s78 offen offset:0 sc1
    s_mov_b64 exec, -1
    s_mov_b32 exec_lo, 0x00f0000f
    s_mov_b32 exec_hi, 0xf0000f00
    buffer_store_dwordx2 v[208:209], v198, s[36:39], s78 offen offset:128 sc1
    s_mov_b64 exec, -1
    s_setprio 0
    s_waitcnt vmcnt(14)
    s_waitcnt lgkmcnt(0)
    s_barrier
    s_add_u32 m0, s64, 118784
    s_nop 0
    buffer_load_dwordx4 v4, s[28:31], s86 offen offset:0  lds
    s_add_u32 m0, s66, 141312
    s_nop 0
    buffer_load_dwordx4 v6, s[32:35], s87 offen offset:2048  lds
    s_add_u32 m0, s64, 120832
    s_add_u32 s101, s86, 32768
    buffer_load_dwordx4 v4, s[28:31], s101 offen offset:0  lds
    s_add_u32 m0, s66, 151552
    s_add_u32 s101, s87, 4096
    buffer_load_dwordx4 v6, s[32:35], s101 offen offset:0  lds
    s_add_u32 m0, s66, 135168
    s_nop 0
    buffer_load_dwordx4 v6, s[32:35], s87 offen offset:0  lds
    s_add_u32 m0, s65, 118784
    s_nop 0
    buffer_load_dwordx4 v5, s[28:31], s86 offen offset:0  lds
    s_add_u32 m0, s67, 141312
    s_nop 0
    s_nop 0
    buffer_load_dwordx4 v7, s[32:35], s87 offen offset:2048  lds
    s_add_u32 m0, s65, 120832
    s_add_u32 s101, s86, 32768
    buffer_load_dwordx4 v5, s[28:31], s101 offen offset:0  lds
    s_add_u32 m0, s67, 151552
    s_add_u32 s101, s87, 4096
    buffer_load_dwordx4 v7, s[32:35], s101 offen offset:0  lds
    s_add_u32 m0, s67, 135168
    s_nop 0
    buffer_load_dwordx4 v7, s[32:35], s87 offen offset:0  lds
    s_add_u32 s86, s86, 128
    s_add_u32 s87, s87, 393216
    s_and_b32 s86, s86, 2047
    s_cselect_b32 s87, s87, 0
    s_waitcnt vmcnt(10)
    s_barrier
    s_cmp_lg_u32 s76, 0
    s_cbranch_scc1 Lfl_29
    s_getreg_b32 s99, hwreg(HW_REG_XCC_ID, 0, 4)
    v_mov_b32 v198, s75
    v_mov_b32 v199, s99
    v_lshlrev_b32 v197, 3, v2
    s_lshl_b32 s78, s77, 7
    s_lshl_b32 s79, s77, 9
    s_add_u32 s79, s79, 8912896
    s_add_u32 s78, s78, 4096
    s_lshl_b32 s80, s71, 4
    s_add_u32 s80, s80, s72
    s_lshl_b32 s80, s80, 7
    s_add_u32 s80, s80, 8847360
    s_mov_b64 exec, 0xffff
    buffer_store_dwordx2 v[198:199], v197, s[36:39], s78 offen sc1
    buffer_store_dwordx2 v[198:199], v197, s[36:39], s80 offen sc1
    s_mov_b64 exec, -1
    v_not_b32 v200, v198
    v_mov_b32 v201, 0
    buffer_store_dwordx2 v[200:201], v197, s[36:39], s79 offen sc1
    v_and_b32 v196, 15, v2
    v_lshlrev_b32 v197, 4, v196
    v_add_u32_e64 v197, s69, v197
    s_lshl_b32 s78, s70, 4
    s_lshl_b32 s79, s71, 4
    s_add_u32 s79, s79, 69088
    v_mov_b32 v202, s78
    v_mov_b32 v203, s79
    v_cmp_gt_u32 vcc, 32, v2
    s_nop 1
    v_cndmask_b32 v202, v203, v202, vcc
    v_add_u32 v196, v202, v196
    v_cmp_gt_u32 vcc, 16, v2
    s_nop 1
    v_cndmask_b32 v196, v196, v197, vcc
    v_lshlrev_b32 v196, 7, v196
    v_add_u32 v196, 4096, v196
Lfl_29:
    s_add_u32 m0, s64, 36864
    s_nop 0
    buffer_load_dwordx4 v4, s[28:31], s86 offen offset:0  lds
    s_add_u32 m0, s66, 59392
    s_nop 0
    buffer_load_dwordx4 v6, s[32:35], s87 offen offset:2048  lds
    s_add_u32 m0, s64, 38912
    s_add_u32 s101, s86, 32768
    buffer_load_dwordx4 v4, s[28:31], s101 offen offset:0  lds
    s_add_u32 m0, s66, 69632
    s_add_u32 s101, s87, 4096
    buffer_load_dwordx4 v6, s[32:35], s101 offen offset:0  lds
    s_add_u32 m0, s66, 53248
    s_nop 0
    buffer_load_dwordx4 v6, s[32:35], s87 offen offset:0  lds
    s_add_u32 m0, s65, 36864
    s_nop 0
    buffer_load_dwordx4 v5, s[28:31], s86 offen offset:0  lds
    s_add_u32 m0, s67, 59392
    s_nop 0
    s_nop 0
    buffer_load_dwordx4 v7, s[32:35], s87 offen offset:2048  lds
    s_add_u32 m0, s65, 38912
    s_add_u32 s101, s86, 32768
    buffer_load_dwordx4 v5, s[28:31], s101 offen offset:0  lds
    s_add_u32 m0, s67, 69632
    s_add_u32 s101, s87, 4096
    buffer_load_dwordx4 v7, s[32:35], s101 offen offset:0  lds
    s_add_u32 m0, s67, 53248
    s_nop 0
    buffer_load_dwordx4 v7, s[32:35], s87 offen offset:0  lds
    s_add_u32 s86, s86, 128
    s_add_u32 s87, s87, 393216
    s_and_b32 s86, s86, 2047
    s_cselect_b32 s87, s87, 0
    s_waitcnt vmcnt(10)
    s_barrier
    s_add_u32 m0, s64, 77824
    s_nop 0
    buffer_load_dwordx4 v4, s[28:31], s86 offen offset:0  lds
    s_add_u32 m0, s66, 100352
    s_nop 0
    buffer_load_dwordx4 v6, s[32:35], s87 offen offset:2048  lds
    s_add_u32 m0, s64, 79872
    s_add_u32 s101, s86, 32768
    buffer_load_dwordx4 v4, s[28:31], s101 offen offset:0  lds
    s_add_u32 m0, s66, 110592
    s_add_u32 s101, s87, 4096
    buffer_load_dwordx4 v6, s[32:35], s101 offen offset:0  lds
    s_add_u32 m0, s66, 94208
    s_nop 0
    buffer_load_dwordx4 v6, s[32:35], s87 offen offset:0  lds
    s_add_u32 m0, s65, 77824
    s_nop 0
    buffer_load_dwordx4 v5, s[28:31], s86 offen offset:0  lds
    s_add_u32 m0, s67, 100352
    s_nop 0
    s_nop 0
    buffer_load_dwordx4 v7, s[32:35], s87 offen offset:2048  lds
    s_add_u32 m0, s65, 79872
    s_add_u32 s101, s86, 32768
    buffer_load_dwordx4 v5, s[28:31], s101 offen offset:0  lds
    s_add_u32 m0, s67, 110592
    s_add_u32 s101, s87, 4096
    buffer_load_dwordx4 v7, s[32:35], s101 offen offset:0  lds
    s_add_u32 m0, s67, 94208
    s_nop 0
    buffer_load_dwordx4 v7, s[32:35], s87 offen offset:0  lds
    s_add_u32 s86, s86, 128
    s_add_u32 s87, s87, 393216
    s_and_b32 s86, s86, 2047
    s_cselect_b32 s87, s87, 0
    s_mov_b32 s100, 0
    buffer_load_dwordx4 v[64:67], v244, s[48:51], s100 offen nt
    s_mov_b32 s100, 0
    buffer_load_dwordx4 v[96:99], v244, s[52:55], s100 offen nt
    s_mov_b32 s100, 7168
    buffer_load_dwordx4 v[68:71], v244, s[48:51], s100 offen nt
    s_mov_b32 s100, 7168
    buffer_load_dwordx4 v[100:103], v244, s[52:55], s100 offen nt
    s_mov_b32 s100, 14336
    buffer_load_dwordx4 v[72:75], v244, s[48:51], s100 offen nt
    s_mov_b32 s100, 14336
    buffer_load_dwordx4 v[104:107], v244, s[52:55], s100 offen nt
    s_mov_b32 s100, 21504
    buffer_load_dwordx4 v[76:79], v244, s[48:51], s100 offen nt
    s_waitcnt vmcnt(17)
    s_barrier
    s_add_u32 m0, s64, 118784
    s_nop 0
    buffer_load_dwordx4 v4, s[28:31], s86 offen offset:0  lds
    s_add_u32 m0, s66, 141312
    s_nop 0
    buffer_load_dwordx4 v6, s[32:35], s87 offen offset:2048  lds
    s_add_u32 m0, s64, 120832
    s_add_u32 s101, s86, 32768
    buffer_load_dwordx4 v4, s[28:31], s101 offen offset:0  lds
    s_add_u32 m0, s66, 151552
    s_add_u32 s101, s87, 4096
    buffer_load_dwordx4 v6, s[32:35], s101 offen offset:0  lds
    s_add_u32 m0, s66, 135168
    s_nop 0
    buffer_load_dwordx4 v6, s[32:35], s87 offen offset:0  lds
    s_add_u32 m0, s65, 118784
    s_nop 0
    buffer_load_dwordx4 v5, s[28:31], s86 offen offset:0  lds
    s_add_u32 m0, s67, 141312
    s_nop 0
    s_nop 0
    buffer_load_dwordx4 v7, s[32:35], s87 offen offset:2048  lds
    s_add_u32 m0, s65, 120832
    s_add_u32 s101, s86, 32768
    buffer_load_dwordx4 v5, s[28:31], s101 offen offset:0  lds
    s_add_u32 m0, s67, 151552
    s_add_u32 s101, s87, 4096
    buffer_load_dwordx4 v7, s[32:35], s101 offen offset:0  lds
    s_add_u32 m0, s67, 135168
    s_nop 0
    buffer_load_dwordx4 v7, s[32:35], s87 offen offset:0  lds
    s_add_u32 s86, s86, 128
    s_add_u32 s87, s87, 393216
    s_and_b32 s86, s86, 2047
    s_cselect_b32 s87, s87, 0
    s_waitcnt vmcnt(17)
    s_barrier
    s_add_u32 m0, s64, 36864
    s_nop 0
    buffer_load_dwordx4 v4, s[28:31], s86 offen offset:0  lds
    s_add_u32 m0, s66, 59392
    s_nop 0
    buffer_load_dwordx4 v6, s[32:35], s87 offen offset:2048  lds
    s_add_u32 m0, s64, 38912
    s_add_u32 s101, s86, 32768
    buffer_load_dwordx4 v4, s[28:31], s101 offen offset:0  lds
    s_add_u32 m0, s66, 69632
    s_add_u32 s101, s87, 4096
    buffer_load_dwordx4 v6, s[32:35], s101 offen offset:0  lds
    s_add_u32 m0, s66, 53248
    s_nop 0
    buffer_load_dwordx4 v6, s[32:35], s87 offen offset:0  lds
    s_add_u32 m0, s65, 36864
    s_nop 0
    buffer_load_dwordx4 v5, s[28:31], s86 offen offset:0  lds
    s_add_u32 m0, s67, 59392
    s_nop 0
    s_nop 0
    buffer_load_dwordx4 v7, s[32:35], s87 offen offset:2048  lds
    s_add_u32 m0, s65, 38912
    s_add_u32 s101, s86, 32768
    buffer_load_dwordx4 v5, s[28:31], s101 offen offset:0  lds
    s_add_u32 m0, s67, 69632
    s_add_u32 s101, s87, 4096
    buffer_load_dwordx4 v7, s[32:35], s101 offen offset:0  lds
    s_add_u32 m0, s67, 53248
    s_nop 0
    buffer_load_dwordx4 v7, s[32:35], s87 offen offset:0  lds
    s_add_u32 s86, s86, 128
    s_add_u32 s87, s87, 393216
    s_and_b32 s86, s86, 2047
    s_cselect_b32 s87, s87, 0
    s_waitcnt vmcnt(10)
    s_barrier
    s_add_u32 m0, s64, 77824
    s_nop 0
    buffer_load_dwordx4 v4, s[28:31], s86 offen offset:0  lds
    s_add_u32 m0, s66, 100352
    s_nop 0
    buffer_load_dwordx4 v6, s[32:35], s87 offen offset:2048  lds
    s_add_u32 m0, s64, 79872
    s_add_u32 s101, s86, 32768
    buffer_load_dwordx4 v4, s[28:31], s101 offen offset:0  lds
    s_add_u32 m0, s66, 110592
    s_add_u32 s101, s87, 4096
    buffer_load_dwordx4 v6, s[32:35], s101 offen offset:0  lds
    s_add_u32 m0, s66, 94208
    s_nop 0
    buffer_load_dwordx4 v6, s[32:35], s87 offen offset:0  lds
    s_add_u32 m0, s65, 77824
    s_nop 0
    buffer_load_dwordx4 v5, s[28:31], s86 offen offset:0  lds
    s_add_u32 m0, s67, 100352
    s_nop 0
    s_nop 0
    buffer_load_dwordx4 v7, s[32:35], s87 offen offset:2048  lds
    s_add_u32 m0, s65, 79872
    s_add_u32 s101, s86, 32768
    buffer_load_dwordx4 v5, s[28:31], s101 offen offset:0  lds
    s_add_u32 m0, s67, 110592
    s_add_u32 s101, s87, 4096
    buffer_load_dwordx4 v7, s[32:35], s101 offen offset:0  lds
    s_add_u32 m0, s67, 94208
    s_nop 0
    buffer_load_dwordx4 v7, s[32:35], s87 offen offset:0  lds
    s_add_u32 s86, s86, 128
    s_add_u32 s87, s87, 393216
    s_and_b32 s86, s86, 2047
    s_cselect_b32 s87, s87, 0
    s_waitcnt vmcnt(10)
    s_barrier
    s_add_u32 m0, s64, 118784
    s_nop 0
    buffer_load_dwordx4 v4, s[28:31], s86 offen offset:0  lds
    s_add_u32 m0, s66, 141312
    s_nop 0
    buffer_load_dwordx4 v6, s[32:35], s87 offen offset:2048  lds
    s_add_u32 m0, s64, 120832
    s_add_u32 s101, s86, 32768
    buffer_load_dwordx4 v4, s[28:31], s101 offen offset:0  lds
    s_add_u32 m0, s66, 151552
    s_add_u32 s101, s87, 4096
    buffer_load_dwordx4 v6, s[32:35], s101 offen offset:0  lds
    s_add_u32 m0, s66, 135168
    s_nop 0
    buffer_load_dwordx4 v6, s[32:35], s87 offen offset:0  lds
    s_add_u32 m0, s65, 118784
    s_nop 0
    buffer_load_dwordx4 v5, s[28:31], s86 offen offset:0  lds
    s_add_u32 m0, s67, 141312
    s_nop 0
    s_nop 0
    buffer_load_dwordx4 v7, s[32:35], s87 offen offset:2048  lds
    s_add_u32 m0, s65, 120832
    s_add_u32 s101, s86, 32768
    buffer_load_dwordx4 v5, s[28:31], s101 offen offset:0  lds
    s_add_u32 m0, s67, 151552
    s_add_u32 s101, s87, 4096
    buffer_load_dwordx4 v7, s[32:35], s101 offen offset:0  lds
    s_add_u32 m0, s67, 135168
    s_nop 0
    buffer_load_dwordx4 v7, s[32:35], s87 offen offset:0  lds
    s_add_u32 s86, s86, 128
    s_add_u32 s87, s87, 393216
    s_and_b32 s86, s86, 2047
    s_cselect_b32 s87, s87, 0
    s_waitcnt vmcnt(10)
    s_barrier
    s_add_u32 m0, s64, 36864
    s_nop 0
    buffer_load_dwordx4 v4, s[28:31], s86 offen offset:0  lds
    s_add_u32 m0, s66, 59392
    s_nop 0
    buffer_load_dwordx4 v6, s[32:35], s87 offen offset:2048  lds
    s_add_u32 m0, s64, 38912
    s_add_u32 s101, s86, 32768
    buffer_load_dwordx4 v4, s[28:31], s101 offen offset:0  lds
    s_add_u32 m0, s66, 69632
    s_add_u32 s101, s87, 4096
    buffer_load_dwordx4 v6, s[32:35], s101 offen offset:0  lds
    s_add_u32 m0, s66, 53248
    s_nop 0
    buffer_load_dwordx4 v6, s[32:35], s87 offen offset:0  lds
    s_add_u32 m0, s65, 36864
    s_nop 0
    buffer_load_dwordx4 v5, s[28:31], s86 offen offset:0  lds
    s_add_u32 m0, s67, 59392
    s_nop 0
    s_nop 0
    buffer_load_dwordx4 v7, s[32:35], s87 offen offset:2048  lds
    s_add_u32 m0, s65, 38912
    s_add_u32 s101, s86, 32768
    buffer_load_dwordx4 v5, s[28:31], s101 offen offset:0  lds
    s_add_u32 m0, s67, 69632
    s_add_u32 s101, s87, 4096
    buffer_load_dwordx4 v7, s[32:35], s101 offen offset:0  lds
    s_add_u32 m0, s67, 53248
    s_nop 0
    buffer_load_dwordx4 v7, s[32:35], s87 offen offset:0  lds
    s_add_u32 s86, s86, 128
    s_add_u32 s87, s87, 393216
    s_and_b32 s86, s86, 2047
    s_cselect_b32 s87, s87, 0
    s_mov_b32 s100, 21504
    buffer_load_dwordx4 v[108:111], v244, s[52:55], s100 offen nt
    s_mov_b32 s100, 28672
    buffer_load_dwordx4 v[80:83], v244, s[48:51], s100 offen nt
    s_mov_b32 s100, 28672
    buffer_load_dwordx4 v[112:115], v244, s[52:55], s100 offen nt
    s_mov_b32 s100, 35840
    buffer_load_dwordx4 v[84:87], v244, s[48:51], s100 offen nt
    s_mov_b32 s100, 35840
    buffer_load_dwordx4 v[116:119], v244, s[52:55], s100 offen nt
    s_mov_b32 s100, 43008
    buffer_load_dwordx4 v[88:91], v244, s[48:51], s100 offen nt
    s_mov_b32 s100, 43008
    buffer_load_dwordx4 v[120:123], v244, s[52:55], s100 offen nt
    s_waitcnt vmcnt(17)
    s_barrier
    s_cmp_lg_u32 s76, 0
    s_cbranch_scc1 Lpl_30
    s_mov_b32 exec_hi, 0xffff
    buffer_load_dwordx2 v[198:199], v196, s[36:39], 0 offen sc1
    s_mov_b64 exec, -1
Lpl_30:
    s_add_u32 m0, s64, 77824
    s_nop 0
    buffer_load_dwordx4 v4, s[28:31], s86 offen offset:0  lds
    s_add_u32 m0, s66, 100352
    s_nop 0
    s_nop 0
    buffer_load_dwordx4 v6, s[32:35], s87 offen offset:2048  lds
    s_add_u32 m0, s64, 79872
    s_add_u32 s101, s86, 32768
    buffer_load_dwordx4 v4, s[28:31], s101 offen offset:0  lds
    s_add_u32 m0, s66, 110592
    s_add_u32 s101, s87, 4096
    buffer_load_dwordx4 v6, s[32:35], s101 offen offset:0  lds
    s_add_u32 m0, s66, 94208
    s_nop 0
    buffer_load_dwordx4 v6, s[32:35], s87 offen offset:0  lds
    s_add_u32 m0, s65, 77824
    s_nop 0
    buffer_load_dwordx4 v5, s[28:31], s86 offen offset:0  lds
    s_add_u32 m0, s67, 100352
    s_nop 0
    s_nop 0
    buffer_load_dwordx4 v7, s[32:35], s87 offen offset:2048  lds
    s_add_u32 m0, s65, 79872
    s_add_u32 s101, s86, 32768
    buffer_load_dwordx4 v5, s[28:31], s101 offen offset:0  lds
    s_add_u32 m0, s67, 110592
    s_add_u32 s101, s87, 4096
    buffer_load_dwordx4 v7, s[32:35], s101 offen offset:0  lds
    s_add_u32 m0, s67, 94208
    s_nop 0
    buffer_load_dwordx4 v7, s[32:35], s87 offen offset:0  lds
    s_add_u32 s86, s86, 128
    s_add_u32 s87, s87, 393216
    s_and_b32 s86, s86, 2047
    s_cselect_b32 s87, s87, 0
    s_waitcnt vmcnt(17)
    s_barrier
    s_cmp_lg_u32 s76, 2
    s_cbranch_scc1 Lc4_31
    s_mov_b32 exec_hi, -1
    buffer_load_dword v238, v63, s[40:43], 0 offen
    s_mov_b64 exec, -1
Lc4_31:
    s_add_u32 m0, s64, 118784
    s_nop 0
    buffer_load_dwordx4 v4, s[28:31], s86 offen offset:0  lds
    s_add_u32 m0, s66, 141312
    s_nop 0
    buffer_load_dwordx4 v6, s[32:35], s87 offen offset:2048  lds
    s_add_u32 m0, s64, 120832
    s_add_u32 s101, s86, 32768
    buffer_load_dwordx4 v4, s[28:31], s101 offen offset:0  lds
    s_add_u32 m0, s66, 151552
    s_add_u32 s101, s87, 4096
    buffer_load_dwordx4 v6, s[32:35], s101 offen offset:0  lds
    s_add_u32 m0, s66, 135168
    s_nop 0
    buffer_load_dwordx4 v6, s[32:35], s87 offen offset:0  lds
    s_add_u32 m0, s65, 118784
    s_nop 0
    buffer_load_dwordx4 v5, s[28:31], s86 offen offset:0  lds
    s_add_u32 m0, s67, 141312
    s_nop 0
    s_nop 0
    buffer_load_dwordx4 v7, s[32:35], s87 offen offset:2048  lds
    s_add_u32 m0, s65, 120832
    s_add_u32 s101, s86, 32768
    buffer_load_dwordx4 v5, s[28:31], s101 offen offset:0  lds
    s_add_u32 m0, s67, 151552
    s_add_u32 s101, s87, 4096
    buffer_load_dwordx4 v7, s[32:35], s101 offen offset:0  lds
    s_add_u32 m0, s67, 135168
    s_nop 0
    buffer_load_dwordx4 v7, s[32:35], s87 offen offset:0  lds
    s_add_u32 s86, s86, 128
    s_add_u32 s87, s87, 393216
    s_and_b32 s86, s86, 2047
    s_cselect_b32 s87, s87, 0
    s_waitcnt vmcnt(10)
    s_cmp_lg_u32 s76, 0
    s_cbranch_scc1 Lpc_32
    s_mov_b32 exec_hi, 0xffff
    s_mov_b32 s85, 0
    s_branch Lpk_33
Lspin_34:
    s_add_u32 s85, s85, 1
    s_cmp_gt_u32 s85, 400000
    s_cbranch_scc1 L_end
    buffer_load_dwordx2 v[198:199], v196, s[36:39], 0 offen sc1
    s_waitcnt vmcnt(0)
Lpk_33:
    v_cmp_ne_u32 vcc, s75, v198
    s_cbranch_vccnz Lspin_34
    v_cmp_ne_u32 vcc, s99, v199
    s_mov_b64 exec, -1
    s_lshr_b32 s78, vcc_lo, 16
    s_cselect_b32 s78, 0, 1
    s_cmp_eq_u32 vcc_hi, 0
    s_cselect_b32 s79, 2, 0
    s_or_b32 s78, s78, s79
    s_and_b32 s78, s78, 3
    v_mov_b32_e64 v198, s78
    v_mov_b32 v199, 163584
    ds_write_b32 v199, v198
    s_waitcnt lgkmcnt(0)
Lpc_32:
    s_barrier
    v_lshrrev_b32 v196, 4, v2
    v_and_b32 v197, 15, v2
    v_lshlrev_b32_e64 v197, 4, v197
    v_lshl_add_u32 v198, v196, 10, v197
    s_lshl_b32 s78, s69, 14
    s_lshl_b32 s79, s76, 8
    s_add_u32 s78, s78, s79
    s_nop 0
    s_add_u32 s78, s78, 65536
    buffer_load_dwordx4 v[20:23], v198, s[36:39], s78 offen sc1
    s_add_u32 s78, s78, 4096
    buffer_load_dwordx4 v[24:27], v198, s[36:39], s78 offen sc1
    s_add_u32 s78, s78, 4096
    buffer_load_dwordx4 v[28:31], v198, s[36:39], s78 offen sc1
    s_add_u32 s78, s78, 4096
    buffer_load_dwordx4 v[32:35], v198, s[36:39], s78 offen sc1
    v_mul_u32_u24 v198, 768, v196
    v_add_u32_e64 v198, v198, v197
    s_mul_i32 s78, s70, 12288
    s_lshl_b32 s79, s76, 8
    s_add_u32 s78, s78, s79
    s_add_u32 s78, s78, 327680
    s_cmp_eq_u32 s76, 3
    s_nop 0
    s_cselect_b32 s78, 0x10000000, s78
    buffer_load_dwordx4 v[36:39], v198, s[36:39], s78 offen sc1
    s_add_u32 s78, s78, 3072
    buffer_load_dwordx4 v[40:43], v198, s[36:39], s78 offen sc1
    s_add_u32 s78, s78, 3072
    buffer_load_dwordx4 v[44:47], v198, s[36:39], s78 offen sc1
    s_add_u32 s78, s78, 3072
    buffer_load_dwordx4 v[48:51], v198, s[36:39], s78 offen sc1
    s_add_u32 m0, s84, 0
    s_mov_b32 s100, 0
    buffer_load_dwordx4 v246, s[40:43], s100 offen  lds
    s_add_u32 m0, s84, 4096
    s_mov_b32 s100, 65536
    buffer_load_dwordx4 v246, s[40:43], s100 offen  lds
    s_add_u32 m0, s84, 8192
    s_mov_b32 s100, 131072
    buffer_load_dwordx4 v246, s[40:43], s100 offen  lds
    s_add_u32 m0, s84, 12288
    s_mov_b32 s100, 196608
    buffer_load_dwordx4 v246, s[40:43], s100 offen  lds
    s_waitcnt vmcnt(12)
    s_waitcnt lgkmcnt(0)
    s_barrier
    s_setprio 2
    s_add_u32 m0, s84, 16384
    s_mov_b32 s100, 262144
    buffer_load_dwordx4 v246, s[40:43], s100 offen  lds
    s_waitcnt vmcnt(9)
    v_add_f32 v20, v20, v24
    v_add_f32 v21, v21, v25
    v_add_f32 v22, v22, v26
    v_add_f32 v23, v23, v27
    v_add_f32 v20, v20, v28
    v_add_f32_e64 v21, v21, v29
    s_add_u32 m0, s84, 20480
    s_mov_b32 s100, 327680
    buffer_load_dwordx4 v246, s[40:43], s100 offen  lds
    v_add_f32 v22, v22, v30
    v_add_f32 v23, v23, v31
    v_add_f32 v20, v20, v32
    v_add_f32 v21, v21, v33
    v_add_f32 v22, v22, v34
    v_add_f32 v23, v23, v35
    s_nop 0
    v_permlane32_swap_b32 v20, v22
    s_add_u32 m0, s84, 24576
    s_mov_b32 s100, 393216
    buffer_load_dwordx4 v246, s[40:43], s100 offen  lds
    v_permlane32_swap_b32 v21, v23
    v_add_f32 v20, v20, v22
    v_add_f32 v21, v21, v23
    v_mov_b32 v22, v20
    v_mov_b32 v23, v21
    s_nop 0
    v_permlane16_swap_b32 v20, v22
    v_permlane16_swap_b32 v21, v23
    v_add_f32_e64 v20, v20, v22
    s_add_u32 m0, s84, 28672
    s_mov_b32 s100, 458752
    buffer_load_dwordx4 v246, s[40:43], s100 offen  lds
    v_add_f32_e64 v21, v21, v23
    v_mul_f32 v24, 0x3a800000, v20
    v_mul_f32 v26, 0x3a800000, v21
    v_fma_f32 v26, -v24, v24, v26
    v_max_f32_e64 v26, 0, v26
    v_cvt_pk_bf16_f32 v24, v24, v24
    v_and_b32 v24, 0xffff0000, v24
    s_add_u32 m0, s84, 32768
    s_mov_b32 s100, 524288
    buffer_load_dwordx4 v246, s[40:43], s100 offen  lds
    v_cvt_pk_bf16_f32 v26, v26, v26
    v_and_b32 v26, 0xffff0000, v26
    v_add_f32 v26, 0x3727c5ac, v26
    v_cvt_pk_bf16_f32 v26, v26, v26
    v_and_b32 v26, 0xffff0000, v26
    v_sqrt_f32 v26, v26
    s_nop 0
    v_cvt_pk_bf16_f32 v26, v26, v26
    v_and_b32 v26, 0xffff0000, v26
    s_add_u32 m0, s84, 36864
    s_mov_b32 s100, 589824
    buffer_load_dwordx4 v246, s[40:43], s100 offen  lds
    v_rcp_f32_e64 v25, v26
    v_xor_b32 v26, 0x80000000, v24
    v_lshrrev_b32 v27, 16, v26
    v_or_b32 v26, v26, v27
    v_mov_b32 v27, 0
    v_and_b32 v196, 15, v2
    v_lshrrev_b32_e64 v197, 5, v2
    s_add_u32 m0, s84, 40960
    s_mov_b32 s100, 655360
    buffer_load_dwordx4 v246, s[40:43], s100 offen  lds
    v_lshl_add_u32 v196, v196, 1, v197
    s_lshl_b32 s78, s76, 5
    v_add_u32 v196, s78, v196
    v_lshlrev_b32_e64 v197, 3, v196
    v_add_u32 v197, 159744, v197
    v_lshlrev_b32_e64 v196, 2, v196
    v_add_u32 v196, 162304, v196
    s_add_u32 m0, s84, 45056
    s_mov_b32 s100, 720896
    buffer_load_dwordx4 v246, s[40:43], s100 offen  lds
    ds_write_b64 v197, v[26:27]
    ds_write_b32 v196, v25
    s_waitcnt vmcnt(12)
    v_add_f32 v36, v36, v40
    v_add_f32 v37, v37, v41
    v_add_f32 v38, v38, v42
    v_add_f32 v39, v39, v43
    v_add_f32 v36, v36, v44
    s_add_u32 m0, s84, 49152
    s_mov_b32 s100, 786432
    buffer_load_dwordx4 v246, s[40:43], s100 offen  lds
    v_add_f32 v37, v37, v45
    v_add_f32 v38, v38, v46
    v_add_f32 v39, v39, v47
    v_add_f32 v36, v36, v48
    v_add_f32 v37, v37, v49
    v_add_f32 v38, v38, v50
    v_add_f32_e64 v39, v39, v51
    s_add_u32 m0, s84, 53248
    s_mov_b32 s100, 851968
    buffer_load_dwordx4 v246, s[40:43], s100 offen  lds
    v_permlane32_swap_b32 v36, v38
    v_permlane32_swap_b32 v37, v39
    v_add_f32 v36, v36, v38
    v_add_f32 v37, v37, v39
    s_nop 1
    v_permlane16_swap_b32 v36, v37
    v_add_f32_e64 v36, v36, v37
    v_cvt_pk_bf16_f32 v37, v36, v36
    v_and_b32 v37, 0xffff0000, v37
    s_add_u32 m0, s84, 57344
    s_mov_b32 s100, 917504
    buffer_load_dwordx4 v246, s[40:43], s100 offen  lds
    v_sub_f32_e64 v38, v36, v37
    v_cvt_pk_bf16_f32 v38, v37, v38
    v_mov_b32 v39, 0
    v_and_b32 v196, 15, v2
    v_lshrrev_b32_e64 v197, 4, v2
    v_lshl_add_u32 v196, v196, 2, v197
    s_lshl_b32 s78, s76, 9
    s_add_u32 m0, s84, 61440
    s_mov_b32 s100, 983040
    buffer_load_dwordx4 v246, s[40:43], s100 offen  lds
    s_add_u32 s78, s78, 160768
    v_lshl_add_u32 v196, v196, 3, s78
    v_and_b32 v197, 15, v2
    v_lshlrev_b32_e64 v197, 3, v197
    v_add_u32 v197, 162816, v197
    v_mov_b32 v198, 0x3f803f80
    s_cmp_eq_u32 s76, 3
    s_cselect_b64 vcc, -1, 0
    v_cndmask_b32 v196, v196, v197, vcc
    v_cndmask_b32 v38, v38, v198, vcc
    v_cndmask_b32_e64 v39, v39, v198, vcc
    ds_write_b64 v196, v[38:39]
    s_setprio 0
    s_waitcnt lgkmcnt(0)
    s_barrier
L_phend:
    s_mov_b32 s66, s96
    s_add_u32 m0, s84, 65536
    s_mov_b32 s100, 1048576
    buffer_load_dwordx4 v246, s[40:43], s100 offen  lds
    v_lshrrev_b32 v52, 2, v2
    v_and_b32 v53, 7, v52
    v_and_b32_e64 v55, 3, v2
    s_add_u32 m0, s84, 69632
    s_mov_b32 s100, 1114112
    buffer_load_dwordx4 v246, s[40:43], s100 offen  lds
    v_xor_b32 v53, v53, v55
    v_lshlrev_b32 v52, 7, v52
    v_lshrrev_b32_e64 v55, 1, v55
    s_add_u32 m0, s84, 73728
    s_mov_b32 s100, 1179648
    buffer_load_dwordx4 v246, s[40:43], s100 offen  lds
    v_lshl_add_u32 v52, v55, 3, v52
    s_lshr_b32 s78, s76, 1
    s_and_b32 s79, s76, 1
    s_lshl_b32 s80, s79, 2
    s_add_u32 m0, s84, 77824
    s_mov_b32 s100, 1245184
    buffer_load_dwordx4 v246, s[40:43], s100 offen  lds
    s_lshl_b32 s81, s78, 2
    v_xor_b32 v55, s80, v53
    v_xor_b32 v53, s81, v53
    s_add_u32 m0, s84, 81920
    s_mov_b32 s100, 1310720
    buffer_load_dwordx4 v246, s[40:43], s100 offen  lds
    s_lshl_b32 s80, s78, 14
    s_add_u32 s80, s80, 110592
    v_lshl_add_u32 v196, v55, 4, v52
    v_add_u32 v196, s80, v196
    s_add_u32 m0, s84, 86016
    s_mov_b32 s100, 1376256
    buffer_load_dwordx4 v246, s[40:43], s100 offen  lds
    v_lshl_add_u32 v198, v53, 4, v52
    v_add_u32 v198, 143360, v198
    v_xor_b32_e64 v197, 8, v196
    s_add_u32 m0, s84, 90112
    s_mov_b32 s100, 1441792
    buffer_load_dwordx4 v246, s[40:43], s100 offen  lds
    v_xor_b32_e64 v199, 8, v198
    v_mov_b32 v200, 0x3f803f80
    v_mov_b32 v201, 0x3f803f80
    v_mov_b32 v202, 0x3f803f80
    s_add_u32 m0, s84, 94208
    s_mov_b32 s100, 1507328
    buffer_load_dwordx4 v246, s[40:43], s100 offen  lds
    v_mov_b32 v203, 0x3f803f80
    v_lshrrev_b32 v62, 4, v2
    v_and_b32 v52, 15, v2
    s_add_u32 m0, s84, 98304
    s_mov_b32 s100, 1572864
    buffer_load_dwordx4 v246, s[40:43], s100 offen  lds
    v_lshlrev_b32_e64 v53, 4, v52
    v_lshl_add_u32 v62, v62, 13, v53
    v_lshrrev_b32_e64 v52, 3, v52
    v_lshl_add_u32 v62, v52, 8, v62
    s_add_u32 m0, s84, 102400
    s_mov_b32 s100, 1638400
    buffer_load_dwordx4 v246, s[40:43], s100 offen  lds
    v_xor_b32 v63, 256, v62
    s_lshl_b32 s78, s70, 2
    s_add_u32 s78, s78, s76
    s_add_u32 m0, s84, 106496
    s_mov_b32 s100, 1703936
    buffer_load_dwordx4 v246, s[40:43], s100 offen  lds
    s_lshl_b32 s78, s78, 15
    s_lshl_b32 s79, s69, 9
    s_add_u32 s78, s78, s79
    s_add_u32 s78, s78, 2097152
    s_mov_b32 s100, 2031616
    buffer_load_dwordx4 v[160:163], v246, s[40:43], s100 offen
    s_lshl_b32 s79, s77, 10
    s_lshl_b32 s80, s76, 6
    s_add_u32 s79, s79, s80
    s_mov_b32 s100, 1966080
    buffer_load_dwordx4 v[164:167], v246, s[40:43], s100 offen
    s_add_u32 s79, s79, 8389120
    v_lshrrev_b32 v52, 3, v2
    v_and_b32 v53, 7, v2
    v_lshlrev_b32_e64 v53, 4, v53
    s_mov_b32 s100, 1900544
    buffer_load_dwordx4 v[168:171], v246, s[40:43], s100 offen
    v_lshl_add_u32 v56, v52, 9, v53
    v_lshl_add_u32 v57, v52, 1, v53
    s_lshl_b32 s82, s70, 14
    s_mov_b32 s100, 1835008
    buffer_load_dwordx4 v[172:175], v246, s[40:43], s100 offen
    s_add_u32 s82, s82, s80
    s_add_u32 s82, s82, 8389120
    s_add_u32 s80, s80, 162944
    v_lshrrev_b32_e64 v58, 2, v2
    s_mov_b32 s100, 1769472
    buffer_load_dwordx4 v[176:179], v246, s[40:43], s100 offen
    v_and_b32 v53, 3, v2
    v_lshlrev_b32 v53, 4, v53
    v_lshl_add_u32 v58, v58, 10, v53
    s_mov_b32 s100, 0
    buffer_load_dwordx4 v[180:183], v247, s[28:31], s100 offen
    v_lshl_add_u32 v59, v52, 1, v53
    v_add_u32 v59, s80, v59
    s_lshl_b32 s64, s77, 13
    s_lshl_b32 s80, s76, 7
    s_mov_b32 s100, 16384
    buffer_load_dwordx4 v[184:187], v248, s[28:31], s100 offen
    s_add_u32 s64, s64, s80
    s_add_u32 s64, s64, 2097152
    s_add_u32 s65, s64, 4096
    s_mov_b32 s100, 32768
    buffer_load_dwordx4 v[188:191], v247, s[28:31], s100 offen
    s_lshl_b32 s81, s77, 10
    s_add_u32 s81, s81, s80
    s_add_u32 s81, s81, 8388608
    s_lshl_b32 s80, s71, 9
    s_mov_b32 s100, 49152
    buffer_load_dwordx4 v[192:195], v248, s[28:31], s100 offen
    s_add_u32 s80, s80, 8912896
    v_lshl_add_u32 v61, v2, 13, s80
    v_mov_b32 v52, 163584
    s_lshl_b32 s100, s77, 13
    s_add_u32 s100, s100, s89
    s_add_u32 s100, s100, 2097152
    buffer_load_dwordx4 v[252:255], v14, s[36:39], s100 offen offset:0 sc1
    ds_read_b32 v52, v52
    s_waitcnt lgkmcnt(0)
    v_readfirstlane_b32 s99, v52
    s_and_b32 s94, s69, 1
    s_lshl_b32 s100, s77, 13
    s_add_u32 s100, s100, s89
    s_nop 0
    s_add_u32 s100, s100, 2097152
    buffer_load_dwordx4 v[252:255], v14, s[36:39], s100 offen offset:1024 sc1
    s_mul_i32 s94, s94, 0x00010001
    s_mov_b32 s95, 0xfffefffe
    s_and_b32 s96, s75, 0x00010001
    buffer_load_dwordx4 v[252:255], v14, s[36:39], s66 offen sc1
    v_mov_b32_e64 v54, s96
    s_and_b32 s83, s75, 1
    s_lshl_b32 s83, s83, 16
    s_sub_u32 s83, 0, s83
    s_barrier
    ds_read_b64_tr_b16 v[4:5], v196 offset:0
    ds_read_b64_tr_b16 v[6:7], v196 offset:2048
    ds_read_b64_tr_b16 v[12:13], v198 offset:0
    ds_read_b64_tr_b16 v[14:15], v198 offset:2048
    ds_read_b64_tr_b16 v[8:9], v197 offset:0
    ds_read_b64_tr_b16 v[10:11], v197 offset:2048
    ds_read_b64_tr_b16 v[16:17], v199 offset:0
    ds_read_b64_tr_b16 v[18:19], v199 offset:2048
    ds_read_b64_tr_b16 v[20:21], v196 offset:4096
    ds_read_b64_tr_b16 v[22:23], v196 offset:6144
    ds_read_b64_tr_b16 v[28:29], v198 offset:4096
    ds_read_b64_tr_b16 v[30:31], v198 offset:6144
    ds_read_b64_tr_b16 v[24:25], v197 offset:4096
    ds_read_b64_tr_b16 v[26:27], v197 offset:6144
    s_waitcnt lgkmcnt(10)
    v_mfma_f32_16x16x32_bf16 v[204:207], v[4:7], v[12:15], 0
    ds_read_b64_tr_b16 v[32:33], v199 offset:4096
    ds_read_b64_tr_b16 v[34:35], v199 offset:6144
    s_waitcnt lgkmcnt(10)
    v_mfma_f32_16x16x32_bf16 v[208:211], v[8:11], v[12:15], 0
    ds_read_b64_tr_b16 v[36:37], v196 offset:8192
    ds_read_b64_tr_b16 v[38:39], v196 offset:10240
    s_waitcnt lgkmcnt(10)
    s_nop 0
    v_mfma_f32_16x16x32_bf16 v[216:219], v[8:11], v[16:19], 0
    ds_read_b64_tr_b16 v[44:45], v198 offset:8192
    ds_read_b64_tr_b16 v[46:47], v198 offset:10240
    v_mfma_f32_16x16x32_bf16 v[212:215], v[4:7], v[16:19], 0
    ds_read_b64_tr_b16 v[40:41], v197 offset:8192
    ds_read_b64_tr_b16 v[42:43], v197 offset:10240
    s_waitcnt lgkmcnt(10)
    v_mfma_f32_16x16x32_bf16 v[204:207], v[20:23], v[28:31], v[204:207]
    ds_read_b64_tr_b16 v[48:49], v199 offset:8192
    ds_read_b64_tr_b16 v[50:51], v199 offset:10240
    s_waitcnt lgkmcnt(10)
    v_mfma_f32_16x16x32_bf16 v[208:211], v[24:27], v[28:31], v[208:211]
    ds_read_b64_tr_b16 v[228:229], v196 offset:12288
    ds_read_b64_tr_b16 v[230:231], v196 offset:14336
    s_waitcnt lgkmcnt(10)
    s_nop 0
    v_mfma_f32_16x16x32_bf16 v[216:219], v[24:27], v[32:35], v[216:219]
    ds_read_b64_tr_b16 v[236:237], v198 offset:12288
    ds_read_b64_tr_b16 v[238:239], v198 offset:14336
    v_mfma_f32_16x16x32_bf16 v[212:215], v[20:23], v[32:35], v[212:215]
    ds_read_b64_tr_b16 v[232:233], v197 offset:12288
    ds_read_b64_tr_b16 v[234:235], v197 offset:14336
    s_waitcnt lgkmcnt(10)
    v_mfma_f32_16x16x32_bf16 v[204:207], v[36:39], v[44:47], v[204:207]
    ds_read_b64_tr_b16 v[240:241], v199 offset:12288
    ds_read_b64_tr_b16 v[242:243], v199 offset:14336
    s_waitcnt lgkmcnt(10)
    v_mfma_f32_16x16x32_bf16 v[208:211], v[40:43], v[44:47], v[208:211]
    s_waitcnt lgkmcnt(8)
    v_mfma_f32_16x16x32_bf16 v[216:219], v[40:43], v[48:51], v[216:219]
    v_mfma_f32_16x16x32_bf16 v[212:215], v[36:39], v[48:51], v[212:215]
    s_waitcnt lgkmcnt(4)
    v_mfma_f32_16x16x32_bf16 v[204:207], v[228:231], v[236:239], v[204:207]
    s_waitcnt lgkmcnt(2)
    v_mfma_f32_16x16x32_bf16 v[208:211], v[232:235], v[236:239], v[208:211]
    s_waitcnt lgkmcnt(0)
    v_mfma_f32_16x16x32_bf16 v[216:219], v[232:235], v[240:243], v[216:219]
    v_mfma_f32_16x16x32_bf16 v[212:215], v[228:231], v[240:243], v[212:215]
    v_mfma_f32_16x16x32_bf16 v[220:223], v[4:7], v[200:203], 0
    v_mfma_f32_16x16x32_bf16 v[224:227], v[8:11], v[200:203], 0
    v_mfma_f32_16x16x32_bf16 v[220:223], v[20:23], v[200:203], v[220:223]
    v_mfma_f32_16x16x32_bf16 v[224:227], v[24:27], v[200:203], v[224:227]
    v_cvt_pk_bf16_f32 v12, v204, v205
    v_cvt_pk_bf16_f32 v13, v206, v207
    v_cvt_pk_bf16_f32 v14, v208, v209
    v_cvt_pk_bf16_f32 v15, v210, v211
    v_mfma_f32_16x16x32_bf16 v[220:223], v[36:39], v[200:203], v[220:223]
    v_add_u32_e64 v12, s94, v12
    v_and_or_b32 v12, v12, s95, v54
    v_mfma_f32_16x16x32_bf16 v[224:227], v[40:43], v[200:203], v[224:227]
    v_add_u32_e64 v13, s94, v13
    v_and_or_b32 v13, v13, s95, v54
    v_mfma_f32_16x16x32_bf16 v[220:223], v[228:231], v[200:203], v[220:223]
    v_add_u32_e64 v14, s94, v14
    v_and_or_b32 v14, v14, s95, v54
    v_mfma_f32_16x16x32_bf16 v[224:227], v[232:235], v[200:203], v[224:227]
    v_add_u32_e64 v15, s94, v15
    v_and_or_b32 v15, v15, s95, v54
    s_bitcmp1_b32 s99, 0
    s_cbranch_scc1 Lls_35
    buffer_store_dwordx4 v[12:15], v62, s[36:39], s78 offen sc1
    s_branch Lle_36
Lls_35:
    buffer_store_dwordx4 v[12:15], v62, s[36:39], s78 offen
Lle_36:
    v_cvt_pk_bf16_f32 v28, v212, v213
    v_cvt_pk_bf16_f32 v29, v214, v215
    v_cvt_pk_bf16_f32 v30, v216, v217
    v_cvt_pk_bf16_f32 v31, v218, v219
    v_add_u32 v28, s94, v28
    v_and_or_b32 v28, v28, s95, v54
    v_add_u32_e64 v29, s94, v29
    v_and_or_b32 v29, v29, s95, v54
    v_add_u32_e64 v30, s94, v30
    v_and_or_b32 v30, v30, s95, v54
    v_add_u32_e64 v31, s94, v31
    v_and_or_b32 v31, v31, s95, v54
    s_bitcmp1_b32 s99, 0
    s_cbranch_scc1 Lls_37
    buffer_store_dwordx4 v[28:31], v63, s[36:39], s78 offen sc1
    s_branch Lle_38
Lls_37:
    s_nop 0
    buffer_store_dwordx4 v[28:31], v63, s[36:39], s78 offen
Lle_38:
    v_cvt_pk_bf16_f32 v44, v220, v221
    v_cvt_pk_bf16_f32 v45, v222, v223
    v_cvt_pk_bf16_f32 v46, v224, v225
    v_cvt_pk_bf16_f32 v47, v226, v227
    s_mov_b32 exec_lo, 0x00010001
    s_mov_b32 exec_hi, 0x00010001
    s_bitcmp1_b32 s99, 0
    s_cbranch_scc1 Lls_39
    buffer_store_dwordx4 v[44:47], v2, s[36:39], s79 offen sc1
    s_branch Lle_40
Lls_39:
    buffer_store_dwordx4 v[44:47], v2, s[36:39], s79 offen
Lle_40:
    s_mov_b64 exec, -1
    s_sleep 3
    s_mov_b32 s85, 0
Lspin_41:
    s_add_u32 s85, s85, 1
    s_cmp_gt_u32 s85, 400000
    s_cbranch_scc1 L_end
    buffer_load_dwordx4 v[20:23], v56, s[36:39], s64 offen sc1
    buffer_load_dwordx4 v[24:27], v56, s[36:39], s65 offen sc1
    buffer_load_dwordx4 v[16:19], v58, s[36:39], s82 offen sc1
    s_waitcnt vmcnt(0)
Lchk_42:
    s_nop 0
    v_bitop3_b32 v28, v20, v24, v54 bitop3:0x7e
    v_bitop3_b32 v29, v21, v25, v54 bitop3:0x7e
    v_bitop3_b32 v30, v22, v26, v54 bitop3:0x7e
    v_bitop3_b32 v31, v23, v27, v54 bitop3:0x7e
    v_or3_b32 v28, v28, v29, v30
    v_cmp_eq_u32 s[90:91], -1, v16
    v_or_b32_e64 v28, v28, v31
    v_and_b32 v28, 0x00010001, v28
    v_cmp_ne_u32_e64 vcc, 0, v28
    s_or_b64 vcc, vcc, s[90:91]
    s_cbranch_vccnz Lspin_41
    v_lshl_add_u32 v28, v20, 16, s83
    v_and_b32 v29, 0xfffe0000, v20
    v_lshl_add_u32 v36, v24, 16, s83
    v_and_b32 v37, 0xfffe0000, v24
    v_pk_add_f32 v[28:29], v[28:29], v[36:37]
    v_lshl_add_u32 v30, v21, 16, s83
    v_and_b32 v31, 0xfffe0000, v21
    v_lshl_add_u32 v38, v25, 16, s83
    v_and_b32 v39, 0xfffe0000, v25
    v_pk_add_f32 v[30:31], v[30:31], v[38:39]
    v_lshl_add_u32 v32, v22, 16, s83
    v_and_b32 v33, 0xfffe0000, v22
    v_lshl_add_u32 v40, v26, 16, s83
    v_and_b32 v41, 0xfffe0000, v26
    v_pk_add_f32 v[32:33], v[32:33], v[40:41]
    v_lshl_add_u32 v34, v23, 16, s83
    v_and_b32 v35, 0xfffe0000, v23
    v_lshl_add_u32 v42, v27, 16, s83
    v_and_b32 v43, 0xfffe0000, v27
    v_pk_add_f32 v[34:35], v[34:35], v[42:43]
    v_permlane32_swap_b32 v28, v32
    v_permlane32_swap_b32 v29, v33
    v_permlane32_swap_b32 v30, v34
    v_permlane32_swap_b32 v31, v35
    v_pk_add_f32 v[28:29], v[28:29], v[32:33]
    v_pk_add_f32 v[30:31], v[30:31], v[34:35]
    s_nop 1
    v_permlane16_swap_b32 v28, v30
    v_permlane16_swap_b32_e64 v29, v31
    v_pk_add_f32 v[28:29], v[28:29], v[30:31]
    s_nop 1
    v_add_f32_dpp v28, v28, v28 row_ror:8 row_mask:0xf bank_mask:0xf
    v_add_f32_dpp v29, v29, v29 row_ror:8 row_mask:0xf bank_mask:0xf
    v_cvt_pk_bf16_f32 v36, v28, v29
    s_mov_b32 exec_lo, 0x00ff00ff
    s_mov_b32 exec_hi, 0x00ff00ff
    s_bitcmp1_b32 s99, 0
    s_cbranch_scc1 Lls_43
    buffer_store_dword v36, v57, s[36:39], s81 offen sc1
    s_branch Lle_44
Lls_43:
    buffer_store_dword v36, v57, s[36:39], s81 offen
Lle_44:
    s_mov_b64 exec, -1
    v_lshlrev_b32 v28, 16, v16
    v_and_b32 v29, 0xffff0000, v16
    v_lshlrev_b32_e64 v30, 16, v17
    v_and_b32 v31, 0xffff0000, v17
    v_lshlrev_b32_e64 v32, 16, v18
    v_and_b32 v33, 0xffff0000, v18
    v_lshlrev_b32_e64 v34, 16, v19
    v_and_b32 v35, 0xffff0000, v19
    v_permlane32_swap_b32 v28, v32
    v_permlane32_swap_b32 v29, v33
    v_permlane32_swap_b32 v30, v34
    v_permlane32_swap_b32 v31, v35
    v_pk_add_f32 v[28:29], v[28:29], v[32:33]
    v_pk_add_f32 v[30:31], v[30:31], v[34:35]
    s_nop 1
    v_permlane16_swap_b32 v28, v30
    v_permlane16_swap_b32_e64 v29, v31
    v_pk_add_f32 v[28:29], v[28:29], v[30:31]
    s_nop 1
    v_add_f32_dpp v38, v28, v28 row_ror:8 row_mask:0xf bank_mask:0x3
    s_nop 1
    v_add_f32_dpp v38, v29, v29 row_ror:8 row_mask:0xf bank_mask:0xc
    s_nop 1
    v_add_f32_dpp v37, v38, v38 row_shr:4 row_mask:0xf bank_mask:0xf
    v_cvt_pk_bf16_f32 v37, v37, v37
    s_mov_b32 exec_lo, 0xf0f0f0f0
    s_mov_b32 exec_hi, 0xf0f0f0f0
    ds_write_b16 v59, v37
    s_mov_b64 exec, -1
    s_waitcnt lgkmcnt(0)
    s_barrier
    s_sleep 4
    v_lshlrev_b32_e64 v4, 4, v2
    s_lshl_b32 s78, s76, 10
    s_add_u32 s78, s78, 110592
    v_add_u32 v5, s78, v4
    s_lshl_b32 s78, s76, 12
    s_add_u32 s78, s78, 131072
    v_add_u32_e64 v6, s78, v4
    ds_write_b128 v5, v[160:163] offset:16384
    ds_write_b128 v5, v[164:167] offset:12288
    ds_write_b128 v5, v[168:171] offset:8192
    ds_write_b128 v5, v[172:175] offset:4096
    ds_write_b128 v5, v[176:179] offset:0
    ds_write_b128 v6, v[180:183] offset:0
    ds_write_b128 v6, v[184:187] offset:1024
    ds_write_b128 v6, v[188:191] offset:2048
    ds_write_b128 v6, v[192:195] offset:3072
    s_waitcnt lgkmcnt(0)
    s_barrier
    s_mov_b32 s100, 50176
    buffer_load_dwordx4 v[92:95], v244, s[48:51], s100 offen nt
    s_mov_b32 s100, 50176
    buffer_load_dwordx4 v[124:127], v244, s[52:55], s100 offen nt
    s_mov_b32 s100, 0
    buffer_load_dwordx4 v[128:131], v245, s[56:59], s100 offen nt
    s_mov_b32 s100, 2048
    buffer_load_dwordx4 v[132:135], v245, s[56:59], s100 offen nt
    s_lshl_b32 s100, s77, 9
    s_add_u32 s100, s100, 8912896
    v_mov_b32 v48, s75
    v_mov_b32 v49, s75
    v_lshl_add_u32 v50, v2, 3, s100
    s_barrier
    s_cmp_lg_u32 s76, 0
    s_cbranch_scc1 Lfs_45
    buffer_store_dwordx2 v[48:49], v50, s[36:39], 0 offen sc1
Lfs_45:
    s_lshl_b32 s83, s71, 4
    s_add_u32 s83, s83, s72
    s_lshl_b32 s78, s0, 11
    s_and_b32 s79, s76, 1
    s_lshl_b32 s79, s79, 10
    s_add_u32 s78, s78, s79
    s_add_u32 s78, s78, 655360
    s_mul_i32 s79, s74, 56
    s_add_u32 s79, s79, s73
    s_lshl_b32 s79, s79, 10
    s_add_u32 s79, s79, 1114112
    s_cmp_eq_u32 s76, 1
    s_cselect_b32 s78, s79, s78
    s_cmp_ge_u32 s73, 56
    s_cselect_b32 s78, 0x10000000, s78
    s_lshl_b32 s79, s83, 9
    s_add_u32 s79, s79, 524288
    s_cmp_eq_u32 s76, 0
    s_cselect_b32 s78, s79, s78
    s_cselect_b32 s79, 0, -1
    v_mov_b32 v56, -1
    v_mov_b32 v57, -1
    v_mov_b32 v58, -1
    v_mov_b32 v59, -1
    s_mov_b32 exec_hi, s79
    buffer_store_dwordx4 v[56:59], v4, s[36:39], s78 offen sc1
    s_mov_b32 exec_hi, -1
    s_lshl_b32 s79, s83, 11
    s_add_u32 s79, s79, s84
    s_add_u32 s79, s79, 1572864
    s_cmp_lt_u32 s76, 2
    s_cselect_b32 s94, s79, s78
    s_cmp_lg_u32 s76, 2
    s_cbranch_scc1 Lf2_46
    s_mov_b64 exec, 0xffff
    s_mov_b32 s85, 1
    s_mov_b32 s101, 0
    s_sleep 14
    s_branch Lb_48
Lspin_47:
    s_add_u32 s85, s85, 1
    s_cmp_gt_u32 s85, 400000
    s_cbranch_scc1 L_end
    s_add_u32 s101, s101, 128
    s_min_u32 s101, s101, 384
Lb_48:
    buffer_load_dword v52, v61, s[36:39], s101 offen sc1
    s_waitcnt vmcnt(0)
    v_cmp_ne_u32_e64 vcc, s75, v52
    s_cbranch_vccnz Lspin_47
    s_mov_b64 exec, -1
Lf2_46:
    s_barrier
    s_waitcnt vmcnt(0)
    s_mov_b32 s100, 0x05040100
    s_mov_b32 s101, 0x07060302
    v_perm_b32 v7, v68, v64, s100
    v_perm_b32 v68, v68, v64, s101
    v_mov_b32_e64 v64, v7
    v_perm_b32 v7, v69, v65, s100
    v_perm_b32 v69, v69, v65, s101
    v_mov_b32_e64 v65, v7
    v_perm_b32 v7, v70, v66, s100
    v_perm_b32 v70, v70, v66, s101
    v_mov_b32_e64 v66, v7
    v_perm_b32 v7, v71, v67, s100
    v_perm_b32 v71, v71, v67, s101
    v_mov_b32_e64 v67, v7
    v_perm_b32 v7, v100, v96, s100
    v_perm_b32 v100, v100, v96, s101
    v_mov_b32_e64 v96, v7
    v_perm_b32 v7, v101, v97, s100
    v_perm_b32 v101, v101, v97, s101
    v_mov_b32_e64 v97, v7
    v_perm_b32 v7, v102, v98, s100
    v_perm_b32 v102, v102, v98, s101
    v_mov_b32_e64 v98, v7
    v_perm_b32 v7, v103, v99, s100
    v_perm_b32 v103, v103, v99, s101
    v_mov_b32_e64 v99, v7
    v_perm_b32 v7, v76, v72, s100
    v_perm_b32 v76, v76, v72, s101
    v_mov_b32_e64 v72, v7
    v_perm_b32 v7, v77, v73, s100
    v_perm_b32 v77, v77, v73, s101
    v_mov_b32_e64 v73, v7
    v_perm_b32 v7, v78, v74, s100
    v_perm_b32 v78, v78, v74, s101
    v_mov_b32_e64 v74, v7
    v_perm_b32 v7, v79, v75, s100
    v_perm_b32 v79, v79, v75, s101
    v_mov_b32_e64 v75, v7
    v_perm_b32 v7, v108, v104, s100
    v_perm_b32 v108, v108, v104, s101
    v_mov_b32_e64 v104, v7
    v_perm_b32 v7, v109, v105, s100
    v_perm_b32 v109, v109, v105, s101
    v_mov_b32_e64 v105, v7
    v_perm_b32 v7, v110, v106, s100
    v_perm_b32 v110, v110, v106, s101
    v_mov_b32_e64 v106, v7
    v_perm_b32 v7, v111, v107, s100
    v_perm_b32 v111, v111, v107, s101
    v_mov_b32_e64 v107, v7
    v_perm_b32 v7, v84, v80, s100
    v_perm_b32 v84, v84, v80, s101
    v_mov_b32_e64 v80, v7
    v_perm_b32 v7, v85, v81, s100
    v_perm_b32 v85, v85, v81, s101
    v_mov_b32_e64 v81, v7
    v_perm_b32 v7, v86, v82, s100
    v_perm_b32 v86, v86, v82, s101
    v_mov_b32_e64 v82, v7
    v_perm_b32 v7, v87, v83, s100
    v_perm_b32 v87, v87, v83, s101
    v_mov_b32_e64 v83, v7
    v_perm_b32 v7, v116, v112, s100
    v_perm_b32 v116, v116, v112, s101
    v_mov_b32_e64 v112, v7
    v_perm_b32 v7, v117, v113, s100
    v_perm_b32 v117, v117, v113, s101
    v_mov_b32_e64 v113, v7
    v_perm_b32 v7, v118, v114, s100
    v_perm_b32 v118, v118, v114, s101
    v_mov_b32_e64 v114, v7
    v_perm_b32 v7, v119, v115, s100
    v_perm_b32 v119, v119, v115, s101
    v_mov_b32_e64 v115, v7
    v_perm_b32 v7, v92, v88, s100
    v_perm_b32 v92, v92, v88, s101
    v_mov_b32_e64 v88, v7
    v_perm_b32 v7, v93, v89, s100
    v_perm_b32 v93, v93, v89, s101
    v_mov_b32_e64 v89, v7
    v_perm_b32 v7, v94, v90, s100
    v_perm_b32 v94, v94, v90, s101
    v_mov_b32_e64 v90, v7
    v_perm_b32 v7, v95, v91, s100
    v_perm_b32 v95, v95, v91, s101
    v_mov_b32_e64 v91, v7
    v_perm_b32 v7, v124, v120, s100
    v_perm_b32 v124, v124, v120, s101
    v_mov_b32_e64 v120, v7
    v_perm_b32 v7, v125, v121, s100
    v_perm_b32 v125, v125, v121, s101
    v_mov_b32_e64 v121, v7
    v_perm_b32 v7, v126, v122, s100
    v_perm_b32 v126, v126, v122, s101
    v_mov_b32_e64 v122, v7
    v_perm_b32 v7, v127, v123, s100
    v_perm_b32 v127, v127, v123, s101
    v_mov_b32_e64 v123, v7
    v_perm_b32 v7, v132, v128, s100
    v_perm_b32 v132, v132, v128, s101
    v_mov_b32_e64 v128, v7
    v_perm_b32 v7, v133, v129, s100
    v_perm_b32 v133, v133, v129, s101
    v_mov_b32_e64 v129, v7
    v_perm_b32 v7, v134, v130, s100
    v_perm_b32 v134, v134, v130, s101
    v_mov_b32_e64 v130, v7
    v_perm_b32 v7, v135, v131, s100
    v_perm_b32 v135, v135, v131, s101
    v_mov_b32 v131, v7
    v_lshrrev_b32 v8, 3, v2
    v_and_b32 v9, 7, v2
    v_lshlrev_b32 v10, 4, v9
    v_lshl_add_u32 v11, v8, 13, v10
    v_and_b32 v12, 15, v2
    v_lshlrev_b32 v12, 13, v12
    v_lshl_add_u32 v13, v8, 9, v10
    v_lshl_add_u32 v14, v9, 3, v8
    s_lshl_b32 s80, s74, 2
    s_add_u32 s80, s80, s76
    s_lshl_b32 s78, s80, 9
    s_add_u32 s78, s78, 524288
    s_add_u32 s79, s78, 65536
    s_add_u32 s81, s73, s76
    s_and_b32 s81, s81, 3
    s_andn2_b32 s100, s73, 3
    s_or_b32 s81, s81, s100
    s_lshl_b32 s81, s81, 13
    s_lshl_b32 s80, s80, 9
    s_add_u32 s80, s80, s81
    s_add_u32 s80, s80, 655360
    s_lshl_b32 s81, s73, 13
    s_add_u32 s81, s81, 655360
    s_barrier
    buffer_load_dwordx4 v[56:59], v4, s[36:39], s94 offen sc1
    s_mov_b32 s100, 4096
    buffer_load_dwordx4 v[136:139], v245, s[56:59], s100 offen nt
    s_mov_b32 s100, 6144
    buffer_load_dwordx4 v[140:143], v245, s[56:59], s100 offen nt
    s_mov_b32 s100, 8192
    buffer_load_dwordx4 v[144:147], v245, s[56:59], s100 offen nt
    s_mov_b32 s100, 10240
    buffer_load_dwordx4 v[148:151], v245, s[56:59], s100 offen nt
    s_barrier
    s_waitcnt vmcnt(0)
    s_mov_b32 s100, 0x05040100
    s_mov_b32 s101, 0x07060302
    v_perm_b32 v7, v140, v136, s100
    v_perm_b32 v140, v140, v136, s101
    v_mov_b32_e64 v136, v7
    v_perm_b32 v7, v141, v137, s100
    v_perm_b32 v141, v141, v137, s101
    v_mov_b32_e64 v137, v7
    v_perm_b32 v7, v142, v138, s100
    v_perm_b32 v142, v142, v138, s101
    v_mov_b32_e64 v138, v7
    v_perm_b32 v7, v143, v139, s100
    v_perm_b32 v143, v143, v139, s101
    v_mov_b32_e64 v139, v7
    v_perm_b32 v7, v148, v144, s100
    v_perm_b32 v148, v148, v144, s101
    v_mov_b32_e64 v144, v7
    v_perm_b32 v7, v149, v145, s100
    v_perm_b32 v149, v149, v145, s101
    v_mov_b32_e64 v145, v7
    v_perm_b32 v7, v150, v146, s100
    v_perm_b32 v150, v150, v146, s101
    v_mov_b32_e64 v146, v7
    v_perm_b32 v7, v151, v147, s100
    v_perm_b32 v151, v151, v147, s101
    v_mov_b32 v147, v7
    s_barrier
    s_mov_b32 s100, 12288
    buffer_load_dwordx4 v[152:155], v245, s[56:59], s100 offen nt
    s_mov_b32 s100, 14336
    buffer_load_dwordx4 v[156:159], v245, s[56:59], s100 offen nt
    s_and_b32 s79, s2, 7
    s_lshl_b32 s79, s79, 9
    s_add_u32 s79, s79, 524288
    s_mov_b64 exec, 0xffff
    s_mov_b32 s85, 1
    s_sleep 16
    s_branch Lb_50
Lspin_49:
    s_add_u32 s85, s85, 1
    s_cmp_gt_u32 s85, 400000
    s_cbranch_scc1 L_end
    s_or_b32 s79, s79, 4096
Lb_50:
    buffer_load_dwordx2 v[24:25], v12, s[36:39], s79 offen offset:128 sc1
    s_waitcnt vmcnt(0)
    v_cmp_ne_u32 vcc, s75, v25
    s_cbranch_vccnz Lspin_49
    v_max_f32_dpp v24, v24, v24 row_ror:8 row_mask:0xf bank_mask:0xf
    s_nop 1
    v_max_f32_dpp v24, v24, v24 row_ror:4 row_mask:0xf bank_mask:0xf
    s_nop 1
    v_max_f32_dpp v24, v24, v24 row_ror:2 row_mask:0xf bank_mask:0xf
    s_nop 1
    v_max_f32_dpp v24, v24, v24 row_ror:1 row_mask:0xf bank_mask:0xf
    s_nop 0
    v_readfirstlane_b32 s97, v24
    s_mov_b64 exec, -1
    s_nop 0
    v_mov_b32 v24, s97
    s_cmp_ge_u32 s73, 56
    s_cbranch_scc1 L_red
    s_bfe_u32 s79, s97, 0x40007
    s_lshl_b32 s79, s79, 13
    s_add_u32 s78, s78, s79
    v_lshlrev_b32_e64 v25, 4, v8
    s_mov_b32 s85, 0
Lspin_51:
    s_add_u32 s85, s85, 1
    s_cmp_gt_u32 s85, 400000
    s_cbranch_scc1 L_end
    buffer_load_dwordx4 v[20:23], v25, s[36:39], s78 offen sc1
    v_mov_b32 v26, 163360
    ds_write_b32 v26, v24
    v_lshlrev_b32_e64 v15, 3, v14
    s_waitcnt vmcnt(0) lgkmcnt(0)
    v_max3_u32 v16, v20, v21, v22
    v_max_u32 v16, v16, v23
    v_cmp_eq_u32_e64 vcc, -1, v16
    s_cbranch_vccnz Lspin_51
    v_dot2_f32_bf16 v28, v64, v20, 0
    v_dot2_f32_bf16 v29, v68, v20, 0
    v_dot2_f32_bf16 v30, v65, v20, 0
    v_dot2_f32_bf16 v31, v69, v20, 0
    v_dot2_f32_bf16 v32, v66, v20, 0
    v_dot2_f32_bf16 v33, v70, v20, 0
    v_dot2_f32_bf16 v34, v67, v20, 0
    v_dot2_f32_bf16 v35, v71, v20, 0
    v_dot2_f32_bf16 v28, v72, v21, v28
    v_dot2_f32_bf16 v29, v76, v21, v29
    v_dot2_f32_bf16 v30, v73, v21, v30
    v_dot2_f32_bf16 v31, v77, v21, v31
    v_dot2_f32_bf16 v32, v74, v21, v32
    v_dot2_f32_bf16 v33, v78, v21, v33
    v_dot2_f32_bf16 v34, v75, v21, v34
    v_dot2_f32_bf16 v35, v79, v21, v35
    v_dot2_f32_bf16 v28, v80, v22, v28
    v_dot2_f32_bf16 v29, v84, v22, v29
    v_dot2_f32_bf16 v30, v81, v22, v30
    v_dot2_f32_bf16 v31, v85, v22, v31
    v_dot2_f32_bf16 v32, v82, v22, v32
    v_dot2_f32_bf16 v33, v86, v22, v33
    v_dot2_f32_bf16 v34, v83, v22, v34
    v_dot2_f32_bf16 v35, v87, v22, v35
    v_dot2_f32_bf16 v28, v88, v23, v28
    v_dot2_f32_bf16 v29, v92, v23, v29
    v_dot2_f32_bf16 v30, v89, v23, v30
    v_dot2_f32_bf16 v31, v93, v23, v31
    v_dot2_f32_bf16 v32, v90, v23, v32
    v_dot2_f32_bf16 v33, v94, v23, v33
    v_dot2_f32_bf16 v34, v91, v23, v34
    v_dot2_f32_bf16 v35, v95, v23, v35
    v_dot2_f32_bf16 v36, v96, v20, 0
    v_dot2_f32_bf16 v37, v100, v20, 0
    v_dot2_f32_bf16 v38, v97, v20, 0
    v_dot2_f32_bf16 v39, v101, v20, 0
    v_dot2_f32_bf16 v40, v98, v20, 0
    v_dot2_f32_bf16 v41, v102, v20, 0
    v_dot2_f32_bf16 v42, v99, v20, 0
    v_dot2_f32_bf16 v43, v103, v20, 0
    v_dot2_f32_bf16 v36, v104, v21, v36
    v_dot2_f32_bf16 v37, v108, v21, v37
    v_dot2_f32_bf16 v38, v105, v21, v38
    v_dot2_f32_bf16 v39, v109, v21, v39
    v_dot2_f32_bf16 v40, v106, v21, v40
    v_dot2_f32_bf16 v41, v110, v21, v41
    v_dot2_f32_bf16 v42, v107, v21, v42
    v_dot2_f32_bf16 v43, v111, v21, v43
    v_dot2_f32_bf16 v36, v112, v22, v36
    v_dot2_f32_bf16 v37, v116, v22, v37
    v_dot2_f32_bf16 v38, v113, v22, v38
    v_dot2_f32_bf16 v39, v117, v22, v39
    v_dot2_f32_bf16 v40, v114, v22, v40
    v_dot2_f32_bf16 v41, v118, v22, v41
    v_dot2_f32_bf16 v42, v115, v22, v42
    v_dot2_f32_bf16 v43, v119, v22, v43
    v_dot2_f32_bf16 v36, v120, v23, v36
    v_dot2_f32_bf16 v37, v124, v23, v37
    v_dot2_f32_bf16 v38, v121, v23, v38
    v_dot2_f32_bf16 v39, v125, v23, v39
    v_dot2_f32_bf16 v40, v122, v23, v40
    v_dot2_f32_bf16 v41, v126, v23, v41
    v_dot2_f32_bf16 v42, v123, v23, v42
    v_dot2_f32_bf16 v43, v127, v23, v43
    v_permlane32_swap_b32 v28, v32
    v_permlane32_swap_b32 v29, v33
    v_permlane32_swap_b32 v30, v34
    v_permlane32_swap_b32 v31, v35
    v_pk_add_f32 v[28:29], v[28:29], v[32:33]
    v_pk_add_f32 v[30:31], v[30:31], v[34:35]
    s_nop 1
    v_permlane16_swap_b32 v28, v30
    v_permlane16_swap_b32_e64 v29, v31
    v_pk_add_f32 v[28:29], v[28:29], v[30:31]
    s_nop 1
    v_add_f32_dpp v44, v28, v28 row_ror:8 row_mask:0xf bank_mask:0x3
    s_nop 1
    v_add_f32_dpp v44, v29, v29 row_ror:8 row_mask:0xf bank_mask:0xc
    v_permlane32_swap_b32 v36, v40
    v_permlane32_swap_b32 v37, v41
    v_permlane32_swap_b32 v38, v42
    v_permlane32_swap_b32 v39, v43
    v_pk_add_f32 v[36:37], v[36:37], v[40:41]
    v_pk_add_f32 v[38:39], v[38:39], v[42:43]
    s_nop 1
    v_permlane16_swap_b32 v36, v38
    v_permlane16_swap_b32_e64 v37, v39
    v_pk_add_f32 v[36:37], v[36:37], v[38:39]
    s_nop 1
    v_add_f32_dpp v45, v36, v36 row_ror:8 row_mask:0xf bank_mask:0x3
    s_nop 1
    v_add_f32_dpp v45, v37, v37 row_ror:8 row_mask:0xf bank_mask:0xc
    s_bitcmp1_b32 s99, 0
    s_cbranch_scc1 Lls_52
    buffer_store_dwordx2 v[44:45], v15, s[36:39], s80 offen sc1
    s_branch Lle_53
Lls_52:
    buffer_store_dwordx2 v[44:45], v15, s[36:39], s80 offen
Lle_53:
    s_mov_b32 s95, s80
    s_barrier
    s_lshl_b32 s78, s76, 7
    s_add_u32 s78, s78, s81
    s_add_u32 s79, s78, 4096
    v_lshrrev_b32 v26, 5, v2
    v_lshl_add_u32 v26, v9, 1, v26
    s_lshl_b32 s80, s76, 5
    s_add_u32 s80, s80, 163456
    v_lshl_add_u32 v26, v26, 1, s80
    v_lshlrev_b32 v27, 4, v8
    v_add_u32 v27, 163456, v27
    v_lshlrev_b32 v15, 2, v14
    s_mul_i32 s80, s74, 56
    s_add_u32 s80, s80, s73
    s_lshl_b32 s80, s80, 10
    s_lshl_b32 s82, s76, 8
    s_add_u32 s80, s80, s82
    s_add_u32 s80, s80, 1114112
    s_waitcnt vmcnt(0)
    s_mov_b32 s100, 0x05040100
    s_mov_b32 s101, 0x07060302
    v_perm_b32 v7, v156, v152, s100
    v_perm_b32 v156, v156, v152, s101
    v_mov_b32 v152, v7
    v_perm_b32 v7, v157, v153, s100
    v_perm_b32 v157, v157, v153, s101
    v_mov_b32_e64 v153, v7
    v_perm_b32 v7, v158, v154, s100
    v_perm_b32 v158, v158, v154, s101
    v_mov_b32_e64 v154, v7
    v_perm_b32 v7, v159, v155, s100
    v_perm_b32 v159, v159, v155, s101
    v_mov_b32_e64 v155, v7
    s_mov_b32 s85, 0
Lspin_54:
    s_add_u32 s85, s85, 1
    s_cmp_gt_u32 s85, 400000
    s_cbranch_scc1 L_end
    buffer_load_dwordx4 v[16:19], v13, s[36:39], s78 offen sc1
    buffer_load_dwordx4 v[20:23], v13, s[36:39], s79 offen sc1
    s_waitcnt vmcnt(0)
    v_max3_u32 v25, v16, v18, v20
    v_max_u32 v25, v25, v22
    v_cmp_eq_u32_e64 vcc, -1, v25
    s_cbranch_vccnz Lspin_54
    v_pk_add_f32 v[16:17], v[16:17], v[20:21]
    v_pk_add_f32 v[18:19], v[18:19], v[22:23]
    s_nop 1
    v_permlane32_swap_b32 v16, v18
    v_permlane32_swap_b32_e64 v17, v19
    v_pk_add_f32 v[16:17], v[16:17], v[18:19]
    v_mov_b32 v18, v16
    v_mov_b32 v19, v17
    s_nop 0
    v_permlane16_swap_b32 v16, v18
    v_permlane16_swap_b32_e64 v17, v19
    v_pk_add_f32 v[16:17], v[16:17], v[18:19]
    s_nop 1
    s_nop 0
    v_add_f32_dpp v16, v16, v16 row_ror:8 row_mask:0xf bank_mask:0xf
    v_add_f32_dpp v17, v17, v17 row_ror:8 row_mask:0xf bank_mask:0xf
    v_cvt_pk_bf16_f32 v16, v16, v16
    v_and_b32 v16, 0xffff0000, v16
    v_cvt_pk_bf16_f32 v17, v17, v17
    v_and_b32 v17, 0xffff0000, v17
    v_mul_f32 v18, 0xbfb8aa3b, v16
    v_exp_f32 v18, v18
    s_nop 0
    v_add_f32 v18, 1.0, v18
    v_rcp_f32 v18, v18
    s_nop 0
    v_mul_f32 v16, v16, v18
    v_cvt_pk_bf16_f32 v16, v16, v16
    v_and_b32 v16, 0xffff0000, v16
    v_mul_f32_e64 v16, v16, v17
    v_cvt_pk_bf16_f32 v16, v16, v16
    ds_write_b16 v26, v16
    s_waitcnt lgkmcnt(0)
    s_barrier
    ds_read_b128 v[20:23], v27
    s_waitcnt lgkmcnt(0)
    s_nop 0
    v_dot2_f32_bf16 v28, v128, v20, 0
    v_dot2_f32_bf16 v29, v132, v20, 0
    v_dot2_f32_bf16 v30, v129, v20, 0
    v_dot2_f32_bf16 v31, v133, v20, 0
    v_dot2_f32_bf16 v32, v130, v20, 0
    v_dot2_f32_bf16 v33, v134, v20, 0
    v_dot2_f32_bf16 v34, v131, v20, 0
    v_dot2_f32_bf16 v35, v135, v20, 0
    v_dot2_f32_bf16 v28, v136, v21, v28
    v_dot2_f32_bf16 v29, v140, v21, v29
    v_dot2_f32_bf16 v30, v137, v21, v30
    v_dot2_f32_bf16 v31, v141, v21, v31
    v_dot2_f32_bf16 v32, v138, v21, v32
    v_dot2_f32_bf16 v33, v142, v21, v33
    v_dot2_f32_bf16 v34, v139, v21, v34
    v_dot2_f32_bf16 v35, v143, v21, v35
    v_dot2_f32_bf16 v28, v144, v22, v28
    v_dot2_f32_bf16 v29, v148, v22, v29
    v_dot2_f32_bf16 v30, v145, v22, v30
    v_dot2_f32_bf16 v31, v149, v22, v31
    v_dot2_f32_bf16 v32, v146, v22, v32
    v_dot2_f32_bf16 v33, v150, v22, v33
    v_dot2_f32_bf16 v34, v147, v22, v34
    v_dot2_f32_bf16 v35, v151, v22, v35
    v_dot2_f32_bf16 v28, v152, v23, v28
    v_dot2_f32_bf16 v29, v156, v23, v29
    v_dot2_f32_bf16 v30, v153, v23, v30
    v_dot2_f32_bf16 v31, v157, v23, v31
    v_dot2_f32_bf16 v32, v154, v23, v32
    v_dot2_f32_bf16 v33, v158, v23, v33
    v_dot2_f32_bf16 v34, v155, v23, v34
    v_dot2_f32_bf16 v35, v159, v23, v35
    v_permlane32_swap_b32 v28, v32
    v_permlane32_swap_b32 v29, v33
    v_permlane32_swap_b32 v30, v34
    v_permlane32_swap_b32 v31, v35
    v_pk_add_f32 v[28:29], v[28:29], v[32:33]
    v_pk_add_f32 v[30:31], v[30:31], v[34:35]
    s_nop 1
    v_permlane16_swap_b32 v28, v30
    v_permlane16_swap_b32_e64 v29, v31
    v_pk_add_f32 v[28:29], v[28:29], v[30:31]
    s_nop 1
    v_add_f32_dpp v46, v28, v28 row_ror:8 row_mask:0xf bank_mask:0x3
    s_nop 1
    v_add_f32_dpp v46, v29, v29 row_ror:8 row_mask:0xf bank_mask:0xc
    buffer_store_dword v46, v15, s[36:39], s80 offen sc1
    s_barrier
    s_branch L_fin
L_red:
    v_mov_b32 v26, 163360
    ds_write_b32 v26, v24
    s_waitcnt lgkmcnt(0)
    s_barrier
    s_barrier
    s_barrier
    s_cmp_lg_u32 s76, 0
    s_cbranch_scc1 L_fin
    s_sub_u32 s83, s0, 224
    v_lshrrev_b32_e64 v14, 4, v2
    v_lshl_add_u32 v14, v9, 2, v14
    v_lshlrev_b32 v15, 2, v14
    v_lshlrev_b32 v14, 1, v14
    s_bfe_u32 s78, s97, 0x40007
    s_lshl_b32 s78, s78, 13
    s_lshr_b32 s79, s83, 1
    s_lshl_b32 s79, s79, 9
    s_add_u32 s78, s78, s79
    s_and_b32 s79, s83, 1
    s_lshl_b32 s79, s79, 7
    s_add_u32 s78, s78, s79
    s_add_u32 s78, s78, 524544
    s_mov_b32 s85, 0
Lspin_55:
    s_add_u32 s85, s85, 1
    s_cmp_gt_u32 s85, 400000
    s_cbranch_scc1 L_end
    buffer_load_dword v46, v15, s[36:39], s78 offen sc1
    s_waitcnt vmcnt(0)
    v_cmp_eq_u32_e64 vcc, -1, v46
    s_cbranch_vccnz Lspin_55
    v_cvt_pk_bf16_f32 v47, v24, v24
    v_and_b32 v47, 0xffff0000, v47
    v_mul_f32 v47, 0xbfb8aa3b, v47
    v_exp_f32 v47, v47
    s_nop 0
    v_add_f32 v47, 1.0, v47
    v_rcp_f32_e64 v47, v47
    s_nop 0
    v_cvt_pk_bf16_f32 v47, v47, v47
    v_and_b32 v47, 0xffff0000, v47
    v_lshl_add_u32 v13, v8, 10, v10
    s_lshr_b32 s78, s83, 3
    s_mul_i32 s78, s78, 57344
    s_and_b32 s79, s83, 7
    s_lshl_b32 s79, s79, 7
    s_add_u32 s78, s78, s79
    s_add_u32 s78, s78, 1114112
    s_and_b32 s80, s97, 0x7ff
    s_lshl_b32 s80, s80, 11
    s_lshl_b32 s79, s83, 6
    s_add_u32 s80, s80, s79
    s_sleep 28
    s_mov_b32 s85, 0
Lspin_56:
    s_add_u32 s85, s85, 1
    s_cmp_gt_u32 s85, 400000
    s_cbranch_scc1 L_end
    s_add_u32 s79, s78, 0
    buffer_load_dwordx4 v[16:19], v13, s[36:39], s79 offen sc1
    s_add_u32 s79, s78, 8192
    buffer_load_dwordx4 v[20:23], v13, s[36:39], s79 offen sc1
    s_add_u32 s79, s78, 16384
    buffer_load_dwordx4 v[24:27], v13, s[36:39], s79 offen sc1
    s_add_u32 s79, s78, 24576
    buffer_load_dwordx4 v[28:31], v13, s[36:39], s79 offen sc1
    s_add_u32 s79, s78, 32768
    buffer_load_dwordx4 v[32:35], v13, s[36:39], s79 offen sc1
    s_add_u32 s79, s78, 40960
    buffer_load_dwordx4 v[36:39], v13, s[36:39], s79 offen sc1
    s_add_u32 s79, s78, 49152
    buffer_load_dwordx4 v[40:43], v13, s[36:39], s79 offen sc1
    s_waitcnt vmcnt(0)
    v_max_u32 v48, v16, v17
    v_max_u32_e64 v49, v18, v19
    v_max3_u32 v48, v48, v20, v21
    v_max3_u32 v49, v49, v22, v23
    v_max3_u32 v48, v48, v24, v25
    v_max3_u32 v49, v49, v26, v27
    v_max3_u32 v48, v48, v28, v29
    v_max3_u32 v49, v49, v30, v31
    v_max3_u32 v48, v48, v32, v33
    v_max3_u32 v49, v49, v34, v35
    v_max3_u32 v48, v48, v36, v37
    v_max3_u32 v49, v49, v38, v39
    v_max3_u32 v48, v48, v40, v41
    v_max3_u32 v49, v49, v42, v43
    v_max_u32 v48, v48, v49
    v_cmp_eq_u32_e64 vcc, -1, v48
    s_cbranch_vccnz Lspin_56
    v_pk_add_f32 v[16:17], v[16:17], v[20:21]
    v_pk_add_f32 v[24:25], v[24:25], v[28:29]
    v_pk_add_f32 v[32:33], v[32:33], v[36:37]
    v_pk_add_f32 v[16:17], v[16:17], v[24:25]
    v_pk_add_f32 v[32:33], v[32:33], v[40:41]
    v_pk_add_f32 v[16:17], v[16:17], v[32:33]
    v_pk_add_f32 v[18:19], v[18:19], v[22:23]
    v_pk_add_f32 v[26:27], v[26:27], v[30:31]
    v_pk_add_f32 v[34:35], v[34:35], v[38:39]
    v_pk_add_f32 v[18:19], v[18:19], v[26:27]
    v_pk_add_f32 v[34:35], v[34:35], v[42:43]
    v_pk_add_f32 v[18:19], v[18:19], v[34:35]
    s_nop 1
    v_permlane32_swap_b32 v16, v18
    v_permlane32_swap_b32_e64 v17, v19
    v_pk_add_f32 v[16:17], v[16:17], v[18:19]
    s_nop 1
    v_permlane16_swap_b32 v16, v17
    v_add_f32 v16, v16, v17
    s_nop 1
    v_add_f32_dpp v16, v16, v16 row_ror:8 row_mask:0xf bank_mask:0xf
    v_cvt_pk_bf16_f32 v16, v16, v16
    v_and_b32 v16, 0xffff0000, v16
    v_mul_f32_e64 v16, v16, v47
    v_cvt_pk_bf16_f32 v16, v16, v16
    v_and_b32 v16, 0xffff0000, v16
    v_add_f32_e64 v16, v16, v46
    v_cvt_pk_bf16_f32 v16, v16, v16
    s_mov_b32 exec_lo, 0x00ff00ff
    s_mov_b32 exec_hi, 0x00ff00ff
    buffer_store_short v16, v14, s[44:47], s80 offen
    s_mov_b64 exec, -1
    s_cmp_lg_u32 s0, 224
    s_cbranch_scc1 Lep_57
    s_cmp_lg_u32 s76, 0
    s_cbranch_scc1 Lep_57
    v_mov_b32 v196, s75
    v_mov_b32_e64 v197, 0
    s_mov_b64 exec, 1
    buffer_store_dword v196, v197, s[36:39], 0 offen sc1
    s_mov_b64 exec, -1
Lep_57:
    s_branch L_fin
    .p2align 3
L_M:
    s_setprio 1
    s_and_b32 s78, s2, 7
    s_lshr_b32 s79, s2, 3
    s_lshl_b32 s71, s78, 1
    s_and_b32 s72, s79, 1
    s_add_u32 s71, s71, s72
    s_lshr_b32 s72, s79, 1
    s_cmp_gt_u32 s70, 3
    s_cselect_b32 s78, 1, 0
    s_cmp_gt_u32 s70, 11
    s_cselect_b32 s78, 2, s78
    s_sub_u32 s78, s70, s78
    s_cmp_eq_u32 s70, 3
    s_cselect_b32 s78, 14, s78
    s_cmp_eq_u32 s70, 11
    s_cselect_b32 s78, 15, s78
    s_lshl_b32 s0, s78, 4
    s_add_u32 s0, s0, s69
    s_lshr_b32 s73, s0, 2
    s_and_b32 s74, s0, 3
    s_lshl_b32 s77, s70, 4
    s_add_u32 s77, s77, s69
    s_and_b32 s80, s76, 1
    s_lshr_b32 s81, s76, 1
    v_and_b32 v8, 15, v2
    v_lshrrev_b32 v9, 4, v2
    v_lshrrev_b32 v10, 1, v8
    s_lshl_b32 s78, s80, 13
    s_add_u32 s78, s78, 118784
    v_lshlrev_b32 v11, 7, v8
    v_add_u32 v11, s78, v11
    v_add_u32 v12, 0, v9
    v_xor_b32 v12, v12, v10
    v_lshl_add_u32 v4, v12, 4, v11
    v_add_u32 v12, 4, v9
    v_xor_b32 v12, v12, v10
    v_lshl_add_u32 v5, v12, 4, v11
    v_bfe_u32 v10, v2, 2, 2
    v_and_b32_e64 v11, 3, v2
    v_lshl_add_u32 v12, v9, 3, v10
    v_lshlrev_b32_e64 v12, 7, v12
    v_lshl_add_u32 v12, v11, 3, v12
    v_add_u32 v12, 135168, v12
    v_lshrrev_b32 v13, 1, v10
    v_and_b32 v14, 1, v9
    v_lshl_add_u32 v13, v14, 1, v13
    s_lshl_b32 s78, s81, 1
    s_add_u32 s79, s78, 0
    v_xor_b32_e64 v14, s79, v13
    v_lshl_add_u32 v6, v14, 5, v12
    s_add_u32 s79, s78, 1
    v_xor_b32 v14, s79, v13
    v_lshl_add_u32 v7, v14, 5, v12
    v_lshrrev_b32_e64 v13, 5, v2
    v_lshl_add_u32 v13, v13, 3, v10
    v_lshlrev_b32 v13, 6, v13
    v_and_b32 v14, 1, v9
    v_lshl_add_u32 v13, v14, 5, v13
    v_lshl_add_u32 v13, v11, 3, v13
    s_lshl_b32 s78, s81, 11
    s_add_u32 s78, s78, 159744
    v_add_u32 v15, s78, v13
    v_mov_b64 v[128:129], 0
    v_mov_b64 v[130:131], 0
    v_mov_b64 v[132:133], 0
    v_mov_b64 v[134:135], 0
    v_mov_b64 v[136:137], 0
    v_mov_b64 v[138:139], 0
    v_mov_b64 v[140:141], 0
    v_mov_b64 v[142:143], 0
    v_mov_b64 v[144:145], 0
    v_mov_b64 v[146:147], 0
    v_mov_b64 v[148:149], 0
    v_mov_b64 v[150:151], 0
    v_mov_b64 v[152:153], 0
    v_mov_b64 v[154:155], 0
    v_mov_b64 v[156:157], 0
    v_mov_b64 v[158:159], 0
    v_mov_b64 v[160:161], 0
    v_mov_b64 v[162:163], 0
    v_mov_b64 v[164:165], 0
    v_mov_b64 v[166:167], 0
    v_mov_b64 v[168:169], 0
    v_mov_b64 v[170:171], 0
    v_mov_b64 v[172:173], 0
    v_mov_b64 v[174:175], 0
    v_mov_b64 v[176:177], 0
    v_mov_b64 v[178:179], 0
    v_mov_b64 v[180:181], 0
    v_mov_b64 v[182:183], 0
    v_mov_b64 v[184:185], 0
    v_mov_b64 v[186:187], 0
    v_mov_b64 v[188:189], 0
    v_mov_b64 v[190:191], 0
    v_mov_b64 v[192:193], 0
    v_mov_b64 v[194:195], 0
    v_mov_b64 v[196:197], 0
    v_mov_b64 v[198:199], 0
    v_mov_b64 v[200:201], 0
    v_mov_b64 v[202:203], 0
    v_mov_b64 v[204:205], 0
    v_mov_b64 v[206:207], 0
    v_mov_b64 v[208:209], 0
    v_mov_b64 v[210:211], 0
    v_mov_b64 v[212:213], 0
    v_mov_b64 v[214:215], 0
    v_mov_b64 v[216:217], 0
    v_mov_b64 v[218:219], 0
    v_mov_b64 v[220:221], 0
    v_mov_b64 v[222:223], 0
    v_mov_b64 v[104:105], 0
    v_mov_b64 v[106:107], 0
    v_mov_b64 v[108:109], 0
    v_mov_b64 v[110:111], 0
    v_and_b32 v14, 31, v2
    v_lshrrev_b32_e64 v13, 5, v2
    s_lshl_b32 s78, s81, 14
    s_lshl_b32 s79, s80, 13
    s_add_u32 s78, s78, s79
    s_add_u32 s78, s78, 110592
    v_lshl_add_u32 v12, v14, 7, s78
    v_and_b32 v14, 7, v14
    v_xor_b32 v14, v14, v13
    v_xor_b32_e64 v13, 0, v14
    v_lshl_add_u32 v112, v13, 4, v12
    v_xor_b32_e64 v13, 2, v14
    v_lshl_add_u32 v113, v13, 4, v12
    v_xor_b32_e64 v13, 4, v14
    v_lshl_add_u32 v114, v13, 4, v12
    v_xor_b32_e64 v13, 6, v14
    v_lshl_add_u32 v115, v13, 4, v12
    s_add_u32 s79, s79, 143360
    v_lshl_add_u32 v12, v8, 7, s79
    s_lshl_b32 s78, s81, 2
    v_add_u32 v14, s78, v9
    v_and_b32 v13, 7, v8
    v_xor_b32 v14, v14, v13
    v_lshl_add_u32 v116, v14, 4, v12
    s_lshl_b32 s78, s80, 6
    v_add_u32 v10, s78, v8
    v_lshlrev_b32_e64 v11, 3, v10
    v_add_u32 v11, 159744, v11
    s_lshl_b32 s79, s81, 5
    v_add_u32 v12, s79, v8
    v_lshlrev_b32_e64 v12, 3, v12
    v_add_u32 v12, 160768, v12
    v_lshlrev_b32_e64 v13, 2, v10
    v_add_u32 v13, 162304, v13
    v_and_b32 v14, 31, v2
    v_add_u32 v14, s78, v14
    v_lshlrev_b32_e64 v14, 2, v14
    v_add_u32 v14, 162304, v14
    s_waitcnt lgkmcnt(0)
    s_load_dword s75, s[26:27], 0
    s_mov_b32 s36, s26
    s_and_b32 s37, s27, 0xffff
    s_mov_b32 s38, 0x10000000
    s_mov_b32 s39, 0x20000
    s_mov_b32 s64, s14
    s_and_b32 s65, s15, 0xffff
    s_mov_b32 s66, 0x800
    s_mov_b32 s67, 0x20000
    s_mov_b32 s44, s22
    s_and_b32 s45, s23, 0xffff
    s_mov_b32 s46, 0x400000
    s_mov_b32 s47, 0x20000
    s_lshl_b32 s78, s72, 7
    buffer_load_dword v118, off, s[64:67], s78
    s_waitcnt lgkmcnt(0)
    s_mul_i32 s75, s75, 0x9E3779B1
    s_add_u32 s75, s75, 0x7F4A7C15
    s_mov_b32 s84, 0
    s_mov_b32 s82, 2
    s_mov_b32 s83, 0xfffec000
    s_barrier
    s_nop 0
    ds_read_b128 v[16:19], v4 offset:0
    ds_read_b64_tr_b16 v[40:41], v6 offset:8192
    ds_read_b64_tr_b16 v[42:43], v6 offset:8704
    ds_read_b128 v[20:23], v4 offset:2048
    ds_read_b128 v[24:27], v4 offset:4096
    ds_read_b128 v[28:31], v4 offset:6144
    ds_read_b64_tr_b16 v[44:45], v7 offset:8192
    ds_read_b64_tr_b16 v[46:47], v7 offset:8704
    ds_read_b64_tr_b16 v[48:49], v6 offset:16384
    ds_read_b64_tr_b16 v[50:51], v6 offset:16896
    ds_read_b64_tr_b16 v[52:53], v7 offset:16384
    ds_read_b64_tr_b16 v[54:55], v7 offset:16896
    ds_read_b64_tr_b16 v[32:33], v6 offset:0
    ds_read_b64_tr_b16 v[34:35], v6 offset:512
    ds_read_b64_tr_b16 v[36:37], v7 offset:0
    ds_read_b64_tr_b16 v[38:39], v7 offset:512
    ds_read_b64_tr_b16 v[96:97], v15 offset:0
    ds_read_b64_tr_b16 v[98:99], v15 offset:1024
    ds_read_b64_tr_b16 v[100:101], v15 offset:256
    ds_read_b64_tr_b16 v[102:103], v15 offset:1280
    .p2align 3
L_Mloop:
    s_waitcnt lgkmcnt(0)
    s_nop 0
    v_mfma_f32_16x16x32_bf16 v[160:163], v[40:43], v[16:19], v[160:163]
    ds_read_b128 v[56:59], v5 offset:0
    v_mfma_f32_16x16x32_bf16 v[176:179], v[44:47], v[16:19], v[176:179]
    ds_read_b64_tr_b16 v[80:81], v6 offset:12288
    v_mfma_f32_16x16x32_bf16 v[180:183], v[44:47], v[20:23], v[180:183]
    ds_read_b64_tr_b16 v[82:83], v6 offset:12800
    v_mfma_f32_16x16x32_bf16 v[164:167], v[40:43], v[20:23], v[164:167]
    ds_read_b128 v[60:63], v5 offset:2048
    v_mfma_f32_16x16x32_bf16 v[168:171], v[40:43], v[24:27], v[168:171]
    ds_read_b128 v[64:67], v5 offset:4096
    v_mfma_f32_16x16x32_bf16 v[184:187], v[44:47], v[24:27], v[184:187]
    ds_read_b128 v[68:71], v5 offset:6144
    v_mfma_f32_16x16x32_bf16 v[188:191], v[44:47], v[28:31], v[188:191]
    ds_read_b64_tr_b16 v[84:85], v7 offset:12288
    v_mfma_f32_16x16x32_bf16 v[172:175], v[40:43], v[28:31], v[172:175]
    ds_read_b64_tr_b16 v[86:87], v7 offset:12800
    v_mfma_f32_16x16x32_bf16 v[204:207], v[48:51], v[28:31], v[204:207]
    ds_read_b64_tr_b16 v[88:89], v6 offset:20480
    v_mfma_f32_16x16x32_bf16 v[220:223], v[52:55], v[28:31], v[220:223]
    ds_read_b64_tr_b16 v[90:91], v6 offset:20992
    v_mfma_f32_16x16x32_bf16 v[216:219], v[52:55], v[24:27], v[216:219]
    ds_read_b64_tr_b16 v[92:93], v7 offset:20480
    v_mfma_f32_16x16x32_bf16 v[200:203], v[48:51], v[24:27], v[200:203]
    ds_read_b64_tr_b16 v[94:95], v7 offset:20992
    v_mfma_f32_16x16x32_bf16 v[196:199], v[48:51], v[20:23], v[196:199]
    ds_read_b64_tr_b16 v[72:73], v6 offset:4096
    v_mfma_f32_16x16x32_bf16 v[212:215], v[52:55], v[20:23], v[212:215]
    ds_read_b64_tr_b16 v[74:75], v6 offset:4608
    v_mfma_f32_16x16x32_bf16 v[208:211], v[52:55], v[16:19], v[208:211]
    ds_read_b64_tr_b16 v[76:77], v7 offset:4096
    v_mfma_f32_16x16x32_bf16 v[192:195], v[48:51], v[16:19], v[192:195]
    ds_read_b64_tr_b16 v[78:79], v7 offset:4608
    v_mfma_f32_16x16x32_bf16 v[128:131], v[32:35], v[16:19], v[128:131]
    s_add_u32 s84, s84, 1
    s_cmp_eq_u32 s82, 2
    s_cselect_b32 s78, s83, 40960
    s_cselect_b32 s82, -1, s82
    s_add_u32 s82, s82, 1
    v_mfma_f32_16x16x32_bf16 v[144:147], v[36:39], v[16:19], v[144:147]
    v_add_u32 v4, s78, v4
    v_add_u32 v5, s78, v5
    v_mfma_f32_16x16x32_bf16 v[148:151], v[36:39], v[20:23], v[148:151]
    v_add_u32 v6, s78, v6
    v_add_u32 v7, s78, v7
    v_mfma_f32_16x16x32_bf16 v[132:135], v[32:35], v[20:23], v[132:135]
    v_mfma_f32_16x16x32_bf16 v[136:139], v[32:35], v[24:27], v[136:139]
    v_mfma_f32_16x16x32_bf16 v[152:155], v[36:39], v[24:27], v[152:155]
    v_mfma_f32_16x16x32_bf16 v[156:159], v[36:39], v[28:31], v[156:159]
    v_mfma_f32_16x16x32_bf16 v[140:143], v[32:35], v[28:31], v[140:143]
    s_waitcnt vmcnt(0) lgkmcnt(0)
    v_mfma_f32_16x16x32_bf16 v[160:163], v[80:83], v[56:59], v[160:163]
    v_mfma_f32_16x16x32_bf16 v[176:179], v[84:87], v[56:59], v[176:179]
    s_barrier
    s_cmp_eq_u32 s84, 16
    s_cbranch_scc1 L_Mtail
    v_mfma_f32_16x16x32_bf16 v[180:183], v[84:87], v[60:63], v[180:183]
    ds_read_b128 v[16:19], v4 offset:0
    v_mfma_f32_16x16x32_bf16 v[164:167], v[80:83], v[60:63], v[164:167]
    ds_read_b64_tr_b16 v[40:41], v6 offset:8192
    v_mfma_f32_16x16x32_bf16 v[168:171], v[80:83], v[64:67], v[168:171]
    ds_read_b64_tr_b16 v[42:43], v6 offset:8704
    v_mfma_f32_16x16x32_bf16 v[184:187], v[84:87], v[64:67], v[184:187]
    ds_read_b128 v[20:23], v4 offset:2048
    v_mfma_f32_16x16x32_bf16 v[188:191], v[84:87], v[68:71], v[188:191]
    ds_read_b128 v[24:27], v4 offset:4096
    v_mfma_f32_16x16x32_bf16 v[172:175], v[80:83], v[68:71], v[172:175]
    ds_read_b128 v[28:31], v4 offset:6144
    v_mfma_f32_16x16x32_bf16 v[204:207], v[88:91], v[68:71], v[204:207]
    ds_read_b64_tr_b16 v[44:45], v7 offset:8192
    v_mfma_f32_16x16x32_bf16 v[220:223], v[92:95], v[68:71], v[220:223]
    ds_read_b64_tr_b16 v[46:47], v7 offset:8704
    v_mfma_f32_16x16x32_bf16 v[216:219], v[92:95], v[64:67], v[216:219]
    ds_read_b64_tr_b16 v[48:49], v6 offset:16384
    v_mfma_f32_16x16x32_bf16 v[200:203], v[88:91], v[64:67], v[200:203]
    ds_read_b64_tr_b16 v[50:51], v6 offset:16896
    v_mfma_f32_16x16x32_bf16 v[196:199], v[88:91], v[60:63], v[196:199]
    ds_read_b64_tr_b16 v[52:53], v7 offset:16384
    v_mfma_f32_16x16x32_bf16 v[212:215], v[92:95], v[60:63], v[212:215]
    ds_read_b64_tr_b16 v[54:55], v7 offset:16896
    v_mfma_f32_16x16x32_bf16 v[208:211], v[92:95], v[56:59], v[208:211]
    ds_read_b64_tr_b16 v[32:33], v6 offset:0
    v_mfma_f32_16x16x32_bf16 v[192:195], v[88:91], v[56:59], v[192:195]
    ds_read_b64_tr_b16 v[34:35], v6 offset:512
    v_mfma_f32_16x16x32_bf16 v[128:131], v[72:75], v[56:59], v[128:131]
    ds_read_b64_tr_b16 v[36:37], v7 offset:0
    v_mfma_f32_16x16x32_bf16 v[144:147], v[76:79], v[56:59], v[144:147]
    ds_read_b64_tr_b16 v[38:39], v7 offset:512
    v_mfma_f32_16x16x32_bf16 v[148:151], v[76:79], v[60:63], v[148:151]
    v_mfma_f32_16x16x32_bf16 v[132:135], v[72:75], v[60:63], v[132:135]
    v_mfma_f32_16x16x32_bf16 v[136:139], v[72:75], v[64:67], v[136:139]
    v_mfma_f32_16x16x32_bf16 v[152:155], v[76:79], v[64:67], v[152:155]
    v_mfma_f32_16x16x32_bf16 v[156:159], v[76:79], v[68:71], v[156:159]
    v_mfma_f32_16x16x32_bf16 v[140:143], v[72:75], v[68:71], v[140:143]
    s_branch L_Mloop
    .p2align 3
L_Mtail:
    s_mov_b64 exec, 0xffff
    ds_read_b64 v[104:105], v11 offset:0
    ds_read_b64 v[106:107], v11 offset:128
    ds_read_b64 v[108:109], v11 offset:256
    ds_read_b64 v[110:111], v11 offset:384
    s_mov_b64 exec, -1
    s_nop 0
    v_mfma_f32_16x16x32_bf16 v[180:183], v[84:87], v[60:63], v[180:183]
    ds_read_b64 v[20:21], v12 offset:512
    v_mfma_f32_16x16x32_bf16 v[164:167], v[80:83], v[60:63], v[164:167]
    ds_read_b64 v[22:23], v12 offset:640
    v_mfma_f32_16x16x32_bf16 v[168:171], v[80:83], v[64:67], v[168:171]
    ds_read_b64 v[24:25], v12 offset:1024
    v_mfma_f32_16x16x32_bf16 v[184:187], v[84:87], v[64:67], v[184:187]
    ds_read_b64 v[26:27], v12 offset:1152
    v_mfma_f32_16x16x32_bf16 v[188:191], v[84:87], v[68:71], v[188:191]
    ds_read_b64 v[16:17], v12 offset:0
    v_mfma_f32_16x16x32_bf16 v[172:175], v[80:83], v[68:71], v[172:175]
    ds_read_b64 v[18:19], v12 offset:128
    v_mfma_f32_16x16x32_bf16 v[204:207], v[88:91], v[68:71], v[204:207]
    ds_read2_b32 v[32:33], v14 offset0:0 offset1:32
    v_mfma_f32_16x16x32_bf16 v[220:223], v[92:95], v[68:71], v[220:223]
    ds_read_b32 v28, v13 offset:0
    v_mfma_f32_16x16x32_bf16 v[216:219], v[92:95], v[64:67], v[216:219]
    ds_read_b32 v30, v13 offset:64
    v_mfma_f32_16x16x32_bf16 v[200:203], v[88:91], v[64:67], v[200:203]
    ds_read_b32 v44, v13 offset:128
    v_mfma_f32_16x16x32_bf16 v[196:199], v[88:91], v[60:63], v[196:199]
    ds_read_b32 v46, v13 offset:192
    v_mfma_f32_16x16x32_bf16 v[212:215], v[92:95], v[60:63], v[212:215]
    v_mfma_f32_16x16x32_bf16 v[208:211], v[92:95], v[56:59], v[208:211]
    v_mfma_f32_16x16x32_bf16 v[192:195], v[88:91], v[56:59], v[192:195]
    s_waitcnt lgkmcnt(0)
    s_nop 0
    v_mfma_f32_16x16x16_bf16 v[160:163], v[20:21], v[104:105], v[160:163]
    v_mfma_f32_16x16x16_bf16 v[176:179], v[22:23], v[104:105], v[176:179]
    v_mfma_f32_16x16x16_bf16 v[164:167], v[20:21], v[106:107], v[164:167]
    v_mfma_f32_16x16x16_bf16 v[180:183], v[22:23], v[106:107], v[180:183]
    v_mfma_f32_16x16x16_bf16 v[168:171], v[20:21], v[108:109], v[168:171]
    v_mfma_f32_16x16x16_bf16 v[184:187], v[22:23], v[108:109], v[184:187]
    v_mfma_f32_16x16x16_bf16 v[172:175], v[20:21], v[110:111], v[172:175]
    v_mfma_f32_16x16x16_bf16 v[188:191], v[22:23], v[110:111], v[188:191]
    v_mul_f32 v34, 0x3fb8aa3b, v32
    v_mul_f32 v48, 0x3fb8aa3b, v33
    v_mfma_f32_16x16x16_bf16 v[192:195], v[24:25], v[104:105], v[192:195]
    v_mfma_f32_16x16x16_bf16 v[208:211], v[26:27], v[104:105], v[208:211]
    v_mfma_f32_16x16x16_bf16 v[196:199], v[24:25], v[106:107], v[196:199]
    v_cvt_pk_bf16_f32 v160, v160, v161
    v_cvt_pk_bf16_f32 v161, v162, v163
    v_cvt_pk_bf16_f32 v162, v176, v177
    v_cvt_pk_bf16_f32 v163, v178, v179
    v_mfma_f32_16x16x16_bf16 v[212:215], v[26:27], v[106:107], v[212:215]
    v_cvt_pk_bf16_f32 v164, v164, v165
    v_cvt_pk_bf16_f32 v165, v166, v167
    v_cvt_pk_bf16_f32 v166, v180, v181
    v_cvt_pk_bf16_f32 v167, v182, v183
    v_mfma_f32_16x16x16_bf16 v[200:203], v[24:25], v[108:109], v[200:203]
    v_cvt_pk_bf16_f32 v168, v168, v169
    v_cvt_pk_bf16_f32 v169, v170, v171
    v_cvt_pk_bf16_f32 v170, v184, v185
    v_cvt_pk_bf16_f32 v171, v186, v187
    v_mfma_f32_16x16x16_bf16 v[216:219], v[26:27], v[108:109], v[216:219]
    v_cvt_pk_bf16_f32 v172, v172, v173
    v_cvt_pk_bf16_f32 v173, v174, v175
    v_cvt_pk_bf16_f32 v174, v188, v189
    v_cvt_pk_bf16_f32 v175, v190, v191
    v_mfma_f32_16x16x16_bf16 v[204:207], v[24:25], v[110:111], v[204:207]
    v_permlane16_swap_b32 v160, v164
    v_permlane16_swap_b32 v161, v165
    v_permlane16_swap_b32 v162, v166
    v_permlane16_swap_b32 v163, v167
    v_mfma_f32_16x16x16_bf16 v[220:223], v[26:27], v[110:111], v[220:223]
    v_permlane16_swap_b32 v168, v172
    v_permlane16_swap_b32 v169, v173
    v_permlane16_swap_b32 v170, v174
    v_permlane16_swap_b32 v171, v175
    v_mfma_f32_32x32x16_bf16 v[224:239], v[96:99], v[160:163], 0
    v_mfma_f32_32x32x16_bf16 v[224:239], v[100:103], v[164:167], v[224:239]
    v_mfma_f32_32x32x16_bf16 v[240:255], v[96:99], v[168:171], 0
    v_mfma_f32_32x32x16_bf16 v[240:255], v[100:103], v[172:175], v[240:255]
    v_pk_mul_f32 v[192:193], v[192:193], v[28:29] op_sel_hi:[1,0]
    v_pk_mul_f32 v[194:195], v[194:195], v[28:29] op_sel_hi:[1,0]
    v_pk_mul_f32 v[208:209], v[208:209], v[28:29] op_sel_hi:[1,0]
    v_pk_mul_f32 v[210:211], v[210:211], v[28:29] op_sel_hi:[1,0]
    v_cvt_pk_bf16_f32 v192, v192, v193
    v_cvt_pk_bf16_f32 v193, v194, v195
    v_cvt_pk_bf16_f32 v194, v208, v209
    v_cvt_pk_bf16_f32 v195, v210, v211
    v_pk_mul_f32 v[196:197], v[196:197], v[30:31] op_sel_hi:[1,0]
    v_pk_mul_f32 v[198:199], v[198:199], v[30:31] op_sel_hi:[1,0]
    v_pk_mul_f32 v[212:213], v[212:213], v[30:31] op_sel_hi:[1,0]
    v_pk_mul_f32 v[214:215], v[214:215], v[30:31] op_sel_hi:[1,0]
    v_cvt_pk_bf16_f32 v196, v196, v197
    v_cvt_pk_bf16_f32 v197, v198, v199
    v_cvt_pk_bf16_f32 v198, v212, v213
    v_cvt_pk_bf16_f32 v199, v214, v215
    v_pk_mul_f32 v[200:201], v[200:201], v[44:45] op_sel_hi:[1,0]
    v_pk_mul_f32 v[202:203], v[202:203], v[44:45] op_sel_hi:[1,0]
    v_pk_mul_f32 v[216:217], v[216:217], v[44:45] op_sel_hi:[1,0]
    v_pk_mul_f32 v[218:219], v[218:219], v[44:45] op_sel_hi:[1,0]
    v_cvt_pk_bf16_f32 v200, v200, v201
    v_cvt_pk_bf16_f32 v201, v202, v203
    v_cvt_pk_bf16_f32 v202, v216, v217
    v_cvt_pk_bf16_f32 v203, v218, v219
    v_pk_mul_f32 v[204:205], v[204:205], v[46:47] op_sel_hi:[1,0]
    v_pk_mul_f32 v[206:207], v[206:207], v[46:47] op_sel_hi:[1,0]
    v_pk_mul_f32 v[220:221], v[220:221], v[46:47] op_sel_hi:[1,0]
    v_pk_mul_f32 v[222:223], v[222:223], v[46:47] op_sel_hi:[1,0]
    v_cvt_pk_bf16_f32 v204, v204, v205
    v_cvt_pk_bf16_f32 v205, v206, v207
    v_cvt_pk_bf16_f32 v206, v220, v221
    v_cvt_pk_bf16_f32 v207, v222, v223
    v_mfma_f32_16x16x32_bf16 v[128:131], v[72:75], v[56:59], v[128:131]
    v_max3_f32 v36, v224, v225, v226
    v_max3_f32 v38, -v224, -v225, -v226
    v_max3_f32 v36, v36, v227, v228
    v_max3_f32 v38, v38, -v227, -v228
    v_mfma_f32_16x16x32_bf16 v[144:147], v[76:79], v[56:59], v[144:147]
    v_max3_f32 v36, v36, v229, v230
    v_max3_f32 v38, v38, -v229, -v230
    v_max3_f32 v36, v36, v231, v232
    v_max3_f32 v38, v38, -v231, -v232
    v_mfma_f32_16x16x32_bf16 v[148:151], v[76:79], v[60:63], v[148:151]
    v_max3_f32 v36, v36, v233, v234
    v_max3_f32 v38, v38, -v233, -v234
    v_max3_f32 v36, v36, v235, v236
    v_max3_f32 v38, v38, -v235, -v236
    v_mfma_f32_16x16x32_bf16 v[132:135], v[72:75], v[60:63], v[132:135]
    v_max3_f32 v36, v36, v237, v238
    v_max3_f32 v38, v38, -v237, -v238
    v_max_f32_e64 v36, v36, v239
    v_max_f32 v38, v38, -v239
    v_mfma_f32_16x16x32_bf16 v[136:139], v[72:75], v[64:67], v[136:139]
    v_max3_f32 v37, v240, v241, v242
    v_max3_f32 v39, -v240, -v241, -v242
    v_max3_f32 v37, v37, v243, v244
    v_max3_f32 v39, v39, -v243, -v244
    v_mfma_f32_16x16x32_bf16 v[152:155], v[76:79], v[64:67], v[152:155]
    v_max3_f32 v37, v37, v245, v246
    v_max3_f32 v39, v39, -v245, -v246
    v_max3_f32 v37, v37, v247, v248
    v_max3_f32 v39, v39, -v247, -v248
    v_mfma_f32_16x16x32_bf16 v[156:159], v[76:79], v[68:71], v[156:159]
    v_max3_f32 v37, v37, v249, v250
    v_max3_f32 v39, v39, -v249, -v250
    v_max3_f32 v37, v37, v251, v252
    v_max3_f32 v39, v39, -v251, -v252
    v_mfma_f32_16x16x32_bf16 v[140:143], v[72:75], v[68:71], v[140:143]
    v_max3_f32 v37, v37, v253, v254
    v_max3_f32 v39, v39, -v253, -v254
    v_max_f32_e64 v37, v37, v255
    v_max_f32 v39, v39, -v255
    v_permlane32_swap_b32 v36, v38
    s_nop 0
    v_permlane32_swap_b32 v37, v39
    v_max_f32 v36, v36, v38
    v_max_f32_e64 v37, v37, v39
    v_mul_f32 v36, -v36, v34
    v_mul_f32 v37, -v37, v48
    v_mov_b32 v38, v36
    v_mov_b32 v39, v37
    s_nop 0
    v_permlane32_swap_b32 v36, v38
    v_permlane32_swap_b32_e64 v37, v39
    v_pk_fma_f32 v[60:61], v[224:225], v[34:35], v[36:37] op_sel_hi:[1,0,0]
    v_pk_fma_f32 v[62:63], v[226:227], v[34:35], v[36:37] op_sel_hi:[1,0,0]
    v_pk_fma_f32 v[64:65], v[228:229], v[34:35], v[36:37] op_sel_hi:[1,0,0]
    v_pk_fma_f32 v[66:67], v[230:231], v[34:35], v[36:37] op_sel_hi:[1,0,0]
    v_pk_fma_f32 v[68:69], v[232:233], v[34:35], v[36:37] op_sel_hi:[1,0,0]
    v_pk_fma_f32 v[70:71], v[234:235], v[34:35], v[36:37] op_sel_hi:[1,0,0]
    v_pk_fma_f32 v[72:73], v[236:237], v[34:35], v[36:37] op_sel_hi:[1,0,0]
    v_pk_fma_f32 v[74:75], v[238:239], v[34:35], v[36:37] op_sel_hi:[1,0,0]
    v_pk_fma_f32 v[76:77], v[224:225], v[34:35], v[38:39] op_sel_hi:[1,0,0] neg_lo:[1,0,0] neg_hi:[1,0,0]
    v_pk_fma_f32 v[78:79], v[226:227], v[34:35], v[38:39] op_sel_hi:[1,0,0] neg_lo:[1,0,0] neg_hi:[1,0,0]
    v_pk_fma_f32 v[80:81], v[228:229], v[34:35], v[38:39] op_sel_hi:[1,0,0] neg_lo:[1,0,0] neg_hi:[1,0,0]
    v_pk_fma_f32 v[82:83], v[230:231], v[34:35], v[38:39] op_sel_hi:[1,0,0] neg_lo:[1,0,0] neg_hi:[1,0,0]
    v_pk_fma_f32 v[84:85], v[232:233], v[34:35], v[38:39] op_sel_hi:[1,0,0] neg_lo:[1,0,0] neg_hi:[1,0,0]
    v_pk_fma_f32 v[86:87], v[234:235], v[34:35], v[38:39] op_sel_hi:[1,0,0] neg_lo:[1,0,0] neg_hi:[1,0,0]
    v_pk_fma_f32 v[88:89], v[236:237], v[34:35], v[38:39] op_sel_hi:[1,0,0] neg_lo:[1,0,0] neg_hi:[1,0,0]
    v_pk_fma_f32 v[90:91], v[238:239], v[34:35], v[38:39] op_sel_hi:[1,0,0] neg_lo:[1,0,0] neg_hi:[1,0,0]
    v_exp_f32 v60, v60
    v_exp_f32 v61, v61
    v_exp_f32 v62, v62
    v_exp_f32 v63, v63
    v_exp_f32 v64, v64
    v_exp_f32 v65, v65
    v_exp_f32 v66, v66
    v_exp_f32 v67, v67
    v_exp_f32 v68, v68
    v_exp_f32 v69, v69
    v_exp_f32 v70, v70
    v_exp_f32 v71, v71
    v_exp_f32 v72, v72
    v_exp_f32 v73, v73
    v_exp_f32 v74, v74
    v_exp_f32 v75, v75
    v_exp_f32 v76, v76
    v_exp_f32 v77, v77
    v_exp_f32 v78, v78
    v_exp_f32 v79, v79
    v_exp_f32 v80, v80
    v_exp_f32 v81, v81
    v_exp_f32 v82, v82
    v_exp_f32 v83, v83
    v_exp_f32 v84, v84
    v_exp_f32 v85, v85
    v_exp_f32 v86, v86
    v_exp_f32 v87, v87
    v_exp_f32 v88, v88
    v_exp_f32 v89, v89
    v_exp_f32 v90, v90
    v_exp_f32 v91, v91
    v_pk_add_f32 v[40:41], v[60:61], v[62:63]
    v_pk_add_f32 v[42:43], v[76:77], v[78:79]
    v_pk_add_f32 v[40:41], v[40:41], v[64:65]
    v_pk_add_f32 v[42:43], v[42:43], v[80:81]
    v_pk_add_f32 v[40:41], v[40:41], v[66:67]
    v_pk_add_f32 v[42:43], v[42:43], v[82:83]
    v_pk_add_f32 v[40:41], v[40:41], v[68:69]
    v_pk_add_f32 v[42:43], v[42:43], v[84:85]
    v_pk_add_f32 v[40:41], v[40:41], v[70:71]
    v_pk_add_f32 v[42:43], v[42:43], v[86:87]
    v_pk_add_f32 v[40:41], v[40:41], v[72:73]
    v_pk_add_f32 v[42:43], v[42:43], v[88:89]
    v_pk_add_f32 v[40:41], v[40:41], v[74:75]
    v_pk_add_f32 v[42:43], v[42:43], v[90:91]
    v_add_f32 v40, v40, v41
    v_add_f32 v42, v42, v43
    s_nop 1
    v_permlane32_swap_b32 v40, v42
    v_add_f32 v40, v40, v42
    v_rcp_f32 v40, v40
    s_nop 0
    v_mov_b32 v42, v40
    s_nop 1
    v_permlane32_swap_b32 v40, v42
    v_pk_mul_f32 v[60:61], v[60:61], v[40:41] op_sel_hi:[1,0]
    v_pk_mul_f32 v[62:63], v[62:63], v[40:41] op_sel_hi:[1,0]
    v_pk_mul_f32 v[64:65], v[64:65], v[40:41] op_sel_hi:[1,0]
    v_pk_mul_f32 v[66:67], v[66:67], v[40:41] op_sel_hi:[1,0]
    v_cvt_pk_bf16_f32 v160, v60, v61
    v_cvt_pk_bf16_f32 v161, v62, v63
    v_cvt_pk_bf16_f32 v162, v64, v65
    v_cvt_pk_bf16_f32 v163, v66, v67
    v_pk_mul_f32 v[68:69], v[68:69], v[40:41] op_sel_hi:[1,0]
    v_pk_mul_f32 v[70:71], v[70:71], v[40:41] op_sel_hi:[1,0]
    v_pk_mul_f32 v[72:73], v[72:73], v[40:41] op_sel_hi:[1,0]
    v_pk_mul_f32 v[74:75], v[74:75], v[40:41] op_sel_hi:[1,0]
    v_cvt_pk_bf16_f32 v166, v68, v69
    v_cvt_pk_bf16_f32 v167, v70, v71
    v_cvt_pk_bf16_f32 v164, v72, v73
    v_cvt_pk_bf16_f32 v165, v74, v75
    v_pk_mul_f32 v[76:77], v[76:77], v[42:43] op_sel_hi:[1,0]
    v_pk_mul_f32 v[78:79], v[78:79], v[42:43] op_sel_hi:[1,0]
    v_pk_mul_f32 v[80:81], v[80:81], v[42:43] op_sel_hi:[1,0]
    v_pk_mul_f32 v[82:83], v[82:83], v[42:43] op_sel_hi:[1,0]
    v_cvt_pk_bf16_f32 v168, v76, v77
    v_cvt_pk_bf16_f32 v169, v78, v79
    v_cvt_pk_bf16_f32 v170, v80, v81
    v_cvt_pk_bf16_f32 v171, v82, v83
    v_pk_mul_f32 v[84:85], v[84:85], v[42:43] op_sel_hi:[1,0]
    v_pk_mul_f32 v[86:87], v[86:87], v[42:43] op_sel_hi:[1,0]
    v_pk_mul_f32 v[88:89], v[88:89], v[42:43] op_sel_hi:[1,0]
    v_pk_mul_f32 v[90:91], v[90:91], v[42:43] op_sel_hi:[1,0]
    v_cvt_pk_bf16_f32 v174, v84, v85
    v_cvt_pk_bf16_f32 v175, v86, v87
    v_cvt_pk_bf16_f32 v172, v88, v89
    v_cvt_pk_bf16_f32 v173, v90, v91
    v_pk_fma_f32 v[60:61], v[240:241], v[48:49], v[36:37] op_sel:[0,0,1] op_sel_hi:[1,0,1]
    v_pk_fma_f32 v[62:63], v[242:243], v[48:49], v[36:37] op_sel:[0,0,1] op_sel_hi:[1,0,1]
    v_pk_fma_f32 v[64:65], v[244:245], v[48:49], v[36:37] op_sel:[0,0,1] op_sel_hi:[1,0,1]
    v_pk_fma_f32 v[66:67], v[246:247], v[48:49], v[36:37] op_sel:[0,0,1] op_sel_hi:[1,0,1]
    v_pk_fma_f32 v[68:69], v[248:249], v[48:49], v[36:37] op_sel:[0,0,1] op_sel_hi:[1,0,1]
    v_pk_fma_f32 v[70:71], v[250:251], v[48:49], v[36:37] op_sel:[0,0,1] op_sel_hi:[1,0,1]
    v_pk_fma_f32 v[72:73], v[252:253], v[48:49], v[36:37] op_sel:[0,0,1] op_sel_hi:[1,0,1]
    v_pk_fma_f32 v[74:75], v[254:255], v[48:49], v[36:37] op_sel:[0,0,1] op_sel_hi:[1,0,1]
    v_pk_fma_f32 v[76:77], v[240:241], v[48:49], v[38:39] op_sel:[0,0,1] op_sel_hi:[1,0,1] neg_lo:[1,0,0] neg_hi:[1,0,0]
    v_pk_fma_f32 v[78:79], v[242:243], v[48:49], v[38:39] op_sel:[0,0,1] op_sel_hi:[1,0,1] neg_lo:[1,0,0] neg_hi:[1,0,0]
    v_pk_fma_f32 v[80:81], v[244:245], v[48:49], v[38:39] op_sel:[0,0,1] op_sel_hi:[1,0,1] neg_lo:[1,0,0] neg_hi:[1,0,0]
    v_pk_fma_f32 v[82:83], v[246:247], v[48:49], v[38:39] op_sel:[0,0,1] op_sel_hi:[1,0,1] neg_lo:[1,0,0] neg_hi:[1,0,0]
    v_pk_fma_f32 v[84:85], v[248:249], v[48:49], v[38:39] op_sel:[0,0,1] op_sel_hi:[1,0,1] neg_lo:[1,0,0] neg_hi:[1,0,0]
    v_pk_fma_f32 v[86:87], v[250:251], v[48:49], v[38:39] op_sel:[0,0,1] op_sel_hi:[1,0,1] neg_lo:[1,0,0] neg_hi:[1,0,0]
    v_pk_fma_f32 v[88:89], v[252:253], v[48:49], v[38:39] op_sel:[0,0,1] op_sel_hi:[1,0,1] neg_lo:[1,0,0] neg_hi:[1,0,0]
    v_pk_fma_f32 v[90:91], v[254:255], v[48:49], v[38:39] op_sel:[0,0,1] op_sel_hi:[1,0,1] neg_lo:[1,0,0] neg_hi:[1,0,0]
    v_exp_f32 v60, v60
    v_exp_f32 v61, v61
    v_exp_f32 v62, v62
    v_exp_f32 v63, v63
    ds_write_b128 v116, v[192:195] offset:0
    v_exp_f32 v64, v64
    v_exp_f32 v65, v65
    v_exp_f32 v66, v66
    v_exp_f32 v67, v67
    ds_write_b128 v116, v[196:199] offset:2048
    v_exp_f32 v68, v68
    v_exp_f32 v69, v69
    v_exp_f32 v70, v70
    v_exp_f32 v71, v71
    ds_write_b128 v116, v[200:203] offset:4096
    v_exp_f32 v72, v72
    v_exp_f32 v73, v73
    v_exp_f32 v74, v74
    v_exp_f32 v75, v75
    ds_write_b128 v116, v[204:207] offset:6144
    v_exp_f32 v76, v76
    v_exp_f32 v77, v77
    v_exp_f32 v78, v78
    v_exp_f32 v79, v79
    ds_write_b128 v112, v[160:163] offset:0
    v_exp_f32 v80, v80
    v_exp_f32 v81, v81
    v_exp_f32 v82, v82
    v_exp_f32 v83, v83
    ds_write_b128 v113, v[164:167] offset:0
    v_exp_f32 v84, v84
    v_exp_f32 v85, v85
    v_exp_f32 v86, v86
    v_exp_f32 v87, v87
    ds_write_b128 v114, v[168:171] offset:0
    v_exp_f32 v88, v88
    v_exp_f32 v89, v89
    v_exp_f32 v90, v90
    v_exp_f32 v91, v91
    ds_write_b128 v115, v[172:175] offset:0
    v_pk_add_f32 v[40:41], v[60:61], v[62:63]
    v_pk_add_f32 v[42:43], v[76:77], v[78:79]
    v_pk_add_f32 v[40:41], v[40:41], v[64:65]
    v_pk_add_f32 v[42:43], v[42:43], v[80:81]
    v_pk_add_f32 v[40:41], v[40:41], v[66:67]
    v_pk_add_f32 v[42:43], v[42:43], v[82:83]
    v_pk_add_f32 v[40:41], v[40:41], v[68:69]
    v_pk_add_f32 v[42:43], v[42:43], v[84:85]
    v_pk_add_f32 v[40:41], v[40:41], v[70:71]
    v_pk_add_f32 v[42:43], v[42:43], v[86:87]
    v_pk_add_f32 v[40:41], v[40:41], v[72:73]
    v_pk_add_f32 v[42:43], v[42:43], v[88:89]
    v_pk_add_f32 v[40:41], v[40:41], v[74:75]
    v_pk_add_f32 v[42:43], v[42:43], v[90:91]
    v_add_f32 v40, v40, v41
    v_add_f32 v42, v42, v43
    s_nop 1
    v_permlane32_swap_b32 v40, v42
    v_add_f32 v40, v40, v42
    v_rcp_f32 v40, v40
    s_nop 0
    v_mov_b32 v42, v40
    s_nop 1
    v_permlane32_swap_b32 v40, v42
    v_pk_mul_f32 v[60:61], v[60:61], v[40:41] op_sel_hi:[1,0]
    v_pk_mul_f32 v[62:63], v[62:63], v[40:41] op_sel_hi:[1,0]
    v_pk_mul_f32 v[64:65], v[64:65], v[40:41] op_sel_hi:[1,0]
    v_pk_mul_f32 v[66:67], v[66:67], v[40:41] op_sel_hi:[1,0]
    v_cvt_pk_bf16_f32 v176, v60, v61
    v_cvt_pk_bf16_f32 v177, v62, v63
    v_cvt_pk_bf16_f32 v178, v64, v65
    v_cvt_pk_bf16_f32 v179, v66, v67
    ds_write_b128 v112, v[176:179] offset:4096
    v_pk_mul_f32 v[68:69], v[68:69], v[40:41] op_sel_hi:[1,0]
    v_pk_mul_f32 v[70:71], v[70:71], v[40:41] op_sel_hi:[1,0]
    v_pk_mul_f32 v[72:73], v[72:73], v[40:41] op_sel_hi:[1,0]
    v_pk_mul_f32 v[74:75], v[74:75], v[40:41] op_sel_hi:[1,0]
    v_cvt_pk_bf16_f32 v182, v68, v69
    v_cvt_pk_bf16_f32 v183, v70, v71
    v_cvt_pk_bf16_f32 v180, v72, v73
    v_cvt_pk_bf16_f32 v181, v74, v75
    ds_write_b128 v113, v[180:183] offset:4096
    v_pk_mul_f32 v[76:77], v[76:77], v[42:43] op_sel_hi:[1,0]
    v_pk_mul_f32 v[78:79], v[78:79], v[42:43] op_sel_hi:[1,0]
    v_pk_mul_f32 v[80:81], v[80:81], v[42:43] op_sel_hi:[1,0]
    v_pk_mul_f32 v[82:83], v[82:83], v[42:43] op_sel_hi:[1,0]
    v_cvt_pk_bf16_f32 v184, v76, v77
    v_cvt_pk_bf16_f32 v185, v78, v79
    v_cvt_pk_bf16_f32 v186, v80, v81
    v_cvt_pk_bf16_f32 v187, v82, v83
    ds_write_b128 v114, v[184:187] offset:4096
    v_pk_mul_f32 v[84:85], v[84:85], v[42:43] op_sel_hi:[1,0]
    v_pk_mul_f32 v[86:87], v[86:87], v[42:43] op_sel_hi:[1,0]
    v_pk_mul_f32 v[88:89], v[88:89], v[42:43] op_sel_hi:[1,0]
    v_pk_mul_f32 v[90:91], v[90:91], v[42:43] op_sel_hi:[1,0]
    v_cvt_pk_bf16_f32 v190, v84, v85
    v_cvt_pk_bf16_f32 v191, v86, v87
    v_cvt_pk_bf16_f32 v188, v88, v89
    v_cvt_pk_bf16_f32 v189, v90, v91
    ds_write_b128 v115, v[188:191] offset:4096
    s_waitcnt lgkmcnt(0)
    s_barrier
    s_setprio 0
    s_nop 0
    v_mfma_f32_16x16x16_bf16 v[128:131], v[16:17], v[104:105], v[128:131]
    v_mfma_f32_16x16x16_bf16 v[144:147], v[18:19], v[104:105], v[144:147]
    v_mfma_f32_16x16x16_bf16 v[132:135], v[16:17], v[106:107], v[132:135]
    v_mfma_f32_16x16x16_bf16 v[148:151], v[18:19], v[106:107], v[148:151]
    v_mfma_f32_16x16x16_bf16 v[136:139], v[16:17], v[108:109], v[136:139]
    v_mfma_f32_16x16x16_bf16 v[152:155], v[18:19], v[108:109], v[152:155]
    v_mfma_f32_16x16x16_bf16 v[140:143], v[16:17], v[110:111], v[140:143]
    v_mfma_f32_16x16x16_bf16 v[156:159], v[18:19], v[110:111], v[156:159]
    v_lshrrev_b32 v11, 5, v2
    s_lshl_b32 s78, s81, 7
    s_add_u32 s78, s78, 162944
    v_lshl_add_u32 v10, v11, 4, s78
    v_and_b32 v13, 1, v2
    v_cmp_eq_u32 vcc, 1, v13
    v_mov_b32 v13, 162816
    v_and_b32 v12, 31, v2
    v_cndmask_b32 v10, v10, v13, vcc
    v_lshlrev_b32_e64 v12, 4, v12
    v_lshl_add_u32 v11, v11, 10, v12
    v_lshlrev_b32_e64 v14, 4, v2
    v_cvt_pk_bf16_f32 v128, v128, v129
    v_cvt_pk_bf16_f32 v129, v130, v131
    v_cvt_pk_bf16_f32 v130, v144, v145
    v_cvt_pk_bf16_f32 v131, v146, v147
    v_cvt_pk_bf16_f32 v132, v132, v133
    v_cvt_pk_bf16_f32 v133, v134, v135
    v_cvt_pk_bf16_f32 v134, v148, v149
    v_cvt_pk_bf16_f32 v135, v150, v151
    v_cvt_pk_bf16_f32 v136, v136, v137
    v_cvt_pk_bf16_f32 v137, v138, v139
    v_cvt_pk_bf16_f32 v138, v152, v153
    v_cvt_pk_bf16_f32 v139, v154, v155
    v_cvt_pk_bf16_f32 v140, v140, v141
    v_cvt_pk_bf16_f32 v141, v142, v143
    v_cvt_pk_bf16_f32 v142, v156, v157
    v_cvt_pk_bf16_f32 v143, v158, v159
    v_permlane16_swap_b32 v128, v132
    v_permlane16_swap_b32 v129, v133
    v_permlane16_swap_b32 v130, v134
    v_permlane16_swap_b32 v131, v135
    v_permlane16_swap_b32 v136, v140
    v_permlane16_swap_b32 v137, v141
    v_permlane16_swap_b32 v138, v142
    v_permlane16_swap_b32 v139, v143
    v_mfma_f32_32x32x16_bf16 v[224:239], v[96:99], v[128:131], 0
    v_mfma_f32_32x32x16_bf16 v[224:239], v[100:103], v[132:135], v[224:239]
    v_mfma_f32_32x32x16_bf16 v[240:255], v[96:99], v[136:139], 0
    v_mfma_f32_32x32x16_bf16 v[240:255], v[100:103], v[140:143], v[240:255]
    s_lshl_b32 s94, s70, 14
    s_lshl_b32 s79, s81, 13
    s_add_u32 s94, s94, s79
    s_add_u32 s94, s94, 8388608
    s_add_u32 s95, s94, 4096
    s_lshl_b32 s78, s69, 1
    s_add_u32 s78, s78, s80
    s_lshl_b32 s78, s78, 6
    s_lshl_b32 s79, s70, 1
    s_add_u32 s78, s78, s79
    s_add_u32 s78, s78, s81
    s_lshl_b32 s78, s78, 11
    s_add_u32 s96, s78, 4194304
    s_add_u32 s97, s96, 65536
    v_max3_f32 v36, v224, v225, v226
    v_max3_f32 v38, -v224, -v225, -v226
    v_max3_f32 v36, v36, v227, v228
    v_max3_f32 v38, v38, -v227, -v228
    v_max3_f32 v36, v36, v229, v230
    v_max3_f32 v38, v38, -v229, -v230
    v_max3_f32 v36, v36, v231, v232
    v_max3_f32 v38, v38, -v231, -v232
    v_max3_f32 v36, v36, v233, v234
    v_max3_f32 v38, v38, -v233, -v234
    v_max3_f32 v36, v36, v235, v236
    v_max3_f32 v38, v38, -v235, -v236
    v_max3_f32 v36, v36, v237, v238
    v_max3_f32 v38, v38, -v237, -v238
    v_max_f32_e64 v36, v36, v239
    v_max_f32 v38, v38, -v239
    v_max3_f32 v37, v240, v241, v242
    v_max3_f32 v39, -v240, -v241, -v242
    v_max3_f32 v37, v37, v243, v244
    v_max3_f32 v39, v39, -v243, -v244
    v_max3_f32 v37, v37, v245, v246
    v_max3_f32 v39, v39, -v245, -v246
    v_max3_f32 v37, v37, v247, v248
    v_max3_f32 v39, v39, -v247, -v248
    v_max3_f32 v37, v37, v249, v250
    v_max3_f32 v39, v39, -v249, -v250
    v_max3_f32 v37, v37, v251, v252
    v_max3_f32 v39, v39, -v251, -v252
    v_max3_f32 v37, v37, v253, v254
    v_max3_f32 v39, v39, -v253, -v254
    v_max_f32_e64 v37, v37, v255
    v_max_f32 v39, v39, -v255
    v_permlane32_swap_b32 v36, v38
    s_nop 0
    v_permlane32_swap_b32 v37, v39
    v_max_f32 v36, v36, v38
    v_max_f32_e64 v37, v37, v39
    v_mul_f32 v36, -v36, v34
    v_mul_f32 v37, -v37, v48
    v_mov_b32 v38, v36
    v_mov_b32 v39, v37
    s_nop 0
    v_permlane32_swap_b32 v36, v38
    v_permlane32_swap_b32_e64 v37, v39
    v_pk_fma_f32 v[60:61], v[224:225], v[34:35], v[36:37] op_sel_hi:[1,0,0]
    v_pk_fma_f32 v[62:63], v[226:227], v[34:35], v[36:37] op_sel_hi:[1,0,0]
    v_pk_fma_f32 v[64:65], v[228:229], v[34:35], v[36:37] op_sel_hi:[1,0,0]
    v_pk_fma_f32 v[66:67], v[230:231], v[34:35], v[36:37] op_sel_hi:[1,0,0]
    v_pk_fma_f32 v[68:69], v[232:233], v[34:35], v[36:37] op_sel_hi:[1,0,0]
    v_pk_fma_f32 v[70:71], v[234:235], v[34:35], v[36:37] op_sel_hi:[1,0,0]
    v_pk_fma_f32 v[72:73], v[236:237], v[34:35], v[36:37] op_sel_hi:[1,0,0]
    v_pk_fma_f32 v[74:75], v[238:239], v[34:35], v[36:37] op_sel_hi:[1,0,0]
    v_pk_fma_f32 v[76:77], v[224:225], v[34:35], v[38:39] op_sel_hi:[1,0,0] neg_lo:[1,0,0] neg_hi:[1,0,0]
    v_pk_fma_f32 v[78:79], v[226:227], v[34:35], v[38:39] op_sel_hi:[1,0,0] neg_lo:[1,0,0] neg_hi:[1,0,0]
    v_pk_fma_f32 v[80:81], v[228:229], v[34:35], v[38:39] op_sel_hi:[1,0,0] neg_lo:[1,0,0] neg_hi:[1,0,0]
    v_pk_fma_f32 v[82:83], v[230:231], v[34:35], v[38:39] op_sel_hi:[1,0,0] neg_lo:[1,0,0] neg_hi:[1,0,0]
    v_pk_fma_f32 v[84:85], v[232:233], v[34:35], v[38:39] op_sel_hi:[1,0,0] neg_lo:[1,0,0] neg_hi:[1,0,0]
    v_pk_fma_f32 v[86:87], v[234:235], v[34:35], v[38:39] op_sel_hi:[1,0,0] neg_lo:[1,0,0] neg_hi:[1,0,0]
    v_pk_fma_f32 v[88:89], v[236:237], v[34:35], v[38:39] op_sel_hi:[1,0,0] neg_lo:[1,0,0] neg_hi:[1,0,0]
    v_pk_fma_f32 v[90:91], v[238:239], v[34:35], v[38:39] op_sel_hi:[1,0,0] neg_lo:[1,0,0] neg_hi:[1,0,0]
    v_exp_f32 v60, v60
    v_exp_f32 v61, v61
    v_exp_f32 v62, v62
    v_exp_f32 v63, v63
    v_exp_f32 v64, v64
    v_exp_f32 v65, v65
    v_exp_f32 v66, v66
    v_exp_f32 v67, v67
    v_exp_f32 v68, v68
    v_exp_f32 v69, v69
    v_exp_f32 v70, v70
    v_exp_f32 v71, v71
    v_exp_f32 v72, v72
    v_exp_f32 v73, v73
    v_exp_f32 v74, v74
    v_exp_f32 v75, v75
    v_exp_f32 v76, v76
    v_exp_f32 v77, v77
    v_exp_f32 v78, v78
    v_exp_f32 v79, v79
    v_exp_f32 v80, v80
    v_exp_f32 v81, v81
    v_exp_f32 v82, v82
    v_exp_f32 v83, v83
    v_exp_f32 v84, v84
    v_exp_f32 v85, v85
    v_exp_f32 v86, v86
    v_exp_f32 v87, v87
    v_exp_f32 v88, v88
    v_exp_f32 v89, v89
    v_exp_f32 v90, v90
    v_exp_f32 v91, v91
    v_cvt_pk_bf16_f32 v160, v60, v61
    v_cvt_pk_bf16_f32 v161, v62, v63
    v_cvt_pk_bf16_f32 v162, v64, v65
    v_cvt_pk_bf16_f32 v163, v66, v67
    v_cvt_pk_bf16_f32 v164, v68, v69
    v_cvt_pk_bf16_f32 v165, v70, v71
    v_cvt_pk_bf16_f32 v166, v72, v73
    v_cvt_pk_bf16_f32 v167, v74, v75
    v_cvt_pk_bf16_f32 v168, v76, v77
    v_cvt_pk_bf16_f32 v169, v78, v79
    v_cvt_pk_bf16_f32 v170, v80, v81
    v_cvt_pk_bf16_f32 v171, v82, v83
    v_cvt_pk_bf16_f32 v172, v84, v85
    v_cvt_pk_bf16_f32 v173, v86, v87
    v_cvt_pk_bf16_f32 v174, v88, v89
    v_cvt_pk_bf16_f32 v175, v90, v91
    v_pk_fma_f32 v[60:61], v[240:241], v[48:49], v[36:37] op_sel:[0,0,1] op_sel_hi:[1,0,1]
    v_pk_fma_f32 v[62:63], v[242:243], v[48:49], v[36:37] op_sel:[0,0,1] op_sel_hi:[1,0,1]
    v_pk_fma_f32 v[64:65], v[244:245], v[48:49], v[36:37] op_sel:[0,0,1] op_sel_hi:[1,0,1]
    v_pk_fma_f32 v[66:67], v[246:247], v[48:49], v[36:37] op_sel:[0,0,1] op_sel_hi:[1,0,1]
    v_pk_fma_f32 v[68:69], v[248:249], v[48:49], v[36:37] op_sel:[0,0,1] op_sel_hi:[1,0,1]
    v_pk_fma_f32 v[70:71], v[250:251], v[48:49], v[36:37] op_sel:[0,0,1] op_sel_hi:[1,0,1]
    v_pk_fma_f32 v[72:73], v[252:253], v[48:49], v[36:37] op_sel:[0,0,1] op_sel_hi:[1,0,1]
    v_pk_fma_f32 v[74:75], v[254:255], v[48:49], v[36:37] op_sel:[0,0,1] op_sel_hi:[1,0,1]
    v_pk_fma_f32 v[76:77], v[240:241], v[48:49], v[38:39] op_sel:[0,0,1] op_sel_hi:[1,0,1] neg_lo:[1,0,0] neg_hi:[1,0,0]
    v_pk_fma_f32 v[78:79], v[242:243], v[48:49], v[38:39] op_sel:[0,0,1] op_sel_hi:[1,0,1] neg_lo:[1,0,0] neg_hi:[1,0,0]
    v_pk_fma_f32 v[80:81], v[244:245], v[48:49], v[38:39] op_sel:[0,0,1] op_sel_hi:[1,0,1] neg_lo:[1,0,0] neg_hi:[1,0,0]
    v_pk_fma_f32 v[82:83], v[246:247], v[48:49], v[38:39] op_sel:[0,0,1] op_sel_hi:[1,0,1] neg_lo:[1,0,0] neg_hi:[1,0,0]
    v_pk_fma_f32 v[84:85], v[248:249], v[48:49], v[38:39] op_sel:[0,0,1] op_sel_hi:[1,0,1] neg_lo:[1,0,0] neg_hi:[1,0,0]
    v_pk_fma_f32 v[86:87], v[250:251], v[48:49], v[38:39] op_sel:[0,0,1] op_sel_hi:[1,0,1] neg_lo:[1,0,0] neg_hi:[1,0,0]
    v_pk_fma_f32 v[88:89], v[252:253], v[48:49], v[38:39] op_sel:[0,0,1] op_sel_hi:[1,0,1] neg_lo:[1,0,0] neg_hi:[1,0,0]
    v_pk_fma_f32 v[90:91], v[254:255], v[48:49], v[38:39] op_sel:[0,0,1] op_sel_hi:[1,0,1] neg_lo:[1,0,0] neg_hi:[1,0,0]
    v_exp_f32 v60, v60
    v_exp_f32 v61, v61
    v_exp_f32 v62, v62
    v_exp_f32 v63, v63
    v_exp_f32 v64, v64
    v_exp_f32 v65, v65
    v_exp_f32 v66, v66
    v_exp_f32 v67, v67
    v_exp_f32 v68, v68
    v_exp_f32 v69, v69
    v_exp_f32 v70, v70
    v_exp_f32 v71, v71
    v_exp_f32 v72, v72
    v_exp_f32 v73, v73
    v_exp_f32 v74, v74
    v_exp_f32 v75, v75
    v_exp_f32 v76, v76
    v_exp_f32 v77, v77
    v_exp_f32 v78, v78
    v_exp_f32 v79, v79
    v_exp_f32 v80, v80
    v_exp_f32 v81, v81
    v_exp_f32 v82, v82
    v_exp_f32 v83, v83
    v_exp_f32 v84, v84
    v_exp_f32 v85, v85
    v_exp_f32 v86, v86
    v_exp_f32 v87, v87
    v_exp_f32 v88, v88
    v_exp_f32 v89, v89
    v_exp_f32 v90, v90
    v_exp_f32 v91, v91
    v_cvt_pk_bf16_f32 v176, v60, v61
    v_cvt_pk_bf16_f32 v177, v62, v63
    v_cvt_pk_bf16_f32 v178, v64, v65
    v_cvt_pk_bf16_f32 v179, v66, v67
    v_cvt_pk_bf16_f32 v180, v68, v69
    v_cvt_pk_bf16_f32 v181, v70, v71
    v_cvt_pk_bf16_f32 v182, v72, v73
    v_cvt_pk_bf16_f32 v183, v74, v75
    v_cvt_pk_bf16_f32 v184, v76, v77
    v_cvt_pk_bf16_f32 v185, v78, v79
    v_cvt_pk_bf16_f32 v186, v80, v81
    v_cvt_pk_bf16_f32 v187, v82, v83
    v_cvt_pk_bf16_f32 v188, v84, v85
    v_cvt_pk_bf16_f32 v189, v86, v87
    v_cvt_pk_bf16_f32 v190, v88, v89
    v_cvt_pk_bf16_f32 v191, v90, v91
    s_barrier
    s_setprio 1
    ds_read_b128 v[16:19], v10 offset:0
    ds_read_b128 v[20:23], v10 offset:32
    ds_read_b128 v[24:27], v10 offset:64
    ds_read_b128 v[28:31], v10 offset:96
    s_waitcnt lgkmcnt(3)
    v_mfma_f32_32x32x16_bf16 v[224:239], v[16:19], v[160:163], 0
    buffer_load_dwordx4 v[96:99], v11, s[36:39], s94 offen offset:0 sc1
    buffer_load_dwordx4 v[100:103], v11, s[36:39], s94 offen offset:2048 sc1
    buffer_load_dwordx4 v[104:107], v11, s[36:39], s95 offen offset:0 sc1
    buffer_load_dwordx4 v[108:111], v11, s[36:39], s95 offen offset:2048 sc1
    s_waitcnt lgkmcnt(2)
    v_mfma_f32_32x32x16_bf16 v[224:239], v[20:23], v[164:167], v[224:239]
    s_waitcnt lgkmcnt(1)
    v_mfma_f32_32x32x16_bf16 v[240:255], v[24:27], v[168:171], 0
    s_waitcnt lgkmcnt(0)
    v_mfma_f32_32x32x16_bf16 v[240:255], v[28:31], v[172:175], v[240:255]
    v_mfma_f32_32x32x16_bf16 v[192:207], v[16:19], v[176:179], 0
    v_mfma_f32_32x32x16_bf16 v[192:207], v[20:23], v[180:183], v[192:207]
    v_mfma_f32_32x32x16_bf16 v[208:223], v[24:27], v[184:187], 0
    v_mfma_f32_32x32x16_bf16 v[208:223], v[28:31], v[188:191], v[208:223]
    s_mov_b32 s85, 0
    s_branch L_kvchk
L_kvspin:
    s_add_u32 s85, s85, 1
    s_cmp_gt_u32 s85, 400000
    s_cbranch_scc1 L_end
    buffer_load_dwordx4 v[96:99], v11, s[36:39], s94 offen offset:0 sc1
    buffer_load_dwordx4 v[100:103], v11, s[36:39], s94 offen offset:2048 sc1
    buffer_load_dwordx4 v[104:107], v11, s[36:39], s95 offen offset:0 sc1
    buffer_load_dwordx4 v[108:111], v11, s[36:39], s95 offen offset:2048 sc1
L_kvchk:
    s_waitcnt vmcnt(0)
    s_nop 0
    v_mfma_f32_32x32x16_bf16 v[60:75], v[96:99], v[160:163], 0
    v_max3_u32 v13, v96, v97, v98
    v_max3_u32 v10, v99, v100, v101
    v_max3_u32 v13, v13, v102, v103
    v_max3_u32 v10, v10, v104, v105
    v_max3_u32 v13, v13, v106, v107
    v_mfma_f32_32x32x16_bf16 v[60:75], v[100:103], v[164:167], v[60:75]
    v_max3_u32 v10, v10, v108, v109
    v_max3_u32 v13, v13, v110, v111
    v_max_u32 v13, v13, v10
    v_cmp_eq_u32_e64 vcc, -1, v13
    s_cbranch_vccnz L_kvspin
    v_mfma_f32_32x32x16_bf16 v[76:91], v[104:107], v[168:171], 0
    v_rcp_f32 v36, v225
    v_rcp_f32 v40, v193
    v_rcp_f32 v38, v241
    v_rcp_f32 v42, v209
    v_mfma_f32_32x32x16_bf16 v[76:91], v[108:111], v[172:175], v[76:91]
    v_mov_b32 v44, 0x358637bd
    v_mov_b32 v45, 0x358637bd
    v_fmac_f32 v44, v224, v36
    v_fmac_f32 v45, v192, v40
    v_fmac_f32 v44, v240, v38
    v_fmac_f32 v45, v208, v42
    v_mfma_f32_32x32x16_bf16 v[128:143], v[96:99], v[176:179], 0
    v_rcp_f32 v44, v44
    v_rcp_f32 v45, v45
    v_mul_f32 v36, v36, v44
    v_mul_f32 v40, v40, v45
    v_mfma_f32_32x32x16_bf16 v[128:143], v[100:103], v[180:183], v[128:143]
    v_mul_f32 v38, v38, v44
    v_mul_f32 v42, v42, v45
    v_mul_f32 v60, v60, v36
    v_mul_f32 v61, v61, v36
    v_mul_f32 v62, v62, v36
    v_mul_f32 v63, v63, v36
    v_mfma_f32_32x32x16_bf16 v[144:159], v[104:107], v[184:187], 0
    v_mul_f32 v64, v64, v36
    v_mul_f32 v65, v65, v36
    v_mul_f32 v66, v66, v36
    v_mul_f32 v67, v67, v36
    v_mul_f32 v68, v68, v36
    v_mul_f32 v69, v69, v36
    v_mfma_f32_32x32x16_bf16 v[144:159], v[108:111], v[188:191], v[144:159]
    v_mul_f32 v70, v70, v36
    v_mul_f32 v71, v71, v36
    v_mul_f32 v72, v72, v36
    v_mul_f32 v73, v73, v36
    v_mul_f32 v74, v74, v36
    v_mul_f32 v75, v75, v36
    v_pk_fma_f32 v[60:61], v[76:77], v[38:39], v[60:61] op_sel_hi:[1,0,1]
    v_pk_fma_f32 v[62:63], v[78:79], v[38:39], v[62:63] op_sel_hi:[1,0,1]
    v_pk_fma_f32 v[64:65], v[80:81], v[38:39], v[64:65] op_sel_hi:[1,0,1]
    v_pk_fma_f32 v[66:67], v[82:83], v[38:39], v[66:67] op_sel_hi:[1,0,1]
    v_cvt_pk_bf16_f32 v16, v60, v61
    v_cvt_pk_bf16_f32 v17, v62, v63
    v_cvt_pk_bf16_f32 v18, v64, v65
    v_cvt_pk_bf16_f32 v19, v66, v67
    buffer_store_dwordx4 v[16:19], v14, s[36:39], s96 offen offset:0 sc1
    v_pk_fma_f32 v[68:69], v[84:85], v[38:39], v[68:69] op_sel_hi:[1,0,1]
    v_pk_fma_f32 v[70:71], v[86:87], v[38:39], v[70:71] op_sel_hi:[1,0,1]
    v_pk_fma_f32 v[72:73], v[88:89], v[38:39], v[72:73] op_sel_hi:[1,0,1]
    v_pk_fma_f32 v[74:75], v[90:91], v[38:39], v[74:75] op_sel_hi:[1,0,1]
    v_cvt_pk_bf16_f32 v20, v68, v69
    v_cvt_pk_bf16_f32 v21, v70, v71
    v_cvt_pk_bf16_f32 v22, v72, v73
    v_cvt_pk_bf16_f32 v23, v74, v75
    buffer_store_dwordx4 v[20:23], v14, s[36:39], s96 offen offset:1024 sc1
    v_pk_mul_f32 v[128:129], v[128:129], v[40:41] op_sel_hi:[1,0]
    v_pk_mul_f32 v[130:131], v[130:131], v[40:41] op_sel_hi:[1,0]
    v_pk_mul_f32 v[132:133], v[132:133], v[40:41] op_sel_hi:[1,0]
    v_pk_mul_f32 v[134:135], v[134:135], v[40:41] op_sel_hi:[1,0]
    v_pk_fma_f32 v[128:129], v[144:145], v[42:43], v[128:129] op_sel_hi:[1,0,1]
    v_pk_fma_f32 v[130:131], v[146:147], v[42:43], v[130:131] op_sel_hi:[1,0,1]
    v_pk_fma_f32 v[132:133], v[148:149], v[42:43], v[132:133] op_sel_hi:[1,0,1]
    v_pk_fma_f32 v[134:135], v[150:151], v[42:43], v[134:135] op_sel_hi:[1,0,1]
    v_cvt_pk_bf16_f32 v24, v128, v129
    v_cvt_pk_bf16_f32 v25, v130, v131
    v_cvt_pk_bf16_f32 v26, v132, v133
    v_cvt_pk_bf16_f32 v27, v134, v135
    buffer_store_dwordx4 v[24:27], v14, s[36:39], s97 offen offset:0 sc1
    v_pk_mul_f32 v[136:137], v[136:137], v[40:41] op_sel_hi:[1,0]
    v_pk_mul_f32 v[138:139], v[138:139], v[40:41] op_sel_hi:[1,0]
    v_pk_mul_f32 v[140:141], v[140:141], v[40:41] op_sel_hi:[1,0]
    v_pk_mul_f32 v[142:143], v[142:143], v[40:41] op_sel_hi:[1,0]
    v_pk_fma_f32 v[136:137], v[152:153], v[42:43], v[136:137] op_sel_hi:[1,0,1]
    v_pk_fma_f32 v[138:139], v[154:155], v[42:43], v[138:139] op_sel_hi:[1,0,1]
    v_pk_fma_f32 v[140:141], v[156:157], v[42:43], v[140:141] op_sel_hi:[1,0,1]
    v_pk_fma_f32 v[142:143], v[158:159], v[42:43], v[142:143] op_sel_hi:[1,0,1]
    v_cvt_pk_bf16_f32 v28, v136, v137
    v_cvt_pk_bf16_f32 v29, v138, v139
    v_cvt_pk_bf16_f32 v30, v140, v141
    v_cvt_pk_bf16_f32 v31, v142, v143
    buffer_store_dwordx4 v[28:31], v14, s[36:39], s97 offen offset:1024 sc1
    v_and_b32 v8, 31, v2
    v_lshrrev_b32 v9, 5, v2
    v_lshlrev_b32 v10, 3, v9
    s_lshl_b32 s78, s72, 7
    buffer_load_dwordx2 v[32:33], v10, s[64:67], s78 offen offset:0
    buffer_load_dwordx2 v[34:35], v10, s[64:67], s78 offen offset:16
    buffer_load_dwordx2 v[36:37], v10, s[64:67], s78 offen offset:32
    buffer_load_dwordx2 v[38:39], v10, s[64:67], s78 offen offset:48
    buffer_load_dwordx2 v[40:41], v10, s[64:67], s78 offen offset:64
    buffer_load_dwordx2 v[42:43], v10, s[64:67], s78 offen offset:80
    buffer_load_dwordx2 v[44:45], v10, s[64:67], s78 offen offset:96
    buffer_load_dwordx2 v[46:47], v10, s[64:67], s78 offen offset:112
    buffer_load_dwordx4 v[48:51], v14, s[64:67], 0 offen
    buffer_load_dwordx4 v[52:55], v14, s[64:67], 0 offen offset:1024
    s_barrier
    s_lshl_b32 s78, s76, 12
    s_add_u32 s78, s78, 131072
    v_lshl_add_u32 v6, v8, 7, s78
    v_add_u32_e64 v6, v6, v10
    v_bfe_u32 v11, v8, 1, 3
    v_lshl_add_u32 v6, v11, 4, v6
    v_xor_b32_e64 v112, 0, v6
    ds_read_b64 v[96:97], v112
    v_xor_b32_e64 v113, 16, v6
    ds_read_b64 v[98:99], v113
    v_xor_b32_e64 v114, 32, v6
    ds_read_b64 v[100:101], v114
    v_xor_b32_e64 v115, 48, v6
    ds_read_b64 v[102:103], v115
    v_xor_b32_e64 v116, 64, v6
    ds_read_b64 v[104:105], v116
    v_xor_b32 v117, 80, v6
    ds_read_b64 v[106:107], v117
    v_xor_b32 v118, 96, v6
    ds_read_b64 v[108:109], v118
    v_xor_b32 v119, 112, v6
    ds_read_b64 v[110:111], v119
    v_bfe_u32 v11, v2, 2, 2
    v_lshl_add_u32 v12, v9, 2, v11
    v_lshlrev_b32 v12, 7, v12
    v_lshrrev_b32 v11, 1, v11
    v_lshl_add_u32 v12, v11, 6, v12
    v_bfe_u32 v11, v2, 4, 1
    v_lshl_add_u32 v12, v11, 5, v12
    v_and_b32_e64 v11, 3, v2
    v_lshl_add_u32 v12, v11, 3, v12
    s_lshl_b32 s82, s72, 0
    s_and_b32 s82, s82, 15
    s_lshl_b32 s78, s82, 13
    v_add_u32 v4, s78, v12
    v_xor_b32 v5, 64, v4
    s_lshl_b32 s83, s71, 2
    s_add_u32 s83, s83, s76
    s_lshl_b32 s83, s83, 16
    s_add_u32 s83, s83, 4194304
    s_lshl_b32 s82, s82, 12
    s_add_u32 s88, s82, s83
    s_waitcnt lgkmcnt(0)
    v_lshlrev_b32 v224, 16, v96
    v_and_b32 v225, 0xffff0000, v96
    v_lshlrev_b32_e64 v226, 16, v97
    v_and_b32 v227, 0xffff0000, v97
    v_lshlrev_b32_e64 v228, 16, v98
    v_and_b32 v229, 0xffff0000, v98
    v_lshlrev_b32_e64 v230, 16, v99
    v_and_b32 v231, 0xffff0000, v99
    v_lshlrev_b32_e64 v232, 16, v100
    v_and_b32 v233, 0xffff0000, v100
    v_lshlrev_b32_e64 v234, 16, v101
    v_and_b32 v235, 0xffff0000, v101
    v_lshlrev_b32_e64 v236, 16, v102
    v_and_b32 v237, 0xffff0000, v102
    v_lshlrev_b32_e64 v238, 16, v103
    v_and_b32 v239, 0xffff0000, v103
    v_lshlrev_b32_e64 v240, 16, v104
    v_and_b32 v241, 0xffff0000, v104
    v_lshlrev_b32_e64 v242, 16, v105
    v_and_b32 v243, 0xffff0000, v105
    v_lshlrev_b32_e64 v244, 16, v106
    v_and_b32 v245, 0xffff0000, v106
    v_lshlrev_b32_e64 v246, 16, v107
    v_and_b32 v247, 0xffff0000, v107
    v_lshlrev_b32_e64 v248, 16, v108
    v_and_b32 v249, 0xffff0000, v108
    v_lshlrev_b32_e64 v250, 16, v109
    v_and_b32 v251, 0xffff0000, v109
    v_lshlrev_b32_e64 v252, 16, v110
    v_and_b32 v253, 0xffff0000, v110
    v_lshlrev_b32_e64 v254, 16, v111
    v_and_b32 v255, 0xffff0000, v111
    s_waitcnt vmcnt(0)
    s_barrier
    v_lshlrev_b32_e64 v60, 16, v32
    v_and_b32 v61, 0xffff0000, v32
    v_lshlrev_b32_e64 v62, 16, v33
    v_and_b32 v63, 0xffff0000, v33
    v_lshlrev_b32_e64 v64, 16, v34
    v_and_b32 v65, 0xffff0000, v34
    v_lshlrev_b32_e64 v66, 16, v35
    v_and_b32 v67, 0xffff0000, v35
    v_lshlrev_b32_e64 v68, 16, v36
    v_and_b32 v69, 0xffff0000, v36
    v_lshlrev_b32_e64 v70, 16, v37
    v_and_b32 v71, 0xffff0000, v37
    v_lshlrev_b32_e64 v72, 16, v38
    v_and_b32 v73, 0xffff0000, v38
    v_lshlrev_b32_e64 v74, 16, v39
    v_and_b32 v75, 0xffff0000, v39
    v_lshlrev_b32_e64 v76, 16, v40
    v_and_b32 v77, 0xffff0000, v40
    v_lshlrev_b32_e64 v78, 16, v41
    v_and_b32 v79, 0xffff0000, v41
    v_lshlrev_b32_e64 v80, 16, v42
    v_and_b32 v81, 0xffff0000, v42
    v_lshlrev_b32_e64 v82, 16, v43
    v_and_b32 v83, 0xffff0000, v43
    v_lshlrev_b32_e64 v84, 16, v44
    v_and_b32 v85, 0xffff0000, v44
    v_lshlrev_b32_e64 v86, 16, v45
    v_and_b32 v87, 0xffff0000, v45
    v_lshlrev_b32_e64 v88, 16, v46
    v_and_b32 v89, 0xffff0000, v46
    v_lshlrev_b32_e64 v90, 16, v47
    v_and_b32 v91, 0xffff0000, v47
    s_mov_b32 s78, 0x3f803f80
    v_dot2_f32_bf16 v126, v48, s78, 0
    v_dot2_f32_bf16 v126, v49, s78, v126
    v_dot2_f32_bf16 v126, v50, s78, v126
    v_dot2_f32_bf16 v126, v51, s78, v126
    v_dot2_f32_bf16 v126, v52, s78, v126
    v_dot2_f32_bf16 v126, v53, s78, v126
    v_dot2_f32_bf16 v126, v54, s78, v126
    v_dot2_f32_bf16 v126, v55, s78, v126
    s_nop 2
    v_add_f32_dpp v126, v126, v126 row_ror:8 row_mask:0xf bank_mask:0xf
    s_nop 1
    v_add_f32_dpp v126, v126, v126 row_ror:4 row_mask:0xf bank_mask:0xf
    s_nop 1
    v_add_f32_dpp v126, v126, v126 row_ror:2 row_mask:0xf bank_mask:0xf
    s_nop 1
    v_add_f32_dpp v126, v126, v126 row_ror:1 row_mask:0xf bank_mask:0xf
    v_mov_b32 v127, v126
    s_nop 1
    v_permlane32_swap_b32 v126, v127
    v_add_f32 v126, v126, v127
    v_mov_b32 v127, v126
    s_nop 1
    v_permlane16_swap_b32 v126, v127
    v_add_f32 v126, v126, v127
    v_lshlrev_b32_e64 v12, 4, v8
    v_lshl_add_u32 v12, v9, 14, v12
    s_lshl_b32 s94, s71, 15
    s_lshl_b32 s79, s76, 9
    s_add_u32 s94, s94, s79
    s_add_u32 s94, s94, 1572864
    s_lshl_b32 s95, s72, 11
    s_add_u32 s95, s95, s94
    s_lshl_b32 s78, s76, 5
    v_add_u32 v11, s78, v8
    v_and_b32 v13, 7, v8
    v_xor_b32 v13, v13, v9
    v_lshlrev_b32 v13, 4, v13
    v_lshl_add_u32 v13, v11, 8, v13
    v_lshlrev_b32_e64 v10, 3, v11
    v_add_u32 v10, 159744, v10
    s_lshl_b32 s78, s71, 7
    v_add_u32 v11, s78, v11
    v_mov_b32 v15, 163584
    ds_read_b32 v15, v15
    s_waitcnt lgkmcnt(0)
    v_readfirstlane_b32 s99, v15
    s_mov_b32 s84, 0
    s_barrier
    buffer_load_dwordx4 v[160:163], v14, s[36:39], s88 offen offset:0 sc1
    ds_read_b64_tr_b16 v[128:129], v4 offset:0
    buffer_load_dwordx4 v[164:167], v14, s[36:39], s88 offen offset:1024 sc1
    ds_read_b64_tr_b16 v[130:131], v4 offset:1024
    buffer_load_dwordx4 v[168:171], v14, s[36:39], s88 offen offset:2048 sc1
    ds_read_b64_tr_b16 v[132:133], v5 offset:0
    buffer_load_dwordx4 v[172:175], v14, s[36:39], s88 offen offset:3072 sc1
    s_add_u32 s82, s82, 4096
    s_and_b32 s82, s82, 0xffff
    s_add_u32 s88, s82, s83
    s_nop 0
    ds_read_b64_tr_b16 v[134:135], v5 offset:1024
    buffer_load_dwordx4 v[176:179], v14, s[36:39], s88 offen offset:0 sc1
    ds_read_b64_tr_b16 v[136:137], v4 offset:2048
    buffer_load_dwordx4 v[180:183], v14, s[36:39], s88 offen offset:1024 sc1
    ds_read_b64_tr_b16 v[138:139], v4 offset:3072
    buffer_load_dwordx4 v[184:187], v14, s[36:39], s88 offen offset:2048 sc1
    ds_read_b64_tr_b16 v[140:141], v5 offset:2048
    buffer_load_dwordx4 v[188:191], v14, s[36:39], s88 offen offset:3072 sc1
    s_add_u32 s82, s82, 4096
    s_and_b32 s82, s82, 0xffff
    s_add_u32 s88, s82, s83
    s_nop 0
    ds_read_b64_tr_b16 v[142:143], v5 offset:3072
    buffer_load_dwordx4 v[192:195], v14, s[36:39], s88 offen offset:0 sc1
    buffer_load_dwordx4 v[196:199], v14, s[36:39], s88 offen offset:1024 sc1
    buffer_load_dwordx4 v[200:203], v14, s[36:39], s88 offen offset:2048 sc1
    buffer_load_dwordx4 v[204:207], v14, s[36:39], s88 offen offset:3072 sc1
    s_add_u32 s82, s82, 4096
    s_and_b32 s82, s82, 0xffff
    s_add_u32 s88, s82, s83
    buffer_load_dwordx4 v[208:211], v14, s[36:39], s88 offen offset:0 sc1
    buffer_load_dwordx4 v[212:215], v14, s[36:39], s88 offen offset:1024 sc1
    .p2align 3
L_G2:
    s_add_u32 s84, s84, 1
    s_waitcnt vmcnt(12) lgkmcnt(6)
    v_mfma_f32_32x32x16_bf16 v[224:239], v[128:131], v[160:163], v[224:239]
    ds_read_b64_tr_b16 v[144:145], v4 offset:4096
    ds_read_b64_tr_b16 v[146:147], v4 offset:5120
    buffer_load_dwordx4 v[216:219], v14, s[36:39], s88 offen offset:2048 sc1
    s_waitcnt lgkmcnt(6)
    v_mfma_f32_32x32x16_bf16 v[240:255], v[132:135], v[160:163], v[240:255]
    ds_read_b64_tr_b16 v[148:149], v5 offset:4096
    ds_read_b64_tr_b16 v[150:151], v5 offset:5120
    s_waitcnt lgkmcnt(6)
    v_mfma_f32_32x32x16_bf16 v[224:239], v[136:139], v[164:167], v[224:239]
    ds_read_b64_tr_b16 v[152:153], v4 offset:6144
    ds_read_b64_tr_b16 v[154:155], v4 offset:7168
    buffer_load_dwordx4 v[220:223], v14, s[36:39], s88 offen offset:3072 sc1
    s_add_u32 s82, s82, 4096
    s_and_b32 s82, s82, 0xffff
    s_add_u32 s88, s82, s83
    s_waitcnt lgkmcnt(6)
    v_mfma_f32_32x32x16_bf16 v[240:255], v[140:143], v[164:167], v[240:255]
    ds_read_b64_tr_b16 v[156:157], v5 offset:6144
    ds_read_b64_tr_b16 v[158:159], v5 offset:7168
    v_add_u32 v4, 0x2000, v4
    v_and_b32 v4, 0x1ffff, v4
    v_xor_b32 v5, 64, v4
    s_waitcnt vmcnt(12) lgkmcnt(6)
    v_mfma_f32_32x32x16_bf16 v[224:239], v[144:147], v[168:171], v[224:239]
    ds_read_b64_tr_b16 v[128:129], v4 offset:0
    ds_read_b64_tr_b16 v[130:131], v4 offset:1024
    buffer_load_dwordx4 v[160:163], v14, s[36:39], s88 offen offset:0 sc1
    s_waitcnt lgkmcnt(6)
    v_mfma_f32_32x32x16_bf16 v[240:255], v[148:151], v[168:171], v[240:255]
    ds_read_b64_tr_b16 v[132:133], v5 offset:0
    ds_read_b64_tr_b16 v[134:135], v5 offset:1024
    s_waitcnt lgkmcnt(6)
    v_mfma_f32_32x32x16_bf16 v[224:239], v[152:155], v[172:175], v[224:239]
    ds_read_b64_tr_b16 v[136:137], v4 offset:2048
    ds_read_b64_tr_b16 v[138:139], v4 offset:3072
    buffer_load_dwordx4 v[164:167], v14, s[36:39], s88 offen offset:1024 sc1
    s_waitcnt lgkmcnt(6)
    v_mfma_f32_32x32x16_bf16 v[240:255], v[156:159], v[172:175], v[240:255]
    ds_read_b64_tr_b16 v[140:141], v5 offset:2048
    ds_read_b64_tr_b16 v[142:143], v5 offset:3072
    s_waitcnt vmcnt(12) lgkmcnt(6)
    v_mfma_f32_32x32x16_bf16 v[224:239], v[128:131], v[176:179], v[224:239]
    ds_read_b64_tr_b16 v[144:145], v4 offset:4096
    ds_read_b64_tr_b16 v[146:147], v4 offset:5120
    buffer_load_dwordx4 v[168:171], v14, s[36:39], s88 offen offset:2048 sc1
    s_waitcnt lgkmcnt(6)
    v_mfma_f32_32x32x16_bf16 v[240:255], v[132:135], v[176:179], v[240:255]
    ds_read_b64_tr_b16 v[148:149], v5 offset:4096
    ds_read_b64_tr_b16 v[150:151], v5 offset:5120
    s_waitcnt lgkmcnt(6)
    v_mfma_f32_32x32x16_bf16 v[224:239], v[136:139], v[180:183], v[224:239]
    ds_read_b64_tr_b16 v[152:153], v4 offset:6144
    ds_read_b64_tr_b16 v[154:155], v4 offset:7168
    buffer_load_dwordx4 v[172:175], v14, s[36:39], s88 offen offset:3072 sc1
    s_add_u32 s82, s82, 4096
    s_and_b32 s82, s82, 0xffff
    s_add_u32 s88, s82, s83
    s_waitcnt lgkmcnt(6)
    v_mfma_f32_32x32x16_bf16 v[240:255], v[140:143], v[180:183], v[240:255]
    ds_read_b64_tr_b16 v[156:157], v5 offset:6144
    ds_read_b64_tr_b16 v[158:159], v5 offset:7168
    v_add_u32 v4, 0x2000, v4
    v_and_b32 v4, 0x1ffff, v4
    v_xor_b32 v5, 64, v4
    s_waitcnt vmcnt(12) lgkmcnt(6)
    v_mfma_f32_32x32x16_bf16 v[224:239], v[144:147], v[184:187], v[224:239]
    ds_read_b64_tr_b16 v[128:129], v4 offset:0
    ds_read_b64_tr_b16 v[130:131], v4 offset:1024
    buffer_load_dwordx4 v[176:179], v14, s[36:39], s88 offen offset:0 sc1
    s_waitcnt lgkmcnt(6)
    v_mfma_f32_32x32x16_bf16 v[240:255], v[148:151], v[184:187], v[240:255]
    ds_read_b64_tr_b16 v[132:133], v5 offset:0
    ds_read_b64_tr_b16 v[134:135], v5 offset:1024
    s_waitcnt lgkmcnt(6)
    v_mfma_f32_32x32x16_bf16 v[224:239], v[152:155], v[188:191], v[224:239]
    ds_read_b64_tr_b16 v[136:137], v4 offset:2048
    ds_read_b64_tr_b16 v[138:139], v4 offset:3072
    buffer_load_dwordx4 v[180:183], v14, s[36:39], s88 offen offset:1024 sc1
    s_waitcnt lgkmcnt(6)
    v_mfma_f32_32x32x16_bf16 v[240:255], v[156:159], v[188:191], v[240:255]
    ds_read_b64_tr_b16 v[140:141], v5 offset:2048
    ds_read_b64_tr_b16 v[142:143], v5 offset:3072
    s_waitcnt vmcnt(12) lgkmcnt(6)
    v_mfma_f32_32x32x16_bf16 v[224:239], v[128:131], v[192:195], v[224:239]
    ds_read_b64_tr_b16 v[144:145], v4 offset:4096
    ds_read_b64_tr_b16 v[146:147], v4 offset:5120
    buffer_load_dwordx4 v[184:187], v14, s[36:39], s88 offen offset:2048 sc1
    s_waitcnt lgkmcnt(6)
    v_mfma_f32_32x32x16_bf16 v[240:255], v[132:135], v[192:195], v[240:255]
    ds_read_b64_tr_b16 v[148:149], v5 offset:4096
    ds_read_b64_tr_b16 v[150:151], v5 offset:5120
    s_waitcnt lgkmcnt(6)
    v_mfma_f32_32x32x16_bf16 v[224:239], v[136:139], v[196:199], v[224:239]
    ds_read_b64_tr_b16 v[152:153], v4 offset:6144
    ds_read_b64_tr_b16 v[154:155], v4 offset:7168
    buffer_load_dwordx4 v[188:191], v14, s[36:39], s88 offen offset:3072 sc1
    s_add_u32 s82, s82, 4096
    s_and_b32 s82, s82, 0xffff
    s_add_u32 s88, s82, s83
    s_waitcnt lgkmcnt(6)
    v_mfma_f32_32x32x16_bf16 v[240:255], v[140:143], v[196:199], v[240:255]
    ds_read_b64_tr_b16 v[156:157], v5 offset:6144
    ds_read_b64_tr_b16 v[158:159], v5 offset:7168
    v_add_u32 v4, 0x2000, v4
    v_and_b32 v4, 0x1ffff, v4
    v_xor_b32 v5, 64, v4
    s_waitcnt vmcnt(12) lgkmcnt(6)
    v_mfma_f32_32x32x16_bf16 v[224:239], v[144:147], v[200:203], v[224:239]
    ds_read_b64_tr_b16 v[128:129], v4 offset:0
    ds_read_b64_tr_b16 v[130:131], v4 offset:1024
    buffer_load_dwordx4 v[192:195], v14, s[36:39], s88 offen offset:0 sc1
    s_waitcnt lgkmcnt(6)
    v_mfma_f32_32x32x16_bf16 v[240:255], v[148:151], v[200:203], v[240:255]
    ds_read_b64_tr_b16 v[132:133], v5 offset:0
    ds_read_b64_tr_b16 v[134:135], v5 offset:1024
    s_waitcnt lgkmcnt(6)
    v_mfma_f32_32x32x16_bf16 v[224:239], v[152:155], v[204:207], v[224:239]
    ds_read_b64_tr_b16 v[136:137], v4 offset:2048
    ds_read_b64_tr_b16 v[138:139], v4 offset:3072
    buffer_load_dwordx4 v[196:199], v14, s[36:39], s88 offen offset:1024 sc1
    s_waitcnt lgkmcnt(6)
    v_mfma_f32_32x32x16_bf16 v[240:255], v[156:159], v[204:207], v[240:255]
    ds_read_b64_tr_b16 v[140:141], v5 offset:2048
    ds_read_b64_tr_b16 v[142:143], v5 offset:3072
    s_waitcnt vmcnt(12) lgkmcnt(6)
    v_mfma_f32_32x32x16_bf16 v[224:239], v[128:131], v[208:211], v[224:239]
    ds_read_b64_tr_b16 v[144:145], v4 offset:4096
    ds_read_b64_tr_b16 v[146:147], v4 offset:5120
    buffer_load_dwordx4 v[200:203], v14, s[36:39], s88 offen offset:2048 sc1
    s_waitcnt lgkmcnt(6)
    v_mfma_f32_32x32x16_bf16 v[240:255], v[132:135], v[208:211], v[240:255]
    ds_read_b64_tr_b16 v[148:149], v5 offset:4096
    ds_read_b64_tr_b16 v[150:151], v5 offset:5120
    s_waitcnt lgkmcnt(6)
    v_mfma_f32_32x32x16_bf16 v[224:239], v[136:139], v[212:215], v[224:239]
    ds_read_b64_tr_b16 v[152:153], v4 offset:6144
    ds_read_b64_tr_b16 v[154:155], v4 offset:7168
    buffer_load_dwordx4 v[204:207], v14, s[36:39], s88 offen offset:3072 sc1
    s_add_u32 s82, s82, 4096
    s_and_b32 s82, s82, 0xffff
    s_add_u32 s88, s82, s83
    s_waitcnt lgkmcnt(6)
    v_mfma_f32_32x32x16_bf16 v[240:255], v[140:143], v[212:215], v[240:255]
    ds_read_b64_tr_b16 v[156:157], v5 offset:6144
    ds_read_b64_tr_b16 v[158:159], v5 offset:7168
    v_add_u32 v4, 0x2000, v4
    v_and_b32 v4, 0x1ffff, v4
    v_xor_b32 v5, 64, v4
    s_waitcnt vmcnt(12) lgkmcnt(6)
    v_mfma_f32_32x32x16_bf16 v[224:239], v[144:147], v[216:219], v[224:239]
    ds_read_b64_tr_b16 v[128:129], v4 offset:0
    ds_read_b64_tr_b16 v[130:131], v4 offset:1024
    buffer_load_dwordx4 v[208:211], v14, s[36:39], s88 offen offset:0 sc1
    s_waitcnt lgkmcnt(6)
    v_mfma_f32_32x32x16_bf16 v[240:255], v[148:151], v[216:219], v[240:255]
    ds_read_b64_tr_b16 v[132:133], v5 offset:0
    ds_read_b64_tr_b16 v[134:135], v5 offset:1024
    s_waitcnt lgkmcnt(6)
    v_mfma_f32_32x32x16_bf16 v[224:239], v[152:155], v[220:223], v[224:239]
    ds_read_b64_tr_b16 v[136:137], v4 offset:2048
    ds_read_b64_tr_b16 v[138:139], v4 offset:3072
    buffer_load_dwordx4 v[212:215], v14, s[36:39], s88 offen offset:1024 sc1
    s_waitcnt lgkmcnt(6)
    v_mfma_f32_32x32x16_bf16 v[240:255], v[156:159], v[220:223], v[240:255]
    ds_read_b64_tr_b16 v[140:141], v5 offset:2048
    ds_read_b64_tr_b16 v[142:143], v5 offset:3072
    s_cmp_lt_u32 s84, 3
    s_cbranch_scc1 L_G2
    s_waitcnt vmcnt(12) lgkmcnt(6)
    v_mfma_f32_32x32x16_bf16 v[224:239], v[128:131], v[160:163], v[224:239]
    ds_read_b64_tr_b16 v[144:145], v4 offset:4096
    ds_read_b64_tr_b16 v[146:147], v4 offset:5120
    buffer_load_dwordx4 v[216:219], v14, s[36:39], s88 offen offset:2048 sc1
    s_waitcnt lgkmcnt(6)
    v_mfma_f32_32x32x16_bf16 v[240:255], v[132:135], v[160:163], v[240:255]
    ds_read_b64_tr_b16 v[148:149], v5 offset:4096
    ds_read_b64_tr_b16 v[150:151], v5 offset:5120
    s_waitcnt lgkmcnt(6)
    v_mfma_f32_32x32x16_bf16 v[224:239], v[136:139], v[164:167], v[224:239]
    ds_read_b64_tr_b16 v[152:153], v4 offset:6144
    ds_read_b64_tr_b16 v[154:155], v4 offset:7168
    buffer_load_dwordx4 v[220:223], v14, s[36:39], s88 offen offset:3072 sc1
    s_add_u32 s82, s82, 4096
    s_and_b32 s82, s82, 0xffff
    s_add_u32 s88, s82, s83
    s_waitcnt lgkmcnt(6)
    v_mfma_f32_32x32x16_bf16 v[240:255], v[140:143], v[164:167], v[240:255]
    ds_read_b64_tr_b16 v[156:157], v5 offset:6144
    ds_read_b64_tr_b16 v[158:159], v5 offset:7168
    s_barrier
    v_add_u32 v4, 0x2000, v4
    v_and_b32 v4, 0x1ffff, v4
    v_xor_b32_e64 v5, 64, v4
    s_waitcnt vmcnt(12) lgkmcnt(6)
    v_mfma_f32_32x32x16_bf16 v[224:239], v[144:147], v[168:171], v[224:239]
    ds_read_b64_tr_b16 v[128:129], v4 offset:0
    ds_read_b64_tr_b16 v[130:131], v4 offset:1024
    s_waitcnt lgkmcnt(6)
    v_mfma_f32_32x32x16_bf16 v[240:255], v[148:151], v[168:171], v[240:255]
    ds_read_b64_tr_b16 v[132:133], v5 offset:0
    ds_read_b64_tr_b16 v[134:135], v5 offset:1024
    s_waitcnt lgkmcnt(6)
    v_mfma_f32_32x32x16_bf16 v[224:239], v[152:155], v[172:175], v[224:239]
    ds_read_b64_tr_b16 v[136:137], v4 offset:2048
    ds_read_b64_tr_b16 v[138:139], v4 offset:3072
    s_waitcnt lgkmcnt(6)
    v_mfma_f32_32x32x16_bf16 v[240:255], v[156:159], v[172:175], v[240:255]
    ds_read_b64_tr_b16 v[140:141], v5 offset:2048
    ds_read_b64_tr_b16 v[142:143], v5 offset:3072
    s_waitcnt vmcnt(10) lgkmcnt(6)
    v_mfma_f32_32x32x16_bf16 v[224:239], v[128:131], v[176:179], v[224:239]
    ds_read_b64_tr_b16 v[144:145], v4 offset:4096
    ds_read_b64_tr_b16 v[146:147], v4 offset:5120
    s_waitcnt lgkmcnt(6)
    v_mfma_f32_32x32x16_bf16 v[240:255], v[132:135], v[176:179], v[240:255]
    ds_read_b64_tr_b16 v[148:149], v5 offset:4096
    ds_read_b64_tr_b16 v[150:151], v5 offset:5120
    s_waitcnt lgkmcnt(6)
    v_mfma_f32_32x32x16_bf16 v[224:239], v[136:139], v[180:183], v[224:239]
    ds_read_b64_tr_b16 v[152:153], v4 offset:6144
    ds_read_b64_tr_b16 v[154:155], v4 offset:7168
    s_waitcnt lgkmcnt(6)
    v_mfma_f32_32x32x16_bf16 v[240:255], v[140:143], v[180:183], v[240:255]
    ds_read_b64_tr_b16 v[156:157], v5 offset:6144
    ds_read_b64_tr_b16 v[158:159], v5 offset:7168
    v_add_u32 v4, 0x2000, v4
    v_and_b32 v4, 0x1ffff, v4
    v_xor_b32_e64 v5, 64, v4
    s_waitcnt vmcnt(8) lgkmcnt(6)
    v_mfma_f32_32x32x16_bf16 v[224:239], v[144:147], v[184:187], v[224:239]
    ds_read_b64_tr_b16 v[128:129], v4 offset:0
    ds_read_b64_tr_b16 v[130:131], v4 offset:1024
    s_waitcnt lgkmcnt(6)
    v_mfma_f32_32x32x16_bf16 v[240:255], v[148:151], v[184:187], v[240:255]
    ds_read_b64_tr_b16 v[132:133], v5 offset:0
    ds_read_b64_tr_b16 v[134:135], v5 offset:1024
    s_waitcnt lgkmcnt(6)
    v_mfma_f32_32x32x16_bf16 v[224:239], v[152:155], v[188:191], v[224:239]
    ds_read_b64_tr_b16 v[136:137], v4 offset:2048
    ds_read_b64_tr_b16 v[138:139], v4 offset:3072
    s_waitcnt lgkmcnt(6)
    v_mfma_f32_32x32x16_bf16 v[240:255], v[156:159], v[188:191], v[240:255]
    ds_read_b64_tr_b16 v[140:141], v5 offset:2048
    ds_read_b64_tr_b16 v[142:143], v5 offset:3072
    s_waitcnt vmcnt(6) lgkmcnt(6)
    v_mfma_f32_32x32x16_bf16 v[224:239], v[128:131], v[192:195], v[224:239]
    ds_read_b64_tr_b16 v[144:145], v4 offset:4096
    ds_read_b64_tr_b16 v[146:147], v4 offset:5120
    s_waitcnt lgkmcnt(6)
    v_mfma_f32_32x32x16_bf16 v[240:255], v[132:135], v[192:195], v[240:255]
    ds_read_b64_tr_b16 v[148:149], v5 offset:4096
    ds_read_b64_tr_b16 v[150:151], v5 offset:5120
    s_waitcnt lgkmcnt(6)
    v_mfma_f32_32x32x16_bf16 v[224:239], v[136:139], v[196:199], v[224:239]
    ds_read_b64_tr_b16 v[152:153], v4 offset:6144
    ds_read_b64_tr_b16 v[154:155], v4 offset:7168
    s_waitcnt lgkmcnt(6)
    v_mfma_f32_32x32x16_bf16 v[240:255], v[140:143], v[196:199], v[240:255]
    ds_read_b64_tr_b16 v[156:157], v5 offset:6144
    ds_read_b64_tr_b16 v[158:159], v5 offset:7168
    v_add_u32 v4, 0x2000, v4
    v_and_b32 v4, 0x1ffff, v4
    v_xor_b32_e64 v5, 64, v4
    s_waitcnt vmcnt(4) lgkmcnt(6)
    v_mfma_f32_32x32x16_bf16 v[224:239], v[144:147], v[200:203], v[224:239]
    ds_read_b64_tr_b16 v[128:129], v4 offset:0
    ds_read_b64_tr_b16 v[130:131], v4 offset:1024
    s_waitcnt lgkmcnt(6)
    v_mfma_f32_32x32x16_bf16 v[240:255], v[148:151], v[200:203], v[240:255]
    ds_read_b64_tr_b16 v[132:133], v5 offset:0
    ds_read_b64_tr_b16 v[134:135], v5 offset:1024
    s_waitcnt lgkmcnt(6)
    v_mfma_f32_32x32x16_bf16 v[224:239], v[152:155], v[204:207], v[224:239]
    ds_read_b64_tr_b16 v[136:137], v4 offset:2048
    ds_read_b64_tr_b16 v[138:139], v4 offset:3072
    s_waitcnt lgkmcnt(6)
    v_mfma_f32_32x32x16_bf16 v[240:255], v[156:159], v[204:207], v[240:255]
    ds_read_b64_tr_b16 v[140:141], v5 offset:2048
    ds_read_b64_tr_b16 v[142:143], v5 offset:3072
    s_waitcnt vmcnt(2) lgkmcnt(6)
    v_mfma_f32_32x32x16_bf16 v[224:239], v[128:131], v[208:211], v[224:239]
    ds_read_b64_tr_b16 v[144:145], v4 offset:4096
    ds_read_b64_tr_b16 v[146:147], v4 offset:5120
    s_waitcnt lgkmcnt(6)
    v_mfma_f32_32x32x16_bf16 v[240:255], v[132:135], v[208:211], v[240:255]
    ds_read_b64_tr_b16 v[148:149], v5 offset:4096
    ds_read_b64_tr_b16 v[150:151], v5 offset:5120
    s_waitcnt lgkmcnt(6)
    v_mfma_f32_32x32x16_bf16 v[224:239], v[136:139], v[212:215], v[224:239]
    ds_read_b64_tr_b16 v[152:153], v4 offset:6144
    ds_read_b64_tr_b16 v[154:155], v4 offset:7168
    s_waitcnt lgkmcnt(6)
    v_mfma_f32_32x32x16_bf16 v[240:255], v[140:143], v[212:215], v[240:255]
    ds_read_b64_tr_b16 v[156:157], v5 offset:6144
    ds_read_b64_tr_b16 v[158:159], v5 offset:7168
    s_waitcnt vmcnt(0) lgkmcnt(6)
    v_mfma_f32_32x32x16_bf16 v[224:239], v[144:147], v[216:219], v[224:239]
    s_waitcnt lgkmcnt(4)
    v_mfma_f32_32x32x16_bf16 v[240:255], v[148:151], v[216:219], v[240:255]
    s_waitcnt lgkmcnt(2)
    v_mfma_f32_32x32x16_bf16 v[224:239], v[152:155], v[220:223], v[224:239]
    s_waitcnt lgkmcnt(0)
    v_mfma_f32_32x32x16_bf16 v[240:255], v[156:159], v[220:223], v[240:255]
    s_nop 9
    v_pk_mul_f32 v[18:19], v[224:225], v[224:225]
    v_pk_mul_f32 v[20:21], v[224:225], v[60:61]
    v_pk_add_f32 v[16:17], v[224:225], v[226:227]
    v_pk_fma_f32 v[18:19], v[226:227], v[226:227], v[18:19]
    v_pk_fma_f32 v[20:21], v[226:227], v[62:63], v[20:21]
    v_pk_add_f32 v[16:17], v[16:17], v[228:229]
    v_pk_fma_f32 v[18:19], v[228:229], v[228:229], v[18:19]
    v_pk_fma_f32 v[20:21], v[228:229], v[64:65], v[20:21]
    v_pk_add_f32 v[16:17], v[16:17], v[230:231]
    v_pk_fma_f32 v[18:19], v[230:231], v[230:231], v[18:19]
    v_pk_fma_f32 v[20:21], v[230:231], v[66:67], v[20:21]
    v_pk_add_f32 v[16:17], v[16:17], v[232:233]
    v_pk_fma_f32 v[18:19], v[232:233], v[232:233], v[18:19]
    v_pk_fma_f32 v[20:21], v[232:233], v[68:69], v[20:21]
    v_pk_add_f32 v[16:17], v[16:17], v[234:235]
    v_pk_fma_f32 v[18:19], v[234:235], v[234:235], v[18:19]
    v_pk_fma_f32 v[20:21], v[234:235], v[70:71], v[20:21]
    v_pk_add_f32 v[16:17], v[16:17], v[236:237]
    v_pk_fma_f32 v[18:19], v[236:237], v[236:237], v[18:19]
    v_pk_fma_f32 v[20:21], v[236:237], v[72:73], v[20:21]
    v_pk_add_f32 v[16:17], v[16:17], v[238:239]
    v_pk_fma_f32 v[18:19], v[238:239], v[238:239], v[18:19]
    v_pk_fma_f32 v[20:21], v[238:239], v[74:75], v[20:21]
    v_pk_add_f32 v[16:17], v[16:17], v[240:241]
    v_pk_fma_f32 v[18:19], v[240:241], v[240:241], v[18:19]
    v_pk_fma_f32 v[20:21], v[240:241], v[76:77], v[20:21]
    v_pk_add_f32 v[16:17], v[16:17], v[242:243]
    v_pk_fma_f32 v[18:19], v[242:243], v[242:243], v[18:19]
    v_pk_fma_f32 v[20:21], v[242:243], v[78:79], v[20:21]
    v_pk_add_f32 v[16:17], v[16:17], v[244:245]
    v_pk_fma_f32 v[18:19], v[244:245], v[244:245], v[18:19]
    v_pk_fma_f32 v[20:21], v[244:245], v[80:81], v[20:21]
    v_pk_add_f32 v[16:17], v[16:17], v[246:247]
    v_pk_fma_f32 v[18:19], v[246:247], v[246:247], v[18:19]
    v_pk_fma_f32 v[20:21], v[246:247], v[82:83], v[20:21]
    v_pk_add_f32 v[16:17], v[16:17], v[248:249]
    v_pk_fma_f32 v[18:19], v[248:249], v[248:249], v[18:19]
    v_pk_fma_f32 v[20:21], v[248:249], v[84:85], v[20:21]
    v_pk_add_f32 v[16:17], v[16:17], v[250:251]
    v_pk_fma_f32 v[18:19], v[250:251], v[250:251], v[18:19]
    v_pk_fma_f32 v[20:21], v[250:251], v[86:87], v[20:21]
    v_pk_add_f32 v[16:17], v[16:17], v[252:253]
    v_pk_fma_f32 v[18:19], v[252:253], v[252:253], v[18:19]
    v_pk_fma_f32 v[20:21], v[252:253], v[88:89], v[20:21]
    v_pk_add_f32 v[16:17], v[16:17], v[254:255]
    v_pk_fma_f32 v[18:19], v[254:255], v[254:255], v[18:19]
    v_pk_fma_f32 v[20:21], v[254:255], v[90:91], v[20:21]
    v_mov_b32 v27, s75
    v_add_f32 v24, v16, v17
    v_add_f32 v25, v18, v19
    v_add_f32 v26, v20, v21
    v_mov_b32 v28, v24
    v_mov_b32 v29, v25
    v_mov_b32 v30, v26
    v_permlane32_swap_b32 v24, v28
    v_permlane32_swap_b32 v25, v29
    v_permlane32_swap_b32 v26, v30
    v_pk_add_f32 v[24:25], v[24:25], v[28:29]
    v_add_f32 v26, v26, v30
    s_mov_b32 exec_hi, 0
    s_bitcmp1_b32 s99, 1
    s_cbranch_scc1 Lls_58
    buffer_store_dwordx4 v[24:27], v14, s[36:39], s95 offen sc1
    s_branch Lle_59
Lls_58:
    buffer_store_dwordx4 v[24:27], v14, s[36:39], s95 offen
Lle_59:
    s_mov_b32 exec_hi, -1
    s_add_u32 s79, s94, 4096
    s_add_u32 s80, s94, 8192
    s_add_u32 s81, s94, 12288
    s_barrier
    s_nop 0
    buffer_load_dwordx4 v[64:67], v12, s[36:39], s94 offen offset:0 sc1
    buffer_load_dwordx4 v[68:71], v12, s[36:39], s94 offen offset:2048 sc1
    buffer_load_dwordx4 v[72:75], v12, s[36:39], s79 offen offset:0 sc1
    buffer_load_dwordx4 v[76:79], v12, s[36:39], s79 offen offset:2048 sc1
    buffer_load_dwordx4 v[80:83], v12, s[36:39], s80 offen offset:0 sc1
    buffer_load_dwordx4 v[84:87], v12, s[36:39], s80 offen offset:2048 sc1
    buffer_load_dwordx4 v[88:91], v12, s[36:39], s81 offen offset:0 sc1
    buffer_load_dwordx4 v[92:95], v12, s[36:39], s81 offen offset:2048 sc1
    v_xor_b32_e64 v112, 0, v13
    ds_write_b128 v112, v[224:227]
    v_xor_b32_e64 v113, 32, v13
    ds_write_b128 v113, v[228:231]
    v_xor_b32_e64 v114, 64, v13
    ds_write_b128 v114, v[232:235]
    v_xor_b32 v115, 96, v13
    ds_write_b128 v115, v[236:239]
    v_xor_b32 v116, 128, v13
    ds_write_b128 v116, v[240:243]
    v_xor_b32 v117, 160, v13
    ds_write_b128 v117, v[244:247]
    v_xor_b32 v118, 192, v13
    ds_write_b128 v118, v[248:251]
    v_xor_b32 v119, 224, v13
    ds_write_b128 v119, v[252:255]
    s_mov_b32 s85, 1
    s_branch L_gchk
Lspin_60:
    s_add_u32 s85, s85, 1
    s_cmp_gt_u32 s85, 400000
    s_cbranch_scc1 L_end
    buffer_load_dwordx4 v[64:67], v12, s[36:39], s94 offen offset:0 sc1
    buffer_load_dwordx4 v[68:71], v12, s[36:39], s94 offen offset:2048 sc1
    buffer_load_dwordx4 v[72:75], v12, s[36:39], s79 offen offset:0 sc1
    buffer_load_dwordx4 v[76:79], v12, s[36:39], s79 offen offset:2048 sc1
    buffer_load_dwordx4 v[80:83], v12, s[36:39], s80 offen offset:0 sc1
    buffer_load_dwordx4 v[84:87], v12, s[36:39], s80 offen offset:2048 sc1
    buffer_load_dwordx4 v[88:91], v12, s[36:39], s81 offen offset:0 sc1
    buffer_load_dwordx4 v[92:95], v12, s[36:39], s81 offen offset:2048 sc1
L_gchk:
    s_waitcnt vmcnt(0)
    s_nop 0
    v_max3_u32 v16, v67, v71, v75
    v_max3_u32 v16, v16, v79, v83
    v_max3_u32 v16, v16, v87, v91
    v_max3_u32 v16, v16, v95, s75
    v_min3_u32 v17, v67, v71, v75
    v_min3_u32 v17, v17, v79, v83
    v_min3_u32 v17, v17, v87, v91
    v_min3_u32 v17, v17, v95, s75
    v_cmp_ne_u32 vcc, v16, v17
    s_cbranch_vccnz Lspin_60
    v_pk_add_f32 v[64:65], v[64:65], v[68:69]
    v_add_f32_e64 v66, v66, v70
    v_pk_add_f32 v[72:73], v[72:73], v[76:77]
    v_add_f32_e64 v74, v74, v78
    v_pk_add_f32 v[80:81], v[80:81], v[84:85]
    v_add_f32_e64 v82, v82, v86
    v_pk_add_f32 v[88:89], v[88:89], v[92:93]
    v_add_f32_e64 v90, v90, v94
    v_pk_add_f32 v[64:65], v[64:65], v[72:73]
    v_add_f32_e64 v66, v66, v74
    v_pk_add_f32 v[80:81], v[80:81], v[88:89]
    v_add_f32 v82, v82, v90
    v_add_f32 v24, v64, v80
    v_add_f32 v25, v65, v81
    v_add_f32 v26, v66, v82
    v_mov_b32 v28, v24
    v_mov_b32 v29, v25
    v_mov_b32 v30, v26
    v_permlane32_swap_b32 v24, v28
    v_permlane32_swap_b32 v25, v29
    v_permlane32_swap_b32 v26, v30
    v_pk_add_f32 v[24:25], v[24:25], v[28:29]
    v_add_f32_e64 v26, v26, v30
    v_mul_f32 v36, 0x3a800000, v24
    v_mul_f32 v40, 0x3a800000, v25
    v_fma_f32 v40, -v36, v36, v40
    v_max_f32_e64 v40, 0, v40
    v_cvt_pk_bf16_f32 v36, v36, v36
    v_and_b32 v36, 0xffff0000, v36
    v_cvt_pk_bf16_f32 v40, v40, v40
    v_and_b32 v40, 0xffff0000, v40
    v_add_f32 v40, 0x3727c5ac, v40
    v_cvt_pk_bf16_f32 v40, v40, v40
    v_and_b32 v40, 0xffff0000, v40
    v_sqrt_f32 v40, v40
    s_nop 0
    v_cvt_pk_bf16_f32 v40, v40, v40
    v_and_b32 v40, 0xffff0000, v40
    v_rcp_f32_e64 v38, v40
    v_fma_f32 v42, -v36, v126, v26
    s_mov_b32 s79, 0xfffff800
    v_mul_f32_e64 v42, v42, v38
    v_mul_f32 v39, -v36, v38
    v_and_or_b32 v42, v42, s79, v11
    ds_write_b64 v10, v[38:39]
    s_nop 0
    v_max_f32_dpp v42, v42, v42 row_ror:8 row_mask:0xf bank_mask:0xf
    s_nop 1
    v_max_f32_dpp v42, v42, v42 row_ror:4 row_mask:0xf bank_mask:0xf
    s_nop 1
    v_max_f32_dpp v42, v42, v42 row_ror:2 row_mask:0xf bank_mask:0xf
    s_nop 1
    v_max_f32_dpp v42, v42, v42 row_ror:1 row_mask:0xf bank_mask:0xf
    s_lshl_b32 s78, s76, 3
    s_add_u32 s78, s78, 163328
    v_bfe_u32 v16, v2, 4, 1
    v_lshl_add_u32 v16, v16, 2, s78
    ds_write_b32 v16, v42
    v_mov_b32 v16, 163328
    s_waitcnt lgkmcnt(0)
    s_barrier
    ds_read_b128 v[20:23], v16
    ds_read_b128 v[24:27], v16 offset:16
    s_lshl_b32 s79, s71, 4
    s_add_u32 s79, s79, s72
    s_lshl_b32 s79, s79, 9
    s_add_u32 s79, s79, 524288
    v_lshlrev_b32 v17, 3, v2
    v_lshlrev_b32_e64 v18, 2, v2
    s_waitcnt lgkmcnt(0)
    v_max3_f32 v20, v20, v21, v22
    v_max3_f32 v24, v24, v25, v26
    v_max_f32_e64 v23, v23, v27
    v_max3_f32 v20, v20, v24, v23
    v_mov_b32 v21, s75
    s_cmp_lg_u32 s76, 0
    s_cbranch_scc1 L_nocand
    s_mov_b32 exec_hi, 0
    v_and_b32 v22, 127, v20
    v_and_b32 v23, 7, v20
    v_lshlrev_b32 v23, 4, v23
    v_xor_b32_e64 v23, v23, v17
    v_lshl_add_u32 v23, v22, 8, v23
    v_lshlrev_b32_e64 v22, 3, v22
    ds_read_b64 v[24:25], v23
    v_add_u32 v22, 159744, v22
    ds_read_b64 v[26:27], v22
    s_mov_b32 exec_lo, 0xffff
    buffer_store_dwordx2 v[20:21], v17, s[36:39], s79 offen offset:128 sc1
    s_mov_b32 exec_lo, -1
    s_waitcnt lgkmcnt(0)
    v_fma_f32 v28, v24, v26, v27
    v_fma_f32 v29, v25, v26, v27
    v_cvt_pk_bf16_f32 v30, v28, v29
    buffer_store_dword v30, v18, s[36:39], s79 offen sc1
    v_add_f32 v28, v28, v24
    v_add_f32 v29, v29, v25
    buffer_store_dwordx2 v[28:29], v17, s[36:39], s79 offen offset:256 sc1
    s_mov_b32 exec_hi, -1
L_nocand:
    v_lshrrev_b32 v16, 3, v2
    v_and_b32 v17, 7, v2
    s_lshl_b32 s78, s76, 5
    v_add_u32 v18, s78, v16
    v_lshlrev_b32 v19, 1, v17
    v_xor_b32 v19, v19, v16
    v_lshlrev_b32 v19, 4, v19
    v_lshl_add_u32 v19, v18, 8, v19
    v_xor_b32 v32, 16, v19
    v_lshlrev_b32 v33, 3, v18
    v_add_u32 v33, 159744, v33
    ds_read_b128 v[64:67], v19 offset:0
    ds_read_b128 v[68:71], v32 offset:0
    ds_read_b64 v[96:97], v33 offset:0
    ds_read_b128 v[72:75], v19 offset:2048
    ds_read_b128 v[76:79], v32 offset:2048
    ds_read_b64 v[98:99], v33 offset:64
    ds_read_b128 v[80:83], v19 offset:4096
    ds_read_b128 v[84:87], v32 offset:4096
    ds_read_b64 v[100:101], v33 offset:128
    ds_read_b128 v[88:91], v19 offset:6144
    ds_read_b128 v[92:95], v32 offset:6144
    ds_read_b64 v[102:103], v33 offset:192
    s_lshl_b32 s78, s71, 7
    v_add_u32_e64 v18, s78, v18
    s_lshl_b32 s79, s72, 7
    v_lshl_add_u32 v19, v18, 11, s79
    v_lshl_add_u32 v19, v17, 4, v19
    v_mov_b32 v16, 163360
    s_waitcnt lgkmcnt(0)
    v_add_f32 v96, 1.0, v96
    v_pk_fma_f32 v[64:65], v[64:65], v[96:97], v[96:97] op_sel:[0,0,1] op_sel_hi:[1,0,1]
    v_pk_fma_f32 v[66:67], v[66:67], v[96:97], v[96:97] op_sel:[0,0,1] op_sel_hi:[1,0,1]
    v_pk_fma_f32 v[68:69], v[68:69], v[96:97], v[96:97] op_sel:[0,0,1] op_sel_hi:[1,0,1]
    v_pk_fma_f32 v[70:71], v[70:71], v[96:97], v[96:97] op_sel:[0,0,1] op_sel_hi:[1,0,1]
    v_cvt_pk_bf16_f32 v104, v64, v65
    v_cvt_pk_bf16_f32 v105, v66, v67
    v_cvt_pk_bf16_f32 v106, v68, v69
    v_cvt_pk_bf16_f32 v107, v70, v71
    v_add_f32_e64 v98, 1.0, v98
    v_pk_fma_f32 v[72:73], v[72:73], v[98:99], v[98:99] op_sel:[0,0,1] op_sel_hi:[1,0,1]
    v_pk_fma_f32 v[74:75], v[74:75], v[98:99], v[98:99] op_sel:[0,0,1] op_sel_hi:[1,0,1]
    v_pk_fma_f32 v[76:77], v[76:77], v[98:99], v[98:99] op_sel:[0,0,1] op_sel_hi:[1,0,1]
    v_pk_fma_f32 v[78:79], v[78:79], v[98:99], v[98:99] op_sel:[0,0,1] op_sel_hi:[1,0,1]
    v_cvt_pk_bf16_f32 v108, v72, v73
    v_cvt_pk_bf16_f32 v109, v74, v75
    v_cvt_pk_bf16_f32 v110, v76, v77
    v_cvt_pk_bf16_f32 v111, v78, v79
    v_add_f32_e64 v100, 1.0, v100
    v_pk_fma_f32 v[80:81], v[80:81], v[100:101], v[100:101] op_sel:[0,0,1] op_sel_hi:[1,0,1]
    v_pk_fma_f32 v[82:83], v[82:83], v[100:101], v[100:101] op_sel:[0,0,1] op_sel_hi:[1,0,1]
    v_pk_fma_f32 v[84:85], v[84:85], v[100:101], v[100:101] op_sel:[0,0,1] op_sel_hi:[1,0,1]
    v_pk_fma_f32 v[86:87], v[86:87], v[100:101], v[100:101] op_sel:[0,0,1] op_sel_hi:[1,0,1]
    v_cvt_pk_bf16_f32 v112, v80, v81
    v_cvt_pk_bf16_f32 v113, v82, v83
    v_cvt_pk_bf16_f32 v114, v84, v85
    v_cvt_pk_bf16_f32 v115, v86, v87
    v_add_f32_e64 v102, 1.0, v102
    v_pk_fma_f32 v[88:89], v[88:89], v[102:103], v[102:103] op_sel:[0,0,1] op_sel_hi:[1,0,1]
    v_pk_fma_f32 v[90:91], v[90:91], v[102:103], v[102:103] op_sel:[0,0,1] op_sel_hi:[1,0,1]
    v_pk_fma_f32 v[92:93], v[92:93], v[102:103], v[102:103] op_sel:[0,0,1] op_sel_hi:[1,0,1]
    v_pk_fma_f32 v[94:95], v[94:95], v[102:103], v[102:103] op_sel:[0,0,1] op_sel_hi:[1,0,1]
    v_cvt_pk_bf16_f32 v116, v88, v89
    v_cvt_pk_bf16_f32 v117, v90, v91
    v_cvt_pk_bf16_f32 v118, v92, v93
    v_cvt_pk_bf16_f32 v119, v94, v95
    s_barrier
    ds_read_b32 v17, v16
    s_waitcnt lgkmcnt(0)
    v_and_b32 v17, 0x7ff, v17
    v_sub_u32 v17, v17, v18
    s_barrier
    s_barrier
    s_mov_b32 s78, 0
    v_cmp_ne_u32_e64 vcc, 0, v17
    s_mov_b64 exec, vcc
    s_cbranch_execz Lo_61
    buffer_store_dwordx4 v[104:107], v19, s[44:47], s78 offen sc1
Lo_61:
    s_mov_b64 exec, -1
    s_mov_b32 s78, 16384
    v_cmp_ne_u32 vcc, 8, v17
    s_mov_b64 exec, vcc
    s_cbranch_execz Lo_62
    buffer_store_dwordx4 v[108:111], v19, s[44:47], s78 offen sc1
Lo_62:
    s_mov_b64 exec, -1
    s_mov_b32 s78, 32768
    v_cmp_ne_u32 vcc, 16, v17
    s_mov_b64 exec, vcc
    s_cbranch_execz Lo_63
    buffer_store_dwordx4 v[112:115], v19, s[44:47], s78 offen sc1
Lo_63:
    s_mov_b64 exec, -1
    s_mov_b32 s78, 49152
    v_cmp_ne_u32 vcc, 24, v17
    s_mov_b64 exec, vcc
    s_cbranch_execz Lo_64
    buffer_store_dwordx4 v[116:119], v19, s[44:47], s78 offen sc1
Lo_64:
    s_mov_b64 exec, -1
    s_branch L_fin
L_fin:
L_end:
    s_endpgm
.fill 64, 4, 0xbf800000
s_endpgm
.section .rodata,"a"
.p2align 6
.amdhsa_kernel sequential_preLN__linear_kernel_hedgehog__moe_arch_mod__prompt_kernel
  .amdhsa_next_free_vgpr 256
  .amdhsa_next_free_sgpr 102
  .amdhsa_accum_offset 256
  .amdhsa_group_segment_fixed_size 0
  .amdhsa_kernarg_size 96
  .amdhsa_user_sgpr_count 2
  .amdhsa_user_sgpr_kernarg_segment_ptr 1
  .amdhsa_system_sgpr_workgroup_id_x 1
  .amdhsa_float_denorm_mode_32 3
.end_amdhsa_kernel
```

```asm
; @launch grid=(256,1,1) block=(512,1,1) lds=163840
.amdgcn_target "amdgcn-amd-amdhsa--gfx950"
.text
.globl sequential_preLN__linear_kernel_hedgehog__moe_arch_mod__prompt_kernel
.p2align 8
.type sequential_preLN__linear_kernel_hedgehog__moe_arch_mod__prompt_kernel,@function
sequential_preLN__linear_kernel_hedgehog__moe_arch_mod__prompt_kernel:
    s_cmp_ge_u32 s2, 256
    s_cbranch_scc1 L_end
    s_load_dwordx16 s[4:19], s[0:1], 0
    s_load_dwordx8 s[20:27], s[0:1], 64
    v_lshrrev_b32 v1, 6, v0
    v_and_b32_e64 v2, 63, v0
    v_readfirstlane_b32 s68, v1
    s_lshr_b32 s69, s2, 4
    s_and_b32 s70, s2, 7
    s_lshl_b32 s70, s70, 1
    s_bfe_u32 s78, s2, 0x10003
    s_or_b32 s70, s70, s78
    s_and_b32 s76, s68, 3
    s_cmp_ge_u32 s68, 4
    s_cbranch_scc1 L_M
    v_lshrrev_b32 v196, 3, v2
    v_and_b32 v197, 7, v2
    v_lshrrev_b32_e64 v198, 4, v2
    s_and_b32 s80, s69, 0
    s_lshl_b32 s89, s76, 11
    s_lshl_b32 s66, s80, 10
    s_or_b32 s66, s66, s89
    s_xor_b32 s67, s66, 1024
    s_lshl_b32 s79, s70, 7
    s_movk_i32 s78, 6144
    v_mov_b32_e64 v199, s79
    v_mad_u32_u24 v199, v196, s78, v199
    s_lshl_b32 s80, s80, 2
    v_and_b32 v200, 2, v196
    v_xor_b32 v200, v200, v197
    v_xor_b32 v200, s80, v200
    v_lshl_add_u32 v199, v200, 4, v199
    s_mul_i32 s78, s66, 48
    s_mul_i32 s79, s67, 48
    v_add_u32 v6, s78, v199
    v_xor_b32 v199, 64, v199
    v_add_u32_e64 v7, s79, v199
    s_and_b32 s80, s70, 0
    s_lshl_b32 s88, s76, 12
    s_lshl_b32 s64, s80, 10
    s_or_b32 s64, s64, s88
    s_xor_b32 s65, s64, 1024
    s_lshl_b32 s80, s80, 2
    s_lshl_b32 s78, s69, 14
    s_add_u32 s78, s78, s64
    s_lshl_b32 s78, s78, 4
    v_lshl_add_u32 v199, v196, 11, s78
    v_xor_b32 v200, v198, v197
    v_xor_b32 v200, s80, v200
    v_lshl_add_u32 v4, v200, 4, v199
    v_xor_b32 v5, 16448, v4
    s_and_b32 s78, s70, 14
    s_and_b32 s79, s69, 14
    s_add_u32 s78, s78, s79
    s_sub_u32 s78, 32, s78
    s_and_b32 s78, s78, 15
    s_lshl_b32 s86, s78, 7
    s_mul_i32 s87, s78, 393216
    s_mov_b32 s30, 0x400000
    s_mov_b32 s31, 0x20000
    s_mov_b32 s34, 0x600000
    s_mov_b32 s35, 0x20000
    s_waitcnt lgkmcnt(0)
    s_mov_b32 s32, s6
    s_and_b32 s33, s7, 0xffff
    s_mov_b32 s28, s4
    s_and_b32 s29, s5, 0xffff
    s_add_u32 m0, s64, 118784
    s_nop 0
    buffer_load_dwordx4 v4, s[28:31], s86 offen offset:0  lds
    s_add_u32 m0, s66, 141312
    s_nop 0
    s_nop 0
    buffer_load_dwordx4 v6, s[32:35], s87 offen offset:2048  lds
    s_add_u32 m0, s64, 120832
    s_add_u32 s101, s86, 32768
    buffer_load_dwordx4 v4, s[28:31], s101 offen offset:0  lds
    s_add_u32 m0, s66, 151552
    s_add_u32 s101, s87, 4096
    buffer_load_dwordx4 v6, s[32:35], s101 offen offset:0  lds
    s_add_u32 m0, s66, 135168
    s_nop 0
    buffer_load_dwordx4 v6, s[32:35], s87 offen offset:0  lds
    s_add_u32 m0, s65, 118784
    s_nop 0
    buffer_load_dwordx4 v5, s[28:31], s86 offen offset:0  lds
    s_add_u32 m0, s67, 141312
    s_nop 0
    s_nop 0
    buffer_load_dwordx4 v7, s[32:35], s87 offen offset:2048  lds
    s_add_u32 m0, s65, 120832
    s_add_u32 s101, s86, 32768
    buffer_load_dwordx4 v5, s[28:31], s101 offen offset:0  lds
    s_add_u32 m0, s67, 151552
    s_add_u32 s101, s87, 4096
    buffer_load_dwordx4 v7, s[32:35], s101 offen offset:0  lds
    s_add_u32 m0, s67, 135168
    s_nop 0
    buffer_load_dwordx4 v7, s[32:35], s87 offen offset:0  lds
    s_add_u32 s86, s86, 128
    s_add_u32 s87, s87, 393216
    s_and_b32 s86, s86, 2047
    s_cselect_b32 s87, s87, 0
    s_mov_b32 s101, 40960
    s_cmp_ge_i32 s64, 0
    s_cselect_b32 s101, 0xfffec000, s101
    s_add_u32 s64, s64, s101
    s_add_u32 s65, s65, s101
    s_add_u32 s66, s66, s101
    s_add_u32 s67, s67, s101
    s_load_dword s75, s[26:27], 0
    s_mov_b32 s60, s8
    s_and_b32 s61, s9, 0xffff
    s_mov_b32 s62, 0x10000
    s_mov_b32 s63, 0x20000
    v_lshlrev_b32 v14, 4, v2
    s_lshl_b32 s78, s70, 12
    s_lshl_b32 s79, s76, 10
    s_add_u32 s78, s78, s79
    s_add_u32 m0, s79, 159744
    s_nop 0
    buffer_load_dwordx4 v14, s[60:63], s78 offen lds
    s_and_b32 s78, s2, 7
    s_lshr_b32 s79, s2, 3
    s_lshl_b32 s71, s78, 1
    s_and_b32 s72, s79, 1
    s_add_u32 s71, s71, s72
    s_lshr_b32 s72, s79, 1
    s_cmp_gt_u32 s70, 3
    s_cselect_b32 s78, 1, 0
    s_cmp_gt_u32 s70, 11
    s_cselect_b32 s78, 2, s78
    s_sub_u32 s78, s70, s78
    s_cmp_eq_u32 s70, 3
    s_cselect_b32 s78, 14, s78
    s_cmp_eq_u32 s70, 11
    s_cselect_b32 s78, 15, s78
    s_lshl_b32 s0, s78, 4
    s_add_u32 s0, s0, s69
    s_lshr_b32 s73, s0, 2
    s_and_b32 s74, s0, 3
    s_lshl_b32 s77, s70, 4
    s_add_u32 s77, s77, s69
    s_mov_b32 s36, s26
    s_and_b32 s37, s27, 0xffff
    s_mov_b32 s38, 0x10000000
    s_mov_b32 s39, 0x20000
    s_mov_b32 s40, s10
    s_and_b32 s41, s11, 0xffff
    s_mov_b32 s42, 0x200000
    s_mov_b32 s43, 0x20000
    s_mov_b32 s44, s22
    s_and_b32 s45, s23, 0xffff
    s_mov_b32 s46, 0x400000
    s_mov_b32 s47, 0x20000
    s_mov_b32 s48, s16
    s_and_b32 s49, s17, 0xffff
    s_mov_b32 s50, 0x700000
    s_mov_b32 s51, 0x20000
    s_mov_b32 s52, s18
    s_and_b32 s53, s19, 0xffff
    s_mov_b32 s54, 0x700000
    s_mov_b32 s55, 0x20000
    s_mov_b32 s56, s20
    s_and_b32 s57, s21, 0xffff
    s_mov_b32 s58, 0x700000
    s_mov_b32 s59, 0x20000
    v_mov_b32 v16, -1
    v_mov_b32 v17, -1
    v_mov_b32 v18, -1
    v_mov_b32_e64 v19, -1
    s_lshl_b32 s94, s77, 14
    s_lshl_b32 s78, s76, 12
    s_add_u32 s94, s94, s78
    s_add_u32 s94, s94, 4194304
    s_lshl_b32 s96, s77, 10
    s_add_u32 s96, s96, 8388608
    s_cmp_eq_u32 s76, 3
    s_cselect_b32 s96, s96, 0x10000000
    v_and_b32 v196, 15, v2
    v_lshrrev_b32 v197, 1, v196
    v_lshlrev_b32 v199, 7, v196
    v_add_u32 v199, s88, v199
    v_xor_b32_e64 v200, v198, v197
    v_lshl_add_u32 v60, v200, 4, v199
    v_bfe_u32 v196, v2, 2, 2
    v_and_b32_e64 v197, 3, v2
    v_lshl_add_u32 v199, v198, 3, v196
    v_lshlrev_b32_e64 v199, 7, v199
    v_lshl_add_u32 v199, v197, 3, v199
    v_lshrrev_b32 v196, 1, v196
    v_and_b32 v197, 1, v198
    v_lshl_add_u32 v196, v197, 1, v196
    s_mul_i32 s80, s76, 3
    s_add_u32 s78, s80, 0
    s_and_b32 s79, s78, 3
    s_lshr_b32 s78, s78, 2
    s_lshl_b32 s78, s78, 13
    s_add_u32 s78, s78, 16384
    v_xor_b32 v197, s79, v196
    v_lshl_add_u32 v197, v197, 5, v199
    v_add_u32_e64 v240, s78, v197
    s_add_u32 s78, s80, 1
    s_and_b32 s79, s78, 3
    s_lshr_b32 s78, s78, 2
    s_lshl_b32 s78, s78, 13
    s_add_u32 s78, s78, 16384
    v_xor_b32_e64 v197, s79, v196
    v_lshl_add_u32 v197, v197, 5, v199
    v_add_u32_e64 v241, s78, v197
    s_add_u32 s78, s80, 2
    s_and_b32 s79, s78, 3
    s_lshr_b32 s78, s78, 2
    s_lshl_b32 s78, s78, 13
    s_add_u32 s78, s78, 16384
    v_xor_b32_e64 v197, s79, v196
    v_lshl_add_u32 v197, v197, 5, v199
    v_add_u32 v242, s78, v197
    s_and_b32 s78, s70, 1
    s_lshl_b32 s78, s78, 6
    v_xor_b32 v60, s78, v60
    s_and_b32 s78, s69, 1
    s_lshl_b32 s78, s78, 12
    v_add_u32 v240, s78, v240
    v_add_u32 v241, s78, v241
    v_add_u32_e64 v242, s78, v242
    s_add_u32 m0, s64, 118784
    s_nop 0
    buffer_load_dwordx4 v4, s[28:31], s86 offen offset:0  lds
    v_lshrrev_b32 v196, 3, v2
    v_and_b32 v197, 7, v2
    v_lshlrev_b32 v199, 4, v197
    v_mul_u32_u24 v244, 57344, v196
    s_add_u32 m0, s66, 141312
    s_nop 0
    buffer_load_dwordx4 v6, s[32:35], s87 offen offset:2048  lds
    v_add_u32 v244, v244, v199
    v_lshl_add_u32 v245, v196, 14, v199
    s_lshl_b32 s78, s74, 2
    s_add_u32 s78, s78, s76
    s_add_u32 m0, s64, 120832
    s_add_u32 s101, s86, 32768
    buffer_load_dwordx4 v4, s[28:31], s101 offen offset:0  lds
    s_mul_i32 s79, s78, 458752
    s_add_u32 s80, s73, s76
    s_and_b32 s80, s80, 3
    s_andn2_b32 s100, s73, 3
    s_add_u32 m0, s66, 151552
    s_add_u32 s101, s87, 4096
    buffer_load_dwordx4 v6, s[32:35], s101 offen offset:0  lds
    s_or_b32 s80, s80, s100
    s_lshl_b32 s80, s80, 7
    s_add_u32 s79, s79, s80
    s_cmp_ge_u32 s73, 56
    s_cselect_b32 s79, 0x8000000, s79
    v_add_u32_e64 v244, s79, v244
    s_lshl_b32 s78, s78, 7
    s_add_u32 m0, s66, 135168
    s_nop 0
    buffer_load_dwordx4 v6, s[32:35], s87 offen offset:0  lds
    s_lshl_b32 s80, s73, 17
    s_add_u32 s78, s78, s80
    v_add_u32_e64 v245, s78, v245
    s_lshl_b32 s78, s72, 7
    s_add_u32 m0, s65, 118784
    s_nop 0
    buffer_load_dwordx4 v5, s[28:31], s86 offen offset:0  lds
    v_lshl_add_u32 v196, v196, 11, s78
    v_and_b32 v199, 1, v198
    v_lshlrev_b32 v199, 2, v199
    v_xor_b32 v199, v199, v197
    s_add_u32 m0, s67, 141312
    s_nop 0
    buffer_load_dwordx4 v7, s[32:35], s87 offen offset:2048  lds
    v_lshl_add_u32 v246, v199, 4, v196
    s_lshl_b32 s78, s71, 2
    s_add_u32 s78, s78, s76
    s_lshl_b32 s78, s78, 16
    v_add_u32_e64 v196, s78, v196
    s_add_u32 m0, s65, 120832
    s_add_u32 s101, s86, 32768
    buffer_load_dwordx4 v5, s[28:31], s101 offen offset:0  lds
    v_xor_b32_e64 v199, v198, v197
    v_lshl_add_u32 v247, v199, 4, v196
    v_xor_b32 v248, 64, v247
    s_lshl_b32 s78, s76, 14
    s_add_u32 m0, s67, 151552
    s_add_u32 s101, s87, 4096
    buffer_load_dwordx4 v7, s[32:35], s101 offen offset:0  lds
    v_add_u32 v246, s78, v246
    s_lshl_b32 s84, s76, 10
    s_bfe_u32 s78, s2, 0x40003
    s_lshl_b32 s78, s78, 17
    s_add_u32 m0, s67, 135168
    s_nop 0
    buffer_load_dwordx4 v7, s[32:35], s87 offen offset:0  lds
    s_add_u32 s86, s86, 128
    s_add_u32 s87, s87, 393216
    s_and_b32 s86, s86, 2047
    s_cselect_b32 s87, s87, 0
    s_mov_b32 s101, 40960
    s_cmp_ge_i32 s64, 0
    s_cselect_b32 s101, 0xfffec000, s101
    s_add_u32 s64, s64, s101
    s_add_u32 s65, s65, s101
    s_add_u32 s66, s66, s101
    s_add_u32 s67, s67, s101
    s_and_b32 s79, s72, 8
    s_add_u32 s79, s79, 3
    s_lshl_b32 s79, s79, 7
    s_add_u32 s78, s78, s79
    v_lshl_add_u32 v63, v2, 11, s78
    s_mul_i32 s100, s69, 52
    s_lshr_b32 s100, s100, 8
    s_mul_i32 s100, s100, 5
    s_sub_u32 s3, s69, s100
    s_branch L_sube
    .p2align 6
L_iss:
    s_add_u32 m0, s64, 118784
    s_nop 0
    buffer_load_dwordx4 v4, s[28:31], s86 offen offset:0  lds
    s_add_u32 m0, s66, 141312
    s_nop 0
    buffer_load_dwordx4 v6, s[32:35], s87 offen offset:2048  lds
    s_add_u32 m0, s64, 120832
    s_add_u32 s101, s86, 32768
    buffer_load_dwordx4 v4, s[28:31], s101 offen offset:0  lds
    s_add_u32 m0, s66, 151552
    s_add_u32 s101, s87, 4096
    buffer_load_dwordx4 v6, s[32:35], s101 offen offset:0  lds
    s_add_u32 m0, s66, 135168
    s_nop 0
    buffer_load_dwordx4 v6, s[32:35], s87 offen offset:0  lds
    s_add_u32 m0, s65, 118784
    s_nop 0
    buffer_load_dwordx4 v5, s[28:31], s86 offen offset:0  lds
    s_add_u32 m0, s67, 141312
    s_nop 0
    s_nop 0
    buffer_load_dwordx4 v7, s[32:35], s87 offen offset:2048  lds
    s_add_u32 m0, s65, 120832
    s_add_u32 s101, s86, 32768
    buffer_load_dwordx4 v5, s[28:31], s101 offen offset:0  lds
    s_add_u32 m0, s67, 151552
    s_add_u32 s101, s87, 4096
    buffer_load_dwordx4 v7, s[32:35], s101 offen offset:0  lds
    s_add_u32 m0, s67, 135168
    s_nop 0
    buffer_load_dwordx4 v7, s[32:35], s87 offen offset:0  lds
    s_add_u32 s86, s86, 128
    s_add_u32 s87, s87, 393216
    s_and_b32 s86, s86, 2047
    s_cselect_b32 s87, s87, 0
    s_mov_b32 s101, 40960
    s_cmp_ge_i32 s64, 0
    s_cselect_b32 s101, 0xfffec000, s101
    s_add_u32 s64, s64, s101
    s_add_u32 s65, s65, s101
    s_add_u32 s66, s66, s101
    s_add_u32 s67, s67, s101
    s_setpc_b64 s[90:91]
    .p2align 6
L_cl0:
    s_mov_b32 s100, 0
    buffer_load_dwordx4 v[64:67], v244, s[48:51], s100 offen nt
    s_mov_b32 s100, 0
    buffer_load_dwordx4 v[96:99], v244, s[52:55], s100 offen nt
    s_mov_b32 s100, 7168
    buffer_load_dwordx4 v[68:71], v244, s[48:51], s100 offen nt
    s_mov_b32 s100, 7168
    buffer_load_dwordx4 v[100:103], v244, s[52:55], s100 offen nt
    s_mov_b32 s100, 14336
    buffer_load_dwordx4 v[72:75], v244, s[48:51], s100 offen nt
    s_mov_b32 s100, 14336
    buffer_load_dwordx4 v[104:107], v244, s[52:55], s100 offen nt
    s_mov_b32 s100, 21504
    buffer_load_dwordx4 v[76:79], v244, s[48:51], s100 offen nt
    s_setpc_b64 s[90:91]
    .p2align 6
L_cl1:
    s_mov_b32 s100, 21504
    buffer_load_dwordx4 v[108:111], v244, s[52:55], s100 offen nt
    s_mov_b32 s100, 28672
    buffer_load_dwordx4 v[80:83], v244, s[48:51], s100 offen nt
    s_mov_b32 s100, 28672
    buffer_load_dwordx4 v[112:115], v244, s[52:55], s100 offen nt
    s_mov_b32 s100, 35840
    buffer_load_dwordx4 v[84:87], v244, s[48:51], s100 offen nt
    s_mov_b32 s100, 35840
    buffer_load_dwordx4 v[116:119], v244, s[52:55], s100 offen nt
    s_mov_b32 s100, 43008
    buffer_load_dwordx4 v[88:91], v244, s[48:51], s100 offen nt
    s_mov_b32 s100, 43008
    buffer_load_dwordx4 v[120:123], v244, s[52:55], s100 offen nt
    s_setpc_b64 s[90:91]
    .p2align 6
L_sube:
    s_waitcnt vmcnt(10)
    s_barrier
    s_call_b64 s[90:91], L_iss
    s_setprio 2
    v_add_u32 v196, 118784, v60
    v_add_u32 v198, 118784, v240
    v_add_u32 v199, 118784, v241
    v_add_u32 v200, 118784, v242
    ds_read_b128 v[20:23], v196 offset:0
    ds_read_b128 v[24:27], v196 offset:2048
    ds_read_b64_tr_b16 v[36:37], v198 offset:0
    ds_read_b64_tr_b16 v[38:39], v198 offset:512
    ds_read_b64_tr_b16 v[44:45], v199 offset:0
    ds_read_b64_tr_b16 v[46:47], v199 offset:512
    ds_read_b64_tr_b16 v[52:53], v200 offset:0
    ds_read_b64_tr_b16 v[54:55], v200 offset:512
    s_setprio 0
    s_waitcnt lgkmcnt(0)
    s_mul_i32 s75, s75, 0x9E3779B1
    s_add_u32 s75, s75, 0x7F4A7C15
    s_waitcnt vmcnt(10)
    s_waitcnt lgkmcnt(0)
    s_barrier
    s_call_b64 s[90:91], L_iss
    s_setprio 2
    s_nop 0
    v_add_u32 v196, 36864, v60
    v_add_u32 v198, 36864, v240
    v_add_u32 v199, 36864, v241
    v_add_u32 v200, 36864, v242
    ds_read_b128 v[28:31], v196 offset:0
    ds_read_b128 v[32:35], v196 offset:2048
    ds_read_b64_tr_b16 v[40:41], v198 offset:0
    ds_read_b64_tr_b16 v[42:43], v198 offset:512
    ds_read_b64_tr_b16 v[48:49], v199 offset:0
    ds_read_b64_tr_b16 v[50:51], v199 offset:512
    ds_read_b64_tr_b16 v[56:57], v200 offset:0
    ds_read_b64_tr_b16 v[58:59], v200 offset:512
    s_setprio 0
    s_waitcnt vmcnt(10)
    s_waitcnt lgkmcnt(0)
    s_barrier
    s_call_b64 s[90:91], L_iss
    s_waitcnt vmcnt(10)
    s_cmp_lg_u32 s3, 0
    s_cbranch_scc1 Lcs_1
    s_call_b64 s[90:91], L_cl0
Lcs_1:
    s_barrier
    s_setprio 2
    s_add_u32 m0, s64, 118784
    s_nop 0
    buffer_load_dwordx4 v4, s[28:31], s86 offen offset:0  lds
    v_mov_b32 v200, 0x3f803f80
    v_mov_b32 v201, 0x3f803f80
    v_mov_b32 v202, 0x3f803f80
    v_mov_b32 v203, 0x3f803f80
    s_add_u32 m0, s66, 141312
    s_nop 0
    s_nop 0
    buffer_load_dwordx4 v6, s[32:35], s87 offen offset:2048  lds
    v_mfma_f32_16x16x32_bf16 v[204:207], v[200:203], v[20:23], 0
    v_mfma_f32_16x16x32_bf16 v[212:215], v[20:23], v[20:23], 0
    v_mfma_f32_16x16x32_bf16 v[208:211], v[200:203], v[24:27], 0
    v_mfma_f32_16x16x32_bf16 v[216:219], v[24:27], v[24:27], 0
    s_add_u32 m0, s64, 120832
    s_add_u32 s101, s86, 32768
    buffer_load_dwordx4 v4, s[28:31], s101 offen offset:0  lds
    v_mfma_f32_16x16x32_bf16 v[220:223], v[200:203], v[36:39], 0
    v_mfma_f32_16x16x32_bf16 v[224:227], v[200:203], v[44:47], 0
    v_mfma_f32_16x16x32_bf16 v[228:231], v[200:203], v[52:55], 0
    v_mfma_f32_16x16x32_bf16 v[204:207], v[200:203], v[28:31], v[204:207]
    v_mfma_f32_16x16x32_bf16 v[212:215], v[28:31], v[28:31], v[212:215]
    s_add_u32 m0, s66, 151552
    s_add_u32 s101, s87, 4096
    buffer_load_dwordx4 v6, s[32:35], s101 offen offset:0  lds
    v_mfma_f32_16x16x32_bf16 v[208:211], v[200:203], v[32:35], v[208:211]
    v_mfma_f32_16x16x32_bf16 v[216:219], v[32:35], v[32:35], v[216:219]
    v_mfma_f32_16x16x32_bf16 v[220:223], v[200:203], v[40:43], v[220:223]
    v_mfma_f32_16x16x32_bf16 v[224:227], v[200:203], v[48:51], v[224:227]
    s_add_u32 m0, s66, 135168
    s_nop 0
    buffer_load_dwordx4 v6, s[32:35], s87 offen offset:0  lds
    v_mfma_f32_16x16x32_bf16 v[228:231], v[200:203], v[56:59], v[228:231]
    v_and_b32 v196, 3, v2
    v_cmp_eq_u32 s[90:91], 1, v196
    v_cmp_eq_u32 s[92:93], 2, v196
    v_cmp_eq_u32_e64 vcc, 3, v196
    s_add_u32 m0, s65, 118784
    s_nop 0
    buffer_load_dwordx4 v5, s[28:31], s86 offen offset:0  lds
    v_cndmask_b32 v212, v212, v213, s[90:91]
    v_cndmask_b32 v212, v212, v214, s[92:93]
    v_cndmask_b32 v205, v212, v215, vcc
    v_cndmask_b32 v216, v216, v217, s[90:91]
    s_add_u32 m0, s67, 141312
    s_nop 0
    buffer_load_dwordx4 v7, s[32:35], s87 offen offset:2048  lds
    v_cndmask_b32 v216, v216, v218, s[92:93]
    v_cndmask_b32 v209, v216, v219, vcc
    v_lshrrev_b32_e64 v196, 4, v2
    v_cmp_eq_u32 s[90:91], 1, v196
    v_cmp_eq_u32_e64 vcc, 2, v196
    s_add_u32 m0, s65, 120832
    s_add_u32 s101, s86, 32768
    buffer_load_dwordx4 v5, s[28:31], s101 offen offset:0  lds
    v_cndmask_b32 v220, v220, v224, s[90:91]
    v_cndmask_b32_e64 v220, v220, v228, vcc
    s_mul_i32 s78, s77, 768
    s_mul_i32 s79, s76, 192
    s_add_u32 m0, s67, 151552
    s_add_u32 s101, s87, 4096
    buffer_load_dwordx4 v7, s[32:35], s101 offen offset:0  lds
    s_add_u32 s78, s78, s79
    s_add_u32 s78, s78, 327680
    v_lshlrev_b32 v197, 2, v2
    s_mov_b32 exec_hi, 0xffff
    buffer_store_dword v220, v197, s[36:39], s78 offen sc1
    s_mov_b32 exec_hi, -1
    s_lshl_b32 s78, s69, 4
    s_add_u32 m0, s67, 135168
    s_nop 0
    buffer_load_dwordx4 v7, s[32:35], s87 offen offset:0  lds
    s_add_u32 s86, s86, 128
    s_add_u32 s87, s87, 393216
    s_and_b32 s86, s86, 2047
    s_cselect_b32 s87, s87, 0
    s_mov_b32 s101, 40960
    s_cmp_ge_i32 s64, 0
    s_cselect_b32 s101, 0xfffec000, s101
    s_add_u32 s64, s64, s101
    s_add_u32 s65, s65, s101
    s_add_u32 s66, s66, s101
    s_add_u32 s67, s67, s101
    s_add_u32 s78, s78, s70
    s_lshl_b32 s78, s78, 10
    s_lshl_b32 s79, s76, 8
    s_add_u32 s78, s78, s79
    buffer_store_dwordx4 v[16:19], v14, s[36:39], s96 offen offset:0 sc1
    s_add_u32 s78, s78, 65536
    v_and_b32 v198, 15, v2
    v_lshlrev_b32_e64 v198, 3, v198
    s_mov_b32 exec_lo, 0x00f0000f
    s_mov_b32 exec_hi, 0xf0000f00
    buffer_store_dwordx2 v[204:205], v198, s[36:39], s78 offen offset:0 sc1
    s_mov_b64 exec, -1
    s_mov_b32 exec_lo, 0x00f0000f
    s_mov_b32 exec_hi, 0xf0000f00
    buffer_store_dwordx2 v[208:209], v198, s[36:39], s78 offen offset:128 sc1
    s_mov_b64 exec, -1
    s_setprio 0
    s_waitcnt vmcnt(14)
    s_cmp_lg_u32 s3, 1
    s_cbranch_scc1 Lcs_2
    s_call_b64 s[90:91], L_cl0
Lcs_2:
    s_barrier
    s_call_b64 s[90:91], L_iss
    s_waitcnt vmcnt(10)
    s_cmp_lg_u32 s3, 2
    s_cbranch_scc1 Lcs_3
    s_call_b64 s[90:91], L_cl0
Lcs_3:
    s_barrier
    s_cmp_lg_u32 s76, 0
    s_cbranch_scc1 Lfl_4
    s_getreg_b32 s99, hwreg(HW_REG_XCC_ID, 0, 4)
    v_mov_b32 v198, s75
    v_mov_b32 v199, s99
    v_lshlrev_b32 v197, 3, v2
    s_lshl_b32 s78, s77, 7
    s_lshl_b32 s79, s77, 9
    s_add_u32 s79, s79, 8912896
    s_add_u32 s78, s78, 4096
    s_lshl_b32 s80, s71, 4
    s_add_u32 s80, s80, s72
    s_lshl_b32 s80, s80, 7
    s_add_u32 s80, s80, 8847360
    s_mov_b64 exec, 0xffff
    buffer_store_dwordx2 v[198:199], v197, s[36:39], s78 offen sc1
    buffer_store_dwordx2 v[198:199], v197, s[36:39], s80 offen sc1
    s_mov_b64 exec, -1
    v_not_b32 v200, v198
    v_mov_b32 v201, 0
    buffer_store_dwordx2 v[200:201], v197, s[36:39], s79 offen sc1
    v_and_b32 v196, 15, v2
    v_lshlrev_b32 v197, 4, v196
    v_add_u32_e64 v197, s69, v197
    s_lshl_b32 s78, s70, 4
    s_lshl_b32 s79, s71, 4
    s_add_u32 s79, s79, 69088
    v_mov_b32 v202, s78
    v_mov_b32 v203, s79
    v_cmp_gt_u32 vcc, 32, v2
    s_nop 1
    v_cndmask_b32 v202, v203, v202, vcc
    v_add_u32 v196, v202, v196
    v_cmp_gt_u32 vcc, 16, v2
    s_nop 1
    v_cndmask_b32 v196, v196, v197, vcc
    v_lshlrev_b32 v196, 7, v196
    v_add_u32 v196, 4096, v196
Lfl_4:
    s_call_b64 s[90:91], L_iss
    s_waitcnt vmcnt(10)
    s_cmp_lg_u32 s3, 3
    s_cbranch_scc1 Lcs_5
    s_call_b64 s[90:91], L_cl0
Lcs_5:
    s_barrier
    s_call_b64 s[90:91], L_iss
    s_waitcnt vmcnt(10)
    s_cmp_lg_u32 s3, 4
    s_cbranch_scc1 Lcs_6
    s_call_b64 s[90:91], L_cl0
Lcs_6:
    s_barrier
    s_call_b64 s[90:91], L_iss
    s_waitcnt vmcnt(10)
    s_cmp_lg_u32 s3, 0
    s_cbranch_scc1 Lcs_7
    s_call_b64 s[90:91], L_cl1
Lcs_7:
    s_barrier
    s_call_b64 s[90:91], L_iss
    s_waitcnt vmcnt(10)
    s_cmp_lg_u32 s3, 1
    s_cbranch_scc1 Lcs_8
    s_call_b64 s[90:91], L_cl1
Lcs_8:
    s_barrier
    s_call_b64 s[90:91], L_iss
    s_waitcnt vmcnt(10)
    s_cmp_lg_u32 s3, 2
    s_cbranch_scc1 Lcs_9
    s_call_b64 s[90:91], L_cl1
Lcs_9:
    s_barrier
    s_call_b64 s[90:91], L_iss
    s_waitcnt vmcnt(10)
    s_cmp_lg_u32 s3, 3
    s_cbranch_scc1 Lcs_10
    s_call_b64 s[90:91], L_cl1
Lcs_10:
    s_barrier
    s_call_b64 s[90:91], L_iss
    s_waitcnt vmcnt(10)
    s_cmp_lg_u32 s3, 4
    s_cbranch_scc1 Lcs_11
    s_call_b64 s[90:91], L_cl1
Lcs_11:
    s_barrier
    s_cmp_lg_u32 s76, 0
    s_cbranch_scc1 Lpl_12
    s_mov_b32 exec_hi, 0xffff
    buffer_load_dwordx2 v[198:199], v196, s[36:39], 0 offen sc1
    s_mov_b64 exec, -1
Lpl_12:
    s_call_b64 s[90:91], L_iss
    s_cmp_lg_u32 s76, 1
    s_cbranch_scc1 Lpf_13
    s_getpc_b64 s[90:91]
Lpc_14:
    s_add_u32 s90, s90, L_phend-Lpc_14
    s_addc_u32 s91, s91, 0
    s_lshr_b32 s100, s2, 3
    s_lshl_b32 s100, s100, 10
    s_min_u32 s100, s100, (L_end-L_phend-768)
    v_add_u32_e64 v236, s100, v14
    global_load_dword v236, v236, s[90:91]
Lpf_13:
    s_waitcnt vmcnt(10)
    s_barrier
    s_cmp_lg_u32 s76, 2
    s_cbranch_scc1 Lc4_15
    s_mov_b32 exec_hi, -1
    buffer_load_dword v238, v63, s[40:43], 0 offen
    s_mov_b64 exec, -1
Lc4_15:
    s_call_b64 s[90:91], L_iss
    s_waitcnt vmcnt(10)
    s_cmp_lg_u32 s76, 0
    s_cbranch_scc1 Lpc_16
    s_mov_b32 exec_hi, 0xffff
    s_mov_b32 s85, 0
    s_branch Lpk_17
Lspin_18:
    s_add_u32 s85, s85, 1
    s_cmp_gt_u32 s85, 400000
    s_cbranch_scc1 L_end
    buffer_load_dwordx2 v[198:199], v196, s[36:39], 0 offen sc1
    s_waitcnt vmcnt(0)
Lpk_17:
    v_cmp_ne_u32 vcc, s75, v198
    s_cbranch_vccnz Lspin_18
    v_cmp_ne_u32 vcc, s99, v199
    s_mov_b64 exec, -1
    s_lshr_b32 s78, vcc_lo, 16
    s_cselect_b32 s78, 0, 1
    s_cmp_eq_u32 vcc_hi, 0
    s_cselect_b32 s79, 2, 0
    s_or_b32 s78, s78, s79
    s_and_b32 s78, s78, 3
    v_mov_b32 v198, s78
    v_mov_b32 v199, 163584
    ds_write_b32 v199, v198
    s_waitcnt lgkmcnt(0)
Lpc_16:
    s_barrier
    v_lshrrev_b32 v196, 4, v2
    v_and_b32 v197, 15, v2
    v_lshlrev_b32_e64 v197, 4, v197
    v_lshl_add_u32 v198, v196, 10, v197
    s_lshl_b32 s78, s69, 14
    s_lshl_b32 s79, s76, 8
    s_add_u32 s78, s78, s79
    s_nop 0
    s_add_u32 s78, s78, 65536
    buffer_load_dwordx4 v[20:23], v198, s[36:39], s78 offen sc1
    s_add_u32 s78, s78, 4096
    buffer_load_dwordx4 v[24:27], v198, s[36:39], s78 offen sc1
    s_add_u32 s78, s78, 4096
    buffer_load_dwordx4 v[28:31], v198, s[36:39], s78 offen sc1
    s_add_u32 s78, s78, 4096
    buffer_load_dwordx4 v[32:35], v198, s[36:39], s78 offen sc1
    v_mul_u32_u24 v198, 768, v196
    v_add_u32_e64 v198, v198, v197
    s_mul_i32 s78, s70, 12288
    s_lshl_b32 s79, s76, 8
    s_add_u32 s78, s78, s79
    s_add_u32 s78, s78, 327680
    s_cmp_eq_u32 s76, 3
    s_nop 0
    s_cselect_b32 s78, 0x10000000, s78
    buffer_load_dwordx4 v[36:39], v198, s[36:39], s78 offen sc1
    s_add_u32 s78, s78, 3072
    buffer_load_dwordx4 v[40:43], v198, s[36:39], s78 offen sc1
    s_add_u32 s78, s78, 3072
    buffer_load_dwordx4 v[44:47], v198, s[36:39], s78 offen sc1
    s_add_u32 s78, s78, 3072
    buffer_load_dwordx4 v[48:51], v198, s[36:39], s78 offen sc1
    s_add_u32 m0, s84, 0
    s_mov_b32 s100, 0
    buffer_load_dwordx4 v246, s[40:43], s100 offen  lds
    s_add_u32 m0, s84, 4096
    s_mov_b32 s100, 65536
    buffer_load_dwordx4 v246, s[40:43], s100 offen  lds
    s_add_u32 m0, s84, 8192
    s_mov_b32 s100, 131072
    buffer_load_dwordx4 v246, s[40:43], s100 offen  lds
    s_add_u32 m0, s84, 12288
    s_mov_b32 s100, 196608
    buffer_load_dwordx4 v246, s[40:43], s100 offen  lds
    s_waitcnt vmcnt(12)
    s_waitcnt lgkmcnt(0)
    s_barrier
    s_setprio 2
    s_add_u32 m0, s84, 16384
    s_mov_b32 s100, 262144
    buffer_load_dwordx4 v246, s[40:43], s100 offen  lds
    s_waitcnt vmcnt(9)
    v_add_f32 v20, v20, v24
    v_add_f32 v21, v21, v25
    v_add_f32 v22, v22, v26
    v_add_f32 v23, v23, v27
    v_add_f32 v20, v20, v28
    v_add_f32_e64 v21, v21, v29
    s_add_u32 m0, s84, 20480
    s_mov_b32 s100, 327680
    buffer_load_dwordx4 v246, s[40:43], s100 offen  lds
    v_add_f32 v22, v22, v30
    v_add_f32 v23, v23, v31
    v_add_f32 v20, v20, v32
    v_add_f32 v21, v21, v33
    v_add_f32 v22, v22, v34
    v_add_f32 v23, v23, v35
    s_nop 0
    v_permlane32_swap_b32 v20, v22
    s_add_u32 m0, s84, 24576
    s_mov_b32 s100, 393216
    buffer_load_dwordx4 v246, s[40:43], s100 offen  lds
    v_permlane32_swap_b32 v21, v23
    v_add_f32 v20, v20, v22
    v_add_f32 v21, v21, v23
    v_mov_b32 v22, v20
    v_mov_b32 v23, v21
    s_nop 0
    v_permlane16_swap_b32 v20, v22
    v_permlane16_swap_b32 v21, v23
    v_add_f32_e64 v20, v20, v22
    s_add_u32 m0, s84, 28672
    s_mov_b32 s100, 458752
    buffer_load_dwordx4 v246, s[40:43], s100 offen  lds
    v_add_f32_e64 v21, v21, v23
    v_mul_f32 v24, 0x3a800000, v20
    v_mul_f32 v26, 0x3a800000, v21
    v_fma_f32 v26, -v24, v24, v26
    v_max_f32_e64 v26, 0, v26
    v_cvt_pk_bf16_f32 v24, v24, v24
    v_and_b32 v24, 0xffff0000, v24
    s_add_u32 m0, s84, 32768
    s_mov_b32 s100, 524288
    buffer_load_dwordx4 v246, s[40:43], s100 offen  lds
    v_cvt_pk_bf16_f32 v26, v26, v26
    v_and_b32 v26, 0xffff0000, v26
    v_add_f32 v26, 0x3727c5ac, v26
    v_cvt_pk_bf16_f32 v26, v26, v26
    v_and_b32 v26, 0xffff0000, v26
    v_sqrt_f32 v26, v26
    s_nop 0
    v_cvt_pk_bf16_f32 v26, v26, v26
    v_and_b32 v26, 0xffff0000, v26
    s_add_u32 m0, s84, 36864
    s_mov_b32 s100, 589824
    buffer_load_dwordx4 v246, s[40:43], s100 offen  lds
    v_rcp_f32_e64 v25, v26
    v_xor_b32 v26, 0x80000000, v24
    v_lshrrev_b32 v27, 16, v26
    v_or_b32 v26, v26, v27
    v_mov_b32 v27, 0
    v_and_b32 v196, 15, v2
    v_lshrrev_b32_e64 v197, 5, v2
    s_add_u32 m0, s84, 40960
    s_mov_b32 s100, 655360
    buffer_load_dwordx4 v246, s[40:43], s100 offen  lds
    v_lshl_add_u32 v196, v196, 1, v197
    s_lshl_b32 s78, s76, 5
    v_add_u32 v196, s78, v196
    v_lshlrev_b32_e64 v197, 3, v196
    v_add_u32 v197, 159744, v197
    v_lshlrev_b32_e64 v196, 2, v196
    v_add_u32 v196, 162304, v196
    s_add_u32 m0, s84, 45056
    s_mov_b32 s100, 720896
    buffer_load_dwordx4 v246, s[40:43], s100 offen  lds
    ds_write_b64 v197, v[26:27]
    ds_write_b32 v196, v25
    s_waitcnt vmcnt(12)
    v_add_f32 v36, v36, v40
    v_add_f32 v37, v37, v41
    v_add_f32 v38, v38, v42
    v_add_f32 v39, v39, v43
    v_add_f32 v36, v36, v44
    s_add_u32 m0, s84, 49152
    s_mov_b32 s100, 786432
    buffer_load_dwordx4 v246, s[40:43], s100 offen  lds
    v_add_f32 v37, v37, v45
    v_add_f32 v38, v38, v46
    v_add_f32 v39, v39, v47
    v_add_f32 v36, v36, v48
    v_add_f32 v37, v37, v49
    v_add_f32 v38, v38, v50
    v_add_f32_e64 v39, v39, v51
    s_add_u32 m0, s84, 53248
    s_mov_b32 s100, 851968
    buffer_load_dwordx4 v246, s[40:43], s100 offen  lds
    v_permlane32_swap_b32 v36, v38
    v_permlane32_swap_b32 v37, v39
    v_add_f32 v36, v36, v38
    v_add_f32 v37, v37, v39
    s_nop 1
    v_permlane16_swap_b32 v36, v37
    v_add_f32_e64 v36, v36, v37
    v_cvt_pk_bf16_f32 v37, v36, v36
    v_and_b32 v37, 0xffff0000, v37
    s_add_u32 m0, s84, 57344
    s_mov_b32 s100, 917504
    buffer_load_dwordx4 v246, s[40:43], s100 offen  lds
    v_sub_f32_e64 v38, v36, v37
    v_cvt_pk_bf16_f32 v38, v37, v38
    v_mov_b32 v39, 0
    v_and_b32 v196, 15, v2
    v_lshrrev_b32_e64 v197, 4, v2
    v_lshl_add_u32 v196, v196, 2, v197
    s_lshl_b32 s78, s76, 9
    s_add_u32 m0, s84, 61440
    s_mov_b32 s100, 983040
    buffer_load_dwordx4 v246, s[40:43], s100 offen  lds
    s_add_u32 s78, s78, 160768
    v_lshl_add_u32 v196, v196, 3, s78
    v_and_b32 v197, 15, v2
    v_lshlrev_b32_e64 v197, 3, v197
    v_add_u32 v197, 162816, v197
    v_mov_b32 v198, 0x3f803f80
    s_cmp_eq_u32 s76, 3
    s_cselect_b64 vcc, -1, 0
    v_cndmask_b32 v196, v196, v197, vcc
    v_cndmask_b32 v38, v38, v198, vcc
    v_cndmask_b32_e64 v39, v39, v198, vcc
    ds_write_b64 v196, v[38:39]
    s_setprio 0
    s_waitcnt lgkmcnt(0)
    s_barrier
L_phend:
    s_mov_b32 s66, s96
    s_add_u32 m0, s84, 65536
    s_mov_b32 s100, 1048576
    buffer_load_dwordx4 v246, s[40:43], s100 offen  lds
    v_lshrrev_b32 v52, 2, v2
    v_and_b32 v53, 7, v52
    v_and_b32_e64 v55, 3, v2
    s_add_u32 m0, s84, 69632
    s_mov_b32 s100, 1114112
    buffer_load_dwordx4 v246, s[40:43], s100 offen  lds
    v_xor_b32 v53, v53, v55
    v_lshlrev_b32 v52, 7, v52
    v_lshrrev_b32_e64 v55, 1, v55
    s_add_u32 m0, s84, 73728
    s_mov_b32 s100, 1179648
    buffer_load_dwordx4 v246, s[40:43], s100 offen  lds
    v_lshl_add_u32 v52, v55, 3, v52
    s_lshr_b32 s78, s76, 1
    s_and_b32 s79, s76, 1
    s_lshl_b32 s80, s79, 2
    s_add_u32 m0, s84, 77824
    s_mov_b32 s100, 1245184
    buffer_load_dwordx4 v246, s[40:43], s100 offen  lds
    s_lshl_b32 s81, s78, 2
    v_xor_b32 v55, s80, v53
    v_xor_b32 v53, s81, v53
    s_add_u32 m0, s84, 81920
    s_mov_b32 s100, 1310720
    buffer_load_dwordx4 v246, s[40:43], s100 offen  lds
    s_lshl_b32 s80, s78, 14
    s_add_u32 s80, s80, 110592
    v_lshl_add_u32 v196, v55, 4, v52
    v_add_u32 v196, s80, v196
    s_add_u32 m0, s84, 86016
    s_mov_b32 s100, 1376256
    buffer_load_dwordx4 v246, s[40:43], s100 offen  lds
    v_lshl_add_u32 v198, v53, 4, v52
    v_add_u32 v198, 143360, v198
    v_xor_b32_e64 v197, 8, v196
    s_add_u32 m0, s84, 90112
    s_mov_b32 s100, 1441792
    buffer_load_dwordx4 v246, s[40:43], s100 offen  lds
    v_xor_b32_e64 v199, 8, v198
    v_mov_b32 v200, 0x3f803f80
    v_mov_b32 v201, 0x3f803f80
    v_mov_b32 v202, 0x3f803f80
    s_add_u32 m0, s84, 94208
    s_mov_b32 s100, 1507328
    buffer_load_dwordx4 v246, s[40:43], s100 offen  lds
    v_mov_b32 v203, 0x3f803f80
    v_lshrrev_b32 v62, 4, v2
    v_and_b32 v52, 15, v2
    s_add_u32 m0, s84, 98304
    s_mov_b32 s100, 1572864
    buffer_load_dwordx4 v246, s[40:43], s100 offen  lds
    v_lshlrev_b32_e64 v53, 4, v52
    v_lshl_add_u32 v62, v62, 13, v53
    v_lshrrev_b32_e64 v52, 3, v52
    v_lshl_add_u32 v62, v52, 8, v62
    s_add_u32 m0, s84, 102400
    s_mov_b32 s100, 1638400
    buffer_load_dwordx4 v246, s[40:43], s100 offen  lds
    v_xor_b32 v63, 256, v62
    s_lshl_b32 s78, s70, 2
    s_add_u32 s78, s78, s76
    s_add_u32 m0, s84, 106496
    s_mov_b32 s100, 1703936
    buffer_load_dwordx4 v246, s[40:43], s100 offen  lds
    s_lshl_b32 s78, s78, 15
    s_lshl_b32 s79, s69, 9
    s_add_u32 s78, s78, s79
    s_add_u32 s78, s78, 2097152
    s_mov_b32 s100, 2031616
    buffer_load_dwordx4 v[160:163], v246, s[40:43], s100 offen
    s_lshl_b32 s79, s77, 10
    s_lshl_b32 s80, s76, 6
    s_add_u32 s79, s79, s80
    s_mov_b32 s100, 1966080
    buffer_load_dwordx4 v[164:167], v246, s[40:43], s100 offen
    s_add_u32 s79, s79, 8389120
    v_lshrrev_b32 v52, 3, v2
    v_and_b32 v53, 7, v2
    v_lshlrev_b32_e64 v53, 4, v53
    s_mov_b32 s100, 1900544
    buffer_load_dwordx4 v[168:171], v246, s[40:43], s100 offen
    v_lshl_add_u32 v56, v52, 9, v53
    v_lshl_add_u32 v57, v52, 1, v53
    s_lshl_b32 s82, s70, 14
    s_mov_b32 s100, 1835008
    buffer_load_dwordx4 v[172:175], v246, s[40:43], s100 offen
    s_add_u32 s82, s82, s80
    s_add_u32 s82, s82, 8389120
    s_add_u32 s80, s80, 162944
    v_lshrrev_b32_e64 v58, 2, v2
    s_mov_b32 s100, 1769472
    buffer_load_dwordx4 v[176:179], v246, s[40:43], s100 offen
    v_and_b32 v53, 3, v2
    v_lshlrev_b32 v53, 4, v53
    v_lshl_add_u32 v58, v58, 10, v53
    s_mov_b32 s100, 0
    buffer_load_dwordx4 v[180:183], v247, s[28:31], s100 offen
    v_lshl_add_u32 v59, v52, 1, v53
    v_add_u32 v59, s80, v59
    s_lshl_b32 s64, s77, 13
    s_lshl_b32 s80, s76, 7
    s_mov_b32 s100, 16384
    buffer_load_dwordx4 v[184:187], v248, s[28:31], s100 offen
    s_add_u32 s64, s64, s80
    s_add_u32 s64, s64, 2097152
    s_add_u32 s65, s64, 4096
    s_mov_b32 s100, 32768
    buffer_load_dwordx4 v[188:191], v247, s[28:31], s100 offen
    s_lshl_b32 s81, s77, 10
    s_add_u32 s81, s81, s80
    s_add_u32 s81, s81, 8388608
    s_lshl_b32 s80, s71, 9
    s_mov_b32 s100, 49152
    buffer_load_dwordx4 v[192:195], v248, s[28:31], s100 offen
    s_add_u32 s80, s80, 8912896
    v_lshl_add_u32 v61, v2, 13, s80
    v_mov_b32 v52, 163584
    s_lshl_b32 s100, s77, 13
    s_add_u32 s100, s100, s89
    s_add_u32 s100, s100, 2097152
    buffer_load_dwordx4 v[252:255], v14, s[36:39], s100 offen offset:0 sc1
    ds_read_b32 v52, v52
    s_waitcnt lgkmcnt(0)
    v_readfirstlane_b32 s99, v52
    s_and_b32 s94, s69, 1
    s_lshl_b32 s100, s77, 13
    s_add_u32 s100, s100, s89
    s_nop 0
    s_add_u32 s100, s100, 2097152
    buffer_load_dwordx4 v[252:255], v14, s[36:39], s100 offen offset:1024 sc1
    s_mul_i32 s94, s94, 0x00010001
    s_mov_b32 s95, 0xfffefffe
    s_and_b32 s96, s75, 0x00010001
    buffer_load_dwordx4 v[252:255], v14, s[36:39], s66 offen sc1
    v_mov_b32_e64 v54, s96
    s_and_b32 s83, s75, 1
    s_lshl_b32 s83, s83, 16
    s_sub_u32 s83, 0, s83
    s_barrier
    ds_read_b64_tr_b16 v[4:5], v196 offset:0
    ds_read_b64_tr_b16 v[6:7], v196 offset:2048
    ds_read_b64_tr_b16 v[12:13], v198 offset:0
    ds_read_b64_tr_b16 v[14:15], v198 offset:2048
    ds_read_b64_tr_b16 v[8:9], v197 offset:0
    ds_read_b64_tr_b16 v[10:11], v197 offset:2048
    ds_read_b64_tr_b16 v[16:17], v199 offset:0
    ds_read_b64_tr_b16 v[18:19], v199 offset:2048
    ds_read_b64_tr_b16 v[20:21], v196 offset:4096
    ds_read_b64_tr_b16 v[22:23], v196 offset:6144
    ds_read_b64_tr_b16 v[28:29], v198 offset:4096
    ds_read_b64_tr_b16 v[30:31], v198 offset:6144
    ds_read_b64_tr_b16 v[24:25], v197 offset:4096
    ds_read_b64_tr_b16 v[26:27], v197 offset:6144
    s_waitcnt lgkmcnt(10)
    v_mfma_f32_16x16x32_bf16 v[204:207], v[4:7], v[12:15], 0
    ds_read_b64_tr_b16 v[32:33], v199 offset:4096
    ds_read_b64_tr_b16 v[34:35], v199 offset:6144
    s_waitcnt lgkmcnt(10)
    v_mfma_f32_16x16x32_bf16 v[208:211], v[8:11], v[12:15], 0
    ds_read_b64_tr_b16 v[36:37], v196 offset:8192
    ds_read_b64_tr_b16 v[38:39], v196 offset:10240
    s_waitcnt lgkmcnt(10)
    s_nop 0
    v_mfma_f32_16x16x32_bf16 v[216:219], v[8:11], v[16:19], 0
    ds_read_b64_tr_b16 v[44:45], v198 offset:8192
    ds_read_b64_tr_b16 v[46:47], v198 offset:10240
    v_mfma_f32_16x16x32_bf16 v[212:215], v[4:7], v[16:19], 0
    ds_read_b64_tr_b16 v[40:41], v197 offset:8192
    ds_read_b64_tr_b16 v[42:43], v197 offset:10240
    s_waitcnt lgkmcnt(10)
    v_mfma_f32_16x16x32_bf16 v[204:207], v[20:23], v[28:31], v[204:207]
    ds_read_b64_tr_b16 v[48:49], v199 offset:8192
    ds_read_b64_tr_b16 v[50:51], v199 offset:10240
    s_waitcnt lgkmcnt(10)
    v_mfma_f32_16x16x32_bf16 v[208:211], v[24:27], v[28:31], v[208:211]
    ds_read_b64_tr_b16 v[228:229], v196 offset:12288
    ds_read_b64_tr_b16 v[230:231], v196 offset:14336
    s_waitcnt lgkmcnt(10)
    s_nop 0
    v_mfma_f32_16x16x32_bf16 v[216:219], v[24:27], v[32:35], v[216:219]
    ds_read_b64_tr_b16 v[236:237], v198 offset:12288
    ds_read_b64_tr_b16 v[238:239], v198 offset:14336
    v_mfma_f32_16x16x32_bf16 v[212:215], v[20:23], v[32:35], v[212:215]
    ds_read_b64_tr_b16 v[232:233], v197 offset:12288
    ds_read_b64_tr_b16 v[234:235], v197 offset:14336
    s_waitcnt lgkmcnt(10)
    v_mfma_f32_16x16x32_bf16 v[204:207], v[36:39], v[44:47], v[204:207]
    ds_read_b64_tr_b16 v[240:241], v199 offset:12288
    ds_read_b64_tr_b16 v[242:243], v199 offset:14336
    s_waitcnt lgkmcnt(10)
    v_mfma_f32_16x16x32_bf16 v[208:211], v[40:43], v[44:47], v[208:211]
    s_waitcnt lgkmcnt(8)
    v_mfma_f32_16x16x32_bf16 v[216:219], v[40:43], v[48:51], v[216:219]
    v_mfma_f32_16x16x32_bf16 v[212:215], v[36:39], v[48:51], v[212:215]
    s_waitcnt lgkmcnt(4)
    v_mfma_f32_16x16x32_bf16 v[204:207], v[228:231], v[236:239], v[204:207]
    s_waitcnt lgkmcnt(2)
    v_mfma_f32_16x16x32_bf16 v[208:211], v[232:235], v[236:239], v[208:211]
    s_waitcnt lgkmcnt(0)
    v_mfma_f32_16x16x32_bf16 v[216:219], v[232:235], v[240:243], v[216:219]
    v_mfma_f32_16x16x32_bf16 v[212:215], v[228:231], v[240:243], v[212:215]
    v_mfma_f32_16x16x32_bf16 v[220:223], v[4:7], v[200:203], 0
    v_mfma_f32_16x16x32_bf16 v[224:227], v[8:11], v[200:203], 0
    v_mfma_f32_16x16x32_bf16 v[220:223], v[20:23], v[200:203], v[220:223]
    v_mfma_f32_16x16x32_bf16 v[224:227], v[24:27], v[200:203], v[224:227]
    v_cvt_pk_bf16_f32 v12, v204, v205
    v_cvt_pk_bf16_f32 v13, v206, v207
    v_cvt_pk_bf16_f32 v14, v208, v209
    v_cvt_pk_bf16_f32 v15, v210, v211
    v_mfma_f32_16x16x32_bf16 v[220:223], v[36:39], v[200:203], v[220:223]
    v_add_u32_e64 v12, s94, v12
    v_and_or_b32 v12, v12, s95, v54
    v_mfma_f32_16x16x32_bf16 v[224:227], v[40:43], v[200:203], v[224:227]
    v_add_u32_e64 v13, s94, v13
    v_and_or_b32 v13, v13, s95, v54
    v_mfma_f32_16x16x32_bf16 v[220:223], v[228:231], v[200:203], v[220:223]
    v_add_u32_e64 v14, s94, v14
    v_and_or_b32 v14, v14, s95, v54
    v_mfma_f32_16x16x32_bf16 v[224:227], v[232:235], v[200:203], v[224:227]
    v_add_u32_e64 v15, s94, v15
    v_and_or_b32 v15, v15, s95, v54
    s_bitcmp1_b32 s99, 0
    s_cbranch_scc1 Lls_19
    buffer_store_dwordx4 v[12:15], v62, s[36:39], s78 offen sc1
    s_branch Lle_20
Lls_19:
    buffer_store_dwordx4 v[12:15], v62, s[36:39], s78 offen
Lle_20:
    v_cvt_pk_bf16_f32 v28, v212, v213
    v_cvt_pk_bf16_f32 v29, v214, v215
    v_cvt_pk_bf16_f32 v30, v216, v217
    v_cvt_pk_bf16_f32 v31, v218, v219
    v_add_u32 v28, s94, v28
    v_and_or_b32 v28, v28, s95, v54
    v_add_u32_e64 v29, s94, v29
    v_and_or_b32 v29, v29, s95, v54
    v_add_u32_e64 v30, s94, v30
    v_and_or_b32 v30, v30, s95, v54
    v_add_u32_e64 v31, s94, v31
    v_and_or_b32 v31, v31, s95, v54
    s_bitcmp1_b32 s99, 0
    s_cbranch_scc1 Lls_21
    buffer_store_dwordx4 v[28:31], v63, s[36:39], s78 offen sc1
    s_branch Lle_22
Lls_21:
    s_nop 0
    buffer_store_dwordx4 v[28:31], v63, s[36:39], s78 offen
Lle_22:
    v_cvt_pk_bf16_f32 v44, v220, v221
    v_cvt_pk_bf16_f32 v45, v222, v223
    v_cvt_pk_bf16_f32 v46, v224, v225
    v_cvt_pk_bf16_f32 v47, v226, v227
    s_mov_b32 exec_lo, 0x00010001
    s_mov_b32 exec_hi, 0x00010001
    s_bitcmp1_b32 s99, 0
    s_cbranch_scc1 Lls_23
    buffer_store_dwordx4 v[44:47], v2, s[36:39], s79 offen sc1
    s_branch Lle_24
Lls_23:
    buffer_store_dwordx4 v[44:47], v2, s[36:39], s79 offen
Lle_24:
    s_mov_b64 exec, -1
    s_sleep 3
    s_mov_b32 s85, 0
Lspin_25:
    s_add_u32 s85, s85, 1
    s_cmp_gt_u32 s85, 400000
    s_cbranch_scc1 L_end
    buffer_load_dwordx4 v[20:23], v56, s[36:39], s64 offen sc1
    buffer_load_dwordx4 v[24:27], v56, s[36:39], s65 offen sc1
    buffer_load_dwordx4 v[16:19], v58, s[36:39], s82 offen sc1
    s_waitcnt vmcnt(0)
Lchk_26:
    s_nop 0
    v_bitop3_b32 v28, v20, v24, v54 bitop3:0x7e
    v_bitop3_b32 v29, v21, v25, v54 bitop3:0x7e
    v_bitop3_b32 v30, v22, v26, v54 bitop3:0x7e
    v_bitop3_b32 v31, v23, v27, v54 bitop3:0x7e
    v_or3_b32 v28, v28, v29, v30
    v_cmp_eq_u32 s[90:91], -1, v16
    v_or_b32_e64 v28, v28, v31
    v_and_b32 v28, 0x00010001, v28
    v_cmp_ne_u32_e64 vcc, 0, v28
    s_or_b64 vcc, vcc, s[90:91]
    s_cbranch_vccnz Lspin_25
    v_lshl_add_u32 v28, v20, 16, s83
    v_and_b32 v29, 0xfffe0000, v20
    v_lshl_add_u32 v36, v24, 16, s83
    v_and_b32 v37, 0xfffe0000, v24
    v_pk_add_f32 v[28:29], v[28:29], v[36:37]
    v_lshl_add_u32 v30, v21, 16, s83
    v_and_b32 v31, 0xfffe0000, v21
    v_lshl_add_u32 v38, v25, 16, s83
    v_and_b32 v39, 0xfffe0000, v25
    v_pk_add_f32 v[30:31], v[30:31], v[38:39]
    v_lshl_add_u32 v32, v22, 16, s83
    v_and_b32 v33, 0xfffe0000, v22
    v_lshl_add_u32 v40, v26, 16, s83
    v_and_b32 v41, 0xfffe0000, v26
    v_pk_add_f32 v[32:33], v[32:33], v[40:41]
    v_lshl_add_u32 v34, v23, 16, s83
    v_and_b32 v35, 0xfffe0000, v23
    v_lshl_add_u32 v42, v27, 16, s83
    v_and_b32 v43, 0xfffe0000, v27
    v_pk_add_f32 v[34:35], v[34:35], v[42:43]
    v_permlane32_swap_b32 v28, v32
    v_permlane32_swap_b32 v29, v33
    v_permlane32_swap_b32 v30, v34
    v_permlane32_swap_b32 v31, v35
    v_pk_add_f32 v[28:29], v[28:29], v[32:33]
    v_pk_add_f32 v[30:31], v[30:31], v[34:35]
    s_nop 1
    v_permlane16_swap_b32 v28, v30
    v_permlane16_swap_b32_e64 v29, v31
    v_pk_add_f32 v[28:29], v[28:29], v[30:31]
    s_nop 1
    v_add_f32_dpp v28, v28, v28 row_ror:8 row_mask:0xf bank_mask:0xf
    v_add_f32_dpp v29, v29, v29 row_ror:8 row_mask:0xf bank_mask:0xf
    v_cvt_pk_bf16_f32 v36, v28, v29
    s_mov_b32 exec_lo, 0x00ff00ff
    s_mov_b32 exec_hi, 0x00ff00ff
    s_bitcmp1_b32 s99, 0
    s_cbranch_scc1 Lls_27
    buffer_store_dword v36, v57, s[36:39], s81 offen sc1
    s_branch Lle_28
Lls_27:
    buffer_store_dword v36, v57, s[36:39], s81 offen
Lle_28:
    s_mov_b64 exec, -1
    v_lshlrev_b32 v28, 16, v16
    v_and_b32 v29, 0xffff0000, v16
    v_lshlrev_b32_e64 v30, 16, v17
    v_and_b32 v31, 0xffff0000, v17
    v_lshlrev_b32_e64 v32, 16, v18
    v_and_b32 v33, 0xffff0000, v18
    v_lshlrev_b32_e64 v34, 16, v19
    v_and_b32 v35, 0xffff0000, v19
    v_permlane32_swap_b32 v28, v32
    v_permlane32_swap_b32 v29, v33
    v_permlane32_swap_b32 v30, v34
    v_permlane32_swap_b32 v31, v35
    v_pk_add_f32 v[28:29], v[28:29], v[32:33]
    v_pk_add_f32 v[30:31], v[30:31], v[34:35]
    s_nop 1
    v_permlane16_swap_b32 v28, v30
    v_permlane16_swap_b32_e64 v29, v31
    v_pk_add_f32 v[28:29], v[28:29], v[30:31]
    s_nop 1
    v_add_f32_dpp v38, v28, v28 row_ror:8 row_mask:0xf bank_mask:0x3
    s_nop 1
    v_add_f32_dpp v38, v29, v29 row_ror:8 row_mask:0xf bank_mask:0xc
    s_nop 1
    v_add_f32_dpp v37, v38, v38 row_shr:4 row_mask:0xf bank_mask:0xf
    v_cvt_pk_bf16_f32 v37, v37, v37
    s_mov_b32 exec_lo, 0xf0f0f0f0
    s_mov_b32 exec_hi, 0xf0f0f0f0
    ds_write_b16 v59, v37
    s_mov_b64 exec, -1
    s_waitcnt lgkmcnt(0)
    s_barrier
    s_sleep 4
    v_lshlrev_b32_e64 v4, 4, v2
    s_lshl_b32 s78, s76, 10
    s_add_u32 s78, s78, 110592
    v_add_u32 v5, s78, v4
    s_lshl_b32 s78, s76, 12
    s_add_u32 s78, s78, 131072
    v_add_u32_e64 v6, s78, v4
    ds_write_b128 v5, v[160:163] offset:16384
    ds_write_b128 v5, v[164:167] offset:12288
    ds_write_b128 v5, v[168:171] offset:8192
    ds_write_b128 v5, v[172:175] offset:4096
    ds_write_b128 v5, v[176:179] offset:0
    ds_write_b128 v6, v[180:183] offset:0
    ds_write_b128 v6, v[184:187] offset:1024
    ds_write_b128 v6, v[188:191] offset:2048
    ds_write_b128 v6, v[192:195] offset:3072
    s_waitcnt lgkmcnt(0)
    s_barrier
    s_mov_b32 s100, 50176
    buffer_load_dwordx4 v[92:95], v244, s[48:51], s100 offen nt
    s_mov_b32 s100, 50176
    buffer_load_dwordx4 v[124:127], v244, s[52:55], s100 offen nt
    s_mov_b32 s100, 0
    buffer_load_dwordx4 v[128:131], v245, s[56:59], s100 offen nt
    s_mov_b32 s100, 2048
    buffer_load_dwordx4 v[132:135], v245, s[56:59], s100 offen nt
    s_lshl_b32 s100, s77, 9
    s_add_u32 s100, s100, 8912896
    v_mov_b32 v48, s75
    v_mov_b32 v49, s75
    v_lshl_add_u32 v50, v2, 3, s100
    s_barrier
    s_cmp_lg_u32 s76, 0
    s_cbranch_scc1 Lfs_29
    buffer_store_dwordx2 v[48:49], v50, s[36:39], 0 offen sc1
Lfs_29:
    s_lshl_b32 s83, s71, 4
    s_add_u32 s83, s83, s72
    s_lshl_b32 s78, s0, 11
    s_and_b32 s79, s76, 1
    s_lshl_b32 s79, s79, 10
    s_add_u32 s78, s78, s79
    s_add_u32 s78, s78, 655360
    s_mul_i32 s79, s74, 56
    s_add_u32 s79, s79, s73
    s_lshl_b32 s79, s79, 10
    s_add_u32 s79, s79, 1114112
    s_cmp_eq_u32 s76, 1
    s_cselect_b32 s78, s79, s78
    s_cmp_ge_u32 s73, 56
    s_cselect_b32 s78, 0x10000000, s78
    s_lshl_b32 s79, s83, 9
    s_add_u32 s79, s79, 524288
    s_cmp_eq_u32 s76, 0
    s_cselect_b32 s78, s79, s78
    s_cselect_b32 s79, 0, -1
    v_mov_b32 v56, -1
    v_mov_b32 v57, -1
    v_mov_b32 v58, -1
    v_mov_b32 v59, -1
    s_mov_b32 exec_hi, s79
    buffer_store_dwordx4 v[56:59], v4, s[36:39], s78 offen sc1
    s_mov_b32 exec_hi, -1
    s_lshl_b32 s79, s83, 11
    s_add_u32 s79, s79, s84
    s_add_u32 s79, s79, 1572864
    s_cmp_lt_u32 s76, 2
    s_cselect_b32 s94, s79, s78
    s_cmp_lg_u32 s76, 2
    s_cbranch_scc1 Lf2_30
    s_mov_b64 exec, 0xffff
    s_mov_b32 s85, 1
    s_mov_b32 s101, 0
    s_sleep 14
    s_branch Lb_32
Lspin_31:
    s_add_u32 s85, s85, 1
    s_cmp_gt_u32 s85, 400000
    s_cbranch_scc1 L_end
    s_add_u32 s101, s101, 128
    s_min_u32 s101, s101, 384
Lb_32:
    buffer_load_dword v52, v61, s[36:39], s101 offen sc1
    s_waitcnt vmcnt(0)
    v_cmp_ne_u32_e64 vcc, s75, v52
    s_cbranch_vccnz Lspin_31
    s_mov_b64 exec, -1
Lf2_30:
    s_barrier
    s_waitcnt vmcnt(0)
    s_mov_b32 s100, 0x05040100
    s_mov_b32 s101, 0x07060302
    v_perm_b32 v7, v68, v64, s100
    v_perm_b32 v68, v68, v64, s101
    v_mov_b32_e64 v64, v7
    v_perm_b32 v7, v69, v65, s100
    v_perm_b32 v69, v69, v65, s101
    v_mov_b32_e64 v65, v7
    v_perm_b32 v7, v70, v66, s100
    v_perm_b32 v70, v70, v66, s101
    v_mov_b32_e64 v66, v7
    v_perm_b32 v7, v71, v67, s100
    v_perm_b32 v71, v71, v67, s101
    v_mov_b32_e64 v67, v7
    v_perm_b32 v7, v100, v96, s100
    v_perm_b32 v100, v100, v96, s101
    v_mov_b32_e64 v96, v7
    v_perm_b32 v7, v101, v97, s100
    v_perm_b32 v101, v101, v97, s101
    v_mov_b32_e64 v97, v7
    v_perm_b32 v7, v102, v98, s100
    v_perm_b32 v102, v102, v98, s101
    v_mov_b32_e64 v98, v7
    v_perm_b32 v7, v103, v99, s100
    v_perm_b32 v103, v103, v99, s101
    v_mov_b32_e64 v99, v7
    v_perm_b32 v7, v76, v72, s100
    v_perm_b32 v76, v76, v72, s101
    v_mov_b32_e64 v72, v7
    v_perm_b32 v7, v77, v73, s100
    v_perm_b32 v77, v77, v73, s101
    v_mov_b32_e64 v73, v7
    v_perm_b32 v7, v78, v74, s100
    v_perm_b32 v78, v78, v74, s101
    v_mov_b32_e64 v74, v7
    v_perm_b32 v7, v79, v75, s100
    v_perm_b32 v79, v79, v75, s101
    v_mov_b32_e64 v75, v7
    v_perm_b32 v7, v108, v104, s100
    v_perm_b32 v108, v108, v104, s101
    v_mov_b32_e64 v104, v7
    v_perm_b32 v7, v109, v105, s100
    v_perm_b32 v109, v109, v105, s101
    v_mov_b32_e64 v105, v7
    v_perm_b32 v7, v110, v106, s100
    v_perm_b32 v110, v110, v106, s101
    v_mov_b32_e64 v106, v7
    v_perm_b32 v7, v111, v107, s100
    v_perm_b32 v111, v111, v107, s101
    v_mov_b32_e64 v107, v7
    v_perm_b32 v7, v84, v80, s100
    v_perm_b32 v84, v84, v80, s101
    v_mov_b32_e64 v80, v7
    v_perm_b32 v7, v85, v81, s100
    v_perm_b32 v85, v85, v81, s101
    v_mov_b32_e64 v81, v7
    v_perm_b32 v7, v86, v82, s100
    v_perm_b32 v86, v86, v82, s101
    v_mov_b32_e64 v82, v7
    v_perm_b32 v7, v87, v83, s100
    v_perm_b32 v87, v87, v83, s101
    v_mov_b32_e64 v83, v7
    v_perm_b32 v7, v116, v112, s100
    v_perm_b32 v116, v116, v112, s101
    v_mov_b32_e64 v112, v7
    v_perm_b32 v7, v117, v113, s100
    v_perm_b32 v117, v117, v113, s101
    v_mov_b32_e64 v113, v7
    v_perm_b32 v7, v118, v114, s100
    v_perm_b32 v118, v118, v114, s101
    v_mov_b32_e64 v114, v7
    v_perm_b32 v7, v119, v115, s100
    v_perm_b32 v119, v119, v115, s101
    v_mov_b32_e64 v115, v7
    v_perm_b32 v7, v92, v88, s100
    v_perm_b32 v92, v92, v88, s101
    v_mov_b32_e64 v88, v7
    v_perm_b32 v7, v93, v89, s100
    v_perm_b32 v93, v93, v89, s101
    v_mov_b32_e64 v89, v7
    v_perm_b32 v7, v94, v90, s100
    v_perm_b32 v94, v94, v90, s101
    v_mov_b32_e64 v90, v7
    v_perm_b32 v7, v95, v91, s100
    v_perm_b32 v95, v95, v91, s101
    v_mov_b32_e64 v91, v7
    v_perm_b32 v7, v124, v120, s100
    v_perm_b32 v124, v124, v120, s101
    v_mov_b32_e64 v120, v7
    v_perm_b32 v7, v125, v121, s100
    v_perm_b32 v125, v125, v121, s101
    v_mov_b32_e64 v121, v7
    v_perm_b32 v7, v126, v122, s100
    v_perm_b32 v126, v126, v122, s101
    v_mov_b32_e64 v122, v7
    v_perm_b32 v7, v127, v123, s100
    v_perm_b32 v127, v127, v123, s101
    v_mov_b32_e64 v123, v7
    v_perm_b32 v7, v132, v128, s100
    v_perm_b32 v132, v132, v128, s101
    v_mov_b32_e64 v128, v7
    v_perm_b32 v7, v133, v129, s100
    v_perm_b32 v133, v133, v129, s101
    v_mov_b32_e64 v129, v7
    v_perm_b32 v7, v134, v130, s100
    v_perm_b32 v134, v134, v130, s101
    v_mov_b32_e64 v130, v7
    v_perm_b32 v7, v135, v131, s100
    v_perm_b32 v135, v135, v131, s101
    v_mov_b32 v131, v7
    v_lshrrev_b32 v8, 3, v2
    v_and_b32 v9, 7, v2
    v_lshlrev_b32 v10, 4, v9
    v_lshl_add_u32 v11, v8, 13, v10
    v_and_b32 v12, 15, v2
    v_lshlrev_b32 v12, 13, v12
    v_lshl_add_u32 v13, v8, 9, v10
    v_lshl_add_u32 v14, v9, 3, v8
    s_lshl_b32 s80, s74, 2
    s_add_u32 s80, s80, s76
    s_lshl_b32 s78, s80, 9
    s_add_u32 s78, s78, 524288
    s_add_u32 s79, s78, 65536
    s_add_u32 s81, s73, s76
    s_and_b32 s81, s81, 3
    s_andn2_b32 s100, s73, 3
    s_or_b32 s81, s81, s100
    s_lshl_b32 s81, s81, 13
    s_lshl_b32 s80, s80, 9
    s_add_u32 s80, s80, s81
    s_add_u32 s80, s80, 655360
    s_lshl_b32 s81, s73, 13
    s_add_u32 s81, s81, 655360
    s_barrier
    buffer_load_dwordx4 v[56:59], v4, s[36:39], s94 offen sc1
    s_mov_b32 s100, 4096
    buffer_load_dwordx4 v[136:139], v245, s[56:59], s100 offen nt
    s_mov_b32 s100, 6144
    buffer_load_dwordx4 v[140:143], v245, s[56:59], s100 offen nt
    s_mov_b32 s100, 8192
    buffer_load_dwordx4 v[144:147], v245, s[56:59], s100 offen nt
    s_mov_b32 s100, 10240
    buffer_load_dwordx4 v[148:151], v245, s[56:59], s100 offen nt
    s_barrier
    s_waitcnt vmcnt(0)
    s_mov_b32 s100, 0x05040100
    s_mov_b32 s101, 0x07060302
    v_perm_b32 v7, v140, v136, s100
    v_perm_b32 v140, v140, v136, s101
    v_mov_b32_e64 v136, v7
    v_perm_b32 v7, v141, v137, s100
    v_perm_b32 v141, v141, v137, s101
    v_mov_b32_e64 v137, v7
    v_perm_b32 v7, v142, v138, s100
    v_perm_b32 v142, v142, v138, s101
    v_mov_b32_e64 v138, v7
    v_perm_b32 v7, v143, v139, s100
    v_perm_b32 v143, v143, v139, s101
    v_mov_b32_e64 v139, v7
    v_perm_b32 v7, v148, v144, s100
    v_perm_b32 v148, v148, v144, s101
    v_mov_b32_e64 v144, v7
    v_perm_b32 v7, v149, v145, s100
    v_perm_b32 v149, v149, v145, s101
    v_mov_b32_e64 v145, v7
    v_perm_b32 v7, v150, v146, s100
    v_perm_b32 v150, v150, v146, s101
    v_mov_b32_e64 v146, v7
    v_perm_b32 v7, v151, v147, s100
    v_perm_b32 v151, v151, v147, s101
    v_mov_b32 v147, v7
    s_barrier
    s_mov_b32 s100, 12288
    buffer_load_dwordx4 v[152:155], v245, s[56:59], s100 offen nt
    s_mov_b32 s100, 14336
    buffer_load_dwordx4 v[156:159], v245, s[56:59], s100 offen nt
    s_and_b32 s79, s2, 7
    s_lshl_b32 s79, s79, 9
    s_add_u32 s79, s79, 524288
    s_mov_b64 exec, 0xffff
    s_mov_b32 s85, 1
    s_sleep 16
    s_branch Lb_34
Lspin_33:
    s_add_u32 s85, s85, 1
    s_cmp_gt_u32 s85, 400000
    s_cbranch_scc1 L_end
    s_or_b32 s79, s79, 4096
Lb_34:
    buffer_load_dwordx2 v[24:25], v12, s[36:39], s79 offen offset:128 sc1
    s_waitcnt vmcnt(0)
    v_cmp_ne_u32 vcc, s75, v25
    s_cbranch_vccnz Lspin_33
    v_max_f32_dpp v24, v24, v24 row_ror:8 row_mask:0xf bank_mask:0xf
    s_nop 1
    v_max_f32_dpp v24, v24, v24 row_ror:4 row_mask:0xf bank_mask:0xf
    s_nop 1
    v_max_f32_dpp v24, v24, v24 row_ror:2 row_mask:0xf bank_mask:0xf
    s_nop 1
    v_max_f32_dpp v24, v24, v24 row_ror:1 row_mask:0xf bank_mask:0xf
    s_nop 0
    v_readfirstlane_b32 s97, v24
    s_mov_b64 exec, -1
    s_nop 0
    v_mov_b32 v24, s97
    s_cmp_ge_u32 s73, 56
    s_cbranch_scc1 L_red
    s_bfe_u32 s79, s97, 0x40007
    s_lshl_b32 s79, s79, 13
    s_add_u32 s78, s78, s79
    v_lshlrev_b32_e64 v25, 4, v8
    s_mov_b32 s85, 0
Lspin_35:
    s_add_u32 s85, s85, 1
    s_cmp_gt_u32 s85, 400000
    s_cbranch_scc1 L_end
    buffer_load_dwordx4 v[20:23], v25, s[36:39], s78 offen sc1
    v_mov_b32 v26, 163360
    ds_write_b32 v26, v24
    v_lshlrev_b32_e64 v15, 3, v14
    s_waitcnt vmcnt(0) lgkmcnt(0)
    v_max3_u32 v16, v20, v21, v22
    v_max_u32 v16, v16, v23
    v_cmp_eq_u32_e64 vcc, -1, v16
    s_cbranch_vccnz Lspin_35
    v_dot2_f32_bf16 v28, v64, v20, 0
    v_dot2_f32_bf16 v29, v68, v20, 0
    v_dot2_f32_bf16 v30, v65, v20, 0
    v_dot2_f32_bf16 v31, v69, v20, 0
    v_dot2_f32_bf16 v32, v66, v20, 0
    v_dot2_f32_bf16 v33, v70, v20, 0
    v_dot2_f32_bf16 v34, v67, v20, 0
    v_dot2_f32_bf16 v35, v71, v20, 0
    v_dot2_f32_bf16 v28, v72, v21, v28
    v_dot2_f32_bf16 v29, v76, v21, v29
    v_dot2_f32_bf16 v30, v73, v21, v30
    v_dot2_f32_bf16 v31, v77, v21, v31
    v_dot2_f32_bf16 v32, v74, v21, v32
    v_dot2_f32_bf16 v33, v78, v21, v33
    v_dot2_f32_bf16 v34, v75, v21, v34
    v_dot2_f32_bf16 v35, v79, v21, v35
    v_dot2_f32_bf16 v28, v80, v22, v28
    v_dot2_f32_bf16 v29, v84, v22, v29
    v_dot2_f32_bf16 v30, v81, v22, v30
    v_dot2_f32_bf16 v31, v85, v22, v31
    v_dot2_f32_bf16 v32, v82, v22, v32
    v_dot2_f32_bf16 v33, v86, v22, v33
    v_dot2_f32_bf16 v34, v83, v22, v34
    v_dot2_f32_bf16 v35, v87, v22, v35
    v_dot2_f32_bf16 v28, v88, v23, v28
    v_dot2_f32_bf16 v29, v92, v23, v29
    v_dot2_f32_bf16 v30, v89, v23, v30
    v_dot2_f32_bf16 v31, v93, v23, v31
    v_dot2_f32_bf16 v32, v90, v23, v32
    v_dot2_f32_bf16 v33, v94, v23, v33
    v_dot2_f32_bf16 v34, v91, v23, v34
    v_dot2_f32_bf16 v35, v95, v23, v35
    v_dot2_f32_bf16 v36, v96, v20, 0
    v_dot2_f32_bf16 v37, v100, v20, 0
    v_dot2_f32_bf16 v38, v97, v20, 0
    v_dot2_f32_bf16 v39, v101, v20, 0
    v_dot2_f32_bf16 v40, v98, v20, 0
    v_dot2_f32_bf16 v41, v102, v20, 0
    v_dot2_f32_bf16 v42, v99, v20, 0
    v_dot2_f32_bf16 v43, v103, v20, 0
    v_dot2_f32_bf16 v36, v104, v21, v36
    v_dot2_f32_bf16 v37, v108, v21, v37
    v_dot2_f32_bf16 v38, v105, v21, v38
    v_dot2_f32_bf16 v39, v109, v21, v39
    v_dot2_f32_bf16 v40, v106, v21, v40
    v_dot2_f32_bf16 v41, v110, v21, v41
    v_dot2_f32_bf16 v42, v107, v21, v42
    v_dot2_f32_bf16 v43, v111, v21, v43
    v_dot2_f32_bf16 v36, v112, v22, v36
    v_dot2_f32_bf16 v37, v116, v22, v37
    v_dot2_f32_bf16 v38, v113, v22, v38
    v_dot2_f32_bf16 v39, v117, v22, v39
    v_dot2_f32_bf16 v40, v114, v22, v40
    v_dot2_f32_bf16 v41, v118, v22, v41
    v_dot2_f32_bf16 v42, v115, v22, v42
    v_dot2_f32_bf16 v43, v119, v22, v43
    v_dot2_f32_bf16 v36, v120, v23, v36
    v_dot2_f32_bf16 v37, v124, v23, v37
    v_dot2_f32_bf16 v38, v121, v23, v38
    v_dot2_f32_bf16 v39, v125, v23, v39
    v_dot2_f32_bf16 v40, v122, v23, v40
    v_dot2_f32_bf16 v41, v126, v23, v41
    v_dot2_f32_bf16 v42, v123, v23, v42
    v_dot2_f32_bf16 v43, v127, v23, v43
    v_permlane32_swap_b32 v28, v32
    v_permlane32_swap_b32 v29, v33
    v_permlane32_swap_b32 v30, v34
    v_permlane32_swap_b32 v31, v35
    v_pk_add_f32 v[28:29], v[28:29], v[32:33]
    v_pk_add_f32 v[30:31], v[30:31], v[34:35]
    s_nop 1
    v_permlane16_swap_b32 v28, v30
    v_permlane16_swap_b32_e64 v29, v31
    v_pk_add_f32 v[28:29], v[28:29], v[30:31]
    s_nop 1
    v_add_f32_dpp v44, v28, v28 row_ror:8 row_mask:0xf bank_mask:0x3
    s_nop 1
    v_add_f32_dpp v44, v29, v29 row_ror:8 row_mask:0xf bank_mask:0xc
    v_permlane32_swap_b32 v36, v40
    v_permlane32_swap_b32 v37, v41
    v_permlane32_swap_b32 v38, v42
    v_permlane32_swap_b32 v39, v43
    v_pk_add_f32 v[36:37], v[36:37], v[40:41]
    v_pk_add_f32 v[38:39], v[38:39], v[42:43]
    s_nop 1
    v_permlane16_swap_b32 v36, v38
    v_permlane16_swap_b32_e64 v37, v39
    v_pk_add_f32 v[36:37], v[36:37], v[38:39]
    s_nop 1
    v_add_f32_dpp v45, v36, v36 row_ror:8 row_mask:0xf bank_mask:0x3
    s_nop 1
    v_add_f32_dpp v45, v37, v37 row_ror:8 row_mask:0xf bank_mask:0xc
    s_bitcmp1_b32 s99, 0
    s_cbranch_scc1 Lls_36
    buffer_store_dwordx2 v[44:45], v15, s[36:39], s80 offen sc1
    s_branch Lle_37
Lls_36:
    buffer_store_dwordx2 v[44:45], v15, s[36:39], s80 offen
Lle_37:
    s_mov_b32 s95, s80
    s_barrier
    s_lshl_b32 s78, s76, 7
    s_add_u32 s78, s78, s81
    s_add_u32 s79, s78, 4096
    v_lshrrev_b32 v26, 5, v2
    v_lshl_add_u32 v26, v9, 1, v26
    s_lshl_b32 s80, s76, 5
    s_add_u32 s80, s80, 163456
    v_lshl_add_u32 v26, v26, 1, s80
    v_lshlrev_b32 v27, 4, v8
    v_add_u32 v27, 163456, v27
    v_lshlrev_b32 v15, 2, v14
    s_mul_i32 s80, s74, 56
    s_add_u32 s80, s80, s73
    s_lshl_b32 s80, s80, 10
    s_lshl_b32 s82, s76, 8
    s_add_u32 s80, s80, s82
    s_add_u32 s80, s80, 1114112
    s_waitcnt vmcnt(0)
    s_mov_b32 s100, 0x05040100
    s_mov_b32 s101, 0x07060302
    v_perm_b32 v7, v156, v152, s100
    v_perm_b32 v156, v156, v152, s101
    v_mov_b32 v152, v7
    v_perm_b32 v7, v157, v153, s100
    v_perm_b32 v157, v157, v153, s101
    v_mov_b32_e64 v153, v7
    v_perm_b32 v7, v158, v154, s100
    v_perm_b32 v158, v158, v154, s101
    v_mov_b32_e64 v154, v7
    v_perm_b32 v7, v159, v155, s100
    v_perm_b32 v159, v159, v155, s101
    v_mov_b32_e64 v155, v7
    s_mov_b32 s85, 0
Lspin_38:
    s_add_u32 s85, s85, 1
    s_cmp_gt_u32 s85, 400000
    s_cbranch_scc1 L_end
    buffer_load_dwordx4 v[16:19], v13, s[36:39], s78 offen sc1
    buffer_load_dwordx4 v[20:23], v13, s[36:39], s79 offen sc1
    s_waitcnt vmcnt(0)
    v_max3_u32 v25, v16, v18, v20
    v_max_u32 v25, v25, v22
    v_cmp_eq_u32_e64 vcc, -1, v25
    s_cbranch_vccnz Lspin_38
    v_pk_add_f32 v[16:17], v[16:17], v[20:21]
    v_pk_add_f32 v[18:19], v[18:19], v[22:23]
    s_nop 1
    v_permlane32_swap_b32 v16, v18
    v_permlane32_swap_b32_e64 v17, v19
    v_pk_add_f32 v[16:17], v[16:17], v[18:19]
    v_mov_b32 v18, v16
    v_mov_b32 v19, v17
    s_nop 0
    v_permlane16_swap_b32 v16, v18
    v_permlane16_swap_b32_e64 v17, v19
    v_pk_add_f32 v[16:17], v[16:17], v[18:19]
    s_nop 1
    s_nop 0
    v_add_f32_dpp v16, v16, v16 row_ror:8 row_mask:0xf bank_mask:0xf
    v_add_f32_dpp v17, v17, v17 row_ror:8 row_mask:0xf bank_mask:0xf
    v_cvt_pk_bf16_f32 v16, v16, v16
    v_and_b32 v16, 0xffff0000, v16
    v_cvt_pk_bf16_f32 v17, v17, v17
    v_and_b32 v17, 0xffff0000, v17
    v_mul_f32 v18, 0xbfb8aa3b, v16
    v_exp_f32 v18, v18
    s_nop 0
    v_add_f32 v18, 1.0, v18
    v_rcp_f32 v18, v18
    s_nop 0
    v_mul_f32 v16, v16, v18
    v_cvt_pk_bf16_f32 v16, v16, v16
    v_and_b32 v16, 0xffff0000, v16
    v_mul_f32_e64 v16, v16, v17
    v_cvt_pk_bf16_f32 v16, v16, v16
    ds_write_b16 v26, v16
    s_waitcnt lgkmcnt(0)
    s_barrier
    ds_read_b128 v[20:23], v27
    s_waitcnt lgkmcnt(0)
    s_nop 0
    v_dot2_f32_bf16 v28, v128, v20, 0
    v_dot2_f32_bf16 v29, v132, v20, 0
    v_dot2_f32_bf16 v30, v129, v20, 0
    v_dot2_f32_bf16 v31, v133, v20, 0
    v_dot2_f32_bf16 v32, v130, v20, 0
    v_dot2_f32_bf16 v33, v134, v20, 0
    v_dot2_f32_bf16 v34, v131, v20, 0
    v_dot2_f32_bf16 v35, v135, v20, 0
    v_dot2_f32_bf16 v28, v136, v21, v28
    v_dot2_f32_bf16 v29, v140, v21, v29
    v_dot2_f32_bf16 v30, v137, v21, v30
    v_dot2_f32_bf16 v31, v141, v21, v31
    v_dot2_f32_bf16 v32, v138, v21, v32
    v_dot2_f32_bf16 v33, v142, v21, v33
    v_dot2_f32_bf16 v34, v139, v21, v34
    v_dot2_f32_bf16 v35, v143, v21, v35
    v_dot2_f32_bf16 v28, v144, v22, v28
    v_dot2_f32_bf16 v29, v148, v22, v29
    v_dot2_f32_bf16 v30, v145, v22, v30
    v_dot2_f32_bf16 v31, v149, v22, v31
    v_dot2_f32_bf16 v32, v146, v22, v32
    v_dot2_f32_bf16 v33, v150, v22, v33
    v_dot2_f32_bf16 v34, v147, v22, v34
    v_dot2_f32_bf16 v35, v151, v22, v35
    v_dot2_f32_bf16 v28, v152, v23, v28
    v_dot2_f32_bf16 v29, v156, v23, v29
    v_dot2_f32_bf16 v30, v153, v23, v30
    v_dot2_f32_bf16 v31, v157, v23, v31
    v_dot2_f32_bf16 v32, v154, v23, v32
    v_dot2_f32_bf16 v33, v158, v23, v33
    v_dot2_f32_bf16 v34, v155, v23, v34
    v_dot2_f32_bf16 v35, v159, v23, v35
    v_permlane32_swap_b32 v28, v32
    v_permlane32_swap_b32 v29, v33
    v_permlane32_swap_b32 v30, v34
    v_permlane32_swap_b32 v31, v35
    v_pk_add_f32 v[28:29], v[28:29], v[32:33]
    v_pk_add_f32 v[30:31], v[30:31], v[34:35]
    s_nop 1
    v_permlane16_swap_b32 v28, v30
    v_permlane16_swap_b32_e64 v29, v31
    v_pk_add_f32 v[28:29], v[28:29], v[30:31]
    s_nop 1
    v_add_f32_dpp v46, v28, v28 row_ror:8 row_mask:0xf bank_mask:0x3
    s_nop 1
    v_add_f32_dpp v46, v29, v29 row_ror:8 row_mask:0xf bank_mask:0xc
    buffer_store_dword v46, v15, s[36:39], s80 offen sc1
    s_barrier
    s_branch L_fin
L_red:
    v_mov_b32 v26, 163360
    ds_write_b32 v26, v24
    s_waitcnt lgkmcnt(0)
    s_barrier
    s_barrier
    s_barrier
    s_cmp_lg_u32 s76, 0
    s_cbranch_scc1 L_fin
    s_sub_u32 s83, s0, 224
    v_lshrrev_b32_e64 v14, 4, v2
    v_lshl_add_u32 v14, v9, 2, v14
    v_lshlrev_b32 v15, 2, v14
    v_lshlrev_b32 v14, 1, v14
    s_bfe_u32 s78, s97, 0x40007
    s_lshl_b32 s78, s78, 13
    s_lshr_b32 s79, s83, 1
    s_lshl_b32 s79, s79, 9
    s_add_u32 s78, s78, s79
    s_and_b32 s79, s83, 1
    s_lshl_b32 s79, s79, 7
    s_add_u32 s78, s78, s79
    s_add_u32 s78, s78, 524544
    s_mov_b32 s85, 0
Lspin_39:
    s_add_u32 s85, s85, 1
    s_cmp_gt_u32 s85, 400000
    s_cbranch_scc1 L_end
    buffer_load_dword v46, v15, s[36:39], s78 offen sc1
    s_waitcnt vmcnt(0)
    v_cmp_eq_u32_e64 vcc, -1, v46
    s_cbranch_vccnz Lspin_39
    v_cvt_pk_bf16_f32 v47, v24, v24
    v_and_b32 v47, 0xffff0000, v47
    v_mul_f32 v47, 0xbfb8aa3b, v47
    v_exp_f32 v47, v47
    s_nop 0
    v_add_f32 v47, 1.0, v47
    v_rcp_f32_e64 v47, v47
    s_nop 0
    v_cvt_pk_bf16_f32 v47, v47, v47
    v_and_b32 v47, 0xffff0000, v47
    v_lshl_add_u32 v13, v8, 10, v10
    s_lshr_b32 s78, s83, 3
    s_mul_i32 s78, s78, 57344
    s_and_b32 s79, s83, 7
    s_lshl_b32 s79, s79, 7
    s_add_u32 s78, s78, s79
    s_add_u32 s78, s78, 1114112
    s_and_b32 s80, s97, 0x7ff
    s_lshl_b32 s80, s80, 11
    s_lshl_b32 s79, s83, 6
    s_add_u32 s80, s80, s79
    s_sleep 28
    s_mov_b32 s85, 0
Lspin_40:
    s_add_u32 s85, s85, 1
    s_cmp_gt_u32 s85, 400000
    s_cbranch_scc1 L_end
    s_add_u32 s79, s78, 0
    buffer_load_dwordx4 v[16:19], v13, s[36:39], s79 offen sc1
    s_add_u32 s79, s78, 8192
    buffer_load_dwordx4 v[20:23], v13, s[36:39], s79 offen sc1
    s_add_u32 s79, s78, 16384
    buffer_load_dwordx4 v[24:27], v13, s[36:39], s79 offen sc1
    s_add_u32 s79, s78, 24576
    buffer_load_dwordx4 v[28:31], v13, s[36:39], s79 offen sc1
    s_add_u32 s79, s78, 32768
    buffer_load_dwordx4 v[32:35], v13, s[36:39], s79 offen sc1
    s_add_u32 s79, s78, 40960
    buffer_load_dwordx4 v[36:39], v13, s[36:39], s79 offen sc1
    s_add_u32 s79, s78, 49152
    buffer_load_dwordx4 v[40:43], v13, s[36:39], s79 offen sc1
    s_waitcnt vmcnt(0)
    v_max_u32 v48, v16, v17
    v_max_u32_e64 v49, v18, v19
    v_max3_u32 v48, v48, v20, v21
    v_max3_u32 v49, v49, v22, v23
    v_max3_u32 v48, v48, v24, v25
    v_max3_u32 v49, v49, v26, v27
    v_max3_u32 v48, v48, v28, v29
    v_max3_u32 v49, v49, v30, v31
    v_max3_u32 v48, v48, v32, v33
    v_max3_u32 v49, v49, v34, v35
    v_max3_u32 v48, v48, v36, v37
    v_max3_u32 v49, v49, v38, v39
    v_max3_u32 v48, v48, v40, v41
    v_max3_u32 v49, v49, v42, v43
    v_max_u32 v48, v48, v49
    v_cmp_eq_u32_e64 vcc, -1, v48
    s_cbranch_vccnz Lspin_40
    v_pk_add_f32 v[16:17], v[16:17], v[20:21]
    v_pk_add_f32 v[24:25], v[24:25], v[28:29]
    v_pk_add_f32 v[32:33], v[32:33], v[36:37]
    v_pk_add_f32 v[16:17], v[16:17], v[24:25]
    v_pk_add_f32 v[32:33], v[32:33], v[40:41]
    v_pk_add_f32 v[16:17], v[16:17], v[32:33]
    v_pk_add_f32 v[18:19], v[18:19], v[22:23]
    v_pk_add_f32 v[26:27], v[26:27], v[30:31]
    v_pk_add_f32 v[34:35], v[34:35], v[38:39]
    v_pk_add_f32 v[18:19], v[18:19], v[26:27]
    v_pk_add_f32 v[34:35], v[34:35], v[42:43]
    v_pk_add_f32 v[18:19], v[18:19], v[34:35]
    s_nop 1
    v_permlane32_swap_b32 v16, v18
    v_permlane32_swap_b32_e64 v17, v19
    v_pk_add_f32 v[16:17], v[16:17], v[18:19]
    s_nop 1
    v_permlane16_swap_b32 v16, v17
    v_add_f32 v16, v16, v17
    s_nop 1
    v_add_f32_dpp v16, v16, v16 row_ror:8 row_mask:0xf bank_mask:0xf
    v_cvt_pk_bf16_f32 v16, v16, v16
    v_and_b32 v16, 0xffff0000, v16
    v_mul_f32_e64 v16, v16, v47
    v_cvt_pk_bf16_f32 v16, v16, v16
    v_and_b32 v16, 0xffff0000, v16
    v_add_f32_e64 v16, v16, v46
    v_cvt_pk_bf16_f32 v16, v16, v16
    s_mov_b32 exec_lo, 0x00ff00ff
    s_mov_b32 exec_hi, 0x00ff00ff
    buffer_store_short v16, v14, s[44:47], s80 offen
    s_mov_b64 exec, -1
    s_cmp_lg_u32 s0, 224
    s_cbranch_scc1 Lep_41
    s_cmp_lg_u32 s76, 0
    s_cbranch_scc1 Lep_41
    v_mov_b32 v196, s75
    v_mov_b32_e64 v197, 0
    s_mov_b64 exec, 1
    buffer_store_dword v196, v197, s[36:39], 0 offen sc1
    s_mov_b64 exec, -1
Lep_41:
    s_branch L_fin
    .p2align 3
L_M:
    s_setprio 1
    s_and_b32 s78, s2, 7
    s_lshr_b32 s79, s2, 3
    s_lshl_b32 s71, s78, 1
    s_and_b32 s72, s79, 1
    s_add_u32 s71, s71, s72
    s_lshr_b32 s72, s79, 1
    s_cmp_gt_u32 s70, 3
    s_cselect_b32 s78, 1, 0
    s_cmp_gt_u32 s70, 11
    s_cselect_b32 s78, 2, s78
    s_sub_u32 s78, s70, s78
    s_cmp_eq_u32 s70, 3
    s_cselect_b32 s78, 14, s78
    s_cmp_eq_u32 s70, 11
    s_cselect_b32 s78, 15, s78
    s_lshl_b32 s0, s78, 4
    s_add_u32 s0, s0, s69
    s_lshr_b32 s73, s0, 2
    s_and_b32 s74, s0, 3
    s_lshl_b32 s77, s70, 4
    s_add_u32 s77, s77, s69
    s_and_b32 s80, s76, 1
    s_lshr_b32 s81, s76, 1
    v_and_b32 v8, 15, v2
    v_lshrrev_b32 v9, 4, v2
    v_lshrrev_b32 v10, 1, v8
    s_lshl_b32 s78, s80, 13
    s_add_u32 s78, s78, 118784
    v_lshlrev_b32 v11, 7, v8
    v_add_u32 v11, s78, v11
    v_add_u32 v12, 0, v9
    v_xor_b32 v12, v12, v10
    v_lshl_add_u32 v4, v12, 4, v11
    v_add_u32 v12, 4, v9
    v_xor_b32 v12, v12, v10
    v_lshl_add_u32 v5, v12, 4, v11
    v_bfe_u32 v10, v2, 2, 2
    v_and_b32_e64 v11, 3, v2
    v_lshl_add_u32 v12, v9, 3, v10
    v_lshlrev_b32_e64 v12, 7, v12
    v_lshl_add_u32 v12, v11, 3, v12
    v_add_u32 v12, 135168, v12
    v_lshrrev_b32 v13, 1, v10
    v_and_b32 v14, 1, v9
    v_lshl_add_u32 v13, v14, 1, v13
    s_lshl_b32 s78, s81, 1
    s_add_u32 s79, s78, 0
    v_xor_b32_e64 v14, s79, v13
    v_lshl_add_u32 v6, v14, 5, v12
    s_add_u32 s79, s78, 1
    v_xor_b32 v14, s79, v13
    v_lshl_add_u32 v7, v14, 5, v12
    v_lshrrev_b32_e64 v13, 5, v2
    v_lshl_add_u32 v13, v13, 3, v10
    v_lshlrev_b32 v13, 6, v13
    v_and_b32 v14, 1, v9
    v_lshl_add_u32 v13, v14, 5, v13
    v_lshl_add_u32 v13, v11, 3, v13
    s_lshl_b32 s78, s81, 11
    s_add_u32 s78, s78, 159744
    v_add_u32 v15, s78, v13
    v_mov_b64 v[128:129], 0
    v_mov_b64 v[130:131], 0
    v_mov_b64 v[132:133], 0
    v_mov_b64 v[134:135], 0
    v_mov_b64 v[136:137], 0
    v_mov_b64 v[138:139], 0
    v_mov_b64 v[140:141], 0
    v_mov_b64 v[142:143], 0
    v_mov_b64 v[144:145], 0
    v_mov_b64 v[146:147], 0
    v_mov_b64 v[148:149], 0
    v_mov_b64 v[150:151], 0
    v_mov_b64 v[152:153], 0
    v_mov_b64 v[154:155], 0
    v_mov_b64 v[156:157], 0
    v_mov_b64 v[158:159], 0
    v_mov_b64 v[160:161], 0
    v_mov_b64 v[162:163], 0
    v_mov_b64 v[164:165], 0
    v_mov_b64 v[166:167], 0
    v_mov_b64 v[168:169], 0
    v_mov_b64 v[170:171], 0
    v_mov_b64 v[172:173], 0
    v_mov_b64 v[174:175], 0
    v_mov_b64 v[176:177], 0
    v_mov_b64 v[178:179], 0
    v_mov_b64 v[180:181], 0
    v_mov_b64 v[182:183], 0
    v_mov_b64 v[184:185], 0
    v_mov_b64 v[186:187], 0
    v_mov_b64 v[188:189], 0
    v_mov_b64 v[190:191], 0
    v_mov_b64 v[192:193], 0
    v_mov_b64 v[194:195], 0
    v_mov_b64 v[196:197], 0
    v_mov_b64 v[198:199], 0
    v_mov_b64 v[200:201], 0
    v_mov_b64 v[202:203], 0
    v_mov_b64 v[204:205], 0
    v_mov_b64 v[206:207], 0
    v_mov_b64 v[208:209], 0
    v_mov_b64 v[210:211], 0
    v_mov_b64 v[212:213], 0
    v_mov_b64 v[214:215], 0
    v_mov_b64 v[216:217], 0
    v_mov_b64 v[218:219], 0
    v_mov_b64 v[220:221], 0
    v_mov_b64 v[222:223], 0
    v_mov_b64 v[104:105], 0
    v_mov_b64 v[106:107], 0
    v_mov_b64 v[108:109], 0
    v_mov_b64 v[110:111], 0
    v_and_b32 v14, 31, v2
    v_lshrrev_b32_e64 v13, 5, v2
    s_lshl_b32 s78, s81, 14
    s_lshl_b32 s79, s80, 13
    s_add_u32 s78, s78, s79
    s_add_u32 s78, s78, 110592
    v_lshl_add_u32 v12, v14, 7, s78
    v_and_b32 v14, 7, v14
    v_xor_b32 v14, v14, v13
    v_xor_b32_e64 v13, 0, v14
    v_lshl_add_u32 v112, v13, 4, v12
    v_xor_b32_e64 v13, 2, v14
    v_lshl_add_u32 v113, v13, 4, v12
    v_xor_b32_e64 v13, 4, v14
    v_lshl_add_u32 v114, v13, 4, v12
    v_xor_b32_e64 v13, 6, v14
    v_lshl_add_u32 v115, v13, 4, v12
    s_add_u32 s79, s79, 143360
    v_lshl_add_u32 v12, v8, 7, s79
    s_lshl_b32 s78, s81, 2
    v_add_u32 v14, s78, v9
    v_and_b32 v13, 7, v8
    v_xor_b32 v14, v14, v13
    v_lshl_add_u32 v116, v14, 4, v12
    s_lshl_b32 s78, s80, 6
    v_add_u32 v10, s78, v8
    v_lshlrev_b32_e64 v11, 3, v10
    v_add_u32 v11, 159744, v11
    s_lshl_b32 s79, s81, 5
    v_add_u32 v12, s79, v8
    v_lshlrev_b32_e64 v12, 3, v12
    v_add_u32 v12, 160768, v12
    v_lshlrev_b32_e64 v13, 2, v10
    v_add_u32 v13, 162304, v13
    v_and_b32 v14, 31, v2
    v_add_u32 v14, s78, v14
    v_lshlrev_b32_e64 v14, 2, v14
    v_add_u32 v14, 162304, v14
    s_waitcnt lgkmcnt(0)
    s_load_dword s75, s[26:27], 0
    s_mov_b32 s36, s26
    s_and_b32 s37, s27, 0xffff
    s_mov_b32 s38, 0x10000000
    s_mov_b32 s39, 0x20000
    s_mov_b32 s64, s14
    s_and_b32 s65, s15, 0xffff
    s_mov_b32 s66, 0x800
    s_mov_b32 s67, 0x20000
    s_mov_b32 s44, s22
    s_and_b32 s45, s23, 0xffff
    s_mov_b32 s46, 0x400000
    s_mov_b32 s47, 0x20000
    s_lshl_b32 s78, s72, 7
    buffer_load_dword v118, off, s[64:67], s78
    s_waitcnt lgkmcnt(0)
    s_mul_i32 s75, s75, 0x9E3779B1
    s_add_u32 s75, s75, 0x7F4A7C15
    s_mov_b32 s84, 0
    s_mov_b32 s82, 2
    s_mov_b32 s83, 0xfffec000
    s_barrier
    s_nop 0
    ds_read_b128 v[16:19], v4 offset:0
    ds_read_b64_tr_b16 v[40:41], v6 offset:8192
    ds_read_b64_tr_b16 v[42:43], v6 offset:8704
    ds_read_b128 v[20:23], v4 offset:2048
    ds_read_b128 v[24:27], v4 offset:4096
    ds_read_b128 v[28:31], v4 offset:6144
    ds_read_b64_tr_b16 v[44:45], v7 offset:8192
    ds_read_b64_tr_b16 v[46:47], v7 offset:8704
    ds_read_b64_tr_b16 v[48:49], v6 offset:16384
    ds_read_b64_tr_b16 v[50:51], v6 offset:16896
    ds_read_b64_tr_b16 v[52:53], v7 offset:16384
    ds_read_b64_tr_b16 v[54:55], v7 offset:16896
    ds_read_b64_tr_b16 v[32:33], v6 offset:0
    ds_read_b64_tr_b16 v[34:35], v6 offset:512
    ds_read_b64_tr_b16 v[36:37], v7 offset:0
    ds_read_b64_tr_b16 v[38:39], v7 offset:512
    ds_read_b64_tr_b16 v[96:97], v15 offset:0
    ds_read_b64_tr_b16 v[98:99], v15 offset:1024
    ds_read_b64_tr_b16 v[100:101], v15 offset:256
    ds_read_b64_tr_b16 v[102:103], v15 offset:1280
    s_waitcnt lgkmcnt(0)
    s_nop 0
    v_mfma_f32_16x16x32_bf16 v[160:163], v[40:43], v[16:19], v[160:163]
    v_mfma_f32_16x16x32_bf16 v[176:179], v[44:47], v[16:19], v[176:179]
    v_mfma_f32_16x16x32_bf16 v[180:183], v[44:47], v[20:23], v[180:183]
    v_mfma_f32_16x16x32_bf16 v[164:167], v[40:43], v[20:23], v[164:167]
    v_mfma_f32_16x16x32_bf16 v[168:171], v[40:43], v[24:27], v[168:171]
    v_mfma_f32_16x16x32_bf16 v[184:187], v[44:47], v[24:27], v[184:187]
    v_mfma_f32_16x16x32_bf16 v[188:191], v[44:47], v[28:31], v[188:191]
    v_mfma_f32_16x16x32_bf16 v[172:175], v[40:43], v[28:31], v[172:175]
    v_mfma_f32_16x16x32_bf16 v[204:207], v[48:51], v[28:31], v[204:207]
    v_mfma_f32_16x16x32_bf16 v[220:223], v[52:55], v[28:31], v[220:223]
    v_mfma_f32_16x16x32_bf16 v[216:219], v[52:55], v[24:27], v[216:219]
    v_mfma_f32_16x16x32_bf16 v[200:203], v[48:51], v[24:27], v[200:203]
    v_mfma_f32_16x16x32_bf16 v[196:199], v[48:51], v[20:23], v[196:199]
    v_mfma_f32_16x16x32_bf16 v[212:215], v[52:55], v[20:23], v[212:215]
    v_mfma_f32_16x16x32_bf16 v[208:211], v[52:55], v[16:19], v[208:211]
    v_mfma_f32_16x16x32_bf16 v[192:195], v[48:51], v[16:19], v[192:195]
    v_mfma_f32_16x16x32_bf16 v[128:131], v[32:35], v[16:19], v[128:131]
    v_mfma_f32_16x16x32_bf16 v[144:147], v[36:39], v[16:19], v[144:147]
    v_mfma_f32_16x16x32_bf16 v[148:151], v[36:39], v[20:23], v[148:151]
    v_mfma_f32_16x16x32_bf16 v[132:135], v[32:35], v[20:23], v[132:135]
    v_mfma_f32_16x16x32_bf16 v[136:139], v[32:35], v[24:27], v[136:139]
    v_mfma_f32_16x16x32_bf16 v[152:155], v[36:39], v[24:27], v[152:155]
    v_mfma_f32_16x16x32_bf16 v[156:159], v[36:39], v[28:31], v[156:159]
    v_mfma_f32_16x16x32_bf16 v[140:143], v[32:35], v[28:31], v[140:143]
    ds_read_b128 v[56:59], v5 offset:0
    ds_read_b64_tr_b16 v[80:81], v6 offset:12288
    ds_read_b64_tr_b16 v[82:83], v6 offset:12800
    ds_read_b128 v[60:63], v5 offset:2048
    ds_read_b128 v[64:67], v5 offset:4096
    ds_read_b128 v[68:71], v5 offset:6144
    ds_read_b64_tr_b16 v[84:85], v7 offset:12288
    ds_read_b64_tr_b16 v[86:87], v7 offset:12800
    ds_read_b64_tr_b16 v[88:89], v6 offset:20480
    ds_read_b64_tr_b16 v[90:91], v6 offset:20992
    ds_read_b64_tr_b16 v[92:93], v7 offset:20480
    ds_read_b64_tr_b16 v[94:95], v7 offset:20992
    ds_read_b64_tr_b16 v[72:73], v6 offset:4096
    ds_read_b64_tr_b16 v[74:75], v6 offset:4608
    ds_read_b64_tr_b16 v[76:77], v7 offset:4096
    ds_read_b64_tr_b16 v[78:79], v7 offset:4608
    s_add_u32 s84, s84, 1
    s_cmp_eq_u32 s82, 2
    s_cselect_b32 s78, s83, 40960
    s_cselect_b32 s82, -1, s82
    s_add_u32 s82, s82, 1
    v_add_u32 v4, s78, v4
    v_add_u32 v5, s78, v5
    v_add_u32 v6, s78, v6
    v_add_u32_e64 v7, s78, v7
    s_waitcnt vmcnt(0) lgkmcnt(0)
    v_mfma_f32_16x16x32_bf16 v[160:163], v[80:83], v[56:59], v[160:163]
    v_mfma_f32_16x16x32_bf16 v[176:179], v[84:87], v[56:59], v[176:179]
    v_mfma_f32_16x16x32_bf16 v[180:183], v[84:87], v[60:63], v[180:183]
    v_mfma_f32_16x16x32_bf16 v[164:167], v[80:83], v[60:63], v[164:167]
    v_mfma_f32_16x16x32_bf16 v[168:171], v[80:83], v[64:67], v[168:171]
    v_mfma_f32_16x16x32_bf16 v[184:187], v[84:87], v[64:67], v[184:187]
    v_mfma_f32_16x16x32_bf16 v[188:191], v[84:87], v[68:71], v[188:191]
    v_mfma_f32_16x16x32_bf16 v[172:175], v[80:83], v[68:71], v[172:175]
    v_mfma_f32_16x16x32_bf16 v[204:207], v[88:91], v[68:71], v[204:207]
    v_mfma_f32_16x16x32_bf16 v[220:223], v[92:95], v[68:71], v[220:223]
    v_mfma_f32_16x16x32_bf16 v[216:219], v[92:95], v[64:67], v[216:219]
    v_mfma_f32_16x16x32_bf16 v[200:203], v[88:91], v[64:67], v[200:203]
    v_mfma_f32_16x16x32_bf16 v[196:199], v[88:91], v[60:63], v[196:199]
    v_mfma_f32_16x16x32_bf16 v[212:215], v[92:95], v[60:63], v[212:215]
    v_mfma_f32_16x16x32_bf16 v[208:211], v[92:95], v[56:59], v[208:211]
    v_mfma_f32_16x16x32_bf16 v[192:195], v[88:91], v[56:59], v[192:195]
    v_mfma_f32_16x16x32_bf16 v[128:131], v[72:75], v[56:59], v[128:131]
    v_mfma_f32_16x16x32_bf16 v[144:147], v[76:79], v[56:59], v[144:147]
    v_mfma_f32_16x16x32_bf16 v[148:151], v[76:79], v[60:63], v[148:151]
    v_mfma_f32_16x16x32_bf16 v[132:135], v[72:75], v[60:63], v[132:135]
    v_mfma_f32_16x16x32_bf16 v[136:139], v[72:75], v[64:67], v[136:139]
    v_mfma_f32_16x16x32_bf16 v[152:155], v[76:79], v[64:67], v[152:155]
    v_mfma_f32_16x16x32_bf16 v[156:159], v[76:79], v[68:71], v[156:159]
    v_mfma_f32_16x16x32_bf16 v[140:143], v[72:75], v[68:71], v[140:143]
    s_barrier
    s_nop 0
    ds_read_b128 v[16:19], v4 offset:0
    ds_read_b64_tr_b16 v[40:41], v6 offset:8192
    ds_read_b64_tr_b16 v[42:43], v6 offset:8704
    ds_read_b128 v[20:23], v4 offset:2048
    ds_read_b128 v[24:27], v4 offset:4096
    ds_read_b128 v[28:31], v4 offset:6144
    ds_read_b64_tr_b16 v[44:45], v7 offset:8192
    ds_read_b64_tr_b16 v[46:47], v7 offset:8704
    ds_read_b64_tr_b16 v[48:49], v6 offset:16384
    ds_read_b64_tr_b16 v[50:51], v6 offset:16896
    ds_read_b64_tr_b16 v[52:53], v7 offset:16384
    ds_read_b64_tr_b16 v[54:55], v7 offset:16896
    ds_read_b64_tr_b16 v[32:33], v6 offset:0
    ds_read_b64_tr_b16 v[34:35], v6 offset:512
    ds_read_b64_tr_b16 v[36:37], v7 offset:0
    ds_read_b64_tr_b16 v[38:39], v7 offset:512
    s_waitcnt lgkmcnt(0)
    s_nop 0
    v_mfma_f32_16x16x32_bf16 v[160:163], v[40:43], v[16:19], v[160:163]
    v_mfma_f32_16x16x32_bf16 v[176:179], v[44:47], v[16:19], v[176:179]
    v_mfma_f32_16x16x32_bf16 v[180:183], v[44:47], v[20:23], v[180:183]
    v_mfma_f32_16x16x32_bf16 v[164:167], v[40:43], v[20:23], v[164:167]
    v_mfma_f32_16x16x32_bf16 v[168:171], v[40:43], v[24:27], v[168:171]
    v_mfma_f32_16x16x32_bf16 v[184:187], v[44:47], v[24:27], v[184:187]
    v_mfma_f32_16x16x32_bf16 v[188:191], v[44:47], v[28:31], v[188:191]
    v_mfma_f32_16x16x32_bf16 v[172:175], v[40:43], v[28:31], v[172:175]
    v_mfma_f32_16x16x32_bf16 v[204:207], v[48:51], v[28:31], v[204:207]
    v_mfma_f32_16x16x32_bf16 v[220:223], v[52:55], v[28:31], v[220:223]
    v_mfma_f32_16x16x32_bf16 v[216:219], v[52:55], v[24:27], v[216:219]
    v_mfma_f32_16x16x32_bf16 v[200:203], v[48:51], v[24:27], v[200:203]
    v_mfma_f32_16x16x32_bf16 v[196:199], v[48:51], v[20:23], v[196:199]
    v_mfma_f32_16x16x32_bf16 v[212:215], v[52:55], v[20:23], v[212:215]
    v_mfma_f32_16x16x32_bf16 v[208:211], v[52:55], v[16:19], v[208:211]
    v_mfma_f32_16x16x32_bf16 v[192:195], v[48:51], v[16:19], v[192:195]
    v_mfma_f32_16x16x32_bf16 v[128:131], v[32:35], v[16:19], v[128:131]
    v_mfma_f32_16x16x32_bf16 v[144:147], v[36:39], v[16:19], v[144:147]
    v_mfma_f32_16x16x32_bf16 v[148:151], v[36:39], v[20:23], v[148:151]
    v_mfma_f32_16x16x32_bf16 v[132:135], v[32:35], v[20:23], v[132:135]
    v_mfma_f32_16x16x32_bf16 v[136:139], v[32:35], v[24:27], v[136:139]
    v_mfma_f32_16x16x32_bf16 v[152:155], v[36:39], v[24:27], v[152:155]
    v_mfma_f32_16x16x32_bf16 v[156:159], v[36:39], v[28:31], v[156:159]
    v_mfma_f32_16x16x32_bf16 v[140:143], v[32:35], v[28:31], v[140:143]
    ds_read_b128 v[56:59], v5 offset:0
    ds_read_b64_tr_b16 v[80:81], v6 offset:12288
    ds_read_b64_tr_b16 v[82:83], v6 offset:12800
    ds_read_b128 v[60:63], v5 offset:2048
    ds_read_b128 v[64:67], v5 offset:4096
    ds_read_b128 v[68:71], v5 offset:6144
    ds_read_b64_tr_b16 v[84:85], v7 offset:12288
    ds_read_b64_tr_b16 v[86:87], v7 offset:12800
    ds_read_b64_tr_b16 v[88:89], v6 offset:20480
    ds_read_b64_tr_b16 v[90:91], v6 offset:20992
    ds_read_b64_tr_b16 v[92:93], v7 offset:20480
    ds_read_b64_tr_b16 v[94:95], v7 offset:20992
    ds_read_b64_tr_b16 v[72:73], v6 offset:4096
    ds_read_b64_tr_b16 v[74:75], v6 offset:4608
    ds_read_b64_tr_b16 v[76:77], v7 offset:4096
    ds_read_b64_tr_b16 v[78:79], v7 offset:4608
    s_add_u32 s84, s84, 1
    s_cmp_eq_u32 s82, 2
    s_cselect_b32 s78, s83, 40960
    s_cselect_b32 s82, -1, s82
    s_add_u32 s82, s82, 1
    v_add_u32 v4, s78, v4
    v_add_u32 v5, s78, v5
    v_add_u32 v6, s78, v6
    v_add_u32_e64 v7, s78, v7
    s_waitcnt vmcnt(0) lgkmcnt(0)
    v_mfma_f32_16x16x32_bf16 v[160:163], v[80:83], v[56:59], v[160:163]
    v_mfma_f32_16x16x32_bf16 v[176:179], v[84:87], v[56:59], v[176:179]
    v_mfma_f32_16x16x32_bf16 v[180:183], v[84:87], v[60:63], v[180:183]
    v_mfma_f32_16x16x32_bf16 v[164:167], v[80:83], v[60:63], v[164:167]
    v_mfma_f32_16x16x32_bf16 v[168:171], v[80:83], v[64:67], v[168:171]
    v_mfma_f32_16x16x32_bf16 v[184:187], v[84:87], v[64:67], v[184:187]
    v_mfma_f32_16x16x32_bf16 v[188:191], v[84:87], v[68:71], v[188:191]
    v_mfma_f32_16x16x32_bf16 v[172:175], v[80:83], v[68:71], v[172:175]
    v_mfma_f32_16x16x32_bf16 v[204:207], v[88:91], v[68:71], v[204:207]
    v_mfma_f32_16x16x32_bf16 v[220:223], v[92:95], v[68:71], v[220:223]
    v_mfma_f32_16x16x32_bf16 v[216:219], v[92:95], v[64:67], v[216:219]
    v_mfma_f32_16x16x32_bf16 v[200:203], v[88:91], v[64:67], v[200:203]
    v_mfma_f32_16x16x32_bf16 v[196:199], v[88:91], v[60:63], v[196:199]
    v_mfma_f32_16x16x32_bf16 v[212:215], v[92:95], v[60:63], v[212:215]
    v_mfma_f32_16x16x32_bf16 v[208:211], v[92:95], v[56:59], v[208:211]
    v_mfma_f32_16x16x32_bf16 v[192:195], v[88:91], v[56:59], v[192:195]
    v_mfma_f32_16x16x32_bf16 v[128:131], v[72:75], v[56:59], v[128:131]
    v_mfma_f32_16x16x32_bf16 v[144:147], v[76:79], v[56:59], v[144:147]
    v_mfma_f32_16x16x32_bf16 v[148:151], v[76:79], v[60:63], v[148:151]
    v_mfma_f32_16x16x32_bf16 v[132:135], v[72:75], v[60:63], v[132:135]
    v_mfma_f32_16x16x32_bf16 v[136:139], v[72:75], v[64:67], v[136:139]
    v_mfma_f32_16x16x32_bf16 v[152:155], v[76:79], v[64:67], v[152:155]
    v_mfma_f32_16x16x32_bf16 v[156:159], v[76:79], v[68:71], v[156:159]
    v_mfma_f32_16x16x32_bf16 v[140:143], v[72:75], v[68:71], v[140:143]
    s_barrier
    s_nop 0
    ds_read_b128 v[16:19], v4 offset:0
    ds_read_b64_tr_b16 v[40:41], v6 offset:8192
    ds_read_b64_tr_b16 v[42:43], v6 offset:8704
    ds_read_b128 v[20:23], v4 offset:2048
    ds_read_b128 v[24:27], v4 offset:4096
    ds_read_b128 v[28:31], v4 offset:6144
    ds_read_b64_tr_b16 v[44:45], v7 offset:8192
    ds_read_b64_tr_b16 v[46:47], v7 offset:8704
    ds_read_b64_tr_b16 v[48:49], v6 offset:16384
    ds_read_b64_tr_b16 v[50:51], v6 offset:16896
    ds_read_b64_tr_b16 v[52:53], v7 offset:16384
    ds_read_b64_tr_b16 v[54:55], v7 offset:16896
    ds_read_b64_tr_b16 v[32:33], v6 offset:0
    ds_read_b64_tr_b16 v[34:35], v6 offset:512
    ds_read_b64_tr_b16 v[36:37], v7 offset:0
    ds_read_b64_tr_b16 v[38:39], v7 offset:512
    s_waitcnt lgkmcnt(0)
    s_nop 0
    v_mfma_f32_16x16x32_bf16 v[160:163], v[40:43], v[16:19], v[160:163]
    v_mfma_f32_16x16x32_bf16 v[176:179], v[44:47], v[16:19], v[176:179]
    v_mfma_f32_16x16x32_bf16 v[180:183], v[44:47], v[20:23], v[180:183]
    v_mfma_f32_16x16x32_bf16 v[164:167], v[40:43], v[20:23], v[164:167]
    v_mfma_f32_16x16x32_bf16 v[168:171], v[40:43], v[24:27], v[168:171]
    v_mfma_f32_16x16x32_bf16 v[184:187], v[44:47], v[24:27], v[184:187]
    v_mfma_f32_16x16x32_bf16 v[188:191], v[44:47], v[28:31], v[188:191]
    v_mfma_f32_16x16x32_bf16 v[172:175], v[40:43], v[28:31], v[172:175]
    v_mfma_f32_16x16x32_bf16 v[204:207], v[48:51], v[28:31], v[204:207]
    v_mfma_f32_16x16x32_bf16 v[220:223], v[52:55], v[28:31], v[220:223]
    v_mfma_f32_16x16x32_bf16 v[216:219], v[52:55], v[24:27], v[216:219]
    v_mfma_f32_16x16x32_bf16 v[200:203], v[48:51], v[24:27], v[200:203]
    v_mfma_f32_16x16x32_bf16 v[196:199], v[48:51], v[20:23], v[196:199]
    v_mfma_f32_16x16x32_bf16 v[212:215], v[52:55], v[20:23], v[212:215]
    v_mfma_f32_16x16x32_bf16 v[208:211], v[52:55], v[16:19], v[208:211]
    v_mfma_f32_16x16x32_bf16 v[192:195], v[48:51], v[16:19], v[192:195]
    v_mfma_f32_16x16x32_bf16 v[128:131], v[32:35], v[16:19], v[128:131]
    v_mfma_f32_16x16x32_bf16 v[144:147], v[36:39], v[16:19], v[144:147]
    v_mfma_f32_16x16x32_bf16 v[148:151], v[36:39], v[20:23], v[148:151]
    v_mfma_f32_16x16x32_bf16 v[132:135], v[32:35], v[20:23], v[132:135]
    v_mfma_f32_16x16x32_bf16 v[136:139], v[32:35], v[24:27], v[136:139]
    v_mfma_f32_16x16x32_bf16 v[152:155], v[36:39], v[24:27], v[152:155]
    v_mfma_f32_16x16x32_bf16 v[156:159], v[36:39], v[28:31], v[156:159]
    v_mfma_f32_16x16x32_bf16 v[140:143], v[32:35], v[28:31], v[140:143]
    ds_read_b128 v[56:59], v5 offset:0
    ds_read_b64_tr_b16 v[80:81], v6 offset:12288
    ds_read_b64_tr_b16 v[82:83], v6 offset:12800
    ds_read_b128 v[60:63], v5 offset:2048
    ds_read_b128 v[64:67], v5 offset:4096
    ds_read_b128 v[68:71], v5 offset:6144
    ds_read_b64_tr_b16 v[84:85], v7 offset:12288
    ds_read_b64_tr_b16 v[86:87], v7 offset:12800
    ds_read_b64_tr_b16 v[88:89], v6 offset:20480
    ds_read_b64_tr_b16 v[90:91], v6 offset:20992
    ds_read_b64_tr_b16 v[92:93], v7 offset:20480
    ds_read_b64_tr_b16 v[94:95], v7 offset:20992
    ds_read_b64_tr_b16 v[72:73], v6 offset:4096
    ds_read_b64_tr_b16 v[74:75], v6 offset:4608
    ds_read_b64_tr_b16 v[76:77], v7 offset:4096
    ds_read_b64_tr_b16 v[78:79], v7 offset:4608
    s_add_u32 s84, s84, 1
    s_cmp_eq_u32 s82, 2
    s_cselect_b32 s78, s83, 40960
    s_cselect_b32 s82, -1, s82
    s_add_u32 s82, s82, 1
    v_add_u32 v4, s78, v4
    v_add_u32 v5, s78, v5
    v_add_u32 v6, s78, v6
    v_add_u32_e64 v7, s78, v7
    s_waitcnt vmcnt(0) lgkmcnt(0)
    v_mfma_f32_16x16x32_bf16 v[160:163], v[80:83], v[56:59], v[160:163]
    v_mfma_f32_16x16x32_bf16 v[176:179], v[84:87], v[56:59], v[176:179]
    v_mfma_f32_16x16x32_bf16 v[180:183], v[84:87], v[60:63], v[180:183]
    v_mfma_f32_16x16x32_bf16 v[164:167], v[80:83], v[60:63], v[164:167]
    v_mfma_f32_16x16x32_bf16 v[168:171], v[80:83], v[64:67], v[168:171]
    v_mfma_f32_16x16x32_bf16 v[184:187], v[84:87], v[64:67], v[184:187]
    v_mfma_f32_16x16x32_bf16 v[188:191], v[84:87], v[68:71], v[188:191]
    v_mfma_f32_16x16x32_bf16 v[172:175], v[80:83], v[68:71], v[172:175]
    v_mfma_f32_16x16x32_bf16 v[204:207], v[88:91], v[68:71], v[204:207]
    v_mfma_f32_16x16x32_bf16 v[220:223], v[92:95], v[68:71], v[220:223]
    v_mfma_f32_16x16x32_bf16 v[216:219], v[92:95], v[64:67], v[216:219]
    v_mfma_f32_16x16x32_bf16 v[200:203], v[88:91], v[64:67], v[200:203]
    v_mfma_f32_16x16x32_bf16 v[196:199], v[88:91], v[60:63], v[196:199]
    v_mfma_f32_16x16x32_bf16 v[212:215], v[92:95], v[60:63], v[212:215]
    v_mfma_f32_16x16x32_bf16 v[208:211], v[92:95], v[56:59], v[208:211]
    v_mfma_f32_16x16x32_bf16 v[192:195], v[88:91], v[56:59], v[192:195]
    v_mfma_f32_16x16x32_bf16 v[128:131], v[72:75], v[56:59], v[128:131]
    v_mfma_f32_16x16x32_bf16 v[144:147], v[76:79], v[56:59], v[144:147]
    v_mfma_f32_16x16x32_bf16 v[148:151], v[76:79], v[60:63], v[148:151]
    v_mfma_f32_16x16x32_bf16 v[132:135], v[72:75], v[60:63], v[132:135]
    v_mfma_f32_16x16x32_bf16 v[136:139], v[72:75], v[64:67], v[136:139]
    v_mfma_f32_16x16x32_bf16 v[152:155], v[76:79], v[64:67], v[152:155]
    v_mfma_f32_16x16x32_bf16 v[156:159], v[76:79], v[68:71], v[156:159]
    v_mfma_f32_16x16x32_bf16 v[140:143], v[72:75], v[68:71], v[140:143]
    s_barrier
    s_nop 0
    ds_read_b128 v[16:19], v4 offset:0
    ds_read_b64_tr_b16 v[40:41], v6 offset:8192
    ds_read_b64_tr_b16 v[42:43], v6 offset:8704
    ds_read_b128 v[20:23], v4 offset:2048
    ds_read_b128 v[24:27], v4 offset:4096
    ds_read_b128 v[28:31], v4 offset:6144
    ds_read_b64_tr_b16 v[44:45], v7 offset:8192
    ds_read_b64_tr_b16 v[46:47], v7 offset:8704
    ds_read_b64_tr_b16 v[48:49], v6 offset:16384
    ds_read_b64_tr_b16 v[50:51], v6 offset:16896
    ds_read_b64_tr_b16 v[52:53], v7 offset:16384
    ds_read_b64_tr_b16 v[54:55], v7 offset:16896
    ds_read_b64_tr_b16 v[32:33], v6 offset:0
    ds_read_b64_tr_b16 v[34:35], v6 offset:512
    ds_read_b64_tr_b16 v[36:37], v7 offset:0
    ds_read_b64_tr_b16 v[38:39], v7 offset:512
    .p2align 3
L_Mloop:
    s_waitcnt lgkmcnt(0)
    s_nop 0
    v_mfma_f32_16x16x32_bf16 v[160:163], v[40:43], v[16:19], v[160:163]
    ds_read_b128 v[56:59], v5 offset:0
    v_mfma_f32_16x16x32_bf16 v[176:179], v[44:47], v[16:19], v[176:179]
    ds_read_b64_tr_b16 v[80:81], v6 offset:12288
    v_mfma_f32_16x16x32_bf16 v[180:183], v[44:47], v[20:23], v[180:183]
    ds_read_b64_tr_b16 v[82:83], v6 offset:12800
    v_mfma_f32_16x16x32_bf16 v[164:167], v[40:43], v[20:23], v[164:167]
    ds_read_b128 v[60:63], v5 offset:2048
    v_mfma_f32_16x16x32_bf16 v[168:171], v[40:43], v[24:27], v[168:171]
    ds_read_b128 v[64:67], v5 offset:4096
    v_mfma_f32_16x16x32_bf16 v[184:187], v[44:47], v[24:27], v[184:187]
    ds_read_b128 v[68:71], v5 offset:6144
    v_mfma_f32_16x16x32_bf16 v[188:191], v[44:47], v[28:31], v[188:191]
    ds_read_b64_tr_b16 v[84:85], v7 offset:12288
    v_mfma_f32_16x16x32_bf16 v[172:175], v[40:43], v[28:31], v[172:175]
    ds_read_b64_tr_b16 v[86:87], v7 offset:12800
    v_mfma_f32_16x16x32_bf16 v[204:207], v[48:51], v[28:31], v[204:207]
    ds_read_b64_tr_b16 v[88:89], v6 offset:20480
    v_mfma_f32_16x16x32_bf16 v[220:223], v[52:55], v[28:31], v[220:223]
    ds_read_b64_tr_b16 v[90:91], v6 offset:20992
    v_mfma_f32_16x16x32_bf16 v[216:219], v[52:55], v[24:27], v[216:219]
    ds_read_b64_tr_b16 v[92:93], v7 offset:20480
    v_mfma_f32_16x16x32_bf16 v[200:203], v[48:51], v[24:27], v[200:203]
    ds_read_b64_tr_b16 v[94:95], v7 offset:20992
    v_mfma_f32_16x16x32_bf16 v[196:199], v[48:51], v[20:23], v[196:199]
    ds_read_b64_tr_b16 v[72:73], v6 offset:4096
    v_mfma_f32_16x16x32_bf16 v[212:215], v[52:55], v[20:23], v[212:215]
    ds_read_b64_tr_b16 v[74:75], v6 offset:4608
    v_mfma_f32_16x16x32_bf16 v[208:211], v[52:55], v[16:19], v[208:211]
    ds_read_b64_tr_b16 v[76:77], v7 offset:4096
    v_mfma_f32_16x16x32_bf16 v[192:195], v[48:51], v[16:19], v[192:195]
    ds_read_b64_tr_b16 v[78:79], v7 offset:4608
    v_mfma_f32_16x16x32_bf16 v[128:131], v[32:35], v[16:19], v[128:131]
    s_add_u32 s84, s84, 1
    s_cmp_eq_u32 s82, 2
    s_cselect_b32 s78, s83, 40960
    s_cselect_b32 s82, -1, s82
    s_add_u32 s82, s82, 1
    v_mfma_f32_16x16x32_bf16 v[144:147], v[36:39], v[16:19], v[144:147]
    v_add_u32 v4, s78, v4
    v_add_u32 v5, s78, v5
    v_mfma_f32_16x16x32_bf16 v[148:151], v[36:39], v[20:23], v[148:151]
    v_add_u32 v6, s78, v6
    v_add_u32 v7, s78, v7
    v_mfma_f32_16x16x32_bf16 v[132:135], v[32:35], v[20:23], v[132:135]
    v_mfma_f32_16x16x32_bf16 v[136:139], v[32:35], v[24:27], v[136:139]
    v_mfma_f32_16x16x32_bf16 v[152:155], v[36:39], v[24:27], v[152:155]
    v_mfma_f32_16x16x32_bf16 v[156:159], v[36:39], v[28:31], v[156:159]
    v_mfma_f32_16x16x32_bf16 v[140:143], v[32:35], v[28:31], v[140:143]
    s_waitcnt vmcnt(0) lgkmcnt(0)
    v_mfma_f32_16x16x32_bf16 v[160:163], v[80:83], v[56:59], v[160:163]
    v_mfma_f32_16x16x32_bf16 v[176:179], v[84:87], v[56:59], v[176:179]
    s_barrier
    s_cmp_eq_u32 s84, 16
    s_cbranch_scc1 L_Mtail
    v_mfma_f32_16x16x32_bf16 v[180:183], v[84:87], v[60:63], v[180:183]
    ds_read_b128 v[16:19], v4 offset:0
    v_mfma_f32_16x16x32_bf16 v[164:167], v[80:83], v[60:63], v[164:167]
    ds_read_b64_tr_b16 v[40:41], v6 offset:8192
    v_mfma_f32_16x16x32_bf16 v[168:171], v[80:83], v[64:67], v[168:171]
    ds_read_b64_tr_b16 v[42:43], v6 offset:8704
    v_mfma_f32_16x16x32_bf16 v[184:187], v[84:87], v[64:67], v[184:187]
    ds_read_b128 v[20:23], v4 offset:2048
    v_mfma_f32_16x16x32_bf16 v[188:191], v[84:87], v[68:71], v[188:191]
    ds_read_b128 v[24:27], v4 offset:4096
    v_mfma_f32_16x16x32_bf16 v[172:175], v[80:83], v[68:71], v[172:175]
    ds_read_b128 v[28:31], v4 offset:6144
    v_mfma_f32_16x16x32_bf16 v[204:207], v[88:91], v[68:71], v[204:207]
    ds_read_b64_tr_b16 v[44:45], v7 offset:8192
    v_mfma_f32_16x16x32_bf16 v[220:223], v[92:95], v[68:71], v[220:223]
    ds_read_b64_tr_b16 v[46:47], v7 offset:8704
    v_mfma_f32_16x16x32_bf16 v[216:219], v[92:95], v[64:67], v[216:219]
    ds_read_b64_tr_b16 v[48:49], v6 offset:16384
    v_mfma_f32_16x16x32_bf16 v[200:203], v[88:91], v[64:67], v[200:203]
    ds_read_b64_tr_b16 v[50:51], v6 offset:16896
    v_mfma_f32_16x16x32_bf16 v[196:199], v[88:91], v[60:63], v[196:199]
    ds_read_b64_tr_b16 v[52:53], v7 offset:16384
    v_mfma_f32_16x16x32_bf16 v[212:215], v[92:95], v[60:63], v[212:215]
    ds_read_b64_tr_b16 v[54:55], v7 offset:16896
    v_mfma_f32_16x16x32_bf16 v[208:211], v[92:95], v[56:59], v[208:211]
    ds_read_b64_tr_b16 v[32:33], v6 offset:0
    v_mfma_f32_16x16x32_bf16 v[192:195], v[88:91], v[56:59], v[192:195]
    ds_read_b64_tr_b16 v[34:35], v6 offset:512
    v_mfma_f32_16x16x32_bf16 v[128:131], v[72:75], v[56:59], v[128:131]
    ds_read_b64_tr_b16 v[36:37], v7 offset:0
    v_mfma_f32_16x16x32_bf16 v[144:147], v[76:79], v[56:59], v[144:147]
    ds_read_b64_tr_b16 v[38:39], v7 offset:512
    v_mfma_f32_16x16x32_bf16 v[148:151], v[76:79], v[60:63], v[148:151]
    v_mfma_f32_16x16x32_bf16 v[132:135], v[72:75], v[60:63], v[132:135]
    v_mfma_f32_16x16x32_bf16 v[136:139], v[72:75], v[64:67], v[136:139]
    v_mfma_f32_16x16x32_bf16 v[152:155], v[76:79], v[64:67], v[152:155]
    v_mfma_f32_16x16x32_bf16 v[156:159], v[76:79], v[68:71], v[156:159]
    v_mfma_f32_16x16x32_bf16 v[140:143], v[72:75], v[68:71], v[140:143]
    s_branch L_Mloop
    .p2align 3
L_Mtail:
    s_mov_b64 exec, 0xffff
    ds_read_b64 v[104:105], v11 offset:0
    ds_read_b64 v[106:107], v11 offset:128
    ds_read_b64 v[108:109], v11 offset:256
    ds_read_b64 v[110:111], v11 offset:384
    s_mov_b64 exec, -1
    s_nop 0
    v_mfma_f32_16x16x32_bf16 v[180:183], v[84:87], v[60:63], v[180:183]
    ds_read_b64 v[20:21], v12 offset:512
    v_mfma_f32_16x16x32_bf16 v[164:167], v[80:83], v[60:63], v[164:167]
    ds_read_b64 v[22:23], v12 offset:640
    v_mfma_f32_16x16x32_bf16 v[168:171], v[80:83], v[64:67], v[168:171]
    ds_read_b64 v[24:25], v12 offset:1024
    v_mfma_f32_16x16x32_bf16 v[184:187], v[84:87], v[64:67], v[184:187]
    ds_read_b64 v[26:27], v12 offset:1152
    v_mfma_f32_16x16x32_bf16 v[188:191], v[84:87], v[68:71], v[188:191]
    ds_read_b64 v[16:17], v12 offset:0
    v_mfma_f32_16x16x32_bf16 v[172:175], v[80:83], v[68:71], v[172:175]
    ds_read_b64 v[18:19], v12 offset:128
    v_mfma_f32_16x16x32_bf16 v[204:207], v[88:91], v[68:71], v[204:207]
    ds_read2_b32 v[32:33], v14 offset0:0 offset1:32
    v_mfma_f32_16x16x32_bf16 v[220:223], v[92:95], v[68:71], v[220:223]
    ds_read_b32 v28, v13 offset:0
    v_mfma_f32_16x16x32_bf16 v[216:219], v[92:95], v[64:67], v[216:219]
    ds_read_b32 v30, v13 offset:64
    v_mfma_f32_16x16x32_bf16 v[200:203], v[88:91], v[64:67], v[200:203]
    ds_read_b32 v44, v13 offset:128
    v_mfma_f32_16x16x32_bf16 v[196:199], v[88:91], v[60:63], v[196:199]
    ds_read_b32 v46, v13 offset:192
    v_mfma_f32_16x16x32_bf16 v[212:215], v[92:95], v[60:63], v[212:215]
    v_mfma_f32_16x16x32_bf16 v[208:211], v[92:95], v[56:59], v[208:211]
    v_mfma_f32_16x16x32_bf16 v[192:195], v[88:91], v[56:59], v[192:195]
    s_waitcnt lgkmcnt(0)
    s_nop 0
    v_mfma_f32_16x16x16_bf16 v[160:163], v[20:21], v[104:105], v[160:163]
    v_mfma_f32_16x16x16_bf16 v[176:179], v[22:23], v[104:105], v[176:179]
    v_mfma_f32_16x16x16_bf16 v[164:167], v[20:21], v[106:107], v[164:167]
    v_mfma_f32_16x16x16_bf16 v[180:183], v[22:23], v[106:107], v[180:183]
    v_mfma_f32_16x16x16_bf16 v[168:171], v[20:21], v[108:109], v[168:171]
    v_mfma_f32_16x16x16_bf16 v[184:187], v[22:23], v[108:109], v[184:187]
    v_mfma_f32_16x16x16_bf16 v[172:175], v[20:21], v[110:111], v[172:175]
    v_mfma_f32_16x16x16_bf16 v[188:191], v[22:23], v[110:111], v[188:191]
    v_mul_f32 v34, 0x3fb8aa3b, v32
    v_mul_f32 v48, 0x3fb8aa3b, v33
    v_mfma_f32_16x16x16_bf16 v[192:195], v[24:25], v[104:105], v[192:195]
    v_mfma_f32_16x16x16_bf16 v[208:211], v[26:27], v[104:105], v[208:211]
    v_mfma_f32_16x16x16_bf16 v[196:199], v[24:25], v[106:107], v[196:199]
    v_cvt_pk_bf16_f32 v160, v160, v161
    v_cvt_pk_bf16_f32 v161, v162, v163
    v_cvt_pk_bf16_f32 v162, v176, v177
    v_cvt_pk_bf16_f32 v163, v178, v179
    v_mfma_f32_16x16x16_bf16 v[212:215], v[26:27], v[106:107], v[212:215]
    v_cvt_pk_bf16_f32 v164, v164, v165
    v_cvt_pk_bf16_f32 v165, v166, v167
    v_cvt_pk_bf16_f32 v166, v180, v181
    v_cvt_pk_bf16_f32 v167, v182, v183
    v_mfma_f32_16x16x16_bf16 v[200:203], v[24:25], v[108:109], v[200:203]
    v_cvt_pk_bf16_f32 v168, v168, v169
    v_cvt_pk_bf16_f32 v169, v170, v171
    v_cvt_pk_bf16_f32 v170, v184, v185
    v_cvt_pk_bf16_f32 v171, v186, v187
    v_mfma_f32_16x16x16_bf16 v[216:219], v[26:27], v[108:109], v[216:219]
    v_cvt_pk_bf16_f32 v172, v172, v173
    v_cvt_pk_bf16_f32 v173, v174, v175
    v_cvt_pk_bf16_f32 v174, v188, v189
    v_cvt_pk_bf16_f32 v175, v190, v191
    v_mfma_f32_16x16x16_bf16 v[204:207], v[24:25], v[110:111], v[204:207]
    v_permlane16_swap_b32 v160, v164
    v_permlane16_swap_b32 v161, v165
    v_permlane16_swap_b32 v162, v166
    v_permlane16_swap_b32 v163, v167
    v_mfma_f32_16x16x16_bf16 v[220:223], v[26:27], v[110:111], v[220:223]
    v_permlane16_swap_b32 v168, v172
    v_permlane16_swap_b32 v169, v173
    v_permlane16_swap_b32 v170, v174
    v_permlane16_swap_b32 v171, v175
    v_mfma_f32_32x32x16_bf16 v[224:239], v[96:99], v[160:163], 0
    v_mfma_f32_32x32x16_bf16 v[224:239], v[100:103], v[164:167], v[224:239]
    v_mfma_f32_32x32x16_bf16 v[240:255], v[96:99], v[168:171], 0
    v_mfma_f32_32x32x16_bf16 v[240:255], v[100:103], v[172:175], v[240:255]
    v_pk_mul_f32 v[192:193], v[192:193], v[28:29] op_sel_hi:[1,0]
    v_pk_mul_f32 v[194:195], v[194:195], v[28:29] op_sel_hi:[1,0]
    v_pk_mul_f32 v[208:209], v[208:209], v[28:29] op_sel_hi:[1,0]
    v_pk_mul_f32 v[210:211], v[210:211], v[28:29] op_sel_hi:[1,0]
    v_cvt_pk_bf16_f32 v192, v192, v193
    v_cvt_pk_bf16_f32 v193, v194, v195
    v_cvt_pk_bf16_f32 v194, v208, v209
    v_cvt_pk_bf16_f32 v195, v210, v211
    v_pk_mul_f32 v[196:197], v[196:197], v[30:31] op_sel_hi:[1,0]
    v_pk_mul_f32 v[198:199], v[198:199], v[30:31] op_sel_hi:[1,0]
    v_pk_mul_f32 v[212:213], v[212:213], v[30:31] op_sel_hi:[1,0]
    v_pk_mul_f32 v[214:215], v[214:215], v[30:31] op_sel_hi:[1,0]
    v_cvt_pk_bf16_f32 v196, v196, v197
    v_cvt_pk_bf16_f32 v197, v198, v199
    v_cvt_pk_bf16_f32 v198, v212, v213
    v_cvt_pk_bf16_f32 v199, v214, v215
    v_pk_mul_f32 v[200:201], v[200:201], v[44:45] op_sel_hi:[1,0]
    v_pk_mul_f32 v[202:203], v[202:203], v[44:45] op_sel_hi:[1,0]
    v_pk_mul_f32 v[216:217], v[216:217], v[44:45] op_sel_hi:[1,0]
    v_pk_mul_f32 v[218:219], v[218:219], v[44:45] op_sel_hi:[1,0]
    v_cvt_pk_bf16_f32 v200, v200, v201
    v_cvt_pk_bf16_f32 v201, v202, v203
    v_cvt_pk_bf16_f32 v202, v216, v217
    v_cvt_pk_bf16_f32 v203, v218, v219
    v_pk_mul_f32 v[204:205], v[204:205], v[46:47] op_sel_hi:[1,0]
    v_pk_mul_f32 v[206:207], v[206:207], v[46:47] op_sel_hi:[1,0]
    v_pk_mul_f32 v[220:221], v[220:221], v[46:47] op_sel_hi:[1,0]
    v_pk_mul_f32 v[222:223], v[222:223], v[46:47] op_sel_hi:[1,0]
    v_cvt_pk_bf16_f32 v204, v204, v205
    v_cvt_pk_bf16_f32 v205, v206, v207
    v_cvt_pk_bf16_f32 v206, v220, v221
    v_cvt_pk_bf16_f32 v207, v222, v223
    v_mfma_f32_16x16x32_bf16 v[128:131], v[72:75], v[56:59], v[128:131]
    v_max3_f32 v36, v224, v225, v226
    v_max3_f32 v38, -v224, -v225, -v226
    v_max3_f32 v36, v36, v227, v228
    v_max3_f32 v38, v38, -v227, -v228
    v_mfma_f32_16x16x32_bf16 v[144:147], v[76:79], v[56:59], v[144:147]
    v_max3_f32 v36, v36, v229, v230
    v_max3_f32 v38, v38, -v229, -v230
    v_max3_f32 v36, v36, v231, v232
    v_max3_f32 v38, v38, -v231, -v232
    v_mfma_f32_16x16x32_bf16 v[148:151], v[76:79], v[60:63], v[148:151]
    v_max3_f32 v36, v36, v233, v234
    v_max3_f32 v38, v38, -v233, -v234
    v_max3_f32 v36, v36, v235, v236
    v_max3_f32 v38, v38, -v235, -v236
    v_mfma_f32_16x16x32_bf16 v[132:135], v[72:75], v[60:63], v[132:135]
    v_max3_f32 v36, v36, v237, v238
    v_max3_f32 v38, v38, -v237, -v238
    v_max_f32_e64 v36, v36, v239
    v_max_f32 v38, v38, -v239
    v_mfma_f32_16x16x32_bf16 v[136:139], v[72:75], v[64:67], v[136:139]
    v_max3_f32 v37, v240, v241, v242
    v_max3_f32 v39, -v240, -v241, -v242
    v_max3_f32 v37, v37, v243, v244
    v_max3_f32 v39, v39, -v243, -v244
    v_mfma_f32_16x16x32_bf16 v[152:155], v[76:79], v[64:67], v[152:155]
    v_max3_f32 v37, v37, v245, v246
    v_max3_f32 v39, v39, -v245, -v246
    v_max3_f32 v37, v37, v247, v248
    v_max3_f32 v39, v39, -v247, -v248
    v_mfma_f32_16x16x32_bf16 v[156:159], v[76:79], v[68:71], v[156:159]
    v_max3_f32 v37, v37, v249, v250
    v_max3_f32 v39, v39, -v249, -v250
    v_max3_f32 v37, v37, v251, v252
    v_max3_f32 v39, v39, -v251, -v252
    v_mfma_f32_16x16x32_bf16 v[140:143], v[72:75], v[68:71], v[140:143]
    v_max3_f32 v37, v37, v253, v254
    v_max3_f32 v39, v39, -v253, -v254
    v_max_f32_e64 v37, v37, v255
    v_max_f32 v39, v39, -v255
    v_permlane32_swap_b32 v36, v38
    s_nop 0
    v_permlane32_swap_b32 v37, v39
    v_max_f32 v36, v36, v38
    v_max_f32_e64 v37, v37, v39
    v_mul_f32 v36, -v36, v34
    v_mul_f32 v37, -v37, v48
    v_mov_b32 v38, v36
    v_mov_b32 v39, v37
    s_nop 0
    v_permlane32_swap_b32 v36, v38
    v_permlane32_swap_b32_e64 v37, v39
    v_pk_fma_f32 v[60:61], v[224:225], v[34:35], v[36:37] op_sel_hi:[1,0,0]
    v_pk_fma_f32 v[62:63], v[226:227], v[34:35], v[36:37] op_sel_hi:[1,0,0]
    v_pk_fma_f32 v[64:65], v[228:229], v[34:35], v[36:37] op_sel_hi:[1,0,0]
    v_pk_fma_f32 v[66:67], v[230:231], v[34:35], v[36:37] op_sel_hi:[1,0,0]
    v_pk_fma_f32 v[68:69], v[232:233], v[34:35], v[36:37] op_sel_hi:[1,0,0]
    v_pk_fma_f32 v[70:71], v[234:235], v[34:35], v[36:37] op_sel_hi:[1,0,0]
    v_pk_fma_f32 v[72:73], v[236:237], v[34:35], v[36:37] op_sel_hi:[1,0,0]
    v_pk_fma_f32 v[74:75], v[238:239], v[34:35], v[36:37] op_sel_hi:[1,0,0]
    v_pk_fma_f32 v[76:77], v[224:225], v[34:35], v[38:39] op_sel_hi:[1,0,0] neg_lo:[1,0,0] neg_hi:[1,0,0]
    v_pk_fma_f32 v[78:79], v[226:227], v[34:35], v[38:39] op_sel_hi:[1,0,0] neg_lo:[1,0,0] neg_hi:[1,0,0]
    v_pk_fma_f32 v[80:81], v[228:229], v[34:35], v[38:39] op_sel_hi:[1,0,0] neg_lo:[1,0,0] neg_hi:[1,0,0]
    v_pk_fma_f32 v[82:83], v[230:231], v[34:35], v[38:39] op_sel_hi:[1,0,0] neg_lo:[1,0,0] neg_hi:[1,0,0]
    v_pk_fma_f32 v[84:85], v[232:233], v[34:35], v[38:39] op_sel_hi:[1,0,0] neg_lo:[1,0,0] neg_hi:[1,0,0]
    v_pk_fma_f32 v[86:87], v[234:235], v[34:35], v[38:39] op_sel_hi:[1,0,0] neg_lo:[1,0,0] neg_hi:[1,0,0]
    v_pk_fma_f32 v[88:89], v[236:237], v[34:35], v[38:39] op_sel_hi:[1,0,0] neg_lo:[1,0,0] neg_hi:[1,0,0]
    v_pk_fma_f32 v[90:91], v[238:239], v[34:35], v[38:39] op_sel_hi:[1,0,0] neg_lo:[1,0,0] neg_hi:[1,0,0]
    v_exp_f32 v60, v60
    v_exp_f32 v61, v61
    v_exp_f32 v62, v62
    v_exp_f32 v63, v63
    v_exp_f32 v64, v64
    v_exp_f32 v65, v65
    v_exp_f32 v66, v66
    v_exp_f32 v67, v67
    v_exp_f32 v68, v68
    v_exp_f32 v69, v69
    v_exp_f32 v70, v70
    v_exp_f32 v71, v71
    v_exp_f32 v72, v72
    v_exp_f32 v73, v73
    v_exp_f32 v74, v74
    v_exp_f32 v75, v75
    v_exp_f32 v76, v76
    v_exp_f32 v77, v77
    v_exp_f32 v78, v78
    v_exp_f32 v79, v79
    v_exp_f32 v80, v80
    v_exp_f32 v81, v81
    v_exp_f32 v82, v82
    v_exp_f32 v83, v83
    v_exp_f32 v84, v84
    v_exp_f32 v85, v85
    v_exp_f32 v86, v86
    v_exp_f32 v87, v87
    v_exp_f32 v88, v88
    v_exp_f32 v89, v89
    v_exp_f32 v90, v90
    v_exp_f32 v91, v91
    v_pk_add_f32 v[40:41], v[60:61], v[62:63]
    v_pk_add_f32 v[42:43], v[76:77], v[78:79]
    v_pk_add_f32 v[40:41], v[40:41], v[64:65]
    v_pk_add_f32 v[42:43], v[42:43], v[80:81]
    v_pk_add_f32 v[40:41], v[40:41], v[66:67]
    v_pk_add_f32 v[42:43], v[42:43], v[82:83]
    v_pk_add_f32 v[40:41], v[40:41], v[68:69]
    v_pk_add_f32 v[42:43], v[42:43], v[84:85]
    v_pk_add_f32 v[40:41], v[40:41], v[70:71]
    v_pk_add_f32 v[42:43], v[42:43], v[86:87]
    v_pk_add_f32 v[40:41], v[40:41], v[72:73]
    v_pk_add_f32 v[42:43], v[42:43], v[88:89]
    v_pk_add_f32 v[40:41], v[40:41], v[74:75]
    v_pk_add_f32 v[42:43], v[42:43], v[90:91]
    v_add_f32 v40, v40, v41
    v_add_f32 v42, v42, v43
    s_nop 1
    v_permlane32_swap_b32 v40, v42
    v_add_f32 v40, v40, v42
    v_rcp_f32 v40, v40
    s_nop 0
    v_mov_b32 v42, v40
    s_nop 1
    v_permlane32_swap_b32 v40, v42
    v_pk_mul_f32 v[60:61], v[60:61], v[40:41] op_sel_hi:[1,0]
    v_pk_mul_f32 v[62:63], v[62:63], v[40:41] op_sel_hi:[1,0]
    v_pk_mul_f32 v[64:65], v[64:65], v[40:41] op_sel_hi:[1,0]
    v_pk_mul_f32 v[66:67], v[66:67], v[40:41] op_sel_hi:[1,0]
    v_cvt_pk_bf16_f32 v160, v60, v61
    v_cvt_pk_bf16_f32 v161, v62, v63
    v_cvt_pk_bf16_f32 v162, v64, v65
    v_cvt_pk_bf16_f32 v163, v66, v67
    v_pk_mul_f32 v[68:69], v[68:69], v[40:41] op_sel_hi:[1,0]
    v_pk_mul_f32 v[70:71], v[70:71], v[40:41] op_sel_hi:[1,0]
    v_pk_mul_f32 v[72:73], v[72:73], v[40:41] op_sel_hi:[1,0]
    v_pk_mul_f32 v[74:75], v[74:75], v[40:41] op_sel_hi:[1,0]
    v_cvt_pk_bf16_f32 v166, v68, v69
    v_cvt_pk_bf16_f32 v167, v70, v71
    v_cvt_pk_bf16_f32 v164, v72, v73
    v_cvt_pk_bf16_f32 v165, v74, v75
    v_pk_mul_f32 v[76:77], v[76:77], v[42:43] op_sel_hi:[1,0]
    v_pk_mul_f32 v[78:79], v[78:79], v[42:43] op_sel_hi:[1,0]
    v_pk_mul_f32 v[80:81], v[80:81], v[42:43] op_sel_hi:[1,0]
    v_pk_mul_f32 v[82:83], v[82:83], v[42:43] op_sel_hi:[1,0]
    v_cvt_pk_bf16_f32 v168, v76, v77
    v_cvt_pk_bf16_f32 v169, v78, v79
    v_cvt_pk_bf16_f32 v170, v80, v81
    v_cvt_pk_bf16_f32 v171, v82, v83
    v_pk_mul_f32 v[84:85], v[84:85], v[42:43] op_sel_hi:[1,0]
    v_pk_mul_f32 v[86:87], v[86:87], v[42:43] op_sel_hi:[1,0]
    v_pk_mul_f32 v[88:89], v[88:89], v[42:43] op_sel_hi:[1,0]
    v_pk_mul_f32 v[90:91], v[90:91], v[42:43] op_sel_hi:[1,0]
    v_cvt_pk_bf16_f32 v174, v84, v85
    v_cvt_pk_bf16_f32 v175, v86, v87
    v_cvt_pk_bf16_f32 v172, v88, v89
    v_cvt_pk_bf16_f32 v173, v90, v91
    v_pk_fma_f32 v[60:61], v[240:241], v[48:49], v[36:37] op_sel:[0,0,1] op_sel_hi:[1,0,1]
    v_pk_fma_f32 v[62:63], v[242:243], v[48:49], v[36:37] op_sel:[0,0,1] op_sel_hi:[1,0,1]
    v_pk_fma_f32 v[64:65], v[244:245], v[48:49], v[36:37] op_sel:[0,0,1] op_sel_hi:[1,0,1]
    v_pk_fma_f32 v[66:67], v[246:247], v[48:49], v[36:37] op_sel:[0,0,1] op_sel_hi:[1,0,1]
    v_pk_fma_f32 v[68:69], v[248:249], v[48:49], v[36:37] op_sel:[0,0,1] op_sel_hi:[1,0,1]
    v_pk_fma_f32 v[70:71], v[250:251], v[48:49], v[36:37] op_sel:[0,0,1] op_sel_hi:[1,0,1]
    v_pk_fma_f32 v[72:73], v[252:253], v[48:49], v[36:37] op_sel:[0,0,1] op_sel_hi:[1,0,1]
    v_pk_fma_f32 v[74:75], v[254:255], v[48:49], v[36:37] op_sel:[0,0,1] op_sel_hi:[1,0,1]
    v_pk_fma_f32 v[76:77], v[240:241], v[48:49], v[38:39] op_sel:[0,0,1] op_sel_hi:[1,0,1] neg_lo:[1,0,0] neg_hi:[1,0,0]
    v_pk_fma_f32 v[78:79], v[242:243], v[48:49], v[38:39] op_sel:[0,0,1] op_sel_hi:[1,0,1] neg_lo:[1,0,0] neg_hi:[1,0,0]
    v_pk_fma_f32 v[80:81], v[244:245], v[48:49], v[38:39] op_sel:[0,0,1] op_sel_hi:[1,0,1] neg_lo:[1,0,0] neg_hi:[1,0,0]
    v_pk_fma_f32 v[82:83], v[246:247], v[48:49], v[38:39] op_sel:[0,0,1] op_sel_hi:[1,0,1] neg_lo:[1,0,0] neg_hi:[1,0,0]
    v_pk_fma_f32 v[84:85], v[248:249], v[48:49], v[38:39] op_sel:[0,0,1] op_sel_hi:[1,0,1] neg_lo:[1,0,0] neg_hi:[1,0,0]
    v_pk_fma_f32 v[86:87], v[250:251], v[48:49], v[38:39] op_sel:[0,0,1] op_sel_hi:[1,0,1] neg_lo:[1,0,0] neg_hi:[1,0,0]
    v_pk_fma_f32 v[88:89], v[252:253], v[48:49], v[38:39] op_sel:[0,0,1] op_sel_hi:[1,0,1] neg_lo:[1,0,0] neg_hi:[1,0,0]
    v_pk_fma_f32 v[90:91], v[254:255], v[48:49], v[38:39] op_sel:[0,0,1] op_sel_hi:[1,0,1] neg_lo:[1,0,0] neg_hi:[1,0,0]
    v_exp_f32 v60, v60
    v_exp_f32 v61, v61
    v_exp_f32 v62, v62
    v_exp_f32 v63, v63
    ds_write_b128 v116, v[192:195] offset:0
    v_exp_f32 v64, v64
    v_exp_f32 v65, v65
    v_exp_f32 v66, v66
    v_exp_f32 v67, v67
    ds_write_b128 v116, v[196:199] offset:2048
    v_exp_f32 v68, v68
    v_exp_f32 v69, v69
    v_exp_f32 v70, v70
    v_exp_f32 v71, v71
    ds_write_b128 v116, v[200:203] offset:4096
    v_exp_f32 v72, v72
    v_exp_f32 v73, v73
    v_exp_f32 v74, v74
    v_exp_f32 v75, v75
    ds_write_b128 v116, v[204:207] offset:6144
    v_exp_f32 v76, v76
    v_exp_f32 v77, v77
    v_exp_f32 v78, v78
    v_exp_f32 v79, v79
    ds_write_b128 v112, v[160:163] offset:0
    v_exp_f32 v80, v80
    v_exp_f32 v81, v81
    v_exp_f32 v82, v82
    v_exp_f32 v83, v83
    ds_write_b128 v113, v[164:167] offset:0
    v_exp_f32 v84, v84
    v_exp_f32 v85, v85
    v_exp_f32 v86, v86
    v_exp_f32 v87, v87
    ds_write_b128 v114, v[168:171] offset:0
    v_exp_f32 v88, v88
    v_exp_f32 v89, v89
    v_exp_f32 v90, v90
    v_exp_f32 v91, v91
    ds_write_b128 v115, v[172:175] offset:0
    v_pk_add_f32 v[40:41], v[60:61], v[62:63]
    v_pk_add_f32 v[42:43], v[76:77], v[78:79]
    v_pk_add_f32 v[40:41], v[40:41], v[64:65]
    v_pk_add_f32 v[42:43], v[42:43], v[80:81]
    v_pk_add_f32 v[40:41], v[40:41], v[66:67]
    v_pk_add_f32 v[42:43], v[42:43], v[82:83]
    v_pk_add_f32 v[40:41], v[40:41], v[68:69]
    v_pk_add_f32 v[42:43], v[42:43], v[84:85]
    v_pk_add_f32 v[40:41], v[40:41], v[70:71]
    v_pk_add_f32 v[42:43], v[42:43], v[86:87]
    v_pk_add_f32 v[40:41], v[40:41], v[72:73]
    v_pk_add_f32 v[42:43], v[42:43], v[88:89]
    v_pk_add_f32 v[40:41], v[40:41], v[74:75]
    v_pk_add_f32 v[42:43], v[42:43], v[90:91]
    v_add_f32 v40, v40, v41
    v_add_f32 v42, v42, v43
    s_nop 1
    v_permlane32_swap_b32 v40, v42
    v_add_f32 v40, v40, v42
    v_rcp_f32 v40, v40
    s_nop 0
    v_mov_b32 v42, v40
    s_nop 1
    v_permlane32_swap_b32 v40, v42
    v_pk_mul_f32 v[60:61], v[60:61], v[40:41] op_sel_hi:[1,0]
    v_pk_mul_f32 v[62:63], v[62:63], v[40:41] op_sel_hi:[1,0]
    v_pk_mul_f32 v[64:65], v[64:65], v[40:41] op_sel_hi:[1,0]
    v_pk_mul_f32 v[66:67], v[66:67], v[40:41] op_sel_hi:[1,0]
    v_cvt_pk_bf16_f32 v176, v60, v61
    v_cvt_pk_bf16_f32 v177, v62, v63
    v_cvt_pk_bf16_f32 v178, v64, v65
    v_cvt_pk_bf16_f32 v179, v66, v67
    ds_write_b128 v112, v[176:179] offset:4096
    v_pk_mul_f32 v[68:69], v[68:69], v[40:41] op_sel_hi:[1,0]
    v_pk_mul_f32 v[70:71], v[70:71], v[40:41] op_sel_hi:[1,0]
    v_pk_mul_f32 v[72:73], v[72:73], v[40:41] op_sel_hi:[1,0]
    v_pk_mul_f32 v[74:75], v[74:75], v[40:41] op_sel_hi:[1,0]
    v_cvt_pk_bf16_f32 v182, v68, v69
    v_cvt_pk_bf16_f32 v183, v70, v71
    v_cvt_pk_bf16_f32 v180, v72, v73
    v_cvt_pk_bf16_f32 v181, v74, v75
    ds_write_b128 v113, v[180:183] offset:4096
    v_pk_mul_f32 v[76:77], v[76:77], v[42:43] op_sel_hi:[1,0]
    v_pk_mul_f32 v[78:79], v[78:79], v[42:43] op_sel_hi:[1,0]
    v_pk_mul_f32 v[80:81], v[80:81], v[42:43] op_sel_hi:[1,0]
    v_pk_mul_f32 v[82:83], v[82:83], v[42:43] op_sel_hi:[1,0]
    v_cvt_pk_bf16_f32 v184, v76, v77
    v_cvt_pk_bf16_f32 v185, v78, v79
    v_cvt_pk_bf16_f32 v186, v80, v81
    v_cvt_pk_bf16_f32 v187, v82, v83
    ds_write_b128 v114, v[184:187] offset:4096
    v_pk_mul_f32 v[84:85], v[84:85], v[42:43] op_sel_hi:[1,0]
    v_pk_mul_f32 v[86:87], v[86:87], v[42:43] op_sel_hi:[1,0]
    v_pk_mul_f32 v[88:89], v[88:89], v[42:43] op_sel_hi:[1,0]
    v_pk_mul_f32 v[90:91], v[90:91], v[42:43] op_sel_hi:[1,0]
    v_cvt_pk_bf16_f32 v190, v84, v85
    v_cvt_pk_bf16_f32 v191, v86, v87
    v_cvt_pk_bf16_f32 v188, v88, v89
    v_cvt_pk_bf16_f32 v189, v90, v91
    ds_write_b128 v115, v[188:191] offset:4096
    s_waitcnt lgkmcnt(0)
    s_barrier
    s_setprio 0
    s_nop 0
    v_mfma_f32_16x16x16_bf16 v[128:131], v[16:17], v[104:105], v[128:131]
    v_mfma_f32_16x16x16_bf16 v[144:147], v[18:19], v[104:105], v[144:147]
    v_mfma_f32_16x16x16_bf16 v[132:135], v[16:17], v[106:107], v[132:135]
    v_mfma_f32_16x16x16_bf16 v[148:151], v[18:19], v[106:107], v[148:151]
    v_mfma_f32_16x16x16_bf16 v[136:139], v[16:17], v[108:109], v[136:139]
    v_mfma_f32_16x16x16_bf16 v[152:155], v[18:19], v[108:109], v[152:155]
    v_mfma_f32_16x16x16_bf16 v[140:143], v[16:17], v[110:111], v[140:143]
    v_mfma_f32_16x16x16_bf16 v[156:159], v[18:19], v[110:111], v[156:159]
    v_lshrrev_b32 v11, 5, v2
    s_lshl_b32 s78, s81, 7
    s_add_u32 s78, s78, 162944
    v_lshl_add_u32 v10, v11, 4, s78
    v_and_b32 v13, 1, v2
    v_cmp_eq_u32 vcc, 1, v13
    v_mov_b32 v13, 162816
    v_and_b32 v12, 31, v2
    v_cndmask_b32 v10, v10, v13, vcc
    v_lshlrev_b32_e64 v12, 4, v12
    v_lshl_add_u32 v11, v11, 10, v12
    v_lshlrev_b32_e64 v14, 4, v2
    v_cvt_pk_bf16_f32 v128, v128, v129
    v_cvt_pk_bf16_f32 v129, v130, v131
    v_cvt_pk_bf16_f32 v130, v144, v145
    v_cvt_pk_bf16_f32 v131, v146, v147
    v_cvt_pk_bf16_f32 v132, v132, v133
    v_cvt_pk_bf16_f32 v133, v134, v135
    v_cvt_pk_bf16_f32 v134, v148, v149
    v_cvt_pk_bf16_f32 v135, v150, v151
    v_cvt_pk_bf16_f32 v136, v136, v137
    v_cvt_pk_bf16_f32 v137, v138, v139
    v_cvt_pk_bf16_f32 v138, v152, v153
    v_cvt_pk_bf16_f32 v139, v154, v155
    v_cvt_pk_bf16_f32 v140, v140, v141
    v_cvt_pk_bf16_f32 v141, v142, v143
    v_cvt_pk_bf16_f32 v142, v156, v157
    v_cvt_pk_bf16_f32 v143, v158, v159
    v_permlane16_swap_b32 v128, v132
    v_permlane16_swap_b32 v129, v133
    v_permlane16_swap_b32 v130, v134
    v_permlane16_swap_b32 v131, v135
    v_permlane16_swap_b32 v136, v140
    v_permlane16_swap_b32 v137, v141
    v_permlane16_swap_b32 v138, v142
    v_permlane16_swap_b32 v139, v143
    v_mfma_f32_32x32x16_bf16 v[224:239], v[96:99], v[128:131], 0
    v_mfma_f32_32x32x16_bf16 v[224:239], v[100:103], v[132:135], v[224:239]
    v_mfma_f32_32x32x16_bf16 v[240:255], v[96:99], v[136:139], 0
    v_mfma_f32_32x32x16_bf16 v[240:255], v[100:103], v[140:143], v[240:255]
    s_lshl_b32 s94, s70, 14
    s_lshl_b32 s79, s81, 13
    s_add_u32 s94, s94, s79
    s_add_u32 s94, s94, 8388608
    s_add_u32 s95, s94, 4096
    s_lshl_b32 s78, s69, 1
    s_add_u32 s78, s78, s80
    s_lshl_b32 s78, s78, 6
    s_lshl_b32 s79, s70, 1
    s_add_u32 s78, s78, s79
    s_add_u32 s78, s78, s81
    s_lshl_b32 s78, s78, 11
    s_add_u32 s96, s78, 4194304
    s_add_u32 s97, s96, 65536
    v_max3_f32 v36, v224, v225, v226
    v_max3_f32 v38, -v224, -v225, -v226
    v_max3_f32 v36, v36, v227, v228
    v_max3_f32 v38, v38, -v227, -v228
    v_max3_f32 v36, v36, v229, v230
    v_max3_f32 v38, v38, -v229, -v230
    v_max3_f32 v36, v36, v231, v232
    v_max3_f32 v38, v38, -v231, -v232
    v_max3_f32 v36, v36, v233, v234
    v_max3_f32 v38, v38, -v233, -v234
    v_max3_f32 v36, v36, v235, v236
    v_max3_f32 v38, v38, -v235, -v236
    v_max3_f32 v36, v36, v237, v238
    v_max3_f32 v38, v38, -v237, -v238
    v_max_f32_e64 v36, v36, v239
    v_max_f32 v38, v38, -v239
    v_max3_f32 v37, v240, v241, v242
    v_max3_f32 v39, -v240, -v241, -v242
    v_max3_f32 v37, v37, v243, v244
    v_max3_f32 v39, v39, -v243, -v244
    v_max3_f32 v37, v37, v245, v246
    v_max3_f32 v39, v39, -v245, -v246
    v_max3_f32 v37, v37, v247, v248
    v_max3_f32 v39, v39, -v247, -v248
    v_max3_f32 v37, v37, v249, v250
    v_max3_f32 v39, v39, -v249, -v250
    v_max3_f32 v37, v37, v251, v252
    v_max3_f32 v39, v39, -v251, -v252
    v_max3_f32 v37, v37, v253, v254
    v_max3_f32 v39, v39, -v253, -v254
    v_max_f32_e64 v37, v37, v255
    v_max_f32 v39, v39, -v255
    v_permlane32_swap_b32 v36, v38
    s_nop 0
    v_permlane32_swap_b32 v37, v39
    v_max_f32 v36, v36, v38
    v_max_f32_e64 v37, v37, v39
    v_mul_f32 v36, -v36, v34
    v_mul_f32 v37, -v37, v48
    v_mov_b32 v38, v36
    v_mov_b32 v39, v37
    s_nop 0
    v_permlane32_swap_b32 v36, v38
    v_permlane32_swap_b32_e64 v37, v39
    v_pk_fma_f32 v[60:61], v[224:225], v[34:35], v[36:37] op_sel_hi:[1,0,0]
    v_pk_fma_f32 v[62:63], v[226:227], v[34:35], v[36:37] op_sel_hi:[1,0,0]
    v_pk_fma_f32 v[64:65], v[228:229], v[34:35], v[36:37] op_sel_hi:[1,0,0]
    v_pk_fma_f32 v[66:67], v[230:231], v[34:35], v[36:37] op_sel_hi:[1,0,0]
    v_pk_fma_f32 v[68:69], v[232:233], v[34:35], v[36:37] op_sel_hi:[1,0,0]
    v_pk_fma_f32 v[70:71], v[234:235], v[34:35], v[36:37] op_sel_hi:[1,0,0]
    v_pk_fma_f32 v[72:73], v[236:237], v[34:35], v[36:37] op_sel_hi:[1,0,0]
    v_pk_fma_f32 v[74:75], v[238:239], v[34:35], v[36:37] op_sel_hi:[1,0,0]
    v_pk_fma_f32 v[76:77], v[224:225], v[34:35], v[38:39] op_sel_hi:[1,0,0] neg_lo:[1,0,0] neg_hi:[1,0,0]
    v_pk_fma_f32 v[78:79], v[226:227], v[34:35], v[38:39] op_sel_hi:[1,0,0] neg_lo:[1,0,0] neg_hi:[1,0,0]
    v_pk_fma_f32 v[80:81], v[228:229], v[34:35], v[38:39] op_sel_hi:[1,0,0] neg_lo:[1,0,0] neg_hi:[1,0,0]
    v_pk_fma_f32 v[82:83], v[230:231], v[34:35], v[38:39] op_sel_hi:[1,0,0] neg_lo:[1,0,0] neg_hi:[1,0,0]
    v_pk_fma_f32 v[84:85], v[232:233], v[34:35], v[38:39] op_sel_hi:[1,0,0] neg_lo:[1,0,0] neg_hi:[1,0,0]
    v_pk_fma_f32 v[86:87], v[234:235], v[34:35], v[38:39] op_sel_hi:[1,0,0] neg_lo:[1,0,0] neg_hi:[1,0,0]
    v_pk_fma_f32 v[88:89], v[236:237], v[34:35], v[38:39] op_sel_hi:[1,0,0] neg_lo:[1,0,0] neg_hi:[1,0,0]
    v_pk_fma_f32 v[90:91], v[238:239], v[34:35], v[38:39] op_sel_hi:[1,0,0] neg_lo:[1,0,0] neg_hi:[1,0,0]
    v_exp_f32 v60, v60
    v_exp_f32 v61, v61
    v_exp_f32 v62, v62
    v_exp_f32 v63, v63
    v_exp_f32 v64, v64
    v_exp_f32 v65, v65
    v_exp_f32 v66, v66
    v_exp_f32 v67, v67
    v_exp_f32 v68, v68
    v_exp_f32 v69, v69
    v_exp_f32 v70, v70
    v_exp_f32 v71, v71
    v_exp_f32 v72, v72
    v_exp_f32 v73, v73
    v_exp_f32 v74, v74
    v_exp_f32 v75, v75
    v_exp_f32 v76, v76
    v_exp_f32 v77, v77
    v_exp_f32 v78, v78
    v_exp_f32 v79, v79
    v_exp_f32 v80, v80
    v_exp_f32 v81, v81
    v_exp_f32 v82, v82
    v_exp_f32 v83, v83
    v_exp_f32 v84, v84
    v_exp_f32 v85, v85
    v_exp_f32 v86, v86
    v_exp_f32 v87, v87
    v_exp_f32 v88, v88
    v_exp_f32 v89, v89
    v_exp_f32 v90, v90
    v_exp_f32 v91, v91
    v_cvt_pk_bf16_f32 v160, v60, v61
    v_cvt_pk_bf16_f32 v161, v62, v63
    v_cvt_pk_bf16_f32 v162, v64, v65
    v_cvt_pk_bf16_f32 v163, v66, v67
    v_cvt_pk_bf16_f32 v164, v68, v69
    v_cvt_pk_bf16_f32 v165, v70, v71
    v_cvt_pk_bf16_f32 v166, v72, v73
    v_cvt_pk_bf16_f32 v167, v74, v75
    v_cvt_pk_bf16_f32 v168, v76, v77
    v_cvt_pk_bf16_f32 v169, v78, v79
    v_cvt_pk_bf16_f32 v170, v80, v81
    v_cvt_pk_bf16_f32 v171, v82, v83
    v_cvt_pk_bf16_f32 v172, v84, v85
    v_cvt_pk_bf16_f32 v173, v86, v87
    v_cvt_pk_bf16_f32 v174, v88, v89
    v_cvt_pk_bf16_f32 v175, v90, v91
    v_pk_fma_f32 v[60:61], v[240:241], v[48:49], v[36:37] op_sel:[0,0,1] op_sel_hi:[1,0,1]
    v_pk_fma_f32 v[62:63], v[242:243], v[48:49], v[36:37] op_sel:[0,0,1] op_sel_hi:[1,0,1]
    v_pk_fma_f32 v[64:65], v[244:245], v[48:49], v[36:37] op_sel:[0,0,1] op_sel_hi:[1,0,1]
    v_pk_fma_f32 v[66:67], v[246:247], v[48:49], v[36:37] op_sel:[0,0,1] op_sel_hi:[1,0,1]
    v_pk_fma_f32 v[68:69], v[248:249], v[48:49], v[36:37] op_sel:[0,0,1] op_sel_hi:[1,0,1]
    v_pk_fma_f32 v[70:71], v[250:251], v[48:49], v[36:37] op_sel:[0,0,1] op_sel_hi:[1,0,1]
    v_pk_fma_f32 v[72:73], v[252:253], v[48:49], v[36:37] op_sel:[0,0,1] op_sel_hi:[1,0,1]
    v_pk_fma_f32 v[74:75], v[254:255], v[48:49], v[36:37] op_sel:[0,0,1] op_sel_hi:[1,0,1]
    v_pk_fma_f32 v[76:77], v[240:241], v[48:49], v[38:39] op_sel:[0,0,1] op_sel_hi:[1,0,1] neg_lo:[1,0,0] neg_hi:[1,0,0]
    v_pk_fma_f32 v[78:79], v[242:243], v[48:49], v[38:39] op_sel:[0,0,1] op_sel_hi:[1,0,1] neg_lo:[1,0,0] neg_hi:[1,0,0]
    v_pk_fma_f32 v[80:81], v[244:245], v[48:49], v[38:39] op_sel:[0,0,1] op_sel_hi:[1,0,1] neg_lo:[1,0,0] neg_hi:[1,0,0]
    v_pk_fma_f32 v[82:83], v[246:247], v[48:49], v[38:39] op_sel:[0,0,1] op_sel_hi:[1,0,1] neg_lo:[1,0,0] neg_hi:[1,0,0]
    v_pk_fma_f32 v[84:85], v[248:249], v[48:49], v[38:39] op_sel:[0,0,1] op_sel_hi:[1,0,1] neg_lo:[1,0,0] neg_hi:[1,0,0]
    v_pk_fma_f32 v[86:87], v[250:251], v[48:49], v[38:39] op_sel:[0,0,1] op_sel_hi:[1,0,1] neg_lo:[1,0,0] neg_hi:[1,0,0]
    v_pk_fma_f32 v[88:89], v[252:253], v[48:49], v[38:39] op_sel:[0,0,1] op_sel_hi:[1,0,1] neg_lo:[1,0,0] neg_hi:[1,0,0]
    v_pk_fma_f32 v[90:91], v[254:255], v[48:49], v[38:39] op_sel:[0,0,1] op_sel_hi:[1,0,1] neg_lo:[1,0,0] neg_hi:[1,0,0]
    v_exp_f32 v60, v60
    v_exp_f32 v61, v61
    v_exp_f32 v62, v62
    v_exp_f32 v63, v63
    v_exp_f32 v64, v64
    v_exp_f32 v65, v65
    v_exp_f32 v66, v66
    v_exp_f32 v67, v67
    v_exp_f32 v68, v68
    v_exp_f32 v69, v69
    v_exp_f32 v70, v70
    v_exp_f32 v71, v71
    v_exp_f32 v72, v72
    v_exp_f32 v73, v73
    v_exp_f32 v74, v74
    v_exp_f32 v75, v75
    v_exp_f32 v76, v76
    v_exp_f32 v77, v77
    v_exp_f32 v78, v78
    v_exp_f32 v79, v79
    v_exp_f32 v80, v80
    v_exp_f32 v81, v81
    v_exp_f32 v82, v82
    v_exp_f32 v83, v83
    v_exp_f32 v84, v84
    v_exp_f32 v85, v85
    v_exp_f32 v86, v86
    v_exp_f32 v87, v87
    v_exp_f32 v88, v88
    v_exp_f32 v89, v89
    v_exp_f32 v90, v90
    v_exp_f32 v91, v91
    v_cvt_pk_bf16_f32 v176, v60, v61
    v_cvt_pk_bf16_f32 v177, v62, v63
    v_cvt_pk_bf16_f32 v178, v64, v65
    v_cvt_pk_bf16_f32 v179, v66, v67
    v_cvt_pk_bf16_f32 v180, v68, v69
    v_cvt_pk_bf16_f32 v181, v70, v71
    v_cvt_pk_bf16_f32 v182, v72, v73
    v_cvt_pk_bf16_f32 v183, v74, v75
    v_cvt_pk_bf16_f32 v184, v76, v77
    v_cvt_pk_bf16_f32 v185, v78, v79
    v_cvt_pk_bf16_f32 v186, v80, v81
    v_cvt_pk_bf16_f32 v187, v82, v83
    v_cvt_pk_bf16_f32 v188, v84, v85
    v_cvt_pk_bf16_f32 v189, v86, v87
    v_cvt_pk_bf16_f32 v190, v88, v89
    v_cvt_pk_bf16_f32 v191, v90, v91
    s_barrier
    s_setprio 1
    ds_read_b128 v[16:19], v10 offset:0
    ds_read_b128 v[20:23], v10 offset:32
    ds_read_b128 v[24:27], v10 offset:64
    ds_read_b128 v[28:31], v10 offset:96
    s_waitcnt lgkmcnt(3)
    v_mfma_f32_32x32x16_bf16 v[224:239], v[16:19], v[160:163], 0
    buffer_load_dwordx4 v[96:99], v11, s[36:39], s94 offen offset:0 sc1
    buffer_load_dwordx4 v[100:103], v11, s[36:39], s94 offen offset:2048 sc1
    buffer_load_dwordx4 v[104:107], v11, s[36:39], s95 offen offset:0 sc1
    buffer_load_dwordx4 v[108:111], v11, s[36:39], s95 offen offset:2048 sc1
    s_waitcnt lgkmcnt(2)
    v_mfma_f32_32x32x16_bf16 v[224:239], v[20:23], v[164:167], v[224:239]
    s_waitcnt lgkmcnt(1)
    v_mfma_f32_32x32x16_bf16 v[240:255], v[24:27], v[168:171], 0
    s_waitcnt lgkmcnt(0)
    v_mfma_f32_32x32x16_bf16 v[240:255], v[28:31], v[172:175], v[240:255]
    v_mfma_f32_32x32x16_bf16 v[192:207], v[16:19], v[176:179], 0
    v_mfma_f32_32x32x16_bf16 v[192:207], v[20:23], v[180:183], v[192:207]
    v_mfma_f32_32x32x16_bf16 v[208:223], v[24:27], v[184:187], 0
    v_mfma_f32_32x32x16_bf16 v[208:223], v[28:31], v[188:191], v[208:223]
    s_mov_b32 s85, 0
    s_branch L_kvchk
L_kvspin:
    s_add_u32 s85, s85, 1
    s_cmp_gt_u32 s85, 400000
    s_cbranch_scc1 L_end
    buffer_load_dwordx4 v[96:99], v11, s[36:39], s94 offen offset:0 sc1
    buffer_load_dwordx4 v[100:103], v11, s[36:39], s94 offen offset:2048 sc1
    buffer_load_dwordx4 v[104:107], v11, s[36:39], s95 offen offset:0 sc1
    buffer_load_dwordx4 v[108:111], v11, s[36:39], s95 offen offset:2048 sc1
L_kvchk:
    s_waitcnt vmcnt(0)
    s_nop 0
    v_mfma_f32_32x32x16_bf16 v[60:75], v[96:99], v[160:163], 0
    v_max3_u32 v13, v96, v97, v98
    v_max3_u32 v10, v99, v100, v101
    v_max3_u32 v13, v13, v102, v103
    v_max3_u32 v10, v10, v104, v105
    v_max3_u32 v13, v13, v106, v107
    v_mfma_f32_32x32x16_bf16 v[60:75], v[100:103], v[164:167], v[60:75]
    v_max3_u32 v10, v10, v108, v109
    v_max3_u32 v13, v13, v110, v111
    v_max_u32 v13, v13, v10
    v_cmp_eq_u32_e64 vcc, -1, v13
    s_cbranch_vccnz L_kvspin
    v_mfma_f32_32x32x16_bf16 v[76:91], v[104:107], v[168:171], 0
    v_rcp_f32 v36, v225
    v_rcp_f32 v40, v193
    v_rcp_f32 v38, v241
    v_rcp_f32 v42, v209
    v_mfma_f32_32x32x16_bf16 v[76:91], v[108:111], v[172:175], v[76:91]
    v_mov_b32 v44, 0x358637bd
    v_mov_b32 v45, 0x358637bd
    v_fmac_f32 v44, v224, v36
    v_fmac_f32 v45, v192, v40
    v_fmac_f32 v44, v240, v38
    v_fmac_f32 v45, v208, v42
    v_mfma_f32_32x32x16_bf16 v[128:143], v[96:99], v[176:179], 0
    v_rcp_f32 v44, v44
    v_rcp_f32 v45, v45
    v_mul_f32 v36, v36, v44
    v_mul_f32 v40, v40, v45
    v_mfma_f32_32x32x16_bf16 v[128:143], v[100:103], v[180:183], v[128:143]
    v_mul_f32 v38, v38, v44
    v_mul_f32 v42, v42, v45
    v_mul_f32 v60, v60, v36
    v_mul_f32 v61, v61, v36
    v_mul_f32 v62, v62, v36
    v_mul_f32 v63, v63, v36
    v_mfma_f32_32x32x16_bf16 v[144:159], v[104:107], v[184:187], 0
    v_mul_f32 v64, v64, v36
    v_mul_f32 v65, v65, v36
    v_mul_f32 v66, v66, v36
    v_mul_f32 v67, v67, v36
    v_mul_f32 v68, v68, v36
    v_mul_f32 v69, v69, v36
    v_mfma_f32_32x32x16_bf16 v[144:159], v[108:111], v[188:191], v[144:159]
    v_mul_f32 v70, v70, v36
    v_mul_f32 v71, v71, v36
    v_mul_f32 v72, v72, v36
    v_mul_f32 v73, v73, v36
    v_mul_f32 v74, v74, v36
    v_mul_f32 v75, v75, v36
    v_pk_fma_f32 v[60:61], v[76:77], v[38:39], v[60:61] op_sel_hi:[1,0,1]
    v_pk_fma_f32 v[62:63], v[78:79], v[38:39], v[62:63] op_sel_hi:[1,0,1]
    v_pk_fma_f32 v[64:65], v[80:81], v[38:39], v[64:65] op_sel_hi:[1,0,1]
    v_pk_fma_f32 v[66:67], v[82:83], v[38:39], v[66:67] op_sel_hi:[1,0,1]
    v_cvt_pk_bf16_f32 v16, v60, v61
    v_cvt_pk_bf16_f32 v17, v62, v63
    v_cvt_pk_bf16_f32 v18, v64, v65
    v_cvt_pk_bf16_f32 v19, v66, v67
    buffer_store_dwordx4 v[16:19], v14, s[36:39], s96 offen offset:0 sc1
    v_pk_fma_f32 v[68:69], v[84:85], v[38:39], v[68:69] op_sel_hi:[1,0,1]
    v_pk_fma_f32 v[70:71], v[86:87], v[38:39], v[70:71] op_sel_hi:[1,0,1]
    v_pk_fma_f32 v[72:73], v[88:89], v[38:39], v[72:73] op_sel_hi:[1,0,1]
    v_pk_fma_f32 v[74:75], v[90:91], v[38:39], v[74:75] op_sel_hi:[1,0,1]
    v_cvt_pk_bf16_f32 v20, v68, v69
    v_cvt_pk_bf16_f32 v21, v70, v71
    v_cvt_pk_bf16_f32 v22, v72, v73
    v_cvt_pk_bf16_f32 v23, v74, v75
    buffer_store_dwordx4 v[20:23], v14, s[36:39], s96 offen offset:1024 sc1
    v_pk_mul_f32 v[128:129], v[128:129], v[40:41] op_sel_hi:[1,0]
    v_pk_mul_f32 v[130:131], v[130:131], v[40:41] op_sel_hi:[1,0]
    v_pk_mul_f32 v[132:133], v[132:133], v[40:41] op_sel_hi:[1,0]
    v_pk_mul_f32 v[134:135], v[134:135], v[40:41] op_sel_hi:[1,0]
    v_pk_fma_f32 v[128:129], v[144:145], v[42:43], v[128:129] op_sel_hi:[1,0,1]
    v_pk_fma_f32 v[130:131], v[146:147], v[42:43], v[130:131] op_sel_hi:[1,0,1]
    v_pk_fma_f32 v[132:133], v[148:149], v[42:43], v[132:133] op_sel_hi:[1,0,1]
    v_pk_fma_f32 v[134:135], v[150:151], v[42:43], v[134:135] op_sel_hi:[1,0,1]
    v_cvt_pk_bf16_f32 v24, v128, v129
    v_cvt_pk_bf16_f32 v25, v130, v131
    v_cvt_pk_bf16_f32 v26, v132, v133
    v_cvt_pk_bf16_f32 v27, v134, v135
    buffer_store_dwordx4 v[24:27], v14, s[36:39], s97 offen offset:0 sc1
    v_pk_mul_f32 v[136:137], v[136:137], v[40:41] op_sel_hi:[1,0]
    v_pk_mul_f32 v[138:139], v[138:139], v[40:41] op_sel_hi:[1,0]
    v_pk_mul_f32 v[140:141], v[140:141], v[40:41] op_sel_hi:[1,0]
    v_pk_mul_f32 v[142:143], v[142:143], v[40:41] op_sel_hi:[1,0]
    v_pk_fma_f32 v[136:137], v[152:153], v[42:43], v[136:137] op_sel_hi:[1,0,1]
    v_pk_fma_f32 v[138:139], v[154:155], v[42:43], v[138:139] op_sel_hi:[1,0,1]
    v_pk_fma_f32 v[140:141], v[156:157], v[42:43], v[140:141] op_sel_hi:[1,0,1]
    v_pk_fma_f32 v[142:143], v[158:159], v[42:43], v[142:143] op_sel_hi:[1,0,1]
    v_cvt_pk_bf16_f32 v28, v136, v137
    v_cvt_pk_bf16_f32 v29, v138, v139
    v_cvt_pk_bf16_f32 v30, v140, v141
    v_cvt_pk_bf16_f32 v31, v142, v143
    buffer_store_dwordx4 v[28:31], v14, s[36:39], s97 offen offset:1024 sc1
    v_and_b32 v8, 31, v2
    v_lshrrev_b32 v9, 5, v2
    v_lshlrev_b32 v10, 3, v9
    s_lshl_b32 s78, s72, 7
    buffer_load_dwordx2 v[32:33], v10, s[64:67], s78 offen offset:0
    buffer_load_dwordx2 v[34:35], v10, s[64:67], s78 offen offset:16
    buffer_load_dwordx2 v[36:37], v10, s[64:67], s78 offen offset:32
    buffer_load_dwordx2 v[38:39], v10, s[64:67], s78 offen offset:48
    buffer_load_dwordx2 v[40:41], v10, s[64:67], s78 offen offset:64
    buffer_load_dwordx2 v[42:43], v10, s[64:67], s78 offen offset:80
    buffer_load_dwordx2 v[44:45], v10, s[64:67], s78 offen offset:96
    buffer_load_dwordx2 v[46:47], v10, s[64:67], s78 offen offset:112
    buffer_load_dwordx4 v[48:51], v14, s[64:67], 0 offen
    buffer_load_dwordx4 v[52:55], v14, s[64:67], 0 offen offset:1024
    s_barrier
    s_lshl_b32 s78, s76, 12
    s_add_u32 s78, s78, 131072
    v_lshl_add_u32 v6, v8, 7, s78
    v_add_u32_e64 v6, v6, v10
    v_bfe_u32 v11, v8, 1, 3
    v_lshl_add_u32 v6, v11, 4, v6
    v_xor_b32_e64 v112, 0, v6
    ds_read_b64 v[96:97], v112
    v_xor_b32_e64 v113, 16, v6
    ds_read_b64 v[98:99], v113
    v_xor_b32_e64 v114, 32, v6
    ds_read_b64 v[100:101], v114
    v_xor_b32_e64 v115, 48, v6
    ds_read_b64 v[102:103], v115
    v_xor_b32_e64 v116, 64, v6
    ds_read_b64 v[104:105], v116
    v_xor_b32 v117, 80, v6
    ds_read_b64 v[106:107], v117
    v_xor_b32 v118, 96, v6
    ds_read_b64 v[108:109], v118
    v_xor_b32 v119, 112, v6
    ds_read_b64 v[110:111], v119
    v_bfe_u32 v11, v2, 2, 2
    v_lshl_add_u32 v12, v9, 2, v11
    v_lshlrev_b32 v12, 7, v12
    v_lshrrev_b32 v11, 1, v11
    v_lshl_add_u32 v12, v11, 6, v12
    v_bfe_u32 v11, v2, 4, 1
    v_lshl_add_u32 v12, v11, 5, v12
    v_and_b32_e64 v11, 3, v2
    v_lshl_add_u32 v12, v11, 3, v12
    s_lshl_b32 s82, s72, 0
    s_and_b32 s82, s82, 15
    s_lshl_b32 s78, s82, 13
    v_add_u32 v4, s78, v12
    v_xor_b32 v5, 64, v4
    s_lshl_b32 s83, s71, 2
    s_add_u32 s83, s83, s76
    s_lshl_b32 s83, s83, 16
    s_add_u32 s83, s83, 4194304
    s_lshl_b32 s82, s82, 12
    s_add_u32 s88, s82, s83
    s_waitcnt lgkmcnt(0)
    v_lshlrev_b32 v224, 16, v96
    v_and_b32 v225, 0xffff0000, v96
    v_lshlrev_b32_e64 v226, 16, v97
    v_and_b32 v227, 0xffff0000, v97
    v_lshlrev_b32_e64 v228, 16, v98
    v_and_b32 v229, 0xffff0000, v98
    v_lshlrev_b32_e64 v230, 16, v99
    v_and_b32 v231, 0xffff0000, v99
    v_lshlrev_b32_e64 v232, 16, v100
    v_and_b32 v233, 0xffff0000, v100
    v_lshlrev_b32_e64 v234, 16, v101
    v_and_b32 v235, 0xffff0000, v101
    v_lshlrev_b32_e64 v236, 16, v102
    v_and_b32 v237, 0xffff0000, v102
    v_lshlrev_b32_e64 v238, 16, v103
    v_and_b32 v239, 0xffff0000, v103
    v_lshlrev_b32_e64 v240, 16, v104
    v_and_b32 v241, 0xffff0000, v104
    v_lshlrev_b32_e64 v242, 16, v105
    v_and_b32 v243, 0xffff0000, v105
    v_lshlrev_b32_e64 v244, 16, v106
    v_and_b32 v245, 0xffff0000, v106
    v_lshlrev_b32_e64 v246, 16, v107
    v_and_b32 v247, 0xffff0000, v107
    v_lshlrev_b32_e64 v248, 16, v108
    v_and_b32 v249, 0xffff0000, v108
    v_lshlrev_b32_e64 v250, 16, v109
    v_and_b32 v251, 0xffff0000, v109
    v_lshlrev_b32_e64 v252, 16, v110
    v_and_b32 v253, 0xffff0000, v110
    v_lshlrev_b32_e64 v254, 16, v111
    v_and_b32 v255, 0xffff0000, v111
    s_waitcnt vmcnt(0)
    s_barrier
    v_lshlrev_b32_e64 v60, 16, v32
    v_and_b32 v61, 0xffff0000, v32
    v_lshlrev_b32_e64 v62, 16, v33
    v_and_b32 v63, 0xffff0000, v33
    v_lshlrev_b32_e64 v64, 16, v34
    v_and_b32 v65, 0xffff0000, v34
    v_lshlrev_b32_e64 v66, 16, v35
    v_and_b32 v67, 0xffff0000, v35
    v_lshlrev_b32_e64 v68, 16, v36
    v_and_b32 v69, 0xffff0000, v36
    v_lshlrev_b32_e64 v70, 16, v37
    v_and_b32 v71, 0xffff0000, v37
    v_lshlrev_b32_e64 v72, 16, v38
    v_and_b32 v73, 0xffff0000, v38
    v_lshlrev_b32_e64 v74, 16, v39
    v_and_b32 v75, 0xffff0000, v39
    v_lshlrev_b32_e64 v76, 16, v40
    v_and_b32 v77, 0xffff0000, v40
    v_lshlrev_b32_e64 v78, 16, v41
    v_and_b32 v79, 0xffff0000, v41
    v_lshlrev_b32_e64 v80, 16, v42
    v_and_b32 v81, 0xffff0000, v42
    v_lshlrev_b32_e64 v82, 16, v43
    v_and_b32 v83, 0xffff0000, v43
    v_lshlrev_b32_e64 v84, 16, v44
    v_and_b32 v85, 0xffff0000, v44
    v_lshlrev_b32_e64 v86, 16, v45
    v_and_b32 v87, 0xffff0000, v45
    v_lshlrev_b32_e64 v88, 16, v46
    v_and_b32 v89, 0xffff0000, v46
    v_lshlrev_b32_e64 v90, 16, v47
    v_and_b32 v91, 0xffff0000, v47
    s_mov_b32 s78, 0x3f803f80
    v_dot2_f32_bf16 v126, v48, s78, 0
    v_dot2_f32_bf16 v126, v49, s78, v126
    v_dot2_f32_bf16 v126, v50, s78, v126
    v_dot2_f32_bf16 v126, v51, s78, v126
    v_dot2_f32_bf16 v126, v52, s78, v126
    v_dot2_f32_bf16 v126, v53, s78, v126
    v_dot2_f32_bf16 v126, v54, s78, v126
    v_dot2_f32_bf16 v126, v55, s78, v126
    s_nop 2
    v_add_f32_dpp v126, v126, v126 row_ror:8 row_mask:0xf bank_mask:0xf
    s_nop 1
    v_add_f32_dpp v126, v126, v126 row_ror:4 row_mask:0xf bank_mask:0xf
    s_nop 1
    v_add_f32_dpp v126, v126, v126 row_ror:2 row_mask:0xf bank_mask:0xf
    s_nop 1
    v_add_f32_dpp v126, v126, v126 row_ror:1 row_mask:0xf bank_mask:0xf
    v_mov_b32 v127, v126
    s_nop 1
    v_permlane32_swap_b32 v126, v127
    v_add_f32 v126, v126, v127
    v_mov_b32 v127, v126
    s_nop 1
    v_permlane16_swap_b32 v126, v127
    v_add_f32 v126, v126, v127
    v_lshlrev_b32_e64 v12, 4, v8
    v_lshl_add_u32 v12, v9, 14, v12
    s_lshl_b32 s94, s71, 15
    s_lshl_b32 s79, s76, 9
    s_add_u32 s94, s94, s79
    s_add_u32 s94, s94, 1572864
    s_lshl_b32 s95, s72, 11
    s_add_u32 s95, s95, s94
    s_lshl_b32 s78, s76, 5
    v_add_u32 v11, s78, v8
    v_and_b32 v13, 7, v8
    v_xor_b32 v13, v13, v9
    v_lshlrev_b32 v13, 4, v13
    v_lshl_add_u32 v13, v11, 8, v13
    v_lshlrev_b32_e64 v10, 3, v11
    v_add_u32 v10, 159744, v10
    s_lshl_b32 s78, s71, 7
    v_add_u32 v11, s78, v11
    v_mov_b32 v15, 163584
    ds_read_b32 v15, v15
    s_waitcnt lgkmcnt(0)
    v_readfirstlane_b32 s99, v15
    s_mov_b32 s84, 0
    s_barrier
    buffer_load_dwordx4 v[160:163], v14, s[36:39], s88 offen offset:0 sc1
    ds_read_b64_tr_b16 v[128:129], v4 offset:0
    buffer_load_dwordx4 v[164:167], v14, s[36:39], s88 offen offset:1024 sc1
    ds_read_b64_tr_b16 v[130:131], v4 offset:1024
    buffer_load_dwordx4 v[168:171], v14, s[36:39], s88 offen offset:2048 sc1
    ds_read_b64_tr_b16 v[132:133], v5 offset:0
    buffer_load_dwordx4 v[172:175], v14, s[36:39], s88 offen offset:3072 sc1
    s_add_u32 s82, s82, 4096
    s_and_b32 s82, s82, 0xffff
    s_add_u32 s88, s82, s83
    s_nop 0
    ds_read_b64_tr_b16 v[134:135], v5 offset:1024
    buffer_load_dwordx4 v[176:179], v14, s[36:39], s88 offen offset:0 sc1
    ds_read_b64_tr_b16 v[136:137], v4 offset:2048
    buffer_load_dwordx4 v[180:183], v14, s[36:39], s88 offen offset:1024 sc1
    ds_read_b64_tr_b16 v[138:139], v4 offset:3072
    buffer_load_dwordx4 v[184:187], v14, s[36:39], s88 offen offset:2048 sc1
    ds_read_b64_tr_b16 v[140:141], v5 offset:2048
    buffer_load_dwordx4 v[188:191], v14, s[36:39], s88 offen offset:3072 sc1
    s_add_u32 s82, s82, 4096
    s_and_b32 s82, s82, 0xffff
    s_add_u32 s88, s82, s83
    s_nop 0
    ds_read_b64_tr_b16 v[142:143], v5 offset:3072
    buffer_load_dwordx4 v[192:195], v14, s[36:39], s88 offen offset:0 sc1
    buffer_load_dwordx4 v[196:199], v14, s[36:39], s88 offen offset:1024 sc1
    buffer_load_dwordx4 v[200:203], v14, s[36:39], s88 offen offset:2048 sc1
    buffer_load_dwordx4 v[204:207], v14, s[36:39], s88 offen offset:3072 sc1
    s_add_u32 s82, s82, 4096
    s_and_b32 s82, s82, 0xffff
    s_add_u32 s88, s82, s83
    buffer_load_dwordx4 v[208:211], v14, s[36:39], s88 offen offset:0 sc1
    buffer_load_dwordx4 v[212:215], v14, s[36:39], s88 offen offset:1024 sc1
    .p2align 3
L_G2:
    s_add_u32 s84, s84, 1
    s_waitcnt vmcnt(12) lgkmcnt(6)
    v_mfma_f32_32x32x16_bf16 v[224:239], v[128:131], v[160:163], v[224:239]
    ds_read_b64_tr_b16 v[144:145], v4 offset:4096
    ds_read_b64_tr_b16 v[146:147], v4 offset:5120
    buffer_load_dwordx4 v[216:219], v14, s[36:39], s88 offen offset:2048 sc1
    s_waitcnt lgkmcnt(6)
    v_mfma_f32_32x32x16_bf16 v[240:255], v[132:135], v[160:163], v[240:255]
    ds_read_b64_tr_b16 v[148:149], v5 offset:4096
    ds_read_b64_tr_b16 v[150:151], v5 offset:5120
    s_waitcnt lgkmcnt(6)
    v_mfma_f32_32x32x16_bf16 v[224:239], v[136:139], v[164:167], v[224:239]
    ds_read_b64_tr_b16 v[152:153], v4 offset:6144
    ds_read_b64_tr_b16 v[154:155], v4 offset:7168
    buffer_load_dwordx4 v[220:223], v14, s[36:39], s88 offen offset:3072 sc1
    s_add_u32 s82, s82, 4096
    s_and_b32 s82, s82, 0xffff
    s_add_u32 s88, s82, s83
    s_waitcnt lgkmcnt(6)
    v_mfma_f32_32x32x16_bf16 v[240:255], v[140:143], v[164:167], v[240:255]
    ds_read_b64_tr_b16 v[156:157], v5 offset:6144
    ds_read_b64_tr_b16 v[158:159], v5 offset:7168
    v_add_u32 v4, 0x2000, v4
    v_and_b32 v4, 0x1ffff, v4
    v_xor_b32 v5, 64, v4
    s_waitcnt vmcnt(12) lgkmcnt(6)
    v_mfma_f32_32x32x16_bf16 v[224:239], v[144:147], v[168:171], v[224:239]
    ds_read_b64_tr_b16 v[128:129], v4 offset:0
    ds_read_b64_tr_b16 v[130:131], v4 offset:1024
    buffer_load_dwordx4 v[160:163], v14, s[36:39], s88 offen offset:0 sc1
    s_waitcnt lgkmcnt(6)
    v_mfma_f32_32x32x16_bf16 v[240:255], v[148:151], v[168:171], v[240:255]
    ds_read_b64_tr_b16 v[132:133], v5 offset:0
    ds_read_b64_tr_b16 v[134:135], v5 offset:1024
    s_waitcnt lgkmcnt(6)
    v_mfma_f32_32x32x16_bf16 v[224:239], v[152:155], v[172:175], v[224:239]
    ds_read_b64_tr_b16 v[136:137], v4 offset:2048
    ds_read_b64_tr_b16 v[138:139], v4 offset:3072
    buffer_load_dwordx4 v[164:167], v14, s[36:39], s88 offen offset:1024 sc1
    s_waitcnt lgkmcnt(6)
    v_mfma_f32_32x32x16_bf16 v[240:255], v[156:159], v[172:175], v[240:255]
    ds_read_b64_tr_b16 v[140:141], v5 offset:2048
    ds_read_b64_tr_b16 v[142:143], v5 offset:3072
    s_waitcnt vmcnt(12) lgkmcnt(6)
    v_mfma_f32_32x32x16_bf16 v[224:239], v[128:131], v[176:179], v[224:239]
    ds_read_b64_tr_b16 v[144:145], v4 offset:4096
    ds_read_b64_tr_b16 v[146:147], v4 offset:5120
    buffer_load_dwordx4 v[168:171], v14, s[36:39], s88 offen offset:2048 sc1
    s_waitcnt lgkmcnt(6)
    v_mfma_f32_32x32x16_bf16 v[240:255], v[132:135], v[176:179], v[240:255]
    ds_read_b64_tr_b16 v[148:149], v5 offset:4096
    ds_read_b64_tr_b16 v[150:151], v5 offset:5120
    s_waitcnt lgkmcnt(6)
    v_mfma_f32_32x32x16_bf16 v[224:239], v[136:139], v[180:183], v[224:239]
    ds_read_b64_tr_b16 v[152:153], v4 offset:6144
    ds_read_b64_tr_b16 v[154:155], v4 offset:7168
    buffer_load_dwordx4 v[172:175], v14, s[36:39], s88 offen offset:3072 sc1
    s_add_u32 s82, s82, 4096
    s_and_b32 s82, s82, 0xffff
    s_add_u32 s88, s82, s83
    s_waitcnt lgkmcnt(6)
    v_mfma_f32_32x32x16_bf16 v[240:255], v[140:143], v[180:183], v[240:255]
    ds_read_b64_tr_b16 v[156:157], v5 offset:6144
    ds_read_b64_tr_b16 v[158:159], v5 offset:7168
    v_add_u32 v4, 0x2000, v4
    v_and_b32 v4, 0x1ffff, v4
    v_xor_b32 v5, 64, v4
    s_waitcnt vmcnt(12) lgkmcnt(6)
    v_mfma_f32_32x32x16_bf16 v[224:239], v[144:147], v[184:187], v[224:239]
    ds_read_b64_tr_b16 v[128:129], v4 offset:0
    ds_read_b64_tr_b16 v[130:131], v4 offset:1024
    buffer_load_dwordx4 v[176:179], v14, s[36:39], s88 offen offset:0 sc1
    s_waitcnt lgkmcnt(6)
    v_mfma_f32_32x32x16_bf16 v[240:255], v[148:151], v[184:187], v[240:255]
    ds_read_b64_tr_b16 v[132:133], v5 offset:0
    ds_read_b64_tr_b16 v[134:135], v5 offset:1024
    s_waitcnt lgkmcnt(6)
    v_mfma_f32_32x32x16_bf16 v[224:239], v[152:155], v[188:191], v[224:239]
    ds_read_b64_tr_b16 v[136:137], v4 offset:2048
    ds_read_b64_tr_b16 v[138:139], v4 offset:3072
    buffer_load_dwordx4 v[180:183], v14, s[36:39], s88 offen offset:1024 sc1
    s_waitcnt lgkmcnt(6)
    v_mfma_f32_32x32x16_bf16 v[240:255], v[156:159], v[188:191], v[240:255]
    ds_read_b64_tr_b16 v[140:141], v5 offset:2048
    ds_read_b64_tr_b16 v[142:143], v5 offset:3072
    s_waitcnt vmcnt(12) lgkmcnt(6)
    v_mfma_f32_32x32x16_bf16 v[224:239], v[128:131], v[192:195], v[224:239]
    ds_read_b64_tr_b16 v[144:145], v4 offset:4096
    ds_read_b64_tr_b16 v[146:147], v4 offset:5120
    buffer_load_dwordx4 v[184:187], v14, s[36:39], s88 offen offset:2048 sc1
    s_waitcnt lgkmcnt(6)
    v_mfma_f32_32x32x16_bf16 v[240:255], v[132:135], v[192:195], v[240:255]
    ds_read_b64_tr_b16 v[148:149], v5 offset:4096
    ds_read_b64_tr_b16 v[150:151], v5 offset:5120
    s_waitcnt lgkmcnt(6)
    v_mfma_f32_32x32x16_bf16 v[224:239], v[136:139], v[196:199], v[224:239]
    ds_read_b64_tr_b16 v[152:153], v4 offset:6144
    ds_read_b64_tr_b16 v[154:155], v4 offset:7168
    buffer_load_dwordx4 v[188:191], v14, s[36:39], s88 offen offset:3072 sc1
    s_add_u32 s82, s82, 4096
    s_and_b32 s82, s82, 0xffff
    s_add_u32 s88, s82, s83
    s_waitcnt lgkmcnt(6)
    v_mfma_f32_32x32x16_bf16 v[240:255], v[140:143], v[196:199], v[240:255]
    ds_read_b64_tr_b16 v[156:157], v5 offset:6144
    ds_read_b64_tr_b16 v[158:159], v5 offset:7168
    v_add_u32 v4, 0x2000, v4
    v_and_b32 v4, 0x1ffff, v4
    v_xor_b32 v5, 64, v4
    s_waitcnt vmcnt(12) lgkmcnt(6)
    v_mfma_f32_32x32x16_bf16 v[224:239], v[144:147], v[200:203], v[224:239]
    ds_read_b64_tr_b16 v[128:129], v4 offset:0
    ds_read_b64_tr_b16 v[130:131], v4 offset:1024
    buffer_load_dwordx4 v[192:195], v14, s[36:39], s88 offen offset:0 sc1
    s_waitcnt lgkmcnt(6)
    v_mfma_f32_32x32x16_bf16 v[240:255], v[148:151], v[200:203], v[240:255]
    ds_read_b64_tr_b16 v[132:133], v5 offset:0
    ds_read_b64_tr_b16 v[134:135], v5 offset:1024
    s_waitcnt lgkmcnt(6)
    v_mfma_f32_32x32x16_bf16 v[224:239], v[152:155], v[204:207], v[224:239]
    ds_read_b64_tr_b16 v[136:137], v4 offset:2048
    ds_read_b64_tr_b16 v[138:139], v4 offset:3072
    buffer_load_dwordx4 v[196:199], v14, s[36:39], s88 offen offset:1024 sc1
    s_waitcnt lgkmcnt(6)
    v_mfma_f32_32x32x16_bf16 v[240:255], v[156:159], v[204:207], v[240:255]
    ds_read_b64_tr_b16 v[140:141], v5 offset:2048
    ds_read_b64_tr_b16 v[142:143], v5 offset:3072
    s_waitcnt vmcnt(12) lgkmcnt(6)
    v_mfma_f32_32x32x16_bf16 v[224:239], v[128:131], v[208:211], v[224:239]
    ds_read_b64_tr_b16 v[144:145], v4 offset:4096
    ds_read_b64_tr_b16 v[146:147], v4 offset:5120
    buffer_load_dwordx4 v[200:203], v14, s[36:39], s88 offen offset:2048 sc1
    s_waitcnt lgkmcnt(6)
    v_mfma_f32_32x32x16_bf16 v[240:255], v[132:135], v[208:211], v[240:255]
    ds_read_b64_tr_b16 v[148:149], v5 offset:4096
    ds_read_b64_tr_b16 v[150:151], v5 offset:5120
    s_waitcnt lgkmcnt(6)
    v_mfma_f32_32x32x16_bf16 v[224:239], v[136:139], v[212:215], v[224:239]
    ds_read_b64_tr_b16 v[152:153], v4 offset:6144
    ds_read_b64_tr_b16 v[154:155], v4 offset:7168
    buffer_load_dwordx4 v[204:207], v14, s[36:39], s88 offen offset:3072 sc1
    s_add_u32 s82, s82, 4096
    s_and_b32 s82, s82, 0xffff
    s_add_u32 s88, s82, s83
    s_waitcnt lgkmcnt(6)
    v_mfma_f32_32x32x16_bf16 v[240:255], v[140:143], v[212:215], v[240:255]
    ds_read_b64_tr_b16 v[156:157], v5 offset:6144
    ds_read_b64_tr_b16 v[158:159], v5 offset:7168
    v_add_u32 v4, 0x2000, v4
    v_and_b32 v4, 0x1ffff, v4
    v_xor_b32 v5, 64, v4
    s_waitcnt vmcnt(12) lgkmcnt(6)
    v_mfma_f32_32x32x16_bf16 v[224:239], v[144:147], v[216:219], v[224:239]
    ds_read_b64_tr_b16 v[128:129], v4 offset:0
    ds_read_b64_tr_b16 v[130:131], v4 offset:1024
    buffer_load_dwordx4 v[208:211], v14, s[36:39], s88 offen offset:0 sc1
    s_waitcnt lgkmcnt(6)
    v_mfma_f32_32x32x16_bf16 v[240:255], v[148:151], v[216:219], v[240:255]
    ds_read_b64_tr_b16 v[132:133], v5 offset:0
    ds_read_b64_tr_b16 v[134:135], v5 offset:1024
    s_waitcnt lgkmcnt(6)
    v_mfma_f32_32x32x16_bf16 v[224:239], v[152:155], v[220:223], v[224:239]
    ds_read_b64_tr_b16 v[136:137], v4 offset:2048
    ds_read_b64_tr_b16 v[138:139], v4 offset:3072
    buffer_load_dwordx4 v[212:215], v14, s[36:39], s88 offen offset:1024 sc1
    s_waitcnt lgkmcnt(6)
    v_mfma_f32_32x32x16_bf16 v[240:255], v[156:159], v[220:223], v[240:255]
    ds_read_b64_tr_b16 v[140:141], v5 offset:2048
    ds_read_b64_tr_b16 v[142:143], v5 offset:3072
    s_cmp_lt_u32 s84, 3
    s_cbranch_scc1 L_G2
    s_waitcnt vmcnt(12) lgkmcnt(6)
    v_mfma_f32_32x32x16_bf16 v[224:239], v[128:131], v[160:163], v[224:239]
    ds_read_b64_tr_b16 v[144:145], v4 offset:4096
    ds_read_b64_tr_b16 v[146:147], v4 offset:5120
    buffer_load_dwordx4 v[216:219], v14, s[36:39], s88 offen offset:2048 sc1
    s_waitcnt lgkmcnt(6)
    v_mfma_f32_32x32x16_bf16 v[240:255], v[132:135], v[160:163], v[240:255]
    ds_read_b64_tr_b16 v[148:149], v5 offset:4096
    ds_read_b64_tr_b16 v[150:151], v5 offset:5120
    s_waitcnt lgkmcnt(6)
    v_mfma_f32_32x32x16_bf16 v[224:239], v[136:139], v[164:167], v[224:239]
    ds_read_b64_tr_b16 v[152:153], v4 offset:6144
    ds_read_b64_tr_b16 v[154:155], v4 offset:7168
    buffer_load_dwordx4 v[220:223], v14, s[36:39], s88 offen offset:3072 sc1
    s_add_u32 s82, s82, 4096
    s_and_b32 s82, s82, 0xffff
    s_add_u32 s88, s82, s83
    s_waitcnt lgkmcnt(6)
    v_mfma_f32_32x32x16_bf16 v[240:255], v[140:143], v[164:167], v[240:255]
    ds_read_b64_tr_b16 v[156:157], v5 offset:6144
    ds_read_b64_tr_b16 v[158:159], v5 offset:7168
    s_barrier
    v_add_u32 v4, 0x2000, v4
    v_and_b32 v4, 0x1ffff, v4
    v_xor_b32_e64 v5, 64, v4
    s_waitcnt vmcnt(12) lgkmcnt(6)
    v_mfma_f32_32x32x16_bf16 v[224:239], v[144:147], v[168:171], v[224:239]
    ds_read_b64_tr_b16 v[128:129], v4 offset:0
    ds_read_b64_tr_b16 v[130:131], v4 offset:1024
    s_waitcnt lgkmcnt(6)
    v_mfma_f32_32x32x16_bf16 v[240:255], v[148:151], v[168:171], v[240:255]
    ds_read_b64_tr_b16 v[132:133], v5 offset:0
    ds_read_b64_tr_b16 v[134:135], v5 offset:1024
    s_waitcnt lgkmcnt(6)
    v_mfma_f32_32x32x16_bf16 v[224:239], v[152:155], v[172:175], v[224:239]
    ds_read_b64_tr_b16 v[136:137], v4 offset:2048
    ds_read_b64_tr_b16 v[138:139], v4 offset:3072
    s_waitcnt lgkmcnt(6)
    v_mfma_f32_32x32x16_bf16 v[240:255], v[156:159], v[172:175], v[240:255]
    ds_read_b64_tr_b16 v[140:141], v5 offset:2048
    ds_read_b64_tr_b16 v[142:143], v5 offset:3072
    s_waitcnt vmcnt(10) lgkmcnt(6)
    v_mfma_f32_32x32x16_bf16 v[224:239], v[128:131], v[176:179], v[224:239]
    ds_read_b64_tr_b16 v[144:145], v4 offset:4096
    ds_read_b64_tr_b16 v[146:147], v4 offset:5120
    s_waitcnt lgkmcnt(6)
    v_mfma_f32_32x32x16_bf16 v[240:255], v[132:135], v[176:179], v[240:255]
    ds_read_b64_tr_b16 v[148:149], v5 offset:4096
    ds_read_b64_tr_b16 v[150:151], v5 offset:5120
    s_waitcnt lgkmcnt(6)
    v_mfma_f32_32x32x16_bf16 v[224:239], v[136:139], v[180:183], v[224:239]
    ds_read_b64_tr_b16 v[152:153], v4 offset:6144
    ds_read_b64_tr_b16 v[154:155], v4 offset:7168
    s_waitcnt lgkmcnt(6)
    v_mfma_f32_32x32x16_bf16 v[240:255], v[140:143], v[180:183], v[240:255]
    ds_read_b64_tr_b16 v[156:157], v5 offset:6144
    ds_read_b64_tr_b16 v[158:159], v5 offset:7168
    v_add_u32 v4, 0x2000, v4
    v_and_b32 v4, 0x1ffff, v4
    v_xor_b32_e64 v5, 64, v4
    s_waitcnt vmcnt(8) lgkmcnt(6)
    v_mfma_f32_32x32x16_bf16 v[224:239], v[144:147], v[184:187], v[224:239]
    ds_read_b64_tr_b16 v[128:129], v4 offset:0
    ds_read_b64_tr_b16 v[130:131], v4 offset:1024
    s_waitcnt lgkmcnt(6)
    v_mfma_f32_32x32x16_bf16 v[240:255], v[148:151], v[184:187], v[240:255]
    ds_read_b64_tr_b16 v[132:133], v5 offset:0
    ds_read_b64_tr_b16 v[134:135], v5 offset:1024
    s_waitcnt lgkmcnt(6)
    v_mfma_f32_32x32x16_bf16 v[224:239], v[152:155], v[188:191], v[224:239]
    ds_read_b64_tr_b16 v[136:137], v4 offset:2048
    ds_read_b64_tr_b16 v[138:139], v4 offset:3072
    s_waitcnt lgkmcnt(6)
    v_mfma_f32_32x32x16_bf16 v[240:255], v[156:159], v[188:191], v[240:255]
    ds_read_b64_tr_b16 v[140:141], v5 offset:2048
    ds_read_b64_tr_b16 v[142:143], v5 offset:3072
    s_waitcnt vmcnt(6) lgkmcnt(6)
    v_mfma_f32_32x32x16_bf16 v[224:239], v[128:131], v[192:195], v[224:239]
    ds_read_b64_tr_b16 v[144:145], v4 offset:4096
    ds_read_b64_tr_b16 v[146:147], v4 offset:5120
    s_waitcnt lgkmcnt(6)
    v_mfma_f32_32x32x16_bf16 v[240:255], v[132:135], v[192:195], v[240:255]
    ds_read_b64_tr_b16 v[148:149], v5 offset:4096
    ds_read_b64_tr_b16 v[150:151], v5 offset:5120
    s_waitcnt lgkmcnt(6)
    v_mfma_f32_32x32x16_bf16 v[224:239], v[136:139], v[196:199], v[224:239]
    ds_read_b64_tr_b16 v[152:153], v4 offset:6144
    ds_read_b64_tr_b16 v[154:155], v4 offset:7168
    s_waitcnt lgkmcnt(6)
    v_mfma_f32_32x32x16_bf16 v[240:255], v[140:143], v[196:199], v[240:255]
    ds_read_b64_tr_b16 v[156:157], v5 offset:6144
    ds_read_b64_tr_b16 v[158:159], v5 offset:7168
    v_add_u32 v4, 0x2000, v4
    v_and_b32 v4, 0x1ffff, v4
    v_xor_b32_e64 v5, 64, v4
    s_waitcnt vmcnt(4) lgkmcnt(6)
    v_mfma_f32_32x32x16_bf16 v[224:239], v[144:147], v[200:203], v[224:239]
    ds_read_b64_tr_b16 v[128:129], v4 offset:0
    ds_read_b64_tr_b16 v[130:131], v4 offset:1024
    s_waitcnt lgkmcnt(6)
    v_mfma_f32_32x32x16_bf16 v[240:255], v[148:151], v[200:203], v[240:255]
    ds_read_b64_tr_b16 v[132:133], v5 offset:0
    ds_read_b64_tr_b16 v[134:135], v5 offset:1024
    s_waitcnt lgkmcnt(6)
    v_mfma_f32_32x32x16_bf16 v[224:239], v[152:155], v[204:207], v[224:239]
    ds_read_b64_tr_b16 v[136:137], v4 offset:2048
    ds_read_b64_tr_b16 v[138:139], v4 offset:3072
    s_waitcnt lgkmcnt(6)
    v_mfma_f32_32x32x16_bf16 v[240:255], v[156:159], v[204:207], v[240:255]
    ds_read_b64_tr_b16 v[140:141], v5 offset:2048
    ds_read_b64_tr_b16 v[142:143], v5 offset:3072
    s_waitcnt vmcnt(2) lgkmcnt(6)
    v_mfma_f32_32x32x16_bf16 v[224:239], v[128:131], v[208:211], v[224:239]
    ds_read_b64_tr_b16 v[144:145], v4 offset:4096
    ds_read_b64_tr_b16 v[146:147], v4 offset:5120
    s_waitcnt lgkmcnt(6)
    v_mfma_f32_32x32x16_bf16 v[240:255], v[132:135], v[208:211], v[240:255]
    ds_read_b64_tr_b16 v[148:149], v5 offset:4096
    ds_read_b64_tr_b16 v[150:151], v5 offset:5120
    s_waitcnt lgkmcnt(6)
    v_mfma_f32_32x32x16_bf16 v[224:239], v[136:139], v[212:215], v[224:239]
    ds_read_b64_tr_b16 v[152:153], v4 offset:6144
    ds_read_b64_tr_b16 v[154:155], v4 offset:7168
    s_waitcnt lgkmcnt(6)
    v_mfma_f32_32x32x16_bf16 v[240:255], v[140:143], v[212:215], v[240:255]
    ds_read_b64_tr_b16 v[156:157], v5 offset:6144
    ds_read_b64_tr_b16 v[158:159], v5 offset:7168
    s_waitcnt vmcnt(0) lgkmcnt(6)
    v_mfma_f32_32x32x16_bf16 v[224:239], v[144:147], v[216:219], v[224:239]
    s_waitcnt lgkmcnt(4)
    v_mfma_f32_32x32x16_bf16 v[240:255], v[148:151], v[216:219], v[240:255]
    s_waitcnt lgkmcnt(2)
    v_mfma_f32_32x32x16_bf16 v[224:239], v[152:155], v[220:223], v[224:239]
    s_waitcnt lgkmcnt(0)
    v_mfma_f32_32x32x16_bf16 v[240:255], v[156:159], v[220:223], v[240:255]
    s_nop 9
    v_pk_mul_f32 v[18:19], v[224:225], v[224:225]
    v_pk_mul_f32 v[20:21], v[224:225], v[60:61]
    v_pk_add_f32 v[16:17], v[224:225], v[226:227]
    v_pk_fma_f32 v[18:19], v[226:227], v[226:227], v[18:19]
    v_pk_fma_f32 v[20:21], v[226:227], v[62:63], v[20:21]
    v_pk_add_f32 v[16:17], v[16:17], v[228:229]
    v_pk_fma_f32 v[18:19], v[228:229], v[228:229], v[18:19]
    v_pk_fma_f32 v[20:21], v[228:229], v[64:65], v[20:21]
    v_pk_add_f32 v[16:17], v[16:17], v[230:231]
    v_pk_fma_f32 v[18:19], v[230:231], v[230:231], v[18:19]
    v_pk_fma_f32 v[20:21], v[230:231], v[66:67], v[20:21]
    v_pk_add_f32 v[16:17], v[16:17], v[232:233]
    v_pk_fma_f32 v[18:19], v[232:233], v[232:233], v[18:19]
    v_pk_fma_f32 v[20:21], v[232:233], v[68:69], v[20:21]
    v_pk_add_f32 v[16:17], v[16:17], v[234:235]
    v_pk_fma_f32 v[18:19], v[234:235], v[234:235], v[18:19]
    v_pk_fma_f32 v[20:21], v[234:235], v[70:71], v[20:21]
    v_pk_add_f32 v[16:17], v[16:17], v[236:237]
    v_pk_fma_f32 v[18:19], v[236:237], v[236:237], v[18:19]
    v_pk_fma_f32 v[20:21], v[236:237], v[72:73], v[20:21]
    v_pk_add_f32 v[16:17], v[16:17], v[238:239]
    v_pk_fma_f32 v[18:19], v[238:239], v[238:239], v[18:19]
    v_pk_fma_f32 v[20:21], v[238:239], v[74:75], v[20:21]
    v_pk_add_f32 v[16:17], v[16:17], v[240:241]
    v_pk_fma_f32 v[18:19], v[240:241], v[240:241], v[18:19]
    v_pk_fma_f32 v[20:21], v[240:241], v[76:77], v[20:21]
    v_pk_add_f32 v[16:17], v[16:17], v[242:243]
    v_pk_fma_f32 v[18:19], v[242:243], v[242:243], v[18:19]
    v_pk_fma_f32 v[20:21], v[242:243], v[78:79], v[20:21]
    v_pk_add_f32 v[16:17], v[16:17], v[244:245]
    v_pk_fma_f32 v[18:19], v[244:245], v[244:245], v[18:19]
    v_pk_fma_f32 v[20:21], v[244:245], v[80:81], v[20:21]
    v_pk_add_f32 v[16:17], v[16:17], v[246:247]
    v_pk_fma_f32 v[18:19], v[246:247], v[246:247], v[18:19]
    v_pk_fma_f32 v[20:21], v[246:247], v[82:83], v[20:21]
    v_pk_add_f32 v[16:17], v[16:17], v[248:249]
    v_pk_fma_f32 v[18:19], v[248:249], v[248:249], v[18:19]
    v_pk_fma_f32 v[20:21], v[248:249], v[84:85], v[20:21]
    v_pk_add_f32 v[16:17], v[16:17], v[250:251]
    v_pk_fma_f32 v[18:19], v[250:251], v[250:251], v[18:19]
    v_pk_fma_f32 v[20:21], v[250:251], v[86:87], v[20:21]
    v_pk_add_f32 v[16:17], v[16:17], v[252:253]
    v_pk_fma_f32 v[18:19], v[252:253], v[252:253], v[18:19]
    v_pk_fma_f32 v[20:21], v[252:253], v[88:89], v[20:21]
    v_pk_add_f32 v[16:17], v[16:17], v[254:255]
    v_pk_fma_f32 v[18:19], v[254:255], v[254:255], v[18:19]
    v_pk_fma_f32 v[20:21], v[254:255], v[90:91], v[20:21]
    v_mov_b32 v27, s75
    v_add_f32 v24, v16, v17
    v_add_f32 v25, v18, v19
    v_add_f32 v26, v20, v21
    v_mov_b32 v28, v24
    v_mov_b32 v29, v25
    v_mov_b32 v30, v26
    v_permlane32_swap_b32 v24, v28
    v_permlane32_swap_b32 v25, v29
    v_permlane32_swap_b32 v26, v30
    v_pk_add_f32 v[24:25], v[24:25], v[28:29]
    v_add_f32 v26, v26, v30
    s_mov_b32 exec_hi, 0
    s_bitcmp1_b32 s99, 1
    s_cbranch_scc1 Lls_42
    buffer_store_dwordx4 v[24:27], v14, s[36:39], s95 offen sc1
    s_branch Lle_43
Lls_42:
    buffer_store_dwordx4 v[24:27], v14, s[36:39], s95 offen
Lle_43:
    s_mov_b32 exec_hi, -1
    s_add_u32 s79, s94, 4096
    s_add_u32 s80, s94, 8192
    s_add_u32 s81, s94, 12288
    s_barrier
    s_nop 0
    buffer_load_dwordx4 v[64:67], v12, s[36:39], s94 offen offset:0 sc1
    buffer_load_dwordx4 v[68:71], v12, s[36:39], s94 offen offset:2048 sc1
    buffer_load_dwordx4 v[72:75], v12, s[36:39], s79 offen offset:0 sc1
    buffer_load_dwordx4 v[76:79], v12, s[36:39], s79 offen offset:2048 sc1
    buffer_load_dwordx4 v[80:83], v12, s[36:39], s80 offen offset:0 sc1
    buffer_load_dwordx4 v[84:87], v12, s[36:39], s80 offen offset:2048 sc1
    buffer_load_dwordx4 v[88:91], v12, s[36:39], s81 offen offset:0 sc1
    buffer_load_dwordx4 v[92:95], v12, s[36:39], s81 offen offset:2048 sc1
    v_xor_b32_e64 v112, 0, v13
    ds_write_b128 v112, v[224:227]
    v_xor_b32_e64 v113, 32, v13
    ds_write_b128 v113, v[228:231]
    v_xor_b32_e64 v114, 64, v13
    ds_write_b128 v114, v[232:235]
    v_xor_b32 v115, 96, v13
    ds_write_b128 v115, v[236:239]
    v_xor_b32 v116, 128, v13
    ds_write_b128 v116, v[240:243]
    v_xor_b32 v117, 160, v13
    ds_write_b128 v117, v[244:247]
    v_xor_b32 v118, 192, v13
    ds_write_b128 v118, v[248:251]
    v_xor_b32 v119, 224, v13
    ds_write_b128 v119, v[252:255]
    s_mov_b32 s85, 1
    s_branch L_gchk
Lspin_44:
    s_add_u32 s85, s85, 1
    s_cmp_gt_u32 s85, 400000
    s_cbranch_scc1 L_end
    buffer_load_dwordx4 v[64:67], v12, s[36:39], s94 offen offset:0 sc1
    buffer_load_dwordx4 v[68:71], v12, s[36:39], s94 offen offset:2048 sc1
    buffer_load_dwordx4 v[72:75], v12, s[36:39], s79 offen offset:0 sc1
    buffer_load_dwordx4 v[76:79], v12, s[36:39], s79 offen offset:2048 sc1
    buffer_load_dwordx4 v[80:83], v12, s[36:39], s80 offen offset:0 sc1
    buffer_load_dwordx4 v[84:87], v12, s[36:39], s80 offen offset:2048 sc1
    buffer_load_dwordx4 v[88:91], v12, s[36:39], s81 offen offset:0 sc1
    buffer_load_dwordx4 v[92:95], v12, s[36:39], s81 offen offset:2048 sc1
L_gchk:
    s_waitcnt vmcnt(0)
    s_nop 0
    v_max3_u32 v16, v67, v71, v75
    v_max3_u32 v16, v16, v79, v83
    v_max3_u32 v16, v16, v87, v91
    v_max3_u32 v16, v16, v95, s75
    v_min3_u32 v17, v67, v71, v75
    v_min3_u32 v17, v17, v79, v83
    v_min3_u32 v17, v17, v87, v91
    v_min3_u32 v17, v17, v95, s75
    v_cmp_ne_u32 vcc, v16, v17
    s_cbranch_vccnz Lspin_44
    v_pk_add_f32 v[64:65], v[64:65], v[68:69]
    v_add_f32_e64 v66, v66, v70
    v_pk_add_f32 v[72:73], v[72:73], v[76:77]
    v_add_f32_e64 v74, v74, v78
    v_pk_add_f32 v[80:81], v[80:81], v[84:85]
    v_add_f32_e64 v82, v82, v86
    v_pk_add_f32 v[88:89], v[88:89], v[92:93]
    v_add_f32_e64 v90, v90, v94
    v_pk_add_f32 v[64:65], v[64:65], v[72:73]
    v_add_f32_e64 v66, v66, v74
    v_pk_add_f32 v[80:81], v[80:81], v[88:89]
    v_add_f32 v82, v82, v90
    v_add_f32 v24, v64, v80
    v_add_f32 v25, v65, v81
    v_add_f32 v26, v66, v82
    v_mov_b32 v28, v24
    v_mov_b32 v29, v25
    v_mov_b32 v30, v26
    v_permlane32_swap_b32 v24, v28
    v_permlane32_swap_b32 v25, v29
    v_permlane32_swap_b32 v26, v30
    v_pk_add_f32 v[24:25], v[24:25], v[28:29]
    v_add_f32_e64 v26, v26, v30
    v_mul_f32 v36, 0x3a800000, v24
    v_mul_f32 v40, 0x3a800000, v25
    v_fma_f32 v40, -v36, v36, v40
    v_max_f32_e64 v40, 0, v40
    v_cvt_pk_bf16_f32 v36, v36, v36
    v_and_b32 v36, 0xffff0000, v36
    v_cvt_pk_bf16_f32 v40, v40, v40
    v_and_b32 v40, 0xffff0000, v40
    v_add_f32 v40, 0x3727c5ac, v40
    v_cvt_pk_bf16_f32 v40, v40, v40
    v_and_b32 v40, 0xffff0000, v40
    v_sqrt_f32 v40, v40
    s_nop 0
    v_cvt_pk_bf16_f32 v40, v40, v40
    v_and_b32 v40, 0xffff0000, v40
    v_rcp_f32_e64 v38, v40
    v_fma_f32 v42, -v36, v126, v26
    s_mov_b32 s79, 0xfffff800
    v_mul_f32_e64 v42, v42, v38
    v_mul_f32 v39, -v36, v38
    v_and_or_b32 v42, v42, s79, v11
    ds_write_b64 v10, v[38:39]
    s_nop 0
    v_max_f32_dpp v42, v42, v42 row_ror:8 row_mask:0xf bank_mask:0xf
    s_nop 1
    v_max_f32_dpp v42, v42, v42 row_ror:4 row_mask:0xf bank_mask:0xf
    s_nop 1
    v_max_f32_dpp v42, v42, v42 row_ror:2 row_mask:0xf bank_mask:0xf
    s_nop 1
    v_max_f32_dpp v42, v42, v42 row_ror:1 row_mask:0xf bank_mask:0xf
    s_lshl_b32 s78, s76, 3
    s_add_u32 s78, s78, 163328
    v_bfe_u32 v16, v2, 4, 1
    v_lshl_add_u32 v16, v16, 2, s78
    ds_write_b32 v16, v42
    v_mov_b32 v16, 163328
    s_waitcnt lgkmcnt(0)
    s_barrier
    ds_read_b128 v[20:23], v16
    ds_read_b128 v[24:27], v16 offset:16
    s_lshl_b32 s79, s71, 4
    s_add_u32 s79, s79, s72
    s_lshl_b32 s79, s79, 9
    s_add_u32 s79, s79, 524288
    v_lshlrev_b32 v17, 3, v2
    v_lshlrev_b32_e64 v18, 2, v2
    s_waitcnt lgkmcnt(0)
    v_max3_f32 v20, v20, v21, v22
    v_max3_f32 v24, v24, v25, v26
    v_max_f32_e64 v23, v23, v27
    v_max3_f32 v20, v20, v24, v23
    v_mov_b32 v21, s75
    s_cmp_lg_u32 s76, 0
    s_cbranch_scc1 L_nocand
    s_mov_b32 exec_hi, 0
    v_and_b32 v22, 127, v20
    v_and_b32 v23, 7, v20
    v_lshlrev_b32 v23, 4, v23
    v_xor_b32_e64 v23, v23, v17
    v_lshl_add_u32 v23, v22, 8, v23
    v_lshlrev_b32_e64 v22, 3, v22
    ds_read_b64 v[24:25], v23
    v_add_u32 v22, 159744, v22
    ds_read_b64 v[26:27], v22
    s_mov_b32 exec_lo, 0xffff
    buffer_store_dwordx2 v[20:21], v17, s[36:39], s79 offen offset:128 sc1
    s_mov_b32 exec_lo, -1
    s_waitcnt lgkmcnt(0)
    v_fma_f32 v28, v24, v26, v27
    v_fma_f32 v29, v25, v26, v27
    v_cvt_pk_bf16_f32 v30, v28, v29
    buffer_store_dword v30, v18, s[36:39], s79 offen sc1
    v_add_f32 v28, v28, v24
    v_add_f32 v29, v29, v25
    buffer_store_dwordx2 v[28:29], v17, s[36:39], s79 offen offset:256 sc1
    s_mov_b32 exec_hi, -1
L_nocand:
    v_lshrrev_b32 v16, 3, v2
    v_and_b32 v17, 7, v2
    s_lshl_b32 s78, s76, 5
    v_add_u32 v18, s78, v16
    v_lshlrev_b32 v19, 1, v17
    v_xor_b32 v19, v19, v16
    v_lshlrev_b32 v19, 4, v19
    v_lshl_add_u32 v19, v18, 8, v19
    v_xor_b32 v32, 16, v19
    v_lshlrev_b32 v33, 3, v18
    v_add_u32 v33, 159744, v33
    ds_read_b128 v[64:67], v19 offset:0
    ds_read_b128 v[68:71], v32 offset:0
    ds_read_b64 v[96:97], v33 offset:0
    ds_read_b128 v[72:75], v19 offset:2048
    ds_read_b128 v[76:79], v32 offset:2048
    ds_read_b64 v[98:99], v33 offset:64
    ds_read_b128 v[80:83], v19 offset:4096
    ds_read_b128 v[84:87], v32 offset:4096
    ds_read_b64 v[100:101], v33 offset:128
    ds_read_b128 v[88:91], v19 offset:6144
    ds_read_b128 v[92:95], v32 offset:6144
    ds_read_b64 v[102:103], v33 offset:192
    s_lshl_b32 s78, s71, 7
    v_add_u32_e64 v18, s78, v18
    s_lshl_b32 s79, s72, 7
    v_lshl_add_u32 v19, v18, 11, s79
    v_lshl_add_u32 v19, v17, 4, v19
    v_mov_b32 v16, 163360
    s_waitcnt lgkmcnt(0)
    v_add_f32 v96, 1.0, v96
    v_pk_fma_f32 v[64:65], v[64:65], v[96:97], v[96:97] op_sel:[0,0,1] op_sel_hi:[1,0,1]
    v_pk_fma_f32 v[66:67], v[66:67], v[96:97], v[96:97] op_sel:[0,0,1] op_sel_hi:[1,0,1]
    v_pk_fma_f32 v[68:69], v[68:69], v[96:97], v[96:97] op_sel:[0,0,1] op_sel_hi:[1,0,1]
    v_pk_fma_f32 v[70:71], v[70:71], v[96:97], v[96:97] op_sel:[0,0,1] op_sel_hi:[1,0,1]
    v_cvt_pk_bf16_f32 v104, v64, v65
    v_cvt_pk_bf16_f32 v105, v66, v67
    v_cvt_pk_bf16_f32 v106, v68, v69
    v_cvt_pk_bf16_f32 v107, v70, v71
    v_add_f32_e64 v98, 1.0, v98
    v_pk_fma_f32 v[72:73], v[72:73], v[98:99], v[98:99] op_sel:[0,0,1] op_sel_hi:[1,0,1]
    v_pk_fma_f32 v[74:75], v[74:75], v[98:99], v[98:99] op_sel:[0,0,1] op_sel_hi:[1,0,1]
    v_pk_fma_f32 v[76:77], v[76:77], v[98:99], v[98:99] op_sel:[0,0,1] op_sel_hi:[1,0,1]
    v_pk_fma_f32 v[78:79], v[78:79], v[98:99], v[98:99] op_sel:[0,0,1] op_sel_hi:[1,0,1]
    v_cvt_pk_bf16_f32 v108, v72, v73
    v_cvt_pk_bf16_f32 v109, v74, v75
    v_cvt_pk_bf16_f32 v110, v76, v77
    v_cvt_pk_bf16_f32 v111, v78, v79
    v_add_f32_e64 v100, 1.0, v100
    v_pk_fma_f32 v[80:81], v[80:81], v[100:101], v[100:101] op_sel:[0,0,1] op_sel_hi:[1,0,1]
    v_pk_fma_f32 v[82:83], v[82:83], v[100:101], v[100:101] op_sel:[0,0,1] op_sel_hi:[1,0,1]
    v_pk_fma_f32 v[84:85], v[84:85], v[100:101], v[100:101] op_sel:[0,0,1] op_sel_hi:[1,0,1]
    v_pk_fma_f32 v[86:87], v[86:87], v[100:101], v[100:101] op_sel:[0,0,1] op_sel_hi:[1,0,1]
    v_cvt_pk_bf16_f32 v112, v80, v81
    v_cvt_pk_bf16_f32 v113, v82, v83
    v_cvt_pk_bf16_f32 v114, v84, v85
    v_cvt_pk_bf16_f32 v115, v86, v87
    v_add_f32_e64 v102, 1.0, v102
    v_pk_fma_f32 v[88:89], v[88:89], v[102:103], v[102:103] op_sel:[0,0,1] op_sel_hi:[1,0,1]
    v_pk_fma_f32 v[90:91], v[90:91], v[102:103], v[102:103] op_sel:[0,0,1] op_sel_hi:[1,0,1]
    v_pk_fma_f32 v[92:93], v[92:93], v[102:103], v[102:103] op_sel:[0,0,1] op_sel_hi:[1,0,1]
    v_pk_fma_f32 v[94:95], v[94:95], v[102:103], v[102:103] op_sel:[0,0,1] op_sel_hi:[1,0,1]
    v_cvt_pk_bf16_f32 v116, v88, v89
    v_cvt_pk_bf16_f32 v117, v90, v91
    v_cvt_pk_bf16_f32 v118, v92, v93
    v_cvt_pk_bf16_f32 v119, v94, v95
    s_barrier
    ds_read_b32 v17, v16
    s_waitcnt lgkmcnt(0)
    v_and_b32 v17, 0x7ff, v17
    v_sub_u32 v17, v17, v18
    s_barrier
    s_barrier
    s_mov_b32 s78, 0
    v_cmp_ne_u32_e64 vcc, 0, v17
    s_mov_b64 exec, vcc
    s_cbranch_execz Lo_45
    buffer_store_dwordx4 v[104:107], v19, s[44:47], s78 offen sc1
Lo_45:
    s_mov_b64 exec, -1
    s_mov_b32 s78, 16384
    v_cmp_ne_u32 vcc, 8, v17
    s_mov_b64 exec, vcc
    s_cbranch_execz Lo_46
    buffer_store_dwordx4 v[108:111], v19, s[44:47], s78 offen sc1
Lo_46:
    s_mov_b64 exec, -1
    s_mov_b32 s78, 32768
    v_cmp_ne_u32 vcc, 16, v17
    s_mov_b64 exec, vcc
    s_cbranch_execz Lo_47
    buffer_store_dwordx4 v[112:115], v19, s[44:47], s78 offen sc1
Lo_47:
    s_mov_b64 exec, -1
    s_mov_b32 s78, 49152
    v_cmp_ne_u32 vcc, 24, v17
    s_mov_b64 exec, vcc
    s_cbranch_execz Lo_48
    buffer_store_dwordx4 v[116:119], v19, s[44:47], s78 offen sc1
Lo_48:
    s_mov_b64 exec, -1
    s_branch L_fin
L_fin:
L_end:
    s_endpgm
.fill 64, 4, 0xbf800000
s_endpgm
.section .rodata,"a"
.p2align 6
.amdhsa_kernel sequential_preLN__linear_kernel_hedgehog__moe_arch_mod__prompt_kernel
  .amdhsa_next_free_vgpr 256
  .amdhsa_next_free_sgpr 102
  .amdhsa_accum_offset 256
  .amdhsa_group_segment_fixed_size 0
  .amdhsa_kernarg_size 96
  .amdhsa_user_sgpr_count 2
  .amdhsa_user_sgpr_kernarg_segment_ptr 1
  .amdhsa_system_sgpr_workgroup_id_x 1
  .amdhsa_float_denorm_mode_32 3
.end_amdhsa_kernel
```

```asm
; @launch grid=(256,1,1) block=(512,1,1) lds=163840
.amdgcn_target "amdgcn-amd-amdhsa--gfx950"
.text
.globl sequential_preLN__linear_kernel_hedgehog__moe_arch_mod__prompt_kernel
.p2align 8
.type sequential_preLN__linear_kernel_hedgehog__moe_arch_mod__prompt_kernel,@function
sequential_preLN__linear_kernel_hedgehog__moe_arch_mod__prompt_kernel:
    s_cmp_ge_u32 s2, 256
    s_cbranch_scc1 L_end
    s_load_dwordx16 s[4:19], s[0:1], 0
    s_load_dwordx8 s[20:27], s[0:1], 64
    v_lshrrev_b32 v1, 6, v0
    v_and_b32_e64 v2, 63, v0
    v_readfirstlane_b32 s68, v1
    s_lshr_b32 s69, s2, 4
    s_and_b32 s70, s2, 7
    s_lshl_b32 s70, s70, 1
    s_bfe_u32 s78, s2, 0x10003
    s_or_b32 s70, s70, s78
    s_and_b32 s76, s68, 3
    s_cmp_ge_u32 s68, 4
    s_cbranch_scc1 L_M
    v_lshrrev_b32 v196, 3, v2
    v_and_b32 v197, 7, v2
    v_lshrrev_b32_e64 v198, 4, v2
    s_and_b32 s80, s69, 0
    s_lshl_b32 s89, s76, 11
    s_lshl_b32 s66, s80, 10
    s_or_b32 s66, s66, s89
    s_xor_b32 s67, s66, 1024
    s_lshl_b32 s79, s70, 7
    s_movk_i32 s78, 6144
    v_mov_b32_e64 v199, s79
    v_mad_u32_u24 v199, v196, s78, v199
    s_lshl_b32 s80, s80, 2
    v_and_b32 v200, 2, v196
    v_xor_b32 v200, v200, v197
    v_xor_b32 v200, s80, v200
    v_lshl_add_u32 v199, v200, 4, v199
    s_mul_i32 s78, s66, 48
    s_mul_i32 s79, s67, 48
    v_add_u32 v6, s78, v199
    v_xor_b32 v199, 64, v199
    v_add_u32_e64 v7, s79, v199
    s_and_b32 s80, s70, 0
    s_lshl_b32 s88, s76, 12
    s_lshl_b32 s64, s80, 10
    s_or_b32 s64, s64, s88
    s_xor_b32 s65, s64, 1024
    s_lshl_b32 s80, s80, 2
    s_lshl_b32 s78, s69, 14
    s_add_u32 s78, s78, s64
    s_lshl_b32 s78, s78, 4
    v_lshl_add_u32 v199, v196, 11, s78
    v_xor_b32 v200, v198, v197
    v_xor_b32 v200, s80, v200
    v_lshl_add_u32 v4, v200, 4, v199
    v_xor_b32 v5, 16448, v4
    s_and_b32 s78, s70, 14
    s_and_b32 s79, s69, 14
    s_add_u32 s78, s78, s79
    s_sub_u32 s78, 32, s78
    s_and_b32 s78, s78, 15
    s_lshl_b32 s86, s78, 7
    s_mul_i32 s87, s78, 393216
    s_mov_b32 s30, 0x400000
    s_mov_b32 s31, 0x20000
    s_mov_b32 s34, 0x600000
    s_mov_b32 s35, 0x20000
    s_waitcnt lgkmcnt(0)
    s_mov_b32 s32, s6
    s_and_b32 s33, s7, 0xffff
    s_mov_b32 s28, s4
    s_and_b32 s29, s5, 0xffff
    s_add_u32 m0, s64, 118784
    s_nop 0
    buffer_load_dwordx4 v4, s[28:31], s86 offen offset:0  lds
    s_add_u32 m0, s66, 141312
    s_nop 0
    s_nop 0
    buffer_load_dwordx4 v6, s[32:35], s87 offen offset:2048  lds
    s_add_u32 m0, s64, 120832
    s_add_u32 s101, s86, 32768
    buffer_load_dwordx4 v4, s[28:31], s101 offen offset:0  lds
    s_add_u32 m0, s66, 151552
    s_add_u32 s101, s87, 4096
    buffer_load_dwordx4 v6, s[32:35], s101 offen offset:0  lds
    s_add_u32 m0, s66, 135168
    s_nop 0
    buffer_load_dwordx4 v6, s[32:35], s87 offen offset:0  lds
    s_add_u32 m0, s65, 118784
    s_nop 0
    buffer_load_dwordx4 v5, s[28:31], s86 offen offset:0  lds
    s_add_u32 m0, s67, 141312
    s_nop 0
    s_nop 0
    buffer_load_dwordx4 v7, s[32:35], s87 offen offset:2048  lds
    s_add_u32 m0, s65, 120832
    s_add_u32 s101, s86, 32768
    buffer_load_dwordx4 v5, s[28:31], s101 offen offset:0  lds
    s_add_u32 m0, s67, 151552
    s_add_u32 s101, s87, 4096
    buffer_load_dwordx4 v7, s[32:35], s101 offen offset:0  lds
    s_add_u32 m0, s67, 135168
    s_nop 0
    buffer_load_dwordx4 v7, s[32:35], s87 offen offset:0  lds
    s_add_u32 s86, s86, 128
    s_add_u32 s87, s87, 393216
    s_and_b32 s86, s86, 2047
    s_cselect_b32 s87, s87, 0
    s_mov_b32 s101, 40960
    s_cmp_ge_i32 s64, 0
    s_cselect_b32 s101, 0xfffec000, s101
    s_add_u32 s64, s64, s101
    s_add_u32 s65, s65, s101
    s_add_u32 s66, s66, s101
    s_add_u32 s67, s67, s101
    s_load_dword s75, s[26:27], 0
    s_mov_b32 s60, s8
    s_and_b32 s61, s9, 0xffff
    s_mov_b32 s62, 0x10000
    s_mov_b32 s63, 0x20000
    v_lshlrev_b32 v14, 4, v2
    s_lshl_b32 s78, s70, 12
    s_lshl_b32 s79, s76, 10
    s_add_u32 s78, s78, s79
    s_add_u32 m0, s79, 159744
    s_nop 0
    buffer_load_dwordx4 v14, s[60:63], s78 offen lds
    s_and_b32 s78, s2, 7
    s_lshr_b32 s79, s2, 3
    s_lshl_b32 s71, s78, 1
    s_and_b32 s72, s79, 1
    s_add_u32 s71, s71, s72
    s_lshr_b32 s72, s79, 1
    s_cmp_gt_u32 s70, 3
    s_cselect_b32 s78, 1, 0
    s_cmp_gt_u32 s70, 11
    s_cselect_b32 s78, 2, s78
    s_sub_u32 s78, s70, s78
    s_cmp_eq_u32 s70, 3
    s_cselect_b32 s78, 14, s78
    s_cmp_eq_u32 s70, 11
    s_cselect_b32 s78, 15, s78
    s_lshl_b32 s0, s78, 4
    s_add_u32 s0, s0, s69
    s_lshr_b32 s73, s0, 2
    s_and_b32 s74, s0, 3
    s_lshl_b32 s77, s70, 4
    s_add_u32 s77, s77, s69
    s_mov_b32 s36, s26
    s_and_b32 s37, s27, 0xffff
    s_mov_b32 s38, 0x10000000
    s_mov_b32 s39, 0x20000
    s_mov_b32 s40, s10
    s_and_b32 s41, s11, 0xffff
    s_mov_b32 s42, 0x200000
    s_mov_b32 s43, 0x20000
    s_mov_b32 s44, s22
    s_and_b32 s45, s23, 0xffff
    s_mov_b32 s46, 0x400000
    s_mov_b32 s47, 0x20000
    s_mov_b32 s48, s16
    s_and_b32 s49, s17, 0xffff
    s_mov_b32 s50, 0x700000
    s_mov_b32 s51, 0x20000
    s_mov_b32 s52, s18
    s_and_b32 s53, s19, 0xffff
    s_mov_b32 s54, 0x700000
    s_mov_b32 s55, 0x20000
    s_mov_b32 s56, s20
    s_and_b32 s57, s21, 0xffff
    s_mov_b32 s58, 0x700000
    s_mov_b32 s59, 0x20000
    v_mov_b32 v16, -1
    v_mov_b32 v17, -1
    v_mov_b32 v18, -1
    v_mov_b32_e64 v19, -1
    s_lshl_b32 s94, s77, 14
    s_lshl_b32 s78, s76, 12
    s_add_u32 s94, s94, s78
    s_add_u32 s94, s94, 4194304
    s_lshl_b32 s96, s77, 10
    s_add_u32 s96, s96, 8388608
    s_cmp_eq_u32 s76, 3
    s_cselect_b32 s96, s96, 0x10000000
    v_and_b32 v196, 15, v2
    v_lshrrev_b32 v197, 1, v196
    v_lshlrev_b32 v199, 7, v196
    v_add_u32 v199, s88, v199
    v_xor_b32_e64 v200, v198, v197
    v_lshl_add_u32 v60, v200, 4, v199
    v_bfe_u32 v196, v2, 2, 2
    v_and_b32_e64 v197, 3, v2
    v_lshl_add_u32 v199, v198, 3, v196
    v_lshlrev_b32_e64 v199, 7, v199
    v_lshl_add_u32 v199, v197, 3, v199
    v_lshrrev_b32 v196, 1, v196
    v_and_b32 v197, 1, v198
    v_lshl_add_u32 v196, v197, 1, v196
    s_mul_i32 s80, s76, 3
    s_add_u32 s78, s80, 0
    s_and_b32 s79, s78, 3
    s_lshr_b32 s78, s78, 2
    s_lshl_b32 s78, s78, 13
    s_add_u32 s78, s78, 16384
    v_xor_b32 v197, s79, v196
    v_lshl_add_u32 v197, v197, 5, v199
    v_add_u32_e64 v240, s78, v197
    s_add_u32 s78, s80, 1
    s_and_b32 s79, s78, 3
    s_lshr_b32 s78, s78, 2
    s_lshl_b32 s78, s78, 13
    s_add_u32 s78, s78, 16384
    v_xor_b32_e64 v197, s79, v196
    v_lshl_add_u32 v197, v197, 5, v199
    v_add_u32_e64 v241, s78, v197
    s_add_u32 s78, s80, 2
    s_and_b32 s79, s78, 3
    s_lshr_b32 s78, s78, 2
    s_lshl_b32 s78, s78, 13
    s_add_u32 s78, s78, 16384
    v_xor_b32_e64 v197, s79, v196
    v_lshl_add_u32 v197, v197, 5, v199
    v_add_u32 v242, s78, v197
    s_and_b32 s78, s70, 1
    s_lshl_b32 s78, s78, 6
    v_xor_b32 v60, s78, v60
    s_and_b32 s78, s69, 1
    s_lshl_b32 s78, s78, 12
    v_add_u32 v240, s78, v240
    v_add_u32 v241, s78, v241
    v_add_u32_e64 v242, s78, v242
    s_add_u32 m0, s64, 118784
    s_nop 0
    buffer_load_dwordx4 v4, s[28:31], s86 offen offset:0  lds
    v_lshrrev_b32 v196, 3, v2
    v_and_b32 v197, 7, v2
    v_lshlrev_b32 v199, 4, v197
    v_mul_u32_u24 v244, 57344, v196
    s_add_u32 m0, s66, 141312
    s_nop 0
    buffer_load_dwordx4 v6, s[32:35], s87 offen offset:2048  lds
    v_add_u32 v244, v244, v199
    v_lshl_add_u32 v245, v196, 14, v199
    s_lshl_b32 s78, s74, 2
    s_add_u32 s78, s78, s76
    s_add_u32 m0, s64, 120832
    s_add_u32 s101, s86, 32768
    buffer_load_dwordx4 v4, s[28:31], s101 offen offset:0  lds
    s_mul_i32 s79, s78, 458752
    s_add_u32 s80, s73, s76
    s_and_b32 s80, s80, 3
    s_andn2_b32 s100, s73, 3
    s_add_u32 m0, s66, 151552
    s_add_u32 s101, s87, 4096
    buffer_load_dwordx4 v6, s[32:35], s101 offen offset:0  lds
    s_or_b32 s80, s80, s100
    s_lshl_b32 s80, s80, 7
    s_add_u32 s79, s79, s80
    s_cmp_ge_u32 s73, 56
    s_cselect_b32 s79, 0x8000000, s79
    v_add_u32_e64 v244, s79, v244
    s_lshl_b32 s78, s78, 7
    s_add_u32 m0, s66, 135168
    s_nop 0
    buffer_load_dwordx4 v6, s[32:35], s87 offen offset:0  lds
    s_lshl_b32 s80, s73, 17
    s_add_u32 s78, s78, s80
    v_add_u32_e64 v245, s78, v245
    s_lshl_b32 s78, s72, 7
    s_add_u32 m0, s65, 118784
    s_nop 0
    buffer_load_dwordx4 v5, s[28:31], s86 offen offset:0  lds
    v_lshl_add_u32 v196, v196, 11, s78
    v_and_b32 v199, 1, v198
    v_lshlrev_b32 v199, 2, v199
    v_xor_b32 v199, v199, v197
    s_add_u32 m0, s67, 141312
    s_nop 0
    buffer_load_dwordx4 v7, s[32:35], s87 offen offset:2048  lds
    v_lshl_add_u32 v246, v199, 4, v196
    s_lshl_b32 s78, s71, 2
    s_add_u32 s78, s78, s76
    s_lshl_b32 s78, s78, 16
    v_add_u32_e64 v196, s78, v196
    s_add_u32 m0, s65, 120832
    s_add_u32 s101, s86, 32768
    buffer_load_dwordx4 v5, s[28:31], s101 offen offset:0  lds
    v_xor_b32_e64 v199, v198, v197
    v_lshl_add_u32 v247, v199, 4, v196
    v_xor_b32 v248, 64, v247
    s_lshl_b32 s78, s76, 14
    s_add_u32 m0, s67, 151552
    s_add_u32 s101, s87, 4096
    buffer_load_dwordx4 v7, s[32:35], s101 offen offset:0  lds
    v_add_u32 v246, s78, v246
    s_lshl_b32 s84, s76, 10
    s_bfe_u32 s78, s2, 0x40003
    s_lshl_b32 s78, s78, 17
    s_add_u32 m0, s67, 135168
    s_nop 0
    buffer_load_dwordx4 v7, s[32:35], s87 offen offset:0  lds
    s_add_u32 s86, s86, 128
    s_add_u32 s87, s87, 393216
    s_and_b32 s86, s86, 2047
    s_cselect_b32 s87, s87, 0
    s_mov_b32 s101, 40960
    s_cmp_ge_i32 s64, 0
    s_cselect_b32 s101, 0xfffec000, s101
    s_add_u32 s64, s64, s101
    s_add_u32 s65, s65, s101
    s_add_u32 s66, s66, s101
    s_add_u32 s67, s67, s101
    s_and_b32 s79, s72, 8
    s_add_u32 s79, s79, 3
    s_lshl_b32 s79, s79, 7
    s_add_u32 s78, s78, s79
    v_lshl_add_u32 v63, v2, 11, s78
    s_mul_i32 s100, s69, 52
    s_lshr_b32 s100, s100, 8
    s_mul_i32 s100, s100, 5
    s_sub_u32 s3, s69, s100
    s_branch L_sube
    .p2align 6
L_iss:
    s_add_u32 m0, s64, 118784
    s_nop 0
    buffer_load_dwordx4 v4, s[28:31], s86 offen offset:0  lds
    s_add_u32 m0, s66, 141312
    s_nop 0
    buffer_load_dwordx4 v6, s[32:35], s87 offen offset:2048  lds
    s_add_u32 m0, s64, 120832
    s_add_u32 s101, s86, 32768
    buffer_load_dwordx4 v4, s[28:31], s101 offen offset:0  lds
    s_add_u32 m0, s66, 151552
    s_add_u32 s101, s87, 4096
    buffer_load_dwordx4 v6, s[32:35], s101 offen offset:0  lds
    s_add_u32 m0, s66, 135168
    s_nop 0
    buffer_load_dwordx4 v6, s[32:35], s87 offen offset:0  lds
    s_add_u32 m0, s65, 118784
    s_nop 0
    buffer_load_dwordx4 v5, s[28:31], s86 offen offset:0  lds
    s_add_u32 m0, s67, 141312
    s_nop 0
    s_nop 0
    buffer_load_dwordx4 v7, s[32:35], s87 offen offset:2048  lds
    s_add_u32 m0, s65, 120832
    s_add_u32 s101, s86, 32768
    buffer_load_dwordx4 v5, s[28:31], s101 offen offset:0  lds
    s_add_u32 m0, s67, 151552
    s_add_u32 s101, s87, 4096
    buffer_load_dwordx4 v7, s[32:35], s101 offen offset:0  lds
    s_add_u32 m0, s67, 135168
    s_nop 0
    buffer_load_dwordx4 v7, s[32:35], s87 offen offset:0  lds
    s_add_u32 s86, s86, 128
    s_add_u32 s87, s87, 393216
    s_and_b32 s86, s86, 2047
    s_cselect_b32 s87, s87, 0
    s_mov_b32 s101, 40960
    s_cmp_ge_i32 s64, 0
    s_cselect_b32 s101, 0xfffec000, s101
    s_add_u32 s64, s64, s101
    s_add_u32 s65, s65, s101
    s_add_u32 s66, s66, s101
    s_add_u32 s67, s67, s101
    s_setpc_b64 s[90:91]
    .p2align 6
L_cl0:
    s_mov_b32 s100, 0
    buffer_load_dwordx4 v[64:67], v244, s[48:51], s100 offen nt
    s_mov_b32 s100, 0
    buffer_load_dwordx4 v[96:99], v244, s[52:55], s100 offen nt
    s_mov_b32 s100, 7168
    buffer_load_dwordx4 v[68:71], v244, s[48:51], s100 offen nt
    s_mov_b32 s100, 7168
    buffer_load_dwordx4 v[100:103], v244, s[52:55], s100 offen nt
    s_mov_b32 s100, 14336
    buffer_load_dwordx4 v[72:75], v244, s[48:51], s100 offen nt
    s_mov_b32 s100, 14336
    buffer_load_dwordx4 v[104:107], v244, s[52:55], s100 offen nt
    s_mov_b32 s100, 21504
    buffer_load_dwordx4 v[76:79], v244, s[48:51], s100 offen nt
    s_setpc_b64 s[90:91]
    .p2align 6
L_cl1:
    s_mov_b32 s100, 21504
    buffer_load_dwordx4 v[108:111], v244, s[52:55], s100 offen nt
    s_mov_b32 s100, 28672
    buffer_load_dwordx4 v[80:83], v244, s[48:51], s100 offen nt
    s_mov_b32 s100, 28672
    buffer_load_dwordx4 v[112:115], v244, s[52:55], s100 offen nt
    s_mov_b32 s100, 35840
    buffer_load_dwordx4 v[84:87], v244, s[48:51], s100 offen nt
    s_mov_b32 s100, 35840
    buffer_load_dwordx4 v[116:119], v244, s[52:55], s100 offen nt
    s_mov_b32 s100, 43008
    buffer_load_dwordx4 v[88:91], v244, s[48:51], s100 offen nt
    s_mov_b32 s100, 43008
    buffer_load_dwordx4 v[120:123], v244, s[52:55], s100 offen nt
    s_setpc_b64 s[90:91]
    .p2align 6
L_sube:
    s_waitcnt vmcnt(10)
    s_barrier
    s_call_b64 s[90:91], L_iss
    s_setprio 2
    v_add_u32 v196, 118784, v60
    v_add_u32 v198, 118784, v240
    v_add_u32 v199, 118784, v241
    v_add_u32 v200, 118784, v242
    ds_read_b128 v[20:23], v196 offset:0
    ds_read_b128 v[24:27], v196 offset:2048
    ds_read_b64_tr_b16 v[36:37], v198 offset:0
    ds_read_b64_tr_b16 v[38:39], v198 offset:512
    ds_read_b64_tr_b16 v[44:45], v199 offset:0
    ds_read_b64_tr_b16 v[46:47], v199 offset:512
    ds_read_b64_tr_b16 v[52:53], v200 offset:0
    ds_read_b64_tr_b16 v[54:55], v200 offset:512
    s_setprio 0
    s_waitcnt lgkmcnt(0)
    s_mul_i32 s75, s75, 0x9E3779B1
    s_add_u32 s75, s75, 0x7F4A7C15
    s_waitcnt vmcnt(10)
    s_waitcnt lgkmcnt(0)
    s_barrier
    s_call_b64 s[90:91], L_iss
    s_setprio 2
    s_nop 0
    v_add_u32 v196, 36864, v60
    v_add_u32 v198, 36864, v240
    v_add_u32 v199, 36864, v241
    v_add_u32 v200, 36864, v242
    ds_read_b128 v[28:31], v196 offset:0
    ds_read_b128 v[32:35], v196 offset:2048
    ds_read_b64_tr_b16 v[40:41], v198 offset:0
    ds_read_b64_tr_b16 v[42:43], v198 offset:512
    ds_read_b64_tr_b16 v[48:49], v199 offset:0
    ds_read_b64_tr_b16 v[50:51], v199 offset:512
    ds_read_b64_tr_b16 v[56:57], v200 offset:0
    ds_read_b64_tr_b16 v[58:59], v200 offset:512
    s_setprio 0
    s_getreg_b32 s99, hwreg(HW_REG_XCC_ID, 0, 4)
    v_mov_b32 v10, s75
    v_mov_b32 v11, s99
    v_not_b32 v12, v10
    v_mov_b32 v13, 0
    v_and_b32 v8, 15, v2
    v_lshlrev_b32 v9, 4, v8
    v_add_u32_e64 v9, s69, v9
    s_lshl_b32 s78, s70, 4
    s_lshl_b32 s79, s71, 4
    s_add_u32 s79, s79, 69088
    v_mov_b32 v202, s78
    v_mov_b32 v203, s79
    v_cmp_gt_u32 vcc, 32, v2
    s_nop 1
    v_cndmask_b32 v202, v203, v202, vcc
    v_add_u32 v8, v202, v8
    v_cmp_gt_u32 vcc, 16, v2
    s_nop 1
    v_cndmask_b32 v8, v8, v9, vcc
    v_lshlrev_b32 v8, 7, v8
    v_add_u32 v8, 4096, v8
    v_lshlrev_b32 v9, 3, v2
    s_lshl_b32 s82, s77, 7
    s_add_u32 s82, s82, 4096
    s_lshl_b32 s79, s71, 4
    s_add_u32 s79, s79, s72
    s_lshl_b32 s79, s79, 7
    s_add_u32 s79, s79, 8847360
    s_cmp_eq_u32 s76, 1
    s_cselect_b32 s82, s79, s82
    s_cmp_gt_u32 s76, 1
    s_cselect_b32 s82, 0x10000000, s82
    s_lshl_b32 s83, s77, 9
    s_add_u32 s83, s83, 8912896
    s_cmp_eq_u32 s76, 2
    s_cselect_b32 s83, s83, 0x10000000
    buffer_store_dwordx2 v[12:13], v9, s[36:39], s83 offen sc1
    s_waitcnt vmcnt(11)
    s_waitcnt lgkmcnt(0)
    s_barrier
    s_call_b64 s[90:91], L_iss
    s_waitcnt vmcnt(11)
    s_cmp_lg_u32 s3, 0
    s_cbranch_scc1 Lcs_1
    s_call_b64 s[90:91], L_cl0
Lcs_1:
    s_barrier
    s_setprio 2
    s_add_u32 m0, s64, 118784
    s_nop 0
    s_nop 0
    buffer_load_dwordx4 v4, s[28:31], s86 offen offset:0  lds
    v_mov_b32 v200, 0x3f803f80
    v_mov_b32 v201, 0x3f803f80
    v_mov_b32 v202, 0x3f803f80
    v_mov_b32 v203, 0x3f803f80
    s_add_u32 m0, s66, 141312
    s_nop 0
    s_nop 0
    buffer_load_dwordx4 v6, s[32:35], s87 offen offset:2048  lds
    v_mfma_f32_16x16x32_bf16 v[204:207], v[200:203], v[20:23], 0
    v_mfma_f32_16x16x32_bf16 v[212:215], v[20:23], v[20:23], 0
    v_mfma_f32_16x16x32_bf16 v[208:211], v[200:203], v[24:27], 0
    v_mfma_f32_16x16x32_bf16 v[216:219], v[24:27], v[24:27], 0
    s_add_u32 m0, s64, 120832
    s_add_u32 s101, s86, 32768
    buffer_load_dwordx4 v4, s[28:31], s101 offen offset:0  lds
    v_mfma_f32_16x16x32_bf16 v[220:223], v[200:203], v[36:39], 0
    v_mfma_f32_16x16x32_bf16 v[224:227], v[200:203], v[44:47], 0
    v_mfma_f32_16x16x32_bf16 v[228:231], v[200:203], v[52:55], 0
    v_mfma_f32_16x16x32_bf16 v[204:207], v[200:203], v[28:31], v[204:207]
    v_mfma_f32_16x16x32_bf16 v[212:215], v[28:31], v[28:31], v[212:215]
    s_add_u32 m0, s66, 151552
    s_add_u32 s101, s87, 4096
    buffer_load_dwordx4 v6, s[32:35], s101 offen offset:0  lds
    v_mfma_f32_16x16x32_bf16 v[208:211], v[200:203], v[32:35], v[208:211]
    v_mfma_f32_16x16x32_bf16 v[216:219], v[32:35], v[32:35], v[216:219]
    v_mfma_f32_16x16x32_bf16 v[220:223], v[200:203], v[40:43], v[220:223]
    v_mfma_f32_16x16x32_bf16 v[224:227], v[200:203], v[48:51], v[224:227]
    s_add_u32 m0, s66, 135168
    s_nop 0
    buffer_load_dwordx4 v6, s[32:35], s87 offen offset:0  lds
    v_mfma_f32_16x16x32_bf16 v[228:231], v[200:203], v[56:59], v[228:231]
    v_and_b32 v196, 3, v2
    v_cmp_eq_u32 s[90:91], 1, v196
    v_cmp_eq_u32 s[92:93], 2, v196
    v_cmp_eq_u32_e64 vcc, 3, v196
    s_add_u32 m0, s65, 118784
    s_nop 0
    buffer_load_dwordx4 v5, s[28:31], s86 offen offset:0  lds
    v_cndmask_b32 v212, v212, v213, s[90:91]
    v_cndmask_b32 v212, v212, v214, s[92:93]
    v_cndmask_b32 v205, v212, v215, vcc
    v_cndmask_b32 v216, v216, v217, s[90:91]
    s_add_u32 m0, s67, 141312
    s_nop 0
    buffer_load_dwordx4 v7, s[32:35], s87 offen offset:2048  lds
    v_cndmask_b32 v216, v216, v218, s[92:93]
    v_cndmask_b32 v209, v216, v219, vcc
    v_lshrrev_b32_e64 v196, 4, v2
    v_cmp_eq_u32 s[90:91], 1, v196
    v_cmp_eq_u32_e64 vcc, 2, v196
    s_add_u32 m0, s65, 120832
    s_add_u32 s101, s86, 32768
    buffer_load_dwordx4 v5, s[28:31], s101 offen offset:0  lds
    v_cndmask_b32 v220, v220, v224, s[90:91]
    v_cndmask_b32_e64 v220, v220, v228, vcc
    s_mul_i32 s78, s77, 768
    s_mul_i32 s79, s76, 192
    s_add_u32 m0, s67, 151552
    s_add_u32 s101, s87, 4096
    buffer_load_dwordx4 v7, s[32:35], s101 offen offset:0  lds
    s_add_u32 s78, s78, s79
    s_add_u32 s78, s78, 327680
    v_lshlrev_b32 v197, 2, v2
    s_mov_b32 exec_hi, 0xffff
    buffer_store_dword v220, v197, s[36:39], s78 offen sc1
    s_mov_b32 exec_hi, -1
    s_lshl_b32 s78, s69, 4
    s_add_u32 m0, s67, 135168
    s_nop 0
    buffer_load_dwordx4 v7, s[32:35], s87 offen offset:0  lds
    s_add_u32 s86, s86, 128
    s_add_u32 s87, s87, 393216
    s_and_b32 s86, s86, 2047
    s_cselect_b32 s87, s87, 0
    s_mov_b32 s101, 40960
    s_cmp_ge_i32 s64, 0
    s_cselect_b32 s101, 0xfffec000, s101
    s_add_u32 s64, s64, s101
    s_add_u32 s65, s65, s101
    s_add_u32 s66, s66, s101
    s_add_u32 s67, s67, s101
    s_add_u32 s78, s78, s70
    s_lshl_b32 s78, s78, 10
    s_lshl_b32 s79, s76, 8
    s_add_u32 s78, s78, s79
    buffer_store_dwordx4 v[16:19], v14, s[36:39], s96 offen offset:0 sc1
    s_add_u32 s78, s78, 65536
    v_and_b32 v198, 15, v2
    v_lshlrev_b32_e64 v198, 3, v198
    s_mov_b32 exec_lo, 0x00f0000f
    s_mov_b32 exec_hi, 0xf0000f00
    buffer_store_dwordx2 v[204:205], v198, s[36:39], s78 offen offset:0 sc1
    s_mov_b64 exec, -1
    s_mov_b32 exec_lo, 0x00f0000f
    s_mov_b32 exec_hi, 0xf0000f00
    buffer_store_dwordx2 v[208:209], v198, s[36:39], s78 offen offset:128 sc1
    s_mov_b64 exec, -1
    s_setprio 0
    s_waitcnt vmcnt(14)
    s_cmp_lg_u32 s3, 1
    s_cbranch_scc1 Lcs_2
    s_call_b64 s[90:91], L_cl0
Lcs_2:
    s_barrier
    s_call_b64 s[90:91], L_iss
    s_waitcnt vmcnt(10)
    s_cmp_lg_u32 s3, 2
    s_cbranch_scc1 Lcs_3
    s_call_b64 s[90:91], L_cl0
Lcs_3:
    s_barrier
    s_mov_b64 exec, 0xffff
    buffer_store_dwordx2 v[10:11], v9, s[36:39], s82 offen sc1
    s_mov_b64 exec, -1
    s_call_b64 s[90:91], L_iss
    s_waitcnt vmcnt(11)
    s_cmp_lg_u32 s3, 3
    s_cbranch_scc1 Lcs_4
    s_call_b64 s[90:91], L_cl0
Lcs_4:
    s_barrier
    s_call_b64 s[90:91], L_iss
    s_waitcnt vmcnt(10)
    s_cmp_lg_u32 s3, 4
    s_cbranch_scc1 Lcs_5
    s_call_b64 s[90:91], L_cl0
Lcs_5:
    s_barrier
    s_call_b64 s[90:91], L_iss
    s_waitcnt vmcnt(10)
    s_cmp_lg_u32 s3, 0
    s_cbranch_scc1 Lcs_6
    s_call_b64 s[90:91], L_cl1
Lcs_6:
    s_barrier
    s_call_b64 s[90:91], L_iss
    s_waitcnt vmcnt(10)
    s_cmp_lg_u32 s3, 1
    s_cbranch_scc1 Lcs_7
    s_call_b64 s[90:91], L_cl1
Lcs_7:
    s_barrier
    s_call_b64 s[90:91], L_iss
    s_waitcnt vmcnt(10)
    s_cmp_lg_u32 s3, 2
    s_cbranch_scc1 Lcs_8
    s_call_b64 s[90:91], L_cl1
Lcs_8:
    s_barrier
    s_call_b64 s[90:91], L_iss
    s_waitcnt vmcnt(10)
    s_cmp_lg_u32 s3, 3
    s_cbranch_scc1 Lcs_9
    s_call_b64 s[90:91], L_cl1
Lcs_9:
    s_barrier
    s_call_b64 s[90:91], L_iss
    s_waitcnt vmcnt(10)
    s_cmp_lg_u32 s3, 4
    s_cbranch_scc1 Lcs_10
    s_call_b64 s[90:91], L_cl1
Lcs_10:
    s_barrier
    s_cmp_lg_u32 s76, 0
    s_cbranch_scc1 Lpl_11
    s_mov_b32 exec_hi, 0xffff
    buffer_load_dwordx2 v[10:11], v8, s[36:39], 0 offen sc1
    s_mov_b64 exec, -1
Lpl_11:
    s_call_b64 s[90:91], L_iss
    s_cmp_lg_u32 s76, 1
    s_cbranch_scc1 Lpf_12
    s_getpc_b64 s[90:91]
Lpc_13:
    s_add_u32 s90, s90, L_phend-Lpc_13
    s_addc_u32 s91, s91, 0
    s_lshr_b32 s100, s2, 3
    s_lshl_b32 s100, s100, 10
    s_min_u32 s100, s100, (L_end-L_phend-768)
    v_add_u32 v236, s100, v14
    global_load_dword v236, v236, s[90:91]
Lpf_12:
    s_waitcnt vmcnt(10)
    s_barrier
    s_cmp_lg_u32 s76, 2
    s_cbranch_scc1 Lc4_14
    s_mov_b32 exec_hi, -1
    buffer_load_dword v238, v63, s[40:43], 0 offen
    s_mov_b64 exec, -1
Lc4_14:
    s_call_b64 s[90:91], L_iss
    s_waitcnt vmcnt(10)
    s_cmp_lg_u32 s76, 0
    s_cbranch_scc1 Lpc_15
    s_setprio 2
    s_mov_b32 exec_hi, 0xffff
    s_mov_b32 s85, 0
    s_branch Lpk_16
Lspin_17:
    s_add_u32 s85, s85, 1
    s_cmp_gt_u32 s85, 400000
    s_cbranch_scc1 L_end
    buffer_load_dwordx2 v[10:11], v8, s[36:39], 0 offen sc1
    s_waitcnt vmcnt(0)
Lpk_16:
    v_cmp_ne_u32 vcc, s75, v10
    s_cbranch_vccnz Lspin_17
    v_cmp_ne_u32 vcc, s99, v11
    s_mov_b64 exec, -1
    s_lshr_b32 s78, vcc_lo, 16
    s_cselect_b32 s78, 0, 1
    s_cmp_eq_u32 vcc_hi, 0
    s_cselect_b32 s79, 2, 0
    s_or_b32 s78, s78, s79
    s_and_b32 s78, s78, 3
    v_mov_b32_e64 v10, s78
    v_mov_b32 v11, 163584
    ds_write_b32 v11, v10
    s_setprio 0
Lpc_15:
    s_barrier
    v_lshrrev_b32 v196, 4, v2
    v_and_b32 v197, 15, v2
    v_lshlrev_b32_e64 v197, 4, v197
    v_lshl_add_u32 v198, v196, 10, v197
    s_lshl_b32 s78, s69, 14
    s_lshl_b32 s79, s76, 8
    s_add_u32 s78, s78, s79
    s_nop 0
    s_add_u32 s78, s78, 65536
    buffer_load_dwordx4 v[20:23], v198, s[36:39], s78 offen sc1
    s_add_u32 s78, s78, 4096
    buffer_load_dwordx4 v[24:27], v198, s[36:39], s78 offen sc1
    s_add_u32 s78, s78, 4096
    buffer_load_dwordx4 v[28:31], v198, s[36:39], s78 offen sc1
    s_add_u32 s78, s78, 4096
    buffer_load_dwordx4 v[32:35], v198, s[36:39], s78 offen sc1
    v_mul_u32_u24 v198, 768, v196
    v_add_u32_e64 v198, v198, v197
    s_mul_i32 s78, s70, 12288
    s_lshl_b32 s79, s76, 8
    s_add_u32 s78, s78, s79
    s_add_u32 s78, s78, 327680
    s_cmp_eq_u32 s76, 3
    s_nop 0
    s_cselect_b32 s78, 0x10000000, s78
    buffer_load_dwordx4 v[36:39], v198, s[36:39], s78 offen sc1
    s_add_u32 s78, s78, 3072
    buffer_load_dwordx4 v[40:43], v198, s[36:39], s78 offen sc1
    s_add_u32 s78, s78, 3072
    buffer_load_dwordx4 v[44:47], v198, s[36:39], s78 offen sc1
    s_add_u32 s78, s78, 3072
    buffer_load_dwordx4 v[48:51], v198, s[36:39], s78 offen sc1
    s_add_u32 m0, s84, 0
    s_mov_b32 s100, 0
    buffer_load_dwordx4 v246, s[40:43], s100 offen  lds
    s_add_u32 m0, s84, 4096
    s_mov_b32 s100, 65536
    buffer_load_dwordx4 v246, s[40:43], s100 offen  lds
    s_add_u32 m0, s84, 8192
    s_mov_b32 s100, 131072
    buffer_load_dwordx4 v246, s[40:43], s100 offen  lds
    s_add_u32 m0, s84, 12288
    s_mov_b32 s100, 196608
    buffer_load_dwordx4 v246, s[40:43], s100 offen  lds
    s_waitcnt vmcnt(12)
    s_barrier
    s_setprio 2
    s_add_u32 m0, s84, 16384
    s_mov_b32 s100, 262144
    buffer_load_dwordx4 v246, s[40:43], s100 offen  lds
    s_waitcnt vmcnt(9)
    v_add_f32 v20, v20, v24
    v_add_f32 v21, v21, v25
    v_add_f32 v22, v22, v26
    v_add_f32 v23, v23, v27
    v_add_f32 v20, v20, v28
    v_add_f32 v21, v21, v29
    s_add_u32 m0, s84, 20480
    s_mov_b32 s100, 327680
    buffer_load_dwordx4 v246, s[40:43], s100 offen  lds
    v_add_f32 v22, v22, v30
    v_add_f32 v23, v23, v31
    v_add_f32 v20, v20, v32
    v_add_f32 v21, v21, v33
    v_add_f32 v22, v22, v34
    v_add_f32 v23, v23, v35
    s_nop 0
    v_permlane32_swap_b32 v20, v22
    s_add_u32 m0, s84, 24576
    s_mov_b32 s100, 393216
    buffer_load_dwordx4 v246, s[40:43], s100 offen  lds
    v_permlane32_swap_b32 v21, v23
    v_add_f32 v20, v20, v22
    v_add_f32 v21, v21, v23
    v_mov_b32 v22, v20
    v_mov_b32 v23, v21
    s_nop 0
    v_permlane16_swap_b32 v20, v22
    v_permlane16_swap_b32 v21, v23
    v_add_f32_e64 v20, v20, v22
    s_add_u32 m0, s84, 28672
    s_mov_b32 s100, 458752
    buffer_load_dwordx4 v246, s[40:43], s100 offen  lds
    v_add_f32_e64 v21, v21, v23
    v_mul_f32 v24, 0x3a800000, v20
    v_mul_f32 v26, 0x3a800000, v21
    v_fma_f32 v26, -v24, v24, v26
    v_max_f32_e64 v26, 0, v26
    v_cvt_pk_bf16_f32 v24, v24, v24
    v_and_b32 v24, 0xffff0000, v24
    s_add_u32 m0, s84, 32768
    s_mov_b32 s100, 524288
    buffer_load_dwordx4 v246, s[40:43], s100 offen  lds
    v_cvt_pk_bf16_f32 v26, v26, v26
    v_and_b32 v26, 0xffff0000, v26
    v_add_f32 v26, 0x3727c5ac, v26
    v_cvt_pk_bf16_f32 v26, v26, v26
    v_and_b32 v26, 0xffff0000, v26
    v_sqrt_f32 v26, v26
    s_nop 0
    v_cvt_pk_bf16_f32 v26, v26, v26
    v_and_b32 v26, 0xffff0000, v26
    s_add_u32 m0, s84, 36864
    s_mov_b32 s100, 589824
    buffer_load_dwordx4 v246, s[40:43], s100 offen  lds
    v_rcp_f32_e64 v25, v26
    v_xor_b32 v26, 0x80000000, v24
    v_lshrrev_b32 v27, 16, v26
    v_or_b32 v26, v26, v27
    v_mov_b32 v27, 0
    v_and_b32 v196, 15, v2
    v_lshrrev_b32_e64 v197, 5, v2
    s_add_u32 m0, s84, 40960
    s_mov_b32 s100, 655360
    buffer_load_dwordx4 v246, s[40:43], s100 offen  lds
    v_lshl_add_u32 v196, v196, 1, v197
    s_lshl_b32 s78, s76, 5
    v_add_u32 v196, s78, v196
    v_lshlrev_b32_e64 v197, 3, v196
    v_add_u32 v197, 159744, v197
    v_lshlrev_b32_e64 v196, 2, v196
    v_add_u32 v196, 162304, v196
    s_add_u32 m0, s84, 45056
    s_mov_b32 s100, 720896
    buffer_load_dwordx4 v246, s[40:43], s100 offen  lds
    ds_write_b64 v197, v[26:27]
    ds_write_b32 v196, v25
    s_waitcnt vmcnt(12)
    v_add_f32 v36, v36, v40
    v_add_f32 v37, v37, v41
    v_add_f32 v38, v38, v42
    v_add_f32 v39, v39, v43
    v_add_f32 v36, v36, v44
    s_add_u32 m0, s84, 49152
    s_mov_b32 s100, 786432
    buffer_load_dwordx4 v246, s[40:43], s100 offen  lds
    v_add_f32 v37, v37, v45
    v_add_f32 v38, v38, v46
    v_add_f32 v39, v39, v47
    v_add_f32 v36, v36, v48
    v_add_f32 v37, v37, v49
    v_add_f32 v38, v38, v50
    v_add_f32_e64 v39, v39, v51
    s_add_u32 m0, s84, 53248
    s_mov_b32 s100, 851968
    buffer_load_dwordx4 v246, s[40:43], s100 offen  lds
    v_permlane32_swap_b32 v36, v38
    v_permlane32_swap_b32 v37, v39
    v_add_f32 v36, v36, v38
    v_add_f32 v37, v37, v39
    s_nop 1
    v_permlane16_swap_b32 v36, v37
    v_add_f32_e64 v36, v36, v37
    v_cvt_pk_bf16_f32 v37, v36, v36
    v_and_b32 v37, 0xffff0000, v37
    s_add_u32 m0, s84, 57344
    s_mov_b32 s100, 917504
    buffer_load_dwordx4 v246, s[40:43], s100 offen  lds
    v_sub_f32_e64 v38, v36, v37
    v_cvt_pk_bf16_f32 v38, v37, v38
    v_mov_b32 v39, 0
    v_and_b32 v196, 15, v2
    v_lshrrev_b32_e64 v197, 4, v2
    v_lshl_add_u32 v196, v196, 2, v197
    s_lshl_b32 s78, s76, 9
    s_add_u32 m0, s84, 61440
    s_mov_b32 s100, 983040
    buffer_load_dwordx4 v246, s[40:43], s100 offen  lds
    s_add_u32 s78, s78, 160768
    v_lshl_add_u32 v196, v196, 3, s78
    v_and_b32 v197, 15, v2
    v_lshlrev_b32_e64 v197, 3, v197
    v_add_u32 v197, 162816, v197
    v_mov_b32 v198, 0x3f803f80
    s_cmp_eq_u32 s76, 3
    s_cselect_b64 vcc, -1, 0
    v_cndmask_b32 v196, v196, v197, vcc
    v_cndmask_b32 v38, v38, v198, vcc
    v_cndmask_b32_e64 v39, v39, v198, vcc
    ds_write_b64 v196, v[38:39]
    s_setprio 0
    s_waitcnt lgkmcnt(0)
    s_barrier
L_phend:
    s_mov_b32 s66, s96
    s_add_u32 m0, s84, 65536
    s_mov_b32 s100, 1048576
    buffer_load_dwordx4 v246, s[40:43], s100 offen  lds
    v_lshrrev_b32 v52, 2, v2
    v_and_b32 v53, 7, v52
    v_and_b32_e64 v55, 3, v2
    s_add_u32 m0, s84, 69632
    s_mov_b32 s100, 1114112
    buffer_load_dwordx4 v246, s[40:43], s100 offen  lds
    v_xor_b32 v53, v53, v55
    v_lshlrev_b32 v52, 7, v52
    v_lshrrev_b32_e64 v55, 1, v55
    s_add_u32 m0, s84, 73728
    s_mov_b32 s100, 1179648
    buffer_load_dwordx4 v246, s[40:43], s100 offen  lds
    v_lshl_add_u32 v52, v55, 3, v52
    s_lshr_b32 s78, s76, 1
    s_and_b32 s79, s76, 1
    s_lshl_b32 s80, s79, 2
    s_add_u32 m0, s84, 77824
    s_mov_b32 s100, 1245184
    buffer_load_dwordx4 v246, s[40:43], s100 offen  lds
    s_lshl_b32 s81, s78, 2
    v_xor_b32 v55, s80, v53
    v_xor_b32 v53, s81, v53
    s_add_u32 m0, s84, 81920
    s_mov_b32 s100, 1310720
    buffer_load_dwordx4 v246, s[40:43], s100 offen  lds
    s_lshl_b32 s80, s78, 14
    s_add_u32 s80, s80, 110592
    v_lshl_add_u32 v196, v55, 4, v52
    v_add_u32 v196, s80, v196
    s_add_u32 m0, s84, 86016
    s_mov_b32 s100, 1376256
    buffer_load_dwordx4 v246, s[40:43], s100 offen  lds
    v_lshl_add_u32 v198, v53, 4, v52
    v_add_u32 v198, 143360, v198
    v_xor_b32_e64 v197, 8, v196
    s_add_u32 m0, s84, 90112
    s_mov_b32 s100, 1441792
    buffer_load_dwordx4 v246, s[40:43], s100 offen  lds
    v_xor_b32_e64 v199, 8, v198
    v_mov_b32 v200, 0x3f803f80
    v_mov_b32 v201, 0x3f803f80
    v_mov_b32 v202, 0x3f803f80
    s_add_u32 m0, s84, 94208
    s_mov_b32 s100, 1507328
    buffer_load_dwordx4 v246, s[40:43], s100 offen  lds
    v_mov_b32 v203, 0x3f803f80
    v_lshrrev_b32 v62, 4, v2
    v_and_b32 v52, 15, v2
    s_add_u32 m0, s84, 98304
    s_mov_b32 s100, 1572864
    buffer_load_dwordx4 v246, s[40:43], s100 offen  lds
    v_lshlrev_b32_e64 v53, 4, v52
    v_lshl_add_u32 v62, v62, 13, v53
    v_lshrrev_b32_e64 v52, 3, v52
    v_lshl_add_u32 v62, v52, 8, v62
    s_add_u32 m0, s84, 102400
    s_mov_b32 s100, 1638400
    buffer_load_dwordx4 v246, s[40:43], s100 offen  lds
    v_xor_b32 v63, 256, v62
    s_lshl_b32 s78, s70, 2
    s_add_u32 s78, s78, s76
    s_add_u32 m0, s84, 106496
    s_mov_b32 s100, 1703936
    buffer_load_dwordx4 v246, s[40:43], s100 offen  lds
    s_lshl_b32 s78, s78, 15
    s_lshl_b32 s79, s69, 9
    s_add_u32 s78, s78, s79
    s_add_u32 s78, s78, 2097152
    s_mov_b32 s100, 2031616
    buffer_load_dwordx4 v[160:163], v246, s[40:43], s100 offen
    s_lshl_b32 s79, s77, 10
    s_lshl_b32 s80, s76, 6
    s_add_u32 s79, s79, s80
    s_mov_b32 s100, 1966080
    buffer_load_dwordx4 v[164:167], v246, s[40:43], s100 offen
    s_add_u32 s79, s79, 8389120
    v_lshrrev_b32 v52, 3, v2
    v_and_b32 v53, 7, v2
    v_lshlrev_b32_e64 v53, 4, v53
    s_mov_b32 s100, 1900544
    buffer_load_dwordx4 v[168:171], v246, s[40:43], s100 offen
    v_lshl_add_u32 v56, v52, 9, v53
    v_lshl_add_u32 v57, v52, 1, v53
    s_lshl_b32 s82, s70, 14
    s_mov_b32 s100, 1835008
    buffer_load_dwordx4 v[172:175], v246, s[40:43], s100 offen
    s_add_u32 s82, s82, s80
    s_add_u32 s82, s82, 8389120
    s_add_u32 s80, s80, 162944
    v_lshrrev_b32_e64 v58, 2, v2
    s_mov_b32 s100, 1769472
    buffer_load_dwordx4 v[176:179], v246, s[40:43], s100 offen
    v_and_b32 v53, 3, v2
    v_lshlrev_b32 v53, 4, v53
    v_lshl_add_u32 v58, v58, 10, v53
    s_mov_b32 s100, 0
    buffer_load_dwordx4 v[180:183], v247, s[28:31], s100 offen
    v_lshl_add_u32 v59, v52, 1, v53
    v_add_u32 v59, s80, v59
    s_lshl_b32 s64, s77, 13
    s_lshl_b32 s80, s76, 7
    s_mov_b32 s100, 16384
    buffer_load_dwordx4 v[184:187], v248, s[28:31], s100 offen
    s_add_u32 s64, s64, s80
    s_add_u32 s64, s64, 2097152
    s_add_u32 s65, s64, 4096
    s_mov_b32 s100, 32768
    buffer_load_dwordx4 v[188:191], v247, s[28:31], s100 offen
    s_lshl_b32 s81, s77, 10
    s_add_u32 s81, s81, s80
    s_add_u32 s81, s81, 8388608
    s_lshl_b32 s80, s71, 9
    s_mov_b32 s100, 49152
    buffer_load_dwordx4 v[192:195], v248, s[28:31], s100 offen
    s_add_u32 s80, s80, 8912896
    v_lshl_add_u32 v61, v2, 13, s80
    v_mov_b32 v52, 163584
    s_lshl_b32 s100, s77, 13
    s_add_u32 s100, s100, s89
    s_add_u32 s100, s100, 2097152
    buffer_load_dwordx4 v[252:255], v14, s[36:39], s100 offen offset:0 sc1
    ds_read_b32 v52, v52
    s_waitcnt lgkmcnt(0)
    v_readfirstlane_b32 s99, v52
    s_and_b32 s94, s69, 1
    s_lshl_b32 s100, s77, 13
    s_add_u32 s100, s100, s89
    s_nop 0
    s_add_u32 s100, s100, 2097152
    buffer_load_dwordx4 v[252:255], v14, s[36:39], s100 offen offset:1024 sc1
    s_mul_i32 s94, s94, 0x00010001
    s_mov_b32 s95, 0xfffefffe
    s_and_b32 s96, s75, 0x00010001
    buffer_load_dwordx4 v[252:255], v14, s[36:39], s66 offen sc1
    v_mov_b32_e64 v54, s96
    s_and_b32 s83, s75, 1
    s_lshl_b32 s83, s83, 16
    s_sub_u32 s83, 0, s83
    s_barrier
    ds_read_b64_tr_b16 v[4:5], v196 offset:0
    ds_read_b64_tr_b16 v[6:7], v196 offset:2048
    ds_read_b64_tr_b16 v[12:13], v198 offset:0
    ds_read_b64_tr_b16 v[14:15], v198 offset:2048
    ds_read_b64_tr_b16 v[8:9], v197 offset:0
    ds_read_b64_tr_b16 v[10:11], v197 offset:2048
    ds_read_b64_tr_b16 v[16:17], v199 offset:0
    ds_read_b64_tr_b16 v[18:19], v199 offset:2048
    ds_read_b64_tr_b16 v[20:21], v196 offset:4096
    ds_read_b64_tr_b16 v[22:23], v196 offset:6144
    ds_read_b64_tr_b16 v[28:29], v198 offset:4096
    ds_read_b64_tr_b16 v[30:31], v198 offset:6144
    ds_read_b64_tr_b16 v[24:25], v197 offset:4096
    ds_read_b64_tr_b16 v[26:27], v197 offset:6144
    s_waitcnt lgkmcnt(10)
    v_mfma_f32_16x16x32_bf16 v[204:207], v[4:7], v[12:15], 0
    ds_read_b64_tr_b16 v[32:33], v199 offset:4096
    ds_read_b64_tr_b16 v[34:35], v199 offset:6144
    s_waitcnt lgkmcnt(10)
    v_mfma_f32_16x16x32_bf16 v[208:211], v[8:11], v[12:15], 0
    ds_read_b64_tr_b16 v[36:37], v196 offset:8192
    ds_read_b64_tr_b16 v[38:39], v196 offset:10240
    s_waitcnt lgkmcnt(10)
    s_nop 0
    v_mfma_f32_16x16x32_bf16 v[216:219], v[8:11], v[16:19], 0
    ds_read_b64_tr_b16 v[44:45], v198 offset:8192
    ds_read_b64_tr_b16 v[46:47], v198 offset:10240
    v_mfma_f32_16x16x32_bf16 v[212:215], v[4:7], v[16:19], 0
    ds_read_b64_tr_b16 v[40:41], v197 offset:8192
    ds_read_b64_tr_b16 v[42:43], v197 offset:10240
    s_waitcnt lgkmcnt(10)
    v_mfma_f32_16x16x32_bf16 v[204:207], v[20:23], v[28:31], v[204:207]
    ds_read_b64_tr_b16 v[48:49], v199 offset:8192
    ds_read_b64_tr_b16 v[50:51], v199 offset:10240
    s_waitcnt lgkmcnt(10)
    v_mfma_f32_16x16x32_bf16 v[208:211], v[24:27], v[28:31], v[208:211]
    ds_read_b64_tr_b16 v[228:229], v196 offset:12288
    ds_read_b64_tr_b16 v[230:231], v196 offset:14336
    s_waitcnt lgkmcnt(10)
    s_nop 0
    v_mfma_f32_16x16x32_bf16 v[216:219], v[24:27], v[32:35], v[216:219]
    ds_read_b64_tr_b16 v[236:237], v198 offset:12288
    ds_read_b64_tr_b16 v[238:239], v198 offset:14336
    v_mfma_f32_16x16x32_bf16 v[212:215], v[20:23], v[32:35], v[212:215]
    ds_read_b64_tr_b16 v[232:233], v197 offset:12288
    ds_read_b64_tr_b16 v[234:235], v197 offset:14336
    s_waitcnt lgkmcnt(10)
    v_mfma_f32_16x16x32_bf16 v[204:207], v[36:39], v[44:47], v[204:207]
    ds_read_b64_tr_b16 v[240:241], v199 offset:12288
    ds_read_b64_tr_b16 v[242:243], v199 offset:14336
    s_waitcnt lgkmcnt(10)
    v_mfma_f32_16x16x32_bf16 v[208:211], v[40:43], v[44:47], v[208:211]
    s_waitcnt lgkmcnt(8)
    v_mfma_f32_16x16x32_bf16 v[216:219], v[40:43], v[48:51], v[216:219]
    v_mfma_f32_16x16x32_bf16 v[212:215], v[36:39], v[48:51], v[212:215]
    s_waitcnt lgkmcnt(4)
    v_mfma_f32_16x16x32_bf16 v[204:207], v[228:231], v[236:239], v[204:207]
    s_waitcnt lgkmcnt(2)
    v_mfma_f32_16x16x32_bf16 v[208:211], v[232:235], v[236:239], v[208:211]
    s_waitcnt lgkmcnt(0)
    v_mfma_f32_16x16x32_bf16 v[216:219], v[232:235], v[240:243], v[216:219]
    v_mfma_f32_16x16x32_bf16 v[212:215], v[228:231], v[240:243], v[212:215]
    v_mfma_f32_16x16x32_bf16 v[220:223], v[4:7], v[200:203], 0
    v_mfma_f32_16x16x32_bf16 v[224:227], v[8:11], v[200:203], 0
    v_mfma_f32_16x16x32_bf16 v[220:223], v[20:23], v[200:203], v[220:223]
    v_mfma_f32_16x16x32_bf16 v[224:227], v[24:27], v[200:203], v[224:227]
    v_cvt_pk_bf16_f32 v12, v204, v205
    v_cvt_pk_bf16_f32 v13, v206, v207
    v_cvt_pk_bf16_f32 v14, v208, v209
    v_cvt_pk_bf16_f32 v15, v210, v211
    v_mfma_f32_16x16x32_bf16 v[220:223], v[36:39], v[200:203], v[220:223]
    v_add_u32_e64 v12, s94, v12
    v_and_or_b32 v12, v12, s95, v54
    v_mfma_f32_16x16x32_bf16 v[224:227], v[40:43], v[200:203], v[224:227]
    v_add_u32_e64 v13, s94, v13
    v_and_or_b32 v13, v13, s95, v54
    v_mfma_f32_16x16x32_bf16 v[220:223], v[228:231], v[200:203], v[220:223]
    v_add_u32_e64 v14, s94, v14
    v_and_or_b32 v14, v14, s95, v54
    v_mfma_f32_16x16x32_bf16 v[224:227], v[232:235], v[200:203], v[224:227]
    v_add_u32_e64 v15, s94, v15
    v_and_or_b32 v15, v15, s95, v54
    s_bitcmp1_b32 s99, 0
    s_cbranch_scc1 Lls_18
    buffer_store_dwordx4 v[12:15], v62, s[36:39], s78 offen sc1
    s_branch Lle_19
Lls_18:
    buffer_store_dwordx4 v[12:15], v62, s[36:39], s78 offen
Lle_19:
    v_cvt_pk_bf16_f32 v28, v212, v213
    v_cvt_pk_bf16_f32 v29, v214, v215
    v_cvt_pk_bf16_f32 v30, v216, v217
    v_cvt_pk_bf16_f32 v31, v218, v219
    v_add_u32 v28, s94, v28
    v_and_or_b32 v28, v28, s95, v54
    v_add_u32_e64 v29, s94, v29
    v_and_or_b32 v29, v29, s95, v54
    v_add_u32_e64 v30, s94, v30
    v_and_or_b32 v30, v30, s95, v54
    v_add_u32_e64 v31, s94, v31
    v_and_or_b32 v31, v31, s95, v54
    s_bitcmp1_b32 s99, 0
    s_cbranch_scc1 Lls_20
    buffer_store_dwordx4 v[28:31], v63, s[36:39], s78 offen sc1
    s_branch Lle_21
Lls_20:
    s_nop 0
    buffer_store_dwordx4 v[28:31], v63, s[36:39], s78 offen
Lle_21:
    v_cvt_pk_bf16_f32 v44, v220, v221
    v_cvt_pk_bf16_f32 v45, v222, v223
    v_cvt_pk_bf16_f32 v46, v224, v225
    v_cvt_pk_bf16_f32 v47, v226, v227
    s_mov_b32 exec_lo, 0x00010001
    s_mov_b32 exec_hi, 0x00010001
    s_bitcmp1_b32 s99, 0
    s_cbranch_scc1 Lls_22
    buffer_store_dwordx4 v[44:47], v2, s[36:39], s79 offen sc1
    s_branch Lle_23
Lls_22:
    buffer_store_dwordx4 v[44:47], v2, s[36:39], s79 offen
Lle_23:
    s_mov_b64 exec, -1
    s_sleep 3
    s_mov_b32 s85, 0
Lspin_24:
    s_add_u32 s85, s85, 1
    s_cmp_gt_u32 s85, 400000
    s_cbranch_scc1 L_end
    buffer_load_dwordx4 v[20:23], v56, s[36:39], s64 offen sc1
    buffer_load_dwordx4 v[24:27], v56, s[36:39], s65 offen sc1
    buffer_load_dwordx4 v[16:19], v58, s[36:39], s82 offen sc1
    s_waitcnt vmcnt(0)
Lchk_25:
    s_nop 0
    v_bitop3_b32 v28, v20, v24, v54 bitop3:0x7e
    v_bitop3_b32 v29, v21, v25, v54 bitop3:0x7e
    v_bitop3_b32 v30, v22, v26, v54 bitop3:0x7e
    v_bitop3_b32 v31, v23, v27, v54 bitop3:0x7e
    v_or3_b32 v28, v28, v29, v30
    v_cmp_eq_u32 s[90:91], -1, v16
    v_or_b32_e64 v28, v28, v31
    v_and_b32 v28, 0x00010001, v28
    v_cmp_ne_u32_e64 vcc, 0, v28
    s_or_b64 vcc, vcc, s[90:91]
    s_cbranch_vccnz Lspin_24
    v_lshl_add_u32 v28, v20, 16, s83
    v_and_b32 v29, 0xfffe0000, v20
    v_lshl_add_u32 v36, v24, 16, s83
    v_and_b32 v37, 0xfffe0000, v24
    v_pk_add_f32 v[28:29], v[28:29], v[36:37]
    v_lshl_add_u32 v30, v21, 16, s83
    v_and_b32 v31, 0xfffe0000, v21
    v_lshl_add_u32 v38, v25, 16, s83
    v_and_b32 v39, 0xfffe0000, v25
    v_pk_add_f32 v[30:31], v[30:31], v[38:39]
    v_lshl_add_u32 v32, v22, 16, s83
    v_and_b32 v33, 0xfffe0000, v22
    v_lshl_add_u32 v40, v26, 16, s83
    v_and_b32 v41, 0xfffe0000, v26
    v_pk_add_f32 v[32:33], v[32:33], v[40:41]
    v_lshl_add_u32 v34, v23, 16, s83
    v_and_b32 v35, 0xfffe0000, v23
    v_lshl_add_u32 v42, v27, 16, s83
    v_and_b32 v43, 0xfffe0000, v27
    v_pk_add_f32 v[34:35], v[34:35], v[42:43]
    v_permlane32_swap_b32 v28, v32
    v_permlane32_swap_b32 v29, v33
    v_permlane32_swap_b32 v30, v34
    v_permlane32_swap_b32 v31, v35
    v_pk_add_f32 v[28:29], v[28:29], v[32:33]
    v_pk_add_f32 v[30:31], v[30:31], v[34:35]
    s_nop 1
    v_permlane16_swap_b32 v28, v30
    v_permlane16_swap_b32_e64 v29, v31
    v_pk_add_f32 v[28:29], v[28:29], v[30:31]
    s_nop 1
    v_add_f32_dpp v28, v28, v28 row_ror:8 row_mask:0xf bank_mask:0xf
    v_add_f32_dpp v29, v29, v29 row_ror:8 row_mask:0xf bank_mask:0xf
    v_cvt_pk_bf16_f32 v36, v28, v29
    s_mov_b32 exec_lo, 0x00ff00ff
    s_mov_b32 exec_hi, 0x00ff00ff
    s_bitcmp1_b32 s99, 0
    s_cbranch_scc1 Lls_26
    buffer_store_dword v36, v57, s[36:39], s81 offen sc1
    s_branch Lle_27
Lls_26:
    buffer_store_dword v36, v57, s[36:39], s81 offen
Lle_27:
    s_mov_b64 exec, -1
    v_lshlrev_b32 v28, 16, v16
    v_and_b32 v29, 0xffff0000, v16
    v_lshlrev_b32_e64 v30, 16, v17
    v_and_b32 v31, 0xffff0000, v17
    v_lshlrev_b32_e64 v32, 16, v18
    v_and_b32 v33, 0xffff0000, v18
    v_lshlrev_b32_e64 v34, 16, v19
    v_and_b32 v35, 0xffff0000, v19
    v_permlane32_swap_b32 v28, v32
    v_permlane32_swap_b32 v29, v33
    v_permlane32_swap_b32 v30, v34
    v_permlane32_swap_b32 v31, v35
    v_pk_add_f32 v[28:29], v[28:29], v[32:33]
    v_pk_add_f32 v[30:31], v[30:31], v[34:35]
    s_nop 1
    v_permlane16_swap_b32 v28, v30
    v_permlane16_swap_b32_e64 v29, v31
    v_pk_add_f32 v[28:29], v[28:29], v[30:31]
    s_nop 1
    v_add_f32_dpp v38, v28, v28 row_ror:8 row_mask:0xf bank_mask:0x3
    s_nop 1
    v_add_f32_dpp v38, v29, v29 row_ror:8 row_mask:0xf bank_mask:0xc
    s_nop 1
    v_add_f32_dpp v37, v38, v38 row_shr:4 row_mask:0xf bank_mask:0xf
    v_cvt_pk_bf16_f32 v37, v37, v37
    s_mov_b32 exec_lo, 0xf0f0f0f0
    s_mov_b32 exec_hi, 0xf0f0f0f0
    ds_write_b16 v59, v37
    s_mov_b64 exec, -1
    s_waitcnt lgkmcnt(0)
    s_barrier
    s_sleep 4
    v_lshlrev_b32_e64 v4, 4, v2
    s_lshl_b32 s78, s76, 10
    s_add_u32 s78, s78, 110592
    v_add_u32 v5, s78, v4
    s_lshl_b32 s78, s76, 12
    s_add_u32 s78, s78, 131072
    v_add_u32_e64 v6, s78, v4
    ds_write_b128 v5, v[160:163] offset:16384
    ds_write_b128 v5, v[164:167] offset:12288
    ds_write_b128 v5, v[168:171] offset:8192
    ds_write_b128 v5, v[172:175] offset:4096
    ds_write_b128 v5, v[176:179] offset:0
    ds_write_b128 v6, v[180:183] offset:0
    ds_write_b128 v6, v[184:187] offset:1024
    ds_write_b128 v6, v[188:191] offset:2048
    ds_write_b128 v6, v[192:195] offset:3072
    s_waitcnt lgkmcnt(0)
    s_barrier
    s_mov_b32 s100, 50176
    buffer_load_dwordx4 v[92:95], v244, s[48:51], s100 offen nt
    s_mov_b32 s100, 50176
    buffer_load_dwordx4 v[124:127], v244, s[52:55], s100 offen nt
    s_mov_b32 s100, 0
    buffer_load_dwordx4 v[128:131], v245, s[56:59], s100 offen nt
    s_mov_b32 s100, 2048
    buffer_load_dwordx4 v[132:135], v245, s[56:59], s100 offen nt
    s_lshl_b32 s100, s77, 9
    s_add_u32 s100, s100, 8912896
    v_mov_b32 v48, s75
    v_mov_b32 v49, s75
    v_lshl_add_u32 v50, v2, 3, s100
    s_barrier
    s_cmp_lg_u32 s76, 0
    s_cbranch_scc1 Lfs_28
    buffer_store_dwordx2 v[48:49], v50, s[36:39], 0 offen sc1
Lfs_28:
    s_lshl_b32 s83, s71, 4
    s_add_u32 s83, s83, s72
    s_lshl_b32 s78, s0, 11
    s_and_b32 s79, s76, 1
    s_lshl_b32 s79, s79, 10
    s_add_u32 s78, s78, s79
    s_add_u32 s78, s78, 655360
    s_mul_i32 s79, s74, 56
    s_add_u32 s79, s79, s73
    s_lshl_b32 s79, s79, 10
    s_add_u32 s79, s79, 1114112
    s_cmp_eq_u32 s76, 1
    s_cselect_b32 s78, s79, s78
    s_cmp_ge_u32 s73, 56
    s_cselect_b32 s78, 0x10000000, s78
    s_lshl_b32 s79, s83, 9
    s_add_u32 s79, s79, 524288
    s_cmp_eq_u32 s76, 0
    s_cselect_b32 s78, s79, s78
    s_cselect_b32 s79, 0, -1
    v_mov_b32 v56, -1
    v_mov_b32 v57, -1
    v_mov_b32 v58, -1
    v_mov_b32 v59, -1
    s_mov_b32 exec_hi, s79
    buffer_store_dwordx4 v[56:59], v4, s[36:39], s78 offen sc1
    s_mov_b32 exec_hi, -1
    s_lshl_b32 s79, s83, 11
    s_add_u32 s79, s79, s84
    s_add_u32 s79, s79, 1572864
    s_cmp_lt_u32 s76, 2
    s_cselect_b32 s94, s79, s78
    s_cmp_lg_u32 s76, 2
    s_cbranch_scc1 Lf2_29
    s_mov_b64 exec, 0xffff
    s_mov_b32 s85, 1
    s_mov_b32 s101, 0
    s_sleep 14
    s_branch Lb_31
Lspin_30:
    s_add_u32 s85, s85, 1
    s_cmp_gt_u32 s85, 400000
    s_cbranch_scc1 L_end
    s_add_u32 s101, s101, 128
    s_min_u32 s101, s101, 384
Lb_31:
    buffer_load_dword v52, v61, s[36:39], s101 offen sc1
    s_waitcnt vmcnt(0)
    v_cmp_ne_u32_e64 vcc, s75, v52
    s_cbranch_vccnz Lspin_30
    s_mov_b64 exec, -1
Lf2_29:
    s_barrier
    s_waitcnt vmcnt(0)
    s_mov_b32 s100, 0x05040100
    s_mov_b32 s101, 0x07060302
    v_perm_b32 v7, v68, v64, s100
    v_perm_b32 v68, v68, v64, s101
    v_mov_b32_e64 v64, v7
    v_perm_b32 v7, v69, v65, s100
    v_perm_b32 v69, v69, v65, s101
    v_mov_b32_e64 v65, v7
    v_perm_b32 v7, v70, v66, s100
    v_perm_b32 v70, v70, v66, s101
    v_mov_b32_e64 v66, v7
    v_perm_b32 v7, v71, v67, s100
    v_perm_b32 v71, v71, v67, s101
    v_mov_b32_e64 v67, v7
    v_perm_b32 v7, v100, v96, s100
    v_perm_b32 v100, v100, v96, s101
    v_mov_b32_e64 v96, v7
    v_perm_b32 v7, v101, v97, s100
    v_perm_b32 v101, v101, v97, s101
    v_mov_b32_e64 v97, v7
    v_perm_b32 v7, v102, v98, s100
    v_perm_b32 v102, v102, v98, s101
    v_mov_b32_e64 v98, v7
    v_perm_b32 v7, v103, v99, s100
    v_perm_b32 v103, v103, v99, s101
    v_mov_b32_e64 v99, v7
    v_perm_b32 v7, v76, v72, s100
    v_perm_b32 v76, v76, v72, s101
    v_mov_b32_e64 v72, v7
    v_perm_b32 v7, v77, v73, s100
    v_perm_b32 v77, v77, v73, s101
    v_mov_b32_e64 v73, v7
    v_perm_b32 v7, v78, v74, s100
    v_perm_b32 v78, v78, v74, s101
    v_mov_b32_e64 v74, v7
    v_perm_b32 v7, v79, v75, s100
    v_perm_b32 v79, v79, v75, s101
    v_mov_b32_e64 v75, v7
    v_perm_b32 v7, v108, v104, s100
    v_perm_b32 v108, v108, v104, s101
    v_mov_b32_e64 v104, v7
    v_perm_b32 v7, v109, v105, s100
    v_perm_b32 v109, v109, v105, s101
    v_mov_b32_e64 v105, v7
    v_perm_b32 v7, v110, v106, s100
    v_perm_b32 v110, v110, v106, s101
    v_mov_b32_e64 v106, v7
    v_perm_b32 v7, v111, v107, s100
    v_perm_b32 v111, v111, v107, s101
    v_mov_b32_e64 v107, v7
    v_perm_b32 v7, v84, v80, s100
    v_perm_b32 v84, v84, v80, s101
    v_mov_b32_e64 v80, v7
    v_perm_b32 v7, v85, v81, s100
    v_perm_b32 v85, v85, v81, s101
    v_mov_b32_e64 v81, v7
    v_perm_b32 v7, v86, v82, s100
    v_perm_b32 v86, v86, v82, s101
    v_mov_b32_e64 v82, v7
    v_perm_b32 v7, v87, v83, s100
    v_perm_b32 v87, v87, v83, s101
    v_mov_b32_e64 v83, v7
    v_perm_b32 v7, v116, v112, s100
    v_perm_b32 v116, v116, v112, s101
    v_mov_b32_e64 v112, v7
    v_perm_b32 v7, v117, v113, s100
    v_perm_b32 v117, v117, v113, s101
    v_mov_b32_e64 v113, v7
    v_perm_b32 v7, v118, v114, s100
    v_perm_b32 v118, v118, v114, s101
    v_mov_b32_e64 v114, v7
    v_perm_b32 v7, v119, v115, s100
    v_perm_b32 v119, v119, v115, s101
    v_mov_b32_e64 v115, v7
    v_perm_b32 v7, v92, v88, s100
    v_perm_b32 v92, v92, v88, s101
    v_mov_b32_e64 v88, v7
    v_perm_b32 v7, v93, v89, s100
    v_perm_b32 v93, v93, v89, s101
    v_mov_b32_e64 v89, v7
    v_perm_b32 v7, v94, v90, s100
    v_perm_b32 v94, v94, v90, s101
    v_mov_b32_e64 v90, v7
    v_perm_b32 v7, v95, v91, s100
    v_perm_b32 v95, v95, v91, s101
    v_mov_b32_e64 v91, v7
    v_perm_b32 v7, v124, v120, s100
    v_perm_b32 v124, v124, v120, s101
    v_mov_b32_e64 v120, v7
    v_perm_b32 v7, v125, v121, s100
    v_perm_b32 v125, v125, v121, s101
    v_mov_b32_e64 v121, v7
    v_perm_b32 v7, v126, v122, s100
    v_perm_b32 v126, v126, v122, s101
    v_mov_b32_e64 v122, v7
    v_perm_b32 v7, v127, v123, s100
    v_perm_b32 v127, v127, v123, s101
    v_mov_b32_e64 v123, v7
    v_perm_b32 v7, v132, v128, s100
    v_perm_b32 v132, v132, v128, s101
    v_mov_b32_e64 v128, v7
    v_perm_b32 v7, v133, v129, s100
    v_perm_b32 v133, v133, v129, s101
    v_mov_b32_e64 v129, v7
    v_perm_b32 v7, v134, v130, s100
    v_perm_b32 v134, v134, v130, s101
    v_mov_b32_e64 v130, v7
    v_perm_b32 v7, v135, v131, s100
    v_perm_b32 v135, v135, v131, s101
    v_mov_b32 v131, v7
    v_lshrrev_b32 v8, 3, v2
    v_and_b32 v9, 7, v2
    v_lshlrev_b32 v10, 4, v9
    v_lshl_add_u32 v11, v8, 13, v10
    v_and_b32 v12, 15, v2
    v_lshlrev_b32 v12, 13, v12
    v_lshl_add_u32 v13, v8, 9, v10
    v_lshl_add_u32 v14, v9, 3, v8
    s_lshl_b32 s80, s74, 2
    s_add_u32 s80, s80, s76
    s_lshl_b32 s78, s80, 9
    s_add_u32 s78, s78, 524288
    s_add_u32 s79, s78, 65536
    s_add_u32 s81, s73, s76
    s_and_b32 s81, s81, 3
    s_andn2_b32 s100, s73, 3
    s_or_b32 s81, s81, s100
    s_lshl_b32 s81, s81, 13
    s_lshl_b32 s80, s80, 9
    s_add_u32 s80, s80, s81
    s_add_u32 s80, s80, 655360
    s_lshl_b32 s81, s73, 13
    s_add_u32 s81, s81, 655360
    s_barrier
    buffer_load_dwordx4 v[56:59], v4, s[36:39], s94 offen sc1
    s_mov_b32 s100, 4096
    buffer_load_dwordx4 v[136:139], v245, s[56:59], s100 offen nt
    s_mov_b32 s100, 6144
    buffer_load_dwordx4 v[140:143], v245, s[56:59], s100 offen nt
    s_mov_b32 s100, 8192
    buffer_load_dwordx4 v[144:147], v245, s[56:59], s100 offen nt
    s_mov_b32 s100, 10240
    buffer_load_dwordx4 v[148:151], v245, s[56:59], s100 offen nt
    s_barrier
    s_waitcnt vmcnt(0)
    s_mov_b32 s100, 0x05040100
    s_mov_b32 s101, 0x07060302
    v_perm_b32 v7, v140, v136, s100
    v_perm_b32 v140, v140, v136, s101
    v_mov_b32_e64 v136, v7
    v_perm_b32 v7, v141, v137, s100
    v_perm_b32 v141, v141, v137, s101
    v_mov_b32_e64 v137, v7
    v_perm_b32 v7, v142, v138, s100
    v_perm_b32 v142, v142, v138, s101
    v_mov_b32_e64 v138, v7
    v_perm_b32 v7, v143, v139, s100
    v_perm_b32 v143, v143, v139, s101
    v_mov_b32_e64 v139, v7
    v_perm_b32 v7, v148, v144, s100
    v_perm_b32 v148, v148, v144, s101
    v_mov_b32_e64 v144, v7
    v_perm_b32 v7, v149, v145, s100
    v_perm_b32 v149, v149, v145, s101
    v_mov_b32_e64 v145, v7
    v_perm_b32 v7, v150, v146, s100
    v_perm_b32 v150, v150, v146, s101
    v_mov_b32_e64 v146, v7
    v_perm_b32 v7, v151, v147, s100
    v_perm_b32 v151, v151, v147, s101
    v_mov_b32 v147, v7
    s_barrier
    s_mov_b32 s100, 12288
    buffer_load_dwordx4 v[152:155], v245, s[56:59], s100 offen nt
    s_mov_b32 s100, 14336
    buffer_load_dwordx4 v[156:159], v245, s[56:59], s100 offen nt
    s_and_b32 s79, s2, 7
    s_lshl_b32 s79, s79, 9
    s_add_u32 s79, s79, 524288
    s_mov_b64 exec, 0xffff
    s_mov_b32 s85, 1
    s_sleep 16
    s_branch Lb_33
Lspin_32:
    s_add_u32 s85, s85, 1
    s_cmp_gt_u32 s85, 400000
    s_cbranch_scc1 L_end
    s_or_b32 s79, s79, 4096
Lb_33:
    buffer_load_dwordx2 v[24:25], v12, s[36:39], s79 offen offset:128 sc1
    s_waitcnt vmcnt(0)
    v_cmp_ne_u32 vcc, s75, v25
    s_cbranch_vccnz Lspin_32
    v_max_f32_dpp v24, v24, v24 row_ror:8 row_mask:0xf bank_mask:0xf
    s_nop 1
    v_max_f32_dpp v24, v24, v24 row_ror:4 row_mask:0xf bank_mask:0xf
    s_nop 1
    v_max_f32_dpp v24, v24, v24 row_ror:2 row_mask:0xf bank_mask:0xf
    s_nop 1
    v_max_f32_dpp v24, v24, v24 row_ror:1 row_mask:0xf bank_mask:0xf
    s_nop 0
    v_readfirstlane_b32 s97, v24
    s_mov_b64 exec, -1
    s_nop 0
    v_mov_b32 v24, s97
    s_cmp_ge_u32 s73, 56
    s_cbranch_scc1 L_red
    s_bfe_u32 s79, s97, 0x40007
    s_lshl_b32 s79, s79, 13
    s_add_u32 s78, s78, s79
    v_lshlrev_b32_e64 v25, 4, v8
    s_mov_b32 s85, 0
Lspin_34:
    s_add_u32 s85, s85, 1
    s_cmp_gt_u32 s85, 400000
    s_cbranch_scc1 L_end
    buffer_load_dwordx4 v[20:23], v25, s[36:39], s78 offen sc1
    v_mov_b32 v26, 163360
    ds_write_b32 v26, v24
    v_lshlrev_b32_e64 v15, 3, v14
    s_waitcnt vmcnt(0) lgkmcnt(0)
    v_max3_u32 v16, v20, v21, v22
    v_max_u32 v16, v16, v23
    v_cmp_eq_u32_e64 vcc, -1, v16
    s_cbranch_vccnz Lspin_34
    v_dot2_f32_bf16 v28, v64, v20, 0
    v_dot2_f32_bf16 v29, v68, v20, 0
    v_dot2_f32_bf16 v30, v65, v20, 0
    v_dot2_f32_bf16 v31, v69, v20, 0
    v_dot2_f32_bf16 v32, v66, v20, 0
    v_dot2_f32_bf16 v33, v70, v20, 0
    v_dot2_f32_bf16 v34, v67, v20, 0
    v_dot2_f32_bf16 v35, v71, v20, 0
    v_dot2_f32_bf16 v28, v72, v21, v28
    v_dot2_f32_bf16 v29, v76, v21, v29
    v_dot2_f32_bf16 v30, v73, v21, v30
    v_dot2_f32_bf16 v31, v77, v21, v31
    v_dot2_f32_bf16 v32, v74, v21, v32
    v_dot2_f32_bf16 v33, v78, v21, v33
    v_dot2_f32_bf16 v34, v75, v21, v34
    v_dot2_f32_bf16 v35, v79, v21, v35
    v_dot2_f32_bf16 v28, v80, v22, v28
    v_dot2_f32_bf16 v29, v84, v22, v29
    v_dot2_f32_bf16 v30, v81, v22, v30
    v_dot2_f32_bf16 v31, v85, v22, v31
    v_dot2_f32_bf16 v32, v82, v22, v32
    v_dot2_f32_bf16 v33, v86, v22, v33
    v_dot2_f32_bf16 v34, v83, v22, v34
    v_dot2_f32_bf16 v35, v87, v22, v35
    v_dot2_f32_bf16 v28, v88, v23, v28
    v_dot2_f32_bf16 v29, v92, v23, v29
    v_dot2_f32_bf16 v30, v89, v23, v30
    v_dot2_f32_bf16 v31, v93, v23, v31
    v_dot2_f32_bf16 v32, v90, v23, v32
    v_dot2_f32_bf16 v33, v94, v23, v33
    v_dot2_f32_bf16 v34, v91, v23, v34
    v_dot2_f32_bf16 v35, v95, v23, v35
    v_dot2_f32_bf16 v36, v96, v20, 0
    v_dot2_f32_bf16 v37, v100, v20, 0
    v_dot2_f32_bf16 v38, v97, v20, 0
    v_dot2_f32_bf16 v39, v101, v20, 0
    v_dot2_f32_bf16 v40, v98, v20, 0
    v_dot2_f32_bf16 v41, v102, v20, 0
    v_dot2_f32_bf16 v42, v99, v20, 0
    v_dot2_f32_bf16 v43, v103, v20, 0
    v_dot2_f32_bf16 v36, v104, v21, v36
    v_dot2_f32_bf16 v37, v108, v21, v37
    v_dot2_f32_bf16 v38, v105, v21, v38
    v_dot2_f32_bf16 v39, v109, v21, v39
    v_dot2_f32_bf16 v40, v106, v21, v40
    v_dot2_f32_bf16 v41, v110, v21, v41
    v_dot2_f32_bf16 v42, v107, v21, v42
    v_dot2_f32_bf16 v43, v111, v21, v43
    v_dot2_f32_bf16 v36, v112, v22, v36
    v_dot2_f32_bf16 v37, v116, v22, v37
    v_dot2_f32_bf16 v38, v113, v22, v38
    v_dot2_f32_bf16 v39, v117, v22, v39
    v_dot2_f32_bf16 v40, v114, v22, v40
    v_dot2_f32_bf16 v41, v118, v22, v41
    v_dot2_f32_bf16 v42, v115, v22, v42
    v_dot2_f32_bf16 v43, v119, v22, v43
    v_dot2_f32_bf16 v36, v120, v23, v36
    v_dot2_f32_bf16 v37, v124, v23, v37
    v_dot2_f32_bf16 v38, v121, v23, v38
    v_dot2_f32_bf16 v39, v125, v23, v39
    v_dot2_f32_bf16 v40, v122, v23, v40
    v_dot2_f32_bf16 v41, v126, v23, v41
    v_dot2_f32_bf16 v42, v123, v23, v42
    v_dot2_f32_bf16 v43, v127, v23, v43
    v_permlane32_swap_b32 v28, v32
    v_permlane32_swap_b32 v29, v33
    v_permlane32_swap_b32 v30, v34
    v_permlane32_swap_b32 v31, v35
    v_pk_add_f32 v[28:29], v[28:29], v[32:33]
    v_pk_add_f32 v[30:31], v[30:31], v[34:35]
    s_nop 1
    v_permlane16_swap_b32 v28, v30
    v_permlane16_swap_b32_e64 v29, v31
    v_pk_add_f32 v[28:29], v[28:29], v[30:31]
    s_nop 1
    v_add_f32_dpp v44, v28, v28 row_ror:8 row_mask:0xf bank_mask:0x3
    s_nop 1
    v_add_f32_dpp v44, v29, v29 row_ror:8 row_mask:0xf bank_mask:0xc
    v_permlane32_swap_b32 v36, v40
    v_permlane32_swap_b32 v37, v41
    v_permlane32_swap_b32 v38, v42
    v_permlane32_swap_b32 v39, v43
    v_pk_add_f32 v[36:37], v[36:37], v[40:41]
    v_pk_add_f32 v[38:39], v[38:39], v[42:43]
    s_nop 1
    v_permlane16_swap_b32 v36, v38
    v_permlane16_swap_b32_e64 v37, v39
    v_pk_add_f32 v[36:37], v[36:37], v[38:39]
    s_nop 1
    v_add_f32_dpp v45, v36, v36 row_ror:8 row_mask:0xf bank_mask:0x3
    s_nop 1
    v_add_f32_dpp v45, v37, v37 row_ror:8 row_mask:0xf bank_mask:0xc
    s_bitcmp1_b32 s99, 0
    s_cbranch_scc1 Lls_35
    buffer_store_dwordx2 v[44:45], v15, s[36:39], s80 offen sc1
    s_branch Lle_36
Lls_35:
    buffer_store_dwordx2 v[44:45], v15, s[36:39], s80 offen
Lle_36:
    s_mov_b32 s95, s80
    s_barrier
    s_lshl_b32 s78, s76, 7
    s_add_u32 s78, s78, s81
    s_add_u32 s79, s78, 4096
    v_lshrrev_b32 v26, 5, v2
    v_lshl_add_u32 v26, v9, 1, v26
    s_lshl_b32 s80, s76, 5
    s_add_u32 s80, s80, 163456
    v_lshl_add_u32 v26, v26, 1, s80
    v_lshlrev_b32 v27, 4, v8
    v_add_u32 v27, 163456, v27
    v_lshlrev_b32 v15, 2, v14
    s_mul_i32 s80, s74, 56
    s_add_u32 s80, s80, s73
    s_lshl_b32 s80, s80, 10
    s_lshl_b32 s82, s76, 8
    s_add_u32 s80, s80, s82
    s_add_u32 s80, s80, 1114112
    s_waitcnt vmcnt(0)
    s_mov_b32 s100, 0x05040100
    s_mov_b32 s101, 0x07060302
    v_perm_b32 v7, v156, v152, s100
    v_perm_b32 v156, v156, v152, s101
    v_mov_b32 v152, v7
    v_perm_b32 v7, v157, v153, s100
    v_perm_b32 v157, v157, v153, s101
    v_mov_b32_e64 v153, v7
    v_perm_b32 v7, v158, v154, s100
    v_perm_b32 v158, v158, v154, s101
    v_mov_b32_e64 v154, v7
    v_perm_b32 v7, v159, v155, s100
    v_perm_b32 v159, v159, v155, s101
    v_mov_b32_e64 v155, v7
    s_mov_b32 s85, 0
Lspin_37:
    s_add_u32 s85, s85, 1
    s_cmp_gt_u32 s85, 400000
    s_cbranch_scc1 L_end
    buffer_load_dwordx4 v[16:19], v13, s[36:39], s78 offen sc1
    buffer_load_dwordx4 v[20:23], v13, s[36:39], s79 offen sc1
    s_waitcnt vmcnt(0)
    v_max3_u32 v25, v16, v18, v20
    v_max_u32 v25, v25, v22
    v_cmp_eq_u32_e64 vcc, -1, v25
    s_cbranch_vccnz Lspin_37
    v_pk_add_f32 v[16:17], v[16:17], v[20:21]
    v_pk_add_f32 v[18:19], v[18:19], v[22:23]
    s_nop 1
    v_permlane32_swap_b32 v16, v18
    v_permlane32_swap_b32_e64 v17, v19
    v_pk_add_f32 v[16:17], v[16:17], v[18:19]
    v_mov_b32 v18, v16
    v_mov_b32 v19, v17
    s_nop 0
    v_permlane16_swap_b32 v16, v18
    v_permlane16_swap_b32_e64 v17, v19
    v_pk_add_f32 v[16:17], v[16:17], v[18:19]
    s_nop 1
    s_nop 0
    v_add_f32_dpp v16, v16, v16 row_ror:8 row_mask:0xf bank_mask:0xf
    v_add_f32_dpp v17, v17, v17 row_ror:8 row_mask:0xf bank_mask:0xf
    v_cvt_pk_bf16_f32 v16, v16, v16
    v_and_b32 v16, 0xffff0000, v16
    v_cvt_pk_bf16_f32 v17, v17, v17
    v_and_b32 v17, 0xffff0000, v17
    v_mul_f32 v18, 0xbfb8aa3b, v16
    v_exp_f32 v18, v18
    s_nop 0
    v_add_f32 v18, 1.0, v18
    v_rcp_f32 v18, v18
    s_nop 0
    v_mul_f32 v16, v16, v18
    v_cvt_pk_bf16_f32 v16, v16, v16
    v_and_b32 v16, 0xffff0000, v16
    v_mul_f32_e64 v16, v16, v17
    v_cvt_pk_bf16_f32 v16, v16, v16
    ds_write_b16 v26, v16
    s_waitcnt lgkmcnt(0)
    s_barrier
    ds_read_b128 v[20:23], v27
    s_waitcnt lgkmcnt(0)
    s_nop 0
    v_dot2_f32_bf16 v28, v128, v20, 0
    v_dot2_f32_bf16 v29, v132, v20, 0
    v_dot2_f32_bf16 v30, v129, v20, 0
    v_dot2_f32_bf16 v31, v133, v20, 0
    v_dot2_f32_bf16 v32, v130, v20, 0
    v_dot2_f32_bf16 v33, v134, v20, 0
    v_dot2_f32_bf16 v34, v131, v20, 0
    v_dot2_f32_bf16 v35, v135, v20, 0
    v_dot2_f32_bf16 v28, v136, v21, v28
    v_dot2_f32_bf16 v29, v140, v21, v29
    v_dot2_f32_bf16 v30, v137, v21, v30
    v_dot2_f32_bf16 v31, v141, v21, v31
    v_dot2_f32_bf16 v32, v138, v21, v32
    v_dot2_f32_bf16 v33, v142, v21, v33
    v_dot2_f32_bf16 v34, v139, v21, v34
    v_dot2_f32_bf16 v35, v143, v21, v35
    v_dot2_f32_bf16 v28, v144, v22, v28
    v_dot2_f32_bf16 v29, v148, v22, v29
    v_dot2_f32_bf16 v30, v145, v22, v30
    v_dot2_f32_bf16 v31, v149, v22, v31
    v_dot2_f32_bf16 v32, v146, v22, v32
    v_dot2_f32_bf16 v33, v150, v22, v33
    v_dot2_f32_bf16 v34, v147, v22, v34
    v_dot2_f32_bf16 v35, v151, v22, v35
    v_dot2_f32_bf16 v28, v152, v23, v28
    v_dot2_f32_bf16 v29, v156, v23, v29
    v_dot2_f32_bf16 v30, v153, v23, v30
    v_dot2_f32_bf16 v31, v157, v23, v31
    v_dot2_f32_bf16 v32, v154, v23, v32
    v_dot2_f32_bf16 v33, v158, v23, v33
    v_dot2_f32_bf16 v34, v155, v23, v34
    v_dot2_f32_bf16 v35, v159, v23, v35
    v_permlane32_swap_b32 v28, v32
    v_permlane32_swap_b32 v29, v33
    v_permlane32_swap_b32 v30, v34
    v_permlane32_swap_b32 v31, v35
    v_pk_add_f32 v[28:29], v[28:29], v[32:33]
    v_pk_add_f32 v[30:31], v[30:31], v[34:35]
    s_nop 1
    v_permlane16_swap_b32 v28, v30
    v_permlane16_swap_b32_e64 v29, v31
    v_pk_add_f32 v[28:29], v[28:29], v[30:31]
    s_nop 1
    v_add_f32_dpp v46, v28, v28 row_ror:8 row_mask:0xf bank_mask:0x3
    s_nop 1
    v_add_f32_dpp v46, v29, v29 row_ror:8 row_mask:0xf bank_mask:0xc
    buffer_store_dword v46, v15, s[36:39], s80 offen sc1
    s_barrier
    s_branch L_fin
L_red:
    v_mov_b32 v26, 163360
    ds_write_b32 v26, v24
    s_waitcnt lgkmcnt(0)
    s_barrier
    s_barrier
    s_barrier
    s_cmp_lg_u32 s76, 0
    s_cbranch_scc1 L_fin
    s_sub_u32 s83, s0, 224
    v_lshrrev_b32_e64 v14, 4, v2
    v_lshl_add_u32 v14, v9, 2, v14
    v_lshlrev_b32 v15, 2, v14
    v_lshlrev_b32 v14, 1, v14
    s_bfe_u32 s78, s97, 0x40007
    s_lshl_b32 s78, s78, 13
    s_lshr_b32 s79, s83, 1
    s_lshl_b32 s79, s79, 9
    s_add_u32 s78, s78, s79
    s_and_b32 s79, s83, 1
    s_lshl_b32 s79, s79, 7
    s_add_u32 s78, s78, s79
    s_add_u32 s78, s78, 524544
    s_mov_b32 s85, 0
Lspin_38:
    s_add_u32 s85, s85, 1
    s_cmp_gt_u32 s85, 400000
    s_cbranch_scc1 L_end
    buffer_load_dword v46, v15, s[36:39], s78 offen sc1
    s_waitcnt vmcnt(0)
    v_cmp_eq_u32_e64 vcc, -1, v46
    s_cbranch_vccnz Lspin_38
    v_cvt_pk_bf16_f32 v47, v24, v24
    v_and_b32 v47, 0xffff0000, v47
    v_mul_f32 v47, 0xbfb8aa3b, v47
    v_exp_f32 v47, v47
    s_nop 0
    v_add_f32 v47, 1.0, v47
    v_rcp_f32_e64 v47, v47
    s_nop 0
    v_cvt_pk_bf16_f32 v47, v47, v47
    v_and_b32 v47, 0xffff0000, v47
    v_lshl_add_u32 v13, v8, 10, v10
    s_lshr_b32 s78, s83, 3
    s_mul_i32 s78, s78, 57344
    s_and_b32 s79, s83, 7
    s_lshl_b32 s79, s79, 7
    s_add_u32 s78, s78, s79
    s_add_u32 s78, s78, 1114112
    s_and_b32 s80, s97, 0x7ff
    s_lshl_b32 s80, s80, 11
    s_lshl_b32 s79, s83, 6
    s_add_u32 s80, s80, s79
    s_sleep 28
    s_mov_b32 s85, 0
Lspin_39:
    s_add_u32 s85, s85, 1
    s_cmp_gt_u32 s85, 400000
    s_cbranch_scc1 L_end
    s_add_u32 s79, s78, 0
    buffer_load_dwordx4 v[16:19], v13, s[36:39], s79 offen sc1
    s_add_u32 s79, s78, 8192
    buffer_load_dwordx4 v[20:23], v13, s[36:39], s79 offen sc1
    s_add_u32 s79, s78, 16384
    buffer_load_dwordx4 v[24:27], v13, s[36:39], s79 offen sc1
    s_add_u32 s79, s78, 24576
    buffer_load_dwordx4 v[28:31], v13, s[36:39], s79 offen sc1
    s_add_u32 s79, s78, 32768
    buffer_load_dwordx4 v[32:35], v13, s[36:39], s79 offen sc1
    s_add_u32 s79, s78, 40960
    buffer_load_dwordx4 v[36:39], v13, s[36:39], s79 offen sc1
    s_add_u32 s79, s78, 49152
    buffer_load_dwordx4 v[40:43], v13, s[36:39], s79 offen sc1
    s_waitcnt vmcnt(0)
    v_max_u32 v48, v16, v17
    v_max_u32_e64 v49, v18, v19
    v_max3_u32 v48, v48, v20, v21
    v_max3_u32 v49, v49, v22, v23
    v_max3_u32 v48, v48, v24, v25
    v_max3_u32 v49, v49, v26, v27
    v_max3_u32 v48, v48, v28, v29
    v_max3_u32 v49, v49, v30, v31
    v_max3_u32 v48, v48, v32, v33
    v_max3_u32 v49, v49, v34, v35
    v_max3_u32 v48, v48, v36, v37
    v_max3_u32 v49, v49, v38, v39
    v_max3_u32 v48, v48, v40, v41
    v_max3_u32 v49, v49, v42, v43
    v_max_u32 v48, v48, v49
    v_cmp_eq_u32_e64 vcc, -1, v48
    s_cbranch_vccnz Lspin_39
    v_pk_add_f32 v[16:17], v[16:17], v[20:21]
    v_pk_add_f32 v[24:25], v[24:25], v[28:29]
    v_pk_add_f32 v[32:33], v[32:33], v[36:37]
    v_pk_add_f32 v[16:17], v[16:17], v[24:25]
    v_pk_add_f32 v[32:33], v[32:33], v[40:41]
    v_pk_add_f32 v[16:17], v[16:17], v[32:33]
    v_pk_add_f32 v[18:19], v[18:19], v[22:23]
    v_pk_add_f32 v[26:27], v[26:27], v[30:31]
    v_pk_add_f32 v[34:35], v[34:35], v[38:39]
    v_pk_add_f32 v[18:19], v[18:19], v[26:27]
    v_pk_add_f32 v[34:35], v[34:35], v[42:43]
    v_pk_add_f32 v[18:19], v[18:19], v[34:35]
    s_nop 1
    v_permlane32_swap_b32 v16, v18
    v_permlane32_swap_b32_e64 v17, v19
    v_pk_add_f32 v[16:17], v[16:17], v[18:19]
    s_nop 1
    v_permlane16_swap_b32 v16, v17
    v_add_f32 v16, v16, v17
    s_nop 1
    v_add_f32_dpp v16, v16, v16 row_ror:8 row_mask:0xf bank_mask:0xf
    v_cvt_pk_bf16_f32 v16, v16, v16
    v_and_b32 v16, 0xffff0000, v16
    v_mul_f32_e64 v16, v16, v47
    v_cvt_pk_bf16_f32 v16, v16, v16
    v_and_b32 v16, 0xffff0000, v16
    v_add_f32_e64 v16, v16, v46
    v_cvt_pk_bf16_f32 v16, v16, v16
    s_mov_b32 exec_lo, 0x00ff00ff
    s_mov_b32 exec_hi, 0x00ff00ff
    buffer_store_short v16, v14, s[44:47], s80 offen
    s_mov_b64 exec, -1
    s_cmp_lg_u32 s0, 224
    s_cbranch_scc1 Lep_40
    s_cmp_lg_u32 s76, 0
    s_cbranch_scc1 Lep_40
    v_mov_b32 v196, s75
    v_mov_b32_e64 v197, 0
    s_mov_b64 exec, 1
    buffer_store_dword v196, v197, s[36:39], 0 offen sc1
    s_mov_b64 exec, -1
Lep_40:
    s_branch L_fin
    .p2align 3
L_M:
    s_setprio 1
    s_and_b32 s78, s2, 7
    s_lshr_b32 s79, s2, 3
    s_lshl_b32 s71, s78, 1
    s_and_b32 s72, s79, 1
    s_add_u32 s71, s71, s72
    s_lshr_b32 s72, s79, 1
    s_cmp_gt_u32 s70, 3
    s_cselect_b32 s78, 1, 0
    s_cmp_gt_u32 s70, 11
    s_cselect_b32 s78, 2, s78
    s_sub_u32 s78, s70, s78
    s_cmp_eq_u32 s70, 3
    s_cselect_b32 s78, 14, s78
    s_cmp_eq_u32 s70, 11
    s_cselect_b32 s78, 15, s78
    s_lshl_b32 s0, s78, 4
    s_add_u32 s0, s0, s69
    s_lshr_b32 s73, s0, 2
    s_and_b32 s74, s0, 3
    s_lshl_b32 s77, s70, 4
    s_add_u32 s77, s77, s69
    s_and_b32 s80, s76, 1
    s_lshr_b32 s81, s76, 1
    v_and_b32 v8, 15, v2
    v_lshrrev_b32 v9, 4, v2
    v_lshrrev_b32 v10, 1, v8
    s_lshl_b32 s78, s80, 13
    s_add_u32 s78, s78, 118784
    v_lshlrev_b32 v11, 7, v8
    v_add_u32 v11, s78, v11
    v_add_u32 v12, 0, v9
    v_xor_b32 v12, v12, v10
    v_lshl_add_u32 v4, v12, 4, v11
    v_add_u32 v12, 4, v9
    v_xor_b32 v12, v12, v10
    v_lshl_add_u32 v5, v12, 4, v11
    v_bfe_u32 v10, v2, 2, 2
    v_and_b32_e64 v11, 3, v2
    v_lshl_add_u32 v12, v9, 3, v10
    v_lshlrev_b32_e64 v12, 7, v12
    v_lshl_add_u32 v12, v11, 3, v12
    v_add_u32 v12, 135168, v12
    v_lshrrev_b32 v13, 1, v10
    v_and_b32 v14, 1, v9
    v_lshl_add_u32 v13, v14, 1, v13
    s_lshl_b32 s78, s81, 1
    s_add_u32 s79, s78, 0
    v_xor_b32_e64 v14, s79, v13
    v_lshl_add_u32 v6, v14, 5, v12
    s_add_u32 s79, s78, 1
    v_xor_b32 v14, s79, v13
    v_lshl_add_u32 v7, v14, 5, v12
    v_lshrrev_b32_e64 v13, 5, v2
    v_lshl_add_u32 v13, v13, 3, v10
    v_lshlrev_b32 v13, 6, v13
    v_and_b32 v14, 1, v9
    v_lshl_add_u32 v13, v14, 5, v13
    v_lshl_add_u32 v13, v11, 3, v13
    s_lshl_b32 s78, s81, 11
    s_add_u32 s78, s78, 159744
    v_add_u32 v15, s78, v13
    v_mov_b64 v[128:129], 0
    v_mov_b64 v[130:131], 0
    v_mov_b64 v[132:133], 0
    v_mov_b64 v[134:135], 0
    v_mov_b64 v[136:137], 0
    v_mov_b64 v[138:139], 0
    v_mov_b64 v[140:141], 0
    v_mov_b64 v[142:143], 0
    v_mov_b64 v[144:145], 0
    v_mov_b64 v[146:147], 0
    v_mov_b64 v[148:149], 0
    v_mov_b64 v[150:151], 0
    v_mov_b64 v[152:153], 0
    v_mov_b64 v[154:155], 0
    v_mov_b64 v[156:157], 0
    v_mov_b64 v[158:159], 0
    v_mov_b64 v[160:161], 0
    v_mov_b64 v[162:163], 0
    v_mov_b64 v[164:165], 0
    v_mov_b64 v[166:167], 0
    v_mov_b64 v[168:169], 0
    v_mov_b64 v[170:171], 0
    v_mov_b64 v[172:173], 0
    v_mov_b64 v[174:175], 0
    v_mov_b64 v[176:177], 0
    v_mov_b64 v[178:179], 0
    v_mov_b64 v[180:181], 0
    v_mov_b64 v[182:183], 0
    v_mov_b64 v[184:185], 0
    v_mov_b64 v[186:187], 0
    v_mov_b64 v[188:189], 0
    v_mov_b64 v[190:191], 0
    v_mov_b64 v[192:193], 0
    v_mov_b64 v[194:195], 0
    v_mov_b64 v[196:197], 0
    v_mov_b64 v[198:199], 0
    v_mov_b64 v[200:201], 0
    v_mov_b64 v[202:203], 0
    v_mov_b64 v[204:205], 0
    v_mov_b64 v[206:207], 0
    v_mov_b64 v[208:209], 0
    v_mov_b64 v[210:211], 0
    v_mov_b64 v[212:213], 0
    v_mov_b64 v[214:215], 0
    v_mov_b64 v[216:217], 0
    v_mov_b64 v[218:219], 0
    v_mov_b64 v[220:221], 0
    v_mov_b64 v[222:223], 0
    v_mov_b64 v[104:105], 0
    v_mov_b64 v[106:107], 0
    v_mov_b64 v[108:109], 0
    v_mov_b64 v[110:111], 0
    v_and_b32 v14, 31, v2
    v_lshrrev_b32_e64 v13, 5, v2
    s_lshl_b32 s78, s81, 14
    s_lshl_b32 s79, s80, 13
    s_add_u32 s78, s78, s79
    s_add_u32 s78, s78, 110592
    v_lshl_add_u32 v12, v14, 7, s78
    v_and_b32 v14, 7, v14
    v_xor_b32 v14, v14, v13
    v_xor_b32_e64 v13, 0, v14
    v_lshl_add_u32 v112, v13, 4, v12
    v_xor_b32_e64 v13, 2, v14
    v_lshl_add_u32 v113, v13, 4, v12
    v_xor_b32_e64 v13, 4, v14
    v_lshl_add_u32 v114, v13, 4, v12
    v_xor_b32_e64 v13, 6, v14
    v_lshl_add_u32 v115, v13, 4, v12
    s_add_u32 s79, s79, 143360
    v_lshl_add_u32 v12, v8, 7, s79
    s_lshl_b32 s78, s81, 2
    v_add_u32 v14, s78, v9
    v_and_b32 v13, 7, v8
    v_xor_b32 v14, v14, v13
    v_lshl_add_u32 v116, v14, 4, v12
    s_lshl_b32 s78, s80, 6
    v_add_u32 v10, s78, v8
    v_lshlrev_b32_e64 v11, 3, v10
    v_add_u32 v11, 159744, v11
    s_lshl_b32 s79, s81, 5
    v_add_u32 v12, s79, v8
    v_lshlrev_b32_e64 v12, 3, v12
    v_add_u32 v12, 160768, v12
    v_lshlrev_b32_e64 v13, 2, v10
    v_add_u32 v13, 162304, v13
    v_and_b32 v14, 31, v2
    v_add_u32 v14, s78, v14
    v_lshlrev_b32_e64 v14, 2, v14
    v_add_u32 v14, 162304, v14
    s_waitcnt lgkmcnt(0)
    s_load_dword s75, s[26:27], 0
    s_mov_b32 s36, s26
    s_and_b32 s37, s27, 0xffff
    s_mov_b32 s38, 0x10000000
    s_mov_b32 s39, 0x20000
    s_mov_b32 s64, s14
    s_and_b32 s65, s15, 0xffff
    s_mov_b32 s66, 0x800
    s_mov_b32 s67, 0x20000
    s_mov_b32 s44, s22
    s_and_b32 s45, s23, 0xffff
    s_mov_b32 s46, 0x400000
    s_mov_b32 s47, 0x20000
    s_lshl_b32 s78, s72, 7
    buffer_load_dword v118, off, s[64:67], s78
    s_waitcnt lgkmcnt(0)
    s_mul_i32 s75, s75, 0x9E3779B1
    s_add_u32 s75, s75, 0x7F4A7C15
    s_mov_b32 s84, 0
    s_mov_b32 s82, 2
    s_mov_b32 s83, 0xfffec000
    s_barrier
    s_nop 0
    ds_read_b128 v[16:19], v4 offset:0
    ds_read_b64_tr_b16 v[40:41], v6 offset:8192
    ds_read_b64_tr_b16 v[42:43], v6 offset:8704
    ds_read_b128 v[20:23], v4 offset:2048
    ds_read_b128 v[24:27], v4 offset:4096
    ds_read_b128 v[28:31], v4 offset:6144
    ds_read_b64_tr_b16 v[44:45], v7 offset:8192
    ds_read_b64_tr_b16 v[46:47], v7 offset:8704
    ds_read_b64_tr_b16 v[48:49], v6 offset:16384
    ds_read_b64_tr_b16 v[50:51], v6 offset:16896
    ds_read_b64_tr_b16 v[52:53], v7 offset:16384
    ds_read_b64_tr_b16 v[54:55], v7 offset:16896
    ds_read_b64_tr_b16 v[32:33], v6 offset:0
    ds_read_b64_tr_b16 v[34:35], v6 offset:512
    ds_read_b64_tr_b16 v[36:37], v7 offset:0
    ds_read_b64_tr_b16 v[38:39], v7 offset:512
    ds_read_b64_tr_b16 v[96:97], v15 offset:0
    ds_read_b64_tr_b16 v[98:99], v15 offset:1024
    ds_read_b64_tr_b16 v[100:101], v15 offset:256
    ds_read_b64_tr_b16 v[102:103], v15 offset:1280
    s_waitcnt lgkmcnt(0)
    s_nop 0
    v_mfma_f32_16x16x32_bf16 v[160:163], v[40:43], v[16:19], v[160:163]
    v_mfma_f32_16x16x32_bf16 v[176:179], v[44:47], v[16:19], v[176:179]
    v_mfma_f32_16x16x32_bf16 v[180:183], v[44:47], v[20:23], v[180:183]
    v_mfma_f32_16x16x32_bf16 v[164:167], v[40:43], v[20:23], v[164:167]
    v_mfma_f32_16x16x32_bf16 v[168:171], v[40:43], v[24:27], v[168:171]
    v_mfma_f32_16x16x32_bf16 v[184:187], v[44:47], v[24:27], v[184:187]
    v_mfma_f32_16x16x32_bf16 v[188:191], v[44:47], v[28:31], v[188:191]
    v_mfma_f32_16x16x32_bf16 v[172:175], v[40:43], v[28:31], v[172:175]
    v_mfma_f32_16x16x32_bf16 v[204:207], v[48:51], v[28:31], v[204:207]
    v_mfma_f32_16x16x32_bf16 v[220:223], v[52:55], v[28:31], v[220:223]
    v_mfma_f32_16x16x32_bf16 v[216:219], v[52:55], v[24:27], v[216:219]
    v_mfma_f32_16x16x32_bf16 v[200:203], v[48:51], v[24:27], v[200:203]
    v_mfma_f32_16x16x32_bf16 v[196:199], v[48:51], v[20:23], v[196:199]
    v_mfma_f32_16x16x32_bf16 v[212:215], v[52:55], v[20:23], v[212:215]
    v_mfma_f32_16x16x32_bf16 v[208:211], v[52:55], v[16:19], v[208:211]
    v_mfma_f32_16x16x32_bf16 v[192:195], v[48:51], v[16:19], v[192:195]
    v_mfma_f32_16x16x32_bf16 v[128:131], v[32:35], v[16:19], v[128:131]
    v_mfma_f32_16x16x32_bf16 v[144:147], v[36:39], v[16:19], v[144:147]
    v_mfma_f32_16x16x32_bf16 v[148:151], v[36:39], v[20:23], v[148:151]
    v_mfma_f32_16x16x32_bf16 v[132:135], v[32:35], v[20:23], v[132:135]
    v_mfma_f32_16x16x32_bf16 v[136:139], v[32:35], v[24:27], v[136:139]
    v_mfma_f32_16x16x32_bf16 v[152:155], v[36:39], v[24:27], v[152:155]
    v_mfma_f32_16x16x32_bf16 v[156:159], v[36:39], v[28:31], v[156:159]
    v_mfma_f32_16x16x32_bf16 v[140:143], v[32:35], v[28:31], v[140:143]
    ds_read_b128 v[56:59], v5 offset:0
    ds_read_b64_tr_b16 v[80:81], v6 offset:12288
    ds_read_b64_tr_b16 v[82:83], v6 offset:12800
    ds_read_b128 v[60:63], v5 offset:2048
    ds_read_b128 v[64:67], v5 offset:4096
    ds_read_b128 v[68:71], v5 offset:6144
    ds_read_b64_tr_b16 v[84:85], v7 offset:12288
    ds_read_b64_tr_b16 v[86:87], v7 offset:12800
    ds_read_b64_tr_b16 v[88:89], v6 offset:20480
    ds_read_b64_tr_b16 v[90:91], v6 offset:20992
    ds_read_b64_tr_b16 v[92:93], v7 offset:20480
    ds_read_b64_tr_b16 v[94:95], v7 offset:20992
    ds_read_b64_tr_b16 v[72:73], v6 offset:4096
    ds_read_b64_tr_b16 v[74:75], v6 offset:4608
    ds_read_b64_tr_b16 v[76:77], v7 offset:4096
    ds_read_b64_tr_b16 v[78:79], v7 offset:4608
    s_add_u32 s84, s84, 1
    s_cmp_eq_u32 s82, 2
    s_cselect_b32 s78, s83, 40960
    s_cselect_b32 s82, -1, s82
    s_add_u32 s82, s82, 1
    v_add_u32 v4, s78, v4
    v_add_u32 v5, s78, v5
    v_add_u32 v6, s78, v6
    v_add_u32_e64 v7, s78, v7
    s_waitcnt vmcnt(0) lgkmcnt(0)
    v_mfma_f32_16x16x32_bf16 v[160:163], v[80:83], v[56:59], v[160:163]
    v_mfma_f32_16x16x32_bf16 v[176:179], v[84:87], v[56:59], v[176:179]
    v_mfma_f32_16x16x32_bf16 v[180:183], v[84:87], v[60:63], v[180:183]
    v_mfma_f32_16x16x32_bf16 v[164:167], v[80:83], v[60:63], v[164:167]
    v_mfma_f32_16x16x32_bf16 v[168:171], v[80:83], v[64:67], v[168:171]
    v_mfma_f32_16x16x32_bf16 v[184:187], v[84:87], v[64:67], v[184:187]
    v_mfma_f32_16x16x32_bf16 v[188:191], v[84:87], v[68:71], v[188:191]
    v_mfma_f32_16x16x32_bf16 v[172:175], v[80:83], v[68:71], v[172:175]
    v_mfma_f32_16x16x32_bf16 v[204:207], v[88:91], v[68:71], v[204:207]
    v_mfma_f32_16x16x32_bf16 v[220:223], v[92:95], v[68:71], v[220:223]
    v_mfma_f32_16x16x32_bf16 v[216:219], v[92:95], v[64:67], v[216:219]
    v_mfma_f32_16x16x32_bf16 v[200:203], v[88:91], v[64:67], v[200:203]
    v_mfma_f32_16x16x32_bf16 v[196:199], v[88:91], v[60:63], v[196:199]
    v_mfma_f32_16x16x32_bf16 v[212:215], v[92:95], v[60:63], v[212:215]
    v_mfma_f32_16x16x32_bf16 v[208:211], v[92:95], v[56:59], v[208:211]
    v_mfma_f32_16x16x32_bf16 v[192:195], v[88:91], v[56:59], v[192:195]
    v_mfma_f32_16x16x32_bf16 v[128:131], v[72:75], v[56:59], v[128:131]
    v_mfma_f32_16x16x32_bf16 v[144:147], v[76:79], v[56:59], v[144:147]
    v_mfma_f32_16x16x32_bf16 v[148:151], v[76:79], v[60:63], v[148:151]
    v_mfma_f32_16x16x32_bf16 v[132:135], v[72:75], v[60:63], v[132:135]
    v_mfma_f32_16x16x32_bf16 v[136:139], v[72:75], v[64:67], v[136:139]
    v_mfma_f32_16x16x32_bf16 v[152:155], v[76:79], v[64:67], v[152:155]
    v_mfma_f32_16x16x32_bf16 v[156:159], v[76:79], v[68:71], v[156:159]
    v_mfma_f32_16x16x32_bf16 v[140:143], v[72:75], v[68:71], v[140:143]
    s_barrier
    s_nop 0
    ds_read_b128 v[16:19], v4 offset:0
    ds_read_b64_tr_b16 v[40:41], v6 offset:8192
    ds_read_b64_tr_b16 v[42:43], v6 offset:8704
    ds_read_b128 v[20:23], v4 offset:2048
    ds_read_b128 v[24:27], v4 offset:4096
    ds_read_b128 v[28:31], v4 offset:6144
    ds_read_b64_tr_b16 v[44:45], v7 offset:8192
    ds_read_b64_tr_b16 v[46:47], v7 offset:8704
    ds_read_b64_tr_b16 v[48:49], v6 offset:16384
    ds_read_b64_tr_b16 v[50:51], v6 offset:16896
    ds_read_b64_tr_b16 v[52:53], v7 offset:16384
    ds_read_b64_tr_b16 v[54:55], v7 offset:16896
    ds_read_b64_tr_b16 v[32:33], v6 offset:0
    ds_read_b64_tr_b16 v[34:35], v6 offset:512
    ds_read_b64_tr_b16 v[36:37], v7 offset:0
    ds_read_b64_tr_b16 v[38:39], v7 offset:512
    s_waitcnt lgkmcnt(0)
    s_nop 0
    v_mfma_f32_16x16x32_bf16 v[160:163], v[40:43], v[16:19], v[160:163]
    v_mfma_f32_16x16x32_bf16 v[176:179], v[44:47], v[16:19], v[176:179]
    v_mfma_f32_16x16x32_bf16 v[180:183], v[44:47], v[20:23], v[180:183]
    v_mfma_f32_16x16x32_bf16 v[164:167], v[40:43], v[20:23], v[164:167]
    v_mfma_f32_16x16x32_bf16 v[168:171], v[40:43], v[24:27], v[168:171]
    v_mfma_f32_16x16x32_bf16 v[184:187], v[44:47], v[24:27], v[184:187]
    v_mfma_f32_16x16x32_bf16 v[188:191], v[44:47], v[28:31], v[188:191]
    v_mfma_f32_16x16x32_bf16 v[172:175], v[40:43], v[28:31], v[172:175]
    v_mfma_f32_16x16x32_bf16 v[204:207], v[48:51], v[28:31], v[204:207]
    v_mfma_f32_16x16x32_bf16 v[220:223], v[52:55], v[28:31], v[220:223]
    v_mfma_f32_16x16x32_bf16 v[216:219], v[52:55], v[24:27], v[216:219]
    v_mfma_f32_16x16x32_bf16 v[200:203], v[48:51], v[24:27], v[200:203]
    v_mfma_f32_16x16x32_bf16 v[196:199], v[48:51], v[20:23], v[196:199]
    v_mfma_f32_16x16x32_bf16 v[212:215], v[52:55], v[20:23], v[212:215]
    v_mfma_f32_16x16x32_bf16 v[208:211], v[52:55], v[16:19], v[208:211]
    v_mfma_f32_16x16x32_bf16 v[192:195], v[48:51], v[16:19], v[192:195]
    v_mfma_f32_16x16x32_bf16 v[128:131], v[32:35], v[16:19], v[128:131]
    v_mfma_f32_16x16x32_bf16 v[144:147], v[36:39], v[16:19], v[144:147]
    v_mfma_f32_16x16x32_bf16 v[148:151], v[36:39], v[20:23], v[148:151]
    v_mfma_f32_16x16x32_bf16 v[132:135], v[32:35], v[20:23], v[132:135]
    v_mfma_f32_16x16x32_bf16 v[136:139], v[32:35], v[24:27], v[136:139]
    v_mfma_f32_16x16x32_bf16 v[152:155], v[36:39], v[24:27], v[152:155]
    v_mfma_f32_16x16x32_bf16 v[156:159], v[36:39], v[28:31], v[156:159]
    v_mfma_f32_16x16x32_bf16 v[140:143], v[32:35], v[28:31], v[140:143]
    ds_read_b128 v[56:59], v5 offset:0
    ds_read_b64_tr_b16 v[80:81], v6 offset:12288
    ds_read_b64_tr_b16 v[82:83], v6 offset:12800
    ds_read_b128 v[60:63], v5 offset:2048
    ds_read_b128 v[64:67], v5 offset:4096
    ds_read_b128 v[68:71], v5 offset:6144
    ds_read_b64_tr_b16 v[84:85], v7 offset:12288
    ds_read_b64_tr_b16 v[86:87], v7 offset:12800
    ds_read_b64_tr_b16 v[88:89], v6 offset:20480
    ds_read_b64_tr_b16 v[90:91], v6 offset:20992
    ds_read_b64_tr_b16 v[92:93], v7 offset:20480
    ds_read_b64_tr_b16 v[94:95], v7 offset:20992
    ds_read_b64_tr_b16 v[72:73], v6 offset:4096
    ds_read_b64_tr_b16 v[74:75], v6 offset:4608
    ds_read_b64_tr_b16 v[76:77], v7 offset:4096
    ds_read_b64_tr_b16 v[78:79], v7 offset:4608
    s_add_u32 s84, s84, 1
    s_cmp_eq_u32 s82, 2
    s_cselect_b32 s78, s83, 40960
    s_cselect_b32 s82, -1, s82
    s_add_u32 s82, s82, 1
    v_add_u32 v4, s78, v4
    v_add_u32 v5, s78, v5
    v_add_u32 v6, s78, v6
    v_add_u32_e64 v7, s78, v7
    s_waitcnt vmcnt(0) lgkmcnt(0)
    v_mfma_f32_16x16x32_bf16 v[160:163], v[80:83], v[56:59], v[160:163]
    v_mfma_f32_16x16x32_bf16 v[176:179], v[84:87], v[56:59], v[176:179]
    v_mfma_f32_16x16x32_bf16 v[180:183], v[84:87], v[60:63], v[180:183]
    v_mfma_f32_16x16x32_bf16 v[164:167], v[80:83], v[60:63], v[164:167]
    v_mfma_f32_16x16x32_bf16 v[168:171], v[80:83], v[64:67], v[168:171]
    v_mfma_f32_16x16x32_bf16 v[184:187], v[84:87], v[64:67], v[184:187]
    v_mfma_f32_16x16x32_bf16 v[188:191], v[84:87], v[68:71], v[188:191]
    v_mfma_f32_16x16x32_bf16 v[172:175], v[80:83], v[68:71], v[172:175]
    v_mfma_f32_16x16x32_bf16 v[204:207], v[88:91], v[68:71], v[204:207]
    v_mfma_f32_16x16x32_bf16 v[220:223], v[92:95], v[68:71], v[220:223]
    v_mfma_f32_16x16x32_bf16 v[216:219], v[92:95], v[64:67], v[216:219]
    v_mfma_f32_16x16x32_bf16 v[200:203], v[88:91], v[64:67], v[200:203]
    v_mfma_f32_16x16x32_bf16 v[196:199], v[88:91], v[60:63], v[196:199]
    v_mfma_f32_16x16x32_bf16 v[212:215], v[92:95], v[60:63], v[212:215]
    v_mfma_f32_16x16x32_bf16 v[208:211], v[92:95], v[56:59], v[208:211]
    v_mfma_f32_16x16x32_bf16 v[192:195], v[88:91], v[56:59], v[192:195]
    v_mfma_f32_16x16x32_bf16 v[128:131], v[72:75], v[56:59], v[128:131]
    v_mfma_f32_16x16x32_bf16 v[144:147], v[76:79], v[56:59], v[144:147]
    v_mfma_f32_16x16x32_bf16 v[148:151], v[76:79], v[60:63], v[148:151]
    v_mfma_f32_16x16x32_bf16 v[132:135], v[72:75], v[60:63], v[132:135]
    v_mfma_f32_16x16x32_bf16 v[136:139], v[72:75], v[64:67], v[136:139]
    v_mfma_f32_16x16x32_bf16 v[152:155], v[76:79], v[64:67], v[152:155]
    v_mfma_f32_16x16x32_bf16 v[156:159], v[76:79], v[68:71], v[156:159]
    v_mfma_f32_16x16x32_bf16 v[140:143], v[72:75], v[68:71], v[140:143]
    s_barrier
    s_nop 0
    ds_read_b128 v[16:19], v4 offset:0
    ds_read_b64_tr_b16 v[40:41], v6 offset:8192
    ds_read_b64_tr_b16 v[42:43], v6 offset:8704
    ds_read_b128 v[20:23], v4 offset:2048
    ds_read_b128 v[24:27], v4 offset:4096
    ds_read_b128 v[28:31], v4 offset:6144
    ds_read_b64_tr_b16 v[44:45], v7 offset:8192
    ds_read_b64_tr_b16 v[46:47], v7 offset:8704
    ds_read_b64_tr_b16 v[48:49], v6 offset:16384
    ds_read_b64_tr_b16 v[50:51], v6 offset:16896
    ds_read_b64_tr_b16 v[52:53], v7 offset:16384
    ds_read_b64_tr_b16 v[54:55], v7 offset:16896
    ds_read_b64_tr_b16 v[32:33], v6 offset:0
    ds_read_b64_tr_b16 v[34:35], v6 offset:512
    ds_read_b64_tr_b16 v[36:37], v7 offset:0
    ds_read_b64_tr_b16 v[38:39], v7 offset:512
    s_waitcnt lgkmcnt(0)
    s_nop 0
    v_mfma_f32_16x16x32_bf16 v[160:163], v[40:43], v[16:19], v[160:163]
    v_mfma_f32_16x16x32_bf16 v[176:179], v[44:47], v[16:19], v[176:179]
    v_mfma_f32_16x16x32_bf16 v[180:183], v[44:47], v[20:23], v[180:183]
    v_mfma_f32_16x16x32_bf16 v[164:167], v[40:43], v[20:23], v[164:167]
    v_mfma_f32_16x16x32_bf16 v[168:171], v[40:43], v[24:27], v[168:171]
    v_mfma_f32_16x16x32_bf16 v[184:187], v[44:47], v[24:27], v[184:187]
    v_mfma_f32_16x16x32_bf16 v[188:191], v[44:47], v[28:31], v[188:191]
    v_mfma_f32_16x16x32_bf16 v[172:175], v[40:43], v[28:31], v[172:175]
    v_mfma_f32_16x16x32_bf16 v[204:207], v[48:51], v[28:31], v[204:207]
    v_mfma_f32_16x16x32_bf16 v[220:223], v[52:55], v[28:31], v[220:223]
    v_mfma_f32_16x16x32_bf16 v[216:219], v[52:55], v[24:27], v[216:219]
    v_mfma_f32_16x16x32_bf16 v[200:203], v[48:51], v[24:27], v[200:203]
    v_mfma_f32_16x16x32_bf16 v[196:199], v[48:51], v[20:23], v[196:199]
    v_mfma_f32_16x16x32_bf16 v[212:215], v[52:55], v[20:23], v[212:215]
    v_mfma_f32_16x16x32_bf16 v[208:211], v[52:55], v[16:19], v[208:211]
    v_mfma_f32_16x16x32_bf16 v[192:195], v[48:51], v[16:19], v[192:195]
    v_mfma_f32_16x16x32_bf16 v[128:131], v[32:35], v[16:19], v[128:131]
    v_mfma_f32_16x16x32_bf16 v[144:147], v[36:39], v[16:19], v[144:147]
    v_mfma_f32_16x16x32_bf16 v[148:151], v[36:39], v[20:23], v[148:151]
    v_mfma_f32_16x16x32_bf16 v[132:135], v[32:35], v[20:23], v[132:135]
    v_mfma_f32_16x16x32_bf16 v[136:139], v[32:35], v[24:27], v[136:139]
    v_mfma_f32_16x16x32_bf16 v[152:155], v[36:39], v[24:27], v[152:155]
    v_mfma_f32_16x16x32_bf16 v[156:159], v[36:39], v[28:31], v[156:159]
    v_mfma_f32_16x16x32_bf16 v[140:143], v[32:35], v[28:31], v[140:143]
    ds_read_b128 v[56:59], v5 offset:0
    ds_read_b64_tr_b16 v[80:81], v6 offset:12288
    ds_read_b64_tr_b16 v[82:83], v6 offset:12800
    ds_read_b128 v[60:63], v5 offset:2048
    ds_read_b128 v[64:67], v5 offset:4096
    ds_read_b128 v[68:71], v5 offset:6144
    ds_read_b64_tr_b16 v[84:85], v7 offset:12288
    ds_read_b64_tr_b16 v[86:87], v7 offset:12800
    ds_read_b64_tr_b16 v[88:89], v6 offset:20480
    ds_read_b64_tr_b16 v[90:91], v6 offset:20992
    ds_read_b64_tr_b16 v[92:93], v7 offset:20480
    ds_read_b64_tr_b16 v[94:95], v7 offset:20992
    ds_read_b64_tr_b16 v[72:73], v6 offset:4096
    ds_read_b64_tr_b16 v[74:75], v6 offset:4608
    ds_read_b64_tr_b16 v[76:77], v7 offset:4096
    ds_read_b64_tr_b16 v[78:79], v7 offset:4608
    s_add_u32 s84, s84, 1
    s_cmp_eq_u32 s82, 2
    s_cselect_b32 s78, s83, 40960
    s_cselect_b32 s82, -1, s82
    s_add_u32 s82, s82, 1
    v_add_u32 v4, s78, v4
    v_add_u32 v5, s78, v5
    v_add_u32 v6, s78, v6
    v_add_u32_e64 v7, s78, v7
    s_waitcnt vmcnt(0) lgkmcnt(0)
    v_mfma_f32_16x16x32_bf16 v[160:163], v[80:83], v[56:59], v[160:163]
    v_mfma_f32_16x16x32_bf16 v[176:179], v[84:87], v[56:59], v[176:179]
    v_mfma_f32_16x16x32_bf16 v[180:183], v[84:87], v[60:63], v[180:183]
    v_mfma_f32_16x16x32_bf16 v[164:167], v[80:83], v[60:63], v[164:167]
    v_mfma_f32_16x16x32_bf16 v[168:171], v[80:83], v[64:67], v[168:171]
    v_mfma_f32_16x16x32_bf16 v[184:187], v[84:87], v[64:67], v[184:187]
    v_mfma_f32_16x16x32_bf16 v[188:191], v[84:87], v[68:71], v[188:191]
    v_mfma_f32_16x16x32_bf16 v[172:175], v[80:83], v[68:71], v[172:175]
    v_mfma_f32_16x16x32_bf16 v[204:207], v[88:91], v[68:71], v[204:207]
    v_mfma_f32_16x16x32_bf16 v[220:223], v[92:95], v[68:71], v[220:223]
    v_mfma_f32_16x16x32_bf16 v[216:219], v[92:95], v[64:67], v[216:219]
    v_mfma_f32_16x16x32_bf16 v[200:203], v[88:91], v[64:67], v[200:203]
    v_mfma_f32_16x16x32_bf16 v[196:199], v[88:91], v[60:63], v[196:199]
    v_mfma_f32_16x16x32_bf16 v[212:215], v[92:95], v[60:63], v[212:215]
    v_mfma_f32_16x16x32_bf16 v[208:211], v[92:95], v[56:59], v[208:211]
    v_mfma_f32_16x16x32_bf16 v[192:195], v[88:91], v[56:59], v[192:195]
    v_mfma_f32_16x16x32_bf16 v[128:131], v[72:75], v[56:59], v[128:131]
    v_mfma_f32_16x16x32_bf16 v[144:147], v[76:79], v[56:59], v[144:147]
    v_mfma_f32_16x16x32_bf16 v[148:151], v[76:79], v[60:63], v[148:151]
    v_mfma_f32_16x16x32_bf16 v[132:135], v[72:75], v[60:63], v[132:135]
    v_mfma_f32_16x16x32_bf16 v[136:139], v[72:75], v[64:67], v[136:139]
    v_mfma_f32_16x16x32_bf16 v[152:155], v[76:79], v[64:67], v[152:155]
    v_mfma_f32_16x16x32_bf16 v[156:159], v[76:79], v[68:71], v[156:159]
    v_mfma_f32_16x16x32_bf16 v[140:143], v[72:75], v[68:71], v[140:143]
    s_barrier
    s_nop 0
    ds_read_b128 v[16:19], v4 offset:0
    ds_read_b64_tr_b16 v[40:41], v6 offset:8192
    ds_read_b64_tr_b16 v[42:43], v6 offset:8704
    ds_read_b128 v[20:23], v4 offset:2048
    ds_read_b128 v[24:27], v4 offset:4096
    ds_read_b128 v[28:31], v4 offset:6144
    ds_read_b64_tr_b16 v[44:45], v7 offset:8192
    ds_read_b64_tr_b16 v[46:47], v7 offset:8704
    ds_read_b64_tr_b16 v[48:49], v6 offset:16384
    ds_read_b64_tr_b16 v[50:51], v6 offset:16896
    ds_read_b64_tr_b16 v[52:53], v7 offset:16384
    ds_read_b64_tr_b16 v[54:55], v7 offset:16896
    ds_read_b64_tr_b16 v[32:33], v6 offset:0
    ds_read_b64_tr_b16 v[34:35], v6 offset:512
    ds_read_b64_tr_b16 v[36:37], v7 offset:0
    ds_read_b64_tr_b16 v[38:39], v7 offset:512
    .p2align 3
L_Mloop:
    s_waitcnt lgkmcnt(0)
    s_nop 0
    v_mfma_f32_16x16x32_bf16 v[160:163], v[40:43], v[16:19], v[160:163]
    ds_read_b128 v[56:59], v5 offset:0
    v_mfma_f32_16x16x32_bf16 v[176:179], v[44:47], v[16:19], v[176:179]
    ds_read_b64_tr_b16 v[80:81], v6 offset:12288
    v_mfma_f32_16x16x32_bf16 v[180:183], v[44:47], v[20:23], v[180:183]
    ds_read_b64_tr_b16 v[82:83], v6 offset:12800
    v_mfma_f32_16x16x32_bf16 v[164:167], v[40:43], v[20:23], v[164:167]
    ds_read_b128 v[60:63], v5 offset:2048
    v_mfma_f32_16x16x32_bf16 v[168:171], v[40:43], v[24:27], v[168:171]
    ds_read_b128 v[64:67], v5 offset:4096
    v_mfma_f32_16x16x32_bf16 v[184:187], v[44:47], v[24:27], v[184:187]
    ds_read_b128 v[68:71], v5 offset:6144
    v_mfma_f32_16x16x32_bf16 v[188:191], v[44:47], v[28:31], v[188:191]
    ds_read_b64_tr_b16 v[84:85], v7 offset:12288
    v_mfma_f32_16x16x32_bf16 v[172:175], v[40:43], v[28:31], v[172:175]
    ds_read_b64_tr_b16 v[86:87], v7 offset:12800
    v_mfma_f32_16x16x32_bf16 v[204:207], v[48:51], v[28:31], v[204:207]
    ds_read_b64_tr_b16 v[88:89], v6 offset:20480
    v_mfma_f32_16x16x32_bf16 v[220:223], v[52:55], v[28:31], v[220:223]
    ds_read_b64_tr_b16 v[90:91], v6 offset:20992
    v_mfma_f32_16x16x32_bf16 v[216:219], v[52:55], v[24:27], v[216:219]
    ds_read_b64_tr_b16 v[92:93], v7 offset:20480
    v_mfma_f32_16x16x32_bf16 v[200:203], v[48:51], v[24:27], v[200:203]
    ds_read_b64_tr_b16 v[94:95], v7 offset:20992
    v_mfma_f32_16x16x32_bf16 v[196:199], v[48:51], v[20:23], v[196:199]
    ds_read_b64_tr_b16 v[72:73], v6 offset:4096
    v_mfma_f32_16x16x32_bf16 v[212:215], v[52:55], v[20:23], v[212:215]
    ds_read_b64_tr_b16 v[74:75], v6 offset:4608
    v_mfma_f32_16x16x32_bf16 v[208:211], v[52:55], v[16:19], v[208:211]
    ds_read_b64_tr_b16 v[76:77], v7 offset:4096
    v_mfma_f32_16x16x32_bf16 v[192:195], v[48:51], v[16:19], v[192:195]
    ds_read_b64_tr_b16 v[78:79], v7 offset:4608
    v_mfma_f32_16x16x32_bf16 v[128:131], v[32:35], v[16:19], v[128:131]
    s_add_u32 s84, s84, 1
    s_cmp_eq_u32 s82, 2
    s_cselect_b32 s78, s83, 40960
    s_cselect_b32 s82, -1, s82
    s_add_u32 s82, s82, 1
    v_mfma_f32_16x16x32_bf16 v[144:147], v[36:39], v[16:19], v[144:147]
    v_add_u32 v4, s78, v4
    v_add_u32 v5, s78, v5
    v_mfma_f32_16x16x32_bf16 v[148:151], v[36:39], v[20:23], v[148:151]
    v_add_u32 v6, s78, v6
    v_add_u32 v7, s78, v7
    v_mfma_f32_16x16x32_bf16 v[132:135], v[32:35], v[20:23], v[132:135]
    v_mfma_f32_16x16x32_bf16 v[136:139], v[32:35], v[24:27], v[136:139]
    v_mfma_f32_16x16x32_bf16 v[152:155], v[36:39], v[24:27], v[152:155]
    v_mfma_f32_16x16x32_bf16 v[156:159], v[36:39], v[28:31], v[156:159]
    v_mfma_f32_16x16x32_bf16 v[140:143], v[32:35], v[28:31], v[140:143]
    s_waitcnt vmcnt(0) lgkmcnt(0)
    v_mfma_f32_16x16x32_bf16 v[160:163], v[80:83], v[56:59], v[160:163]
    v_mfma_f32_16x16x32_bf16 v[176:179], v[84:87], v[56:59], v[176:179]
    s_barrier
    s_cmp_eq_u32 s84, 16
    s_cbranch_scc1 L_Mtail
    v_mfma_f32_16x16x32_bf16 v[180:183], v[84:87], v[60:63], v[180:183]
    ds_read_b128 v[16:19], v4 offset:0
    v_mfma_f32_16x16x32_bf16 v[164:167], v[80:83], v[60:63], v[164:167]
    ds_read_b64_tr_b16 v[40:41], v6 offset:8192
    v_mfma_f32_16x16x32_bf16 v[168:171], v[80:83], v[64:67], v[168:171]
    ds_read_b64_tr_b16 v[42:43], v6 offset:8704
    v_mfma_f32_16x16x32_bf16 v[184:187], v[84:87], v[64:67], v[184:187]
    ds_read_b128 v[20:23], v4 offset:2048
    v_mfma_f32_16x16x32_bf16 v[188:191], v[84:87], v[68:71], v[188:191]
    ds_read_b128 v[24:27], v4 offset:4096
    v_mfma_f32_16x16x32_bf16 v[172:175], v[80:83], v[68:71], v[172:175]
    ds_read_b128 v[28:31], v4 offset:6144
    v_mfma_f32_16x16x32_bf16 v[204:207], v[88:91], v[68:71], v[204:207]
    ds_read_b64_tr_b16 v[44:45], v7 offset:8192
    v_mfma_f32_16x16x32_bf16 v[220:223], v[92:95], v[68:71], v[220:223]
    ds_read_b64_tr_b16 v[46:47], v7 offset:8704
    v_mfma_f32_16x16x32_bf16 v[216:219], v[92:95], v[64:67], v[216:219]
    ds_read_b64_tr_b16 v[48:49], v6 offset:16384
    v_mfma_f32_16x16x32_bf16 v[200:203], v[88:91], v[64:67], v[200:203]
    ds_read_b64_tr_b16 v[50:51], v6 offset:16896
    v_mfma_f32_16x16x32_bf16 v[196:199], v[88:91], v[60:63], v[196:199]
    ds_read_b64_tr_b16 v[52:53], v7 offset:16384
    v_mfma_f32_16x16x32_bf16 v[212:215], v[92:95], v[60:63], v[212:215]
    ds_read_b64_tr_b16 v[54:55], v7 offset:16896
    v_mfma_f32_16x16x32_bf16 v[208:211], v[92:95], v[56:59], v[208:211]
    ds_read_b64_tr_b16 v[32:33], v6 offset:0
    v_mfma_f32_16x16x32_bf16 v[192:195], v[88:91], v[56:59], v[192:195]
    ds_read_b64_tr_b16 v[34:35], v6 offset:512
    v_mfma_f32_16x16x32_bf16 v[128:131], v[72:75], v[56:59], v[128:131]
    ds_read_b64_tr_b16 v[36:37], v7 offset:0
    v_mfma_f32_16x16x32_bf16 v[144:147], v[76:79], v[56:59], v[144:147]
    ds_read_b64_tr_b16 v[38:39], v7 offset:512
    v_mfma_f32_16x16x32_bf16 v[148:151], v[76:79], v[60:63], v[148:151]
    v_mfma_f32_16x16x32_bf16 v[132:135], v[72:75], v[60:63], v[132:135]
    v_mfma_f32_16x16x32_bf16 v[136:139], v[72:75], v[64:67], v[136:139]
    v_mfma_f32_16x16x32_bf16 v[152:155], v[76:79], v[64:67], v[152:155]
    v_mfma_f32_16x16x32_bf16 v[156:159], v[76:79], v[68:71], v[156:159]
    v_mfma_f32_16x16x32_bf16 v[140:143], v[72:75], v[68:71], v[140:143]
    s_branch L_Mloop
    .p2align 3
L_Mtail:
    s_mov_b64 exec, 0xffff
    ds_read_b64 v[104:105], v11 offset:0
    ds_read_b64 v[106:107], v11 offset:128
    ds_read_b64 v[108:109], v11 offset:256
    ds_read_b64 v[110:111], v11 offset:384
    s_mov_b64 exec, -1
    s_nop 0
    v_mfma_f32_16x16x32_bf16 v[180:183], v[84:87], v[60:63], v[180:183]
    ds_read_b64 v[20:21], v12 offset:512
    v_mfma_f32_16x16x32_bf16 v[164:167], v[80:83], v[60:63], v[164:167]
    ds_read_b64 v[22:23], v12 offset:640
    v_mfma_f32_16x16x32_bf16 v[168:171], v[80:83], v[64:67], v[168:171]
    ds_read_b64 v[24:25], v12 offset:1024
    v_mfma_f32_16x16x32_bf16 v[184:187], v[84:87], v[64:67], v[184:187]
    ds_read_b64 v[26:27], v12 offset:1152
    v_mfma_f32_16x16x32_bf16 v[188:191], v[84:87], v[68:71], v[188:191]
    ds_read_b64 v[16:17], v12 offset:0
    v_mfma_f32_16x16x32_bf16 v[172:175], v[80:83], v[68:71], v[172:175]
    ds_read_b64 v[18:19], v12 offset:128
    v_mfma_f32_16x16x32_bf16 v[204:207], v[88:91], v[68:71], v[204:207]
    ds_read2_b32 v[32:33], v14 offset0:0 offset1:32
    v_mfma_f32_16x16x32_bf16 v[220:223], v[92:95], v[68:71], v[220:223]
    ds_read_b32 v28, v13 offset:0
    v_mfma_f32_16x16x32_bf16 v[216:219], v[92:95], v[64:67], v[216:219]
    ds_read_b32 v30, v13 offset:64
    v_mfma_f32_16x16x32_bf16 v[200:203], v[88:91], v[64:67], v[200:203]
    ds_read_b32 v44, v13 offset:128
    v_mfma_f32_16x16x32_bf16 v[196:199], v[88:91], v[60:63], v[196:199]
    ds_read_b32 v46, v13 offset:192
    v_mfma_f32_16x16x32_bf16 v[212:215], v[92:95], v[60:63], v[212:215]
    v_mfma_f32_16x16x32_bf16 v[208:211], v[92:95], v[56:59], v[208:211]
    v_mfma_f32_16x16x32_bf16 v[192:195], v[88:91], v[56:59], v[192:195]
    s_waitcnt lgkmcnt(0)
    s_nop 0
    v_mfma_f32_16x16x16_bf16 v[160:163], v[20:21], v[104:105], v[160:163]
    v_mfma_f32_16x16x16_bf16 v[176:179], v[22:23], v[104:105], v[176:179]
    v_mfma_f32_16x16x16_bf16 v[164:167], v[20:21], v[106:107], v[164:167]
    v_mfma_f32_16x16x16_bf16 v[180:183], v[22:23], v[106:107], v[180:183]
    v_mfma_f32_16x16x16_bf16 v[168:171], v[20:21], v[108:109], v[168:171]
    v_mfma_f32_16x16x16_bf16 v[184:187], v[22:23], v[108:109], v[184:187]
    v_mfma_f32_16x16x16_bf16 v[172:175], v[20:21], v[110:111], v[172:175]
    v_mfma_f32_16x16x16_bf16 v[188:191], v[22:23], v[110:111], v[188:191]
    v_mul_f32 v34, 0x3fb8aa3b, v32
    v_mul_f32 v48, 0x3fb8aa3b, v33
    v_mfma_f32_16x16x16_bf16 v[192:195], v[24:25], v[104:105], v[192:195]
    v_mfma_f32_16x16x16_bf16 v[208:211], v[26:27], v[104:105], v[208:211]
    v_mfma_f32_16x16x16_bf16 v[196:199], v[24:25], v[106:107], v[196:199]
    v_cvt_pk_bf16_f32 v160, v160, v161
    v_cvt_pk_bf16_f32 v161, v162, v163
    v_cvt_pk_bf16_f32 v162, v176, v177
    v_cvt_pk_bf16_f32 v163, v178, v179
    v_mfma_f32_16x16x16_bf16 v[212:215], v[26:27], v[106:107], v[212:215]
    v_cvt_pk_bf16_f32 v164, v164, v165
    v_cvt_pk_bf16_f32 v165, v166, v167
    v_cvt_pk_bf16_f32 v166, v180, v181
    v_cvt_pk_bf16_f32 v167, v182, v183
    v_mfma_f32_16x16x16_bf16 v[200:203], v[24:25], v[108:109], v[200:203]
    v_cvt_pk_bf16_f32 v168, v168, v169
    v_cvt_pk_bf16_f32 v169, v170, v171
    v_cvt_pk_bf16_f32 v170, v184, v185
    v_cvt_pk_bf16_f32 v171, v186, v187
    v_mfma_f32_16x16x16_bf16 v[216:219], v[26:27], v[108:109], v[216:219]
    v_cvt_pk_bf16_f32 v172, v172, v173
    v_cvt_pk_bf16_f32 v173, v174, v175
    v_cvt_pk_bf16_f32 v174, v188, v189
    v_cvt_pk_bf16_f32 v175, v190, v191
    v_mfma_f32_16x16x16_bf16 v[204:207], v[24:25], v[110:111], v[204:207]
    v_permlane16_swap_b32 v160, v164
    v_permlane16_swap_b32 v161, v165
    v_permlane16_swap_b32 v162, v166
    v_permlane16_swap_b32 v163, v167
    v_mfma_f32_16x16x16_bf16 v[220:223], v[26:27], v[110:111], v[220:223]
    v_permlane16_swap_b32 v168, v172
    v_permlane16_swap_b32 v169, v173
    v_permlane16_swap_b32 v170, v174
    v_permlane16_swap_b32 v171, v175
    v_mfma_f32_32x32x16_bf16 v[224:239], v[96:99], v[160:163], 0
    v_mfma_f32_32x32x16_bf16 v[224:239], v[100:103], v[164:167], v[224:239]
    v_mfma_f32_32x32x16_bf16 v[240:255], v[96:99], v[168:171], 0
    v_mfma_f32_32x32x16_bf16 v[240:255], v[100:103], v[172:175], v[240:255]
    v_pk_mul_f32 v[192:193], v[192:193], v[28:29] op_sel_hi:[1,0]
    v_pk_mul_f32 v[194:195], v[194:195], v[28:29] op_sel_hi:[1,0]
    v_pk_mul_f32 v[208:209], v[208:209], v[28:29] op_sel_hi:[1,0]
    v_pk_mul_f32 v[210:211], v[210:211], v[28:29] op_sel_hi:[1,0]
    v_cvt_pk_bf16_f32 v192, v192, v193
    v_cvt_pk_bf16_f32 v193, v194, v195
    v_cvt_pk_bf16_f32 v194, v208, v209
    v_cvt_pk_bf16_f32 v195, v210, v211
    v_pk_mul_f32 v[196:197], v[196:197], v[30:31] op_sel_hi:[1,0]
    v_pk_mul_f32 v[198:199], v[198:199], v[30:31] op_sel_hi:[1,0]
    v_pk_mul_f32 v[212:213], v[212:213], v[30:31] op_sel_hi:[1,0]
    v_pk_mul_f32 v[214:215], v[214:215], v[30:31] op_sel_hi:[1,0]
    v_cvt_pk_bf16_f32 v196, v196, v197
    v_cvt_pk_bf16_f32 v197, v198, v199
    v_cvt_pk_bf16_f32 v198, v212, v213
    v_cvt_pk_bf16_f32 v199, v214, v215
    v_pk_mul_f32 v[200:201], v[200:201], v[44:45] op_sel_hi:[1,0]
    v_pk_mul_f32 v[202:203], v[202:203], v[44:45] op_sel_hi:[1,0]
    v_pk_mul_f32 v[216:217], v[216:217], v[44:45] op_sel_hi:[1,0]
    v_pk_mul_f32 v[218:219], v[218:219], v[44:45] op_sel_hi:[1,0]
    v_cvt_pk_bf16_f32 v200, v200, v201
    v_cvt_pk_bf16_f32 v201, v202, v203
    v_cvt_pk_bf16_f32 v202, v216, v217
    v_cvt_pk_bf16_f32 v203, v218, v219
    v_pk_mul_f32 v[204:205], v[204:205], v[46:47] op_sel_hi:[1,0]
    v_pk_mul_f32 v[206:207], v[206:207], v[46:47] op_sel_hi:[1,0]
    v_pk_mul_f32 v[220:221], v[220:221], v[46:47] op_sel_hi:[1,0]
    v_pk_mul_f32 v[222:223], v[222:223], v[46:47] op_sel_hi:[1,0]
    v_cvt_pk_bf16_f32 v204, v204, v205
    v_cvt_pk_bf16_f32 v205, v206, v207
    v_cvt_pk_bf16_f32 v206, v220, v221
    v_cvt_pk_bf16_f32 v207, v222, v223
    v_mfma_f32_16x16x32_bf16 v[128:131], v[72:75], v[56:59], v[128:131]
    v_max3_f32 v36, v224, v225, v226
    v_max3_f32 v38, -v224, -v225, -v226
    v_max3_f32 v36, v36, v227, v228
    v_max3_f32 v38, v38, -v227, -v228
    v_mfma_f32_16x16x32_bf16 v[144:147], v[76:79], v[56:59], v[144:147]
    v_max3_f32 v36, v36, v229, v230
    v_max3_f32 v38, v38, -v229, -v230
    v_max3_f32 v36, v36, v231, v232
    v_max3_f32 v38, v38, -v231, -v232
    v_mfma_f32_16x16x32_bf16 v[148:151], v[76:79], v[60:63], v[148:151]
    v_max3_f32 v36, v36, v233, v234
    v_max3_f32 v38, v38, -v233, -v234
    v_max3_f32 v36, v36, v235, v236
    v_max3_f32 v38, v38, -v235, -v236
    v_mfma_f32_16x16x32_bf16 v[132:135], v[72:75], v[60:63], v[132:135]
    v_max3_f32 v36, v36, v237, v238
    v_max3_f32 v38, v38, -v237, -v238
    v_max_f32_e64 v36, v36, v239
    v_max_f32 v38, v38, -v239
    v_mfma_f32_16x16x32_bf16 v[136:139], v[72:75], v[64:67], v[136:139]
    v_max3_f32 v37, v240, v241, v242
    v_max3_f32 v39, -v240, -v241, -v242
    v_max3_f32 v37, v37, v243, v244
    v_max3_f32 v39, v39, -v243, -v244
    v_mfma_f32_16x16x32_bf16 v[152:155], v[76:79], v[64:67], v[152:155]
    v_max3_f32 v37, v37, v245, v246
    v_max3_f32 v39, v39, -v245, -v246
    v_max3_f32 v37, v37, v247, v248
    v_max3_f32 v39, v39, -v247, -v248
    v_mfma_f32_16x16x32_bf16 v[156:159], v[76:79], v[68:71], v[156:159]
    v_max3_f32 v37, v37, v249, v250
    v_max3_f32 v39, v39, -v249, -v250
    v_max3_f32 v37, v37, v251, v252
    v_max3_f32 v39, v39, -v251, -v252
    v_mfma_f32_16x16x32_bf16 v[140:143], v[72:75], v[68:71], v[140:143]
    v_max3_f32 v37, v37, v253, v254
    v_max3_f32 v39, v39, -v253, -v254
    v_max_f32_e64 v37, v37, v255
    v_max_f32 v39, v39, -v255
    v_permlane32_swap_b32 v36, v38
    s_nop 0
    v_permlane32_swap_b32 v37, v39
    v_max_f32 v36, v36, v38
    v_max_f32_e64 v37, v37, v39
    v_mul_f32 v36, -v36, v34
    v_mul_f32 v37, -v37, v48
    v_mov_b32 v38, v36
    v_mov_b32 v39, v37
    s_nop 0
    v_permlane32_swap_b32 v36, v38
    v_permlane32_swap_b32_e64 v37, v39
    v_pk_fma_f32 v[60:61], v[224:225], v[34:35], v[36:37] op_sel_hi:[1,0,0]
    v_pk_fma_f32 v[62:63], v[226:227], v[34:35], v[36:37] op_sel_hi:[1,0,0]
    v_pk_fma_f32 v[64:65], v[228:229], v[34:35], v[36:37] op_sel_hi:[1,0,0]
    v_pk_fma_f32 v[66:67], v[230:231], v[34:35], v[36:37] op_sel_hi:[1,0,0]
    v_pk_fma_f32 v[68:69], v[232:233], v[34:35], v[36:37] op_sel_hi:[1,0,0]
    v_pk_fma_f32 v[70:71], v[234:235], v[34:35], v[36:37] op_sel_hi:[1,0,0]
    v_pk_fma_f32 v[72:73], v[236:237], v[34:35], v[36:37] op_sel_hi:[1,0,0]
    v_pk_fma_f32 v[74:75], v[238:239], v[34:35], v[36:37] op_sel_hi:[1,0,0]
    v_pk_fma_f32 v[76:77], v[224:225], v[34:35], v[38:39] op_sel_hi:[1,0,0] neg_lo:[1,0,0] neg_hi:[1,0,0]
    v_pk_fma_f32 v[78:79], v[226:227], v[34:35], v[38:39] op_sel_hi:[1,0,0] neg_lo:[1,0,0] neg_hi:[1,0,0]
    v_pk_fma_f32 v[80:81], v[228:229], v[34:35], v[38:39] op_sel_hi:[1,0,0] neg_lo:[1,0,0] neg_hi:[1,0,0]
    v_pk_fma_f32 v[82:83], v[230:231], v[34:35], v[38:39] op_sel_hi:[1,0,0] neg_lo:[1,0,0] neg_hi:[1,0,0]
    v_pk_fma_f32 v[84:85], v[232:233], v[34:35], v[38:39] op_sel_hi:[1,0,0] neg_lo:[1,0,0] neg_hi:[1,0,0]
    v_pk_fma_f32 v[86:87], v[234:235], v[34:35], v[38:39] op_sel_hi:[1,0,0] neg_lo:[1,0,0] neg_hi:[1,0,0]
    v_pk_fma_f32 v[88:89], v[236:237], v[34:35], v[38:39] op_sel_hi:[1,0,0] neg_lo:[1,0,0] neg_hi:[1,0,0]
    v_pk_fma_f32 v[90:91], v[238:239], v[34:35], v[38:39] op_sel_hi:[1,0,0] neg_lo:[1,0,0] neg_hi:[1,0,0]
    v_exp_f32 v60, v60
    v_exp_f32 v61, v61
    v_exp_f32 v62, v62
    v_exp_f32 v63, v63
    v_exp_f32 v64, v64
    v_exp_f32 v65, v65
    v_exp_f32 v66, v66
    v_exp_f32 v67, v67
    v_exp_f32 v68, v68
    v_exp_f32 v69, v69
    v_exp_f32 v70, v70
    v_exp_f32 v71, v71
    v_exp_f32 v72, v72
    v_exp_f32 v73, v73
    v_exp_f32 v74, v74
    v_exp_f32 v75, v75
    v_exp_f32 v76, v76
    v_exp_f32 v77, v77
    v_exp_f32 v78, v78
    v_exp_f32 v79, v79
    v_exp_f32 v80, v80
    v_exp_f32 v81, v81
    v_exp_f32 v82, v82
    v_exp_f32 v83, v83
    v_exp_f32 v84, v84
    v_exp_f32 v85, v85
    v_exp_f32 v86, v86
    v_exp_f32 v87, v87
    v_exp_f32 v88, v88
    v_exp_f32 v89, v89
    v_exp_f32 v90, v90
    v_exp_f32 v91, v91
    v_pk_add_f32 v[40:41], v[60:61], v[62:63]
    v_pk_add_f32 v[42:43], v[76:77], v[78:79]
    v_pk_add_f32 v[40:41], v[40:41], v[64:65]
    v_pk_add_f32 v[42:43], v[42:43], v[80:81]
    v_pk_add_f32 v[40:41], v[40:41], v[66:67]
    v_pk_add_f32 v[42:43], v[42:43], v[82:83]
    v_pk_add_f32 v[40:41], v[40:41], v[68:69]
    v_pk_add_f32 v[42:43], v[42:43], v[84:85]
    v_pk_add_f32 v[40:41], v[40:41], v[70:71]
    v_pk_add_f32 v[42:43], v[42:43], v[86:87]
    v_pk_add_f32 v[40:41], v[40:41], v[72:73]
    v_pk_add_f32 v[42:43], v[42:43], v[88:89]
    v_pk_add_f32 v[40:41], v[40:41], v[74:75]
    v_pk_add_f32 v[42:43], v[42:43], v[90:91]
    v_add_f32 v40, v40, v41
    v_add_f32 v42, v42, v43
    s_nop 1
    v_permlane32_swap_b32 v40, v42
    v_add_f32 v40, v40, v42
    v_rcp_f32 v40, v40
    s_nop 0
    v_mov_b32 v42, v40
    s_nop 1
    v_permlane32_swap_b32 v40, v42
    v_pk_mul_f32 v[60:61], v[60:61], v[40:41] op_sel_hi:[1,0]
    v_pk_mul_f32 v[62:63], v[62:63], v[40:41] op_sel_hi:[1,0]
    v_pk_mul_f32 v[64:65], v[64:65], v[40:41] op_sel_hi:[1,0]
    v_pk_mul_f32 v[66:67], v[66:67], v[40:41] op_sel_hi:[1,0]
    v_cvt_pk_bf16_f32 v160, v60, v61
    v_cvt_pk_bf16_f32 v161, v62, v63
    v_cvt_pk_bf16_f32 v162, v64, v65
    v_cvt_pk_bf16_f32 v163, v66, v67
    v_pk_mul_f32 v[68:69], v[68:69], v[40:41] op_sel_hi:[1,0]
    v_pk_mul_f32 v[70:71], v[70:71], v[40:41] op_sel_hi:[1,0]
    v_pk_mul_f32 v[72:73], v[72:73], v[40:41] op_sel_hi:[1,0]
    v_pk_mul_f32 v[74:75], v[74:75], v[40:41] op_sel_hi:[1,0]
    v_cvt_pk_bf16_f32 v166, v68, v69
    v_cvt_pk_bf16_f32 v167, v70, v71
    v_cvt_pk_bf16_f32 v164, v72, v73
    v_cvt_pk_bf16_f32 v165, v74, v75
    v_pk_mul_f32 v[76:77], v[76:77], v[42:43] op_sel_hi:[1,0]
    v_pk_mul_f32 v[78:79], v[78:79], v[42:43] op_sel_hi:[1,0]
    v_pk_mul_f32 v[80:81], v[80:81], v[42:43] op_sel_hi:[1,0]
    v_pk_mul_f32 v[82:83], v[82:83], v[42:43] op_sel_hi:[1,0]
    v_cvt_pk_bf16_f32 v168, v76, v77
    v_cvt_pk_bf16_f32 v169, v78, v79
    v_cvt_pk_bf16_f32 v170, v80, v81
    v_cvt_pk_bf16_f32 v171, v82, v83
    v_pk_mul_f32 v[84:85], v[84:85], v[42:43] op_sel_hi:[1,0]
    v_pk_mul_f32 v[86:87], v[86:87], v[42:43] op_sel_hi:[1,0]
    v_pk_mul_f32 v[88:89], v[88:89], v[42:43] op_sel_hi:[1,0]
    v_pk_mul_f32 v[90:91], v[90:91], v[42:43] op_sel_hi:[1,0]
    v_cvt_pk_bf16_f32 v174, v84, v85
    v_cvt_pk_bf16_f32 v175, v86, v87
    v_cvt_pk_bf16_f32 v172, v88, v89
    v_cvt_pk_bf16_f32 v173, v90, v91
    v_pk_fma_f32 v[60:61], v[240:241], v[48:49], v[36:37] op_sel:[0,0,1] op_sel_hi:[1,0,1]
    v_pk_fma_f32 v[62:63], v[242:243], v[48:49], v[36:37] op_sel:[0,0,1] op_sel_hi:[1,0,1]
    v_pk_fma_f32 v[64:65], v[244:245], v[48:49], v[36:37] op_sel:[0,0,1] op_sel_hi:[1,0,1]
    v_pk_fma_f32 v[66:67], v[246:247], v[48:49], v[36:37] op_sel:[0,0,1] op_sel_hi:[1,0,1]
    v_pk_fma_f32 v[68:69], v[248:249], v[48:49], v[36:37] op_sel:[0,0,1] op_sel_hi:[1,0,1]
    v_pk_fma_f32 v[70:71], v[250:251], v[48:49], v[36:37] op_sel:[0,0,1] op_sel_hi:[1,0,1]
    v_pk_fma_f32 v[72:73], v[252:253], v[48:49], v[36:37] op_sel:[0,0,1] op_sel_hi:[1,0,1]
    v_pk_fma_f32 v[74:75], v[254:255], v[48:49], v[36:37] op_sel:[0,0,1] op_sel_hi:[1,0,1]
    v_pk_fma_f32 v[76:77], v[240:241], v[48:49], v[38:39] op_sel:[0,0,1] op_sel_hi:[1,0,1] neg_lo:[1,0,0] neg_hi:[1,0,0]
    v_pk_fma_f32 v[78:79], v[242:243], v[48:49], v[38:39] op_sel:[0,0,1] op_sel_hi:[1,0,1] neg_lo:[1,0,0] neg_hi:[1,0,0]
    v_pk_fma_f32 v[80:81], v[244:245], v[48:49], v[38:39] op_sel:[0,0,1] op_sel_hi:[1,0,1] neg_lo:[1,0,0] neg_hi:[1,0,0]
    v_pk_fma_f32 v[82:83], v[246:247], v[48:49], v[38:39] op_sel:[0,0,1] op_sel_hi:[1,0,1] neg_lo:[1,0,0] neg_hi:[1,0,0]
    v_pk_fma_f32 v[84:85], v[248:249], v[48:49], v[38:39] op_sel:[0,0,1] op_sel_hi:[1,0,1] neg_lo:[1,0,0] neg_hi:[1,0,0]
    v_pk_fma_f32 v[86:87], v[250:251], v[48:49], v[38:39] op_sel:[0,0,1] op_sel_hi:[1,0,1] neg_lo:[1,0,0] neg_hi:[1,0,0]
    v_pk_fma_f32 v[88:89], v[252:253], v[48:49], v[38:39] op_sel:[0,0,1] op_sel_hi:[1,0,1] neg_lo:[1,0,0] neg_hi:[1,0,0]
    v_pk_fma_f32 v[90:91], v[254:255], v[48:49], v[38:39] op_sel:[0,0,1] op_sel_hi:[1,0,1] neg_lo:[1,0,0] neg_hi:[1,0,0]
    v_exp_f32 v60, v60
    v_exp_f32 v61, v61
    v_exp_f32 v62, v62
    v_exp_f32 v63, v63
    ds_write_b128 v116, v[192:195] offset:0
    v_exp_f32 v64, v64
    v_exp_f32 v65, v65
    v_exp_f32 v66, v66
    v_exp_f32 v67, v67
    ds_write_b128 v116, v[196:199] offset:2048
    v_exp_f32 v68, v68
    v_exp_f32 v69, v69
    v_exp_f32 v70, v70
    v_exp_f32 v71, v71
    ds_write_b128 v116, v[200:203] offset:4096
    v_exp_f32 v72, v72
    v_exp_f32 v73, v73
    v_exp_f32 v74, v74
    v_exp_f32 v75, v75
    ds_write_b128 v116, v[204:207] offset:6144
    v_exp_f32 v76, v76
    v_exp_f32 v77, v77
    v_exp_f32 v78, v78
    v_exp_f32 v79, v79
    ds_write_b128 v112, v[160:163] offset:0
    v_exp_f32 v80, v80
    v_exp_f32 v81, v81
    v_exp_f32 v82, v82
    v_exp_f32 v83, v83
    ds_write_b128 v113, v[164:167] offset:0
    v_exp_f32 v84, v84
    v_exp_f32 v85, v85
    v_exp_f32 v86, v86
    v_exp_f32 v87, v87
    ds_write_b128 v114, v[168:171] offset:0
    v_exp_f32 v88, v88
    v_exp_f32 v89, v89
    v_exp_f32 v90, v90
    v_exp_f32 v91, v91
    ds_write_b128 v115, v[172:175] offset:0
    v_pk_add_f32 v[40:41], v[60:61], v[62:63]
    v_pk_add_f32 v[42:43], v[76:77], v[78:79]
    v_pk_add_f32 v[40:41], v[40:41], v[64:65]
    v_pk_add_f32 v[42:43], v[42:43], v[80:81]
    v_pk_add_f32 v[40:41], v[40:41], v[66:67]
    v_pk_add_f32 v[42:43], v[42:43], v[82:83]
    v_pk_add_f32 v[40:41], v[40:41], v[68:69]
    v_pk_add_f32 v[42:43], v[42:43], v[84:85]
    v_pk_add_f32 v[40:41], v[40:41], v[70:71]
    v_pk_add_f32 v[42:43], v[42:43], v[86:87]
    v_pk_add_f32 v[40:41], v[40:41], v[72:73]
    v_pk_add_f32 v[42:43], v[42:43], v[88:89]
    v_pk_add_f32 v[40:41], v[40:41], v[74:75]
    v_pk_add_f32 v[42:43], v[42:43], v[90:91]
    v_add_f32 v40, v40, v41
    v_add_f32 v42, v42, v43
    s_nop 1
    v_permlane32_swap_b32 v40, v42
    v_add_f32 v40, v40, v42
    v_rcp_f32 v40, v40
    s_nop 0
    v_mov_b32 v42, v40
    s_nop 1
    v_permlane32_swap_b32 v40, v42
    v_pk_mul_f32 v[60:61], v[60:61], v[40:41] op_sel_hi:[1,0]
    v_pk_mul_f32 v[62:63], v[62:63], v[40:41] op_sel_hi:[1,0]
    v_pk_mul_f32 v[64:65], v[64:65], v[40:41] op_sel_hi:[1,0]
    v_pk_mul_f32 v[66:67], v[66:67], v[40:41] op_sel_hi:[1,0]
    v_cvt_pk_bf16_f32 v176, v60, v61
    v_cvt_pk_bf16_f32 v177, v62, v63
    v_cvt_pk_bf16_f32 v178, v64, v65
    v_cvt_pk_bf16_f32 v179, v66, v67
    ds_write_b128 v112, v[176:179] offset:4096
    v_pk_mul_f32 v[68:69], v[68:69], v[40:41] op_sel_hi:[1,0]
    v_pk_mul_f32 v[70:71], v[70:71], v[40:41] op_sel_hi:[1,0]
    v_pk_mul_f32 v[72:73], v[72:73], v[40:41] op_sel_hi:[1,0]
    v_pk_mul_f32 v[74:75], v[74:75], v[40:41] op_sel_hi:[1,0]
    v_cvt_pk_bf16_f32 v182, v68, v69
    v_cvt_pk_bf16_f32 v183, v70, v71
    v_cvt_pk_bf16_f32 v180, v72, v73
    v_cvt_pk_bf16_f32 v181, v74, v75
    ds_write_b128 v113, v[180:183] offset:4096
    v_pk_mul_f32 v[76:77], v[76:77], v[42:43] op_sel_hi:[1,0]
    v_pk_mul_f32 v[78:79], v[78:79], v[42:43] op_sel_hi:[1,0]
    v_pk_mul_f32 v[80:81], v[80:81], v[42:43] op_sel_hi:[1,0]
    v_pk_mul_f32 v[82:83], v[82:83], v[42:43] op_sel_hi:[1,0]
    v_cvt_pk_bf16_f32 v184, v76, v77
    v_cvt_pk_bf16_f32 v185, v78, v79
    v_cvt_pk_bf16_f32 v186, v80, v81
    v_cvt_pk_bf16_f32 v187, v82, v83
    ds_write_b128 v114, v[184:187] offset:4096
    v_pk_mul_f32 v[84:85], v[84:85], v[42:43] op_sel_hi:[1,0]
    v_pk_mul_f32 v[86:87], v[86:87], v[42:43] op_sel_hi:[1,0]
    v_pk_mul_f32 v[88:89], v[88:89], v[42:43] op_sel_hi:[1,0]
    v_pk_mul_f32 v[90:91], v[90:91], v[42:43] op_sel_hi:[1,0]
    v_cvt_pk_bf16_f32 v190, v84, v85
    v_cvt_pk_bf16_f32 v191, v86, v87
    v_cvt_pk_bf16_f32 v188, v88, v89
    v_cvt_pk_bf16_f32 v189, v90, v91
    ds_write_b128 v115, v[188:191] offset:4096
    s_waitcnt lgkmcnt(0)
    s_barrier
    s_setprio 0
    s_nop 0
    v_mfma_f32_16x16x16_bf16 v[128:131], v[16:17], v[104:105], v[128:131]
    v_mfma_f32_16x16x16_bf16 v[144:147], v[18:19], v[104:105], v[144:147]
    v_mfma_f32_16x16x16_bf16 v[132:135], v[16:17], v[106:107], v[132:135]
    v_mfma_f32_16x16x16_bf16 v[148:151], v[18:19], v[106:107], v[148:151]
    v_mfma_f32_16x16x16_bf16 v[136:139], v[16:17], v[108:109], v[136:139]
    v_mfma_f32_16x16x16_bf16 v[152:155], v[18:19], v[108:109], v[152:155]
    v_mfma_f32_16x16x16_bf16 v[140:143], v[16:17], v[110:111], v[140:143]
    v_mfma_f32_16x16x16_bf16 v[156:159], v[18:19], v[110:111], v[156:159]
    v_lshrrev_b32 v11, 5, v2
    s_lshl_b32 s78, s81, 7
    s_add_u32 s78, s78, 162944
    v_lshl_add_u32 v10, v11, 4, s78
    v_and_b32 v13, 1, v2
    v_cmp_eq_u32 vcc, 1, v13
    v_mov_b32 v13, 162816
    v_and_b32 v12, 31, v2
    v_cndmask_b32 v10, v10, v13, vcc
    v_lshlrev_b32_e64 v12, 4, v12
    v_lshl_add_u32 v11, v11, 10, v12
    v_lshlrev_b32_e64 v14, 4, v2
    v_cvt_pk_bf16_f32 v128, v128, v129
    v_cvt_pk_bf16_f32 v129, v130, v131
    v_cvt_pk_bf16_f32 v130, v144, v145
    v_cvt_pk_bf16_f32 v131, v146, v147
    v_cvt_pk_bf16_f32 v132, v132, v133
    v_cvt_pk_bf16_f32 v133, v134, v135
    v_cvt_pk_bf16_f32 v134, v148, v149
    v_cvt_pk_bf16_f32 v135, v150, v151
    v_cvt_pk_bf16_f32 v136, v136, v137
    v_cvt_pk_bf16_f32 v137, v138, v139
    v_cvt_pk_bf16_f32 v138, v152, v153
    v_cvt_pk_bf16_f32 v139, v154, v155
    v_cvt_pk_bf16_f32 v140, v140, v141
    v_cvt_pk_bf16_f32 v141, v142, v143
    v_cvt_pk_bf16_f32 v142, v156, v157
    v_cvt_pk_bf16_f32 v143, v158, v159
    v_permlane16_swap_b32 v128, v132
    v_permlane16_swap_b32 v129, v133
    v_permlane16_swap_b32 v130, v134
    v_permlane16_swap_b32 v131, v135
    v_permlane16_swap_b32 v136, v140
    v_permlane16_swap_b32 v137, v141
    v_permlane16_swap_b32 v138, v142
    v_permlane16_swap_b32 v139, v143
    v_mfma_f32_32x32x16_bf16 v[224:239], v[96:99], v[128:131], 0
    v_mfma_f32_32x32x16_bf16 v[224:239], v[100:103], v[132:135], v[224:239]
    v_mfma_f32_32x32x16_bf16 v[240:255], v[96:99], v[136:139], 0
    v_mfma_f32_32x32x16_bf16 v[240:255], v[100:103], v[140:143], v[240:255]
    s_lshl_b32 s94, s70, 14
    s_lshl_b32 s79, s81, 13
    s_add_u32 s94, s94, s79
    s_add_u32 s94, s94, 8388608
    s_add_u32 s95, s94, 4096
    s_lshl_b32 s78, s69, 1
    s_add_u32 s78, s78, s80
    s_lshl_b32 s78, s78, 6
    s_lshl_b32 s79, s70, 1
    s_add_u32 s78, s78, s79
    s_add_u32 s78, s78, s81
    s_lshl_b32 s78, s78, 11
    s_add_u32 s96, s78, 4194304
    s_add_u32 s97, s96, 65536
    v_max3_f32 v36, v224, v225, v226
    v_max3_f32 v38, -v224, -v225, -v226
    v_max3_f32 v36, v36, v227, v228
    v_max3_f32 v38, v38, -v227, -v228
    v_max3_f32 v36, v36, v229, v230
    v_max3_f32 v38, v38, -v229, -v230
    v_max3_f32 v36, v36, v231, v232
    v_max3_f32 v38, v38, -v231, -v232
    v_max3_f32 v36, v36, v233, v234
    v_max3_f32 v38, v38, -v233, -v234
    v_max3_f32 v36, v36, v235, v236
    v_max3_f32 v38, v38, -v235, -v236
    v_max3_f32 v36, v36, v237, v238
    v_max3_f32 v38, v38, -v237, -v238
    v_max_f32_e64 v36, v36, v239
    v_max_f32 v38, v38, -v239
    v_max3_f32 v37, v240, v241, v242
    v_max3_f32 v39, -v240, -v241, -v242
    v_max3_f32 v37, v37, v243, v244
    v_max3_f32 v39, v39, -v243, -v244
    v_max3_f32 v37, v37, v245, v246
    v_max3_f32 v39, v39, -v245, -v246
    v_max3_f32 v37, v37, v247, v248
    v_max3_f32 v39, v39, -v247, -v248
    v_max3_f32 v37, v37, v249, v250
    v_max3_f32 v39, v39, -v249, -v250
    v_max3_f32 v37, v37, v251, v252
    v_max3_f32 v39, v39, -v251, -v252
    v_max3_f32 v37, v37, v253, v254
    v_max3_f32 v39, v39, -v253, -v254
    v_max_f32_e64 v37, v37, v255
    v_max_f32 v39, v39, -v255
    v_permlane32_swap_b32 v36, v38
    s_nop 0
    v_permlane32_swap_b32 v37, v39
    v_max_f32 v36, v36, v38
    v_max_f32_e64 v37, v37, v39
    v_mul_f32 v36, -v36, v34
    v_mul_f32 v37, -v37, v48
    v_mov_b32 v38, v36
    v_mov_b32 v39, v37
    s_nop 0
    v_permlane32_swap_b32 v36, v38
    v_permlane32_swap_b32_e64 v37, v39
    v_pk_fma_f32 v[60:61], v[224:225], v[34:35], v[36:37] op_sel_hi:[1,0,0]
    v_pk_fma_f32 v[62:63], v[226:227], v[34:35], v[36:37] op_sel_hi:[1,0,0]
    v_pk_fma_f32 v[64:65], v[228:229], v[34:35], v[36:37] op_sel_hi:[1,0,0]
    v_pk_fma_f32 v[66:67], v[230:231], v[34:35], v[36:37] op_sel_hi:[1,0,0]
    v_pk_fma_f32 v[68:69], v[232:233], v[34:35], v[36:37] op_sel_hi:[1,0,0]
    v_pk_fma_f32 v[70:71], v[234:235], v[34:35], v[36:37] op_sel_hi:[1,0,0]
    v_pk_fma_f32 v[72:73], v[236:237], v[34:35], v[36:37] op_sel_hi:[1,0,0]
    v_pk_fma_f32 v[74:75], v[238:239], v[34:35], v[36:37] op_sel_hi:[1,0,0]
    v_pk_fma_f32 v[76:77], v[224:225], v[34:35], v[38:39] op_sel_hi:[1,0,0] neg_lo:[1,0,0] neg_hi:[1,0,0]
    v_pk_fma_f32 v[78:79], v[226:227], v[34:35], v[38:39] op_sel_hi:[1,0,0] neg_lo:[1,0,0] neg_hi:[1,0,0]
    v_pk_fma_f32 v[80:81], v[228:229], v[34:35], v[38:39] op_sel_hi:[1,0,0] neg_lo:[1,0,0] neg_hi:[1,0,0]
    v_pk_fma_f32 v[82:83], v[230:231], v[34:35], v[38:39] op_sel_hi:[1,0,0] neg_lo:[1,0,0] neg_hi:[1,0,0]
    v_pk_fma_f32 v[84:85], v[232:233], v[34:35], v[38:39] op_sel_hi:[1,0,0] neg_lo:[1,0,0] neg_hi:[1,0,0]
    v_pk_fma_f32 v[86:87], v[234:235], v[34:35], v[38:39] op_sel_hi:[1,0,0] neg_lo:[1,0,0] neg_hi:[1,0,0]
    v_pk_fma_f32 v[88:89], v[236:237], v[34:35], v[38:39] op_sel_hi:[1,0,0] neg_lo:[1,0,0] neg_hi:[1,0,0]
    v_pk_fma_f32 v[90:91], v[238:239], v[34:35], v[38:39] op_sel_hi:[1,0,0] neg_lo:[1,0,0] neg_hi:[1,0,0]
    v_exp_f32 v60, v60
    v_exp_f32 v61, v61
    v_exp_f32 v62, v62
    v_exp_f32 v63, v63
    v_exp_f32 v64, v64
    v_exp_f32 v65, v65
    v_exp_f32 v66, v66
    v_exp_f32 v67, v67
    v_exp_f32 v68, v68
    v_exp_f32 v69, v69
    v_exp_f32 v70, v70
    v_exp_f32 v71, v71
    v_exp_f32 v72, v72
    v_exp_f32 v73, v73
    v_exp_f32 v74, v74
    v_exp_f32 v75, v75
    v_exp_f32 v76, v76
    v_exp_f32 v77, v77
    v_exp_f32 v78, v78
    v_exp_f32 v79, v79
    v_exp_f32 v80, v80
    v_exp_f32 v81, v81
    v_exp_f32 v82, v82
    v_exp_f32 v83, v83
    v_exp_f32 v84, v84
    v_exp_f32 v85, v85
    v_exp_f32 v86, v86
    v_exp_f32 v87, v87
    v_exp_f32 v88, v88
    v_exp_f32 v89, v89
    v_exp_f32 v90, v90
    v_exp_f32 v91, v91
    v_cvt_pk_bf16_f32 v160, v60, v61
    v_cvt_pk_bf16_f32 v161, v62, v63
    v_cvt_pk_bf16_f32 v162, v64, v65
    v_cvt_pk_bf16_f32 v163, v66, v67
    v_cvt_pk_bf16_f32 v164, v68, v69
    v_cvt_pk_bf16_f32 v165, v70, v71
    v_cvt_pk_bf16_f32 v166, v72, v73
    v_cvt_pk_bf16_f32 v167, v74, v75
    v_cvt_pk_bf16_f32 v168, v76, v77
    v_cvt_pk_bf16_f32 v169, v78, v79
    v_cvt_pk_bf16_f32 v170, v80, v81
    v_cvt_pk_bf16_f32 v171, v82, v83
    v_cvt_pk_bf16_f32 v172, v84, v85
    v_cvt_pk_bf16_f32 v173, v86, v87
    v_cvt_pk_bf16_f32 v174, v88, v89
    v_cvt_pk_bf16_f32 v175, v90, v91
    v_pk_fma_f32 v[60:61], v[240:241], v[48:49], v[36:37] op_sel:[0,0,1] op_sel_hi:[1,0,1]
    v_pk_fma_f32 v[62:63], v[242:243], v[48:49], v[36:37] op_sel:[0,0,1] op_sel_hi:[1,0,1]
    v_pk_fma_f32 v[64:65], v[244:245], v[48:49], v[36:37] op_sel:[0,0,1] op_sel_hi:[1,0,1]
    v_pk_fma_f32 v[66:67], v[246:247], v[48:49], v[36:37] op_sel:[0,0,1] op_sel_hi:[1,0,1]
    v_pk_fma_f32 v[68:69], v[248:249], v[48:49], v[36:37] op_sel:[0,0,1] op_sel_hi:[1,0,1]
    v_pk_fma_f32 v[70:71], v[250:251], v[48:49], v[36:37] op_sel:[0,0,1] op_sel_hi:[1,0,1]
    v_pk_fma_f32 v[72:73], v[252:253], v[48:49], v[36:37] op_sel:[0,0,1] op_sel_hi:[1,0,1]
    v_pk_fma_f32 v[74:75], v[254:255], v[48:49], v[36:37] op_sel:[0,0,1] op_sel_hi:[1,0,1]
    v_pk_fma_f32 v[76:77], v[240:241], v[48:49], v[38:39] op_sel:[0,0,1] op_sel_hi:[1,0,1] neg_lo:[1,0,0] neg_hi:[1,0,0]
    v_pk_fma_f32 v[78:79], v[242:243], v[48:49], v[38:39] op_sel:[0,0,1] op_sel_hi:[1,0,1] neg_lo:[1,0,0] neg_hi:[1,0,0]
    v_pk_fma_f32 v[80:81], v[244:245], v[48:49], v[38:39] op_sel:[0,0,1] op_sel_hi:[1,0,1] neg_lo:[1,0,0] neg_hi:[1,0,0]
    v_pk_fma_f32 v[82:83], v[246:247], v[48:49], v[38:39] op_sel:[0,0,1] op_sel_hi:[1,0,1] neg_lo:[1,0,0] neg_hi:[1,0,0]
    v_pk_fma_f32 v[84:85], v[248:249], v[48:49], v[38:39] op_sel:[0,0,1] op_sel_hi:[1,0,1] neg_lo:[1,0,0] neg_hi:[1,0,0]
    v_pk_fma_f32 v[86:87], v[250:251], v[48:49], v[38:39] op_sel:[0,0,1] op_sel_hi:[1,0,1] neg_lo:[1,0,0] neg_hi:[1,0,0]
    v_pk_fma_f32 v[88:89], v[252:253], v[48:49], v[38:39] op_sel:[0,0,1] op_sel_hi:[1,0,1] neg_lo:[1,0,0] neg_hi:[1,0,0]
    v_pk_fma_f32 v[90:91], v[254:255], v[48:49], v[38:39] op_sel:[0,0,1] op_sel_hi:[1,0,1] neg_lo:[1,0,0] neg_hi:[1,0,0]
    v_exp_f32 v60, v60
    v_exp_f32 v61, v61
    v_exp_f32 v62, v62
    v_exp_f32 v63, v63
    v_exp_f32 v64, v64
    v_exp_f32 v65, v65
    v_exp_f32 v66, v66
    v_exp_f32 v67, v67
    v_exp_f32 v68, v68
    v_exp_f32 v69, v69
    v_exp_f32 v70, v70
    v_exp_f32 v71, v71
    v_exp_f32 v72, v72
    v_exp_f32 v73, v73
    v_exp_f32 v74, v74
    v_exp_f32 v75, v75
    v_exp_f32 v76, v76
    v_exp_f32 v77, v77
    v_exp_f32 v78, v78
    v_exp_f32 v79, v79
    v_exp_f32 v80, v80
    v_exp_f32 v81, v81
    v_exp_f32 v82, v82
    v_exp_f32 v83, v83
    v_exp_f32 v84, v84
    v_exp_f32 v85, v85
    v_exp_f32 v86, v86
    v_exp_f32 v87, v87
    v_exp_f32 v88, v88
    v_exp_f32 v89, v89
    v_exp_f32 v90, v90
    v_exp_f32 v91, v91
    v_cvt_pk_bf16_f32 v176, v60, v61
    v_cvt_pk_bf16_f32 v177, v62, v63
    v_cvt_pk_bf16_f32 v178, v64, v65
    v_cvt_pk_bf16_f32 v179, v66, v67
    v_cvt_pk_bf16_f32 v180, v68, v69
    v_cvt_pk_bf16_f32 v181, v70, v71
    v_cvt_pk_bf16_f32 v182, v72, v73
    v_cvt_pk_bf16_f32 v183, v74, v75
    v_cvt_pk_bf16_f32 v184, v76, v77
    v_cvt_pk_bf16_f32 v185, v78, v79
    v_cvt_pk_bf16_f32 v186, v80, v81
    v_cvt_pk_bf16_f32 v187, v82, v83
    v_cvt_pk_bf16_f32 v188, v84, v85
    v_cvt_pk_bf16_f32 v189, v86, v87
    v_cvt_pk_bf16_f32 v190, v88, v89
    v_cvt_pk_bf16_f32 v191, v90, v91
    s_barrier
    s_setprio 1
    ds_read_b128 v[16:19], v10 offset:0
    ds_read_b128 v[20:23], v10 offset:32
    ds_read_b128 v[24:27], v10 offset:64
    ds_read_b128 v[28:31], v10 offset:96
    s_waitcnt lgkmcnt(3)
    v_mfma_f32_32x32x16_bf16 v[224:239], v[16:19], v[160:163], 0
    buffer_load_dwordx4 v[96:99], v11, s[36:39], s94 offen offset:0 sc1
    buffer_load_dwordx4 v[100:103], v11, s[36:39], s94 offen offset:2048 sc1
    buffer_load_dwordx4 v[104:107], v11, s[36:39], s95 offen offset:0 sc1
    buffer_load_dwordx4 v[108:111], v11, s[36:39], s95 offen offset:2048 sc1
    s_waitcnt lgkmcnt(2)
    v_mfma_f32_32x32x16_bf16 v[224:239], v[20:23], v[164:167], v[224:239]
    s_waitcnt lgkmcnt(1)
    v_mfma_f32_32x32x16_bf16 v[240:255], v[24:27], v[168:171], 0
    s_waitcnt lgkmcnt(0)
    v_mfma_f32_32x32x16_bf16 v[240:255], v[28:31], v[172:175], v[240:255]
    v_mfma_f32_32x32x16_bf16 v[192:207], v[16:19], v[176:179], 0
    v_mfma_f32_32x32x16_bf16 v[192:207], v[20:23], v[180:183], v[192:207]
    v_mfma_f32_32x32x16_bf16 v[208:223], v[24:27], v[184:187], 0
    v_mfma_f32_32x32x16_bf16 v[208:223], v[28:31], v[188:191], v[208:223]
    s_mov_b32 s85, 0
    s_branch L_kvchk
L_kvspin:
    s_add_u32 s85, s85, 1
    s_cmp_gt_u32 s85, 400000
    s_cbranch_scc1 L_end
    buffer_load_dwordx4 v[96:99], v11, s[36:39], s94 offen offset:0 sc1
    buffer_load_dwordx4 v[100:103], v11, s[36:39], s94 offen offset:2048 sc1
    buffer_load_dwordx4 v[104:107], v11, s[36:39], s95 offen offset:0 sc1
    buffer_load_dwordx4 v[108:111], v11, s[36:39], s95 offen offset:2048 sc1
L_kvchk:
    s_waitcnt vmcnt(0)
    s_nop 0
    v_mfma_f32_32x32x16_bf16 v[60:75], v[96:99], v[160:163], 0
    v_max3_u32 v13, v96, v97, v98
    v_max3_u32 v10, v99, v100, v101
    v_max3_u32 v13, v13, v102, v103
    v_max3_u32 v10, v10, v104, v105
    v_max3_u32 v13, v13, v106, v107
    v_mfma_f32_32x32x16_bf16 v[60:75], v[100:103], v[164:167], v[60:75]
    v_max3_u32 v10, v10, v108, v109
    v_max3_u32 v13, v13, v110, v111
    v_max_u32 v13, v13, v10
    v_cmp_eq_u32_e64 vcc, -1, v13
    s_cbranch_vccnz L_kvspin
    v_mfma_f32_32x32x16_bf16 v[76:91], v[104:107], v[168:171], 0
    v_rcp_f32 v36, v225
    v_rcp_f32 v40, v193
    v_rcp_f32 v38, v241
    v_rcp_f32 v42, v209
    v_mfma_f32_32x32x16_bf16 v[76:91], v[108:111], v[172:175], v[76:91]
    v_mov_b32 v44, 0x358637bd
    v_mov_b32 v45, 0x358637bd
    v_fmac_f32 v44, v224, v36
    v_fmac_f32 v45, v192, v40
    v_fmac_f32 v44, v240, v38
    v_fmac_f32 v45, v208, v42
    v_mfma_f32_32x32x16_bf16 v[128:143], v[96:99], v[176:179], 0
    v_rcp_f32 v44, v44
    v_rcp_f32 v45, v45
    v_mul_f32 v36, v36, v44
    v_mul_f32 v40, v40, v45
    v_mfma_f32_32x32x16_bf16 v[128:143], v[100:103], v[180:183], v[128:143]
    v_mul_f32 v38, v38, v44
    v_mul_f32 v42, v42, v45
    v_mul_f32 v60, v60, v36
    v_mul_f32 v61, v61, v36
    v_mul_f32 v62, v62, v36
    v_mul_f32 v63, v63, v36
    v_mfma_f32_32x32x16_bf16 v[144:159], v[104:107], v[184:187], 0
    v_mul_f32 v64, v64, v36
    v_mul_f32 v65, v65, v36
    v_mul_f32 v66, v66, v36
    v_mul_f32 v67, v67, v36
    v_mul_f32 v68, v68, v36
    v_mul_f32 v69, v69, v36
    v_mfma_f32_32x32x16_bf16 v[144:159], v[108:111], v[188:191], v[144:159]
    v_mul_f32 v70, v70, v36
    v_mul_f32 v71, v71, v36
    v_mul_f32 v72, v72, v36
    v_mul_f32 v73, v73, v36
    v_mul_f32 v74, v74, v36
    v_mul_f32 v75, v75, v36
    v_pk_fma_f32 v[60:61], v[76:77], v[38:39], v[60:61] op_sel_hi:[1,0,1]
    v_pk_fma_f32 v[62:63], v[78:79], v[38:39], v[62:63] op_sel_hi:[1,0,1]
    v_pk_fma_f32 v[64:65], v[80:81], v[38:39], v[64:65] op_sel_hi:[1,0,1]
    v_pk_fma_f32 v[66:67], v[82:83], v[38:39], v[66:67] op_sel_hi:[1,0,1]
    v_cvt_pk_bf16_f32 v16, v60, v61
    v_cvt_pk_bf16_f32 v17, v62, v63
    v_cvt_pk_bf16_f32 v18, v64, v65
    v_cvt_pk_bf16_f32 v19, v66, v67
    buffer_store_dwordx4 v[16:19], v14, s[36:39], s96 offen offset:0 sc1
    v_pk_fma_f32 v[68:69], v[84:85], v[38:39], v[68:69] op_sel_hi:[1,0,1]
    v_pk_fma_f32 v[70:71], v[86:87], v[38:39], v[70:71] op_sel_hi:[1,0,1]
    v_pk_fma_f32 v[72:73], v[88:89], v[38:39], v[72:73] op_sel_hi:[1,0,1]
    v_pk_fma_f32 v[74:75], v[90:91], v[38:39], v[74:75] op_sel_hi:[1,0,1]
    v_cvt_pk_bf16_f32 v20, v68, v69
    v_cvt_pk_bf16_f32 v21, v70, v71
    v_cvt_pk_bf16_f32 v22, v72, v73
    v_cvt_pk_bf16_f32 v23, v74, v75
    buffer_store_dwordx4 v[20:23], v14, s[36:39], s96 offen offset:1024 sc1
    v_pk_mul_f32 v[128:129], v[128:129], v[40:41] op_sel_hi:[1,0]
    v_pk_mul_f32 v[130:131], v[130:131], v[40:41] op_sel_hi:[1,0]
    v_pk_mul_f32 v[132:133], v[132:133], v[40:41] op_sel_hi:[1,0]
    v_pk_mul_f32 v[134:135], v[134:135], v[40:41] op_sel_hi:[1,0]
    v_pk_fma_f32 v[128:129], v[144:145], v[42:43], v[128:129] op_sel_hi:[1,0,1]
    v_pk_fma_f32 v[130:131], v[146:147], v[42:43], v[130:131] op_sel_hi:[1,0,1]
    v_pk_fma_f32 v[132:133], v[148:149], v[42:43], v[132:133] op_sel_hi:[1,0,1]
    v_pk_fma_f32 v[134:135], v[150:151], v[42:43], v[134:135] op_sel_hi:[1,0,1]
    v_cvt_pk_bf16_f32 v24, v128, v129
    v_cvt_pk_bf16_f32 v25, v130, v131
    v_cvt_pk_bf16_f32 v26, v132, v133
    v_cvt_pk_bf16_f32 v27, v134, v135
    buffer_store_dwordx4 v[24:27], v14, s[36:39], s97 offen offset:0 sc1
    v_pk_mul_f32 v[136:137], v[136:137], v[40:41] op_sel_hi:[1,0]
    v_pk_mul_f32 v[138:139], v[138:139], v[40:41] op_sel_hi:[1,0]
    v_pk_mul_f32 v[140:141], v[140:141], v[40:41] op_sel_hi:[1,0]
    v_pk_mul_f32 v[142:143], v[142:143], v[40:41] op_sel_hi:[1,0]
    v_pk_fma_f32 v[136:137], v[152:153], v[42:43], v[136:137] op_sel_hi:[1,0,1]
    v_pk_fma_f32 v[138:139], v[154:155], v[42:43], v[138:139] op_sel_hi:[1,0,1]
    v_pk_fma_f32 v[140:141], v[156:157], v[42:43], v[140:141] op_sel_hi:[1,0,1]
    v_pk_fma_f32 v[142:143], v[158:159], v[42:43], v[142:143] op_sel_hi:[1,0,1]
    v_cvt_pk_bf16_f32 v28, v136, v137
    v_cvt_pk_bf16_f32 v29, v138, v139
    v_cvt_pk_bf16_f32 v30, v140, v141
    v_cvt_pk_bf16_f32 v31, v142, v143
    buffer_store_dwordx4 v[28:31], v14, s[36:39], s97 offen offset:1024 sc1
    v_and_b32 v8, 31, v2
    v_lshrrev_b32 v9, 5, v2
    v_lshlrev_b32 v10, 3, v9
    s_lshl_b32 s78, s72, 7
    buffer_load_dwordx2 v[32:33], v10, s[64:67], s78 offen offset:0
    buffer_load_dwordx2 v[34:35], v10, s[64:67], s78 offen offset:16
    buffer_load_dwordx2 v[36:37], v10, s[64:67], s78 offen offset:32
    buffer_load_dwordx2 v[38:39], v10, s[64:67], s78 offen offset:48
    buffer_load_dwordx2 v[40:41], v10, s[64:67], s78 offen offset:64
    buffer_load_dwordx2 v[42:43], v10, s[64:67], s78 offen offset:80
    buffer_load_dwordx2 v[44:45], v10, s[64:67], s78 offen offset:96
    buffer_load_dwordx2 v[46:47], v10, s[64:67], s78 offen offset:112
    buffer_load_dwordx4 v[48:51], v14, s[64:67], 0 offen
    buffer_load_dwordx4 v[52:55], v14, s[64:67], 0 offen offset:1024
    s_barrier
    s_lshl_b32 s78, s76, 12
    s_add_u32 s78, s78, 131072
    v_lshl_add_u32 v6, v8, 7, s78
    v_add_u32_e64 v6, v6, v10
    v_bfe_u32 v11, v8, 1, 3
    v_lshl_add_u32 v6, v11, 4, v6
    v_xor_b32_e64 v112, 0, v6
    ds_read_b64 v[96:97], v112
    v_xor_b32_e64 v113, 16, v6
    ds_read_b64 v[98:99], v113
    v_xor_b32_e64 v114, 32, v6
    ds_read_b64 v[100:101], v114
    v_xor_b32_e64 v115, 48, v6
    ds_read_b64 v[102:103], v115
    v_xor_b32_e64 v116, 64, v6
    ds_read_b64 v[104:105], v116
    v_xor_b32 v117, 80, v6
    ds_read_b64 v[106:107], v117
    v_xor_b32 v118, 96, v6
    ds_read_b64 v[108:109], v118
    v_xor_b32 v119, 112, v6
    ds_read_b64 v[110:111], v119
    v_bfe_u32 v11, v2, 2, 2
    v_lshl_add_u32 v12, v9, 2, v11
    v_lshlrev_b32 v12, 7, v12
    v_lshrrev_b32 v11, 1, v11
    v_lshl_add_u32 v12, v11, 6, v12
    v_bfe_u32 v11, v2, 4, 1
    v_lshl_add_u32 v12, v11, 5, v12
    v_and_b32_e64 v11, 3, v2
    v_lshl_add_u32 v12, v11, 3, v12
    s_lshl_b32 s82, s72, 0
    s_and_b32 s82, s82, 15
    s_lshl_b32 s78, s82, 13
    v_add_u32 v4, s78, v12
    v_xor_b32 v5, 64, v4
    s_lshl_b32 s83, s71, 2
    s_add_u32 s83, s83, s76
    s_lshl_b32 s83, s83, 16
    s_add_u32 s83, s83, 4194304
    s_lshl_b32 s82, s82, 12
    s_add_u32 s88, s82, s83
    s_waitcnt lgkmcnt(0)
    v_lshlrev_b32 v224, 16, v96
    v_and_b32 v225, 0xffff0000, v96
    v_lshlrev_b32_e64 v226, 16, v97
    v_and_b32 v227, 0xffff0000, v97
    v_lshlrev_b32_e64 v228, 16, v98
    v_and_b32 v229, 0xffff0000, v98
    v_lshlrev_b32_e64 v230, 16, v99
    v_and_b32 v231, 0xffff0000, v99
    v_lshlrev_b32_e64 v232, 16, v100
    v_and_b32 v233, 0xffff0000, v100
    v_lshlrev_b32_e64 v234, 16, v101
    v_and_b32 v235, 0xffff0000, v101
    v_lshlrev_b32_e64 v236, 16, v102
    v_and_b32 v237, 0xffff0000, v102
    v_lshlrev_b32_e64 v238, 16, v103
    v_and_b32 v239, 0xffff0000, v103
    v_lshlrev_b32_e64 v240, 16, v104
    v_and_b32 v241, 0xffff0000, v104
    v_lshlrev_b32_e64 v242, 16, v105
    v_and_b32 v243, 0xffff0000, v105
    v_lshlrev_b32_e64 v244, 16, v106
    v_and_b32 v245, 0xffff0000, v106
    v_lshlrev_b32_e64 v246, 16, v107
    v_and_b32 v247, 0xffff0000, v107
    v_lshlrev_b32_e64 v248, 16, v108
    v_and_b32 v249, 0xffff0000, v108
    v_lshlrev_b32_e64 v250, 16, v109
    v_and_b32 v251, 0xffff0000, v109
    v_lshlrev_b32_e64 v252, 16, v110
    v_and_b32 v253, 0xffff0000, v110
    v_lshlrev_b32_e64 v254, 16, v111
    v_and_b32 v255, 0xffff0000, v111
    s_waitcnt vmcnt(0)
    s_barrier
    v_lshlrev_b32_e64 v60, 16, v32
    v_and_b32 v61, 0xffff0000, v32
    v_lshlrev_b32_e64 v62, 16, v33
    v_and_b32 v63, 0xffff0000, v33
    v_lshlrev_b32_e64 v64, 16, v34
    v_and_b32 v65, 0xffff0000, v34
    v_lshlrev_b32_e64 v66, 16, v35
    v_and_b32 v67, 0xffff0000, v35
    v_lshlrev_b32_e64 v68, 16, v36
    v_and_b32 v69, 0xffff0000, v36
    v_lshlrev_b32_e64 v70, 16, v37
    v_and_b32 v71, 0xffff0000, v37
    v_lshlrev_b32_e64 v72, 16, v38
    v_and_b32 v73, 0xffff0000, v38
    v_lshlrev_b32_e64 v74, 16, v39
    v_and_b32 v75, 0xffff0000, v39
    v_lshlrev_b32_e64 v76, 16, v40
    v_and_b32 v77, 0xffff0000, v40
    v_lshlrev_b32_e64 v78, 16, v41
    v_and_b32 v79, 0xffff0000, v41
    v_lshlrev_b32_e64 v80, 16, v42
    v_and_b32 v81, 0xffff0000, v42
    v_lshlrev_b32_e64 v82, 16, v43
    v_and_b32 v83, 0xffff0000, v43
    v_lshlrev_b32_e64 v84, 16, v44
    v_and_b32 v85, 0xffff0000, v44
    v_lshlrev_b32_e64 v86, 16, v45
    v_and_b32 v87, 0xffff0000, v45
    v_lshlrev_b32_e64 v88, 16, v46
    v_and_b32 v89, 0xffff0000, v46
    v_lshlrev_b32_e64 v90, 16, v47
    v_and_b32 v91, 0xffff0000, v47
    s_mov_b32 s78, 0x3f803f80
    v_dot2_f32_bf16 v126, v48, s78, 0
    v_dot2_f32_bf16 v126, v49, s78, v126
    v_dot2_f32_bf16 v126, v50, s78, v126
    v_dot2_f32_bf16 v126, v51, s78, v126
    v_dot2_f32_bf16 v126, v52, s78, v126
    v_dot2_f32_bf16 v126, v53, s78, v126
    v_dot2_f32_bf16 v126, v54, s78, v126
    v_dot2_f32_bf16 v126, v55, s78, v126
    s_nop 2
    v_add_f32_dpp v126, v126, v126 row_ror:8 row_mask:0xf bank_mask:0xf
    s_nop 1
    v_add_f32_dpp v126, v126, v126 row_ror:4 row_mask:0xf bank_mask:0xf
    s_nop 1
    v_add_f32_dpp v126, v126, v126 row_ror:2 row_mask:0xf bank_mask:0xf
    s_nop 1
    v_add_f32_dpp v126, v126, v126 row_ror:1 row_mask:0xf bank_mask:0xf
    v_mov_b32 v127, v126
    s_nop 1
    v_permlane32_swap_b32 v126, v127
    v_add_f32 v126, v126, v127
    v_mov_b32 v127, v126
    s_nop 1
    v_permlane16_swap_b32 v126, v127
    v_add_f32 v126, v126, v127
    v_lshlrev_b32_e64 v12, 4, v8
    v_lshl_add_u32 v12, v9, 14, v12
    s_lshl_b32 s94, s71, 15
    s_lshl_b32 s79, s76, 9
    s_add_u32 s94, s94, s79
    s_add_u32 s94, s94, 1572864
    s_lshl_b32 s95, s72, 11
    s_add_u32 s95, s95, s94
    s_lshl_b32 s78, s76, 5
    v_add_u32 v11, s78, v8
    v_and_b32 v13, 7, v8
    v_xor_b32 v13, v13, v9
    v_lshlrev_b32 v13, 4, v13
    v_lshl_add_u32 v13, v11, 8, v13
    v_lshlrev_b32_e64 v10, 3, v11
    v_add_u32 v10, 159744, v10
    s_lshl_b32 s78, s71, 7
    v_add_u32 v11, s78, v11
    v_mov_b32 v15, 163584
    ds_read_b32 v15, v15
    s_waitcnt lgkmcnt(0)
    v_readfirstlane_b32 s99, v15
    s_mov_b32 s84, 0
    s_barrier
    buffer_load_dwordx4 v[160:163], v14, s[36:39], s88 offen offset:0 sc1
    ds_read_b64_tr_b16 v[128:129], v4 offset:0
    buffer_load_dwordx4 v[164:167], v14, s[36:39], s88 offen offset:1024 sc1
    ds_read_b64_tr_b16 v[130:131], v4 offset:1024
    buffer_load_dwordx4 v[168:171], v14, s[36:39], s88 offen offset:2048 sc1
    ds_read_b64_tr_b16 v[132:133], v5 offset:0
    buffer_load_dwordx4 v[172:175], v14, s[36:39], s88 offen offset:3072 sc1
    s_add_u32 s82, s82, 4096
    s_and_b32 s82, s82, 0xffff
    s_add_u32 s88, s82, s83
    s_nop 0
    ds_read_b64_tr_b16 v[134:135], v5 offset:1024
    buffer_load_dwordx4 v[176:179], v14, s[36:39], s88 offen offset:0 sc1
    ds_read_b64_tr_b16 v[136:137], v4 offset:2048
    buffer_load_dwordx4 v[180:183], v14, s[36:39], s88 offen offset:1024 sc1
    ds_read_b64_tr_b16 v[138:139], v4 offset:3072
    buffer_load_dwordx4 v[184:187], v14, s[36:39], s88 offen offset:2048 sc1
    ds_read_b64_tr_b16 v[140:141], v5 offset:2048
    buffer_load_dwordx4 v[188:191], v14, s[36:39], s88 offen offset:3072 sc1
    s_add_u32 s82, s82, 4096
    s_and_b32 s82, s82, 0xffff
    s_add_u32 s88, s82, s83
    s_nop 0
    ds_read_b64_tr_b16 v[142:143], v5 offset:3072
    buffer_load_dwordx4 v[192:195], v14, s[36:39], s88 offen offset:0 sc1
    buffer_load_dwordx4 v[196:199], v14, s[36:39], s88 offen offset:1024 sc1
    buffer_load_dwordx4 v[200:203], v14, s[36:39], s88 offen offset:2048 sc1
    buffer_load_dwordx4 v[204:207], v14, s[36:39], s88 offen offset:3072 sc1
    s_add_u32 s82, s82, 4096
    s_and_b32 s82, s82, 0xffff
    s_add_u32 s88, s82, s83
    buffer_load_dwordx4 v[208:211], v14, s[36:39], s88 offen offset:0 sc1
    buffer_load_dwordx4 v[212:215], v14, s[36:39], s88 offen offset:1024 sc1
    .p2align 3
L_G2:
    s_add_u32 s84, s84, 1
    s_waitcnt vmcnt(12) lgkmcnt(6)
    v_mfma_f32_32x32x16_bf16 v[224:239], v[128:131], v[160:163], v[224:239]
    ds_read_b64_tr_b16 v[144:145], v4 offset:4096
    ds_read_b64_tr_b16 v[146:147], v4 offset:5120
    buffer_load_dwordx4 v[216:219], v14, s[36:39], s88 offen offset:2048 sc1
    s_waitcnt lgkmcnt(6)
    v_mfma_f32_32x32x16_bf16 v[240:255], v[132:135], v[160:163], v[240:255]
    ds_read_b64_tr_b16 v[148:149], v5 offset:4096
    ds_read_b64_tr_b16 v[150:151], v5 offset:5120
    s_waitcnt lgkmcnt(6)
    v_mfma_f32_32x32x16_bf16 v[224:239], v[136:139], v[164:167], v[224:239]
    ds_read_b64_tr_b16 v[152:153], v4 offset:6144
    ds_read_b64_tr_b16 v[154:155], v4 offset:7168
    buffer_load_dwordx4 v[220:223], v14, s[36:39], s88 offen offset:3072 sc1
    s_add_u32 s82, s82, 4096
    s_and_b32 s82, s82, 0xffff
    s_add_u32 s88, s82, s83
    s_waitcnt lgkmcnt(6)
    v_mfma_f32_32x32x16_bf16 v[240:255], v[140:143], v[164:167], v[240:255]
    ds_read_b64_tr_b16 v[156:157], v5 offset:6144
    ds_read_b64_tr_b16 v[158:159], v5 offset:7168
    v_add_u32 v4, 0x2000, v4
    v_and_b32 v4, 0x1ffff, v4
    v_xor_b32 v5, 64, v4
    s_waitcnt vmcnt(12) lgkmcnt(6)
    v_mfma_f32_32x32x16_bf16 v[224:239], v[144:147], v[168:171], v[224:239]
    ds_read_b64_tr_b16 v[128:129], v4 offset:0
    ds_read_b64_tr_b16 v[130:131], v4 offset:1024
    buffer_load_dwordx4 v[160:163], v14, s[36:39], s88 offen offset:0 sc1
    s_waitcnt lgkmcnt(6)
    v_mfma_f32_32x32x16_bf16 v[240:255], v[148:151], v[168:171], v[240:255]
    ds_read_b64_tr_b16 v[132:133], v5 offset:0
    ds_read_b64_tr_b16 v[134:135], v5 offset:1024
    s_waitcnt lgkmcnt(6)
    v_mfma_f32_32x32x16_bf16 v[224:239], v[152:155], v[172:175], v[224:239]
    ds_read_b64_tr_b16 v[136:137], v4 offset:2048
    ds_read_b64_tr_b16 v[138:139], v4 offset:3072
    buffer_load_dwordx4 v[164:167], v14, s[36:39], s88 offen offset:1024 sc1
    s_waitcnt lgkmcnt(6)
    v_mfma_f32_32x32x16_bf16 v[240:255], v[156:159], v[172:175], v[240:255]
    ds_read_b64_tr_b16 v[140:141], v5 offset:2048
    ds_read_b64_tr_b16 v[142:143], v5 offset:3072
    s_waitcnt vmcnt(12) lgkmcnt(6)
    v_mfma_f32_32x32x16_bf16 v[224:239], v[128:131], v[176:179], v[224:239]
    ds_read_b64_tr_b16 v[144:145], v4 offset:4096
    ds_read_b64_tr_b16 v[146:147], v4 offset:5120
    buffer_load_dwordx4 v[168:171], v14, s[36:39], s88 offen offset:2048 sc1
    s_waitcnt lgkmcnt(6)
    v_mfma_f32_32x32x16_bf16 v[240:255], v[132:135], v[176:179], v[240:255]
    ds_read_b64_tr_b16 v[148:149], v5 offset:4096
    ds_read_b64_tr_b16 v[150:151], v5 offset:5120
    s_waitcnt lgkmcnt(6)
    v_mfma_f32_32x32x16_bf16 v[224:239], v[136:139], v[180:183], v[224:239]
    ds_read_b64_tr_b16 v[152:153], v4 offset:6144
    ds_read_b64_tr_b16 v[154:155], v4 offset:7168
    buffer_load_dwordx4 v[172:175], v14, s[36:39], s88 offen offset:3072 sc1
    s_add_u32 s82, s82, 4096
    s_and_b32 s82, s82, 0xffff
    s_add_u32 s88, s82, s83
    s_waitcnt lgkmcnt(6)
    v_mfma_f32_32x32x16_bf16 v[240:255], v[140:143], v[180:183], v[240:255]
    ds_read_b64_tr_b16 v[156:157], v5 offset:6144
    ds_read_b64_tr_b16 v[158:159], v5 offset:7168
    v_add_u32 v4, 0x2000, v4
    v_and_b32 v4, 0x1ffff, v4
    v_xor_b32 v5, 64, v4
    s_waitcnt vmcnt(12) lgkmcnt(6)
    v_mfma_f32_32x32x16_bf16 v[224:239], v[144:147], v[184:187], v[224:239]
    ds_read_b64_tr_b16 v[128:129], v4 offset:0
    ds_read_b64_tr_b16 v[130:131], v4 offset:1024
    buffer_load_dwordx4 v[176:179], v14, s[36:39], s88 offen offset:0 sc1
    s_waitcnt lgkmcnt(6)
    v_mfma_f32_32x32x16_bf16 v[240:255], v[148:151], v[184:187], v[240:255]
    ds_read_b64_tr_b16 v[132:133], v5 offset:0
    ds_read_b64_tr_b16 v[134:135], v5 offset:1024
    s_waitcnt lgkmcnt(6)
    v_mfma_f32_32x32x16_bf16 v[224:239], v[152:155], v[188:191], v[224:239]
    ds_read_b64_tr_b16 v[136:137], v4 offset:2048
    ds_read_b64_tr_b16 v[138:139], v4 offset:3072
    buffer_load_dwordx4 v[180:183], v14, s[36:39], s88 offen offset:1024 sc1
    s_waitcnt lgkmcnt(6)
    v_mfma_f32_32x32x16_bf16 v[240:255], v[156:159], v[188:191], v[240:255]
    ds_read_b64_tr_b16 v[140:141], v5 offset:2048
    ds_read_b64_tr_b16 v[142:143], v5 offset:3072
    s_waitcnt vmcnt(12) lgkmcnt(6)
    v_mfma_f32_32x32x16_bf16 v[224:239], v[128:131], v[192:195], v[224:239]
    ds_read_b64_tr_b16 v[144:145], v4 offset:4096
    ds_read_b64_tr_b16 v[146:147], v4 offset:5120
    buffer_load_dwordx4 v[184:187], v14, s[36:39], s88 offen offset:2048 sc1
    s_waitcnt lgkmcnt(6)
    v_mfma_f32_32x32x16_bf16 v[240:255], v[132:135], v[192:195], v[240:255]
    ds_read_b64_tr_b16 v[148:149], v5 offset:4096
    ds_read_b64_tr_b16 v[150:151], v5 offset:5120
    s_waitcnt lgkmcnt(6)
    v_mfma_f32_32x32x16_bf16 v[224:239], v[136:139], v[196:199], v[224:239]
    ds_read_b64_tr_b16 v[152:153], v4 offset:6144
    ds_read_b64_tr_b16 v[154:155], v4 offset:7168
    buffer_load_dwordx4 v[188:191], v14, s[36:39], s88 offen offset:3072 sc1
    s_add_u32 s82, s82, 4096
    s_and_b32 s82, s82, 0xffff
    s_add_u32 s88, s82, s83
    s_waitcnt lgkmcnt(6)
    v_mfma_f32_32x32x16_bf16 v[240:255], v[140:143], v[196:199], v[240:255]
    ds_read_b64_tr_b16 v[156:157], v5 offset:6144
    ds_read_b64_tr_b16 v[158:159], v5 offset:7168
    v_add_u32 v4, 0x2000, v4
    v_and_b32 v4, 0x1ffff, v4
    v_xor_b32 v5, 64, v4
    s_waitcnt vmcnt(12) lgkmcnt(6)
    v_mfma_f32_32x32x16_bf16 v[224:239], v[144:147], v[200:203], v[224:239]
    ds_read_b64_tr_b16 v[128:129], v4 offset:0
    ds_read_b64_tr_b16 v[130:131], v4 offset:1024
    buffer_load_dwordx4 v[192:195], v14, s[36:39], s88 offen offset:0 sc1
    s_waitcnt lgkmcnt(6)
    v_mfma_f32_32x32x16_bf16 v[240:255], v[148:151], v[200:203], v[240:255]
    ds_read_b64_tr_b16 v[132:133], v5 offset:0
    ds_read_b64_tr_b16 v[134:135], v5 offset:1024
    s_waitcnt lgkmcnt(6)
    v_mfma_f32_32x32x16_bf16 v[224:239], v[152:155], v[204:207], v[224:239]
    ds_read_b64_tr_b16 v[136:137], v4 offset:2048
    ds_read_b64_tr_b16 v[138:139], v4 offset:3072
    buffer_load_dwordx4 v[196:199], v14, s[36:39], s88 offen offset:1024 sc1
    s_waitcnt lgkmcnt(6)
    v_mfma_f32_32x32x16_bf16 v[240:255], v[156:159], v[204:207], v[240:255]
    ds_read_b64_tr_b16 v[140:141], v5 offset:2048
    ds_read_b64_tr_b16 v[142:143], v5 offset:3072
    s_waitcnt vmcnt(12) lgkmcnt(6)
    v_mfma_f32_32x32x16_bf16 v[224:239], v[128:131], v[208:211], v[224:239]
    ds_read_b64_tr_b16 v[144:145], v4 offset:4096
    ds_read_b64_tr_b16 v[146:147], v4 offset:5120
    buffer_load_dwordx4 v[200:203], v14, s[36:39], s88 offen offset:2048 sc1
    s_waitcnt lgkmcnt(6)
    v_mfma_f32_32x32x16_bf16 v[240:255], v[132:135], v[208:211], v[240:255]
    ds_read_b64_tr_b16 v[148:149], v5 offset:4096
    ds_read_b64_tr_b16 v[150:151], v5 offset:5120
    s_waitcnt lgkmcnt(6)
    v_mfma_f32_32x32x16_bf16 v[224:239], v[136:139], v[212:215], v[224:239]
    ds_read_b64_tr_b16 v[152:153], v4 offset:6144
    ds_read_b64_tr_b16 v[154:155], v4 offset:7168
    buffer_load_dwordx4 v[204:207], v14, s[36:39], s88 offen offset:3072 sc1
    s_add_u32 s82, s82, 4096
    s_and_b32 s82, s82, 0xffff
    s_add_u32 s88, s82, s83
    s_waitcnt lgkmcnt(6)
    v_mfma_f32_32x32x16_bf16 v[240:255], v[140:143], v[212:215], v[240:255]
    ds_read_b64_tr_b16 v[156:157], v5 offset:6144
    ds_read_b64_tr_b16 v[158:159], v5 offset:7168
    v_add_u32 v4, 0x2000, v4
    v_and_b32 v4, 0x1ffff, v4
    v_xor_b32 v5, 64, v4
    s_waitcnt vmcnt(12) lgkmcnt(6)
    v_mfma_f32_32x32x16_bf16 v[224:239], v[144:147], v[216:219], v[224:239]
    ds_read_b64_tr_b16 v[128:129], v4 offset:0
    ds_read_b64_tr_b16 v[130:131], v4 offset:1024
    buffer_load_dwordx4 v[208:211], v14, s[36:39], s88 offen offset:0 sc1
    s_waitcnt lgkmcnt(6)
    v_mfma_f32_32x32x16_bf16 v[240:255], v[148:151], v[216:219], v[240:255]
    ds_read_b64_tr_b16 v[132:133], v5 offset:0
    ds_read_b64_tr_b16 v[134:135], v5 offset:1024
    s_waitcnt lgkmcnt(6)
    v_mfma_f32_32x32x16_bf16 v[224:239], v[152:155], v[220:223], v[224:239]
    ds_read_b64_tr_b16 v[136:137], v4 offset:2048
    ds_read_b64_tr_b16 v[138:139], v4 offset:3072
    buffer_load_dwordx4 v[212:215], v14, s[36:39], s88 offen offset:1024 sc1
    s_waitcnt lgkmcnt(6)
    v_mfma_f32_32x32x16_bf16 v[240:255], v[156:159], v[220:223], v[240:255]
    ds_read_b64_tr_b16 v[140:141], v5 offset:2048
    ds_read_b64_tr_b16 v[142:143], v5 offset:3072
    s_cmp_lt_u32 s84, 3
    s_cbranch_scc1 L_G2
    s_waitcnt vmcnt(12) lgkmcnt(6)
    v_mfma_f32_32x32x16_bf16 v[224:239], v[128:131], v[160:163], v[224:239]
    ds_read_b64_tr_b16 v[144:145], v4 offset:4096
    ds_read_b64_tr_b16 v[146:147], v4 offset:5120
    buffer_load_dwordx4 v[216:219], v14, s[36:39], s88 offen offset:2048 sc1
    s_waitcnt lgkmcnt(6)
    v_mfma_f32_32x32x16_bf16 v[240:255], v[132:135], v[160:163], v[240:255]
    ds_read_b64_tr_b16 v[148:149], v5 offset:4096
    ds_read_b64_tr_b16 v[150:151], v5 offset:5120
    s_waitcnt lgkmcnt(6)
    v_mfma_f32_32x32x16_bf16 v[224:239], v[136:139], v[164:167], v[224:239]
    ds_read_b64_tr_b16 v[152:153], v4 offset:6144
    ds_read_b64_tr_b16 v[154:155], v4 offset:7168
    buffer_load_dwordx4 v[220:223], v14, s[36:39], s88 offen offset:3072 sc1
    s_add_u32 s82, s82, 4096
    s_and_b32 s82, s82, 0xffff
    s_add_u32 s88, s82, s83
    s_waitcnt lgkmcnt(6)
    v_mfma_f32_32x32x16_bf16 v[240:255], v[140:143], v[164:167], v[240:255]
    ds_read_b64_tr_b16 v[156:157], v5 offset:6144
    ds_read_b64_tr_b16 v[158:159], v5 offset:7168
    s_barrier
    v_add_u32 v4, 0x2000, v4
    v_and_b32 v4, 0x1ffff, v4
    v_xor_b32_e64 v5, 64, v4
    s_waitcnt vmcnt(12) lgkmcnt(6)
    v_mfma_f32_32x32x16_bf16 v[224:239], v[144:147], v[168:171], v[224:239]
    ds_read_b64_tr_b16 v[128:129], v4 offset:0
    ds_read_b64_tr_b16 v[130:131], v4 offset:1024
    s_waitcnt lgkmcnt(6)
    v_mfma_f32_32x32x16_bf16 v[240:255], v[148:151], v[168:171], v[240:255]
    ds_read_b64_tr_b16 v[132:133], v5 offset:0
    ds_read_b64_tr_b16 v[134:135], v5 offset:1024
    s_waitcnt lgkmcnt(6)
    v_mfma_f32_32x32x16_bf16 v[224:239], v[152:155], v[172:175], v[224:239]
    ds_read_b64_tr_b16 v[136:137], v4 offset:2048
    ds_read_b64_tr_b16 v[138:139], v4 offset:3072
    s_waitcnt lgkmcnt(6)
    v_mfma_f32_32x32x16_bf16 v[240:255], v[156:159], v[172:175], v[240:255]
    ds_read_b64_tr_b16 v[140:141], v5 offset:2048
    ds_read_b64_tr_b16 v[142:143], v5 offset:3072
    s_waitcnt vmcnt(10) lgkmcnt(6)
    v_mfma_f32_32x32x16_bf16 v[224:239], v[128:131], v[176:179], v[224:239]
    ds_read_b64_tr_b16 v[144:145], v4 offset:4096
    ds_read_b64_tr_b16 v[146:147], v4 offset:5120
    s_waitcnt lgkmcnt(6)
    v_mfma_f32_32x32x16_bf16 v[240:255], v[132:135], v[176:179], v[240:255]
    ds_read_b64_tr_b16 v[148:149], v5 offset:4096
    ds_read_b64_tr_b16 v[150:151], v5 offset:5120
    s_waitcnt lgkmcnt(6)
    v_mfma_f32_32x32x16_bf16 v[224:239], v[136:139], v[180:183], v[224:239]
    ds_read_b64_tr_b16 v[152:153], v4 offset:6144
    ds_read_b64_tr_b16 v[154:155], v4 offset:7168
    s_waitcnt lgkmcnt(6)
    v_mfma_f32_32x32x16_bf16 v[240:255], v[140:143], v[180:183], v[240:255]
    ds_read_b64_tr_b16 v[156:157], v5 offset:6144
    ds_read_b64_tr_b16 v[158:159], v5 offset:7168
    v_add_u32 v4, 0x2000, v4
    v_and_b32 v4, 0x1ffff, v4
    v_xor_b32_e64 v5, 64, v4
    s_waitcnt vmcnt(8) lgkmcnt(6)
    v_mfma_f32_32x32x16_bf16 v[224:239], v[144:147], v[184:187], v[224:239]
    ds_read_b64_tr_b16 v[128:129], v4 offset:0
    ds_read_b64_tr_b16 v[130:131], v4 offset:1024
    s_waitcnt lgkmcnt(6)
    v_mfma_f32_32x32x16_bf16 v[240:255], v[148:151], v[184:187], v[240:255]
    ds_read_b64_tr_b16 v[132:133], v5 offset:0
    ds_read_b64_tr_b16 v[134:135], v5 offset:1024
    s_waitcnt lgkmcnt(6)
    v_mfma_f32_32x32x16_bf16 v[224:239], v[152:155], v[188:191], v[224:239]
    ds_read_b64_tr_b16 v[136:137], v4 offset:2048
    ds_read_b64_tr_b16 v[138:139], v4 offset:3072
    s_waitcnt lgkmcnt(6)
    v_mfma_f32_32x32x16_bf16 v[240:255], v[156:159], v[188:191], v[240:255]
    ds_read_b64_tr_b16 v[140:141], v5 offset:2048
    ds_read_b64_tr_b16 v[142:143], v5 offset:3072
    s_waitcnt vmcnt(6) lgkmcnt(6)
    v_mfma_f32_32x32x16_bf16 v[224:239], v[128:131], v[192:195], v[224:239]
    ds_read_b64_tr_b16 v[144:145], v4 offset:4096
    ds_read_b64_tr_b16 v[146:147], v4 offset:5120
    s_waitcnt lgkmcnt(6)
    v_mfma_f32_32x32x16_bf16 v[240:255], v[132:135], v[192:195], v[240:255]
    ds_read_b64_tr_b16 v[148:149], v5 offset:4096
    ds_read_b64_tr_b16 v[150:151], v5 offset:5120
    s_waitcnt lgkmcnt(6)
    v_mfma_f32_32x32x16_bf16 v[224:239], v[136:139], v[196:199], v[224:239]
    ds_read_b64_tr_b16 v[152:153], v4 offset:6144
    ds_read_b64_tr_b16 v[154:155], v4 offset:7168
    s_waitcnt lgkmcnt(6)
    v_mfma_f32_32x32x16_bf16 v[240:255], v[140:143], v[196:199], v[240:255]
    ds_read_b64_tr_b16 v[156:157], v5 offset:6144
    ds_read_b64_tr_b16 v[158:159], v5 offset:7168
    v_add_u32 v4, 0x2000, v4
    v_and_b32 v4, 0x1ffff, v4
    v_xor_b32_e64 v5, 64, v4
    s_waitcnt vmcnt(4) lgkmcnt(6)
    v_mfma_f32_32x32x16_bf16 v[224:239], v[144:147], v[200:203], v[224:239]
    ds_read_b64_tr_b16 v[128:129], v4 offset:0
    ds_read_b64_tr_b16 v[130:131], v4 offset:1024
    s_waitcnt lgkmcnt(6)
    v_mfma_f32_32x32x16_bf16 v[240:255], v[148:151], v[200:203], v[240:255]
    ds_read_b64_tr_b16 v[132:133], v5 offset:0
    ds_read_b64_tr_b16 v[134:135], v5 offset:1024
    s_waitcnt lgkmcnt(6)
    v_mfma_f32_32x32x16_bf16 v[224:239], v[152:155], v[204:207], v[224:239]
    ds_read_b64_tr_b16 v[136:137], v4 offset:2048
    ds_read_b64_tr_b16 v[138:139], v4 offset:3072
    s_waitcnt lgkmcnt(6)
    v_mfma_f32_32x32x16_bf16 v[240:255], v[156:159], v[204:207], v[240:255]
    ds_read_b64_tr_b16 v[140:141], v5 offset:2048
    ds_read_b64_tr_b16 v[142:143], v5 offset:3072
    s_waitcnt vmcnt(2) lgkmcnt(6)
    v_mfma_f32_32x32x16_bf16 v[224:239], v[128:131], v[208:211], v[224:239]
    ds_read_b64_tr_b16 v[144:145], v4 offset:4096
    ds_read_b64_tr_b16 v[146:147], v4 offset:5120
    s_waitcnt lgkmcnt(6)
    v_mfma_f32_32x32x16_bf16 v[240:255], v[132:135], v[208:211], v[240:255]
    ds_read_b64_tr_b16 v[148:149], v5 offset:4096
    ds_read_b64_tr_b16 v[150:151], v5 offset:5120
    s_waitcnt lgkmcnt(6)
    v_mfma_f32_32x32x16_bf16 v[224:239], v[136:139], v[212:215], v[224:239]
    ds_read_b64_tr_b16 v[152:153], v4 offset:6144
    ds_read_b64_tr_b16 v[154:155], v4 offset:7168
    s_waitcnt lgkmcnt(6)
    v_mfma_f32_32x32x16_bf16 v[240:255], v[140:143], v[212:215], v[240:255]
    ds_read_b64_tr_b16 v[156:157], v5 offset:6144
    ds_read_b64_tr_b16 v[158:159], v5 offset:7168
    s_waitcnt vmcnt(0) lgkmcnt(6)
    v_mfma_f32_32x32x16_bf16 v[224:239], v[144:147], v[216:219], v[224:239]
    s_waitcnt lgkmcnt(4)
    v_mfma_f32_32x32x16_bf16 v[240:255], v[148:151], v[216:219], v[240:255]
    s_waitcnt lgkmcnt(2)
    v_mfma_f32_32x32x16_bf16 v[224:239], v[152:155], v[220:223], v[224:239]
    s_waitcnt lgkmcnt(0)
    v_mfma_f32_32x32x16_bf16 v[240:255], v[156:159], v[220:223], v[240:255]
    s_nop 9
    v_pk_mul_f32 v[18:19], v[224:225], v[224:225]
    v_pk_mul_f32 v[20:21], v[224:225], v[60:61]
    v_pk_add_f32 v[16:17], v[224:225], v[226:227]
    v_pk_fma_f32 v[18:19], v[226:227], v[226:227], v[18:19]
    v_pk_fma_f32 v[20:21], v[226:227], v[62:63], v[20:21]
    v_pk_add_f32 v[16:17], v[16:17], v[228:229]
    v_pk_fma_f32 v[18:19], v[228:229], v[228:229], v[18:19]
    v_pk_fma_f32 v[20:21], v[228:229], v[64:65], v[20:21]
    v_pk_add_f32 v[16:17], v[16:17], v[230:231]
    v_pk_fma_f32 v[18:19], v[230:231], v[230:231], v[18:19]
    v_pk_fma_f32 v[20:21], v[230:231], v[66:67], v[20:21]
    v_pk_add_f32 v[16:17], v[16:17], v[232:233]
    v_pk_fma_f32 v[18:19], v[232:233], v[232:233], v[18:19]
    v_pk_fma_f32 v[20:21], v[232:233], v[68:69], v[20:21]
    v_pk_add_f32 v[16:17], v[16:17], v[234:235]
    v_pk_fma_f32 v[18:19], v[234:235], v[234:235], v[18:19]
    v_pk_fma_f32 v[20:21], v[234:235], v[70:71], v[20:21]
    v_pk_add_f32 v[16:17], v[16:17], v[236:237]
    v_pk_fma_f32 v[18:19], v[236:237], v[236:237], v[18:19]
    v_pk_fma_f32 v[20:21], v[236:237], v[72:73], v[20:21]
    v_pk_add_f32 v[16:17], v[16:17], v[238:239]
    v_pk_fma_f32 v[18:19], v[238:239], v[238:239], v[18:19]
    v_pk_fma_f32 v[20:21], v[238:239], v[74:75], v[20:21]
    v_pk_add_f32 v[16:17], v[16:17], v[240:241]
    v_pk_fma_f32 v[18:19], v[240:241], v[240:241], v[18:19]
    v_pk_fma_f32 v[20:21], v[240:241], v[76:77], v[20:21]
    v_pk_add_f32 v[16:17], v[16:17], v[242:243]
    v_pk_fma_f32 v[18:19], v[242:243], v[242:243], v[18:19]
    v_pk_fma_f32 v[20:21], v[242:243], v[78:79], v[20:21]
    v_pk_add_f32 v[16:17], v[16:17], v[244:245]
    v_pk_fma_f32 v[18:19], v[244:245], v[244:245], v[18:19]
    v_pk_fma_f32 v[20:21], v[244:245], v[80:81], v[20:21]
    v_pk_add_f32 v[16:17], v[16:17], v[246:247]
    v_pk_fma_f32 v[18:19], v[246:247], v[246:247], v[18:19]
    v_pk_fma_f32 v[20:21], v[246:247], v[82:83], v[20:21]
    v_pk_add_f32 v[16:17], v[16:17], v[248:249]
    v_pk_fma_f32 v[18:19], v[248:249], v[248:249], v[18:19]
    v_pk_fma_f32 v[20:21], v[248:249], v[84:85], v[20:21]
    v_pk_add_f32 v[16:17], v[16:17], v[250:251]
    v_pk_fma_f32 v[18:19], v[250:251], v[250:251], v[18:19]
    v_pk_fma_f32 v[20:21], v[250:251], v[86:87], v[20:21]
    v_pk_add_f32 v[16:17], v[16:17], v[252:253]
    v_pk_fma_f32 v[18:19], v[252:253], v[252:253], v[18:19]
    v_pk_fma_f32 v[20:21], v[252:253], v[88:89], v[20:21]
    v_pk_add_f32 v[16:17], v[16:17], v[254:255]
    v_pk_fma_f32 v[18:19], v[254:255], v[254:255], v[18:19]
    v_pk_fma_f32 v[20:21], v[254:255], v[90:91], v[20:21]
    v_mov_b32 v27, s75
    v_add_f32 v24, v16, v17
    v_add_f32 v25, v18, v19
    v_add_f32 v26, v20, v21
    v_mov_b32 v28, v24
    v_mov_b32 v29, v25
    v_mov_b32 v30, v26
    v_permlane32_swap_b32 v24, v28
    v_permlane32_swap_b32 v25, v29
    v_permlane32_swap_b32 v26, v30
    v_pk_add_f32 v[24:25], v[24:25], v[28:29]
    v_add_f32 v26, v26, v30
    s_mov_b32 exec_hi, 0
    s_bitcmp1_b32 s99, 1
    s_cbranch_scc1 Lls_41
    buffer_store_dwordx4 v[24:27], v14, s[36:39], s95 offen sc1
    s_branch Lle_42
Lls_41:
    buffer_store_dwordx4 v[24:27], v14, s[36:39], s95 offen
Lle_42:
    s_mov_b32 exec_hi, -1
    s_add_u32 s79, s94, 4096
    s_add_u32 s80, s94, 8192
    s_add_u32 s81, s94, 12288
    s_barrier
    s_nop 0
    buffer_load_dwordx4 v[64:67], v12, s[36:39], s94 offen offset:0 sc1
    buffer_load_dwordx4 v[68:71], v12, s[36:39], s94 offen offset:2048 sc1
    buffer_load_dwordx4 v[72:75], v12, s[36:39], s79 offen offset:0 sc1
    buffer_load_dwordx4 v[76:79], v12, s[36:39], s79 offen offset:2048 sc1
    buffer_load_dwordx4 v[80:83], v12, s[36:39], s80 offen offset:0 sc1
    buffer_load_dwordx4 v[84:87], v12, s[36:39], s80 offen offset:2048 sc1
    buffer_load_dwordx4 v[88:91], v12, s[36:39], s81 offen offset:0 sc1
    buffer_load_dwordx4 v[92:95], v12, s[36:39], s81 offen offset:2048 sc1
    v_xor_b32_e64 v112, 0, v13
    ds_write_b128 v112, v[224:227]
    v_xor_b32_e64 v113, 32, v13
    ds_write_b128 v113, v[228:231]
    v_xor_b32_e64 v114, 64, v13
    ds_write_b128 v114, v[232:235]
    v_xor_b32 v115, 96, v13
    ds_write_b128 v115, v[236:239]
    v_xor_b32 v116, 128, v13
    ds_write_b128 v116, v[240:243]
    v_xor_b32 v117, 160, v13
    ds_write_b128 v117, v[244:247]
    v_xor_b32 v118, 192, v13
    ds_write_b128 v118, v[248:251]
    v_xor_b32 v119, 224, v13
    ds_write_b128 v119, v[252:255]
    s_mov_b32 s85, 1
    s_branch L_gchk
Lspin_43:
    s_add_u32 s85, s85, 1
    s_cmp_gt_u32 s85, 400000
    s_cbranch_scc1 L_end
    buffer_load_dwordx4 v[64:67], v12, s[36:39], s94 offen offset:0 sc1
    buffer_load_dwordx4 v[68:71], v12, s[36:39], s94 offen offset:2048 sc1
    buffer_load_dwordx4 v[72:75], v12, s[36:39], s79 offen offset:0 sc1
    buffer_load_dwordx4 v[76:79], v12, s[36:39], s79 offen offset:2048 sc1
    buffer_load_dwordx4 v[80:83], v12, s[36:39], s80 offen offset:0 sc1
    buffer_load_dwordx4 v[84:87], v12, s[36:39], s80 offen offset:2048 sc1
    buffer_load_dwordx4 v[88:91], v12, s[36:39], s81 offen offset:0 sc1
    buffer_load_dwordx4 v[92:95], v12, s[36:39], s81 offen offset:2048 sc1
L_gchk:
    s_waitcnt vmcnt(0)
    s_nop 0
    v_max3_u32 v16, v67, v71, v75
    v_max3_u32 v16, v16, v79, v83
    v_max3_u32 v16, v16, v87, v91
    v_max3_u32 v16, v16, v95, s75
    v_min3_u32 v17, v67, v71, v75
    v_min3_u32 v17, v17, v79, v83
    v_min3_u32 v17, v17, v87, v91
    v_min3_u32 v17, v17, v95, s75
    v_cmp_ne_u32 vcc, v16, v17
    s_cbranch_vccnz Lspin_43
    v_pk_add_f32 v[64:65], v[64:65], v[68:69]
    v_add_f32_e64 v66, v66, v70
    v_pk_add_f32 v[72:73], v[72:73], v[76:77]
    v_add_f32_e64 v74, v74, v78
    v_pk_add_f32 v[80:81], v[80:81], v[84:85]
    v_add_f32_e64 v82, v82, v86
    v_pk_add_f32 v[88:89], v[88:89], v[92:93]
    v_add_f32_e64 v90, v90, v94
    v_pk_add_f32 v[64:65], v[64:65], v[72:73]
    v_add_f32_e64 v66, v66, v74
    v_pk_add_f32 v[80:81], v[80:81], v[88:89]
    v_add_f32 v82, v82, v90
    v_add_f32 v24, v64, v80
    v_add_f32 v25, v65, v81
    v_add_f32 v26, v66, v82
    v_mov_b32 v28, v24
    v_mov_b32 v29, v25
    v_mov_b32 v30, v26
    v_permlane32_swap_b32 v24, v28
    v_permlane32_swap_b32 v25, v29
    v_permlane32_swap_b32 v26, v30
    v_pk_add_f32 v[24:25], v[24:25], v[28:29]
    v_add_f32_e64 v26, v26, v30
    v_mul_f32 v36, 0x3a800000, v24
    v_mul_f32 v40, 0x3a800000, v25
    v_fma_f32 v40, -v36, v36, v40
    v_max_f32_e64 v40, 0, v40
    v_cvt_pk_bf16_f32 v36, v36, v36
    v_and_b32 v36, 0xffff0000, v36
    v_cvt_pk_bf16_f32 v40, v40, v40
    v_and_b32 v40, 0xffff0000, v40
    v_add_f32 v40, 0x3727c5ac, v40
    v_cvt_pk_bf16_f32 v40, v40, v40
    v_and_b32 v40, 0xffff0000, v40
    v_sqrt_f32 v40, v40
    s_nop 0
    v_cvt_pk_bf16_f32 v40, v40, v40
    v_and_b32 v40, 0xffff0000, v40
    v_rcp_f32_e64 v38, v40
    v_fma_f32 v42, -v36, v126, v26
    s_mov_b32 s79, 0xfffff800
    v_mul_f32_e64 v42, v42, v38
    v_mul_f32 v39, -v36, v38
    v_and_or_b32 v42, v42, s79, v11
    ds_write_b64 v10, v[38:39]
    s_nop 0
    v_max_f32_dpp v42, v42, v42 row_ror:8 row_mask:0xf bank_mask:0xf
    s_nop 1
    v_max_f32_dpp v42, v42, v42 row_ror:4 row_mask:0xf bank_mask:0xf
    s_nop 1
    v_max_f32_dpp v42, v42, v42 row_ror:2 row_mask:0xf bank_mask:0xf
    s_nop 1
    v_max_f32_dpp v42, v42, v42 row_ror:1 row_mask:0xf bank_mask:0xf
    s_lshl_b32 s78, s76, 3
    s_add_u32 s78, s78, 163328
    v_bfe_u32 v16, v2, 4, 1
    v_lshl_add_u32 v16, v16, 2, s78
    ds_write_b32 v16, v42
    v_mov_b32 v16, 163328
    s_waitcnt lgkmcnt(0)
    s_barrier
    ds_read_b128 v[20:23], v16
    ds_read_b128 v[24:27], v16 offset:16
    s_lshl_b32 s79, s71, 4
    s_add_u32 s79, s79, s72
    s_lshl_b32 s79, s79, 9
    s_add_u32 s79, s79, 524288
    v_lshlrev_b32 v17, 3, v2
    v_lshlrev_b32_e64 v18, 2, v2
    s_waitcnt lgkmcnt(0)
    v_max3_f32 v20, v20, v21, v22
    v_max3_f32 v24, v24, v25, v26
    v_max_f32_e64 v23, v23, v27
    v_max3_f32 v20, v20, v24, v23
    v_mov_b32 v21, s75
    s_cmp_lg_u32 s76, 0
    s_cbranch_scc1 L_nocand
    s_mov_b32 exec_hi, 0
    v_and_b32 v22, 127, v20
    v_and_b32 v23, 7, v20
    v_lshlrev_b32 v23, 4, v23
    v_xor_b32_e64 v23, v23, v17
    v_lshl_add_u32 v23, v22, 8, v23
    v_lshlrev_b32_e64 v22, 3, v22
    ds_read_b64 v[24:25], v23
    v_add_u32 v22, 159744, v22
    ds_read_b64 v[26:27], v22
    s_mov_b32 exec_lo, 0xffff
    buffer_store_dwordx2 v[20:21], v17, s[36:39], s79 offen offset:128 sc1
    s_mov_b32 exec_lo, -1
    s_waitcnt lgkmcnt(0)
    v_fma_f32 v28, v24, v26, v27
    v_fma_f32 v29, v25, v26, v27
    v_cvt_pk_bf16_f32 v30, v28, v29
    buffer_store_dword v30, v18, s[36:39], s79 offen sc1
    v_add_f32 v28, v28, v24
    v_add_f32 v29, v29, v25
    buffer_store_dwordx2 v[28:29], v17, s[36:39], s79 offen offset:256 sc1
    s_mov_b32 exec_hi, -1
L_nocand:
    v_lshrrev_b32 v16, 3, v2
    v_and_b32 v17, 7, v2
    s_lshl_b32 s78, s76, 5
    v_add_u32 v18, s78, v16
    v_lshlrev_b32 v19, 1, v17
    v_xor_b32 v19, v19, v16
    v_lshlrev_b32 v19, 4, v19
    v_lshl_add_u32 v19, v18, 8, v19
    v_xor_b32 v32, 16, v19
    v_lshlrev_b32 v33, 3, v18
    v_add_u32 v33, 159744, v33
    ds_read_b128 v[64:67], v19 offset:0
    ds_read_b128 v[68:71], v32 offset:0
    ds_read_b64 v[96:97], v33 offset:0
    ds_read_b128 v[72:75], v19 offset:2048
    ds_read_b128 v[76:79], v32 offset:2048
    ds_read_b64 v[98:99], v33 offset:64
    ds_read_b128 v[80:83], v19 offset:4096
    ds_read_b128 v[84:87], v32 offset:4096
    ds_read_b64 v[100:101], v33 offset:128
    ds_read_b128 v[88:91], v19 offset:6144
    ds_read_b128 v[92:95], v32 offset:6144
    ds_read_b64 v[102:103], v33 offset:192
    s_lshl_b32 s78, s71, 7
    v_add_u32_e64 v18, s78, v18
    s_lshl_b32 s79, s72, 7
    v_lshl_add_u32 v19, v18, 11, s79
    v_lshl_add_u32 v19, v17, 4, v19
    v_mov_b32 v16, 163360
    s_waitcnt lgkmcnt(0)
    v_add_f32 v96, 1.0, v96
    v_pk_fma_f32 v[64:65], v[64:65], v[96:97], v[96:97] op_sel:[0,0,1] op_sel_hi:[1,0,1]
    v_pk_fma_f32 v[66:67], v[66:67], v[96:97], v[96:97] op_sel:[0,0,1] op_sel_hi:[1,0,1]
    v_pk_fma_f32 v[68:69], v[68:69], v[96:97], v[96:97] op_sel:[0,0,1] op_sel_hi:[1,0,1]
    v_pk_fma_f32 v[70:71], v[70:71], v[96:97], v[96:97] op_sel:[0,0,1] op_sel_hi:[1,0,1]
    v_cvt_pk_bf16_f32 v104, v64, v65
    v_cvt_pk_bf16_f32 v105, v66, v67
    v_cvt_pk_bf16_f32 v106, v68, v69
    v_cvt_pk_bf16_f32 v107, v70, v71
    v_add_f32_e64 v98, 1.0, v98
    v_pk_fma_f32 v[72:73], v[72:73], v[98:99], v[98:99] op_sel:[0,0,1] op_sel_hi:[1,0,1]
    v_pk_fma_f32 v[74:75], v[74:75], v[98:99], v[98:99] op_sel:[0,0,1] op_sel_hi:[1,0,1]
    v_pk_fma_f32 v[76:77], v[76:77], v[98:99], v[98:99] op_sel:[0,0,1] op_sel_hi:[1,0,1]
    v_pk_fma_f32 v[78:79], v[78:79], v[98:99], v[98:99] op_sel:[0,0,1] op_sel_hi:[1,0,1]
    v_cvt_pk_bf16_f32 v108, v72, v73
    v_cvt_pk_bf16_f32 v109, v74, v75
    v_cvt_pk_bf16_f32 v110, v76, v77
    v_cvt_pk_bf16_f32 v111, v78, v79
    v_add_f32_e64 v100, 1.0, v100
    v_pk_fma_f32 v[80:81], v[80:81], v[100:101], v[100:101] op_sel:[0,0,1] op_sel_hi:[1,0,1]
    v_pk_fma_f32 v[82:83], v[82:83], v[100:101], v[100:101] op_sel:[0,0,1] op_sel_hi:[1,0,1]
    v_pk_fma_f32 v[84:85], v[84:85], v[100:101], v[100:101] op_sel:[0,0,1] op_sel_hi:[1,0,1]
    v_pk_fma_f32 v[86:87], v[86:87], v[100:101], v[100:101] op_sel:[0,0,1] op_sel_hi:[1,0,1]
    v_cvt_pk_bf16_f32 v112, v80, v81
    v_cvt_pk_bf16_f32 v113, v82, v83
    v_cvt_pk_bf16_f32 v114, v84, v85
    v_cvt_pk_bf16_f32 v115, v86, v87
    v_add_f32_e64 v102, 1.0, v102
    v_pk_fma_f32 v[88:89], v[88:89], v[102:103], v[102:103] op_sel:[0,0,1] op_sel_hi:[1,0,1]
    v_pk_fma_f32 v[90:91], v[90:91], v[102:103], v[102:103] op_sel:[0,0,1] op_sel_hi:[1,0,1]
    v_pk_fma_f32 v[92:93], v[92:93], v[102:103], v[102:103] op_sel:[0,0,1] op_sel_hi:[1,0,1]
    v_pk_fma_f32 v[94:95], v[94:95], v[102:103], v[102:103] op_sel:[0,0,1] op_sel_hi:[1,0,1]
    v_cvt_pk_bf16_f32 v116, v88, v89
    v_cvt_pk_bf16_f32 v117, v90, v91
    v_cvt_pk_bf16_f32 v118, v92, v93
    v_cvt_pk_bf16_f32 v119, v94, v95
    s_barrier
    ds_read_b32 v17, v16
    s_waitcnt lgkmcnt(0)
    v_and_b32 v17, 0x7ff, v17
    v_sub_u32 v17, v17, v18
    s_barrier
    s_barrier
    s_mov_b32 s78, 0
    v_cmp_ne_u32_e64 vcc, 0, v17
    s_mov_b64 exec, vcc
    s_cbranch_execz Lo_44
    buffer_store_dwordx4 v[104:107], v19, s[44:47], s78 offen sc1
Lo_44:
    s_mov_b64 exec, -1
    s_mov_b32 s78, 16384
    v_cmp_ne_u32 vcc, 8, v17
    s_mov_b64 exec, vcc
    s_cbranch_execz Lo_45
    buffer_store_dwordx4 v[108:111], v19, s[44:47], s78 offen sc1
Lo_45:
    s_mov_b64 exec, -1
    s_mov_b32 s78, 32768
    v_cmp_ne_u32 vcc, 16, v17
    s_mov_b64 exec, vcc
    s_cbranch_execz Lo_46
    buffer_store_dwordx4 v[112:115], v19, s[44:47], s78 offen sc1
Lo_46:
    s_mov_b64 exec, -1
    s_mov_b32 s78, 49152
    v_cmp_ne_u32 vcc, 24, v17
    s_mov_b64 exec, vcc
    s_cbranch_execz Lo_47
    buffer_store_dwordx4 v[116:119], v19, s[44:47], s78 offen sc1
Lo_47:
    s_mov_b64 exec, -1
    s_branch L_fin
L_fin:
L_end:
    s_endpgm
.fill 64, 4, 0xbf800000
s_endpgm
.section .rodata,"a"
.p2align 6
.amdhsa_kernel sequential_preLN__linear_kernel_hedgehog__moe_arch_mod__prompt_kernel
  .amdhsa_next_free_vgpr 256
  .amdhsa_next_free_sgpr 102
  .amdhsa_accum_offset 256
  .amdhsa_group_segment_fixed_size 0
  .amdhsa_kernarg_size 96
  .amdhsa_user_sgpr_count 2
  .amdhsa_user_sgpr_kernarg_segment_ptr 1
  .amdhsa_system_sgpr_workgroup_id_x 1
  .amdhsa_float_denorm_mode_32 3
.end_amdhsa_kernel
```

```asm
; @launch grid=(256,1,1) block=(512,1,1) lds=163840
.amdgcn_target "amdgcn-amd-amdhsa--gfx950"
.text
.globl sequential_preLN__linear_kernel_hedgehog__moe_arch_mod__prompt_kernel
.p2align 8
.type sequential_preLN__linear_kernel_hedgehog__moe_arch_mod__prompt_kernel,@function
sequential_preLN__linear_kernel_hedgehog__moe_arch_mod__prompt_kernel:
    s_cmp_ge_u32 s2, 256
    s_cbranch_scc1 L_end
    s_load_dwordx16 s[4:19], s[0:1], 0
    s_load_dwordx8 s[20:27], s[0:1], 64
    v_lshrrev_b32 v1, 6, v0
    v_and_b32_e64 v2, 63, v0
    v_readfirstlane_b32 s68, v1
    s_lshr_b32 s69, s2, 4
    s_and_b32 s70, s2, 7
    s_lshl_b32 s70, s70, 1
    s_bfe_u32 s78, s2, 0x10003
    s_or_b32 s70, s70, s78
    s_and_b32 s76, s68, 3
    s_cmp_ge_u32 s68, 4
    s_cbranch_scc1 L_M
    v_lshrrev_b32 v196, 3, v2
    v_and_b32 v197, 7, v2
    v_lshrrev_b32_e64 v198, 4, v2
    s_and_b32 s80, s69, 0
    s_lshl_b32 s89, s76, 11
    s_lshl_b32 s66, s80, 10
    s_or_b32 s66, s66, s89
    s_xor_b32 s67, s66, 1024
    s_lshl_b32 s79, s70, 7
    s_movk_i32 s78, 6144
    v_mov_b32_e64 v199, s79
    v_mad_u32_u24 v199, v196, s78, v199
    s_lshl_b32 s80, s80, 2
    v_and_b32 v200, 2, v196
    v_xor_b32 v200, v200, v197
    v_xor_b32 v200, s80, v200
    v_lshl_add_u32 v199, v200, 4, v199
    s_mul_i32 s78, s66, 48
    s_mul_i32 s79, s67, 48
    v_add_u32 v6, s78, v199
    v_xor_b32 v199, 64, v199
    v_add_u32_e64 v7, s79, v199
    s_and_b32 s80, s70, 0
    s_lshl_b32 s88, s76, 12
    s_lshl_b32 s64, s80, 10
    s_or_b32 s64, s64, s88
    s_xor_b32 s65, s64, 1024
    s_lshl_b32 s80, s80, 2
    s_lshl_b32 s78, s69, 14
    s_add_u32 s78, s78, s64
    s_lshl_b32 s78, s78, 4
    v_lshl_add_u32 v199, v196, 11, s78
    v_xor_b32 v200, v198, v197
    v_xor_b32 v200, s80, v200
    v_lshl_add_u32 v4, v200, 4, v199
    v_xor_b32 v5, 16448, v4
    s_and_b32 s78, s70, 14
    s_and_b32 s79, s69, 14
    s_add_u32 s78, s78, s79
    s_sub_u32 s78, 32, s78
    s_and_b32 s78, s78, 15
    s_lshl_b32 s86, s78, 7
    s_mul_i32 s87, s78, 393216
    s_mov_b32 s30, 0x400000
    s_mov_b32 s31, 0x20000
    s_mov_b32 s34, 0x600000
    s_mov_b32 s35, 0x20000
    s_waitcnt lgkmcnt(0)
    s_mov_b32 s32, s6
    s_and_b32 s33, s7, 0xffff
    s_mov_b32 s28, s4
    s_and_b32 s29, s5, 0xffff
    s_add_u32 m0, s64, 118784
    s_nop 0
    buffer_load_dwordx4 v4, s[28:31], s86 offen offset:0  lds
    s_add_u32 m0, s66, 141312
    s_nop 0
    s_nop 0
    buffer_load_dwordx4 v6, s[32:35], s87 offen offset:2048  lds
    s_add_u32 m0, s64, 120832
    s_add_u32 s101, s86, 32768
    buffer_load_dwordx4 v4, s[28:31], s101 offen offset:0  lds
    s_add_u32 m0, s66, 151552
    s_add_u32 s101, s87, 4096
    buffer_load_dwordx4 v6, s[32:35], s101 offen offset:0  lds
    s_add_u32 m0, s66, 135168
    s_nop 0
    buffer_load_dwordx4 v6, s[32:35], s87 offen offset:0  lds
    s_add_u32 m0, s65, 118784
    s_nop 0
    buffer_load_dwordx4 v5, s[28:31], s86 offen offset:0  lds
    s_add_u32 m0, s67, 141312
    s_nop 0
    s_nop 0
    buffer_load_dwordx4 v7, s[32:35], s87 offen offset:2048  lds
    s_add_u32 m0, s65, 120832
    s_add_u32 s101, s86, 32768
    buffer_load_dwordx4 v5, s[28:31], s101 offen offset:0  lds
    s_add_u32 m0, s67, 151552
    s_add_u32 s101, s87, 4096
    buffer_load_dwordx4 v7, s[32:35], s101 offen offset:0  lds
    s_add_u32 m0, s67, 135168
    s_nop 0
    buffer_load_dwordx4 v7, s[32:35], s87 offen offset:0  lds
    s_add_u32 s86, s86, 128
    s_add_u32 s87, s87, 393216
    s_and_b32 s86, s86, 2047
    s_cselect_b32 s87, s87, 0
    s_mov_b32 s101, 40960
    s_cmp_ge_i32 s64, 0
    s_cselect_b32 s101, 0xfffec000, s101
    s_add_u32 s64, s64, s101
    s_add_u32 s65, s65, s101
    s_add_u32 s66, s66, s101
    s_add_u32 s67, s67, s101
    s_load_dword s75, s[26:27], 0
    s_mov_b32 s60, s8
    s_and_b32 s61, s9, 0xffff
    s_mov_b32 s62, 0x10000
    s_mov_b32 s63, 0x20000
    v_lshlrev_b32 v14, 4, v2
    s_lshl_b32 s78, s70, 12
    s_lshl_b32 s79, s76, 10
    s_add_u32 s78, s78, s79
    s_add_u32 m0, s79, 159744
    s_nop 0
    buffer_load_dwordx4 v14, s[60:63], s78 offen lds
    s_and_b32 s78, s2, 7
    s_lshr_b32 s79, s2, 3
    s_lshl_b32 s71, s78, 1
    s_and_b32 s72, s79, 1
    s_add_u32 s71, s71, s72
    s_lshr_b32 s72, s79, 1
    s_cmp_gt_u32 s70, 3
    s_cselect_b32 s78, 1, 0
    s_cmp_gt_u32 s70, 11
    s_cselect_b32 s78, 2, s78
    s_sub_u32 s78, s70, s78
    s_cmp_eq_u32 s70, 3
    s_cselect_b32 s78, 14, s78
    s_cmp_eq_u32 s70, 11
    s_cselect_b32 s78, 15, s78
    s_lshl_b32 s0, s78, 4
    s_add_u32 s0, s0, s69
    s_lshr_b32 s73, s0, 2
    s_and_b32 s74, s0, 3
    s_lshl_b32 s77, s70, 4
    s_add_u32 s77, s77, s69
    s_mov_b32 s36, s26
    s_and_b32 s37, s27, 0xffff
    s_mov_b32 s38, 0x10000000
    s_mov_b32 s39, 0x20000
    s_mov_b32 s40, s10
    s_and_b32 s41, s11, 0xffff
    s_mov_b32 s42, 0x200000
    s_mov_b32 s43, 0x20000
    s_mov_b32 s44, s22
    s_and_b32 s45, s23, 0xffff
    s_mov_b32 s46, 0x400000
    s_mov_b32 s47, 0x20000
    s_mov_b32 s48, s16
    s_and_b32 s49, s17, 0xffff
    s_mov_b32 s50, 0x700000
    s_mov_b32 s51, 0x20000
    s_mov_b32 s52, s18
    s_and_b32 s53, s19, 0xffff
    s_mov_b32 s54, 0x700000
    s_mov_b32 s55, 0x20000
    s_mov_b32 s56, s20
    s_and_b32 s57, s21, 0xffff
    s_mov_b32 s58, 0x700000
    s_mov_b32 s59, 0x20000
    v_mov_b32 v16, -1
    v_mov_b32 v17, -1
    v_mov_b32 v18, -1
    v_mov_b32_e64 v19, -1
    s_lshl_b32 s94, s77, 14
    s_lshl_b32 s78, s76, 12
    s_add_u32 s94, s94, s78
    s_add_u32 s94, s94, 4194304
    s_lshl_b32 s96, s77, 10
    s_add_u32 s96, s96, 8388608
    s_cmp_eq_u32 s76, 3
    s_cselect_b32 s96, s96, 0x10000000
    v_and_b32 v196, 15, v2
    v_lshrrev_b32 v197, 1, v196
    v_lshlrev_b32 v199, 7, v196
    v_add_u32 v199, s88, v199
    v_xor_b32_e64 v200, v198, v197
    v_lshl_add_u32 v60, v200, 4, v199
    v_bfe_u32 v196, v2, 2, 2
    v_and_b32_e64 v197, 3, v2
    v_lshl_add_u32 v199, v198, 3, v196
    v_lshlrev_b32_e64 v199, 7, v199
    v_lshl_add_u32 v199, v197, 3, v199
    v_lshrrev_b32 v196, 1, v196
    v_and_b32 v197, 1, v198
    v_lshl_add_u32 v196, v197, 1, v196
    s_mul_i32 s80, s76, 3
    s_add_u32 s78, s80, 0
    s_and_b32 s79, s78, 3
    s_lshr_b32 s78, s78, 2
    s_lshl_b32 s78, s78, 13
    s_add_u32 s78, s78, 16384
    v_xor_b32 v197, s79, v196
    v_lshl_add_u32 v197, v197, 5, v199
    v_add_u32_e64 v240, s78, v197
    s_add_u32 s78, s80, 1
    s_and_b32 s79, s78, 3
    s_lshr_b32 s78, s78, 2
    s_lshl_b32 s78, s78, 13
    s_add_u32 s78, s78, 16384
    v_xor_b32_e64 v197, s79, v196
    v_lshl_add_u32 v197, v197, 5, v199
    v_add_u32_e64 v241, s78, v197
    s_add_u32 s78, s80, 2
    s_and_b32 s79, s78, 3
    s_lshr_b32 s78, s78, 2
    s_lshl_b32 s78, s78, 13
    s_add_u32 s78, s78, 16384
    v_xor_b32_e64 v197, s79, v196
    v_lshl_add_u32 v197, v197, 5, v199
    v_add_u32 v242, s78, v197
    s_and_b32 s78, s70, 1
    s_lshl_b32 s78, s78, 6
    v_xor_b32 v60, s78, v60
    s_and_b32 s78, s69, 1
    s_lshl_b32 s78, s78, 12
    v_add_u32 v240, s78, v240
    v_add_u32 v241, s78, v241
    v_add_u32_e64 v242, s78, v242
    s_add_u32 m0, s64, 118784
    s_nop 0
    buffer_load_dwordx4 v4, s[28:31], s86 offen offset:0  lds
    v_lshrrev_b32 v196, 3, v2
    v_and_b32 v197, 7, v2
    v_lshlrev_b32 v199, 4, v197
    v_mul_u32_u24 v244, 57344, v196
    s_add_u32 m0, s66, 141312
    s_nop 0
    buffer_load_dwordx4 v6, s[32:35], s87 offen offset:2048  lds
    v_add_u32 v244, v244, v199
    v_lshl_add_u32 v245, v196, 14, v199
    s_lshl_b32 s78, s74, 2
    s_add_u32 s78, s78, s76
    s_add_u32 m0, s64, 120832
    s_add_u32 s101, s86, 32768
    buffer_load_dwordx4 v4, s[28:31], s101 offen offset:0  lds
    s_mul_i32 s79, s78, 458752
    s_add_u32 s80, s73, s76
    s_and_b32 s80, s80, 3
    s_andn2_b32 s100, s73, 3
    s_add_u32 m0, s66, 151552
    s_add_u32 s101, s87, 4096
    buffer_load_dwordx4 v6, s[32:35], s101 offen offset:0  lds
    s_or_b32 s80, s80, s100
    s_lshl_b32 s80, s80, 7
    s_add_u32 s79, s79, s80
    s_cmp_ge_u32 s73, 56
    s_cselect_b32 s79, 0x8000000, s79
    v_add_u32_e64 v244, s79, v244
    s_lshl_b32 s78, s78, 7
    s_add_u32 m0, s66, 135168
    s_nop 0
    buffer_load_dwordx4 v6, s[32:35], s87 offen offset:0  lds
    s_lshl_b32 s80, s73, 17
    s_add_u32 s78, s78, s80
    v_add_u32_e64 v245, s78, v245
    s_lshl_b32 s78, s72, 7
    s_add_u32 m0, s65, 118784
    s_nop 0
    buffer_load_dwordx4 v5, s[28:31], s86 offen offset:0  lds
    v_lshl_add_u32 v196, v196, 11, s78
    v_and_b32 v199, 1, v198
    v_lshlrev_b32 v199, 2, v199
    v_xor_b32 v199, v199, v197
    s_add_u32 m0, s67, 141312
    s_nop 0
    buffer_load_dwordx4 v7, s[32:35], s87 offen offset:2048  lds
    v_lshl_add_u32 v246, v199, 4, v196
    s_lshl_b32 s78, s71, 2
    s_add_u32 s78, s78, s76
    s_lshl_b32 s78, s78, 16
    v_add_u32_e64 v196, s78, v196
    s_add_u32 m0, s65, 120832
    s_add_u32 s101, s86, 32768
    buffer_load_dwordx4 v5, s[28:31], s101 offen offset:0  lds
    v_xor_b32_e64 v199, v198, v197
    v_lshl_add_u32 v247, v199, 4, v196
    v_xor_b32 v248, 64, v247
    s_lshl_b32 s78, s76, 14
    s_add_u32 m0, s67, 151552
    s_add_u32 s101, s87, 4096
    buffer_load_dwordx4 v7, s[32:35], s101 offen offset:0  lds
    v_add_u32 v246, s78, v246
    s_lshl_b32 s84, s76, 10
    s_bfe_u32 s78, s2, 0x40003
    s_lshl_b32 s78, s78, 17
    s_add_u32 m0, s67, 135168
    s_nop 0
    buffer_load_dwordx4 v7, s[32:35], s87 offen offset:0  lds
    s_add_u32 s86, s86, 128
    s_add_u32 s87, s87, 393216
    s_and_b32 s86, s86, 2047
    s_cselect_b32 s87, s87, 0
    s_mov_b32 s101, 40960
    s_cmp_ge_i32 s64, 0
    s_cselect_b32 s101, 0xfffec000, s101
    s_add_u32 s64, s64, s101
    s_add_u32 s65, s65, s101
    s_add_u32 s66, s66, s101
    s_add_u32 s67, s67, s101
    s_and_b32 s79, s72, 8
    s_add_u32 s79, s79, 3
    s_lshl_b32 s79, s79, 7
    s_add_u32 s78, s78, s79
    v_lshl_add_u32 v63, v2, 11, s78
    s_mul_i32 s100, s69, 52
    s_lshr_b32 s100, s100, 8
    s_mul_i32 s100, s100, 5
    s_sub_u32 s3, s69, s100
    s_branch L_sube
    .p2align 6
L_iss:
    s_add_u32 m0, s64, 118784
    s_nop 0
    buffer_load_dwordx4 v4, s[28:31], s86 offen offset:0  lds
    s_add_u32 m0, s66, 141312
    s_nop 0
    buffer_load_dwordx4 v6, s[32:35], s87 offen offset:2048  lds
    s_add_u32 m0, s64, 120832
    s_add_u32 s101, s86, 32768
    buffer_load_dwordx4 v4, s[28:31], s101 offen offset:0  lds
    s_add_u32 m0, s66, 151552
    s_add_u32 s101, s87, 4096
    buffer_load_dwordx4 v6, s[32:35], s101 offen offset:0  lds
    s_add_u32 m0, s66, 135168
    s_nop 0
    buffer_load_dwordx4 v6, s[32:35], s87 offen offset:0  lds
    s_add_u32 m0, s65, 118784
    s_nop 0
    buffer_load_dwordx4 v5, s[28:31], s86 offen offset:0  lds
    s_add_u32 m0, s67, 141312
    s_nop 0
    s_nop 0
    buffer_load_dwordx4 v7, s[32:35], s87 offen offset:2048  lds
    s_add_u32 m0, s65, 120832
    s_add_u32 s101, s86, 32768
    buffer_load_dwordx4 v5, s[28:31], s101 offen offset:0  lds
    s_add_u32 m0, s67, 151552
    s_add_u32 s101, s87, 4096
    buffer_load_dwordx4 v7, s[32:35], s101 offen offset:0  lds
    s_add_u32 m0, s67, 135168
    s_nop 0
    buffer_load_dwordx4 v7, s[32:35], s87 offen offset:0  lds
    s_add_u32 s86, s86, 128
    s_add_u32 s87, s87, 393216
    s_and_b32 s86, s86, 2047
    s_cselect_b32 s87, s87, 0
    s_mov_b32 s101, 40960
    s_cmp_ge_i32 s64, 0
    s_cselect_b32 s101, 0xfffec000, s101
    s_add_u32 s64, s64, s101
    s_add_u32 s65, s65, s101
    s_add_u32 s66, s66, s101
    s_add_u32 s67, s67, s101
    s_setpc_b64 s[90:91]
    .p2align 6
L_cl0:
    s_mov_b32 s100, 0
    buffer_load_dwordx4 v[64:67], v244, s[48:51], s100 offen nt
    s_mov_b32 s100, 0
    buffer_load_dwordx4 v[96:99], v244, s[52:55], s100 offen nt
    s_mov_b32 s100, 7168
    buffer_load_dwordx4 v[68:71], v244, s[48:51], s100 offen nt
    s_mov_b32 s100, 7168
    buffer_load_dwordx4 v[100:103], v244, s[52:55], s100 offen nt
    s_mov_b32 s100, 14336
    buffer_load_dwordx4 v[72:75], v244, s[48:51], s100 offen nt
    s_mov_b32 s100, 14336
    buffer_load_dwordx4 v[104:107], v244, s[52:55], s100 offen nt
    s_mov_b32 s100, 21504
    buffer_load_dwordx4 v[76:79], v244, s[48:51], s100 offen nt
    s_setpc_b64 s[90:91]
    .p2align 6
L_cl1:
    s_mov_b32 s100, 21504
    buffer_load_dwordx4 v[108:111], v244, s[52:55], s100 offen nt
    s_mov_b32 s100, 28672
    buffer_load_dwordx4 v[80:83], v244, s[48:51], s100 offen nt
    s_mov_b32 s100, 28672
    buffer_load_dwordx4 v[112:115], v244, s[52:55], s100 offen nt
    s_mov_b32 s100, 35840
    buffer_load_dwordx4 v[84:87], v244, s[48:51], s100 offen nt
    s_mov_b32 s100, 35840
    buffer_load_dwordx4 v[116:119], v244, s[52:55], s100 offen nt
    s_mov_b32 s100, 43008
    buffer_load_dwordx4 v[88:91], v244, s[48:51], s100 offen nt
    s_mov_b32 s100, 43008
    buffer_load_dwordx4 v[120:123], v244, s[52:55], s100 offen nt
    s_setpc_b64 s[90:91]
    .p2align 12
L_sube:
    s_waitcnt vmcnt(10)
    s_barrier
    s_call_b64 s[90:91], L_iss
    s_setprio 2
    v_add_u32 v196, 118784, v60
    v_add_u32 v198, 118784, v240
    v_add_u32 v199, 118784, v241
    v_add_u32 v200, 118784, v242
    ds_read_b128 v[20:23], v196 offset:0
    ds_read_b128 v[24:27], v196 offset:2048
    ds_read_b64_tr_b16 v[36:37], v198 offset:0
    ds_read_b64_tr_b16 v[38:39], v198 offset:512
    ds_read_b64_tr_b16 v[44:45], v199 offset:0
    ds_read_b64_tr_b16 v[46:47], v199 offset:512
    ds_read_b64_tr_b16 v[52:53], v200 offset:0
    ds_read_b64_tr_b16 v[54:55], v200 offset:512
    s_setprio 0
    s_waitcnt lgkmcnt(0)
    s_mul_i32 s75, s75, 0x9E3779B1
    s_add_u32 s75, s75, 0x7F4A7C15
    s_waitcnt vmcnt(10)
    s_waitcnt lgkmcnt(0)
    s_barrier
    s_call_b64 s[90:91], L_iss
    s_setprio 2
    s_nop 0
    v_add_u32 v196, 36864, v60
    v_add_u32 v198, 36864, v240
    v_add_u32 v199, 36864, v241
    v_add_u32 v200, 36864, v242
    ds_read_b128 v[28:31], v196 offset:0
    ds_read_b128 v[32:35], v196 offset:2048
    ds_read_b64_tr_b16 v[40:41], v198 offset:0
    ds_read_b64_tr_b16 v[42:43], v198 offset:512
    ds_read_b64_tr_b16 v[48:49], v199 offset:0
    ds_read_b64_tr_b16 v[50:51], v199 offset:512
    ds_read_b64_tr_b16 v[56:57], v200 offset:0
    ds_read_b64_tr_b16 v[58:59], v200 offset:512
    s_setprio 0
    s_getreg_b32 s99, hwreg(HW_REG_XCC_ID, 0, 4)
    v_mov_b32 v10, s75
    v_mov_b32 v11, s99
    v_not_b32 v12, v10
    v_mov_b32 v13, 0
    v_and_b32 v8, 15, v2
    v_lshlrev_b32 v9, 4, v8
    v_add_u32_e64 v9, s69, v9
    s_lshl_b32 s78, s70, 4
    s_lshl_b32 s79, s71, 4
    s_add_u32 s79, s79, 69088
    v_mov_b32 v202, s78
    v_mov_b32 v203, s79
    v_cmp_gt_u32 vcc, 32, v2
    s_nop 1
    v_cndmask_b32 v202, v203, v202, vcc
    v_add_u32 v8, v202, v8
    v_cmp_gt_u32 vcc, 16, v2
    s_nop 1
    v_cndmask_b32 v8, v8, v9, vcc
    v_lshlrev_b32 v8, 7, v8
    v_add_u32 v8, 4096, v8
    v_lshlrev_b32 v9, 3, v2
    s_lshl_b32 s82, s77, 7
    s_add_u32 s82, s82, 4096
    s_lshl_b32 s79, s71, 4
    s_add_u32 s79, s79, s72
    s_lshl_b32 s79, s79, 7
    s_add_u32 s79, s79, 8847360
    s_cmp_eq_u32 s76, 1
    s_cselect_b32 s82, s79, s82
    s_cmp_gt_u32 s76, 1
    s_cselect_b32 s82, 0x10000000, s82
    s_lshl_b32 s83, s77, 9
    s_add_u32 s83, s83, 8912896
    s_cmp_eq_u32 s76, 2
    s_cselect_b32 s83, s83, 0x10000000
    buffer_store_dwordx2 v[12:13], v9, s[36:39], s83 offen sc1
    s_waitcnt vmcnt(11)
    s_waitcnt lgkmcnt(0)
    s_barrier
    s_call_b64 s[90:91], L_iss
    s_waitcnt vmcnt(11)
    s_cmp_lg_u32 s3, 0
    s_cbranch_scc1 Lcs_1
    s_call_b64 s[90:91], L_cl0
Lcs_1:
    s_barrier
    s_setprio 2
    s_add_u32 m0, s64, 118784
    s_nop 0
    s_nop 0
    buffer_load_dwordx4 v4, s[28:31], s86 offen offset:0  lds
    v_mov_b32 v200, 0x3f803f80
    v_mov_b32 v201, 0x3f803f80
    v_mov_b32 v202, 0x3f803f80
    v_mov_b32 v203, 0x3f803f80
    s_add_u32 m0, s66, 141312
    s_nop 0
    s_nop 0
    buffer_load_dwordx4 v6, s[32:35], s87 offen offset:2048  lds
    v_mfma_f32_16x16x32_bf16 v[204:207], v[200:203], v[20:23], 0
    v_mfma_f32_16x16x32_bf16 v[212:215], v[20:23], v[20:23], 0
    v_mfma_f32_16x16x32_bf16 v[208:211], v[200:203], v[24:27], 0
    v_mfma_f32_16x16x32_bf16 v[216:219], v[24:27], v[24:27], 0
    s_add_u32 m0, s64, 120832
    s_add_u32 s101, s86, 32768
    buffer_load_dwordx4 v4, s[28:31], s101 offen offset:0  lds
    v_mfma_f32_16x16x32_bf16 v[220:223], v[200:203], v[36:39], 0
    v_mfma_f32_16x16x32_bf16 v[224:227], v[200:203], v[44:47], 0
    v_mfma_f32_16x16x32_bf16 v[228:231], v[200:203], v[52:55], 0
    v_mfma_f32_16x16x32_bf16 v[204:207], v[200:203], v[28:31], v[204:207]
    v_mfma_f32_16x16x32_bf16 v[212:215], v[28:31], v[28:31], v[212:215]
    s_add_u32 m0, s66, 151552
    s_add_u32 s101, s87, 4096
    buffer_load_dwordx4 v6, s[32:35], s101 offen offset:0  lds
    v_mfma_f32_16x16x32_bf16 v[208:211], v[200:203], v[32:35], v[208:211]
    v_mfma_f32_16x16x32_bf16 v[216:219], v[32:35], v[32:35], v[216:219]
    v_mfma_f32_16x16x32_bf16 v[220:223], v[200:203], v[40:43], v[220:223]
    v_mfma_f32_16x16x32_bf16 v[224:227], v[200:203], v[48:51], v[224:227]
    s_add_u32 m0, s66, 135168
    s_nop 0
    buffer_load_dwordx4 v6, s[32:35], s87 offen offset:0  lds
    v_mfma_f32_16x16x32_bf16 v[228:231], v[200:203], v[56:59], v[228:231]
    v_and_b32 v196, 3, v2
    v_cmp_eq_u32 s[90:91], 1, v196
    v_cmp_eq_u32 s[92:93], 2, v196
    v_cmp_eq_u32_e64 vcc, 3, v196
    s_add_u32 m0, s65, 118784
    s_nop 0
    buffer_load_dwordx4 v5, s[28:31], s86 offen offset:0  lds
    v_cndmask_b32 v212, v212, v213, s[90:91]
    v_cndmask_b32 v212, v212, v214, s[92:93]
    v_cndmask_b32 v205, v212, v215, vcc
    v_cndmask_b32 v216, v216, v217, s[90:91]
    s_add_u32 m0, s67, 141312
    s_nop 0
    buffer_load_dwordx4 v7, s[32:35], s87 offen offset:2048  lds
    v_cndmask_b32 v216, v216, v218, s[92:93]
    v_cndmask_b32 v209, v216, v219, vcc
    v_lshrrev_b32_e64 v196, 4, v2
    v_cmp_eq_u32 s[90:91], 1, v196
    v_cmp_eq_u32_e64 vcc, 2, v196
    s_add_u32 m0, s65, 120832
    s_add_u32 s101, s86, 32768
    buffer_load_dwordx4 v5, s[28:31], s101 offen offset:0  lds
    v_cndmask_b32 v220, v220, v224, s[90:91]
    v_cndmask_b32_e64 v220, v220, v228, vcc
    s_mul_i32 s78, s77, 768
    s_mul_i32 s79, s76, 192
    s_add_u32 m0, s67, 151552
    s_add_u32 s101, s87, 4096
    buffer_load_dwordx4 v7, s[32:35], s101 offen offset:0  lds
    s_add_u32 s78, s78, s79
    s_add_u32 s78, s78, 327680
    v_lshlrev_b32 v197, 2, v2
    s_mov_b32 exec_hi, 0xffff
    buffer_store_dword v220, v197, s[36:39], s78 offen sc1
    s_mov_b32 exec_hi, -1
    s_lshl_b32 s78, s69, 4
    s_add_u32 m0, s67, 135168
    s_nop 0
    buffer_load_dwordx4 v7, s[32:35], s87 offen offset:0  lds
    s_add_u32 s86, s86, 128
    s_add_u32 s87, s87, 393216
    s_and_b32 s86, s86, 2047
    s_cselect_b32 s87, s87, 0
    s_mov_b32 s101, 40960
    s_cmp_ge_i32 s64, 0
    s_cselect_b32 s101, 0xfffec000, s101
    s_add_u32 s64, s64, s101
    s_add_u32 s65, s65, s101
    s_add_u32 s66, s66, s101
    s_add_u32 s67, s67, s101
    s_add_u32 s78, s78, s70
    s_lshl_b32 s78, s78, 10
    s_lshl_b32 s79, s76, 8
    s_add_u32 s78, s78, s79
    buffer_store_dwordx4 v[16:19], v14, s[36:39], s96 offen offset:0 sc1
    s_add_u32 s78, s78, 65536
    v_and_b32 v198, 15, v2
    v_lshlrev_b32_e64 v198, 3, v198
    s_mov_b32 exec_lo, 0x00f0000f
    s_mov_b32 exec_hi, 0xf0000f00
    buffer_store_dwordx2 v[204:205], v198, s[36:39], s78 offen offset:0 sc1
    s_mov_b64 exec, -1
    s_mov_b32 exec_lo, 0x00f0000f
    s_mov_b32 exec_hi, 0xf0000f00
    buffer_store_dwordx2 v[208:209], v198, s[36:39], s78 offen offset:128 sc1
    s_mov_b64 exec, -1
    s_setprio 0
    s_waitcnt vmcnt(14)
    s_cmp_lg_u32 s3, 1
    s_cbranch_scc1 Lcs_2
    s_call_b64 s[90:91], L_cl0
Lcs_2:
    s_barrier
    s_call_b64 s[90:91], L_iss
    s_waitcnt vmcnt(10)
    s_cmp_lg_u32 s3, 2
    s_cbranch_scc1 Lcs_3
    s_call_b64 s[90:91], L_cl0
Lcs_3:
    s_barrier
    s_mov_b64 exec, 0xffff
    buffer_store_dwordx2 v[10:11], v9, s[36:39], s82 offen sc1
    s_mov_b64 exec, -1
    s_call_b64 s[90:91], L_iss
    s_waitcnt vmcnt(11)
    s_cmp_lg_u32 s3, 3
    s_cbranch_scc1 Lcs_4
    s_call_b64 s[90:91], L_cl0
Lcs_4:
    s_barrier
    s_call_b64 s[90:91], L_iss
    s_waitcnt vmcnt(10)
    s_cmp_lg_u32 s3, 4
    s_cbranch_scc1 Lcs_5
    s_call_b64 s[90:91], L_cl0
Lcs_5:
    s_barrier
    s_call_b64 s[90:91], L_iss
    s_waitcnt vmcnt(10)
    s_cmp_lg_u32 s3, 0
    s_cbranch_scc1 Lcs_6
    s_call_b64 s[90:91], L_cl1
Lcs_6:
    s_barrier
    s_call_b64 s[90:91], L_iss
    s_waitcnt vmcnt(10)
    s_cmp_lg_u32 s3, 1
    s_cbranch_scc1 Lcs_7
    s_call_b64 s[90:91], L_cl1
Lcs_7:
    s_barrier
    s_call_b64 s[90:91], L_iss
    s_waitcnt vmcnt(10)
    s_cmp_lg_u32 s3, 2
    s_cbranch_scc1 Lcs_8
    s_call_b64 s[90:91], L_cl1
Lcs_8:
    s_barrier
    s_call_b64 s[90:91], L_iss
    s_waitcnt vmcnt(10)
    s_cmp_lg_u32 s3, 3
    s_cbranch_scc1 Lcs_9
    s_call_b64 s[90:91], L_cl1
Lcs_9:
    s_barrier
    s_call_b64 s[90:91], L_iss
    s_waitcnt vmcnt(10)
    s_cmp_lg_u32 s3, 4
    s_cbranch_scc1 Lcs_10
    s_call_b64 s[90:91], L_cl1
Lcs_10:
    s_barrier
    s_cmp_lg_u32 s76, 0
    s_cbranch_scc1 Lpl_11
    s_mov_b32 exec_hi, 0xffff
    buffer_load_dwordx2 v[10:11], v8, s[36:39], 0 offen sc1
    s_mov_b64 exec, -1
Lpl_11:
    s_call_b64 s[90:91], L_iss
    s_cmp_lg_u32 s76, 1
    s_cbranch_scc1 Lpf_12
    s_getpc_b64 s[90:91]
Lpc_13:
    s_add_u32 s90, s90, L_phend-Lpc_13
    s_addc_u32 s91, s91, 0
    s_lshr_b32 s100, s2, 3
    s_lshl_b32 s100, s100, 10
    s_min_u32 s100, s100, (L_end-L_phend-768)
    v_add_u32 v236, s100, v14
    global_load_dword v236, v236, s[90:91]
Lpf_12:
    s_waitcnt vmcnt(10)
    s_barrier
    s_cmp_lg_u32 s76, 2
    s_cbranch_scc1 Lc4_14
    s_mov_b32 exec_hi, -1
    buffer_load_dword v238, v63, s[40:43], 0 offen
    s_mov_b64 exec, -1
Lc4_14:
    s_call_b64 s[90:91], L_iss
    s_waitcnt vmcnt(10)
    s_cmp_lg_u32 s76, 0
    s_cbranch_scc1 Lpc_15
    s_setprio 2
    s_mov_b32 exec_hi, 0xffff
    s_mov_b32 s85, 0
    s_branch Lpk_16
Lspin_17:
    s_add_u32 s85, s85, 1
    s_cmp_gt_u32 s85, 400000
    s_cbranch_scc1 L_end
    buffer_load_dwordx2 v[10:11], v8, s[36:39], 0 offen sc1
    s_waitcnt vmcnt(0)
Lpk_16:
    v_cmp_ne_u32 vcc, s75, v10
    s_cbranch_vccnz Lspin_17
    v_cmp_ne_u32 vcc, s99, v11
    s_mov_b64 exec, -1
    s_lshr_b32 s78, vcc_lo, 16
    s_cselect_b32 s78, 0, 1
    s_cmp_eq_u32 vcc_hi, 0
    s_cselect_b32 s79, 2, 0
    s_or_b32 s78, s78, s79
    s_and_b32 s78, s78, 3
    v_mov_b32_e64 v10, s78
    v_mov_b32 v11, 163584
    ds_write_b32 v11, v10
    s_setprio 0
Lpc_15:
    s_barrier
    v_lshrrev_b32 v196, 4, v2
    v_and_b32 v197, 15, v2
    v_lshlrev_b32_e64 v197, 4, v197
    v_lshl_add_u32 v198, v196, 10, v197
    s_lshl_b32 s78, s69, 14
    s_lshl_b32 s79, s76, 8
    s_add_u32 s78, s78, s79
    s_nop 0
    s_add_u32 s78, s78, 65536
    buffer_load_dwordx4 v[20:23], v198, s[36:39], s78 offen sc1
    s_add_u32 s78, s78, 4096
    buffer_load_dwordx4 v[24:27], v198, s[36:39], s78 offen sc1
    s_add_u32 s78, s78, 4096
    buffer_load_dwordx4 v[28:31], v198, s[36:39], s78 offen sc1
    s_add_u32 s78, s78, 4096
    buffer_load_dwordx4 v[32:35], v198, s[36:39], s78 offen sc1
    v_mul_u32_u24 v198, 768, v196
    v_add_u32_e64 v198, v198, v197
    s_mul_i32 s78, s70, 12288
    s_lshl_b32 s79, s76, 8
    s_add_u32 s78, s78, s79
    s_add_u32 s78, s78, 327680
    s_cmp_eq_u32 s76, 3
    s_nop 0
    s_cselect_b32 s78, 0x10000000, s78
    buffer_load_dwordx4 v[36:39], v198, s[36:39], s78 offen sc1
    s_add_u32 s78, s78, 3072
    buffer_load_dwordx4 v[40:43], v198, s[36:39], s78 offen sc1
    s_add_u32 s78, s78, 3072
    buffer_load_dwordx4 v[44:47], v198, s[36:39], s78 offen sc1
    s_add_u32 s78, s78, 3072
    buffer_load_dwordx4 v[48:51], v198, s[36:39], s78 offen sc1
    s_add_u32 m0, s84, 0
    s_mov_b32 s100, 0
    buffer_load_dwordx4 v246, s[40:43], s100 offen  lds
    s_add_u32 m0, s84, 4096
    s_mov_b32 s100, 65536
    buffer_load_dwordx4 v246, s[40:43], s100 offen  lds
    s_add_u32 m0, s84, 8192
    s_mov_b32 s100, 131072
    buffer_load_dwordx4 v246, s[40:43], s100 offen  lds
    s_add_u32 m0, s84, 12288
    s_mov_b32 s100, 196608
    buffer_load_dwordx4 v246, s[40:43], s100 offen  lds
    s_waitcnt vmcnt(12)
    s_barrier
    s_setprio 2
    s_add_u32 m0, s84, 16384
    s_mov_b32 s100, 262144
    buffer_load_dwordx4 v246, s[40:43], s100 offen  lds
    s_waitcnt vmcnt(9)
    v_add_f32 v20, v20, v24
    v_add_f32 v21, v21, v25
    v_add_f32 v22, v22, v26
    v_add_f32 v23, v23, v27
    v_add_f32 v20, v20, v28
    v_add_f32 v21, v21, v29
    s_add_u32 m0, s84, 20480
L_pad0:
    s_cbranch_execz L_pad4
    s_mov_b32 s100, 327680
    buffer_load_dwordx4 v246, s[40:43], s100 offen  lds
    v_add_f32 v22, v22, v30
    v_add_f32 v23, v23, v31
    v_add_f32 v20, v20, v32
    v_add_f32 v21, v21, v33
    v_add_f32 v22, v22, v34
    v_add_f32 v23, v23, v35
    s_nop 0
    v_permlane32_swap_b32_e64 v20, v22
    s_add_u32 m0, s84, 24576
    s_mov_b32 s100, 393216
    buffer_load_dwordx4 v246, s[40:43], s100 offen  lds
    v_permlane32_swap_b32 v21, v23
    v_add_f32 v20, v20, v22
    v_add_f32 v21, v21, v23
    v_mov_b32 v22, v20
    v_mov_b32 v23, v21
    s_nop 0
    v_permlane16_swap_b32 v20, v22
    v_permlane16_swap_b32 v21, v23
    v_add_f32_e64 v20, v20, v22
    s_add_u32 m0, s84, 28672
    s_mov_b32 s100, 458752
    buffer_load_dwordx4 v246, s[40:43], s100 offen  lds
    v_add_f32_e64 v21, v21, v23
    v_mul_f32 v24, 0x3a800000, v20
    v_mul_f32 v26, 0x3a800000, v21
    v_fma_f32 v26, -v24, v24, v26
    v_max_f32_e64 v26, 0, v26
    v_cvt_pk_bf16_f32 v24, v24, v24
    v_and_b32 v24, 0xffff0000, v24
    s_add_u32 m0, s84, 32768
    s_mov_b32 s100, 524288
    buffer_load_dwordx4 v246, s[40:43], s100 offen  lds
    v_cvt_pk_bf16_f32 v26, v26, v26
    v_and_b32 v26, 0xffff0000, v26
    v_add_f32 v26, 0x3727c5ac, v26
    v_cvt_pk_bf16_f32 v26, v26, v26
    v_and_b32 v26, 0xffff0000, v26
    v_sqrt_f32 v26, v26
    s_nop 0
    v_cvt_pk_bf16_f32 v26, v26, v26
    v_and_b32 v26, 0xffff0000, v26
    s_add_u32 m0, s84, 36864
    s_mov_b32 s100, 589824
    buffer_load_dwordx4 v246, s[40:43], s100 offen  lds
    v_rcp_f32_e64 v25, v26
    v_xor_b32 v26, 0x80000000, v24
    v_lshrrev_b32 v27, 16, v26
    v_or_b32 v26, v26, v27
    v_mov_b32 v27, 0
    v_and_b32 v196, 15, v2
    v_lshrrev_b32_e64 v197, 5, v2
    s_add_u32 m0, s84, 40960
    s_mov_b32 s100, 655360
    buffer_load_dwordx4 v246, s[40:43], s100 offen  lds
    v_lshl_add_u32 v196, v196, 1, v197
    s_lshl_b32 s78, s76, 5
    v_add_u32 v196, s78, v196
    v_lshlrev_b32_e64 v197, 3, v196
    v_add_u32 v197, 159744, v197
    v_lshlrev_b32_e64 v196, 2, v196
    v_add_u32 v196, 162304, v196
    s_add_u32 m0, s84, 45056
    s_mov_b32 s100, 720896
    buffer_load_dwordx4 v246, s[40:43], s100 offen  lds
    ds_write_b64 v197, v[26:27]
    ds_write_b32 v196, v25
    s_waitcnt vmcnt(12)
    v_add_f32 v36, v36, v40
    v_add_f32 v37, v37, v41
    v_add_f32 v38, v38, v42
    v_add_f32 v39, v39, v43
    v_add_f32 v36, v36, v44
    s_add_u32 m0, s84, 49152
    s_mov_b32 s100, 786432
    buffer_load_dwordx4 v246, s[40:43], s100 offen  lds
    v_add_f32 v37, v37, v45
    v_add_f32 v38, v38, v46
    v_add_f32 v39, v39, v47
    v_add_f32 v36, v36, v48
    v_add_f32 v37, v37, v49
    v_add_f32 v38, v38, v50
    v_add_f32_e64 v39, v39, v51
    s_add_u32 m0, s84, 53248
    s_mov_b32 s100, 851968
    buffer_load_dwordx4 v246, s[40:43], s100 offen  lds
    v_permlane32_swap_b32 v36, v38
    v_permlane32_swap_b32 v37, v39
    v_add_f32 v36, v36, v38
    v_add_f32 v37, v37, v39
    s_nop 1
    v_permlane16_swap_b32 v36, v37
    v_add_f32_e64 v36, v36, v37
    v_cvt_pk_bf16_f32 v37, v36, v36
    v_and_b32 v37, 0xffff0000, v37
    s_add_u32 m0, s84, 57344
    s_mov_b32 s100, 917504
    buffer_load_dwordx4 v246, s[40:43], s100 offen  lds
    v_sub_f32_e64 v38, v36, v37
    v_cvt_pk_bf16_f32 v38, v37, v38
    v_mov_b32 v39, 0
    v_and_b32 v196, 15, v2
    v_lshrrev_b32_e64 v197, 4, v2
    v_lshl_add_u32 v196, v196, 2, v197
    s_lshl_b32 s78, s76, 9
    s_add_u32 m0, s84, 61440
    s_mov_b32 s100, 983040
    buffer_load_dwordx4 v246, s[40:43], s100 offen  lds
    s_add_u32 s78, s78, 160768
    v_lshl_add_u32 v196, v196, 3, s78
    v_and_b32 v197, 15, v2
    v_lshlrev_b32_e64 v197, 3, v197
    v_add_u32 v197, 162816, v197
    v_mov_b32 v198, 0x3f803f80
    s_cmp_eq_u32 s76, 3
    s_cselect_b64 vcc, -1, 0
    v_cndmask_b32 v196, v196, v197, vcc
    v_cndmask_b32 v38, v38, v198, vcc
    v_cndmask_b32_e64 v39, v39, v198, vcc
    ds_write_b64 v196, v[38:39]
    s_setprio 0
    s_waitcnt lgkmcnt(0)
    s_barrier
L_phend:
    s_mov_b32 s66, s96
    s_add_u32 m0, s84, 65536
    s_mov_b32 s100, 1048576
    buffer_load_dwordx4 v246, s[40:43], s100 offen  lds
    v_lshrrev_b32 v52, 2, v2
    v_and_b32 v53, 7, v52
    v_and_b32_e64 v55, 3, v2
    s_add_u32 m0, s84, 69632
    s_mov_b32 s100, 1114112
    buffer_load_dwordx4 v246, s[40:43], s100 offen  lds
    v_xor_b32 v53, v53, v55
    v_lshlrev_b32 v52, 7, v52
    v_lshrrev_b32_e64 v55, 1, v55
    s_add_u32 m0, s84, 73728
    s_mov_b32 s100, 1179648
    buffer_load_dwordx4 v246, s[40:43], s100 offen  lds
    v_lshl_add_u32 v52, v55, 3, v52
    s_lshr_b32 s78, s76, 1
    s_and_b32 s79, s76, 1
    s_lshl_b32 s80, s79, 2
    s_add_u32 m0, s84, 77824
    s_mov_b32 s100, 1245184
    buffer_load_dwordx4 v246, s[40:43], s100 offen  lds
    s_lshl_b32 s81, s78, 2
    v_xor_b32 v55, s80, v53
    v_xor_b32 v53, s81, v53
    s_add_u32 m0, s84, 81920
    s_mov_b32 s100, 1310720
    buffer_load_dwordx4 v246, s[40:43], s100 offen  lds
    s_lshl_b32 s80, s78, 14
    s_add_u32 s80, s80, 110592
    v_lshl_add_u32 v196, v55, 4, v52
    v_add_u32 v196, s80, v196
    s_add_u32 m0, s84, 86016
    s_mov_b32 s100, 1376256
    buffer_load_dwordx4 v246, s[40:43], s100 offen  lds
    v_lshl_add_u32 v198, v53, 4, v52
    v_add_u32 v198, 143360, v198
    v_xor_b32_e64 v197, 8, v196
    s_add_u32 m0, s84, 90112
    s_mov_b32 s100, 1441792
    buffer_load_dwordx4 v246, s[40:43], s100 offen  lds
    v_xor_b32_e64 v199, 8, v198
    v_mov_b32 v200, 0x3f803f80
    v_mov_b32 v201, 0x3f803f80
    v_mov_b32 v202, 0x3f803f80
    s_add_u32 m0, s84, 94208
    s_mov_b32 s100, 1507328
    buffer_load_dwordx4 v246, s[40:43], s100 offen  lds
    v_mov_b32 v203, 0x3f803f80
    v_lshrrev_b32 v62, 4, v2
    v_and_b32 v52, 15, v2
    s_add_u32 m0, s84, 98304
    s_mov_b32 s100, 1572864
    buffer_load_dwordx4 v246, s[40:43], s100 offen  lds
    v_lshlrev_b32_e64 v53, 4, v52
    v_lshl_add_u32 v62, v62, 13, v53
    v_lshrrev_b32_e64 v52, 3, v52
    v_lshl_add_u32 v62, v52, 8, v62
    s_add_u32 m0, s84, 102400
    s_mov_b32 s100, 1638400
    buffer_load_dwordx4 v246, s[40:43], s100 offen  lds
    v_xor_b32 v63, 256, v62
    s_lshl_b32 s78, s70, 2
    s_add_u32 s78, s78, s76
    s_add_u32 m0, s84, 106496
    s_mov_b32 s100, 1703936
    buffer_load_dwordx4 v246, s[40:43], s100 offen  lds
    s_lshl_b32 s78, s78, 15
    s_lshl_b32 s79, s69, 9
    s_add_u32 s78, s78, s79
    s_add_u32 s78, s78, 2097152
    s_mov_b32 s100, 2031616
    buffer_load_dwordx4 v[160:163], v246, s[40:43], s100 offen
    s_lshl_b32 s79, s77, 10
    s_lshl_b32 s80, s76, 6
    s_add_u32 s79, s79, s80
    s_mov_b32 s100, 1966080
    buffer_load_dwordx4 v[164:167], v246, s[40:43], s100 offen
    s_add_u32 s79, s79, 8389120
    v_lshrrev_b32 v52, 3, v2
    v_and_b32 v53, 7, v2
    v_lshlrev_b32_e64 v53, 4, v53
    s_mov_b32 s100, 1900544
    buffer_load_dwordx4 v[168:171], v246, s[40:43], s100 offen
    v_lshl_add_u32 v56, v52, 9, v53
    v_lshl_add_u32 v57, v52, 1, v53
    s_lshl_b32 s82, s70, 14
    s_mov_b32 s100, 1835008
    buffer_load_dwordx4 v[172:175], v246, s[40:43], s100 offen
    s_add_u32 s82, s82, s80
    s_add_u32 s82, s82, 8389120
    s_add_u32 s80, s80, 162944
    v_lshrrev_b32_e64 v58, 2, v2
    s_mov_b32 s100, 1769472
    buffer_load_dwordx4 v[176:179], v246, s[40:43], s100 offen
    v_and_b32 v53, 3, v2
    v_lshlrev_b32 v53, 4, v53
    v_lshl_add_u32 v58, v58, 10, v53
    s_mov_b32 s100, 0
    buffer_load_dwordx4 v[180:183], v247, s[28:31], s100 offen
    v_lshl_add_u32 v59, v52, 1, v53
    v_add_u32 v59, s80, v59
    s_lshl_b32 s64, s77, 13
    s_lshl_b32 s80, s76, 7
    s_mov_b32 s100, 16384
    buffer_load_dwordx4 v[184:187], v248, s[28:31], s100 offen
    s_add_u32 s64, s64, s80
    s_add_u32 s64, s64, 2097152
    s_add_u32 s65, s64, 4096
    s_mov_b32 s100, 32768
    buffer_load_dwordx4 v[188:191], v247, s[28:31], s100 offen
    s_lshl_b32 s81, s77, 10
    s_add_u32 s81, s81, s80
    s_add_u32 s81, s81, 8388608
    s_lshl_b32 s80, s71, 9
    s_mov_b32 s100, 49152
    buffer_load_dwordx4 v[192:195], v248, s[28:31], s100 offen
    s_add_u32 s80, s80, 8912896
    v_lshl_add_u32 v61, v2, 13, s80
    v_mov_b32 v52, 163584
    s_lshl_b32 s100, s77, 13
    s_add_u32 s100, s100, s89
    s_add_u32 s100, s100, 2097152
    buffer_load_dwordx4 v[252:255], v14, s[36:39], s100 offen offset:0 sc1
    ds_read_b32 v52, v52
    s_waitcnt lgkmcnt(0)
    v_readfirstlane_b32 s99, v52
    s_and_b32 s94, s69, 1
    s_lshl_b32 s100, s77, 13
    s_add_u32 s100, s100, s89
    s_nop 0
    s_add_u32 s100, s100, 2097152
    buffer_load_dwordx4 v[252:255], v14, s[36:39], s100 offen offset:1024 sc1
    s_mul_i32 s94, s94, 0x00010001
    s_mov_b32 s95, 0xfffefffe
    s_and_b32 s96, s75, 0x00010001
    buffer_load_dwordx4 v[252:255], v14, s[36:39], s66 offen sc1
    v_mov_b32_e64 v54, s96
    s_and_b32 s83, s75, 1
    s_lshl_b32 s83, s83, 16
    s_sub_u32 s83, 0, s83
    s_barrier
    ds_read_b64_tr_b16 v[4:5], v196 offset:0
    ds_read_b64_tr_b16 v[6:7], v196 offset:2048
    ds_read_b64_tr_b16 v[12:13], v198 offset:0
    ds_read_b64_tr_b16 v[14:15], v198 offset:2048
    ds_read_b64_tr_b16 v[8:9], v197 offset:0
    ds_read_b64_tr_b16 v[10:11], v197 offset:2048
    ds_read_b64_tr_b16 v[16:17], v199 offset:0
    ds_read_b64_tr_b16 v[18:19], v199 offset:2048
    ds_read_b64_tr_b16 v[20:21], v196 offset:4096
    ds_read_b64_tr_b16 v[22:23], v196 offset:6144
    ds_read_b64_tr_b16 v[28:29], v198 offset:4096
    ds_read_b64_tr_b16 v[30:31], v198 offset:6144
    ds_read_b64_tr_b16 v[24:25], v197 offset:4096
    ds_read_b64_tr_b16 v[26:27], v197 offset:6144
    s_waitcnt lgkmcnt(10)
    v_mfma_f32_16x16x32_bf16 v[204:207], v[4:7], v[12:15], 0
    ds_read_b64_tr_b16 v[32:33], v199 offset:4096
    ds_read_b64_tr_b16 v[34:35], v199 offset:6144
    s_waitcnt lgkmcnt(10)
    v_mfma_f32_16x16x32_bf16 v[208:211], v[8:11], v[12:15], 0
    ds_read_b64_tr_b16 v[36:37], v196 offset:8192
    ds_read_b64_tr_b16 v[38:39], v196 offset:10240
    s_waitcnt lgkmcnt(10)
    s_nop 0
    v_mfma_f32_16x16x32_bf16 v[216:219], v[8:11], v[16:19], 0
    ds_read_b64_tr_b16 v[44:45], v198 offset:8192
    ds_read_b64_tr_b16 v[46:47], v198 offset:10240
    v_mfma_f32_16x16x32_bf16 v[212:215], v[4:7], v[16:19], 0
    ds_read_b64_tr_b16 v[40:41], v197 offset:8192
    ds_read_b64_tr_b16 v[42:43], v197 offset:10240
    s_waitcnt lgkmcnt(10)
    v_mfma_f32_16x16x32_bf16 v[204:207], v[20:23], v[28:31], v[204:207]
    ds_read_b64_tr_b16 v[48:49], v199 offset:8192
    ds_read_b64_tr_b16 v[50:51], v199 offset:10240
    s_waitcnt lgkmcnt(10)
    v_mfma_f32_16x16x32_bf16 v[208:211], v[24:27], v[28:31], v[208:211]
    ds_read_b64_tr_b16 v[228:229], v196 offset:12288
    ds_read_b64_tr_b16 v[230:231], v196 offset:14336
    s_waitcnt lgkmcnt(10)
    s_nop 0
    v_mfma_f32_16x16x32_bf16 v[216:219], v[24:27], v[32:35], v[216:219]
    ds_read_b64_tr_b16 v[236:237], v198 offset:12288
L_pad1:
    s_cbranch_execz L_pad5
    ds_read_b64_tr_b16 v[238:239], v198 offset:14336
    v_mfma_f32_16x16x32_bf16 v[212:215], v[20:23], v[32:35], v[212:215]
    ds_read_b64_tr_b16 v[232:233], v197 offset:12288
    ds_read_b64_tr_b16 v[234:235], v197 offset:14336
    s_waitcnt lgkmcnt(10)
    v_mfma_f32_16x16x32_bf16 v[204:207], v[36:39], v[44:47], v[204:207]
    ds_read_b64_tr_b16 v[240:241], v199 offset:12288
    ds_read_b64_tr_b16 v[242:243], v199 offset:14336
    s_waitcnt lgkmcnt(10)
    v_mfma_f32_16x16x32_bf16 v[208:211], v[40:43], v[44:47], v[208:211]
    s_waitcnt lgkmcnt(8)
    v_mfma_f32_16x16x32_bf16 v[216:219], v[40:43], v[48:51], v[216:219]
    v_mfma_f32_16x16x32_bf16 v[212:215], v[36:39], v[48:51], v[212:215]
    s_waitcnt lgkmcnt(4)
    v_mfma_f32_16x16x32_bf16 v[204:207], v[228:231], v[236:239], v[204:207]
    s_waitcnt lgkmcnt(2)
    v_mfma_f32_16x16x32_bf16 v[208:211], v[232:235], v[236:239], v[208:211]
    s_waitcnt lgkmcnt(0)
    s_nop 0
    v_mfma_f32_16x16x32_bf16 v[216:219], v[232:235], v[240:243], v[216:219]
    v_mfma_f32_16x16x32_bf16 v[212:215], v[228:231], v[240:243], v[212:215]
    v_mfma_f32_16x16x32_bf16 v[220:223], v[4:7], v[200:203], 0
    v_mfma_f32_16x16x32_bf16 v[224:227], v[8:11], v[200:203], 0
    v_mfma_f32_16x16x32_bf16 v[220:223], v[20:23], v[200:203], v[220:223]
    v_mfma_f32_16x16x32_bf16 v[224:227], v[24:27], v[200:203], v[224:227]
    v_cvt_pk_bf16_f32 v12, v204, v205
    v_cvt_pk_bf16_f32 v13, v206, v207
    v_cvt_pk_bf16_f32 v14, v208, v209
    v_cvt_pk_bf16_f32 v15, v210, v211
    v_mfma_f32_16x16x32_bf16 v[220:223], v[36:39], v[200:203], v[220:223]
    v_add_u32_e64 v12, s94, v12
    v_and_or_b32 v12, v12, s95, v54
    v_mfma_f32_16x16x32_bf16 v[224:227], v[40:43], v[200:203], v[224:227]
    v_add_u32_e64 v13, s94, v13
    v_and_or_b32 v13, v13, s95, v54
    v_mfma_f32_16x16x32_bf16 v[220:223], v[228:231], v[200:203], v[220:223]
    v_add_u32_e64 v14, s94, v14
    v_and_or_b32 v14, v14, s95, v54
    v_mfma_f32_16x16x32_bf16 v[224:227], v[232:235], v[200:203], v[224:227]
    v_add_u32_e64 v15, s94, v15
    v_and_or_b32 v15, v15, s95, v54
    s_bitcmp1_b32 s99, 0
    s_cbranch_scc1 Lls_18
    buffer_store_dwordx4 v[12:15], v62, s[36:39], s78 offen sc1
    s_branch Lle_19
Lls_18:
    buffer_store_dwordx4 v[12:15], v62, s[36:39], s78 offen
Lle_19:
    v_cvt_pk_bf16_f32 v28, v212, v213
    v_cvt_pk_bf16_f32 v29, v214, v215
    v_cvt_pk_bf16_f32 v30, v216, v217
    v_cvt_pk_bf16_f32 v31, v218, v219
    v_add_u32 v28, s94, v28
    v_and_or_b32 v28, v28, s95, v54
    v_add_u32_e64 v29, s94, v29
    v_and_or_b32 v29, v29, s95, v54
    v_add_u32_e64 v30, s94, v30
    v_and_or_b32 v30, v30, s95, v54
    v_add_u32_e64 v31, s94, v31
    v_and_or_b32 v31, v31, s95, v54
    s_bitcmp1_b32 s99, 0
    s_cbranch_scc1 Lls_20
    buffer_store_dwordx4 v[28:31], v63, s[36:39], s78 offen sc1
    s_branch Lle_21
Lls_20:
    s_nop 0
    buffer_store_dwordx4 v[28:31], v63, s[36:39], s78 offen
Lle_21:
    v_cvt_pk_bf16_f32 v44, v220, v221
    v_cvt_pk_bf16_f32 v45, v222, v223
    v_cvt_pk_bf16_f32 v46, v224, v225
    v_cvt_pk_bf16_f32 v47, v226, v227
    s_mov_b32 exec_lo, 0x00010001
    s_mov_b32 exec_hi, 0x00010001
    s_bitcmp1_b32 s99, 0
    s_cbranch_scc1 Lls_22
    buffer_store_dwordx4 v[44:47], v2, s[36:39], s79 offen sc1
    s_branch Lle_23
Lls_22:
    buffer_store_dwordx4 v[44:47], v2, s[36:39], s79 offen
Lle_23:
    s_mov_b64 exec, -1
    s_sleep 3
    s_mov_b32 s85, 0
Lspin_24:
    s_add_u32 s85, s85, 1
    s_cmp_gt_u32 s85, 400000
    s_cbranch_scc1 L_end
    buffer_load_dwordx4 v[20:23], v56, s[36:39], s64 offen sc1
    buffer_load_dwordx4 v[24:27], v56, s[36:39], s65 offen sc1
    buffer_load_dwordx4 v[16:19], v58, s[36:39], s82 offen sc1
    s_waitcnt vmcnt(0)
Lchk_25:
    s_nop 0
    v_bitop3_b32 v28, v20, v24, v54 bitop3:0x7e
    v_bitop3_b32 v29, v21, v25, v54 bitop3:0x7e
    v_bitop3_b32 v30, v22, v26, v54 bitop3:0x7e
    v_bitop3_b32 v31, v23, v27, v54 bitop3:0x7e
    v_or3_b32 v28, v28, v29, v30
    v_cmp_eq_u32 s[90:91], -1, v16
    v_or_b32_e64 v28, v28, v31
    v_and_b32 v28, 0x00010001, v28
    v_cmp_ne_u32_e64 vcc, 0, v28
    s_or_b64 vcc, vcc, s[90:91]
    s_cbranch_vccnz Lspin_24
    v_lshl_add_u32 v28, v20, 16, s83
    v_and_b32 v29, 0xfffe0000, v20
    v_lshl_add_u32 v36, v24, 16, s83
    v_and_b32 v37, 0xfffe0000, v24
    v_pk_add_f32 v[28:29], v[28:29], v[36:37]
    v_lshl_add_u32 v30, v21, 16, s83
    v_and_b32 v31, 0xfffe0000, v21
    v_lshl_add_u32 v38, v25, 16, s83
    v_and_b32 v39, 0xfffe0000, v25
    v_pk_add_f32 v[30:31], v[30:31], v[38:39]
    v_lshl_add_u32 v32, v22, 16, s83
    v_and_b32 v33, 0xfffe0000, v22
    v_lshl_add_u32 v40, v26, 16, s83
    v_and_b32 v41, 0xfffe0000, v26
    v_pk_add_f32 v[32:33], v[32:33], v[40:41]
    v_lshl_add_u32 v34, v23, 16, s83
    v_and_b32 v35, 0xfffe0000, v23
    v_lshl_add_u32 v42, v27, 16, s83
    v_and_b32 v43, 0xfffe0000, v27
    v_pk_add_f32 v[34:35], v[34:35], v[42:43]
    v_permlane32_swap_b32 v28, v32
    v_permlane32_swap_b32 v29, v33
    v_permlane32_swap_b32 v30, v34
    v_permlane32_swap_b32 v31, v35
    v_pk_add_f32 v[28:29], v[28:29], v[32:33]
    v_pk_add_f32 v[30:31], v[30:31], v[34:35]
    s_nop 1
    v_permlane16_swap_b32 v28, v30
    v_permlane16_swap_b32_e64 v29, v31
    v_pk_add_f32 v[28:29], v[28:29], v[30:31]
    s_nop 1
    v_add_f32_dpp v28, v28, v28 row_ror:8 row_mask:0xf bank_mask:0xf
    v_add_f32_dpp v29, v29, v29 row_ror:8 row_mask:0xf bank_mask:0xf
    v_cvt_pk_bf16_f32 v36, v28, v29
    s_mov_b32 exec_lo, 0x00ff00ff
    s_mov_b32 exec_hi, 0x00ff00ff
    s_bitcmp1_b32 s99, 0
    s_cbranch_scc1 Lls_26
    buffer_store_dword v36, v57, s[36:39], s81 offen sc1
    s_branch Lle_27
Lls_26:
    buffer_store_dword v36, v57, s[36:39], s81 offen
Lle_27:
    s_mov_b64 exec, -1
    v_lshlrev_b32 v28, 16, v16
    v_and_b32 v29, 0xffff0000, v16
    v_lshlrev_b32_e64 v30, 16, v17
    v_and_b32 v31, 0xffff0000, v17
    v_lshlrev_b32_e64 v32, 16, v18
    v_and_b32 v33, 0xffff0000, v18
    v_lshlrev_b32_e64 v34, 16, v19
    v_and_b32 v35, 0xffff0000, v19
    v_permlane32_swap_b32 v28, v32
    v_permlane32_swap_b32 v29, v33
    v_permlane32_swap_b32 v30, v34
    v_permlane32_swap_b32 v31, v35
    v_pk_add_f32 v[28:29], v[28:29], v[32:33]
    v_pk_add_f32 v[30:31], v[30:31], v[34:35]
    s_nop 1
    v_permlane16_swap_b32 v28, v30
    v_permlane16_swap_b32_e64 v29, v31
    v_pk_add_f32 v[28:29], v[28:29], v[30:31]
    s_nop 1
    v_add_f32_dpp v38, v28, v28 row_ror:8 row_mask:0xf bank_mask:0x3
    s_nop 1
    v_add_f32_dpp v38, v29, v29 row_ror:8 row_mask:0xf bank_mask:0xc
    s_nop 1
    v_add_f32_dpp v37, v38, v38 row_shr:4 row_mask:0xf bank_mask:0xf
    v_cvt_pk_bf16_f32 v37, v37, v37
    s_mov_b32 exec_lo, 0xf0f0f0f0
    s_mov_b32 exec_hi, 0xf0f0f0f0
    ds_write_b16 v59, v37
    s_mov_b64 exec, -1
    s_waitcnt lgkmcnt(0)
    s_barrier
    v_lshlrev_b32 v4, 4, v2
    s_lshl_b32 s78, s76, 10
    s_add_u32 s78, s78, 110592
    v_add_u32 v5, s78, v4
    s_lshl_b32 s78, s76, 12
    s_add_u32 s78, s78, 131072
    v_add_u32 v6, s78, v4
    s_lshl_b32 s100, s77, 9
    s_add_u32 s100, s100, 8912896
    v_mov_b32 v48, s75
    v_mov_b32 v49, s75
    v_lshl_add_u32 v50, v2, 3, s100
    s_lshl_b32 s83, s71, 4
    s_add_u32 s83, s83, s72
    s_lshl_b32 s78, s0, 11
    s_and_b32 s79, s76, 1
    s_lshl_b32 s79, s79, 10
    s_add_u32 s78, s78, s79
    s_add_u32 s78, s78, 655360
    s_mul_i32 s79, s74, 56
    s_add_u32 s79, s79, s73
    s_lshl_b32 s79, s79, 10
    s_add_u32 s79, s79, 1114112
    s_cmp_eq_u32 s76, 1
    s_cselect_b32 s78, s79, s78
    s_cmp_ge_u32 s73, 56
    s_cselect_b32 s78, 0x10000000, s78
    s_lshl_b32 s79, s83, 11
    s_add_u32 s79, s79, s84
    s_add_u32 s79, s79, 1572864
    s_cmp_lt_u32 s76, 2
    s_cselect_b32 s94, s79, s78
    s_lshl_b32 s79, s83, 9
    s_add_u32 s79, s79, 524288
    s_cmp_eq_u32 s76, 0
    s_cselect_b32 s78, s79, s78
    s_cselect_b32 s79, 0, -1
    v_mov_b32 v56, -1
    v_mov_b32 v57, -1
    v_mov_b32 v58, -1
    v_mov_b32_e64 v59, -1
    s_barrier
    s_mov_b32 s100, 50176
    buffer_load_dwordx4 v[92:95], v244, s[48:51], s100 offen nt
    s_mov_b32 s100, 50176
    buffer_load_dwordx4 v[124:127], v244, s[52:55], s100 offen nt
    s_mov_b32 s100, 0
    s_nop 0
    buffer_load_dwordx4 v[128:131], v245, s[56:59], s100 offen nt
    s_mov_b32 s100, 2048
    buffer_load_dwordx4 v[132:135], v245, s[56:59], s100 offen nt
    ds_write_b128 v6, v[180:183] offset:0
    ds_write_b128 v6, v[184:187] offset:1024
    ds_write_b128 v6, v[188:191] offset:2048
    ds_write_b128 v6, v[192:195] offset:3072
    ds_write_b128 v5, v[160:163] offset:16384
    ds_write_b128 v5, v[164:167] offset:12288
    ds_write_b128 v5, v[168:171] offset:8192
    ds_write_b128 v5, v[172:175] offset:4096
    ds_write_b128 v5, v[176:179] offset:0
    s_waitcnt lgkmcnt(0)
    s_barrier
    s_cmp_lg_u32 s76, 0
    s_cbranch_scc1 Lfs_28
    buffer_store_dwordx2 v[48:49], v50, s[36:39], 0 offen sc1
Lfs_28:
    s_mov_b32 exec_hi, s79
    buffer_store_dwordx4 v[56:59], v4, s[36:39], s78 offen sc1
    s_mov_b32 exec_hi, -1
    s_mov_b32 s100, 0x05040100
    s_mov_b32 s101, 0x07060302
    v_perm_b32 v7, v68, v64, s100
    v_perm_b32 v68, v68, v64, s101
    v_mov_b32_e64 v64, v7
    v_perm_b32 v7, v69, v65, s100
    v_perm_b32 v69, v69, v65, s101
    v_mov_b32_e64 v65, v7
    v_perm_b32 v7, v70, v66, s100
    v_perm_b32 v70, v70, v66, s101
    v_mov_b32_e64 v66, v7
    v_perm_b32 v7, v71, v67, s100
    v_perm_b32 v71, v71, v67, s101
    v_mov_b32_e64 v67, v7
    v_perm_b32 v7, v100, v96, s100
    v_perm_b32 v100, v100, v96, s101
    v_mov_b32_e64 v96, v7
    v_perm_b32 v7, v101, v97, s100
    v_perm_b32 v101, v101, v97, s101
    v_mov_b32_e64 v97, v7
    v_perm_b32 v7, v102, v98, s100
    v_perm_b32 v102, v102, v98, s101
    v_mov_b32_e64 v98, v7
    v_perm_b32 v7, v103, v99, s100
    v_perm_b32 v103, v103, v99, s101
    v_mov_b32_e64 v99, v7
    v_perm_b32 v7, v76, v72, s100
    v_perm_b32 v76, v76, v72, s101
    v_mov_b32_e64 v72, v7
    v_perm_b32 v7, v77, v73, s100
    v_perm_b32 v77, v77, v73, s101
    v_mov_b32_e64 v73, v7
    v_perm_b32 v7, v78, v74, s100
    v_perm_b32 v78, v78, v74, s101
    v_mov_b32_e64 v74, v7
    v_perm_b32 v7, v79, v75, s100
    v_perm_b32 v79, v79, v75, s101
    v_mov_b32_e64 v75, v7
    v_perm_b32 v7, v108, v104, s100
    v_perm_b32 v108, v108, v104, s101
    v_mov_b32_e64 v104, v7
    v_perm_b32 v7, v109, v105, s100
    v_perm_b32 v109, v109, v105, s101
    v_mov_b32_e64 v105, v7
    v_perm_b32 v7, v110, v106, s100
    v_perm_b32 v110, v110, v106, s101
    v_mov_b32_e64 v106, v7
    v_perm_b32 v7, v111, v107, s100
    v_perm_b32 v111, v111, v107, s101
    v_mov_b32_e64 v107, v7
    v_perm_b32 v7, v84, v80, s100
    v_perm_b32 v84, v84, v80, s101
    v_mov_b32_e64 v80, v7
    v_perm_b32 v7, v85, v81, s100
    v_perm_b32 v85, v85, v81, s101
    v_mov_b32_e64 v81, v7
    v_perm_b32 v7, v86, v82, s100
    v_perm_b32 v86, v86, v82, s101
    v_mov_b32_e64 v82, v7
    v_perm_b32 v7, v87, v83, s100
    v_perm_b32 v87, v87, v83, s101
    v_mov_b32_e64 v83, v7
    v_perm_b32 v7, v116, v112, s100
L_pad2:
    s_cbranch_execz L_pad6
    v_perm_b32 v116, v116, v112, s101
    v_mov_b32 v112, v7
    v_perm_b32 v7, v117, v113, s100
    v_perm_b32 v117, v117, v113, s101
    v_mov_b32_e64 v113, v7
    v_perm_b32 v7, v118, v114, s100
    v_perm_b32 v118, v118, v114, s101
    v_mov_b32_e64 v114, v7
    v_perm_b32 v7, v119, v115, s100
    v_perm_b32 v119, v119, v115, s101
    v_mov_b32_e64 v115, v7
    s_cmp_lg_u32 s76, 2
    s_cbranch_scc1 Lf2_29
    s_mov_b64 exec, 0xffff
    s_mov_b32 s85, 1
    s_mov_b32 s101, 0
    s_branch Lb_31
Lspin_30:
    s_add_u32 s85, s85, 1
    s_cmp_gt_u32 s85, 400000
    s_cbranch_scc1 L_end
    s_add_u32 s101, s101, 128
    s_min_u32 s101, s101, 384
Lb_31:
    buffer_load_dword v52, v61, s[36:39], s101 offen sc1
    s_waitcnt vmcnt(0)
    v_cmp_ne_u32_e64 vcc, s75, v52
    s_cbranch_vccnz Lspin_30
    s_mov_b64 exec, -1
Lf2_29:
    s_barrier
    s_waitcnt vmcnt(0)
    s_mov_b32 s100, 0x05040100
    s_mov_b32 s101, 0x07060302
    v_perm_b32 v7, v92, v88, s100
    v_perm_b32 v92, v92, v88, s101
    v_mov_b32_e64 v88, v7
    v_perm_b32 v7, v93, v89, s100
    v_perm_b32 v93, v93, v89, s101
    v_mov_b32_e64 v89, v7
    v_perm_b32 v7, v94, v90, s100
    v_perm_b32 v94, v94, v90, s101
    v_mov_b32_e64 v90, v7
    v_perm_b32 v7, v95, v91, s100
    v_perm_b32 v95, v95, v91, s101
    v_mov_b32_e64 v91, v7
    v_perm_b32 v7, v124, v120, s100
    v_perm_b32 v124, v124, v120, s101
    v_mov_b32_e64 v120, v7
    v_perm_b32 v7, v125, v121, s100
    v_perm_b32 v125, v125, v121, s101
    v_mov_b32_e64 v121, v7
    v_perm_b32 v7, v126, v122, s100
    v_perm_b32 v126, v126, v122, s101
    v_mov_b32_e64 v122, v7
    v_perm_b32 v7, v127, v123, s100
    v_perm_b32 v127, v127, v123, s101
    v_mov_b32_e64 v123, v7
    v_perm_b32 v7, v132, v128, s100
    v_perm_b32 v132, v132, v128, s101
    v_mov_b32_e64 v128, v7
    v_perm_b32 v7, v133, v129, s100
    v_perm_b32 v133, v133, v129, s101
    v_mov_b32_e64 v129, v7
    v_perm_b32 v7, v134, v130, s100
    v_perm_b32 v134, v134, v130, s101
    v_mov_b32_e64 v130, v7
    v_perm_b32 v7, v135, v131, s100
    v_perm_b32 v135, v135, v131, s101
    v_mov_b32 v131, v7
    v_lshrrev_b32 v8, 3, v2
    v_and_b32 v9, 7, v2
    v_lshlrev_b32 v10, 4, v9
    v_lshl_add_u32 v11, v8, 13, v10
    v_and_b32 v12, 15, v2
    v_lshlrev_b32 v12, 13, v12
    v_lshl_add_u32 v13, v8, 9, v10
    v_lshl_add_u32 v14, v9, 3, v8
    s_lshl_b32 s80, s74, 2
    s_add_u32 s80, s80, s76
    s_lshl_b32 s78, s80, 9
    s_add_u32 s78, s78, 524288
    s_add_u32 s79, s78, 65536
    s_add_u32 s81, s73, s76
    s_and_b32 s81, s81, 3
    s_andn2_b32 s100, s73, 3
    s_or_b32 s81, s81, s100
    s_lshl_b32 s81, s81, 13
    s_lshl_b32 s80, s80, 9
    s_add_u32 s80, s80, s81
    s_add_u32 s80, s80, 655360
    s_lshl_b32 s81, s73, 13
    s_add_u32 s81, s81, 655360
    s_lshl_b32 s64, s76, 7
    s_add_u32 s64, s64, s81
    s_add_u32 s65, s64, 4096
    v_lshrrev_b32 v50, 5, v2
    v_lshl_add_u32 v50, v9, 1, v50
    s_lshl_b32 s82, s76, 5
    s_add_u32 s82, s82, 163456
    v_lshl_add_u32 v50, v50, 1, s82
    v_lshlrev_b32 v27, 4, v8
    v_add_u32 v51, 163456, v27
    v_lshlrev_b32 v49, 2, v14
    v_lshlrev_b32 v15, 3, v14
    v_mov_b32 v26, 163360
    s_mul_i32 s66, s74, 56
    s_add_u32 s66, s66, s73
    s_lshl_b32 s66, s66, 10
    s_lshl_b32 s82, s76, 8
    s_add_u32 s66, s66, s82
    s_add_u32 s66, s66, 1114112
    s_barrier
    buffer_load_dwordx4 v[56:59], v4, s[36:39], s94 offen sc1
    s_mov_b32 s100, 4096
    buffer_load_dwordx4 v[136:139], v245, s[56:59], s100 offen nt
    s_mov_b32 s100, 6144
    buffer_load_dwordx4 v[140:143], v245, s[56:59], s100 offen nt
    s_mov_b32 s100, 8192
    buffer_load_dwordx4 v[144:147], v245, s[56:59], s100 offen nt
    s_mov_b32 s100, 10240
    buffer_load_dwordx4 v[148:151], v245, s[56:59], s100 offen nt
    s_barrier
    s_waitcnt vmcnt(0)
    s_mov_b32 s100, 0x05040100
    s_mov_b32 s101, 0x07060302
    v_perm_b32 v7, v140, v136, s100
    v_perm_b32 v140, v140, v136, s101
    v_mov_b32_e64 v136, v7
    v_perm_b32 v7, v141, v137, s100
    v_perm_b32 v141, v141, v137, s101
    v_mov_b32_e64 v137, v7
    v_perm_b32 v7, v142, v138, s100
    v_perm_b32 v142, v142, v138, s101
    v_mov_b32_e64 v138, v7
    v_perm_b32 v7, v143, v139, s100
    v_perm_b32 v143, v143, v139, s101
    v_mov_b32_e64 v139, v7
    v_perm_b32 v7, v148, v144, s100
    v_perm_b32 v148, v148, v144, s101
    v_mov_b32_e64 v144, v7
    v_perm_b32 v7, v149, v145, s100
    v_perm_b32 v149, v149, v145, s101
    v_mov_b32_e64 v145, v7
    v_perm_b32 v7, v150, v146, s100
    v_perm_b32 v150, v150, v146, s101
    v_mov_b32_e64 v146, v7
    v_perm_b32 v7, v151, v147, s100
    v_perm_b32 v151, v151, v147, s101
    v_mov_b32 v147, v7
    s_barrier
    s_mov_b32 s100, 12288
    buffer_load_dwordx4 v[152:155], v245, s[56:59], s100 offen nt
    s_mov_b32 s100, 14336
    buffer_load_dwordx4 v[156:159], v245, s[56:59], s100 offen nt
    s_and_b32 s79, s2, 7
    s_lshl_b32 s79, s79, 9
    s_add_u32 s79, s79, 524288
    s_mov_b64 exec, 0xffff
    s_mov_b32 s85, 1
    s_sleep 18
    s_branch Lb_33
Lspin_32:
    s_add_u32 s85, s85, 1
    s_cmp_gt_u32 s85, 400000
    s_cbranch_scc1 L_end
    s_or_b32 s79, s79, 4096
Lb_33:
    buffer_load_dwordx2 v[24:25], v12, s[36:39], s79 offen offset:128 sc1
    s_waitcnt vmcnt(0)
    v_cmp_ne_u32 vcc, s75, v25
    s_cbranch_vccnz Lspin_32
    v_max_f32_dpp v24, v24, v24 row_ror:8 row_mask:0xf bank_mask:0xf
    s_nop 1
    v_max_f32_dpp v24, v24, v24 row_ror:4 row_mask:0xf bank_mask:0xf
    s_nop 1
    v_max_f32_dpp v24, v24, v24 row_ror:2 row_mask:0xf bank_mask:0xf
    s_nop 1
    v_max_f32_dpp v24, v24, v24 row_ror:1 row_mask:0xf bank_mask:0xf
    s_nop 0
    v_readfirstlane_b32 s97, v24
    s_mov_b64 exec, -1
    s_nop 0
    v_mov_b32 v24, s97
    s_cmp_ge_u32 s73, 56
    s_cbranch_scc1 L_red
    s_bfe_u32 s79, s97, 0x40007
    s_lshl_b32 s79, s79, 13
    s_add_u32 s78, s78, s79
    buffer_load_dwordx4 v[20:23], v27, s[36:39], s78 offen sc1
    ds_write_b32 v26, v24
    s_mov_b32 s85, 1
    s_mov_b32 s100, 0x05040100
    s_mov_b32 s101, 0x07060302
    v_perm_b32 v7, v156, v152, s100
    v_perm_b32 v156, v156, v152, s101
    v_mov_b32 v152, v7
    v_perm_b32 v7, v157, v153, s100
    v_perm_b32 v157, v157, v153, s101
    v_mov_b32_e64 v153, v7
    v_perm_b32 v7, v158, v154, s100
    v_perm_b32 v158, v158, v154, s101
    v_mov_b32_e64 v154, v7
    v_perm_b32 v7, v159, v155, s100
    v_perm_b32 v159, v159, v155, s101
    v_mov_b32_e64 v155, v7
    s_branch Lb_35
Lspin_34:
    s_add_u32 s85, s85, 1
    s_cmp_gt_u32 s85, 400000
    s_cbranch_scc1 L_end
    buffer_load_dwordx4 v[20:23], v27, s[36:39], s78 offen sc1
Lb_35:
    s_waitcnt vmcnt(0) lgkmcnt(0)
    v_max3_u32 v16, v20, v21, v22
    v_max_u32 v16, v16, v23
    v_cmp_eq_u32_e64 vcc, -1, v16
    s_cbranch_vccnz Lspin_34
    v_dot2_f32_bf16 v28, v64, v20, 0
    v_dot2_f32_bf16 v29, v68, v20, 0
    v_dot2_f32_bf16 v30, v65, v20, 0
    v_dot2_f32_bf16 v31, v69, v20, 0
    v_dot2_f32_bf16 v32, v66, v20, 0
    v_dot2_f32_bf16 v33, v70, v20, 0
    v_dot2_f32_bf16 v34, v67, v20, 0
    v_dot2_f32_bf16 v35, v71, v20, 0
    v_dot2_f32_bf16 v28, v72, v21, v28
    v_dot2_f32_bf16 v29, v76, v21, v29
    v_dot2_f32_bf16 v30, v73, v21, v30
    v_dot2_f32_bf16 v31, v77, v21, v31
    v_dot2_f32_bf16 v32, v74, v21, v32
    v_dot2_f32_bf16 v33, v78, v21, v33
    v_dot2_f32_bf16 v34, v75, v21, v34
    v_dot2_f32_bf16 v35, v79, v21, v35
    v_dot2_f32_bf16 v28, v80, v22, v28
    v_dot2_f32_bf16 v29, v84, v22, v29
    v_dot2_f32_bf16 v30, v81, v22, v30
    v_dot2_f32_bf16 v31, v85, v22, v31
    v_dot2_f32_bf16 v32, v82, v22, v32
    v_dot2_f32_bf16 v33, v86, v22, v33
    v_dot2_f32_bf16 v34, v83, v22, v34
    v_dot2_f32_bf16 v35, v87, v22, v35
    v_dot2_f32_bf16 v28, v88, v23, v28
    v_dot2_f32_bf16 v29, v92, v23, v29
    v_dot2_f32_bf16 v30, v89, v23, v30
    v_dot2_f32_bf16 v31, v93, v23, v31
    v_dot2_f32_bf16 v32, v90, v23, v32
    v_dot2_f32_bf16 v33, v94, v23, v33
    v_dot2_f32_bf16 v34, v91, v23, v34
    v_dot2_f32_bf16 v35, v95, v23, v35
    v_dot2_f32_bf16 v36, v96, v20, 0
    v_dot2_f32_bf16 v37, v100, v20, 0
    v_dot2_f32_bf16 v38, v97, v20, 0
    v_dot2_f32_bf16 v39, v101, v20, 0
    v_dot2_f32_bf16 v40, v98, v20, 0
    v_dot2_f32_bf16 v41, v102, v20, 0
    v_dot2_f32_bf16 v42, v99, v20, 0
    v_dot2_f32_bf16 v43, v103, v20, 0
    v_dot2_f32_bf16 v36, v104, v21, v36
    v_dot2_f32_bf16 v37, v108, v21, v37
    v_dot2_f32_bf16 v38, v105, v21, v38
    v_dot2_f32_bf16 v39, v109, v21, v39
    v_dot2_f32_bf16 v40, v106, v21, v40
    v_dot2_f32_bf16 v41, v110, v21, v41
    v_dot2_f32_bf16 v42, v107, v21, v42
    v_dot2_f32_bf16 v43, v111, v21, v43
    v_dot2_f32_bf16 v36, v112, v22, v36
    v_dot2_f32_bf16 v37, v116, v22, v37
    v_dot2_f32_bf16 v38, v113, v22, v38
    v_dot2_f32_bf16 v39, v117, v22, v39
    v_dot2_f32_bf16 v40, v114, v22, v40
    v_dot2_f32_bf16 v41, v118, v22, v41
    v_dot2_f32_bf16 v42, v115, v22, v42
    v_dot2_f32_bf16 v43, v119, v22, v43
    v_dot2_f32_bf16 v36, v120, v23, v36
    v_dot2_f32_bf16 v37, v124, v23, v37
    v_dot2_f32_bf16 v38, v121, v23, v38
    v_dot2_f32_bf16 v39, v125, v23, v39
    v_dot2_f32_bf16 v40, v122, v23, v40
    v_dot2_f32_bf16 v41, v126, v23, v41
    v_dot2_f32_bf16 v42, v123, v23, v42
    v_dot2_f32_bf16 v43, v127, v23, v43
    v_permlane32_swap_b32 v28, v32
    v_permlane32_swap_b32 v29, v33
    v_permlane32_swap_b32 v30, v34
    v_permlane32_swap_b32 v31, v35
    v_permlane32_swap_b32 v36, v40
    v_permlane32_swap_b32 v37, v41
    v_permlane32_swap_b32 v38, v42
    v_permlane32_swap_b32 v39, v43
    v_pk_add_f32 v[28:29], v[28:29], v[32:33]
    v_pk_add_f32 v[30:31], v[30:31], v[34:35]
    v_pk_add_f32 v[36:37], v[36:37], v[40:41]
    v_pk_add_f32 v[38:39], v[38:39], v[42:43]
    v_permlane16_swap_b32 v28, v30
    v_permlane16_swap_b32 v29, v31
    v_permlane16_swap_b32 v36, v38
    v_permlane16_swap_b32 v37, v39
    v_pk_add_f32 v[28:29], v[28:29], v[30:31]
    v_pk_add_f32 v[36:37], v[36:37], v[38:39]
    s_nop 0
    v_add_f32_dpp v44, v28, v28 row_ror:8 row_mask:0xf bank_mask:0x3
    v_add_f32_dpp v45, v36, v36 row_ror:8 row_mask:0xf bank_mask:0x3
    s_nop 0
    v_add_f32_dpp v44, v29, v29 row_ror:8 row_mask:0xf bank_mask:0xc
    v_add_f32_dpp v45, v37, v37 row_ror:8 row_mask:0xf bank_mask:0xc
    s_bitcmp1_b32 s99, 0
    s_cbranch_scc1 Lls_36
    buffer_store_dwordx2 v[44:45], v15, s[36:39], s80 offen sc1
L_pad3:
    s_cbranch_execz L_pad7
    s_branch Lle_37
Lls_36:
    buffer_store_dwordx2 v[44:45], v15, s[36:39], s80 offen
Lle_37:
    s_mov_b32 s95, s80
    s_barrier
    s_sleep 3
    s_mov_b32 s85, 0
Lspin_38:
    s_add_u32 s85, s85, 1
    s_cmp_gt_u32 s85, 400000
    s_cbranch_scc1 L_end
    buffer_load_dwordx4 v[16:19], v13, s[36:39], s64 offen sc1
    buffer_load_dwordx4 v[20:23], v13, s[36:39], s65 offen sc1
    s_waitcnt vmcnt(0)
    v_max3_u32 v25, v16, v18, v20
    v_max_u32 v25, v25, v22
    v_cmp_eq_u32 vcc, -1, v25
    s_cbranch_vccnz Lspin_38
    v_pk_add_f32 v[16:17], v[16:17], v[20:21]
    v_pk_add_f32 v[18:19], v[18:19], v[22:23]
    s_nop 1
    v_permlane32_swap_b32 v16, v18
    v_permlane32_swap_b32_e64 v17, v19
    v_pk_add_f32 v[16:17], v[16:17], v[18:19]
    v_mov_b32 v18, v16
    v_mov_b32 v19, v17
    s_nop 0
    v_permlane16_swap_b32 v16, v18
    v_permlane16_swap_b32_e64 v17, v19
    v_pk_add_f32 v[16:17], v[16:17], v[18:19]
    s_nop 1
    v_add_f32_dpp v16, v16, v16 row_ror:8 row_mask:0xf bank_mask:0xf
    v_add_f32_dpp v17, v17, v17 row_ror:8 row_mask:0xf bank_mask:0xf
    v_cvt_pk_bf16_f32 v17, v16, v17
    v_lshlrev_b32 v16, 16, v17
    v_mul_f32 v18, 0xbfb8aa3b, v16
    v_exp_f32_e64 v18, v18
    v_and_b32 v17, 0xffff0000, v17
    v_add_f32 v18, 1.0, v18
    v_rcp_f32 v18, v18
    s_nop 0
    v_mul_f32 v16, v16, v18
    v_cvt_pk_bf16_f32 v16, v16, v16
    v_and_b32 v16, 0xffff0000, v16
    v_mul_f32_e64 v16, v16, v17
    v_cvt_pk_bf16_f32 v16, v16, v16
    ds_write_b16 v50, v16
    s_waitcnt lgkmcnt(0)
    s_barrier
    ds_read_b128 v[20:23], v51
    s_waitcnt lgkmcnt(0)
    s_nop 0
    v_dot2_f32_bf16 v28, v128, v20, 0
    v_dot2_f32_bf16 v29, v132, v20, 0
    v_dot2_f32_bf16 v30, v129, v20, 0
    v_dot2_f32_bf16 v31, v133, v20, 0
    v_dot2_f32_bf16 v32, v130, v20, 0
    v_dot2_f32_bf16 v33, v134, v20, 0
    v_dot2_f32_bf16 v34, v131, v20, 0
    v_dot2_f32_bf16 v35, v135, v20, 0
    v_dot2_f32_bf16 v28, v136, v21, v28
    v_dot2_f32_bf16 v29, v140, v21, v29
    v_dot2_f32_bf16 v30, v137, v21, v30
    v_dot2_f32_bf16 v31, v141, v21, v31
    v_dot2_f32_bf16 v32, v138, v21, v32
    v_dot2_f32_bf16 v33, v142, v21, v33
    v_dot2_f32_bf16 v34, v139, v21, v34
    v_dot2_f32_bf16 v35, v143, v21, v35
    v_dot2_f32_bf16 v28, v144, v22, v28
    v_dot2_f32_bf16 v29, v148, v22, v29
    v_dot2_f32_bf16 v30, v145, v22, v30
    v_dot2_f32_bf16 v31, v149, v22, v31
    v_dot2_f32_bf16 v32, v146, v22, v32
    v_dot2_f32_bf16 v33, v150, v22, v33
    v_dot2_f32_bf16 v34, v147, v22, v34
    v_dot2_f32_bf16 v35, v151, v22, v35
    v_dot2_f32_bf16 v28, v152, v23, v28
    v_dot2_f32_bf16 v29, v156, v23, v29
    v_dot2_f32_bf16 v30, v153, v23, v30
    v_dot2_f32_bf16 v31, v157, v23, v31
    v_dot2_f32_bf16 v32, v154, v23, v32
    v_dot2_f32_bf16 v33, v158, v23, v33
    v_dot2_f32_bf16 v34, v155, v23, v34
    v_dot2_f32_bf16 v35, v159, v23, v35
    v_permlane32_swap_b32 v28, v32
    v_permlane32_swap_b32 v29, v33
    v_permlane32_swap_b32 v30, v34
    v_permlane32_swap_b32 v31, v35
    v_pk_add_f32 v[28:29], v[28:29], v[32:33]
    v_pk_add_f32 v[30:31], v[30:31], v[34:35]
    s_nop 1
    v_permlane16_swap_b32 v28, v30
    v_permlane16_swap_b32_e64 v29, v31
    v_pk_add_f32 v[28:29], v[28:29], v[30:31]
    s_nop 1
    v_add_f32_dpp v46, v28, v28 row_ror:8 row_mask:0xf bank_mask:0x3
    s_nop 1
    v_add_f32_dpp v46, v29, v29 row_ror:8 row_mask:0xf bank_mask:0xc
    buffer_store_dword v46, v49, s[36:39], s66 offen sc1
    s_barrier
    s_branch L_fin
L_red:
    v_mov_b32 v26, 163360
    ds_write_b32 v26, v24
    s_waitcnt lgkmcnt(0)
    s_barrier
    s_barrier
    s_barrier
    s_cmp_lg_u32 s76, 0
    s_cbranch_scc1 L_fin
    s_sub_u32 s83, s0, 224
    v_lshrrev_b32_e64 v14, 4, v2
    v_lshl_add_u32 v14, v9, 2, v14
    v_lshlrev_b32 v15, 2, v14
    v_lshlrev_b32 v14, 1, v14
    s_bfe_u32 s78, s97, 0x40007
    s_lshl_b32 s78, s78, 13
    s_lshr_b32 s79, s83, 1
    s_lshl_b32 s79, s79, 9
    s_add_u32 s78, s78, s79
    s_and_b32 s79, s83, 1
    s_lshl_b32 s79, s79, 7
    s_add_u32 s78, s78, s79
    s_add_u32 s78, s78, 524544
    s_mov_b32 s85, 0
Lspin_39:
    s_add_u32 s85, s85, 1
    s_cmp_gt_u32 s85, 400000
    s_cbranch_scc1 L_end
    buffer_load_dword v46, v15, s[36:39], s78 offen sc1
    s_waitcnt vmcnt(0)
    v_cmp_eq_u32_e64 vcc, -1, v46
    s_cbranch_vccnz Lspin_39
    v_cvt_pk_bf16_f32 v47, v24, v24
    v_and_b32 v47, 0xffff0000, v47
    v_mul_f32 v47, 0xbfb8aa3b, v47
    v_exp_f32 v47, v47
    s_nop 0
    v_add_f32 v47, 1.0, v47
    v_rcp_f32_e64 v47, v47
    s_nop 0
    v_cvt_pk_bf16_f32 v47, v47, v47
    v_and_b32 v47, 0xffff0000, v47
    v_lshl_add_u32 v13, v8, 10, v10
    s_lshr_b32 s78, s83, 3
    s_mul_i32 s78, s78, 57344
    s_and_b32 s79, s83, 7
    s_lshl_b32 s79, s79, 7
    s_add_u32 s78, s78, s79
    s_add_u32 s78, s78, 1114112
    s_and_b32 s80, s97, 0x7ff
    s_lshl_b32 s80, s80, 11
    s_lshl_b32 s79, s83, 6
    s_add_u32 s80, s80, s79
    s_sleep 26
    s_mov_b32 s85, 0
Lspin_40:
    s_add_u32 s85, s85, 1
    s_cmp_gt_u32 s85, 400000
    s_cbranch_scc1 L_end
    s_add_u32 s79, s78, 0
    buffer_load_dwordx4 v[16:19], v13, s[36:39], s79 offen sc1
    s_add_u32 s79, s78, 8192
    buffer_load_dwordx4 v[20:23], v13, s[36:39], s79 offen sc1
    s_add_u32 s79, s78, 16384
    buffer_load_dwordx4 v[24:27], v13, s[36:39], s79 offen sc1
    s_add_u32 s79, s78, 24576
    buffer_load_dwordx4 v[28:31], v13, s[36:39], s79 offen sc1
    s_add_u32 s79, s78, 32768
    buffer_load_dwordx4 v[32:35], v13, s[36:39], s79 offen sc1
    s_add_u32 s79, s78, 40960
    buffer_load_dwordx4 v[36:39], v13, s[36:39], s79 offen sc1
    s_add_u32 s79, s78, 49152
    buffer_load_dwordx4 v[40:43], v13, s[36:39], s79 offen sc1
    s_waitcnt vmcnt(0)
    v_max_u32 v48, v16, v17
    v_max_u32_e64 v49, v18, v19
    v_max3_u32 v48, v48, v20, v21
    v_max3_u32 v49, v49, v22, v23
    v_max3_u32 v48, v48, v24, v25
    v_max3_u32 v49, v49, v26, v27
    v_max3_u32 v48, v48, v28, v29
    v_max3_u32 v49, v49, v30, v31
    v_max3_u32 v48, v48, v32, v33
    v_max3_u32 v49, v49, v34, v35
    v_max3_u32 v48, v48, v36, v37
    v_max3_u32 v49, v49, v38, v39
    v_max3_u32 v48, v48, v40, v41
    v_max3_u32 v49, v49, v42, v43
    v_max_u32 v48, v48, v49
    v_cmp_eq_u32_e64 vcc, -1, v48
    s_cbranch_vccnz Lspin_40
    v_pk_add_f32 v[16:17], v[16:17], v[20:21]
    v_pk_add_f32 v[24:25], v[24:25], v[28:29]
    v_pk_add_f32 v[32:33], v[32:33], v[36:37]
    v_pk_add_f32 v[16:17], v[16:17], v[24:25]
    v_pk_add_f32 v[32:33], v[32:33], v[40:41]
    v_pk_add_f32 v[16:17], v[16:17], v[32:33]
    v_pk_add_f32 v[18:19], v[18:19], v[22:23]
    v_pk_add_f32 v[26:27], v[26:27], v[30:31]
    v_pk_add_f32 v[34:35], v[34:35], v[38:39]
    v_pk_add_f32 v[18:19], v[18:19], v[26:27]
    v_pk_add_f32 v[34:35], v[34:35], v[42:43]
    v_pk_add_f32 v[18:19], v[18:19], v[34:35]
    s_nop 1
    v_permlane32_swap_b32 v16, v18
    v_permlane32_swap_b32_e64 v17, v19
    v_pk_add_f32 v[16:17], v[16:17], v[18:19]
    s_nop 1
    v_permlane16_swap_b32 v16, v17
    v_add_f32 v16, v16, v17
    s_nop 1
    v_add_f32_dpp v16, v16, v16 row_ror:8 row_mask:0xf bank_mask:0xf
    v_cvt_pk_bf16_f32 v16, v16, v16
    v_and_b32 v16, 0xffff0000, v16
    v_mul_f32_e64 v16, v16, v47
    v_cvt_pk_bf16_f32 v16, v16, v16
    v_and_b32 v16, 0xffff0000, v16
    v_add_f32_e64 v16, v16, v46
    v_cvt_pk_bf16_f32 v16, v16, v16
    s_mov_b32 exec_lo, 0x00ff00ff
    s_mov_b32 exec_hi, 0x00ff00ff
    buffer_store_short v16, v14, s[44:47], s80 offen
    s_mov_b64 exec, -1
    s_cmp_lg_u32 s0, 224
    s_cbranch_scc1 Lep_41
    s_cmp_lg_u32 s76, 0
    s_cbranch_scc1 Lep_41
    v_mov_b32 v196, s75
    v_mov_b32_e64 v197, 0
    s_mov_b64 exec, 1
    buffer_store_dword v196, v197, s[36:39], 0 offen sc1
    s_mov_b64 exec, -1
Lep_41:
    s_branch L_fin
L_padret:
    s_setpc_b64 s[90:91]
    .p2align 3
L_M:
    s_getpc_b64 s[90:91]
L_mpc:
    s_sub_u32 s90, s90, L_mpc-L_sube
    s_subb_u32 s91, s91, 0
    s_lshr_b32 s78, s2, 3
    s_lshl_b32 s78, s78, 10
    s_lshl_b32 s79, s76, 8
    s_add_u32 s78, s78, s79
    s_min_u32 s78, s78, (L_end-L_sube)
    v_lshl_add_u32 v119, v2, 2, s78
    global_load_dword v119, v119, s[90:91]
    s_setprio 1
    s_and_b32 s78, s2, 7
    s_lshr_b32 s79, s2, 3
    s_lshl_b32 s71, s78, 1
    s_and_b32 s72, s79, 1
    s_add_u32 s71, s71, s72
    s_lshr_b32 s72, s79, 1
    s_cmp_gt_u32 s70, 3
    s_cselect_b32 s78, 1, 0
    s_cmp_gt_u32 s70, 11
    s_cselect_b32 s78, 2, s78
    s_sub_u32 s78, s70, s78
    s_cmp_eq_u32 s70, 3
    s_cselect_b32 s78, 14, s78
    s_cmp_eq_u32 s70, 11
    s_cselect_b32 s78, 15, s78
    s_lshl_b32 s0, s78, 4
    s_add_u32 s0, s0, s69
    s_lshr_b32 s73, s0, 2
    s_and_b32 s74, s0, 3
    s_lshl_b32 s77, s70, 4
    s_add_u32 s77, s77, s69
    s_and_b32 s80, s76, 1
    s_lshr_b32 s81, s76, 1
    v_and_b32 v8, 15, v2
    v_lshrrev_b32 v9, 4, v2
    v_lshrrev_b32 v10, 1, v8
    s_lshl_b32 s78, s80, 13
    s_add_u32 s78, s78, 118784
    v_lshlrev_b32 v11, 7, v8
    v_add_u32 v11, s78, v11
    v_add_u32 v12, 0, v9
    v_xor_b32 v12, v12, v10
    v_lshl_add_u32 v4, v12, 4, v11
    v_add_u32 v12, 4, v9
    v_xor_b32 v12, v12, v10
    v_lshl_add_u32 v5, v12, 4, v11
    v_bfe_u32 v10, v2, 2, 2
    v_and_b32_e64 v11, 3, v2
    v_lshl_add_u32 v12, v9, 3, v10
    v_lshlrev_b32_e64 v12, 7, v12
    v_lshl_add_u32 v12, v11, 3, v12
    v_add_u32 v12, 135168, v12
    v_lshrrev_b32 v13, 1, v10
    v_and_b32 v14, 1, v9
    v_lshl_add_u32 v13, v14, 1, v13
    s_lshl_b32 s78, s81, 1
    s_add_u32 s79, s78, 0
    v_xor_b32_e64 v14, s79, v13
    v_lshl_add_u32 v6, v14, 5, v12
    s_add_u32 s79, s78, 1
    v_xor_b32 v14, s79, v13
    v_lshl_add_u32 v7, v14, 5, v12
    v_lshrrev_b32_e64 v13, 5, v2
    v_lshl_add_u32 v13, v13, 3, v10
    v_lshlrev_b32 v13, 6, v13
    v_and_b32 v14, 1, v9
    v_lshl_add_u32 v13, v14, 5, v13
    v_lshl_add_u32 v13, v11, 3, v13
    s_lshl_b32 s78, s81, 11
    s_add_u32 s78, s78, 159744
    v_add_u32 v15, s78, v13
    v_mov_b64 v[128:129], 0
    v_mov_b64 v[130:131], 0
    v_mov_b64 v[132:133], 0
    v_mov_b64 v[134:135], 0
    v_mov_b64 v[136:137], 0
    v_mov_b64 v[138:139], 0
    v_mov_b64 v[140:141], 0
    v_mov_b64 v[142:143], 0
    v_mov_b64 v[144:145], 0
    v_mov_b64 v[146:147], 0
    v_mov_b64 v[148:149], 0
    v_mov_b64 v[150:151], 0
    v_mov_b64 v[152:153], 0
    v_mov_b64 v[154:155], 0
    v_mov_b64 v[156:157], 0
    v_mov_b64 v[158:159], 0
    v_mov_b64 v[160:161], 0
    v_mov_b64 v[162:163], 0
    v_mov_b64 v[164:165], 0
    v_mov_b64 v[166:167], 0
    v_mov_b64 v[168:169], 0
    v_mov_b64 v[170:171], 0
    v_mov_b64 v[172:173], 0
    v_mov_b64 v[174:175], 0
    v_mov_b64 v[176:177], 0
    v_mov_b64 v[178:179], 0
    v_mov_b64 v[180:181], 0
    v_mov_b64 v[182:183], 0
    v_mov_b64 v[184:185], 0
    v_mov_b64 v[186:187], 0
    v_mov_b64 v[188:189], 0
    v_mov_b64 v[190:191], 0
    v_mov_b64 v[192:193], 0
    v_mov_b64 v[194:195], 0
    v_mov_b64 v[196:197], 0
    v_mov_b64 v[198:199], 0
    v_mov_b64 v[200:201], 0
    v_mov_b64 v[202:203], 0
    v_mov_b64 v[204:205], 0
    v_mov_b64 v[206:207], 0
    v_mov_b64 v[208:209], 0
    v_mov_b64 v[210:211], 0
    v_mov_b64 v[212:213], 0
    v_mov_b64 v[214:215], 0
    v_mov_b64 v[216:217], 0
    v_mov_b64 v[218:219], 0
    v_mov_b64 v[220:221], 0
    v_mov_b64 v[222:223], 0
L_pad4:
    s_cbranch_execz L_pad8
    v_mov_b64 v[104:105], 0
    v_mov_b64 v[106:107], 0
    v_mov_b64 v[108:109], 0
    v_mov_b64 v[110:111], 0
    v_and_b32 v14, 31, v2
    v_lshrrev_b32 v13, 5, v2
    s_lshl_b32 s78, s81, 14
    s_lshl_b32 s79, s80, 13
    s_add_u32 s78, s78, s79
    s_add_u32 s78, s78, 110592
    v_lshl_add_u32 v12, v14, 7, s78
    v_and_b32 v14, 7, v14
    v_xor_b32 v14, v14, v13
    v_xor_b32_e64 v13, 0, v14
    v_lshl_add_u32 v112, v13, 4, v12
    v_xor_b32_e64 v13, 2, v14
    v_lshl_add_u32 v113, v13, 4, v12
    v_xor_b32_e64 v13, 4, v14
    v_lshl_add_u32 v114, v13, 4, v12
    v_xor_b32_e64 v13, 6, v14
    v_lshl_add_u32 v115, v13, 4, v12
    s_add_u32 s79, s79, 143360
    v_lshl_add_u32 v12, v8, 7, s79
    s_lshl_b32 s78, s81, 2
    v_add_u32 v14, s78, v9
    v_and_b32 v13, 7, v8
    v_xor_b32 v14, v14, v13
    v_lshl_add_u32 v116, v14, 4, v12
    s_lshl_b32 s78, s80, 6
    v_add_u32 v10, s78, v8
    v_lshlrev_b32_e64 v11, 3, v10
    v_add_u32 v11, 159744, v11
    s_lshl_b32 s79, s81, 5
    v_add_u32 v12, s79, v8
    v_lshlrev_b32_e64 v12, 3, v12
    v_add_u32 v12, 160768, v12
    v_lshlrev_b32_e64 v13, 2, v10
    v_add_u32 v13, 162304, v13
    v_and_b32 v14, 31, v2
    v_add_u32 v14, s78, v14
    v_lshlrev_b32_e64 v14, 2, v14
    v_add_u32 v14, 162304, v14
    s_waitcnt lgkmcnt(0)
    s_load_dword s75, s[26:27], 0
    s_mov_b32 s36, s26
    s_and_b32 s37, s27, 0xffff
    s_mov_b32 s38, 0x10000000
    s_mov_b32 s39, 0x20000
    s_mov_b32 s64, s14
    s_and_b32 s65, s15, 0xffff
    s_mov_b32 s66, 0x800
    s_mov_b32 s67, 0x20000
    s_mov_b32 s44, s22
    s_and_b32 s45, s23, 0xffff
    s_mov_b32 s46, 0x400000
    s_mov_b32 s47, 0x20000
    s_lshl_b32 s78, s72, 7
    buffer_load_dword v118, off, s[64:67], s78
    s_waitcnt lgkmcnt(0)
    s_mul_i32 s75, s75, 0x9E3779B1
    s_add_u32 s75, s75, 0x7F4A7C15
    s_mov_b32 s84, 0
    s_mov_b32 s82, 2
    s_mov_b32 s83, 0xfffec000
    s_barrier
    s_nop 0
    ds_read_b128 v[16:19], v4 offset:0
    ds_read_b64_tr_b16 v[40:41], v6 offset:8192
    ds_read_b64_tr_b16 v[42:43], v6 offset:8704
    ds_read_b128 v[20:23], v4 offset:2048
    ds_read_b128 v[24:27], v4 offset:4096
    ds_read_b128 v[28:31], v4 offset:6144
    ds_read_b64_tr_b16 v[44:45], v7 offset:8192
    ds_read_b64_tr_b16 v[46:47], v7 offset:8704
    ds_read_b64_tr_b16 v[48:49], v6 offset:16384
    ds_read_b64_tr_b16 v[50:51], v6 offset:16896
    ds_read_b64_tr_b16 v[52:53], v7 offset:16384
    ds_read_b64_tr_b16 v[54:55], v7 offset:16896
    ds_read_b64_tr_b16 v[32:33], v6 offset:0
    ds_read_b64_tr_b16 v[34:35], v6 offset:512
    ds_read_b64_tr_b16 v[36:37], v7 offset:0
    ds_read_b64_tr_b16 v[38:39], v7 offset:512
    ds_read_b64_tr_b16 v[96:97], v15 offset:0
    ds_read_b64_tr_b16 v[98:99], v15 offset:1024
    ds_read_b64_tr_b16 v[100:101], v15 offset:256
    ds_read_b64_tr_b16 v[102:103], v15 offset:1280
    s_waitcnt lgkmcnt(0)
    s_nop 0
    v_mfma_f32_16x16x32_bf16 v[160:163], v[40:43], v[16:19], v[160:163]
    v_mfma_f32_16x16x32_bf16 v[176:179], v[44:47], v[16:19], v[176:179]
    v_mfma_f32_16x16x32_bf16 v[180:183], v[44:47], v[20:23], v[180:183]
    v_mfma_f32_16x16x32_bf16 v[164:167], v[40:43], v[20:23], v[164:167]
    v_mfma_f32_16x16x32_bf16 v[168:171], v[40:43], v[24:27], v[168:171]
    v_mfma_f32_16x16x32_bf16 v[184:187], v[44:47], v[24:27], v[184:187]
    v_mfma_f32_16x16x32_bf16 v[188:191], v[44:47], v[28:31], v[188:191]
    v_mfma_f32_16x16x32_bf16 v[172:175], v[40:43], v[28:31], v[172:175]
    v_mfma_f32_16x16x32_bf16 v[204:207], v[48:51], v[28:31], v[204:207]
    v_mfma_f32_16x16x32_bf16 v[220:223], v[52:55], v[28:31], v[220:223]
    v_mfma_f32_16x16x32_bf16 v[216:219], v[52:55], v[24:27], v[216:219]
    v_mfma_f32_16x16x32_bf16 v[200:203], v[48:51], v[24:27], v[200:203]
    v_mfma_f32_16x16x32_bf16 v[196:199], v[48:51], v[20:23], v[196:199]
    v_mfma_f32_16x16x32_bf16 v[212:215], v[52:55], v[20:23], v[212:215]
    v_mfma_f32_16x16x32_bf16 v[208:211], v[52:55], v[16:19], v[208:211]
    v_mfma_f32_16x16x32_bf16 v[192:195], v[48:51], v[16:19], v[192:195]
    v_mfma_f32_16x16x32_bf16 v[128:131], v[32:35], v[16:19], v[128:131]
    v_mfma_f32_16x16x32_bf16 v[144:147], v[36:39], v[16:19], v[144:147]
    v_mfma_f32_16x16x32_bf16 v[148:151], v[36:39], v[20:23], v[148:151]
    v_mfma_f32_16x16x32_bf16 v[132:135], v[32:35], v[20:23], v[132:135]
    v_mfma_f32_16x16x32_bf16 v[136:139], v[32:35], v[24:27], v[136:139]
    v_mfma_f32_16x16x32_bf16 v[152:155], v[36:39], v[24:27], v[152:155]
    v_mfma_f32_16x16x32_bf16 v[156:159], v[36:39], v[28:31], v[156:159]
    v_mfma_f32_16x16x32_bf16 v[140:143], v[32:35], v[28:31], v[140:143]
    ds_read_b128 v[56:59], v5 offset:0
    ds_read_b64_tr_b16 v[80:81], v6 offset:12288
    ds_read_b64_tr_b16 v[82:83], v6 offset:12800
    ds_read_b128 v[60:63], v5 offset:2048
    ds_read_b128 v[64:67], v5 offset:4096
    ds_read_b128 v[68:71], v5 offset:6144
    ds_read_b64_tr_b16 v[84:85], v7 offset:12288
    ds_read_b64_tr_b16 v[86:87], v7 offset:12800
    ds_read_b64_tr_b16 v[88:89], v6 offset:20480
    ds_read_b64_tr_b16 v[90:91], v6 offset:20992
    ds_read_b64_tr_b16 v[92:93], v7 offset:20480
    ds_read_b64_tr_b16 v[94:95], v7 offset:20992
    ds_read_b64_tr_b16 v[72:73], v6 offset:4096
    ds_read_b64_tr_b16 v[74:75], v6 offset:4608
    ds_read_b64_tr_b16 v[76:77], v7 offset:4096
    ds_read_b64_tr_b16 v[78:79], v7 offset:4608
    s_add_u32 s84, s84, 1
    s_cmp_eq_u32 s82, 2
    s_cselect_b32 s78, s83, 40960
    s_cselect_b32 s82, -1, s82
    s_add_u32 s82, s82, 1
    v_add_u32 v4, s78, v4
    v_add_u32 v5, s78, v5
    v_add_u32 v6, s78, v6
    v_add_u32_e64 v7, s78, v7
    s_waitcnt vmcnt(0) lgkmcnt(0)
    v_mfma_f32_16x16x32_bf16 v[160:163], v[80:83], v[56:59], v[160:163]
    v_mfma_f32_16x16x32_bf16 v[176:179], v[84:87], v[56:59], v[176:179]
    v_mfma_f32_16x16x32_bf16 v[180:183], v[84:87], v[60:63], v[180:183]
    v_mfma_f32_16x16x32_bf16 v[164:167], v[80:83], v[60:63], v[164:167]
    v_mfma_f32_16x16x32_bf16 v[168:171], v[80:83], v[64:67], v[168:171]
    v_mfma_f32_16x16x32_bf16 v[184:187], v[84:87], v[64:67], v[184:187]
    v_mfma_f32_16x16x32_bf16 v[188:191], v[84:87], v[68:71], v[188:191]
    v_mfma_f32_16x16x32_bf16 v[172:175], v[80:83], v[68:71], v[172:175]
    v_mfma_f32_16x16x32_bf16 v[204:207], v[88:91], v[68:71], v[204:207]
    v_mfma_f32_16x16x32_bf16 v[220:223], v[92:95], v[68:71], v[220:223]
    v_mfma_f32_16x16x32_bf16 v[216:219], v[92:95], v[64:67], v[216:219]
    v_mfma_f32_16x16x32_bf16 v[200:203], v[88:91], v[64:67], v[200:203]
    v_mfma_f32_16x16x32_bf16 v[196:199], v[88:91], v[60:63], v[196:199]
    v_mfma_f32_16x16x32_bf16 v[212:215], v[92:95], v[60:63], v[212:215]
    v_mfma_f32_16x16x32_bf16 v[208:211], v[92:95], v[56:59], v[208:211]
    v_mfma_f32_16x16x32_bf16 v[192:195], v[88:91], v[56:59], v[192:195]
    v_mfma_f32_16x16x32_bf16 v[128:131], v[72:75], v[56:59], v[128:131]
    v_mfma_f32_16x16x32_bf16 v[144:147], v[76:79], v[56:59], v[144:147]
    v_mfma_f32_16x16x32_bf16 v[148:151], v[76:79], v[60:63], v[148:151]
    v_mfma_f32_16x16x32_bf16 v[132:135], v[72:75], v[60:63], v[132:135]
    v_mfma_f32_16x16x32_bf16 v[136:139], v[72:75], v[64:67], v[136:139]
    v_mfma_f32_16x16x32_bf16 v[152:155], v[76:79], v[64:67], v[152:155]
    v_mfma_f32_16x16x32_bf16 v[156:159], v[76:79], v[68:71], v[156:159]
    v_mfma_f32_16x16x32_bf16 v[140:143], v[72:75], v[68:71], v[140:143]
    s_barrier
    s_nop 0
    ds_read_b128 v[16:19], v4 offset:0
    ds_read_b64_tr_b16 v[40:41], v6 offset:8192
    ds_read_b64_tr_b16 v[42:43], v6 offset:8704
    ds_read_b128 v[20:23], v4 offset:2048
    ds_read_b128 v[24:27], v4 offset:4096
    ds_read_b128 v[28:31], v4 offset:6144
    ds_read_b64_tr_b16 v[44:45], v7 offset:8192
    ds_read_b64_tr_b16 v[46:47], v7 offset:8704
    ds_read_b64_tr_b16 v[48:49], v6 offset:16384
    ds_read_b64_tr_b16 v[50:51], v6 offset:16896
    ds_read_b64_tr_b16 v[52:53], v7 offset:16384
    ds_read_b64_tr_b16 v[54:55], v7 offset:16896
    ds_read_b64_tr_b16 v[32:33], v6 offset:0
    ds_read_b64_tr_b16 v[34:35], v6 offset:512
    ds_read_b64_tr_b16 v[36:37], v7 offset:0
    ds_read_b64_tr_b16 v[38:39], v7 offset:512
    s_waitcnt lgkmcnt(0)
    s_nop 0
    v_mfma_f32_16x16x32_bf16 v[160:163], v[40:43], v[16:19], v[160:163]
    v_mfma_f32_16x16x32_bf16 v[176:179], v[44:47], v[16:19], v[176:179]
    v_mfma_f32_16x16x32_bf16 v[180:183], v[44:47], v[20:23], v[180:183]
    v_mfma_f32_16x16x32_bf16 v[164:167], v[40:43], v[20:23], v[164:167]
    v_mfma_f32_16x16x32_bf16 v[168:171], v[40:43], v[24:27], v[168:171]
    v_mfma_f32_16x16x32_bf16 v[184:187], v[44:47], v[24:27], v[184:187]
    v_mfma_f32_16x16x32_bf16 v[188:191], v[44:47], v[28:31], v[188:191]
    v_mfma_f32_16x16x32_bf16 v[172:175], v[40:43], v[28:31], v[172:175]
    v_mfma_f32_16x16x32_bf16 v[204:207], v[48:51], v[28:31], v[204:207]
    v_mfma_f32_16x16x32_bf16 v[220:223], v[52:55], v[28:31], v[220:223]
    v_mfma_f32_16x16x32_bf16 v[216:219], v[52:55], v[24:27], v[216:219]
    v_mfma_f32_16x16x32_bf16 v[200:203], v[48:51], v[24:27], v[200:203]
    v_mfma_f32_16x16x32_bf16 v[196:199], v[48:51], v[20:23], v[196:199]
    v_mfma_f32_16x16x32_bf16 v[212:215], v[52:55], v[20:23], v[212:215]
    v_mfma_f32_16x16x32_bf16 v[208:211], v[52:55], v[16:19], v[208:211]
    v_mfma_f32_16x16x32_bf16 v[192:195], v[48:51], v[16:19], v[192:195]
    v_mfma_f32_16x16x32_bf16 v[128:131], v[32:35], v[16:19], v[128:131]
    v_mfma_f32_16x16x32_bf16 v[144:147], v[36:39], v[16:19], v[144:147]
    v_mfma_f32_16x16x32_bf16 v[148:151], v[36:39], v[20:23], v[148:151]
    v_mfma_f32_16x16x32_bf16 v[132:135], v[32:35], v[20:23], v[132:135]
    v_mfma_f32_16x16x32_bf16 v[136:139], v[32:35], v[24:27], v[136:139]
    v_mfma_f32_16x16x32_bf16 v[152:155], v[36:39], v[24:27], v[152:155]
    v_mfma_f32_16x16x32_bf16 v[156:159], v[36:39], v[28:31], v[156:159]
    v_mfma_f32_16x16x32_bf16 v[140:143], v[32:35], v[28:31], v[140:143]
    ds_read_b128 v[56:59], v5 offset:0
    ds_read_b64_tr_b16 v[80:81], v6 offset:12288
    ds_read_b64_tr_b16 v[82:83], v6 offset:12800
    ds_read_b128 v[60:63], v5 offset:2048
    ds_read_b128 v[64:67], v5 offset:4096
    ds_read_b128 v[68:71], v5 offset:6144
    ds_read_b64_tr_b16 v[84:85], v7 offset:12288
    ds_read_b64_tr_b16 v[86:87], v7 offset:12800
    ds_read_b64_tr_b16 v[88:89], v6 offset:20480
    ds_read_b64_tr_b16 v[90:91], v6 offset:20992
    ds_read_b64_tr_b16 v[92:93], v7 offset:20480
    ds_read_b64_tr_b16 v[94:95], v7 offset:20992
    ds_read_b64_tr_b16 v[72:73], v6 offset:4096
    ds_read_b64_tr_b16 v[74:75], v6 offset:4608
    ds_read_b64_tr_b16 v[76:77], v7 offset:4096
    ds_read_b64_tr_b16 v[78:79], v7 offset:4608
    s_add_u32 s84, s84, 1
    s_cmp_eq_u32 s82, 2
    s_cselect_b32 s78, s83, 40960
    s_cselect_b32 s82, -1, s82
    s_add_u32 s82, s82, 1
    v_add_u32 v4, s78, v4
    v_add_u32 v5, s78, v5
    v_add_u32 v6, s78, v6
    v_add_u32_e64 v7, s78, v7
    s_waitcnt vmcnt(0) lgkmcnt(0)
    v_mfma_f32_16x16x32_bf16 v[160:163], v[80:83], v[56:59], v[160:163]
    v_mfma_f32_16x16x32_bf16 v[176:179], v[84:87], v[56:59], v[176:179]
    v_mfma_f32_16x16x32_bf16 v[180:183], v[84:87], v[60:63], v[180:183]
    v_mfma_f32_16x16x32_bf16 v[164:167], v[80:83], v[60:63], v[164:167]
    v_mfma_f32_16x16x32_bf16 v[168:171], v[80:83], v[64:67], v[168:171]
    v_mfma_f32_16x16x32_bf16 v[184:187], v[84:87], v[64:67], v[184:187]
    v_mfma_f32_16x16x32_bf16 v[188:191], v[84:87], v[68:71], v[188:191]
    v_mfma_f32_16x16x32_bf16 v[172:175], v[80:83], v[68:71], v[172:175]
    v_mfma_f32_16x16x32_bf16 v[204:207], v[88:91], v[68:71], v[204:207]
    v_mfma_f32_16x16x32_bf16 v[220:223], v[92:95], v[68:71], v[220:223]
    v_mfma_f32_16x16x32_bf16 v[216:219], v[92:95], v[64:67], v[216:219]
    v_mfma_f32_16x16x32_bf16 v[200:203], v[88:91], v[64:67], v[200:203]
    v_mfma_f32_16x16x32_bf16 v[196:199], v[88:91], v[60:63], v[196:199]
    v_mfma_f32_16x16x32_bf16 v[212:215], v[92:95], v[60:63], v[212:215]
    v_mfma_f32_16x16x32_bf16 v[208:211], v[92:95], v[56:59], v[208:211]
    v_mfma_f32_16x16x32_bf16 v[192:195], v[88:91], v[56:59], v[192:195]
    v_mfma_f32_16x16x32_bf16 v[128:131], v[72:75], v[56:59], v[128:131]
    v_mfma_f32_16x16x32_bf16 v[144:147], v[76:79], v[56:59], v[144:147]
    v_mfma_f32_16x16x32_bf16 v[148:151], v[76:79], v[60:63], v[148:151]
    v_mfma_f32_16x16x32_bf16 v[132:135], v[72:75], v[60:63], v[132:135]
    v_mfma_f32_16x16x32_bf16 v[136:139], v[72:75], v[64:67], v[136:139]
    v_mfma_f32_16x16x32_bf16 v[152:155], v[76:79], v[64:67], v[152:155]
    v_mfma_f32_16x16x32_bf16 v[156:159], v[76:79], v[68:71], v[156:159]
    v_mfma_f32_16x16x32_bf16 v[140:143], v[72:75], v[68:71], v[140:143]
    s_mov_b64 exec, 0
    s_cmp_lg_u32 s76, 0
    s_cbranch_scc1 Lt_42
    s_call_b64 s[90:91], L_pad0
Lt_42:
    s_cmp_lg_u32 s76, 1
    s_cbranch_scc1 Lt_43
    s_call_b64 s[90:91], L_pad1
Lt_43:
    s_cmp_lg_u32 s76, 2
    s_cbranch_scc1 Lt_44
    s_call_b64 s[90:91], L_pad2
Lt_44:
    s_cmp_lg_u32 s76, 3
    s_cbranch_scc1 Lt_45
    s_call_b64 s[90:91], L_pad3
Lt_45:
    s_mov_b64 exec, -1
    s_barrier
    s_nop 0
    ds_read_b128 v[16:19], v4 offset:0
    ds_read_b64_tr_b16 v[40:41], v6 offset:8192
    ds_read_b64_tr_b16 v[42:43], v6 offset:8704
    ds_read_b128 v[20:23], v4 offset:2048
    ds_read_b128 v[24:27], v4 offset:4096
    ds_read_b128 v[28:31], v4 offset:6144
    ds_read_b64_tr_b16 v[44:45], v7 offset:8192
    ds_read_b64_tr_b16 v[46:47], v7 offset:8704
    ds_read_b64_tr_b16 v[48:49], v6 offset:16384
    ds_read_b64_tr_b16 v[50:51], v6 offset:16896
    ds_read_b64_tr_b16 v[52:53], v7 offset:16384
    ds_read_b64_tr_b16 v[54:55], v7 offset:16896
    ds_read_b64_tr_b16 v[32:33], v6 offset:0
    ds_read_b64_tr_b16 v[34:35], v6 offset:512
    ds_read_b64_tr_b16 v[36:37], v7 offset:0
    ds_read_b64_tr_b16 v[38:39], v7 offset:512
    s_waitcnt lgkmcnt(0)
    s_nop 0
    v_mfma_f32_16x16x32_bf16 v[160:163], v[40:43], v[16:19], v[160:163]
L_pad5:
    s_cbranch_execz L_pad9
    s_nop 0
    v_mfma_f32_16x16x32_bf16 v[176:179], v[44:47], v[16:19], v[176:179]
    v_mfma_f32_16x16x32_bf16 v[180:183], v[44:47], v[20:23], v[180:183]
    v_mfma_f32_16x16x32_bf16 v[164:167], v[40:43], v[20:23], v[164:167]
    v_mfma_f32_16x16x32_bf16 v[168:171], v[40:43], v[24:27], v[168:171]
    v_mfma_f32_16x16x32_bf16 v[184:187], v[44:47], v[24:27], v[184:187]
    v_mfma_f32_16x16x32_bf16 v[188:191], v[44:47], v[28:31], v[188:191]
    v_mfma_f32_16x16x32_bf16 v[172:175], v[40:43], v[28:31], v[172:175]
    v_mfma_f32_16x16x32_bf16 v[204:207], v[48:51], v[28:31], v[204:207]
    v_mfma_f32_16x16x32_bf16 v[220:223], v[52:55], v[28:31], v[220:223]
    v_mfma_f32_16x16x32_bf16 v[216:219], v[52:55], v[24:27], v[216:219]
    v_mfma_f32_16x16x32_bf16 v[200:203], v[48:51], v[24:27], v[200:203]
    v_mfma_f32_16x16x32_bf16 v[196:199], v[48:51], v[20:23], v[196:199]
    v_mfma_f32_16x16x32_bf16 v[212:215], v[52:55], v[20:23], v[212:215]
    v_mfma_f32_16x16x32_bf16 v[208:211], v[52:55], v[16:19], v[208:211]
    v_mfma_f32_16x16x32_bf16 v[192:195], v[48:51], v[16:19], v[192:195]
    v_mfma_f32_16x16x32_bf16 v[128:131], v[32:35], v[16:19], v[128:131]
    v_mfma_f32_16x16x32_bf16 v[144:147], v[36:39], v[16:19], v[144:147]
    v_mfma_f32_16x16x32_bf16 v[148:151], v[36:39], v[20:23], v[148:151]
    v_mfma_f32_16x16x32_bf16 v[132:135], v[32:35], v[20:23], v[132:135]
    v_mfma_f32_16x16x32_bf16 v[136:139], v[32:35], v[24:27], v[136:139]
    v_mfma_f32_16x16x32_bf16 v[152:155], v[36:39], v[24:27], v[152:155]
    v_mfma_f32_16x16x32_bf16 v[156:159], v[36:39], v[28:31], v[156:159]
    v_mfma_f32_16x16x32_bf16 v[140:143], v[32:35], v[28:31], v[140:143]
    ds_read_b128 v[56:59], v5 offset:0
    ds_read_b64_tr_b16 v[80:81], v6 offset:12288
    ds_read_b64_tr_b16 v[82:83], v6 offset:12800
    ds_read_b128 v[60:63], v5 offset:2048
    ds_read_b128 v[64:67], v5 offset:4096
    ds_read_b128 v[68:71], v5 offset:6144
    ds_read_b64_tr_b16 v[84:85], v7 offset:12288
    ds_read_b64_tr_b16 v[86:87], v7 offset:12800
    ds_read_b64_tr_b16 v[88:89], v6 offset:20480
    ds_read_b64_tr_b16 v[90:91], v6 offset:20992
    ds_read_b64_tr_b16 v[92:93], v7 offset:20480
    ds_read_b64_tr_b16 v[94:95], v7 offset:20992
    ds_read_b64_tr_b16 v[72:73], v6 offset:4096
    ds_read_b64_tr_b16 v[74:75], v6 offset:4608
    ds_read_b64_tr_b16 v[76:77], v7 offset:4096
    ds_read_b64_tr_b16 v[78:79], v7 offset:4608
    s_add_u32 s84, s84, 1
    s_cmp_eq_u32 s82, 2
    s_cselect_b32 s78, s83, 40960
    s_cselect_b32 s82, -1, s82
    s_add_u32 s82, s82, 1
    v_add_u32 v4, s78, v4
    v_add_u32 v5, s78, v5
    v_add_u32 v6, s78, v6
    v_add_u32_e64 v7, s78, v7
    s_waitcnt vmcnt(0) lgkmcnt(0)
    v_mfma_f32_16x16x32_bf16 v[160:163], v[80:83], v[56:59], v[160:163]
    v_mfma_f32_16x16x32_bf16 v[176:179], v[84:87], v[56:59], v[176:179]
    v_mfma_f32_16x16x32_bf16 v[180:183], v[84:87], v[60:63], v[180:183]
    v_mfma_f32_16x16x32_bf16 v[164:167], v[80:83], v[60:63], v[164:167]
    v_mfma_f32_16x16x32_bf16 v[168:171], v[80:83], v[64:67], v[168:171]
    v_mfma_f32_16x16x32_bf16 v[184:187], v[84:87], v[64:67], v[184:187]
    v_mfma_f32_16x16x32_bf16 v[188:191], v[84:87], v[68:71], v[188:191]
    v_mfma_f32_16x16x32_bf16 v[172:175], v[80:83], v[68:71], v[172:175]
    v_mfma_f32_16x16x32_bf16 v[204:207], v[88:91], v[68:71], v[204:207]
    v_mfma_f32_16x16x32_bf16 v[220:223], v[92:95], v[68:71], v[220:223]
    v_mfma_f32_16x16x32_bf16 v[216:219], v[92:95], v[64:67], v[216:219]
    v_mfma_f32_16x16x32_bf16 v[200:203], v[88:91], v[64:67], v[200:203]
    v_mfma_f32_16x16x32_bf16 v[196:199], v[88:91], v[60:63], v[196:199]
    v_mfma_f32_16x16x32_bf16 v[212:215], v[92:95], v[60:63], v[212:215]
    v_mfma_f32_16x16x32_bf16 v[208:211], v[92:95], v[56:59], v[208:211]
    v_mfma_f32_16x16x32_bf16 v[192:195], v[88:91], v[56:59], v[192:195]
    v_mfma_f32_16x16x32_bf16 v[128:131], v[72:75], v[56:59], v[128:131]
    v_mfma_f32_16x16x32_bf16 v[144:147], v[76:79], v[56:59], v[144:147]
    v_mfma_f32_16x16x32_bf16 v[148:151], v[76:79], v[60:63], v[148:151]
    v_mfma_f32_16x16x32_bf16 v[132:135], v[72:75], v[60:63], v[132:135]
    v_mfma_f32_16x16x32_bf16 v[136:139], v[72:75], v[64:67], v[136:139]
    v_mfma_f32_16x16x32_bf16 v[152:155], v[76:79], v[64:67], v[152:155]
    v_mfma_f32_16x16x32_bf16 v[156:159], v[76:79], v[68:71], v[156:159]
    v_mfma_f32_16x16x32_bf16 v[140:143], v[72:75], v[68:71], v[140:143]
    s_barrier
    s_nop 0
    ds_read_b128 v[16:19], v4 offset:0
    ds_read_b64_tr_b16 v[40:41], v6 offset:8192
    ds_read_b64_tr_b16 v[42:43], v6 offset:8704
    ds_read_b128 v[20:23], v4 offset:2048
    ds_read_b128 v[24:27], v4 offset:4096
    ds_read_b128 v[28:31], v4 offset:6144
    ds_read_b64_tr_b16 v[44:45], v7 offset:8192
    ds_read_b64_tr_b16 v[46:47], v7 offset:8704
    ds_read_b64_tr_b16 v[48:49], v6 offset:16384
    ds_read_b64_tr_b16 v[50:51], v6 offset:16896
    ds_read_b64_tr_b16 v[52:53], v7 offset:16384
    ds_read_b64_tr_b16 v[54:55], v7 offset:16896
    ds_read_b64_tr_b16 v[32:33], v6 offset:0
    ds_read_b64_tr_b16 v[34:35], v6 offset:512
    ds_read_b64_tr_b16 v[36:37], v7 offset:0
    ds_read_b64_tr_b16 v[38:39], v7 offset:512
    .p2align 3
L_Mloop:
    s_waitcnt lgkmcnt(0)
    s_nop 0
    v_mfma_f32_16x16x32_bf16 v[160:163], v[40:43], v[16:19], v[160:163]
    ds_read_b128 v[56:59], v5 offset:0
    v_mfma_f32_16x16x32_bf16 v[176:179], v[44:47], v[16:19], v[176:179]
    ds_read_b64_tr_b16 v[80:81], v6 offset:12288
    v_mfma_f32_16x16x32_bf16 v[180:183], v[44:47], v[20:23], v[180:183]
    ds_read_b64_tr_b16 v[82:83], v6 offset:12800
    v_mfma_f32_16x16x32_bf16 v[164:167], v[40:43], v[20:23], v[164:167]
    ds_read_b128 v[60:63], v5 offset:2048
    v_mfma_f32_16x16x32_bf16 v[168:171], v[40:43], v[24:27], v[168:171]
    ds_read_b128 v[64:67], v5 offset:4096
    v_mfma_f32_16x16x32_bf16 v[184:187], v[44:47], v[24:27], v[184:187]
    ds_read_b128 v[68:71], v5 offset:6144
    v_mfma_f32_16x16x32_bf16 v[188:191], v[44:47], v[28:31], v[188:191]
    ds_read_b64_tr_b16 v[84:85], v7 offset:12288
    v_mfma_f32_16x16x32_bf16 v[172:175], v[40:43], v[28:31], v[172:175]
    ds_read_b64_tr_b16 v[86:87], v7 offset:12800
    v_mfma_f32_16x16x32_bf16 v[204:207], v[48:51], v[28:31], v[204:207]
    ds_read_b64_tr_b16 v[88:89], v6 offset:20480
    v_mfma_f32_16x16x32_bf16 v[220:223], v[52:55], v[28:31], v[220:223]
    ds_read_b64_tr_b16 v[90:91], v6 offset:20992
    v_mfma_f32_16x16x32_bf16 v[216:219], v[52:55], v[24:27], v[216:219]
    ds_read_b64_tr_b16 v[92:93], v7 offset:20480
    v_mfma_f32_16x16x32_bf16 v[200:203], v[48:51], v[24:27], v[200:203]
    ds_read_b64_tr_b16 v[94:95], v7 offset:20992
    v_mfma_f32_16x16x32_bf16 v[196:199], v[48:51], v[20:23], v[196:199]
    ds_read_b64_tr_b16 v[72:73], v6 offset:4096
    v_mfma_f32_16x16x32_bf16 v[212:215], v[52:55], v[20:23], v[212:215]
    ds_read_b64_tr_b16 v[74:75], v6 offset:4608
    v_mfma_f32_16x16x32_bf16 v[208:211], v[52:55], v[16:19], v[208:211]
    ds_read_b64_tr_b16 v[76:77], v7 offset:4096
    v_mfma_f32_16x16x32_bf16 v[192:195], v[48:51], v[16:19], v[192:195]
    ds_read_b64_tr_b16 v[78:79], v7 offset:4608
    v_mfma_f32_16x16x32_bf16 v[128:131], v[32:35], v[16:19], v[128:131]
    s_add_u32 s84, s84, 1
    s_cmp_eq_u32 s82, 2
    s_cselect_b32 s78, s83, 40960
    s_cselect_b32 s82, -1, s82
    s_add_u32 s82, s82, 1
    v_mfma_f32_16x16x32_bf16 v[144:147], v[36:39], v[16:19], v[144:147]
    v_add_u32 v4, s78, v4
    v_add_u32 v5, s78, v5
    v_mfma_f32_16x16x32_bf16 v[148:151], v[36:39], v[20:23], v[148:151]
    v_add_u32 v6, s78, v6
    v_add_u32 v7, s78, v7
    v_mfma_f32_16x16x32_bf16 v[132:135], v[32:35], v[20:23], v[132:135]
    v_mfma_f32_16x16x32_bf16 v[136:139], v[32:35], v[24:27], v[136:139]
    v_mfma_f32_16x16x32_bf16 v[152:155], v[36:39], v[24:27], v[152:155]
    v_mfma_f32_16x16x32_bf16 v[156:159], v[36:39], v[28:31], v[156:159]
    v_mfma_f32_16x16x32_bf16 v[140:143], v[32:35], v[28:31], v[140:143]
    s_waitcnt vmcnt(0) lgkmcnt(0)
    v_mfma_f32_16x16x32_bf16 v[160:163], v[80:83], v[56:59], v[160:163]
    v_mfma_f32_16x16x32_bf16 v[176:179], v[84:87], v[56:59], v[176:179]
    s_barrier
    s_cmp_eq_u32 s84, 16
    s_cbranch_scc1 L_Mtail
    v_mfma_f32_16x16x32_bf16 v[180:183], v[84:87], v[60:63], v[180:183]
    ds_read_b128 v[16:19], v4 offset:0
    v_mfma_f32_16x16x32_bf16 v[164:167], v[80:83], v[60:63], v[164:167]
    ds_read_b64_tr_b16 v[40:41], v6 offset:8192
    v_mfma_f32_16x16x32_bf16 v[168:171], v[80:83], v[64:67], v[168:171]
    ds_read_b64_tr_b16 v[42:43], v6 offset:8704
    v_mfma_f32_16x16x32_bf16 v[184:187], v[84:87], v[64:67], v[184:187]
    ds_read_b128 v[20:23], v4 offset:2048
    v_mfma_f32_16x16x32_bf16 v[188:191], v[84:87], v[68:71], v[188:191]
    ds_read_b128 v[24:27], v4 offset:4096
    v_mfma_f32_16x16x32_bf16 v[172:175], v[80:83], v[68:71], v[172:175]
    ds_read_b128 v[28:31], v4 offset:6144
    v_mfma_f32_16x16x32_bf16 v[204:207], v[88:91], v[68:71], v[204:207]
    ds_read_b64_tr_b16 v[44:45], v7 offset:8192
    v_mfma_f32_16x16x32_bf16 v[220:223], v[92:95], v[68:71], v[220:223]
    ds_read_b64_tr_b16 v[46:47], v7 offset:8704
    v_mfma_f32_16x16x32_bf16 v[216:219], v[92:95], v[64:67], v[216:219]
    ds_read_b64_tr_b16 v[48:49], v6 offset:16384
    v_mfma_f32_16x16x32_bf16 v[200:203], v[88:91], v[64:67], v[200:203]
    ds_read_b64_tr_b16 v[50:51], v6 offset:16896
    v_mfma_f32_16x16x32_bf16 v[196:199], v[88:91], v[60:63], v[196:199]
    ds_read_b64_tr_b16 v[52:53], v7 offset:16384
    v_mfma_f32_16x16x32_bf16 v[212:215], v[92:95], v[60:63], v[212:215]
    ds_read_b64_tr_b16 v[54:55], v7 offset:16896
    v_mfma_f32_16x16x32_bf16 v[208:211], v[92:95], v[56:59], v[208:211]
    ds_read_b64_tr_b16 v[32:33], v6 offset:0
    v_mfma_f32_16x16x32_bf16 v[192:195], v[88:91], v[56:59], v[192:195]
    ds_read_b64_tr_b16 v[34:35], v6 offset:512
    v_mfma_f32_16x16x32_bf16 v[128:131], v[72:75], v[56:59], v[128:131]
    ds_read_b64_tr_b16 v[36:37], v7 offset:0
    v_mfma_f32_16x16x32_bf16 v[144:147], v[76:79], v[56:59], v[144:147]
    ds_read_b64_tr_b16 v[38:39], v7 offset:512
    v_mfma_f32_16x16x32_bf16 v[148:151], v[76:79], v[60:63], v[148:151]
    v_mfma_f32_16x16x32_bf16 v[132:135], v[72:75], v[60:63], v[132:135]
    v_mfma_f32_16x16x32_bf16 v[136:139], v[72:75], v[64:67], v[136:139]
    v_mfma_f32_16x16x32_bf16 v[152:155], v[76:79], v[64:67], v[152:155]
    v_mfma_f32_16x16x32_bf16 v[156:159], v[76:79], v[68:71], v[156:159]
    v_mfma_f32_16x16x32_bf16 v[140:143], v[72:75], v[68:71], v[140:143]
    s_branch L_Mloop
    .p2align 3
L_Mtail:
    s_mov_b64 exec, 0xffff
    ds_read_b64 v[104:105], v11 offset:0
    ds_read_b64 v[106:107], v11 offset:128
    ds_read_b64 v[108:109], v11 offset:256
    ds_read_b64 v[110:111], v11 offset:384
    s_mov_b64 exec, -1
    s_nop 0
    v_mfma_f32_16x16x32_bf16 v[180:183], v[84:87], v[60:63], v[180:183]
    ds_read_b64 v[20:21], v12 offset:512
    v_mfma_f32_16x16x32_bf16 v[164:167], v[80:83], v[60:63], v[164:167]
    ds_read_b64 v[22:23], v12 offset:640
    v_mfma_f32_16x16x32_bf16 v[168:171], v[80:83], v[64:67], v[168:171]
    ds_read_b64 v[24:25], v12 offset:1024
    v_mfma_f32_16x16x32_bf16 v[184:187], v[84:87], v[64:67], v[184:187]
    ds_read_b64 v[26:27], v12 offset:1152
    v_mfma_f32_16x16x32_bf16 v[188:191], v[84:87], v[68:71], v[188:191]
    ds_read_b64 v[16:17], v12 offset:0
    v_mfma_f32_16x16x32_bf16 v[172:175], v[80:83], v[68:71], v[172:175]
    ds_read_b64 v[18:19], v12 offset:128
    v_mfma_f32_16x16x32_bf16 v[204:207], v[88:91], v[68:71], v[204:207]
    ds_read2_b32 v[32:33], v14 offset0:0 offset1:32
    v_mfma_f32_16x16x32_bf16 v[220:223], v[92:95], v[68:71], v[220:223]
    ds_read_b32 v28, v13 offset:0
    v_mfma_f32_16x16x32_bf16 v[216:219], v[92:95], v[64:67], v[216:219]
    ds_read_b32 v30, v13 offset:64
    v_mfma_f32_16x16x32_bf16 v[200:203], v[88:91], v[64:67], v[200:203]
    ds_read_b32 v44, v13 offset:128
    v_mfma_f32_16x16x32_bf16 v[196:199], v[88:91], v[60:63], v[196:199]
    ds_read_b32 v46, v13 offset:192
    v_mfma_f32_16x16x32_bf16 v[212:215], v[92:95], v[60:63], v[212:215]
    v_mfma_f32_16x16x32_bf16 v[208:211], v[92:95], v[56:59], v[208:211]
    v_mfma_f32_16x16x32_bf16 v[192:195], v[88:91], v[56:59], v[192:195]
    s_waitcnt lgkmcnt(0)
    s_nop 0
    v_mfma_f32_16x16x16_bf16 v[160:163], v[20:21], v[104:105], v[160:163]
    v_mfma_f32_16x16x16_bf16 v[176:179], v[22:23], v[104:105], v[176:179]
    v_mfma_f32_16x16x16_bf16 v[164:167], v[20:21], v[106:107], v[164:167]
    v_mfma_f32_16x16x16_bf16 v[180:183], v[22:23], v[106:107], v[180:183]
    v_mfma_f32_16x16x16_bf16 v[168:171], v[20:21], v[108:109], v[168:171]
    v_mfma_f32_16x16x16_bf16 v[184:187], v[22:23], v[108:109], v[184:187]
    v_mfma_f32_16x16x16_bf16 v[172:175], v[20:21], v[110:111], v[172:175]
    v_mfma_f32_16x16x16_bf16 v[188:191], v[22:23], v[110:111], v[188:191]
    v_mul_f32 v34, 0x3fb8aa3b, v32
    v_mul_f32 v48, 0x3fb8aa3b, v33
    v_mfma_f32_16x16x16_bf16 v[192:195], v[24:25], v[104:105], v[192:195]
    v_mfma_f32_16x16x16_bf16 v[208:211], v[26:27], v[104:105], v[208:211]
    v_mfma_f32_16x16x16_bf16 v[196:199], v[24:25], v[106:107], v[196:199]
    v_cvt_pk_bf16_f32 v160, v160, v161
    v_cvt_pk_bf16_f32 v161, v162, v163
    v_cvt_pk_bf16_f32 v162, v176, v177
    v_cvt_pk_bf16_f32 v163, v178, v179
    v_mfma_f32_16x16x16_bf16 v[212:215], v[26:27], v[106:107], v[212:215]
    v_cvt_pk_bf16_f32 v164, v164, v165
    v_cvt_pk_bf16_f32 v165, v166, v167
    v_cvt_pk_bf16_f32 v166, v180, v181
    v_cvt_pk_bf16_f32 v167, v182, v183
    v_mfma_f32_16x16x16_bf16 v[200:203], v[24:25], v[108:109], v[200:203]
    v_cvt_pk_bf16_f32 v168, v168, v169
    v_cvt_pk_bf16_f32 v169, v170, v171
    v_cvt_pk_bf16_f32 v170, v184, v185
    v_cvt_pk_bf16_f32 v171, v186, v187
    v_mfma_f32_16x16x16_bf16 v[216:219], v[26:27], v[108:109], v[216:219]
    v_cvt_pk_bf16_f32 v172, v172, v173
    v_cvt_pk_bf16_f32 v173, v174, v175
    v_cvt_pk_bf16_f32 v174, v188, v189
    v_cvt_pk_bf16_f32 v175, v190, v191
    v_mfma_f32_16x16x16_bf16 v[204:207], v[24:25], v[110:111], v[204:207]
    v_permlane16_swap_b32 v160, v164
    v_permlane16_swap_b32 v161, v165
    v_permlane16_swap_b32 v162, v166
    v_permlane16_swap_b32 v163, v167
    v_mfma_f32_16x16x16_bf16 v[220:223], v[26:27], v[110:111], v[220:223]
    v_permlane16_swap_b32 v168, v172
    v_permlane16_swap_b32 v169, v173
    v_permlane16_swap_b32 v170, v174
    v_permlane16_swap_b32 v171, v175
    v_mfma_f32_32x32x16_bf16 v[224:239], v[96:99], v[160:163], 0
    v_mfma_f32_32x32x16_bf16 v[224:239], v[100:103], v[164:167], v[224:239]
    v_mfma_f32_32x32x16_bf16 v[240:255], v[96:99], v[168:171], 0
    v_mfma_f32_32x32x16_bf16 v[240:255], v[100:103], v[172:175], v[240:255]
    v_pk_mul_f32 v[192:193], v[192:193], v[28:29] op_sel_hi:[1,0]
    v_pk_mul_f32 v[194:195], v[194:195], v[28:29] op_sel_hi:[1,0]
    v_pk_mul_f32 v[208:209], v[208:209], v[28:29] op_sel_hi:[1,0]
    v_pk_mul_f32 v[210:211], v[210:211], v[28:29] op_sel_hi:[1,0]
    v_cvt_pk_bf16_f32 v192, v192, v193
    v_cvt_pk_bf16_f32 v193, v194, v195
L_pad6:
    s_cbranch_execz L_pad10
    s_nop 0
    v_cvt_pk_bf16_f32 v194, v208, v209
    v_cvt_pk_bf16_f32 v195, v210, v211
    v_pk_mul_f32 v[196:197], v[196:197], v[30:31] op_sel_hi:[1,0]
    v_pk_mul_f32 v[198:199], v[198:199], v[30:31] op_sel_hi:[1,0]
    v_pk_mul_f32 v[212:213], v[212:213], v[30:31] op_sel_hi:[1,0]
    v_pk_mul_f32 v[214:215], v[214:215], v[30:31] op_sel_hi:[1,0]
    v_cvt_pk_bf16_f32 v196, v196, v197
    v_cvt_pk_bf16_f32 v197, v198, v199
    v_cvt_pk_bf16_f32 v198, v212, v213
    v_cvt_pk_bf16_f32 v199, v214, v215
    v_pk_mul_f32 v[200:201], v[200:201], v[44:45] op_sel_hi:[1,0]
    v_pk_mul_f32 v[202:203], v[202:203], v[44:45] op_sel_hi:[1,0]
    v_pk_mul_f32 v[216:217], v[216:217], v[44:45] op_sel_hi:[1,0]
    v_pk_mul_f32 v[218:219], v[218:219], v[44:45] op_sel_hi:[1,0]
    v_cvt_pk_bf16_f32 v200, v200, v201
    v_cvt_pk_bf16_f32 v201, v202, v203
    v_cvt_pk_bf16_f32 v202, v216, v217
    v_cvt_pk_bf16_f32 v203, v218, v219
    v_pk_mul_f32 v[204:205], v[204:205], v[46:47] op_sel_hi:[1,0]
    v_pk_mul_f32 v[206:207], v[206:207], v[46:47] op_sel_hi:[1,0]
    v_pk_mul_f32 v[220:221], v[220:221], v[46:47] op_sel_hi:[1,0]
    v_pk_mul_f32 v[222:223], v[222:223], v[46:47] op_sel_hi:[1,0]
    v_cvt_pk_bf16_f32 v204, v204, v205
    v_cvt_pk_bf16_f32 v205, v206, v207
    v_cvt_pk_bf16_f32 v206, v220, v221
    v_cvt_pk_bf16_f32 v207, v222, v223
    v_mfma_f32_16x16x32_bf16 v[128:131], v[72:75], v[56:59], v[128:131]
    v_max3_f32 v36, v224, v225, v226
    v_max3_f32 v38, -v224, -v225, -v226
    v_max3_f32 v36, v36, v227, v228
    v_max3_f32 v38, v38, -v227, -v228
    v_mfma_f32_16x16x32_bf16 v[144:147], v[76:79], v[56:59], v[144:147]
    v_max3_f32 v36, v36, v229, v230
    v_max3_f32 v38, v38, -v229, -v230
    v_max3_f32 v36, v36, v231, v232
    v_max3_f32 v38, v38, -v231, -v232
    v_mfma_f32_16x16x32_bf16 v[148:151], v[76:79], v[60:63], v[148:151]
    v_max3_f32 v36, v36, v233, v234
    v_max3_f32 v38, v38, -v233, -v234
    v_max3_f32 v36, v36, v235, v236
    v_max3_f32 v38, v38, -v235, -v236
    v_mfma_f32_16x16x32_bf16 v[132:135], v[72:75], v[60:63], v[132:135]
    v_max3_f32 v36, v36, v237, v238
    v_max3_f32 v38, v38, -v237, -v238
    v_max_f32_e64 v36, v36, v239
    v_max_f32 v38, v38, -v239
    v_mfma_f32_16x16x32_bf16 v[136:139], v[72:75], v[64:67], v[136:139]
    v_max3_f32 v37, v240, v241, v242
    v_max3_f32 v39, -v240, -v241, -v242
    v_max3_f32 v37, v37, v243, v244
    v_max3_f32 v39, v39, -v243, -v244
    v_mfma_f32_16x16x32_bf16 v[152:155], v[76:79], v[64:67], v[152:155]
    v_max3_f32 v37, v37, v245, v246
    v_max3_f32 v39, v39, -v245, -v246
    v_max3_f32 v37, v37, v247, v248
    v_max3_f32 v39, v39, -v247, -v248
    v_mfma_f32_16x16x32_bf16 v[156:159], v[76:79], v[68:71], v[156:159]
    v_max3_f32 v37, v37, v249, v250
    v_max3_f32 v39, v39, -v249, -v250
    v_max3_f32 v37, v37, v251, v252
    v_max3_f32 v39, v39, -v251, -v252
    v_mfma_f32_16x16x32_bf16 v[140:143], v[72:75], v[68:71], v[140:143]
    v_max3_f32 v37, v37, v253, v254
    v_max3_f32 v39, v39, -v253, -v254
    v_max_f32_e64 v37, v37, v255
    v_max_f32 v39, v39, -v255
    v_permlane32_swap_b32 v36, v38
    s_nop 0
    v_permlane32_swap_b32 v37, v39
    v_max_f32 v36, v36, v38
    v_max_f32_e64 v37, v37, v39
    v_mul_f32 v36, -v36, v34
    v_mul_f32 v37, -v37, v48
    v_mov_b32 v38, v36
    v_mov_b32 v39, v37
    s_nop 0
    v_permlane32_swap_b32 v36, v38
    v_permlane32_swap_b32_e64 v37, v39
    v_pk_fma_f32 v[60:61], v[224:225], v[34:35], v[36:37] op_sel_hi:[1,0,0]
    v_pk_fma_f32 v[62:63], v[226:227], v[34:35], v[36:37] op_sel_hi:[1,0,0]
    v_pk_fma_f32 v[64:65], v[228:229], v[34:35], v[36:37] op_sel_hi:[1,0,0]
    v_pk_fma_f32 v[66:67], v[230:231], v[34:35], v[36:37] op_sel_hi:[1,0,0]
    v_pk_fma_f32 v[68:69], v[232:233], v[34:35], v[36:37] op_sel_hi:[1,0,0]
    v_pk_fma_f32 v[70:71], v[234:235], v[34:35], v[36:37] op_sel_hi:[1,0,0]
    v_pk_fma_f32 v[72:73], v[236:237], v[34:35], v[36:37] op_sel_hi:[1,0,0]
    v_pk_fma_f32 v[74:75], v[238:239], v[34:35], v[36:37] op_sel_hi:[1,0,0]
    v_pk_fma_f32 v[76:77], v[224:225], v[34:35], v[38:39] op_sel_hi:[1,0,0] neg_lo:[1,0,0] neg_hi:[1,0,0]
    v_pk_fma_f32 v[78:79], v[226:227], v[34:35], v[38:39] op_sel_hi:[1,0,0] neg_lo:[1,0,0] neg_hi:[1,0,0]
    v_pk_fma_f32 v[80:81], v[228:229], v[34:35], v[38:39] op_sel_hi:[1,0,0] neg_lo:[1,0,0] neg_hi:[1,0,0]
    v_pk_fma_f32 v[82:83], v[230:231], v[34:35], v[38:39] op_sel_hi:[1,0,0] neg_lo:[1,0,0] neg_hi:[1,0,0]
    v_pk_fma_f32 v[84:85], v[232:233], v[34:35], v[38:39] op_sel_hi:[1,0,0] neg_lo:[1,0,0] neg_hi:[1,0,0]
    v_pk_fma_f32 v[86:87], v[234:235], v[34:35], v[38:39] op_sel_hi:[1,0,0] neg_lo:[1,0,0] neg_hi:[1,0,0]
    v_pk_fma_f32 v[88:89], v[236:237], v[34:35], v[38:39] op_sel_hi:[1,0,0] neg_lo:[1,0,0] neg_hi:[1,0,0]
    v_pk_fma_f32 v[90:91], v[238:239], v[34:35], v[38:39] op_sel_hi:[1,0,0] neg_lo:[1,0,0] neg_hi:[1,0,0]
    v_exp_f32 v60, v60
    v_exp_f32 v61, v61
    v_exp_f32 v62, v62
    v_exp_f32 v63, v63
    v_exp_f32 v64, v64
    v_exp_f32 v65, v65
    v_exp_f32 v66, v66
    v_exp_f32 v67, v67
    v_exp_f32 v68, v68
    v_exp_f32 v69, v69
    v_exp_f32 v70, v70
    v_exp_f32 v71, v71
    v_exp_f32 v72, v72
    v_exp_f32 v73, v73
    v_exp_f32 v74, v74
    v_exp_f32 v75, v75
    v_exp_f32 v76, v76
    v_exp_f32 v77, v77
    v_exp_f32 v78, v78
    v_exp_f32 v79, v79
    v_exp_f32 v80, v80
    v_exp_f32 v81, v81
    v_exp_f32 v82, v82
    v_exp_f32 v83, v83
    v_exp_f32 v84, v84
    v_exp_f32 v85, v85
    v_exp_f32 v86, v86
    v_exp_f32 v87, v87
    v_exp_f32 v88, v88
    v_exp_f32 v89, v89
    v_exp_f32 v90, v90
    v_exp_f32 v91, v91
    v_pk_add_f32 v[40:41], v[60:61], v[62:63]
    v_pk_add_f32 v[42:43], v[76:77], v[78:79]
    v_pk_add_f32 v[40:41], v[40:41], v[64:65]
    v_pk_add_f32 v[42:43], v[42:43], v[80:81]
    v_pk_add_f32 v[40:41], v[40:41], v[66:67]
    v_pk_add_f32 v[42:43], v[42:43], v[82:83]
    v_pk_add_f32 v[40:41], v[40:41], v[68:69]
    v_pk_add_f32 v[42:43], v[42:43], v[84:85]
    v_pk_add_f32 v[40:41], v[40:41], v[70:71]
    v_pk_add_f32 v[42:43], v[42:43], v[86:87]
    v_pk_add_f32 v[40:41], v[40:41], v[72:73]
    v_pk_add_f32 v[42:43], v[42:43], v[88:89]
    v_pk_add_f32 v[40:41], v[40:41], v[74:75]
    v_pk_add_f32 v[42:43], v[42:43], v[90:91]
    v_add_f32 v40, v40, v41
    v_add_f32 v42, v42, v43
    s_nop 1
    v_permlane32_swap_b32 v40, v42
    v_add_f32 v40, v40, v42
    v_rcp_f32 v40, v40
    s_nop 0
    v_mov_b32 v42, v40
    s_nop 1
    v_permlane32_swap_b32 v40, v42
    v_pk_mul_f32 v[60:61], v[60:61], v[40:41] op_sel_hi:[1,0]
    v_pk_mul_f32 v[62:63], v[62:63], v[40:41] op_sel_hi:[1,0]
    v_pk_mul_f32 v[64:65], v[64:65], v[40:41] op_sel_hi:[1,0]
    v_pk_mul_f32 v[66:67], v[66:67], v[40:41] op_sel_hi:[1,0]
    v_cvt_pk_bf16_f32 v160, v60, v61
    v_cvt_pk_bf16_f32 v161, v62, v63
    v_cvt_pk_bf16_f32 v162, v64, v65
    v_cvt_pk_bf16_f32 v163, v66, v67
    v_pk_mul_f32 v[68:69], v[68:69], v[40:41] op_sel_hi:[1,0]
    v_pk_mul_f32 v[70:71], v[70:71], v[40:41] op_sel_hi:[1,0]
    v_pk_mul_f32 v[72:73], v[72:73], v[40:41] op_sel_hi:[1,0]
    v_pk_mul_f32 v[74:75], v[74:75], v[40:41] op_sel_hi:[1,0]
    v_cvt_pk_bf16_f32 v166, v68, v69
    v_cvt_pk_bf16_f32 v167, v70, v71
    v_cvt_pk_bf16_f32 v164, v72, v73
    v_cvt_pk_bf16_f32 v165, v74, v75
    v_pk_mul_f32 v[76:77], v[76:77], v[42:43] op_sel_hi:[1,0]
    v_pk_mul_f32 v[78:79], v[78:79], v[42:43] op_sel_hi:[1,0]
    v_pk_mul_f32 v[80:81], v[80:81], v[42:43] op_sel_hi:[1,0]
    v_pk_mul_f32 v[82:83], v[82:83], v[42:43] op_sel_hi:[1,0]
    v_cvt_pk_bf16_f32 v168, v76, v77
    v_cvt_pk_bf16_f32 v169, v78, v79
    v_cvt_pk_bf16_f32 v170, v80, v81
    v_cvt_pk_bf16_f32 v171, v82, v83
    v_pk_mul_f32 v[84:85], v[84:85], v[42:43] op_sel_hi:[1,0]
    v_pk_mul_f32 v[86:87], v[86:87], v[42:43] op_sel_hi:[1,0]
    v_pk_mul_f32 v[88:89], v[88:89], v[42:43] op_sel_hi:[1,0]
    v_pk_mul_f32 v[90:91], v[90:91], v[42:43] op_sel_hi:[1,0]
    v_cvt_pk_bf16_f32 v174, v84, v85
    v_cvt_pk_bf16_f32 v175, v86, v87
    v_cvt_pk_bf16_f32 v172, v88, v89
    v_cvt_pk_bf16_f32 v173, v90, v91
    v_pk_fma_f32 v[60:61], v[240:241], v[48:49], v[36:37] op_sel:[0,0,1] op_sel_hi:[1,0,1]
    v_pk_fma_f32 v[62:63], v[242:243], v[48:49], v[36:37] op_sel:[0,0,1] op_sel_hi:[1,0,1]
    v_pk_fma_f32 v[64:65], v[244:245], v[48:49], v[36:37] op_sel:[0,0,1] op_sel_hi:[1,0,1]
    v_pk_fma_f32 v[66:67], v[246:247], v[48:49], v[36:37] op_sel:[0,0,1] op_sel_hi:[1,0,1]
    v_pk_fma_f32 v[68:69], v[248:249], v[48:49], v[36:37] op_sel:[0,0,1] op_sel_hi:[1,0,1]
    v_pk_fma_f32 v[70:71], v[250:251], v[48:49], v[36:37] op_sel:[0,0,1] op_sel_hi:[1,0,1]
    v_pk_fma_f32 v[72:73], v[252:253], v[48:49], v[36:37] op_sel:[0,0,1] op_sel_hi:[1,0,1]
    v_pk_fma_f32 v[74:75], v[254:255], v[48:49], v[36:37] op_sel:[0,0,1] op_sel_hi:[1,0,1]
    v_pk_fma_f32 v[76:77], v[240:241], v[48:49], v[38:39] op_sel:[0,0,1] op_sel_hi:[1,0,1] neg_lo:[1,0,0] neg_hi:[1,0,0]
    v_pk_fma_f32 v[78:79], v[242:243], v[48:49], v[38:39] op_sel:[0,0,1] op_sel_hi:[1,0,1] neg_lo:[1,0,0] neg_hi:[1,0,0]
    v_pk_fma_f32 v[80:81], v[244:245], v[48:49], v[38:39] op_sel:[0,0,1] op_sel_hi:[1,0,1] neg_lo:[1,0,0] neg_hi:[1,0,0]
    v_pk_fma_f32 v[82:83], v[246:247], v[48:49], v[38:39] op_sel:[0,0,1] op_sel_hi:[1,0,1] neg_lo:[1,0,0] neg_hi:[1,0,0]
    v_pk_fma_f32 v[84:85], v[248:249], v[48:49], v[38:39] op_sel:[0,0,1] op_sel_hi:[1,0,1] neg_lo:[1,0,0] neg_hi:[1,0,0]
    v_pk_fma_f32 v[86:87], v[250:251], v[48:49], v[38:39] op_sel:[0,0,1] op_sel_hi:[1,0,1] neg_lo:[1,0,0] neg_hi:[1,0,0]
    v_pk_fma_f32 v[88:89], v[252:253], v[48:49], v[38:39] op_sel:[0,0,1] op_sel_hi:[1,0,1] neg_lo:[1,0,0] neg_hi:[1,0,0]
    v_pk_fma_f32 v[90:91], v[254:255], v[48:49], v[38:39] op_sel:[0,0,1] op_sel_hi:[1,0,1] neg_lo:[1,0,0] neg_hi:[1,0,0]
    v_exp_f32 v60, v60
    v_exp_f32 v61, v61
    v_exp_f32 v62, v62
    v_exp_f32 v63, v63
    ds_write_b128 v116, v[192:195] offset:0
    v_exp_f32 v64, v64
    v_exp_f32 v65, v65
    v_exp_f32 v66, v66
    v_exp_f32 v67, v67
    ds_write_b128 v116, v[196:199] offset:2048
    v_exp_f32 v68, v68
    v_exp_f32 v69, v69
    v_exp_f32 v70, v70
    v_exp_f32 v71, v71
    ds_write_b128 v116, v[200:203] offset:4096
    v_exp_f32 v72, v72
    v_exp_f32 v73, v73
    v_exp_f32 v74, v74
    v_exp_f32 v75, v75
    ds_write_b128 v116, v[204:207] offset:6144
    v_exp_f32 v76, v76
    v_exp_f32 v77, v77
    v_exp_f32 v78, v78
    v_exp_f32 v79, v79
    ds_write_b128 v112, v[160:163] offset:0
    v_exp_f32 v80, v80
    v_exp_f32 v81, v81
    v_exp_f32 v82, v82
    v_exp_f32 v83, v83
    ds_write_b128 v113, v[164:167] offset:0
    v_exp_f32 v84, v84
    v_exp_f32 v85, v85
    v_exp_f32 v86, v86
    v_exp_f32 v87, v87
    ds_write_b128 v114, v[168:171] offset:0
    v_exp_f32 v88, v88
    v_exp_f32 v89, v89
    v_exp_f32 v90, v90
    v_exp_f32 v91, v91
    ds_write_b128 v115, v[172:175] offset:0
    v_pk_add_f32 v[40:41], v[60:61], v[62:63]
    v_pk_add_f32 v[42:43], v[76:77], v[78:79]
    v_pk_add_f32 v[40:41], v[40:41], v[64:65]
    v_pk_add_f32 v[42:43], v[42:43], v[80:81]
    v_pk_add_f32 v[40:41], v[40:41], v[66:67]
    v_pk_add_f32 v[42:43], v[42:43], v[82:83]
    v_pk_add_f32 v[40:41], v[40:41], v[68:69]
    v_pk_add_f32 v[42:43], v[42:43], v[84:85]
    v_pk_add_f32 v[40:41], v[40:41], v[70:71]
    v_pk_add_f32 v[42:43], v[42:43], v[86:87]
    v_pk_add_f32 v[40:41], v[40:41], v[72:73]
    v_pk_add_f32 v[42:43], v[42:43], v[88:89]
    v_pk_add_f32 v[40:41], v[40:41], v[74:75]
    v_pk_add_f32 v[42:43], v[42:43], v[90:91]
    v_add_f32 v40, v40, v41
    v_add_f32 v42, v42, v43
    s_nop 1
    v_permlane32_swap_b32 v40, v42
    v_add_f32 v40, v40, v42
    v_rcp_f32 v40, v40
    s_nop 0
    v_mov_b32 v42, v40
    s_nop 1
    v_permlane32_swap_b32 v40, v42
    v_pk_mul_f32 v[60:61], v[60:61], v[40:41] op_sel_hi:[1,0]
    v_pk_mul_f32 v[62:63], v[62:63], v[40:41] op_sel_hi:[1,0]
    v_pk_mul_f32 v[64:65], v[64:65], v[40:41] op_sel_hi:[1,0]
    v_pk_mul_f32 v[66:67], v[66:67], v[40:41] op_sel_hi:[1,0]
    v_cvt_pk_bf16_f32 v176, v60, v61
    v_cvt_pk_bf16_f32 v177, v62, v63
    v_cvt_pk_bf16_f32 v178, v64, v65
    v_cvt_pk_bf16_f32 v179, v66, v67
    ds_write_b128 v112, v[176:179] offset:4096
    v_pk_mul_f32 v[68:69], v[68:69], v[40:41] op_sel_hi:[1,0]
    v_pk_mul_f32 v[70:71], v[70:71], v[40:41] op_sel_hi:[1,0]
    v_pk_mul_f32 v[72:73], v[72:73], v[40:41] op_sel_hi:[1,0]
    v_pk_mul_f32 v[74:75], v[74:75], v[40:41] op_sel_hi:[1,0]
    v_cvt_pk_bf16_f32 v182, v68, v69
    v_cvt_pk_bf16_f32 v183, v70, v71
    v_cvt_pk_bf16_f32 v180, v72, v73
    v_cvt_pk_bf16_f32 v181, v74, v75
    ds_write_b128 v113, v[180:183] offset:4096
    v_pk_mul_f32 v[76:77], v[76:77], v[42:43] op_sel_hi:[1,0]
    v_pk_mul_f32 v[78:79], v[78:79], v[42:43] op_sel_hi:[1,0]
    v_pk_mul_f32 v[80:81], v[80:81], v[42:43] op_sel_hi:[1,0]
    v_pk_mul_f32 v[82:83], v[82:83], v[42:43] op_sel_hi:[1,0]
    v_cvt_pk_bf16_f32 v184, v76, v77
    v_cvt_pk_bf16_f32 v185, v78, v79
    v_cvt_pk_bf16_f32 v186, v80, v81
    v_cvt_pk_bf16_f32 v187, v82, v83
    ds_write_b128 v114, v[184:187] offset:4096
    v_pk_mul_f32 v[84:85], v[84:85], v[42:43] op_sel_hi:[1,0]
    v_pk_mul_f32 v[86:87], v[86:87], v[42:43] op_sel_hi:[1,0]
    v_pk_mul_f32 v[88:89], v[88:89], v[42:43] op_sel_hi:[1,0]
    v_pk_mul_f32 v[90:91], v[90:91], v[42:43] op_sel_hi:[1,0]
    v_cvt_pk_bf16_f32 v190, v84, v85
    v_cvt_pk_bf16_f32 v191, v86, v87
    v_cvt_pk_bf16_f32 v188, v88, v89
    v_cvt_pk_bf16_f32 v189, v90, v91
    ds_write_b128 v115, v[188:191] offset:4096
    s_waitcnt lgkmcnt(0)
    s_barrier
    s_setprio 0
    s_nop 0
    v_mfma_f32_16x16x16_bf16 v[128:131], v[16:17], v[104:105], v[128:131]
L_pad7:
    s_cbranch_execz L_padret
    s_nop 0
    v_mfma_f32_16x16x16_bf16 v[144:147], v[18:19], v[104:105], v[144:147]
    v_mfma_f32_16x16x16_bf16 v[132:135], v[16:17], v[106:107], v[132:135]
    v_mfma_f32_16x16x16_bf16 v[148:151], v[18:19], v[106:107], v[148:151]
    v_mfma_f32_16x16x16_bf16 v[136:139], v[16:17], v[108:109], v[136:139]
    v_mfma_f32_16x16x16_bf16 v[152:155], v[18:19], v[108:109], v[152:155]
    v_mfma_f32_16x16x16_bf16 v[140:143], v[16:17], v[110:111], v[140:143]
    v_mfma_f32_16x16x16_bf16 v[156:159], v[18:19], v[110:111], v[156:159]
    v_lshrrev_b32 v11, 5, v2
    s_lshl_b32 s78, s81, 7
    s_add_u32 s78, s78, 162944
    v_lshl_add_u32 v10, v11, 4, s78
    v_and_b32 v13, 1, v2
    v_cmp_eq_u32 vcc, 1, v13
    v_mov_b32 v13, 162816
    v_and_b32 v12, 31, v2
    v_cndmask_b32 v10, v10, v13, vcc
    v_lshlrev_b32_e64 v12, 4, v12
    v_lshl_add_u32 v11, v11, 10, v12
    v_lshlrev_b32_e64 v14, 4, v2
    v_cvt_pk_bf16_f32 v128, v128, v129
    v_cvt_pk_bf16_f32 v129, v130, v131
    v_cvt_pk_bf16_f32 v130, v144, v145
    v_cvt_pk_bf16_f32 v131, v146, v147
    v_cvt_pk_bf16_f32 v132, v132, v133
    v_cvt_pk_bf16_f32 v133, v134, v135
    v_cvt_pk_bf16_f32 v134, v148, v149
    v_cvt_pk_bf16_f32 v135, v150, v151
    v_cvt_pk_bf16_f32 v136, v136, v137
    v_cvt_pk_bf16_f32 v137, v138, v139
    v_cvt_pk_bf16_f32 v138, v152, v153
    v_cvt_pk_bf16_f32 v139, v154, v155
    v_cvt_pk_bf16_f32 v140, v140, v141
    v_cvt_pk_bf16_f32 v141, v142, v143
    v_cvt_pk_bf16_f32 v142, v156, v157
    v_cvt_pk_bf16_f32 v143, v158, v159
    v_permlane16_swap_b32 v128, v132
    v_permlane16_swap_b32 v129, v133
    v_permlane16_swap_b32 v130, v134
    v_permlane16_swap_b32 v131, v135
    v_permlane16_swap_b32 v136, v140
    v_permlane16_swap_b32 v137, v141
    v_permlane16_swap_b32 v138, v142
    v_permlane16_swap_b32 v139, v143
    v_mfma_f32_32x32x16_bf16 v[224:239], v[96:99], v[128:131], 0
    v_mfma_f32_32x32x16_bf16 v[224:239], v[100:103], v[132:135], v[224:239]
    v_mfma_f32_32x32x16_bf16 v[240:255], v[96:99], v[136:139], 0
    v_mfma_f32_32x32x16_bf16 v[240:255], v[100:103], v[140:143], v[240:255]
    s_lshl_b32 s94, s70, 14
    s_lshl_b32 s79, s81, 13
    s_add_u32 s94, s94, s79
    s_add_u32 s94, s94, 8388608
    s_add_u32 s95, s94, 4096
    s_lshl_b32 s78, s69, 1
    s_add_u32 s78, s78, s80
    s_lshl_b32 s78, s78, 6
    s_lshl_b32 s79, s70, 1
    s_add_u32 s78, s78, s79
    s_add_u32 s78, s78, s81
    s_lshl_b32 s78, s78, 11
    s_add_u32 s96, s78, 4194304
    s_add_u32 s97, s96, 65536
    v_max3_f32 v36, v224, v225, v226
    v_max3_f32 v38, -v224, -v225, -v226
    v_max3_f32 v36, v36, v227, v228
    v_max3_f32 v38, v38, -v227, -v228
    v_max3_f32 v36, v36, v229, v230
    v_max3_f32 v38, v38, -v229, -v230
    v_max3_f32 v36, v36, v231, v232
    v_max3_f32 v38, v38, -v231, -v232
    v_max3_f32 v36, v36, v233, v234
    v_max3_f32 v38, v38, -v233, -v234
    v_max3_f32 v36, v36, v235, v236
    v_max3_f32 v38, v38, -v235, -v236
    v_max3_f32 v36, v36, v237, v238
    v_max3_f32 v38, v38, -v237, -v238
    v_max_f32_e64 v36, v36, v239
    v_max_f32 v38, v38, -v239
    v_max3_f32 v37, v240, v241, v242
    v_max3_f32 v39, -v240, -v241, -v242
    v_max3_f32 v37, v37, v243, v244
    v_max3_f32 v39, v39, -v243, -v244
    v_max3_f32 v37, v37, v245, v246
    v_max3_f32 v39, v39, -v245, -v246
    v_max3_f32 v37, v37, v247, v248
    v_max3_f32 v39, v39, -v247, -v248
    v_max3_f32 v37, v37, v249, v250
    v_max3_f32 v39, v39, -v249, -v250
    v_max3_f32 v37, v37, v251, v252
    v_max3_f32 v39, v39, -v251, -v252
    v_max3_f32 v37, v37, v253, v254
    v_max3_f32 v39, v39, -v253, -v254
    v_max_f32_e64 v37, v37, v255
    v_max_f32 v39, v39, -v255
    v_permlane32_swap_b32 v36, v38
    s_nop 0
    v_permlane32_swap_b32 v37, v39
    v_max_f32 v36, v36, v38
    v_max_f32_e64 v37, v37, v39
    v_mul_f32 v36, -v36, v34
    v_mul_f32 v37, -v37, v48
    v_mov_b32 v38, v36
    v_mov_b32 v39, v37
    s_nop 0
    v_permlane32_swap_b32 v36, v38
    v_permlane32_swap_b32_e64 v37, v39
    v_pk_fma_f32 v[60:61], v[224:225], v[34:35], v[36:37] op_sel_hi:[1,0,0]
    v_pk_fma_f32 v[62:63], v[226:227], v[34:35], v[36:37] op_sel_hi:[1,0,0]
    v_pk_fma_f32 v[64:65], v[228:229], v[34:35], v[36:37] op_sel_hi:[1,0,0]
    v_pk_fma_f32 v[66:67], v[230:231], v[34:35], v[36:37] op_sel_hi:[1,0,0]
    v_pk_fma_f32 v[68:69], v[232:233], v[34:35], v[36:37] op_sel_hi:[1,0,0]
    v_pk_fma_f32 v[70:71], v[234:235], v[34:35], v[36:37] op_sel_hi:[1,0,0]
    v_pk_fma_f32 v[72:73], v[236:237], v[34:35], v[36:37] op_sel_hi:[1,0,0]
    v_pk_fma_f32 v[74:75], v[238:239], v[34:35], v[36:37] op_sel_hi:[1,0,0]
    v_pk_fma_f32 v[76:77], v[224:225], v[34:35], v[38:39] op_sel_hi:[1,0,0] neg_lo:[1,0,0] neg_hi:[1,0,0]
    v_pk_fma_f32 v[78:79], v[226:227], v[34:35], v[38:39] op_sel_hi:[1,0,0] neg_lo:[1,0,0] neg_hi:[1,0,0]
    v_pk_fma_f32 v[80:81], v[228:229], v[34:35], v[38:39] op_sel_hi:[1,0,0] neg_lo:[1,0,0] neg_hi:[1,0,0]
    v_pk_fma_f32 v[82:83], v[230:231], v[34:35], v[38:39] op_sel_hi:[1,0,0] neg_lo:[1,0,0] neg_hi:[1,0,0]
    v_pk_fma_f32 v[84:85], v[232:233], v[34:35], v[38:39] op_sel_hi:[1,0,0] neg_lo:[1,0,0] neg_hi:[1,0,0]
    v_pk_fma_f32 v[86:87], v[234:235], v[34:35], v[38:39] op_sel_hi:[1,0,0] neg_lo:[1,0,0] neg_hi:[1,0,0]
    v_pk_fma_f32 v[88:89], v[236:237], v[34:35], v[38:39] op_sel_hi:[1,0,0] neg_lo:[1,0,0] neg_hi:[1,0,0]
    v_pk_fma_f32 v[90:91], v[238:239], v[34:35], v[38:39] op_sel_hi:[1,0,0] neg_lo:[1,0,0] neg_hi:[1,0,0]
    v_exp_f32 v60, v60
    v_exp_f32 v61, v61
    v_exp_f32 v62, v62
    v_exp_f32 v63, v63
    v_exp_f32 v64, v64
    v_exp_f32 v65, v65
    v_exp_f32 v66, v66
    v_exp_f32 v67, v67
    v_exp_f32 v68, v68
    v_exp_f32 v69, v69
    v_exp_f32 v70, v70
    v_exp_f32 v71, v71
    v_exp_f32 v72, v72
    v_exp_f32 v73, v73
    v_exp_f32 v74, v74
    v_exp_f32 v75, v75
    v_exp_f32 v76, v76
    v_exp_f32 v77, v77
    v_exp_f32 v78, v78
    v_exp_f32 v79, v79
    v_exp_f32 v80, v80
    v_exp_f32 v81, v81
    v_exp_f32 v82, v82
    v_exp_f32 v83, v83
    v_exp_f32 v84, v84
    v_exp_f32 v85, v85
    v_exp_f32 v86, v86
    v_exp_f32 v87, v87
    v_exp_f32 v88, v88
    v_exp_f32 v89, v89
    v_exp_f32 v90, v90
    v_exp_f32 v91, v91
    v_cvt_pk_bf16_f32 v160, v60, v61
    v_cvt_pk_bf16_f32 v161, v62, v63
    v_cvt_pk_bf16_f32 v162, v64, v65
    v_cvt_pk_bf16_f32 v163, v66, v67
    v_cvt_pk_bf16_f32 v164, v68, v69
    v_cvt_pk_bf16_f32 v165, v70, v71
    v_cvt_pk_bf16_f32 v166, v72, v73
    v_cvt_pk_bf16_f32 v167, v74, v75
    v_cvt_pk_bf16_f32 v168, v76, v77
    v_cvt_pk_bf16_f32 v169, v78, v79
    v_cvt_pk_bf16_f32 v170, v80, v81
    v_cvt_pk_bf16_f32 v171, v82, v83
    v_cvt_pk_bf16_f32 v172, v84, v85
    v_cvt_pk_bf16_f32 v173, v86, v87
    v_cvt_pk_bf16_f32 v174, v88, v89
    v_cvt_pk_bf16_f32 v175, v90, v91
    v_pk_fma_f32 v[60:61], v[240:241], v[48:49], v[36:37] op_sel:[0,0,1] op_sel_hi:[1,0,1]
    v_pk_fma_f32 v[62:63], v[242:243], v[48:49], v[36:37] op_sel:[0,0,1] op_sel_hi:[1,0,1]
    v_pk_fma_f32 v[64:65], v[244:245], v[48:49], v[36:37] op_sel:[0,0,1] op_sel_hi:[1,0,1]
    v_pk_fma_f32 v[66:67], v[246:247], v[48:49], v[36:37] op_sel:[0,0,1] op_sel_hi:[1,0,1]
    v_pk_fma_f32 v[68:69], v[248:249], v[48:49], v[36:37] op_sel:[0,0,1] op_sel_hi:[1,0,1]
    v_pk_fma_f32 v[70:71], v[250:251], v[48:49], v[36:37] op_sel:[0,0,1] op_sel_hi:[1,0,1]
    v_pk_fma_f32 v[72:73], v[252:253], v[48:49], v[36:37] op_sel:[0,0,1] op_sel_hi:[1,0,1]
    v_pk_fma_f32 v[74:75], v[254:255], v[48:49], v[36:37] op_sel:[0,0,1] op_sel_hi:[1,0,1]
    v_pk_fma_f32 v[76:77], v[240:241], v[48:49], v[38:39] op_sel:[0,0,1] op_sel_hi:[1,0,1] neg_lo:[1,0,0] neg_hi:[1,0,0]
    v_pk_fma_f32 v[78:79], v[242:243], v[48:49], v[38:39] op_sel:[0,0,1] op_sel_hi:[1,0,1] neg_lo:[1,0,0] neg_hi:[1,0,0]
    v_pk_fma_f32 v[80:81], v[244:245], v[48:49], v[38:39] op_sel:[0,0,1] op_sel_hi:[1,0,1] neg_lo:[1,0,0] neg_hi:[1,0,0]
    v_pk_fma_f32 v[82:83], v[246:247], v[48:49], v[38:39] op_sel:[0,0,1] op_sel_hi:[1,0,1] neg_lo:[1,0,0] neg_hi:[1,0,0]
    v_pk_fma_f32 v[84:85], v[248:249], v[48:49], v[38:39] op_sel:[0,0,1] op_sel_hi:[1,0,1] neg_lo:[1,0,0] neg_hi:[1,0,0]
    v_pk_fma_f32 v[86:87], v[250:251], v[48:49], v[38:39] op_sel:[0,0,1] op_sel_hi:[1,0,1] neg_lo:[1,0,0] neg_hi:[1,0,0]
    v_pk_fma_f32 v[88:89], v[252:253], v[48:49], v[38:39] op_sel:[0,0,1] op_sel_hi:[1,0,1] neg_lo:[1,0,0] neg_hi:[1,0,0]
    v_pk_fma_f32 v[90:91], v[254:255], v[48:49], v[38:39] op_sel:[0,0,1] op_sel_hi:[1,0,1] neg_lo:[1,0,0] neg_hi:[1,0,0]
    v_exp_f32 v60, v60
    v_exp_f32 v61, v61
    v_exp_f32 v62, v62
    v_exp_f32 v63, v63
    v_exp_f32 v64, v64
    v_exp_f32 v65, v65
    v_exp_f32 v66, v66
    v_exp_f32 v67, v67
    v_exp_f32 v68, v68
    v_exp_f32 v69, v69
    v_exp_f32 v70, v70
    v_exp_f32 v71, v71
    v_exp_f32 v72, v72
    v_exp_f32 v73, v73
    v_exp_f32 v74, v74
    v_exp_f32 v75, v75
    v_exp_f32 v76, v76
    v_exp_f32 v77, v77
    v_exp_f32 v78, v78
    v_exp_f32 v79, v79
    v_exp_f32 v80, v80
    v_exp_f32 v81, v81
    v_exp_f32 v82, v82
    v_exp_f32 v83, v83
    v_exp_f32 v84, v84
    v_exp_f32 v85, v85
    v_exp_f32 v86, v86
    v_exp_f32 v87, v87
    v_exp_f32 v88, v88
    v_exp_f32 v89, v89
    v_exp_f32 v90, v90
    v_exp_f32 v91, v91
    v_cvt_pk_bf16_f32 v176, v60, v61
    v_cvt_pk_bf16_f32 v177, v62, v63
    v_cvt_pk_bf16_f32 v178, v64, v65
    v_cvt_pk_bf16_f32 v179, v66, v67
    v_cvt_pk_bf16_f32 v180, v68, v69
    v_cvt_pk_bf16_f32 v181, v70, v71
    v_cvt_pk_bf16_f32 v182, v72, v73
    v_cvt_pk_bf16_f32 v183, v74, v75
    v_cvt_pk_bf16_f32 v184, v76, v77
    v_cvt_pk_bf16_f32 v185, v78, v79
    v_cvt_pk_bf16_f32 v186, v80, v81
    v_cvt_pk_bf16_f32 v187, v82, v83
    v_cvt_pk_bf16_f32 v188, v84, v85
    v_cvt_pk_bf16_f32 v189, v86, v87
    v_cvt_pk_bf16_f32 v190, v88, v89
    v_cvt_pk_bf16_f32 v191, v90, v91
    s_barrier
    s_setprio 1
    ds_read_b128 v[16:19], v10 offset:0
    ds_read_b128 v[20:23], v10 offset:32
    ds_read_b128 v[24:27], v10 offset:64
    ds_read_b128 v[28:31], v10 offset:96
    s_waitcnt lgkmcnt(3)
    v_mfma_f32_32x32x16_bf16 v[224:239], v[16:19], v[160:163], 0
    s_waitcnt lgkmcnt(2)
    v_mfma_f32_32x32x16_bf16 v[224:239], v[20:23], v[164:167], v[224:239]
    buffer_load_dwordx4 v[96:99], v11, s[36:39], s94 offen offset:0 sc1
    buffer_load_dwordx4 v[100:103], v11, s[36:39], s94 offen offset:2048 sc1
    buffer_load_dwordx4 v[104:107], v11, s[36:39], s95 offen offset:0 sc1
    buffer_load_dwordx4 v[108:111], v11, s[36:39], s95 offen offset:2048 sc1
    s_waitcnt lgkmcnt(1)
    v_mfma_f32_32x32x16_bf16 v[240:255], v[24:27], v[168:171], 0
    s_waitcnt lgkmcnt(0)
    v_mfma_f32_32x32x16_bf16 v[240:255], v[28:31], v[172:175], v[240:255]
    v_mfma_f32_32x32x16_bf16 v[192:207], v[16:19], v[176:179], 0
    v_mfma_f32_32x32x16_bf16 v[192:207], v[20:23], v[180:183], v[192:207]
    v_mfma_f32_32x32x16_bf16 v[208:223], v[24:27], v[184:187], 0
    v_mfma_f32_32x32x16_bf16 v[208:223], v[28:31], v[188:191], v[208:223]
    s_mov_b32 s85, 0
    s_branch L_kvchk
L_kvspin:
    s_add_u32 s85, s85, 1
    s_cmp_gt_u32 s85, 400000
    s_cbranch_scc1 L_end
    buffer_load_dwordx4 v[96:99], v11, s[36:39], s94 offen offset:0 sc1
    buffer_load_dwordx4 v[100:103], v11, s[36:39], s94 offen offset:2048 sc1
    buffer_load_dwordx4 v[104:107], v11, s[36:39], s95 offen offset:0 sc1
    buffer_load_dwordx4 v[108:111], v11, s[36:39], s95 offen offset:2048 sc1
L_kvchk:
    s_waitcnt vmcnt(0)
    s_nop 0
    v_mfma_f32_32x32x16_bf16 v[60:75], v[96:99], v[160:163], 0
    v_max3_u32 v13, v96, v97, v98
    v_max3_u32 v10, v99, v100, v101
    v_max3_u32 v13, v13, v102, v103
    v_max3_u32 v10, v10, v104, v105
    v_max3_u32 v13, v13, v106, v107
    v_mfma_f32_32x32x16_bf16 v[60:75], v[100:103], v[164:167], v[60:75]
    v_max3_u32 v10, v10, v108, v109
    v_max3_u32 v13, v13, v110, v111
    v_max_u32 v13, v13, v10
    v_cmp_eq_u32_e64 vcc, -1, v13
    s_cbranch_vccnz L_kvspin
    v_mfma_f32_32x32x16_bf16 v[76:91], v[104:107], v[168:171], 0
    v_rcp_f32 v36, v225
    v_rcp_f32 v40, v193
    v_rcp_f32 v38, v241
    v_rcp_f32 v42, v209
    v_mfma_f32_32x32x16_bf16 v[76:91], v[108:111], v[172:175], v[76:91]
    v_mov_b32 v44, 0x358637bd
    v_mov_b32 v45, 0x358637bd
    v_fmac_f32 v44, v224, v36
    v_fmac_f32 v45, v192, v40
    v_fmac_f32 v44, v240, v38
    v_fmac_f32 v45, v208, v42
    v_mfma_f32_32x32x16_bf16 v[128:143], v[96:99], v[176:179], 0
    v_rcp_f32 v44, v44
    v_rcp_f32 v45, v45
    v_mul_f32 v36, v36, v44
    v_mul_f32 v40, v40, v45
    v_mfma_f32_32x32x16_bf16 v[128:143], v[100:103], v[180:183], v[128:143]
    v_mul_f32 v38, v38, v44
    v_mul_f32 v42, v42, v45
    v_mul_f32 v60, v60, v36
    v_mul_f32 v61, v61, v36
    v_mul_f32 v62, v62, v36
    v_mul_f32 v63, v63, v36
    v_mfma_f32_32x32x16_bf16 v[144:159], v[104:107], v[184:187], 0
    v_mul_f32 v64, v64, v36
    v_mul_f32 v65, v65, v36
    v_mul_f32 v66, v66, v36
    v_mul_f32 v67, v67, v36
    v_mul_f32 v68, v68, v36
    v_mul_f32 v69, v69, v36
    v_mfma_f32_32x32x16_bf16 v[144:159], v[108:111], v[188:191], v[144:159]
    v_mul_f32 v70, v70, v36
    v_mul_f32 v71, v71, v36
    v_mul_f32 v72, v72, v36
    v_mul_f32 v73, v73, v36
    v_mul_f32 v74, v74, v36
    v_mul_f32 v75, v75, v36
    v_pk_fma_f32 v[60:61], v[76:77], v[38:39], v[60:61] op_sel_hi:[1,0,1]
    v_pk_fma_f32 v[62:63], v[78:79], v[38:39], v[62:63] op_sel_hi:[1,0,1]
    v_pk_fma_f32 v[64:65], v[80:81], v[38:39], v[64:65] op_sel_hi:[1,0,1]
    v_pk_fma_f32 v[66:67], v[82:83], v[38:39], v[66:67] op_sel_hi:[1,0,1]
    v_cvt_pk_bf16_f32 v16, v60, v61
    v_cvt_pk_bf16_f32 v17, v62, v63
    v_cvt_pk_bf16_f32 v18, v64, v65
    v_cvt_pk_bf16_f32 v19, v66, v67
    buffer_store_dwordx4 v[16:19], v14, s[36:39], s96 offen offset:0 sc1
L_pad8:
    s_cbranch_execz L_padret
    s_nop 0
    v_pk_fma_f32 v[68:69], v[84:85], v[38:39], v[68:69] op_sel_hi:[1,0,1]
    v_pk_fma_f32 v[70:71], v[86:87], v[38:39], v[70:71] op_sel_hi:[1,0,1]
    v_pk_fma_f32 v[72:73], v[88:89], v[38:39], v[72:73] op_sel_hi:[1,0,1]
    v_pk_fma_f32 v[74:75], v[90:91], v[38:39], v[74:75] op_sel_hi:[1,0,1]
    v_cvt_pk_bf16_f32 v20, v68, v69
    v_cvt_pk_bf16_f32 v21, v70, v71
    v_cvt_pk_bf16_f32 v22, v72, v73
    v_cvt_pk_bf16_f32 v23, v74, v75
    buffer_store_dwordx4 v[20:23], v14, s[36:39], s96 offen offset:1024 sc1
    v_pk_mul_f32 v[128:129], v[128:129], v[40:41] op_sel_hi:[1,0]
    v_pk_mul_f32 v[130:131], v[130:131], v[40:41] op_sel_hi:[1,0]
    v_pk_mul_f32 v[132:133], v[132:133], v[40:41] op_sel_hi:[1,0]
    v_pk_mul_f32 v[134:135], v[134:135], v[40:41] op_sel_hi:[1,0]
    v_pk_fma_f32 v[128:129], v[144:145], v[42:43], v[128:129] op_sel_hi:[1,0,1]
    v_pk_fma_f32 v[130:131], v[146:147], v[42:43], v[130:131] op_sel_hi:[1,0,1]
    v_pk_fma_f32 v[132:133], v[148:149], v[42:43], v[132:133] op_sel_hi:[1,0,1]
    v_pk_fma_f32 v[134:135], v[150:151], v[42:43], v[134:135] op_sel_hi:[1,0,1]
    v_cvt_pk_bf16_f32 v24, v128, v129
    v_cvt_pk_bf16_f32 v25, v130, v131
    v_cvt_pk_bf16_f32 v26, v132, v133
    v_cvt_pk_bf16_f32 v27, v134, v135
    buffer_store_dwordx4 v[24:27], v14, s[36:39], s97 offen offset:0 sc1
    v_pk_mul_f32 v[136:137], v[136:137], v[40:41] op_sel_hi:[1,0]
    v_pk_mul_f32 v[138:139], v[138:139], v[40:41] op_sel_hi:[1,0]
    v_pk_mul_f32 v[140:141], v[140:141], v[40:41] op_sel_hi:[1,0]
    v_pk_mul_f32 v[142:143], v[142:143], v[40:41] op_sel_hi:[1,0]
    v_pk_fma_f32 v[136:137], v[152:153], v[42:43], v[136:137] op_sel_hi:[1,0,1]
    v_pk_fma_f32 v[138:139], v[154:155], v[42:43], v[138:139] op_sel_hi:[1,0,1]
    v_pk_fma_f32 v[140:141], v[156:157], v[42:43], v[140:141] op_sel_hi:[1,0,1]
    v_pk_fma_f32 v[142:143], v[158:159], v[42:43], v[142:143] op_sel_hi:[1,0,1]
    v_cvt_pk_bf16_f32 v28, v136, v137
    v_cvt_pk_bf16_f32 v29, v138, v139
    v_cvt_pk_bf16_f32 v30, v140, v141
    v_cvt_pk_bf16_f32 v31, v142, v143
    buffer_store_dwordx4 v[28:31], v14, s[36:39], s97 offen offset:1024 sc1
    v_and_b32 v8, 31, v2
    v_lshrrev_b32 v9, 5, v2
    v_lshlrev_b32 v10, 3, v9
    s_lshl_b32 s78, s72, 7
    buffer_load_dwordx2 v[32:33], v10, s[64:67], s78 offen offset:0
    buffer_load_dwordx2 v[34:35], v10, s[64:67], s78 offen offset:16
    buffer_load_dwordx2 v[36:37], v10, s[64:67], s78 offen offset:32
    buffer_load_dwordx2 v[38:39], v10, s[64:67], s78 offen offset:48
    buffer_load_dwordx2 v[40:41], v10, s[64:67], s78 offen offset:64
    buffer_load_dwordx2 v[42:43], v10, s[64:67], s78 offen offset:80
    buffer_load_dwordx2 v[44:45], v10, s[64:67], s78 offen offset:96
    buffer_load_dwordx2 v[46:47], v10, s[64:67], s78 offen offset:112
    buffer_load_dwordx4 v[48:51], v14, s[64:67], 0 offen
    buffer_load_dwordx4 v[52:55], v14, s[64:67], 0 offen offset:1024
    s_barrier
    s_lshl_b32 s78, s76, 12
    s_add_u32 s78, s78, 131072
    v_lshl_add_u32 v6, v8, 7, s78
    v_add_u32_e64 v6, v6, v10
    v_bfe_u32 v11, v8, 1, 3
    v_lshl_add_u32 v6, v11, 4, v6
    v_xor_b32 v112, 0, v6
    v_xor_b32 v113, 16, v6
    v_xor_b32 v114, 32, v6
    v_xor_b32 v115, 48, v6
    v_xor_b32_e64 v116, 64, v6
    v_xor_b32 v117, 80, v6
    v_xor_b32 v118, 96, v6
    v_xor_b32 v119, 112, v6
    v_bfe_u32 v11, v2, 2, 2
    v_lshl_add_u32 v12, v9, 2, v11
    v_lshlrev_b32 v12, 7, v12
    v_lshrrev_b32 v11, 1, v11
    v_lshl_add_u32 v12, v11, 6, v12
    v_bfe_u32 v11, v2, 4, 1
    v_lshl_add_u32 v12, v11, 5, v12
    v_and_b32_e64 v11, 3, v2
    v_lshl_add_u32 v12, v11, 3, v12
    s_lshl_b32 s82, s72, 0
    s_and_b32 s82, s82, 15
    s_lshl_b32 s78, s82, 13
    v_add_u32 v4, s78, v12
    v_xor_b32 v5, 64, v4
    s_lshl_b32 s83, s71, 2
    s_add_u32 s83, s83, s76
    s_lshl_b32 s83, s83, 16
    s_add_u32 s83, s83, 4194304
    s_lshl_b32 s82, s82, 12
    s_add_u32 s88, s82, s83
    v_lshlrev_b32_e64 v12, 4, v8
    v_lshl_add_u32 v12, v9, 14, v12
    s_lshl_b32 s94, s71, 15
    s_lshl_b32 s79, s76, 9
    s_add_u32 s94, s94, s79
    s_add_u32 s94, s94, 1572864
    s_lshl_b32 s95, s72, 11
    s_add_u32 s95, s95, s94
    s_lshl_b32 s78, s76, 5
    v_add_u32 v11, s78, v8
    v_and_b32 v13, 7, v8
    v_xor_b32 v13, v13, v9
    v_lshlrev_b32 v13, 4, v13
    v_lshl_add_u32 v13, v11, 8, v13
    v_lshlrev_b32_e64 v10, 3, v11
    v_add_u32 v10, 159744, v10
    s_lshl_b32 s78, s71, 7
    v_add_u32 v11, s78, v11
    s_waitcnt vmcnt(0)
    s_barrier
    ds_read_b64 v[96:97], v112
    ds_read_b64 v[98:99], v113
    ds_read_b64 v[100:101], v114
    ds_read_b64 v[102:103], v115
    ds_read_b64 v[104:105], v116
    ds_read_b64 v[106:107], v117
    ds_read_b64 v[108:109], v118
    ds_read_b64 v[110:111], v119
    v_lshlrev_b32_e64 v60, 16, v32
    v_and_b32 v61, 0xffff0000, v32
    v_lshlrev_b32_e64 v62, 16, v33
    v_and_b32 v63, 0xffff0000, v33
    v_lshlrev_b32_e64 v64, 16, v34
    v_and_b32 v65, 0xffff0000, v34
    v_lshlrev_b32_e64 v66, 16, v35
    v_and_b32 v67, 0xffff0000, v35
    v_lshlrev_b32_e64 v68, 16, v36
    v_and_b32 v69, 0xffff0000, v36
    v_lshlrev_b32_e64 v70, 16, v37
    v_and_b32 v71, 0xffff0000, v37
    v_lshlrev_b32_e64 v72, 16, v38
    v_and_b32 v73, 0xffff0000, v38
    v_lshlrev_b32_e64 v74, 16, v39
    v_and_b32 v75, 0xffff0000, v39
    v_lshlrev_b32_e64 v76, 16, v40
    v_and_b32 v77, 0xffff0000, v40
    v_lshlrev_b32_e64 v78, 16, v41
    v_and_b32 v79, 0xffff0000, v41
    v_lshlrev_b32_e64 v80, 16, v42
    v_and_b32 v81, 0xffff0000, v42
    v_lshlrev_b32_e64 v82, 16, v43
    v_and_b32 v83, 0xffff0000, v43
    v_lshlrev_b32_e64 v84, 16, v44
    v_and_b32 v85, 0xffff0000, v44
    v_lshlrev_b32_e64 v86, 16, v45
    v_and_b32 v87, 0xffff0000, v45
    v_lshlrev_b32_e64 v88, 16, v46
    v_and_b32 v89, 0xffff0000, v46
    v_lshlrev_b32_e64 v90, 16, v47
    v_and_b32 v91, 0xffff0000, v47
    s_mov_b32 s78, 0x3f803f80
    v_dot2_f32_bf16 v126, v48, s78, 0
    v_dot2_f32_bf16 v126, v49, s78, v126
    v_dot2_f32_bf16 v126, v50, s78, v126
    v_dot2_f32_bf16 v126, v51, s78, v126
    v_dot2_f32_bf16 v126, v52, s78, v126
    v_dot2_f32_bf16 v126, v53, s78, v126
    v_dot2_f32_bf16 v126, v54, s78, v126
    v_dot2_f32_bf16 v126, v55, s78, v126
    s_nop 2
    v_add_f32_dpp v126, v126, v126 row_ror:8 row_mask:0xf bank_mask:0xf
    s_nop 1
    v_add_f32_dpp v126, v126, v126 row_ror:4 row_mask:0xf bank_mask:0xf
    s_nop 1
    v_add_f32_dpp v126, v126, v126 row_ror:2 row_mask:0xf bank_mask:0xf
    s_nop 1
    v_add_f32_dpp v126, v126, v126 row_ror:1 row_mask:0xf bank_mask:0xf
    v_mov_b32 v127, v126
    s_nop 1
    v_permlane32_swap_b32 v126, v127
    v_add_f32 v126, v126, v127
    v_mov_b32 v127, v126
    s_nop 1
    v_permlane16_swap_b32 v126, v127
    v_add_f32 v126, v126, v127
    v_mov_b32 v44, 163328
    v_mov_b32_e64 v45, 1
    v_mov_b32 v46, 0xff800000
    v_mov_b32_e64 v47, 0
    ds_write_b64 v44, v[46:47]
    s_lshl_b32 s96, s71, 4
    s_add_u32 s96, s96, s72
    s_lshl_b32 s96, s96, 9
    s_add_u32 s96, s96, 524288
    v_mov_b32 v15, 163584
    ds_read_b32 v15, v15
    s_waitcnt lgkmcnt(0)
    v_readfirstlane_b32 s99, v15
    v_lshlrev_b32 v224, 16, v96
    v_and_b32 v225, 0xffff0000, v96
    v_lshlrev_b32_e64 v226, 16, v97
    v_and_b32 v227, 0xffff0000, v97
    v_lshlrev_b32_e64 v228, 16, v98
    v_and_b32 v229, 0xffff0000, v98
    v_lshlrev_b32_e64 v230, 16, v99
    v_and_b32 v231, 0xffff0000, v99
    v_lshlrev_b32_e64 v232, 16, v100
    v_and_b32 v233, 0xffff0000, v100
    v_lshlrev_b32_e64 v234, 16, v101
    v_and_b32 v235, 0xffff0000, v101
    v_lshlrev_b32_e64 v236, 16, v102
    v_and_b32 v237, 0xffff0000, v102
    v_lshlrev_b32_e64 v238, 16, v103
    v_and_b32 v239, 0xffff0000, v103
    v_lshlrev_b32_e64 v240, 16, v104
    v_and_b32 v241, 0xffff0000, v104
    v_lshlrev_b32_e64 v242, 16, v105
    v_and_b32 v243, 0xffff0000, v105
    v_lshlrev_b32_e64 v244, 16, v106
    v_and_b32 v245, 0xffff0000, v106
    v_lshlrev_b32_e64 v246, 16, v107
    v_and_b32 v247, 0xffff0000, v107
    v_lshlrev_b32_e64 v248, 16, v108
    v_and_b32 v249, 0xffff0000, v108
    v_lshlrev_b32_e64 v250, 16, v109
    v_and_b32 v251, 0xffff0000, v109
    v_lshlrev_b32_e64 v252, 16, v110
    v_and_b32 v253, 0xffff0000, v110
    v_lshlrev_b32_e64 v254, 16, v111
    v_and_b32 v255, 0xffff0000, v111
    s_mov_b32 s84, 0
    s_barrier
    buffer_load_dwordx4 v[160:163], v14, s[36:39], s88 offen offset:0 sc1
    ds_read_b64_tr_b16 v[128:129], v4 offset:0
    buffer_load_dwordx4 v[164:167], v14, s[36:39], s88 offen offset:1024 sc1
    ds_read_b64_tr_b16 v[130:131], v4 offset:1024
    buffer_load_dwordx4 v[168:171], v14, s[36:39], s88 offen offset:2048 sc1
    ds_read_b64_tr_b16 v[132:133], v5 offset:0
    buffer_load_dwordx4 v[172:175], v14, s[36:39], s88 offen offset:3072 sc1
    s_add_u32 s82, s82, 4096
    s_and_b32 s82, s82, 0xffff
    s_add_u32 s88, s82, s83
    s_nop 0
    ds_read_b64_tr_b16 v[134:135], v5 offset:1024
    buffer_load_dwordx4 v[176:179], v14, s[36:39], s88 offen offset:0 sc1
    ds_read_b64_tr_b16 v[136:137], v4 offset:2048
    buffer_load_dwordx4 v[180:183], v14, s[36:39], s88 offen offset:1024 sc1
    ds_read_b64_tr_b16 v[138:139], v4 offset:3072
    buffer_load_dwordx4 v[184:187], v14, s[36:39], s88 offen offset:2048 sc1
    ds_read_b64_tr_b16 v[140:141], v5 offset:2048
    buffer_load_dwordx4 v[188:191], v14, s[36:39], s88 offen offset:3072 sc1
    s_add_u32 s82, s82, 4096
    s_and_b32 s82, s82, 0xffff
    s_add_u32 s88, s82, s83
    s_nop 0
    ds_read_b64_tr_b16 v[142:143], v5 offset:3072
    buffer_load_dwordx4 v[192:195], v14, s[36:39], s88 offen offset:0 sc1
    buffer_load_dwordx4 v[196:199], v14, s[36:39], s88 offen offset:1024 sc1
    buffer_load_dwordx4 v[200:203], v14, s[36:39], s88 offen offset:2048 sc1
    buffer_load_dwordx4 v[204:207], v14, s[36:39], s88 offen offset:3072 sc1
    s_add_u32 s82, s82, 4096
    s_and_b32 s82, s82, 0xffff
    s_add_u32 s88, s82, s83
    buffer_load_dwordx4 v[208:211], v14, s[36:39], s88 offen offset:0 sc1
    buffer_load_dwordx4 v[212:215], v14, s[36:39], s88 offen offset:1024 sc1
    .p2align 3
L_G2:
    s_add_u32 s84, s84, 1
    s_waitcnt vmcnt(12) lgkmcnt(6)
    v_mfma_f32_32x32x16_bf16 v[224:239], v[128:131], v[160:163], v[224:239]
    ds_read_b64_tr_b16 v[144:145], v4 offset:4096
    ds_read_b64_tr_b16 v[146:147], v4 offset:5120
    buffer_load_dwordx4 v[216:219], v14, s[36:39], s88 offen offset:2048 sc1
    s_waitcnt lgkmcnt(6)
    v_mfma_f32_32x32x16_bf16 v[240:255], v[132:135], v[160:163], v[240:255]
    ds_read_b64_tr_b16 v[148:149], v5 offset:4096
    ds_read_b64_tr_b16 v[150:151], v5 offset:5120
    s_waitcnt lgkmcnt(6)
    v_mfma_f32_32x32x16_bf16 v[224:239], v[136:139], v[164:167], v[224:239]
    ds_read_b64_tr_b16 v[152:153], v4 offset:6144
    ds_read_b64_tr_b16 v[154:155], v4 offset:7168
    buffer_load_dwordx4 v[220:223], v14, s[36:39], s88 offen offset:3072 sc1
    s_add_u32 s82, s82, 4096
    s_and_b32 s82, s82, 0xffff
    s_add_u32 s88, s82, s83
    s_waitcnt lgkmcnt(6)
    v_mfma_f32_32x32x16_bf16 v[240:255], v[140:143], v[164:167], v[240:255]
    ds_read_b64_tr_b16 v[156:157], v5 offset:6144
    ds_read_b64_tr_b16 v[158:159], v5 offset:7168
    v_add_u32 v4, 0x2000, v4
    v_and_b32 v4, 0x1ffff, v4
    v_xor_b32 v5, 64, v4
    s_waitcnt vmcnt(12) lgkmcnt(6)
    v_mfma_f32_32x32x16_bf16 v[224:239], v[144:147], v[168:171], v[224:239]
    ds_read_b64_tr_b16 v[128:129], v4 offset:0
    ds_read_b64_tr_b16 v[130:131], v4 offset:1024
    buffer_load_dwordx4 v[160:163], v14, s[36:39], s88 offen offset:0 sc1
    s_waitcnt lgkmcnt(6)
    v_mfma_f32_32x32x16_bf16 v[240:255], v[148:151], v[168:171], v[240:255]
    ds_read_b64_tr_b16 v[132:133], v5 offset:0
    ds_read_b64_tr_b16 v[134:135], v5 offset:1024
    s_waitcnt lgkmcnt(6)
    v_mfma_f32_32x32x16_bf16 v[224:239], v[152:155], v[172:175], v[224:239]
    ds_read_b64_tr_b16 v[136:137], v4 offset:2048
    ds_read_b64_tr_b16 v[138:139], v4 offset:3072
    buffer_load_dwordx4 v[164:167], v14, s[36:39], s88 offen offset:1024 sc1
    s_waitcnt lgkmcnt(6)
    v_mfma_f32_32x32x16_bf16 v[240:255], v[156:159], v[172:175], v[240:255]
    ds_read_b64_tr_b16 v[140:141], v5 offset:2048
L_pad9:
    s_cbranch_execz L_padret
    ds_read_b64_tr_b16 v[142:143], v5 offset:3072
    s_waitcnt vmcnt(12) lgkmcnt(6)
    v_mfma_f32_32x32x16_bf16 v[224:239], v[128:131], v[176:179], v[224:239]
    ds_read_b64_tr_b16 v[144:145], v4 offset:4096
    ds_read_b64_tr_b16 v[146:147], v4 offset:5120
    buffer_load_dwordx4 v[168:171], v14, s[36:39], s88 offen offset:2048 sc1
    s_waitcnt lgkmcnt(6)
    v_mfma_f32_32x32x16_bf16 v[240:255], v[132:135], v[176:179], v[240:255]
    ds_read_b64_tr_b16 v[148:149], v5 offset:4096
    ds_read_b64_tr_b16 v[150:151], v5 offset:5120
    s_waitcnt lgkmcnt(6)
    s_nop 0
    v_mfma_f32_32x32x16_bf16 v[224:239], v[136:139], v[180:183], v[224:239]
    ds_read_b64_tr_b16 v[152:153], v4 offset:6144
    ds_read_b64_tr_b16 v[154:155], v4 offset:7168
    buffer_load_dwordx4 v[172:175], v14, s[36:39], s88 offen offset:3072 sc1
    s_add_u32 s82, s82, 4096
    s_and_b32 s82, s82, 0xffff
    s_add_u32 s88, s82, s83
    s_waitcnt lgkmcnt(6)
    v_mfma_f32_32x32x16_bf16 v[240:255], v[140:143], v[180:183], v[240:255]
    ds_read_b64_tr_b16 v[156:157], v5 offset:6144
    ds_read_b64_tr_b16 v[158:159], v5 offset:7168
    v_add_u32 v4, 0x2000, v4
    v_and_b32 v4, 0x1ffff, v4
    v_xor_b32 v5, 64, v4
    s_waitcnt vmcnt(12) lgkmcnt(6)
    v_mfma_f32_32x32x16_bf16 v[224:239], v[144:147], v[184:187], v[224:239]
    ds_read_b64_tr_b16 v[128:129], v4 offset:0
    ds_read_b64_tr_b16 v[130:131], v4 offset:1024
    buffer_load_dwordx4 v[176:179], v14, s[36:39], s88 offen offset:0 sc1
    s_waitcnt lgkmcnt(6)
    v_mfma_f32_32x32x16_bf16 v[240:255], v[148:151], v[184:187], v[240:255]
    ds_read_b64_tr_b16 v[132:133], v5 offset:0
    ds_read_b64_tr_b16 v[134:135], v5 offset:1024
    s_waitcnt lgkmcnt(6)
    v_mfma_f32_32x32x16_bf16 v[224:239], v[152:155], v[188:191], v[224:239]
    ds_read_b64_tr_b16 v[136:137], v4 offset:2048
    ds_read_b64_tr_b16 v[138:139], v4 offset:3072
    buffer_load_dwordx4 v[180:183], v14, s[36:39], s88 offen offset:1024 sc1
    s_waitcnt lgkmcnt(6)
    v_mfma_f32_32x32x16_bf16 v[240:255], v[156:159], v[188:191], v[240:255]
    ds_read_b64_tr_b16 v[140:141], v5 offset:2048
    ds_read_b64_tr_b16 v[142:143], v5 offset:3072
    s_waitcnt vmcnt(12) lgkmcnt(6)
    v_mfma_f32_32x32x16_bf16 v[224:239], v[128:131], v[192:195], v[224:239]
    ds_read_b64_tr_b16 v[144:145], v4 offset:4096
    ds_read_b64_tr_b16 v[146:147], v4 offset:5120
    buffer_load_dwordx4 v[184:187], v14, s[36:39], s88 offen offset:2048 sc1
    s_waitcnt lgkmcnt(6)
    v_mfma_f32_32x32x16_bf16 v[240:255], v[132:135], v[192:195], v[240:255]
    ds_read_b64_tr_b16 v[148:149], v5 offset:4096
    ds_read_b64_tr_b16 v[150:151], v5 offset:5120
    s_waitcnt lgkmcnt(6)
    v_mfma_f32_32x32x16_bf16 v[224:239], v[136:139], v[196:199], v[224:239]
    ds_read_b64_tr_b16 v[152:153], v4 offset:6144
    ds_read_b64_tr_b16 v[154:155], v4 offset:7168
    buffer_load_dwordx4 v[188:191], v14, s[36:39], s88 offen offset:3072 sc1
    s_add_u32 s82, s82, 4096
    s_and_b32 s82, s82, 0xffff
    s_add_u32 s88, s82, s83
    s_waitcnt lgkmcnt(6)
    v_mfma_f32_32x32x16_bf16 v[240:255], v[140:143], v[196:199], v[240:255]
    ds_read_b64_tr_b16 v[156:157], v5 offset:6144
    ds_read_b64_tr_b16 v[158:159], v5 offset:7168
    v_add_u32 v4, 0x2000, v4
    v_and_b32 v4, 0x1ffff, v4
    v_xor_b32 v5, 64, v4
    s_waitcnt vmcnt(12) lgkmcnt(6)
    v_mfma_f32_32x32x16_bf16 v[224:239], v[144:147], v[200:203], v[224:239]
    ds_read_b64_tr_b16 v[128:129], v4 offset:0
    ds_read_b64_tr_b16 v[130:131], v4 offset:1024
    buffer_load_dwordx4 v[192:195], v14, s[36:39], s88 offen offset:0 sc1
    s_waitcnt lgkmcnt(6)
    v_mfma_f32_32x32x16_bf16 v[240:255], v[148:151], v[200:203], v[240:255]
    ds_read_b64_tr_b16 v[132:133], v5 offset:0
    ds_read_b64_tr_b16 v[134:135], v5 offset:1024
    s_waitcnt lgkmcnt(6)
    v_mfma_f32_32x32x16_bf16 v[224:239], v[152:155], v[204:207], v[224:239]
    ds_read_b64_tr_b16 v[136:137], v4 offset:2048
    ds_read_b64_tr_b16 v[138:139], v4 offset:3072
    buffer_load_dwordx4 v[196:199], v14, s[36:39], s88 offen offset:1024 sc1
    s_waitcnt lgkmcnt(6)
    v_mfma_f32_32x32x16_bf16 v[240:255], v[156:159], v[204:207], v[240:255]
    ds_read_b64_tr_b16 v[140:141], v5 offset:2048
    ds_read_b64_tr_b16 v[142:143], v5 offset:3072
    s_waitcnt vmcnt(12) lgkmcnt(6)
    v_mfma_f32_32x32x16_bf16 v[224:239], v[128:131], v[208:211], v[224:239]
    ds_read_b64_tr_b16 v[144:145], v4 offset:4096
    ds_read_b64_tr_b16 v[146:147], v4 offset:5120
    buffer_load_dwordx4 v[200:203], v14, s[36:39], s88 offen offset:2048 sc1
    s_waitcnt lgkmcnt(6)
    v_mfma_f32_32x32x16_bf16 v[240:255], v[132:135], v[208:211], v[240:255]
    ds_read_b64_tr_b16 v[148:149], v5 offset:4096
    ds_read_b64_tr_b16 v[150:151], v5 offset:5120
    s_waitcnt lgkmcnt(6)
    v_mfma_f32_32x32x16_bf16 v[224:239], v[136:139], v[212:215], v[224:239]
    ds_read_b64_tr_b16 v[152:153], v4 offset:6144
    ds_read_b64_tr_b16 v[154:155], v4 offset:7168
    buffer_load_dwordx4 v[204:207], v14, s[36:39], s88 offen offset:3072 sc1
    s_add_u32 s82, s82, 4096
    s_and_b32 s82, s82, 0xffff
    s_add_u32 s88, s82, s83
    s_waitcnt lgkmcnt(6)
    v_mfma_f32_32x32x16_bf16 v[240:255], v[140:143], v[212:215], v[240:255]
    ds_read_b64_tr_b16 v[156:157], v5 offset:6144
    ds_read_b64_tr_b16 v[158:159], v5 offset:7168
    v_add_u32 v4, 0x2000, v4
    v_and_b32 v4, 0x1ffff, v4
    v_xor_b32 v5, 64, v4
    s_waitcnt vmcnt(12) lgkmcnt(6)
    v_mfma_f32_32x32x16_bf16 v[224:239], v[144:147], v[216:219], v[224:239]
    ds_read_b64_tr_b16 v[128:129], v4 offset:0
    ds_read_b64_tr_b16 v[130:131], v4 offset:1024
    buffer_load_dwordx4 v[208:211], v14, s[36:39], s88 offen offset:0 sc1
    s_waitcnt lgkmcnt(6)
    v_mfma_f32_32x32x16_bf16 v[240:255], v[148:151], v[216:219], v[240:255]
    ds_read_b64_tr_b16 v[132:133], v5 offset:0
    ds_read_b64_tr_b16 v[134:135], v5 offset:1024
    s_waitcnt lgkmcnt(6)
    v_mfma_f32_32x32x16_bf16 v[224:239], v[152:155], v[220:223], v[224:239]
    ds_read_b64_tr_b16 v[136:137], v4 offset:2048
    ds_read_b64_tr_b16 v[138:139], v4 offset:3072
    buffer_load_dwordx4 v[212:215], v14, s[36:39], s88 offen offset:1024 sc1
    s_waitcnt lgkmcnt(6)
    v_mfma_f32_32x32x16_bf16 v[240:255], v[156:159], v[220:223], v[240:255]
    ds_read_b64_tr_b16 v[140:141], v5 offset:2048
    ds_read_b64_tr_b16 v[142:143], v5 offset:3072
    s_cmp_lt_u32 s84, 3
    s_cbranch_scc1 L_G2
    s_waitcnt vmcnt(12) lgkmcnt(6)
    v_mfma_f32_32x32x16_bf16 v[224:239], v[128:131], v[160:163], v[224:239]
    ds_read_b64_tr_b16 v[144:145], v4 offset:4096
    ds_read_b64_tr_b16 v[146:147], v4 offset:5120
    buffer_load_dwordx4 v[216:219], v14, s[36:39], s88 offen offset:2048 sc1
    s_waitcnt lgkmcnt(6)
    v_mfma_f32_32x32x16_bf16 v[240:255], v[132:135], v[160:163], v[240:255]
    ds_read_b64_tr_b16 v[148:149], v5 offset:4096
    ds_read_b64_tr_b16 v[150:151], v5 offset:5120
    s_waitcnt lgkmcnt(6)
    v_mfma_f32_32x32x16_bf16 v[224:239], v[136:139], v[164:167], v[224:239]
    ds_read_b64_tr_b16 v[152:153], v4 offset:6144
    ds_read_b64_tr_b16 v[154:155], v4 offset:7168
    buffer_load_dwordx4 v[220:223], v14, s[36:39], s88 offen offset:3072 sc1
    s_add_u32 s82, s82, 4096
    s_and_b32 s82, s82, 0xffff
    s_add_u32 s88, s82, s83
    s_waitcnt lgkmcnt(6)
    v_mfma_f32_32x32x16_bf16 v[240:255], v[140:143], v[164:167], v[240:255]
    ds_read_b64_tr_b16 v[156:157], v5 offset:6144
    ds_read_b64_tr_b16 v[158:159], v5 offset:7168
    s_barrier
    v_add_u32 v4, 0x2000, v4
    v_and_b32 v4, 0x1ffff, v4
    v_xor_b32_e64 v5, 64, v4
    s_waitcnt vmcnt(12) lgkmcnt(6)
    v_mfma_f32_32x32x16_bf16 v[224:239], v[144:147], v[168:171], v[224:239]
    ds_read_b64_tr_b16 v[128:129], v4 offset:0
    ds_read_b64_tr_b16 v[130:131], v4 offset:1024
    s_waitcnt lgkmcnt(6)
    v_mfma_f32_32x32x16_bf16 v[240:255], v[148:151], v[168:171], v[240:255]
    ds_read_b64_tr_b16 v[132:133], v5 offset:0
    ds_read_b64_tr_b16 v[134:135], v5 offset:1024
    s_waitcnt lgkmcnt(6)
    v_mfma_f32_32x32x16_bf16 v[224:239], v[152:155], v[172:175], v[224:239]
    ds_read_b64_tr_b16 v[136:137], v4 offset:2048
    ds_read_b64_tr_b16 v[138:139], v4 offset:3072
    s_waitcnt lgkmcnt(6)
    v_mfma_f32_32x32x16_bf16 v[240:255], v[156:159], v[172:175], v[240:255]
    ds_read_b64_tr_b16 v[140:141], v5 offset:2048
    ds_read_b64_tr_b16 v[142:143], v5 offset:3072
    s_waitcnt vmcnt(10) lgkmcnt(6)
    v_mfma_f32_32x32x16_bf16 v[224:239], v[128:131], v[176:179], v[224:239]
    ds_read_b64_tr_b16 v[144:145], v4 offset:4096
    ds_read_b64_tr_b16 v[146:147], v4 offset:5120
    s_waitcnt lgkmcnt(6)
    v_mfma_f32_32x32x16_bf16 v[240:255], v[132:135], v[176:179], v[240:255]
    ds_read_b64_tr_b16 v[148:149], v5 offset:4096
    ds_read_b64_tr_b16 v[150:151], v5 offset:5120
    s_waitcnt lgkmcnt(6)
    v_mfma_f32_32x32x16_bf16 v[224:239], v[136:139], v[180:183], v[224:239]
    ds_read_b64_tr_b16 v[152:153], v4 offset:6144
    ds_read_b64_tr_b16 v[154:155], v4 offset:7168
    s_waitcnt lgkmcnt(6)
    v_mfma_f32_32x32x16_bf16 v[240:255], v[140:143], v[180:183], v[240:255]
    ds_read_b64_tr_b16 v[156:157], v5 offset:6144
    ds_read_b64_tr_b16 v[158:159], v5 offset:7168
    v_add_u32 v4, 0x2000, v4
    v_and_b32 v4, 0x1ffff, v4
    v_xor_b32_e64 v5, 64, v4
    s_waitcnt vmcnt(8) lgkmcnt(6)
    v_mfma_f32_32x32x16_bf16 v[224:239], v[144:147], v[184:187], v[224:239]
    ds_read_b64_tr_b16 v[128:129], v4 offset:0
    ds_read_b64_tr_b16 v[130:131], v4 offset:1024
    s_waitcnt lgkmcnt(6)
    v_mfma_f32_32x32x16_bf16 v[240:255], v[148:151], v[184:187], v[240:255]
    ds_read_b64_tr_b16 v[132:133], v5 offset:0
    ds_read_b64_tr_b16 v[134:135], v5 offset:1024
    s_waitcnt lgkmcnt(6)
    v_mfma_f32_32x32x16_bf16 v[224:239], v[152:155], v[188:191], v[224:239]
    ds_read_b64_tr_b16 v[136:137], v4 offset:2048
    ds_read_b64_tr_b16 v[138:139], v4 offset:3072
    s_waitcnt lgkmcnt(6)
    v_mfma_f32_32x32x16_bf16 v[240:255], v[156:159], v[188:191], v[240:255]
    ds_read_b64_tr_b16 v[140:141], v5 offset:2048
    ds_read_b64_tr_b16 v[142:143], v5 offset:3072
    s_waitcnt vmcnt(6) lgkmcnt(6)
    v_mfma_f32_32x32x16_bf16 v[224:239], v[128:131], v[192:195], v[224:239]
    ds_read_b64_tr_b16 v[144:145], v4 offset:4096
    ds_read_b64_tr_b16 v[146:147], v4 offset:5120
    s_waitcnt lgkmcnt(6)
    v_mfma_f32_32x32x16_bf16 v[240:255], v[132:135], v[192:195], v[240:255]
    ds_read_b64_tr_b16 v[148:149], v5 offset:4096
    ds_read_b64_tr_b16 v[150:151], v5 offset:5120
    s_waitcnt lgkmcnt(6)
    v_mfma_f32_32x32x16_bf16 v[224:239], v[136:139], v[196:199], v[224:239]
    ds_read_b64_tr_b16 v[152:153], v4 offset:6144
    ds_read_b64_tr_b16 v[154:155], v4 offset:7168
    s_waitcnt lgkmcnt(6)
    v_mfma_f32_32x32x16_bf16 v[240:255], v[140:143], v[196:199], v[240:255]
    ds_read_b64_tr_b16 v[156:157], v5 offset:6144
    ds_read_b64_tr_b16 v[158:159], v5 offset:7168
    v_add_u32 v4, 0x2000, v4
    v_and_b32 v4, 0x1ffff, v4
    v_xor_b32_e64 v5, 64, v4
    s_waitcnt vmcnt(4) lgkmcnt(6)
    v_mfma_f32_32x32x16_bf16 v[224:239], v[144:147], v[200:203], v[224:239]
    ds_read_b64_tr_b16 v[128:129], v4 offset:0
    ds_read_b64_tr_b16 v[130:131], v4 offset:1024
    s_waitcnt lgkmcnt(6)
    v_mfma_f32_32x32x16_bf16 v[240:255], v[148:151], v[200:203], v[240:255]
    ds_read_b64_tr_b16 v[132:133], v5 offset:0
    ds_read_b64_tr_b16 v[134:135], v5 offset:1024
    s_waitcnt lgkmcnt(6)
    v_mfma_f32_32x32x16_bf16 v[224:239], v[152:155], v[204:207], v[224:239]
    ds_read_b64_tr_b16 v[136:137], v4 offset:2048
    ds_read_b64_tr_b16 v[138:139], v4 offset:3072
    s_waitcnt lgkmcnt(6)
    v_mfma_f32_32x32x16_bf16 v[240:255], v[156:159], v[204:207], v[240:255]
    ds_read_b64_tr_b16 v[140:141], v5 offset:2048
    ds_read_b64_tr_b16 v[142:143], v5 offset:3072
    s_waitcnt vmcnt(2) lgkmcnt(6)
    v_mfma_f32_32x32x16_bf16 v[224:239], v[128:131], v[208:211], v[224:239]
    ds_read_b64_tr_b16 v[144:145], v4 offset:4096
    ds_read_b64_tr_b16 v[146:147], v4 offset:5120
    s_waitcnt lgkmcnt(6)
    v_mfma_f32_32x32x16_bf16 v[240:255], v[132:135], v[208:211], v[240:255]
    ds_read_b64_tr_b16 v[148:149], v5 offset:4096
    ds_read_b64_tr_b16 v[150:151], v5 offset:5120
    s_waitcnt lgkmcnt(6)
    v_mfma_f32_32x32x16_bf16 v[224:239], v[136:139], v[212:215], v[224:239]
    ds_read_b64_tr_b16 v[152:153], v4 offset:6144
    ds_read_b64_tr_b16 v[154:155], v4 offset:7168
    s_waitcnt lgkmcnt(6)
    v_mfma_f32_32x32x16_bf16 v[240:255], v[140:143], v[212:215], v[240:255]
    ds_read_b64_tr_b16 v[156:157], v5 offset:6144
    ds_read_b64_tr_b16 v[158:159], v5 offset:7168
    s_waitcnt vmcnt(0) lgkmcnt(6)
    v_mfma_f32_32x32x16_bf16 v[224:239], v[144:147], v[216:219], v[224:239]
    s_waitcnt lgkmcnt(4)
    v_mfma_f32_32x32x16_bf16 v[240:255], v[148:151], v[216:219], v[240:255]
    s_waitcnt lgkmcnt(2)
    v_mfma_f32_32x32x16_bf16 v[224:239], v[152:155], v[220:223], v[224:239]
    s_waitcnt lgkmcnt(0)
    v_mfma_f32_32x32x16_bf16 v[240:255], v[156:159], v[220:223], v[240:255]
    s_nop 9
    v_pk_mul_f32 v[18:19], v[224:225], v[224:225]
    v_pk_mul_f32 v[20:21], v[224:225], v[60:61]
    v_pk_add_f32 v[16:17], v[224:225], v[226:227]
    v_pk_fma_f32 v[18:19], v[226:227], v[226:227], v[18:19]
    v_pk_fma_f32 v[20:21], v[226:227], v[62:63], v[20:21]
    v_pk_add_f32 v[16:17], v[16:17], v[228:229]
    v_pk_fma_f32 v[18:19], v[228:229], v[228:229], v[18:19]
    v_pk_fma_f32 v[20:21], v[228:229], v[64:65], v[20:21]
    v_pk_add_f32 v[16:17], v[16:17], v[230:231]
    v_pk_fma_f32 v[18:19], v[230:231], v[230:231], v[18:19]
    v_pk_fma_f32 v[20:21], v[230:231], v[66:67], v[20:21]
    v_pk_add_f32 v[16:17], v[16:17], v[232:233]
    v_pk_fma_f32 v[18:19], v[232:233], v[232:233], v[18:19]
    v_pk_fma_f32 v[20:21], v[232:233], v[68:69], v[20:21]
    v_pk_add_f32 v[16:17], v[16:17], v[234:235]
    v_pk_fma_f32 v[18:19], v[234:235], v[234:235], v[18:19]
    v_pk_fma_f32 v[20:21], v[234:235], v[70:71], v[20:21]
    v_pk_add_f32 v[16:17], v[16:17], v[236:237]
    v_pk_fma_f32 v[18:19], v[236:237], v[236:237], v[18:19]
    v_pk_fma_f32 v[20:21], v[236:237], v[72:73], v[20:21]
    v_pk_add_f32 v[16:17], v[16:17], v[238:239]
    v_pk_fma_f32 v[18:19], v[238:239], v[238:239], v[18:19]
    v_pk_fma_f32 v[20:21], v[238:239], v[74:75], v[20:21]
L_pad10:
    s_cbranch_execz L_padret
    s_nop 0
    v_pk_add_f32 v[16:17], v[16:17], v[240:241]
    v_pk_fma_f32 v[18:19], v[240:241], v[240:241], v[18:19]
    v_pk_fma_f32 v[20:21], v[240:241], v[76:77], v[20:21]
    v_pk_add_f32 v[16:17], v[16:17], v[242:243]
    v_pk_fma_f32 v[18:19], v[242:243], v[242:243], v[18:19]
    v_pk_fma_f32 v[20:21], v[242:243], v[78:79], v[20:21]
    v_pk_add_f32 v[16:17], v[16:17], v[244:245]
    v_pk_fma_f32 v[18:19], v[244:245], v[244:245], v[18:19]
    v_pk_fma_f32 v[20:21], v[244:245], v[80:81], v[20:21]
    v_pk_add_f32 v[16:17], v[16:17], v[246:247]
    v_pk_fma_f32 v[18:19], v[246:247], v[246:247], v[18:19]
    v_pk_fma_f32 v[20:21], v[246:247], v[82:83], v[20:21]
    v_pk_add_f32 v[16:17], v[16:17], v[248:249]
    v_pk_fma_f32 v[18:19], v[248:249], v[248:249], v[18:19]
    v_pk_fma_f32 v[20:21], v[248:249], v[84:85], v[20:21]
    v_pk_add_f32 v[16:17], v[16:17], v[250:251]
    v_pk_fma_f32 v[18:19], v[250:251], v[250:251], v[18:19]
    v_pk_fma_f32 v[20:21], v[250:251], v[86:87], v[20:21]
    v_pk_add_f32 v[16:17], v[16:17], v[252:253]
    v_pk_fma_f32 v[18:19], v[252:253], v[252:253], v[18:19]
    v_pk_fma_f32 v[20:21], v[252:253], v[88:89], v[20:21]
    v_pk_add_f32 v[16:17], v[16:17], v[254:255]
    v_pk_fma_f32 v[18:19], v[254:255], v[254:255], v[18:19]
    v_pk_fma_f32 v[20:21], v[254:255], v[90:91], v[20:21]
    v_mov_b32 v27, s75
    v_add_f32 v24, v16, v17
    v_add_f32 v25, v18, v19
    v_add_f32 v26, v20, v21
    v_mov_b32 v28, v24
    v_mov_b32 v29, v25
    v_mov_b32 v30, v26
    v_permlane32_swap_b32 v24, v28
    v_permlane32_swap_b32 v25, v29
    v_permlane32_swap_b32 v26, v30
    v_pk_add_f32 v[24:25], v[24:25], v[28:29]
    v_add_f32 v26, v26, v30
    s_mov_b32 exec_hi, 0
    s_bitcmp1_b32 s99, 1
    s_cbranch_scc1 Lls_46
    buffer_store_dwordx4 v[24:27], v14, s[36:39], s95 offen sc1
    s_branch Lle_47
Lls_46:
    buffer_store_dwordx4 v[24:27], v14, s[36:39], s95 offen
Lle_47:
    s_mov_b32 exec_hi, -1
    s_add_u32 s79, s94, 4096
    s_add_u32 s80, s94, 8192
    s_add_u32 s81, s94, 12288
    s_barrier
    v_xor_b32 v112, 0, v13
    ds_write_b128 v112, v[224:227]
    v_xor_b32_e64 v113, 32, v13
    ds_write_b128 v113, v[228:231]
    buffer_load_dwordx4 v[64:67], v12, s[36:39], s94 offen offset:0 sc1
    buffer_load_dwordx4 v[68:71], v12, s[36:39], s94 offen offset:2048 sc1
    buffer_load_dwordx4 v[72:75], v12, s[36:39], s79 offen offset:0 sc1
    buffer_load_dwordx4 v[76:79], v12, s[36:39], s79 offen offset:2048 sc1
    buffer_load_dwordx4 v[80:83], v12, s[36:39], s80 offen offset:0 sc1
    buffer_load_dwordx4 v[84:87], v12, s[36:39], s80 offen offset:2048 sc1
    buffer_load_dwordx4 v[88:91], v12, s[36:39], s81 offen offset:0 sc1
    buffer_load_dwordx4 v[92:95], v12, s[36:39], s81 offen offset:2048 sc1
    v_xor_b32_e64 v114, 64, v13
    ds_write_b128 v114, v[232:235]
    v_xor_b32 v115, 96, v13
    ds_write_b128 v115, v[236:239]
    v_xor_b32 v116, 128, v13
    ds_write_b128 v116, v[240:243]
    v_xor_b32 v117, 160, v13
    ds_write_b128 v117, v[244:247]
    v_xor_b32 v118, 192, v13
    ds_write_b128 v118, v[248:251]
    v_xor_b32 v119, 224, v13
    ds_write_b128 v119, v[252:255]
    s_mov_b32 s85, 1
    s_branch L_gchk
Lspin_48:
    s_add_u32 s85, s85, 1
    s_cmp_gt_u32 s85, 400000
    s_cbranch_scc1 L_end
    buffer_load_dwordx4 v[64:67], v12, s[36:39], s94 offen offset:0 sc1
    buffer_load_dwordx4 v[68:71], v12, s[36:39], s94 offen offset:2048 sc1
    buffer_load_dwordx4 v[72:75], v12, s[36:39], s79 offen offset:0 sc1
    buffer_load_dwordx4 v[76:79], v12, s[36:39], s79 offen offset:2048 sc1
    buffer_load_dwordx4 v[80:83], v12, s[36:39], s80 offen offset:0 sc1
    buffer_load_dwordx4 v[84:87], v12, s[36:39], s80 offen offset:2048 sc1
    buffer_load_dwordx4 v[88:91], v12, s[36:39], s81 offen offset:0 sc1
    buffer_load_dwordx4 v[92:95], v12, s[36:39], s81 offen offset:2048 sc1
L_gchk:
    s_waitcnt vmcnt(0)
    s_nop 0
    v_max3_u32 v16, v67, v71, v75
    v_max3_u32 v16, v16, v79, v83
    v_max3_u32 v16, v16, v87, v91
    v_max3_u32 v16, v16, v95, s75
    v_min3_u32 v17, v67, v71, v75
    v_min3_u32 v17, v17, v79, v83
    v_min3_u32 v17, v17, v87, v91
    v_min3_u32 v17, v17, v95, s75
    v_cmp_ne_u32_e64 vcc, v16, v17
    s_cbranch_vccnz Lspin_48
    s_barrier
    v_pk_add_f32 v[64:65], v[64:65], v[68:69]
    v_add_f32_e64 v66, v66, v70
    v_pk_add_f32 v[72:73], v[72:73], v[76:77]
    v_add_f32_e64 v74, v74, v78
    v_pk_add_f32 v[80:81], v[80:81], v[84:85]
    v_add_f32_e64 v82, v82, v86
    v_pk_add_f32 v[88:89], v[88:89], v[92:93]
    v_add_f32_e64 v90, v90, v94
    v_pk_add_f32 v[64:65], v[64:65], v[72:73]
    v_add_f32_e64 v66, v66, v74
    v_pk_add_f32 v[80:81], v[80:81], v[88:89]
    v_add_f32 v82, v82, v90
    v_add_f32 v24, v64, v80
    v_add_f32 v25, v65, v81
    v_add_f32 v26, v66, v82
    v_mov_b32 v28, v24
    v_mov_b32 v29, v25
    v_mov_b32 v30, v26
    v_permlane32_swap_b32 v24, v28
    v_permlane32_swap_b32 v25, v29
    v_permlane32_swap_b32 v26, v30
    v_pk_add_f32 v[24:25], v[24:25], v[28:29]
    v_add_f32_e64 v26, v26, v30
    v_mul_f32 v36, 0x3a800000, v24
    v_mul_f32 v40, 0x3a800000, v25
    v_fma_f32 v40, -v36, v36, v40
    v_max_f32_e64 v40, 0, v40
    v_cvt_pk_bf16_f32 v36, v36, v36
    v_and_b32 v36, 0xffff0000, v36
    v_cvt_pk_bf16_f32 v40, v40, v40
    v_and_b32 v40, 0xffff0000, v40
    v_add_f32 v40, 0x3727c5ac, v40
    v_cvt_pk_bf16_f32 v40, v40, v40
    v_and_b32 v40, 0xffff0000, v40
    v_sqrt_f32 v40, v40
    s_nop 0
    v_cvt_pk_bf16_f32 v40, v40, v40
    v_and_b32 v40, 0xffff0000, v40
    v_rcp_f32_e64 v38, v40
    v_fma_f32 v42, -v36, v126, v26
    s_mov_b32 s79, 0xfffff800
    v_mul_f32_e64 v42, v42, v38
    v_mul_f32 v39, -v36, v38
    v_and_or_b32 v42, v42, s79, v11
    s_mov_b32 exec_hi, 0
    ds_write_b64 v10, v[38:39]
    ds_max_f32 v44, v42
    s_mov_b32 exec_lo, 1
    ds_add_rtn_u32 v46, v44, v45 offset:4
    s_mov_b32 exec_lo, -1
    ds_read_b32 v20, v44
    v_lshlrev_b32 v17, 3, v2
    v_lshlrev_b32 v18, 2, v2
    v_mov_b32_e64 v21, s75
    s_mov_b32 s79, s96
    s_waitcnt lgkmcnt(0)
    v_readfirstlane_b32 s78, v46
    s_cmp_lg_u32 s78, 3
    s_cbranch_scc1 L_nocand
    s_mov_b32 exec_lo, 0xffff
    buffer_store_dwordx2 v[20:21], v17, s[36:39], s79 offen offset:128 sc1
    s_mov_b32 exec_lo, -1
    v_and_b32 v22, 127, v20
    v_and_b32 v23, 7, v20
    v_lshlrev_b32 v23, 4, v23
    v_xor_b32 v23, v23, v17
    v_lshl_add_u32 v23, v22, 8, v23
    v_lshlrev_b32_e64 v22, 3, v22
    ds_read_b64 v[24:25], v23
    v_add_u32 v22, 159744, v22
    ds_read_b64 v[26:27], v22
    s_waitcnt lgkmcnt(0)
    v_fma_f32 v28, v24, v26, v27
    v_fma_f32 v29, v25, v26, v27
    v_cvt_pk_bf16_f32 v30, v28, v29
    buffer_store_dword v30, v18, s[36:39], s79 offen sc1
    v_add_f32 v28, v28, v24
    v_add_f32_e64 v29, v29, v25
    buffer_store_dwordx2 v[28:29], v17, s[36:39], s79 offen offset:256 sc1
L_nocand:
    s_mov_b32 exec_hi, -1
    v_lshrrev_b32 v16, 3, v2
    v_and_b32 v17, 7, v2
    s_lshl_b32 s78, s76, 5
    v_add_u32 v18, s78, v16
    v_lshlrev_b32 v19, 1, v17
    v_xor_b32 v19, v19, v16
    v_lshlrev_b32 v19, 4, v19
    v_lshl_add_u32 v19, v18, 8, v19
    v_xor_b32 v32, 16, v19
    v_lshlrev_b32 v33, 3, v18
    v_add_u32 v33, 159744, v33
    ds_read_b128 v[64:67], v19 offset:0
    ds_read_b128 v[68:71], v32 offset:0
    ds_read_b64 v[96:97], v33 offset:0
    ds_read_b128 v[72:75], v19 offset:2048
    ds_read_b128 v[76:79], v32 offset:2048
    ds_read_b64 v[98:99], v33 offset:64
    ds_read_b128 v[80:83], v19 offset:4096
    ds_read_b128 v[84:87], v32 offset:4096
    ds_read_b64 v[100:101], v33 offset:128
    ds_read_b128 v[88:91], v19 offset:6144
    ds_read_b128 v[92:95], v32 offset:6144
    ds_read_b64 v[102:103], v33 offset:192
    s_lshl_b32 s78, s71, 7
    v_add_u32_e64 v18, s78, v18
    s_lshl_b32 s79, s72, 7
    v_lshl_add_u32 v19, v18, 11, s79
    v_lshl_add_u32 v19, v17, 4, v19
    v_mov_b32 v16, 163360
    s_waitcnt lgkmcnt(0)
    v_add_f32 v96, 1.0, v96
    v_pk_fma_f32 v[64:65], v[64:65], v[96:97], v[96:97] op_sel:[0,0,1] op_sel_hi:[1,0,1]
    v_pk_fma_f32 v[66:67], v[66:67], v[96:97], v[96:97] op_sel:[0,0,1] op_sel_hi:[1,0,1]
    v_pk_fma_f32 v[68:69], v[68:69], v[96:97], v[96:97] op_sel:[0,0,1] op_sel_hi:[1,0,1]
    v_pk_fma_f32 v[70:71], v[70:71], v[96:97], v[96:97] op_sel:[0,0,1] op_sel_hi:[1,0,1]
    v_cvt_pk_bf16_f32 v104, v64, v65
    v_cvt_pk_bf16_f32 v105, v66, v67
    v_cvt_pk_bf16_f32 v106, v68, v69
    v_cvt_pk_bf16_f32 v107, v70, v71
    v_add_f32_e64 v98, 1.0, v98
    v_pk_fma_f32 v[72:73], v[72:73], v[98:99], v[98:99] op_sel:[0,0,1] op_sel_hi:[1,0,1]
    v_pk_fma_f32 v[74:75], v[74:75], v[98:99], v[98:99] op_sel:[0,0,1] op_sel_hi:[1,0,1]
    v_pk_fma_f32 v[76:77], v[76:77], v[98:99], v[98:99] op_sel:[0,0,1] op_sel_hi:[1,0,1]
    v_pk_fma_f32 v[78:79], v[78:79], v[98:99], v[98:99] op_sel:[0,0,1] op_sel_hi:[1,0,1]
    v_cvt_pk_bf16_f32 v108, v72, v73
    v_cvt_pk_bf16_f32 v109, v74, v75
    v_cvt_pk_bf16_f32 v110, v76, v77
    v_cvt_pk_bf16_f32 v111, v78, v79
    v_add_f32_e64 v100, 1.0, v100
    v_pk_fma_f32 v[80:81], v[80:81], v[100:101], v[100:101] op_sel:[0,0,1] op_sel_hi:[1,0,1]
    v_pk_fma_f32 v[82:83], v[82:83], v[100:101], v[100:101] op_sel:[0,0,1] op_sel_hi:[1,0,1]
    v_pk_fma_f32 v[84:85], v[84:85], v[100:101], v[100:101] op_sel:[0,0,1] op_sel_hi:[1,0,1]
    v_pk_fma_f32 v[86:87], v[86:87], v[100:101], v[100:101] op_sel:[0,0,1] op_sel_hi:[1,0,1]
    v_cvt_pk_bf16_f32 v112, v80, v81
    v_cvt_pk_bf16_f32 v113, v82, v83
    v_cvt_pk_bf16_f32 v114, v84, v85
    v_cvt_pk_bf16_f32 v115, v86, v87
    v_add_f32_e64 v102, 1.0, v102
    v_pk_fma_f32 v[88:89], v[88:89], v[102:103], v[102:103] op_sel:[0,0,1] op_sel_hi:[1,0,1]
    v_pk_fma_f32 v[90:91], v[90:91], v[102:103], v[102:103] op_sel:[0,0,1] op_sel_hi:[1,0,1]
    v_pk_fma_f32 v[92:93], v[92:93], v[102:103], v[102:103] op_sel:[0,0,1] op_sel_hi:[1,0,1]
    v_pk_fma_f32 v[94:95], v[94:95], v[102:103], v[102:103] op_sel:[0,0,1] op_sel_hi:[1,0,1]
    v_cvt_pk_bf16_f32 v116, v88, v89
    v_cvt_pk_bf16_f32 v117, v90, v91
    v_cvt_pk_bf16_f32 v118, v92, v93
    v_cvt_pk_bf16_f32 v119, v94, v95
    s_barrier
    ds_read_b32 v17, v16
    s_waitcnt lgkmcnt(0)
    v_and_b32 v17, 0x7ff, v17
    v_sub_u32 v17, v17, v18
    s_barrier
    s_barrier
    s_mov_b32 s78, 0
    v_cmp_ne_u32_e64 vcc, 0, v17
    s_mov_b64 exec, vcc
    s_cbranch_execz Lo_49
    buffer_store_dwordx4 v[104:107], v19, s[44:47], s78 offen sc1
Lo_49:
    s_mov_b64 exec, -1
    s_mov_b32 s78, 16384
    v_cmp_ne_u32 vcc, 8, v17
    s_mov_b64 exec, vcc
    s_cbranch_execz Lo_50
    buffer_store_dwordx4 v[108:111], v19, s[44:47], s78 offen sc1
Lo_50:
    s_mov_b64 exec, -1
    s_mov_b32 s78, 32768
    v_cmp_ne_u32 vcc, 16, v17
    s_mov_b64 exec, vcc
    s_cbranch_execz Lo_51
    buffer_store_dwordx4 v[112:115], v19, s[44:47], s78 offen sc1
Lo_51:
    s_mov_b64 exec, -1
    s_mov_b32 s78, 49152
    v_cmp_ne_u32 vcc, 24, v17
    s_mov_b64 exec, vcc
    s_cbranch_execz Lo_52
    buffer_store_dwordx4 v[116:119], v19, s[44:47], s78 offen sc1
Lo_52:
    s_mov_b64 exec, -1
    s_branch L_fin
L_fin:
L_end:
    s_endpgm
.fill 64, 4, 0xbf800000
s_endpgm
.section .rodata,"a"
.p2align 6
.amdhsa_kernel sequential_preLN__linear_kernel_hedgehog__moe_arch_mod__prompt_kernel
  .amdhsa_next_free_vgpr 256
  .amdhsa_next_free_sgpr 102
  .amdhsa_accum_offset 256
  .amdhsa_group_segment_fixed_size 0
  .amdhsa_kernarg_size 96
  .amdhsa_user_sgpr_count 2
  .amdhsa_user_sgpr_kernarg_segment_ptr 1
  .amdhsa_system_sgpr_workgroup_id_x 1
  .amdhsa_float_denorm_mode_32 3
.end_amdhsa_kernel
```

```asm
; @launch grid=(256,1,1) block=(512,1,1) lds=163840
.amdgcn_target "amdgcn-amd-amdhsa--gfx950"
.text
.globl sequential_preLN__linear_kernel_hedgehog__moe_arch_mod__prompt_kernel
.p2align 8
.type sequential_preLN__linear_kernel_hedgehog__moe_arch_mod__prompt_kernel,@function
sequential_preLN__linear_kernel_hedgehog__moe_arch_mod__prompt_kernel:
    s_cmp_ge_u32 s2, 256
    s_cbranch_scc1 L_end
    s_load_dwordx16 s[4:19], s[0:1], 0
    s_load_dwordx8 s[20:27], s[0:1], 64
    v_lshrrev_b32 v1, 6, v0
    v_and_b32_e64 v2, 63, v0
    v_readfirstlane_b32 s68, v1
    s_lshr_b32 s69, s2, 4
    s_and_b32 s70, s2, 7
    s_lshl_b32 s70, s70, 1
    s_bfe_u32 s78, s2, 0x10003
    s_or_b32 s70, s70, s78
    s_and_b32 s76, s68, 3
    s_cmp_ge_u32 s68, 4
    s_cbranch_scc1 L_M
    v_lshrrev_b32 v196, 3, v2
    v_and_b32 v197, 7, v2
    v_lshrrev_b32_e64 v198, 4, v2
    s_and_b32 s80, s69, 0
    s_lshl_b32 s89, s76, 11
    s_lshl_b32 s66, s80, 10
    s_or_b32 s66, s66, s89
    s_xor_b32 s67, s66, 1024
    s_lshl_b32 s79, s70, 7
    s_movk_i32 s78, 6144
    v_mov_b32_e64 v199, s79
    v_mad_u32_u24 v199, v196, s78, v199
    s_lshl_b32 s80, s80, 2
    v_and_b32 v200, 2, v196
    v_xor_b32 v200, v200, v197
    v_xor_b32 v200, s80, v200
    v_lshl_add_u32 v199, v200, 4, v199
    s_mul_i32 s78, s66, 48
    s_mul_i32 s79, s67, 48
    v_add_u32 v6, s78, v199
    v_xor_b32 v199, 64, v199
    v_add_u32_e64 v7, s79, v199
    s_and_b32 s80, s70, 0
    s_lshl_b32 s88, s76, 12
    s_lshl_b32 s64, s80, 10
    s_or_b32 s64, s64, s88
    s_xor_b32 s65, s64, 1024
    s_lshl_b32 s80, s80, 2
    s_lshl_b32 s78, s69, 14
    s_add_u32 s78, s78, s64
    s_lshl_b32 s78, s78, 4
    v_lshl_add_u32 v199, v196, 11, s78
    v_xor_b32 v200, v198, v197
    v_xor_b32 v200, s80, v200
    v_lshl_add_u32 v4, v200, 4, v199
    v_xor_b32 v5, 16448, v4
    s_and_b32 s78, s70, 14
    s_and_b32 s79, s69, 14
    s_add_u32 s78, s78, s79
    s_sub_u32 s78, 32, s78
    s_and_b32 s78, s78, 15
    s_lshl_b32 s86, s78, 7
    s_mul_i32 s87, s78, 393216
    s_mov_b32 s30, 0x400000
    s_mov_b32 s31, 0x20000
    s_mov_b32 s34, 0x600000
    s_mov_b32 s35, 0x20000
    s_waitcnt lgkmcnt(0)
    s_mov_b32 s32, s6
    s_and_b32 s33, s7, 0xffff
    s_mov_b32 s28, s4
    s_and_b32 s29, s5, 0xffff
    s_add_u32 m0, s64, 118784
    s_nop 0
    buffer_load_dwordx4 v4, s[28:31], s86 offen offset:0  lds
    s_add_u32 m0, s66, 141312
    s_nop 0
    s_nop 0
    buffer_load_dwordx4 v6, s[32:35], s87 offen offset:2048  lds
    s_add_u32 m0, s64, 120832
    s_add_u32 s101, s86, 32768
    buffer_load_dwordx4 v4, s[28:31], s101 offen offset:0  lds
    s_add_u32 m0, s66, 151552
    s_add_u32 s101, s87, 4096
    buffer_load_dwordx4 v6, s[32:35], s101 offen offset:0  lds
    s_add_u32 m0, s66, 135168
    s_nop 0
    buffer_load_dwordx4 v6, s[32:35], s87 offen offset:0  lds
    s_add_u32 m0, s65, 118784
    s_nop 0
    buffer_load_dwordx4 v5, s[28:31], s86 offen offset:0  lds
    s_add_u32 m0, s67, 141312
    s_nop 0
    s_nop 0
    buffer_load_dwordx4 v7, s[32:35], s87 offen offset:2048  lds
    s_add_u32 m0, s65, 120832
    s_add_u32 s101, s86, 32768
    buffer_load_dwordx4 v5, s[28:31], s101 offen offset:0  lds
    s_add_u32 m0, s67, 151552
    s_add_u32 s101, s87, 4096
    buffer_load_dwordx4 v7, s[32:35], s101 offen offset:0  lds
    s_add_u32 m0, s67, 135168
    s_nop 0
    buffer_load_dwordx4 v7, s[32:35], s87 offen offset:0  lds
    s_add_u32 s86, s86, 128
    s_add_u32 s87, s87, 393216
    s_and_b32 s86, s86, 2047
    s_cselect_b32 s87, s87, 0
    s_mov_b32 s101, 40960
    s_cmp_ge_i32 s64, 0
    s_cselect_b32 s101, 0xfffec000, s101
    s_add_u32 s64, s64, s101
    s_add_u32 s65, s65, s101
    s_add_u32 s66, s66, s101
    s_add_u32 s67, s67, s101
    s_load_dword s75, s[26:27], 0
    s_mov_b32 s60, s8
    s_and_b32 s61, s9, 0xffff
    s_mov_b32 s62, 0x10000
    s_mov_b32 s63, 0x20000
    v_lshlrev_b32 v14, 4, v2
    s_lshl_b32 s78, s70, 12
    s_lshl_b32 s79, s76, 10
    s_add_u32 s78, s78, s79
    s_add_u32 m0, s79, 159744
    s_nop 0
    buffer_load_dwordx4 v14, s[60:63], s78 offen lds
    s_and_b32 s78, s2, 7
    s_lshr_b32 s79, s2, 3
    s_lshl_b32 s71, s78, 1
    s_and_b32 s72, s79, 1
    s_add_u32 s71, s71, s72
    s_lshr_b32 s72, s79, 1
    s_cmp_gt_u32 s70, 3
    s_cselect_b32 s78, 1, 0
    s_cmp_gt_u32 s70, 11
    s_cselect_b32 s78, 2, s78
    s_sub_u32 s78, s70, s78
    s_cmp_eq_u32 s70, 3
    s_cselect_b32 s78, 14, s78
    s_cmp_eq_u32 s70, 11
    s_cselect_b32 s78, 15, s78
    s_lshl_b32 s0, s78, 4
    s_add_u32 s0, s0, s69
    s_lshr_b32 s73, s0, 2
    s_and_b32 s74, s0, 3
    s_lshl_b32 s77, s70, 4
    s_add_u32 s77, s77, s69
    s_mov_b32 s36, s26
    s_and_b32 s37, s27, 0xffff
    s_mov_b32 s38, 0x10000000
    s_mov_b32 s39, 0x20000
    s_mov_b32 s40, s10
    s_and_b32 s41, s11, 0xffff
    s_mov_b32 s42, 0x200000
    s_mov_b32 s43, 0x20000
    s_mov_b32 s44, s22
    s_and_b32 s45, s23, 0xffff
    s_mov_b32 s46, 0x400000
    s_mov_b32 s47, 0x20000
    s_mov_b32 s48, s16
    s_and_b32 s49, s17, 0xffff
    s_mov_b32 s50, 0x700000
    s_mov_b32 s51, 0x20000
    s_mov_b32 s52, s18
    s_and_b32 s53, s19, 0xffff
    s_mov_b32 s54, 0x700000
    s_mov_b32 s55, 0x20000
    s_mov_b32 s56, s20
    s_and_b32 s57, s21, 0xffff
    s_mov_b32 s58, 0x700000
    s_mov_b32 s59, 0x20000
    v_mov_b32 v16, -1
    v_mov_b32 v17, -1
    v_mov_b32 v18, -1
    v_mov_b32_e64 v19, -1
    s_lshl_b32 s94, s77, 14
    s_lshl_b32 s78, s76, 12
    s_add_u32 s94, s94, s78
    s_add_u32 s94, s94, 4194304
    s_lshl_b32 s96, s77, 10
    s_add_u32 s96, s96, 8388608
    s_cmp_eq_u32 s76, 3
    s_cselect_b32 s96, s96, 0x10000000
    v_and_b32 v196, 15, v2
    v_lshrrev_b32 v197, 1, v196
    v_lshlrev_b32 v199, 7, v196
    v_add_u32 v199, s88, v199
    v_xor_b32_e64 v200, v198, v197
    v_lshl_add_u32 v60, v200, 4, v199
    v_bfe_u32 v196, v2, 2, 2
    v_and_b32_e64 v197, 3, v2
    v_lshl_add_u32 v199, v198, 3, v196
    v_lshlrev_b32_e64 v199, 7, v199
    v_lshl_add_u32 v199, v197, 3, v199
    v_lshrrev_b32 v196, 1, v196
    v_and_b32 v197, 1, v198
    v_lshl_add_u32 v196, v197, 1, v196
    s_mul_i32 s80, s76, 3
    s_add_u32 s78, s80, 0
    s_and_b32 s79, s78, 3
    s_lshr_b32 s78, s78, 2
    s_lshl_b32 s78, s78, 13
    s_add_u32 s78, s78, 16384
    v_xor_b32 v197, s79, v196
    v_lshl_add_u32 v197, v197, 5, v199
    v_add_u32_e64 v240, s78, v197
    s_add_u32 s78, s80, 1
    s_and_b32 s79, s78, 3
    s_lshr_b32 s78, s78, 2
    s_lshl_b32 s78, s78, 13
    s_add_u32 s78, s78, 16384
    v_xor_b32_e64 v197, s79, v196
    v_lshl_add_u32 v197, v197, 5, v199
    v_add_u32_e64 v241, s78, v197
    s_add_u32 s78, s80, 2
    s_and_b32 s79, s78, 3
    s_lshr_b32 s78, s78, 2
    s_lshl_b32 s78, s78, 13
    s_add_u32 s78, s78, 16384
    v_xor_b32_e64 v197, s79, v196
    v_lshl_add_u32 v197, v197, 5, v199
    v_add_u32 v242, s78, v197
    s_and_b32 s78, s70, 1
    s_lshl_b32 s78, s78, 6
    v_xor_b32 v60, s78, v60
    s_and_b32 s78, s69, 1
    s_lshl_b32 s78, s78, 12
    v_add_u32 v240, s78, v240
    v_add_u32 v241, s78, v241
    v_add_u32_e64 v242, s78, v242
    s_add_u32 m0, s64, 118784
    s_nop 0
    buffer_load_dwordx4 v4, s[28:31], s86 offen offset:0  lds
    v_lshrrev_b32 v196, 3, v2
    v_and_b32 v197, 7, v2
    v_lshlrev_b32 v199, 4, v197
    v_mul_u32_u24 v244, 57344, v196
    s_add_u32 m0, s66, 141312
    s_nop 0
    buffer_load_dwordx4 v6, s[32:35], s87 offen offset:2048  lds
    v_add_u32 v244, v244, v199
    v_lshl_add_u32 v245, v196, 14, v199
    s_lshl_b32 s78, s74, 2
    s_add_u32 s78, s78, s76
    s_add_u32 m0, s64, 120832
    s_add_u32 s101, s86, 32768
    buffer_load_dwordx4 v4, s[28:31], s101 offen offset:0  lds
    s_mul_i32 s79, s78, 458752
    s_add_u32 s80, s73, s76
    s_and_b32 s80, s80, 3
    s_andn2_b32 s100, s73, 3
    s_add_u32 m0, s66, 151552
    s_add_u32 s101, s87, 4096
    buffer_load_dwordx4 v6, s[32:35], s101 offen offset:0  lds
    s_or_b32 s80, s80, s100
    s_lshl_b32 s80, s80, 7
    s_add_u32 s79, s79, s80
    s_cmp_ge_u32 s73, 56
    s_cselect_b32 s79, 0x8000000, s79
    v_add_u32_e64 v244, s79, v244
    s_lshl_b32 s78, s78, 7
    s_add_u32 m0, s66, 135168
    s_nop 0
    buffer_load_dwordx4 v6, s[32:35], s87 offen offset:0  lds
    s_lshl_b32 s80, s73, 17
    s_add_u32 s78, s78, s80
    v_add_u32_e64 v245, s78, v245
    s_lshl_b32 s78, s72, 7
    s_add_u32 m0, s65, 118784
    s_nop 0
    buffer_load_dwordx4 v5, s[28:31], s86 offen offset:0  lds
    v_lshl_add_u32 v196, v196, 11, s78
    v_and_b32 v199, 1, v198
    v_lshlrev_b32 v199, 2, v199
    v_xor_b32 v199, v199, v197
    s_add_u32 m0, s67, 141312
    s_nop 0
    buffer_load_dwordx4 v7, s[32:35], s87 offen offset:2048  lds
    v_lshl_add_u32 v246, v199, 4, v196
    s_lshl_b32 s78, s71, 2
    s_add_u32 s78, s78, s76
    s_lshl_b32 s78, s78, 16
    v_add_u32_e64 v196, s78, v196
    s_add_u32 m0, s65, 120832
    s_add_u32 s101, s86, 32768
    buffer_load_dwordx4 v5, s[28:31], s101 offen offset:0  lds
    v_xor_b32_e64 v199, v198, v197
    v_lshl_add_u32 v247, v199, 4, v196
    v_xor_b32 v248, 64, v247
    s_lshl_b32 s78, s76, 14
    s_add_u32 m0, s67, 151552
    s_add_u32 s101, s87, 4096
    buffer_load_dwordx4 v7, s[32:35], s101 offen offset:0  lds
    v_add_u32 v246, s78, v246
    s_lshl_b32 s84, s76, 10
    s_bfe_u32 s78, s2, 0x40003
    s_lshl_b32 s78, s78, 17
    s_add_u32 m0, s67, 135168
    s_nop 0
    buffer_load_dwordx4 v7, s[32:35], s87 offen offset:0  lds
    s_add_u32 s86, s86, 128
    s_add_u32 s87, s87, 393216
    s_and_b32 s86, s86, 2047
    s_cselect_b32 s87, s87, 0
    s_mov_b32 s101, 40960
    s_cmp_ge_i32 s64, 0
    s_cselect_b32 s101, 0xfffec000, s101
    s_add_u32 s64, s64, s101
    s_add_u32 s65, s65, s101
    s_add_u32 s66, s66, s101
    s_add_u32 s67, s67, s101
    s_and_b32 s79, s72, 8
    s_add_u32 s79, s79, 3
    s_lshl_b32 s79, s79, 7
    s_add_u32 s78, s78, s79
    v_lshl_add_u32 v63, v2, 11, s78
    s_mul_i32 s100, s69, 52
    s_lshr_b32 s100, s100, 8
    s_mul_i32 s100, s100, 5
    s_sub_u32 s3, s69, s100
    s_branch L_sube
    .p2align 6
L_iss:
    s_add_u32 m0, s64, 118784
    s_nop 0
    buffer_load_dwordx4 v4, s[28:31], s86 offen offset:0  lds
    s_add_u32 m0, s66, 141312
    s_nop 0
    buffer_load_dwordx4 v6, s[32:35], s87 offen offset:2048  lds
    s_add_u32 m0, s64, 120832
    s_add_u32 s101, s86, 32768
    buffer_load_dwordx4 v4, s[28:31], s101 offen offset:0  lds
    s_add_u32 m0, s66, 151552
    s_add_u32 s101, s87, 4096
    buffer_load_dwordx4 v6, s[32:35], s101 offen offset:0  lds
    s_add_u32 m0, s66, 135168
    s_nop 0
    buffer_load_dwordx4 v6, s[32:35], s87 offen offset:0  lds
    s_add_u32 m0, s65, 118784
    s_nop 0
    buffer_load_dwordx4 v5, s[28:31], s86 offen offset:0  lds
    s_add_u32 m0, s67, 141312
    s_nop 0
    s_nop 0
    buffer_load_dwordx4 v7, s[32:35], s87 offen offset:2048  lds
    s_add_u32 m0, s65, 120832
    s_add_u32 s101, s86, 32768
    buffer_load_dwordx4 v5, s[28:31], s101 offen offset:0  lds
    s_add_u32 m0, s67, 151552
    s_add_u32 s101, s87, 4096
    buffer_load_dwordx4 v7, s[32:35], s101 offen offset:0  lds
    s_add_u32 m0, s67, 135168
    s_nop 0
    buffer_load_dwordx4 v7, s[32:35], s87 offen offset:0  lds
    s_add_u32 s86, s86, 128
    s_add_u32 s87, s87, 393216
    s_and_b32 s86, s86, 2047
    s_cselect_b32 s87, s87, 0
    s_mov_b32 s101, 40960
    s_cmp_ge_i32 s64, 0
    s_cselect_b32 s101, 0xfffec000, s101
    s_add_u32 s64, s64, s101
    s_add_u32 s65, s65, s101
    s_add_u32 s66, s66, s101
    s_add_u32 s67, s67, s101
    s_setpc_b64 s[90:91]
    .p2align 6
L_cl0:
    s_mov_b32 s100, 0
    buffer_load_dwordx4 v[64:67], v244, s[48:51], s100 offen nt
    s_mov_b32 s100, 0
    buffer_load_dwordx4 v[96:99], v244, s[52:55], s100 offen nt
    s_mov_b32 s100, 7168
    buffer_load_dwordx4 v[68:71], v244, s[48:51], s100 offen nt
    s_mov_b32 s100, 7168
    buffer_load_dwordx4 v[100:103], v244, s[52:55], s100 offen nt
    s_mov_b32 s100, 14336
    buffer_load_dwordx4 v[72:75], v244, s[48:51], s100 offen nt
    s_mov_b32 s100, 14336
    buffer_load_dwordx4 v[104:107], v244, s[52:55], s100 offen nt
    s_setpc_b64 s[90:91]
    .p2align 6
L_cl1:
    s_mov_b32 s100, 21504
    buffer_load_dwordx4 v[76:79], v244, s[48:51], s100 offen nt
    s_mov_b32 s100, 21504
    buffer_load_dwordx4 v[108:111], v244, s[52:55], s100 offen nt
    s_mov_b32 s100, 28672
    buffer_load_dwordx4 v[80:83], v244, s[48:51], s100 offen nt
    s_mov_b32 s100, 28672
    buffer_load_dwordx4 v[112:115], v244, s[52:55], s100 offen nt
    s_mov_b32 s100, 35840
    buffer_load_dwordx4 v[84:87], v244, s[48:51], s100 offen nt
    s_mov_b32 s100, 35840
    buffer_load_dwordx4 v[116:119], v244, s[52:55], s100 offen nt
    s_setpc_b64 s[90:91]
    .p2align 12
L_sube:
    s_waitcnt vmcnt(10)
    s_barrier
    s_call_b64 s[90:91], L_iss
    s_setprio 2
    v_add_u32 v196, 118784, v60
    v_add_u32 v198, 118784, v240
    v_add_u32 v199, 118784, v241
    v_add_u32 v200, 118784, v242
    ds_read_b128 v[20:23], v196 offset:0
    ds_read_b128 v[24:27], v196 offset:2048
    ds_read_b64_tr_b16 v[36:37], v198 offset:0
    ds_read_b64_tr_b16 v[38:39], v198 offset:512
    ds_read_b64_tr_b16 v[44:45], v199 offset:0
    ds_read_b64_tr_b16 v[46:47], v199 offset:512
    ds_read_b64_tr_b16 v[52:53], v200 offset:0
    ds_read_b64_tr_b16 v[54:55], v200 offset:512
    s_setprio 0
    s_waitcnt lgkmcnt(0)
    s_mul_i32 s75, s75, 0x9E3779B1
    s_add_u32 s75, s75, 0x7F4A7C15
    s_waitcnt vmcnt(10)
    s_waitcnt lgkmcnt(0)
    s_barrier
    s_call_b64 s[90:91], L_iss
    s_setprio 2
    s_nop 0
    v_add_u32 v196, 36864, v60
    v_add_u32 v198, 36864, v240
    v_add_u32 v199, 36864, v241
    v_add_u32 v200, 36864, v242
    ds_read_b128 v[28:31], v196 offset:0
    ds_read_b128 v[32:35], v196 offset:2048
    ds_read_b64_tr_b16 v[40:41], v198 offset:0
    ds_read_b64_tr_b16 v[42:43], v198 offset:512
    ds_read_b64_tr_b16 v[48:49], v199 offset:0
    ds_read_b64_tr_b16 v[50:51], v199 offset:512
    ds_read_b64_tr_b16 v[56:57], v200 offset:0
    ds_read_b64_tr_b16 v[58:59], v200 offset:512
    s_setprio 0
    s_getreg_b32 s99, hwreg(HW_REG_XCC_ID, 0, 4)
    v_mov_b32 v10, s75
    v_mov_b32 v11, s99
    v_not_b32 v12, v10
    v_mov_b32 v13, 0
    v_and_b32 v8, 15, v2
    v_lshlrev_b32 v9, 4, v8
    v_add_u32_e64 v9, s69, v9
    s_lshl_b32 s78, s70, 4
    s_lshl_b32 s79, s71, 4
    s_add_u32 s79, s79, 69088
    v_mov_b32 v202, s78
    v_mov_b32 v203, s79
    v_cmp_gt_u32 vcc, 32, v2
    s_nop 1
    v_cndmask_b32 v202, v203, v202, vcc
    v_add_u32 v8, v202, v8
    v_cmp_gt_u32 vcc, 16, v2
    s_nop 1
    v_cndmask_b32 v8, v8, v9, vcc
    v_lshlrev_b32 v8, 7, v8
    v_add_u32 v8, 4096, v8
    v_lshlrev_b32 v9, 3, v2
    s_lshl_b32 s82, s77, 7
    s_add_u32 s82, s82, 4096
    s_lshl_b32 s79, s71, 4
    s_add_u32 s79, s79, s72
    s_lshl_b32 s79, s79, 7
    s_add_u32 s79, s79, 8847360
    s_cmp_eq_u32 s76, 1
    s_cselect_b32 s82, s79, s82
    s_cmp_gt_u32 s76, 1
    s_cselect_b32 s82, 0x10000000, s82
    s_lshl_b32 s83, s77, 9
    s_add_u32 s83, s83, 8912896
    s_cmp_eq_u32 s76, 2
    s_cselect_b32 s83, s83, 0x10000000
    buffer_store_dwordx2 v[12:13], v9, s[36:39], s83 offen sc1
    s_waitcnt vmcnt(11)
    s_waitcnt lgkmcnt(0)
    s_barrier
    s_call_b64 s[90:91], L_iss
    s_waitcnt vmcnt(11)
    s_cmp_lg_u32 s3, 0
    s_cbranch_scc1 Lcs_1
    s_call_b64 s[90:91], L_cl0
Lcs_1:
    s_barrier
    s_setprio 2
    s_add_u32 m0, s64, 118784
    s_nop 0
    s_nop 0
    buffer_load_dwordx4 v4, s[28:31], s86 offen offset:0  lds
    v_mov_b32 v200, 0x3f803f80
    v_mov_b32 v201, 0x3f803f80
    v_mov_b32 v202, 0x3f803f80
    v_mov_b32 v203, 0x3f803f80
    s_add_u32 m0, s66, 141312
    s_nop 0
    s_nop 0
    buffer_load_dwordx4 v6, s[32:35], s87 offen offset:2048  lds
    v_mfma_f32_16x16x32_bf16 v[204:207], v[200:203], v[20:23], 0
    v_mfma_f32_16x16x32_bf16 v[212:215], v[20:23], v[20:23], 0
    v_mfma_f32_16x16x32_bf16 v[208:211], v[200:203], v[24:27], 0
    v_mfma_f32_16x16x32_bf16 v[216:219], v[24:27], v[24:27], 0
    s_add_u32 m0, s64, 120832
    s_add_u32 s101, s86, 32768
    buffer_load_dwordx4 v4, s[28:31], s101 offen offset:0  lds
    v_mfma_f32_16x16x32_bf16 v[220:223], v[200:203], v[36:39], 0
    v_mfma_f32_16x16x32_bf16 v[224:227], v[200:203], v[44:47], 0
    v_mfma_f32_16x16x32_bf16 v[228:231], v[200:203], v[52:55], 0
    v_mfma_f32_16x16x32_bf16 v[204:207], v[200:203], v[28:31], v[204:207]
    v_mfma_f32_16x16x32_bf16 v[212:215], v[28:31], v[28:31], v[212:215]
    s_add_u32 m0, s66, 151552
    s_add_u32 s101, s87, 4096
    buffer_load_dwordx4 v6, s[32:35], s101 offen offset:0  lds
    v_mfma_f32_16x16x32_bf16 v[208:211], v[200:203], v[32:35], v[208:211]
    v_mfma_f32_16x16x32_bf16 v[216:219], v[32:35], v[32:35], v[216:219]
    v_mfma_f32_16x16x32_bf16 v[220:223], v[200:203], v[40:43], v[220:223]
    v_mfma_f32_16x16x32_bf16 v[224:227], v[200:203], v[48:51], v[224:227]
    s_add_u32 m0, s66, 135168
    s_nop 0
    buffer_load_dwordx4 v6, s[32:35], s87 offen offset:0  lds
    v_mfma_f32_16x16x32_bf16 v[228:231], v[200:203], v[56:59], v[228:231]
    v_and_b32 v196, 3, v2
    v_cmp_eq_u32 s[90:91], 1, v196
    v_cmp_eq_u32 s[92:93], 2, v196
    v_cmp_eq_u32_e64 vcc, 3, v196
    s_add_u32 m0, s65, 118784
    s_nop 0
    buffer_load_dwordx4 v5, s[28:31], s86 offen offset:0  lds
    v_cndmask_b32 v212, v212, v213, s[90:91]
    v_cndmask_b32 v212, v212, v214, s[92:93]
    v_cndmask_b32 v205, v212, v215, vcc
    v_cndmask_b32 v216, v216, v217, s[90:91]
    s_add_u32 m0, s67, 141312
    s_nop 0
    buffer_load_dwordx4 v7, s[32:35], s87 offen offset:2048  lds
    v_cndmask_b32 v216, v216, v218, s[92:93]
    v_cndmask_b32 v209, v216, v219, vcc
    v_lshrrev_b32_e64 v196, 4, v2
    v_cmp_eq_u32 s[90:91], 1, v196
    v_cmp_eq_u32_e64 vcc, 2, v196
    s_add_u32 m0, s65, 120832
    s_add_u32 s101, s86, 32768
    buffer_load_dwordx4 v5, s[28:31], s101 offen offset:0  lds
    v_cndmask_b32 v220, v220, v224, s[90:91]
    v_cndmask_b32_e64 v220, v220, v228, vcc
    s_mul_i32 s78, s77, 768
    s_mul_i32 s79, s76, 192
    s_add_u32 m0, s67, 151552
    s_add_u32 s101, s87, 4096
    buffer_load_dwordx4 v7, s[32:35], s101 offen offset:0  lds
    s_add_u32 s78, s78, s79
    s_add_u32 s78, s78, 327680
    v_lshlrev_b32 v197, 2, v2
    s_mov_b32 exec_hi, 0xffff
    buffer_store_dword v220, v197, s[36:39], s78 offen sc1
    s_mov_b32 exec_hi, -1
    s_lshl_b32 s78, s69, 4
    s_add_u32 m0, s67, 135168
    s_nop 0
    buffer_load_dwordx4 v7, s[32:35], s87 offen offset:0  lds
    s_add_u32 s86, s86, 128
    s_add_u32 s87, s87, 393216
    s_and_b32 s86, s86, 2047
    s_cselect_b32 s87, s87, 0
    s_mov_b32 s101, 40960
    s_cmp_ge_i32 s64, 0
    s_cselect_b32 s101, 0xfffec000, s101
    s_add_u32 s64, s64, s101
    s_add_u32 s65, s65, s101
    s_add_u32 s66, s66, s101
    s_add_u32 s67, s67, s101
    s_add_u32 s78, s78, s70
    s_lshl_b32 s78, s78, 10
    s_lshl_b32 s79, s76, 8
    s_add_u32 s78, s78, s79
    buffer_store_dwordx4 v[16:19], v14, s[36:39], s96 offen offset:0 sc1
    s_add_u32 s78, s78, 65536
    v_and_b32 v198, 15, v2
    v_lshlrev_b32_e64 v198, 3, v198
    s_mov_b32 exec_lo, 0x00f0000f
    s_mov_b32 exec_hi, 0xf0000f00
    buffer_store_dwordx2 v[204:205], v198, s[36:39], s78 offen offset:0 sc1
    s_mov_b64 exec, -1
    s_mov_b32 exec_lo, 0x00f0000f
    s_mov_b32 exec_hi, 0xf0000f00
    buffer_store_dwordx2 v[208:209], v198, s[36:39], s78 offen offset:128 sc1
    s_mov_b64 exec, -1
    s_setprio 0
    s_waitcnt vmcnt(14)
    s_cmp_lg_u32 s3, 1
    s_cbranch_scc1 Lcs_2
    s_call_b64 s[90:91], L_cl0
Lcs_2:
    s_barrier
    s_call_b64 s[90:91], L_iss
    s_waitcnt vmcnt(10)
    s_cmp_lg_u32 s3, 2
    s_cbranch_scc1 Lcs_3
    s_call_b64 s[90:91], L_cl0
Lcs_3:
    s_barrier
    s_mov_b64 exec, 0xffff
    buffer_store_dwordx2 v[10:11], v9, s[36:39], s82 offen sc1
    s_mov_b64 exec, -1
    s_call_b64 s[90:91], L_iss
    s_waitcnt vmcnt(11)
    s_cmp_lg_u32 s3, 3
    s_cbranch_scc1 Lcs_4
    s_call_b64 s[90:91], L_cl0
Lcs_4:
    s_barrier
    s_call_b64 s[90:91], L_iss
    s_waitcnt vmcnt(10)
    s_cmp_lg_u32 s3, 4
    s_cbranch_scc1 Lcs_5
    s_call_b64 s[90:91], L_cl0
Lcs_5:
    s_barrier
    s_call_b64 s[90:91], L_iss
    s_waitcnt vmcnt(10)
    s_cmp_lg_u32 s3, 0
    s_cbranch_scc1 Lcs_6
    s_call_b64 s[90:91], L_cl1
Lcs_6:
    s_barrier
    s_call_b64 s[90:91], L_iss
    s_waitcnt vmcnt(10)
    s_cmp_lg_u32 s3, 1
    s_cbranch_scc1 Lcs_7
    s_call_b64 s[90:91], L_cl1
Lcs_7:
    s_barrier
    s_call_b64 s[90:91], L_iss
    s_waitcnt vmcnt(10)
    s_cmp_lg_u32 s3, 2
    s_cbranch_scc1 Lcs_8
    s_call_b64 s[90:91], L_cl1
Lcs_8:
    s_barrier
    s_call_b64 s[90:91], L_iss
    s_waitcnt vmcnt(10)
    s_cmp_lg_u32 s3, 3
    s_cbranch_scc1 Lcs_9
    s_call_b64 s[90:91], L_cl1
Lcs_9:
    s_barrier
    s_call_b64 s[90:91], L_iss
    s_waitcnt vmcnt(10)
    s_cmp_lg_u32 s3, 4
    s_cbranch_scc1 Lcs_10
    s_call_b64 s[90:91], L_cl1
Lcs_10:
    s_barrier
    s_cmp_lg_u32 s76, 0
    s_cbranch_scc1 Lpl_11
    s_mov_b32 exec_hi, 0xffff
    buffer_load_dwordx2 v[10:11], v8, s[36:39], 0 offen sc1
    s_mov_b64 exec, -1
Lpl_11:
    s_call_b64 s[90:91], L_iss
    s_cmp_lg_u32 s76, 1
    s_cbranch_scc1 Lpf_12
    s_getpc_b64 s[90:91]
Lpc_13:
    s_add_u32 s90, s90, L_phend-Lpc_13
    s_addc_u32 s91, s91, 0
    s_lshr_b32 s100, s2, 3
    s_lshl_b32 s100, s100, 10
    s_min_u32 s100, s100, (L_end-L_phend-768)
    v_add_u32 v236, s100, v14
    global_load_dword v236, v236, s[90:91]
Lpf_12:
    s_waitcnt vmcnt(10)
    s_barrier
    s_cmp_lg_u32 s76, 2
    s_cbranch_scc1 Lc4_14
    s_mov_b32 exec_hi, -1
    buffer_load_dword v238, v63, s[40:43], 0 offen
    s_mov_b64 exec, -1
Lc4_14:
    s_call_b64 s[90:91], L_iss
    s_waitcnt vmcnt(10)
    s_cmp_lg_u32 s76, 0
    s_cbranch_scc1 Lpc_15
    s_setprio 2
    s_mov_b32 exec_hi, 0xffff
    s_mov_b32 s85, 0
    s_branch Lpk_16
Lspin_17:
    s_add_u32 s85, s85, 1
    s_cmp_gt_u32 s85, 400000
    s_cbranch_scc1 L_end
    buffer_load_dwordx2 v[10:11], v8, s[36:39], 0 offen sc1
    s_waitcnt vmcnt(0)
Lpk_16:
    v_cmp_ne_u32 vcc, s75, v10
    s_cbranch_vccnz Lspin_17
    v_cmp_ne_u32 vcc, s99, v11
    s_mov_b64 exec, -1
    s_lshr_b32 s78, vcc_lo, 16
    s_cselect_b32 s78, 0, 1
    s_cmp_eq_u32 vcc_hi, 0
    s_cselect_b32 s79, 2, 0
    s_or_b32 s78, s78, s79
    s_and_b32 s78, s78, 3
    v_mov_b32_e64 v10, s78
    v_mov_b32 v11, 163584
    ds_write_b32 v11, v10
    s_setprio 0
Lpc_15:
    s_barrier
    v_lshrrev_b32 v196, 4, v2
    v_and_b32 v197, 15, v2
    v_lshlrev_b32_e64 v197, 4, v197
    v_lshl_add_u32 v198, v196, 10, v197
    s_lshl_b32 s78, s69, 14
    s_lshl_b32 s79, s76, 8
    s_add_u32 s78, s78, s79
    s_nop 0
    s_add_u32 s78, s78, 65536
    buffer_load_dwordx4 v[20:23], v198, s[36:39], s78 offen sc1
    s_add_u32 s78, s78, 4096
    buffer_load_dwordx4 v[24:27], v198, s[36:39], s78 offen sc1
    s_add_u32 s78, s78, 4096
    buffer_load_dwordx4 v[28:31], v198, s[36:39], s78 offen sc1
    s_add_u32 s78, s78, 4096
    buffer_load_dwordx4 v[32:35], v198, s[36:39], s78 offen sc1
    v_mul_u32_u24 v198, 768, v196
    v_add_u32_e64 v198, v198, v197
    s_mul_i32 s78, s70, 12288
    s_lshl_b32 s79, s76, 8
    s_add_u32 s78, s78, s79
    s_add_u32 s78, s78, 327680
    s_cmp_eq_u32 s76, 3
    s_nop 0
    s_cselect_b32 s78, 0x10000000, s78
    buffer_load_dwordx4 v[36:39], v198, s[36:39], s78 offen sc1
    s_add_u32 s78, s78, 3072
    buffer_load_dwordx4 v[40:43], v198, s[36:39], s78 offen sc1
    s_add_u32 s78, s78, 3072
    buffer_load_dwordx4 v[44:47], v198, s[36:39], s78 offen sc1
    s_add_u32 s78, s78, 3072
    buffer_load_dwordx4 v[48:51], v198, s[36:39], s78 offen sc1
    s_add_u32 m0, s84, 0
    s_mov_b32 s100, 0
    buffer_load_dwordx4 v246, s[40:43], s100 offen  lds
    s_add_u32 m0, s84, 4096
    s_mov_b32 s100, 65536
    buffer_load_dwordx4 v246, s[40:43], s100 offen  lds
    s_add_u32 m0, s84, 8192
    s_mov_b32 s100, 131072
    buffer_load_dwordx4 v246, s[40:43], s100 offen  lds
    s_add_u32 m0, s84, 12288
    s_mov_b32 s100, 196608
    buffer_load_dwordx4 v246, s[40:43], s100 offen  lds
    s_waitcnt vmcnt(12)
    s_barrier
    s_setprio 2
    s_add_u32 m0, s84, 16384
    s_mov_b32 s100, 262144
    buffer_load_dwordx4 v246, s[40:43], s100 offen  lds
    s_waitcnt vmcnt(9)
    v_add_f32 v20, v20, v24
    v_add_f32 v21, v21, v25
    v_add_f32 v22, v22, v26
    v_add_f32 v23, v23, v27
    v_add_f32 v20, v20, v28
    v_add_f32 v21, v21, v29
    s_add_u32 m0, s84, 20480
L_pad0:
    s_cbranch_execz L_pad4
    s_mov_b32 s100, 327680
    buffer_load_dwordx4 v246, s[40:43], s100 offen  lds
    v_add_f32 v22, v22, v30
    v_add_f32 v23, v23, v31
    v_add_f32 v20, v20, v32
    v_add_f32 v21, v21, v33
    v_add_f32 v22, v22, v34
    v_add_f32 v23, v23, v35
    s_nop 0
    v_permlane32_swap_b32_e64 v20, v22
    s_add_u32 m0, s84, 24576
    s_mov_b32 s100, 393216
    buffer_load_dwordx4 v246, s[40:43], s100 offen  lds
    v_permlane32_swap_b32 v21, v23
    v_add_f32 v20, v20, v22
    v_add_f32 v21, v21, v23
    v_mov_b32 v22, v20
    v_mov_b32 v23, v21
    s_nop 0
    v_permlane16_swap_b32 v20, v22
    v_permlane16_swap_b32 v21, v23
    v_add_f32_e64 v20, v20, v22
    s_add_u32 m0, s84, 28672
    s_mov_b32 s100, 458752
    buffer_load_dwordx4 v246, s[40:43], s100 offen  lds
    v_add_f32_e64 v21, v21, v23
    v_mul_f32 v24, 0x3a800000, v20
    v_mul_f32 v26, 0x3a800000, v21
    v_fma_f32 v26, -v24, v24, v26
    v_max_f32_e64 v26, 0, v26
    v_cvt_pk_bf16_f32 v24, v24, v24
    v_and_b32 v24, 0xffff0000, v24
    s_add_u32 m0, s84, 32768
    s_mov_b32 s100, 524288
    buffer_load_dwordx4 v246, s[40:43], s100 offen  lds
    v_cvt_pk_bf16_f32 v26, v26, v26
    v_and_b32 v26, 0xffff0000, v26
    v_add_f32 v26, 0x3727c5ac, v26
    v_cvt_pk_bf16_f32 v26, v26, v26
    v_and_b32 v26, 0xffff0000, v26
    v_sqrt_f32 v26, v26
    s_nop 0
    v_cvt_pk_bf16_f32 v26, v26, v26
    v_and_b32 v26, 0xffff0000, v26
    s_add_u32 m0, s84, 36864
    s_mov_b32 s100, 589824
    buffer_load_dwordx4 v246, s[40:43], s100 offen  lds
    v_rcp_f32_e64 v25, v26
    v_xor_b32 v26, 0x80000000, v24
    v_lshrrev_b32 v27, 16, v26
    v_or_b32 v26, v26, v27
    v_mov_b32 v27, 0
    v_and_b32 v196, 15, v2
    v_lshrrev_b32_e64 v197, 5, v2
    s_add_u32 m0, s84, 40960
    s_mov_b32 s100, 655360
    buffer_load_dwordx4 v246, s[40:43], s100 offen  lds
    v_lshl_add_u32 v196, v196, 1, v197
    s_lshl_b32 s78, s76, 5
    v_add_u32 v196, s78, v196
    v_lshlrev_b32_e64 v197, 3, v196
    v_add_u32 v197, 159744, v197
    v_lshlrev_b32_e64 v196, 2, v196
    v_add_u32 v196, 162304, v196
    s_add_u32 m0, s84, 45056
    s_mov_b32 s100, 720896
    buffer_load_dwordx4 v246, s[40:43], s100 offen  lds
    ds_write_b64 v197, v[26:27]
    ds_write_b32 v196, v25
    s_waitcnt vmcnt(12)
    v_add_f32 v36, v36, v40
    v_add_f32 v37, v37, v41
    v_add_f32 v38, v38, v42
    v_add_f32 v39, v39, v43
    v_add_f32 v36, v36, v44
    s_add_u32 m0, s84, 49152
    s_mov_b32 s100, 786432
    buffer_load_dwordx4 v246, s[40:43], s100 offen  lds
    v_add_f32 v37, v37, v45
    v_add_f32 v38, v38, v46
    v_add_f32 v39, v39, v47
    v_add_f32 v36, v36, v48
    v_add_f32 v37, v37, v49
    v_add_f32 v38, v38, v50
    v_add_f32_e64 v39, v39, v51
    s_add_u32 m0, s84, 53248
    s_mov_b32 s100, 851968
    buffer_load_dwordx4 v246, s[40:43], s100 offen  lds
    v_permlane32_swap_b32 v36, v38
    v_permlane32_swap_b32 v37, v39
    v_add_f32 v36, v36, v38
    v_add_f32 v37, v37, v39
    s_nop 1
    v_permlane16_swap_b32 v36, v37
    v_add_f32_e64 v36, v36, v37
    v_cvt_pk_bf16_f32 v37, v36, v36
    v_and_b32 v37, 0xffff0000, v37
    s_add_u32 m0, s84, 57344
    s_mov_b32 s100, 917504
    buffer_load_dwordx4 v246, s[40:43], s100 offen  lds
    v_sub_f32_e64 v38, v36, v37
    v_cvt_pk_bf16_f32 v38, v37, v38
    v_mov_b32 v39, 0
    v_and_b32 v196, 15, v2
    v_lshrrev_b32_e64 v197, 4, v2
    v_lshl_add_u32 v196, v196, 2, v197
    s_lshl_b32 s78, s76, 9
    s_add_u32 m0, s84, 61440
    s_mov_b32 s100, 983040
    buffer_load_dwordx4 v246, s[40:43], s100 offen  lds
    s_add_u32 s78, s78, 160768
    v_lshl_add_u32 v196, v196, 3, s78
    v_and_b32 v197, 15, v2
    v_lshlrev_b32_e64 v197, 3, v197
    v_add_u32 v197, 162816, v197
    v_mov_b32 v198, 0x3f803f80
    s_cmp_eq_u32 s76, 3
    s_cselect_b64 vcc, -1, 0
    v_cndmask_b32 v196, v196, v197, vcc
    v_cndmask_b32 v38, v38, v198, vcc
    v_cndmask_b32_e64 v39, v39, v198, vcc
    ds_write_b64 v196, v[38:39]
    s_setprio 0
    s_waitcnt lgkmcnt(0)
    s_barrier
L_phend:
    s_mov_b32 s66, s96
    s_add_u32 m0, s84, 65536
    s_mov_b32 s100, 1048576
    buffer_load_dwordx4 v246, s[40:43], s100 offen  lds
    v_lshrrev_b32 v52, 2, v2
    v_and_b32 v53, 7, v52
    v_and_b32_e64 v55, 3, v2
    s_add_u32 m0, s84, 69632
    s_mov_b32 s100, 1114112
    buffer_load_dwordx4 v246, s[40:43], s100 offen  lds
    v_xor_b32 v53, v53, v55
    v_lshlrev_b32 v52, 7, v52
    v_lshrrev_b32_e64 v55, 1, v55
    s_add_u32 m0, s84, 73728
    s_mov_b32 s100, 1179648
    buffer_load_dwordx4 v246, s[40:43], s100 offen  lds
    v_lshl_add_u32 v52, v55, 3, v52
    s_lshr_b32 s78, s76, 1
    s_and_b32 s79, s76, 1
    s_lshl_b32 s80, s79, 2
    s_add_u32 m0, s84, 77824
    s_mov_b32 s100, 1245184
    buffer_load_dwordx4 v246, s[40:43], s100 offen  lds
    s_lshl_b32 s81, s78, 2
    v_xor_b32 v55, s80, v53
    v_xor_b32 v53, s81, v53
    s_add_u32 m0, s84, 81920
    s_mov_b32 s100, 1310720
    buffer_load_dwordx4 v246, s[40:43], s100 offen  lds
    s_lshl_b32 s80, s78, 14
    s_add_u32 s80, s80, 110592
    v_lshl_add_u32 v196, v55, 4, v52
    v_add_u32 v196, s80, v196
    s_add_u32 m0, s84, 86016
    s_mov_b32 s100, 1376256
    buffer_load_dwordx4 v246, s[40:43], s100 offen  lds
    v_lshl_add_u32 v198, v53, 4, v52
    v_add_u32 v198, 143360, v198
    v_xor_b32_e64 v197, 8, v196
    s_add_u32 m0, s84, 90112
    s_mov_b32 s100, 1441792
    buffer_load_dwordx4 v246, s[40:43], s100 offen  lds
    v_xor_b32_e64 v199, 8, v198
    v_mov_b32 v200, 0x3f803f80
    v_mov_b32 v201, 0x3f803f80
    v_mov_b32 v202, 0x3f803f80
    s_add_u32 m0, s84, 94208
    s_mov_b32 s100, 1507328
    buffer_load_dwordx4 v246, s[40:43], s100 offen  lds
    v_mov_b32 v203, 0x3f803f80
    v_lshrrev_b32 v62, 4, v2
    v_and_b32 v52, 15, v2
    s_add_u32 m0, s84, 98304
    s_mov_b32 s100, 1572864
    buffer_load_dwordx4 v246, s[40:43], s100 offen  lds
    v_lshlrev_b32_e64 v53, 4, v52
    v_lshl_add_u32 v62, v62, 13, v53
    v_lshrrev_b32_e64 v52, 3, v52
    v_lshl_add_u32 v62, v52, 8, v62
    s_add_u32 m0, s84, 102400
    s_mov_b32 s100, 1638400
    buffer_load_dwordx4 v246, s[40:43], s100 offen  lds
    v_xor_b32 v63, 256, v62
    s_lshl_b32 s78, s70, 2
    s_add_u32 s78, s78, s76
    s_add_u32 m0, s84, 106496
    s_mov_b32 s100, 1703936
    buffer_load_dwordx4 v246, s[40:43], s100 offen  lds
    s_lshl_b32 s78, s78, 15
    s_lshl_b32 s79, s69, 9
    s_add_u32 s78, s78, s79
    s_add_u32 s78, s78, 2097152
    s_mov_b32 s100, 2031616
    buffer_load_dwordx4 v[160:163], v246, s[40:43], s100 offen
    s_lshl_b32 s79, s77, 10
    s_lshl_b32 s80, s76, 6
    s_add_u32 s79, s79, s80
    s_mov_b32 s100, 1966080
    buffer_load_dwordx4 v[164:167], v246, s[40:43], s100 offen
    s_add_u32 s79, s79, 8389120
    v_lshrrev_b32 v52, 3, v2
    v_and_b32 v53, 7, v2
    v_lshlrev_b32_e64 v53, 4, v53
    s_mov_b32 s100, 1900544
    buffer_load_dwordx4 v[168:171], v246, s[40:43], s100 offen
    v_lshl_add_u32 v56, v52, 9, v53
    v_lshl_add_u32 v57, v52, 1, v53
    s_lshl_b32 s82, s70, 14
    s_mov_b32 s100, 1835008
    buffer_load_dwordx4 v[172:175], v246, s[40:43], s100 offen
    s_add_u32 s82, s82, s80
    s_add_u32 s82, s82, 8389120
    s_add_u32 s80, s80, 162944
    v_lshrrev_b32_e64 v58, 2, v2
    s_mov_b32 s100, 1769472
    buffer_load_dwordx4 v[176:179], v246, s[40:43], s100 offen
    v_and_b32 v53, 3, v2
    v_lshlrev_b32 v53, 4, v53
    v_lshl_add_u32 v58, v58, 10, v53
    s_mov_b32 s100, 0
    buffer_load_dwordx4 v[180:183], v247, s[28:31], s100 offen
    v_lshl_add_u32 v59, v52, 1, v53
    v_add_u32 v59, s80, v59
    s_lshl_b32 s64, s77, 13
    s_lshl_b32 s80, s76, 7
    s_mov_b32 s100, 16384
    buffer_load_dwordx4 v[184:187], v248, s[28:31], s100 offen
    s_add_u32 s64, s64, s80
    s_add_u32 s64, s64, 2097152
    s_add_u32 s65, s64, 4096
    s_mov_b32 s100, 32768
    buffer_load_dwordx4 v[188:191], v247, s[28:31], s100 offen
    s_lshl_b32 s81, s77, 10
    s_add_u32 s81, s81, s80
    s_add_u32 s81, s81, 8388608
    s_lshl_b32 s80, s71, 9
    s_mov_b32 s100, 49152
    buffer_load_dwordx4 v[192:195], v248, s[28:31], s100 offen
    s_add_u32 s80, s80, 8912896
    v_lshl_add_u32 v61, v2, 13, s80
    v_mov_b32 v52, 163584
    s_lshl_b32 s100, s77, 13
    s_add_u32 s100, s100, s89
    s_add_u32 s100, s100, 2097152
    buffer_load_dwordx4 v[252:255], v14, s[36:39], s100 offen offset:0 sc1
    ds_read_b32 v52, v52
    s_waitcnt lgkmcnt(0)
    v_readfirstlane_b32 s99, v52
    s_and_b32 s94, s69, 1
    s_lshl_b32 s100, s77, 13
    s_add_u32 s100, s100, s89
    s_nop 0
    s_add_u32 s100, s100, 2097152
    buffer_load_dwordx4 v[252:255], v14, s[36:39], s100 offen offset:1024 sc1
    s_mul_i32 s94, s94, 0x00010001
    s_mov_b32 s95, 0xfffefffe
    s_and_b32 s96, s75, 0x00010001
    buffer_load_dwordx4 v[252:255], v14, s[36:39], s66 offen sc1
    v_mov_b32_e64 v54, s96
    s_and_b32 s83, s75, 1
    s_lshl_b32 s83, s83, 16
    s_sub_u32 s83, 0, s83
    s_barrier
    ds_read_b64_tr_b16 v[4:5], v196 offset:0
    ds_read_b64_tr_b16 v[6:7], v196 offset:2048
    ds_read_b64_tr_b16 v[12:13], v198 offset:0
    ds_read_b64_tr_b16 v[14:15], v198 offset:2048
    ds_read_b64_tr_b16 v[8:9], v197 offset:0
    ds_read_b64_tr_b16 v[10:11], v197 offset:2048
    ds_read_b64_tr_b16 v[16:17], v199 offset:0
    ds_read_b64_tr_b16 v[18:19], v199 offset:2048
    ds_read_b64_tr_b16 v[20:21], v196 offset:4096
    ds_read_b64_tr_b16 v[22:23], v196 offset:6144
    ds_read_b64_tr_b16 v[28:29], v198 offset:4096
    ds_read_b64_tr_b16 v[30:31], v198 offset:6144
    ds_read_b64_tr_b16 v[24:25], v197 offset:4096
    ds_read_b64_tr_b16 v[26:27], v197 offset:6144
    s_waitcnt lgkmcnt(10)
    v_mfma_f32_16x16x32_bf16 v[204:207], v[4:7], v[12:15], 0
    ds_read_b64_tr_b16 v[32:33], v199 offset:4096
    ds_read_b64_tr_b16 v[34:35], v199 offset:6144
    s_waitcnt lgkmcnt(10)
    v_mfma_f32_16x16x32_bf16 v[208:211], v[8:11], v[12:15], 0
    ds_read_b64_tr_b16 v[36:37], v196 offset:8192
    ds_read_b64_tr_b16 v[38:39], v196 offset:10240
    s_waitcnt lgkmcnt(10)
    s_nop 0
    v_mfma_f32_16x16x32_bf16 v[216:219], v[8:11], v[16:19], 0
    ds_read_b64_tr_b16 v[44:45], v198 offset:8192
    ds_read_b64_tr_b16 v[46:47], v198 offset:10240
    v_mfma_f32_16x16x32_bf16 v[212:215], v[4:7], v[16:19], 0
    ds_read_b64_tr_b16 v[40:41], v197 offset:8192
    ds_read_b64_tr_b16 v[42:43], v197 offset:10240
    s_waitcnt lgkmcnt(10)
    v_mfma_f32_16x16x32_bf16 v[204:207], v[20:23], v[28:31], v[204:207]
    ds_read_b64_tr_b16 v[48:49], v199 offset:8192
    ds_read_b64_tr_b16 v[50:51], v199 offset:10240
    s_waitcnt lgkmcnt(10)
    v_mfma_f32_16x16x32_bf16 v[208:211], v[24:27], v[28:31], v[208:211]
    ds_read_b64_tr_b16 v[228:229], v196 offset:12288
    ds_read_b64_tr_b16 v[230:231], v196 offset:14336
    s_waitcnt lgkmcnt(10)
    s_nop 0
    v_mfma_f32_16x16x32_bf16 v[216:219], v[24:27], v[32:35], v[216:219]
    ds_read_b64_tr_b16 v[236:237], v198 offset:12288
L_pad1:
    s_cbranch_execz L_pad5
    ds_read_b64_tr_b16 v[238:239], v198 offset:14336
    v_mfma_f32_16x16x32_bf16 v[212:215], v[20:23], v[32:35], v[212:215]
    ds_read_b64_tr_b16 v[232:233], v197 offset:12288
    ds_read_b64_tr_b16 v[234:235], v197 offset:14336
    s_waitcnt lgkmcnt(10)
    v_mfma_f32_16x16x32_bf16 v[204:207], v[36:39], v[44:47], v[204:207]
    ds_read_b64_tr_b16 v[240:241], v199 offset:12288
    ds_read_b64_tr_b16 v[242:243], v199 offset:14336
    s_waitcnt lgkmcnt(10)
    v_mfma_f32_16x16x32_bf16 v[208:211], v[40:43], v[44:47], v[208:211]
    s_waitcnt lgkmcnt(8)
    v_mfma_f32_16x16x32_bf16 v[216:219], v[40:43], v[48:51], v[216:219]
    v_mfma_f32_16x16x32_bf16 v[212:215], v[36:39], v[48:51], v[212:215]
    s_waitcnt lgkmcnt(4)
    v_mfma_f32_16x16x32_bf16 v[204:207], v[228:231], v[236:239], v[204:207]
    s_waitcnt lgkmcnt(2)
    v_mfma_f32_16x16x32_bf16 v[208:211], v[232:235], v[236:239], v[208:211]
    s_waitcnt lgkmcnt(0)
    s_nop 0
    v_mfma_f32_16x16x32_bf16 v[216:219], v[232:235], v[240:243], v[216:219]
    v_mfma_f32_16x16x32_bf16 v[212:215], v[228:231], v[240:243], v[212:215]
    v_mfma_f32_16x16x32_bf16 v[220:223], v[4:7], v[200:203], 0
    v_mfma_f32_16x16x32_bf16 v[224:227], v[8:11], v[200:203], 0
    v_mfma_f32_16x16x32_bf16 v[220:223], v[20:23], v[200:203], v[220:223]
    v_mfma_f32_16x16x32_bf16 v[224:227], v[24:27], v[200:203], v[224:227]
    v_cvt_pk_bf16_f32 v12, v204, v205
    v_cvt_pk_bf16_f32 v13, v206, v207
    v_cvt_pk_bf16_f32 v14, v208, v209
    v_cvt_pk_bf16_f32 v15, v210, v211
    v_mfma_f32_16x16x32_bf16 v[220:223], v[36:39], v[200:203], v[220:223]
    v_add_u32_e64 v12, s94, v12
    v_and_or_b32 v12, v12, s95, v54
    v_mfma_f32_16x16x32_bf16 v[224:227], v[40:43], v[200:203], v[224:227]
    v_add_u32_e64 v13, s94, v13
    v_and_or_b32 v13, v13, s95, v54
    v_mfma_f32_16x16x32_bf16 v[220:223], v[228:231], v[200:203], v[220:223]
    v_add_u32_e64 v14, s94, v14
    v_and_or_b32 v14, v14, s95, v54
    v_mfma_f32_16x16x32_bf16 v[224:227], v[232:235], v[200:203], v[224:227]
    v_add_u32_e64 v15, s94, v15
    v_and_or_b32 v15, v15, s95, v54
    s_bitcmp1_b32 s99, 0
    s_cbranch_scc1 Lls_18
    buffer_store_dwordx4 v[12:15], v62, s[36:39], s78 offen sc1
    s_branch Lle_19
Lls_18:
    buffer_store_dwordx4 v[12:15], v62, s[36:39], s78 offen
Lle_19:
    v_cvt_pk_bf16_f32 v28, v212, v213
    v_cvt_pk_bf16_f32 v29, v214, v215
    v_cvt_pk_bf16_f32 v30, v216, v217
    v_cvt_pk_bf16_f32 v31, v218, v219
    v_add_u32 v28, s94, v28
    v_and_or_b32 v28, v28, s95, v54
    v_add_u32_e64 v29, s94, v29
    v_and_or_b32 v29, v29, s95, v54
    v_add_u32_e64 v30, s94, v30
    v_and_or_b32 v30, v30, s95, v54
    v_add_u32_e64 v31, s94, v31
    v_and_or_b32 v31, v31, s95, v54
    s_bitcmp1_b32 s99, 0
    s_cbranch_scc1 Lls_20
    buffer_store_dwordx4 v[28:31], v63, s[36:39], s78 offen sc1
    s_branch Lle_21
Lls_20:
    s_nop 0
    buffer_store_dwordx4 v[28:31], v63, s[36:39], s78 offen
Lle_21:
    v_cvt_pk_bf16_f32 v44, v220, v221
    v_cvt_pk_bf16_f32 v45, v222, v223
    v_cvt_pk_bf16_f32 v46, v224, v225
    v_cvt_pk_bf16_f32 v47, v226, v227
    s_mov_b32 exec_lo, 0x00010001
    s_mov_b32 exec_hi, 0x00010001
    s_bitcmp1_b32 s99, 0
    s_cbranch_scc1 Lls_22
    buffer_store_dwordx4 v[44:47], v2, s[36:39], s79 offen sc1
    s_branch Lle_23
Lls_22:
    buffer_store_dwordx4 v[44:47], v2, s[36:39], s79 offen
Lle_23:
    s_mov_b64 exec, -1
    s_mov_b32 s85, 0
Lspin_24:
    s_add_u32 s85, s85, 1
    s_cmp_gt_u32 s85, 400000
    s_cbranch_scc1 L_end
    buffer_load_dwordx4 v[20:23], v56, s[36:39], s64 offen sc1
    buffer_load_dwordx4 v[24:27], v56, s[36:39], s65 offen sc1
    buffer_load_dwordx4 v[16:19], v58, s[36:39], s82 offen sc1
    s_waitcnt vmcnt(0)
Lchk_25:
    v_bitop3_b32 v28, v20, v24, v54 bitop3:0x7e
    v_bitop3_b32 v29, v21, v25, v54 bitop3:0x7e
    v_bitop3_b32 v30, v22, v26, v54 bitop3:0x7e
    v_bitop3_b32 v31, v23, v27, v54 bitop3:0x7e
    v_or3_b32 v28, v28, v29, v30
    v_cmp_eq_u32 s[90:91], -1, v16
    v_or_b32_e64 v28, v28, v31
    v_and_b32 v28, 0x00010001, v28
    v_cmp_ne_u32_e64 vcc, 0, v28
    s_or_b64 vcc, vcc, s[90:91]
    s_cbranch_vccnz Lspin_24
    v_lshl_add_u32 v28, v20, 16, s83
    v_and_b32 v29, 0xfffe0000, v20
    v_lshl_add_u32 v36, v24, 16, s83
    v_and_b32 v37, 0xfffe0000, v24
    v_pk_add_f32 v[28:29], v[28:29], v[36:37]
    v_lshl_add_u32 v30, v21, 16, s83
    v_and_b32 v31, 0xfffe0000, v21
    v_lshl_add_u32 v38, v25, 16, s83
    v_and_b32 v39, 0xfffe0000, v25
    v_pk_add_f32 v[30:31], v[30:31], v[38:39]
    v_lshl_add_u32 v32, v22, 16, s83
    v_and_b32 v33, 0xfffe0000, v22
    v_lshl_add_u32 v40, v26, 16, s83
    v_and_b32 v41, 0xfffe0000, v26
    v_pk_add_f32 v[32:33], v[32:33], v[40:41]
    v_lshl_add_u32 v34, v23, 16, s83
    v_and_b32 v35, 0xfffe0000, v23
    v_lshl_add_u32 v42, v27, 16, s83
    v_and_b32 v43, 0xfffe0000, v27
    v_pk_add_f32 v[34:35], v[34:35], v[42:43]
    v_permlane32_swap_b32 v28, v32
    v_permlane32_swap_b32 v29, v33
    v_permlane32_swap_b32 v30, v34
    v_permlane32_swap_b32 v31, v35
    v_pk_add_f32 v[28:29], v[28:29], v[32:33]
    v_pk_add_f32 v[30:31], v[30:31], v[34:35]
    s_nop 1
    v_permlane16_swap_b32 v28, v30
    v_permlane16_swap_b32_e64 v29, v31
    v_pk_add_f32 v[28:29], v[28:29], v[30:31]
    s_nop 1
    v_add_f32_dpp v28, v28, v28 row_ror:8 row_mask:0xf bank_mask:0xf
    v_add_f32_dpp v29, v29, v29 row_ror:8 row_mask:0xf bank_mask:0xf
    v_cvt_pk_bf16_f32 v36, v28, v29
    s_mov_b32 exec_lo, 0x00ff00ff
    s_mov_b32 exec_hi, 0x00ff00ff
    s_bitcmp1_b32 s99, 0
    s_cbranch_scc1 Lls_26
    buffer_store_dword v36, v57, s[36:39], s81 offen sc1
    s_branch Lle_27
Lls_26:
    buffer_store_dword v36, v57, s[36:39], s81 offen
Lle_27:
    s_mov_b64 exec, -1
    v_lshlrev_b32 v28, 16, v16
    v_and_b32 v29, 0xffff0000, v16
    v_lshlrev_b32_e64 v30, 16, v17
    v_and_b32 v31, 0xffff0000, v17
    v_lshlrev_b32_e64 v32, 16, v18
    v_and_b32 v33, 0xffff0000, v18
    v_lshlrev_b32_e64 v34, 16, v19
    v_and_b32 v35, 0xffff0000, v19
    v_permlane32_swap_b32 v28, v32
    v_permlane32_swap_b32 v29, v33
    v_permlane32_swap_b32 v30, v34
    v_permlane32_swap_b32 v31, v35
    v_pk_add_f32 v[28:29], v[28:29], v[32:33]
    v_pk_add_f32 v[30:31], v[30:31], v[34:35]
    s_nop 1
    v_permlane16_swap_b32 v28, v30
    v_permlane16_swap_b32_e64 v29, v31
    v_pk_add_f32 v[28:29], v[28:29], v[30:31]
    s_nop 1
    v_add_f32_dpp v38, v28, v28 row_ror:8 row_mask:0xf bank_mask:0x3
    s_nop 1
    v_add_f32_dpp v38, v29, v29 row_ror:8 row_mask:0xf bank_mask:0xc
    s_nop 1
    v_add_f32_dpp v37, v38, v38 row_shr:4 row_mask:0xf bank_mask:0xf
    v_cvt_pk_bf16_f32 v37, v37, v37
    s_mov_b32 exec_lo, 0xf0f0f0f0
    s_mov_b32 exec_hi, 0xf0f0f0f0
    ds_write_b16 v59, v37
    s_mov_b64 exec, -1
    s_waitcnt lgkmcnt(0)
    s_barrier
    v_lshlrev_b32 v4, 4, v2
    s_lshl_b32 s78, s76, 10
    s_add_u32 s78, s78, 110592
    v_add_u32 v5, s78, v4
    s_lshl_b32 s78, s76, 12
    s_add_u32 s78, s78, 131072
    v_add_u32 v6, s78, v4
    s_lshl_b32 s100, s77, 9
    s_add_u32 s100, s100, 8912896
    v_mov_b32 v48, s75
    v_mov_b32 v49, s75
    v_lshl_add_u32 v50, v2, 3, s100
    s_lshl_b32 s83, s71, 4
    s_add_u32 s83, s83, s72
    s_lshl_b32 s78, s0, 11
    s_and_b32 s79, s76, 1
    s_lshl_b32 s79, s79, 10
    s_add_u32 s78, s78, s79
    s_add_u32 s78, s78, 655360
    s_mul_i32 s79, s74, 56
    s_add_u32 s79, s79, s73
    s_lshl_b32 s79, s79, 10
    s_add_u32 s79, s79, 1114112
    s_cmp_eq_u32 s76, 1
    s_cselect_b32 s78, s79, s78
    s_cmp_ge_u32 s73, 56
    s_cselect_b32 s78, 0x10000000, s78
    s_lshl_b32 s79, s83, 11
    s_add_u32 s79, s79, s84
    s_add_u32 s79, s79, 1572864
    s_cmp_lt_u32 s76, 2
    s_cselect_b32 s94, s79, s78
    s_lshl_b32 s79, s83, 9
    s_add_u32 s79, s79, 524288
    s_cmp_eq_u32 s76, 0
    s_cselect_b32 s78, s79, s78
    s_cselect_b32 s79, 0, -1
    v_mov_b32 v56, -1
    v_mov_b32 v57, -1
    v_mov_b32 v58, -1
    v_mov_b32_e64 v59, -1
    s_barrier
    s_mov_b32 s100, 43008
    buffer_load_dwordx4 v[88:91], v244, s[48:51], s100 offen nt
    s_mov_b32 s100, 43008
    buffer_load_dwordx4 v[120:123], v244, s[52:55], s100 offen nt
    s_mov_b32 s100, 50176
    buffer_load_dwordx4 v[92:95], v244, s[48:51], s100 offen nt
    s_mov_b32 s100, 50176
    buffer_load_dwordx4 v[124:127], v244, s[52:55], s100 offen nt
    ds_write_b128 v6, v[180:183] offset:0
    ds_write_b128 v6, v[184:187] offset:1024
    ds_write_b128 v6, v[188:191] offset:2048
    ds_write_b128 v6, v[192:195] offset:3072
    ds_write_b128 v5, v[160:163] offset:16384
    ds_write_b128 v5, v[164:167] offset:12288
    ds_write_b128 v5, v[168:171] offset:8192
    ds_write_b128 v5, v[172:175] offset:4096
    ds_write_b128 v5, v[176:179] offset:0
    s_waitcnt lgkmcnt(0)
    s_barrier
    s_cmp_lg_u32 s76, 0
    s_cbranch_scc1 Lfs_28
    buffer_store_dwordx2 v[48:49], v50, s[36:39], 0 offen sc1
Lfs_28:
    s_mov_b32 exec_hi, s79
    buffer_store_dwordx4 v[56:59], v4, s[36:39], s78 offen sc1
    s_mov_b32 exec_hi, -1
    s_mov_b32 s100, 0x05040100
    s_mov_b32 s101, 0x07060302
    v_perm_b32 v7, v68, v64, s100
    v_perm_b32 v68, v68, v64, s101
    v_mov_b32_e64 v64, v7
    v_perm_b32 v7, v69, v65, s100
    v_perm_b32 v69, v69, v65, s101
    v_mov_b32_e64 v65, v7
    v_perm_b32 v7, v70, v66, s100
    v_perm_b32 v70, v70, v66, s101
    v_mov_b32_e64 v66, v7
    v_perm_b32 v7, v71, v67, s100
    v_perm_b32 v71, v71, v67, s101
    v_mov_b32_e64 v67, v7
    v_perm_b32 v7, v100, v96, s100
    v_perm_b32 v100, v100, v96, s101
    v_mov_b32_e64 v96, v7
    v_perm_b32 v7, v101, v97, s100
    v_perm_b32 v101, v101, v97, s101
    v_mov_b32_e64 v97, v7
    v_perm_b32 v7, v102, v98, s100
    v_perm_b32 v102, v102, v98, s101
    v_mov_b32_e64 v98, v7
    v_perm_b32 v7, v103, v99, s100
    v_perm_b32 v103, v103, v99, s101
    v_mov_b32_e64 v99, v7
    v_perm_b32 v7, v76, v72, s100
    v_perm_b32 v76, v76, v72, s101
    v_mov_b32_e64 v72, v7
    v_perm_b32 v7, v77, v73, s100
    v_perm_b32 v77, v77, v73, s101
    v_mov_b32_e64 v73, v7
    v_perm_b32 v7, v78, v74, s100
    v_perm_b32 v78, v78, v74, s101
    v_mov_b32_e64 v74, v7
    v_perm_b32 v7, v79, v75, s100
    v_perm_b32 v79, v79, v75, s101
    v_mov_b32_e64 v75, v7
    v_perm_b32 v7, v108, v104, s100
    v_perm_b32 v108, v108, v104, s101
    v_mov_b32_e64 v104, v7
    v_perm_b32 v7, v109, v105, s100
    v_perm_b32 v109, v109, v105, s101
    v_mov_b32_e64 v105, v7
    v_perm_b32 v7, v110, v106, s100
    v_perm_b32 v110, v110, v106, s101
    v_mov_b32_e64 v106, v7
    v_perm_b32 v7, v111, v107, s100
    v_perm_b32 v111, v111, v107, s101
    v_mov_b32_e64 v107, v7
    v_perm_b32 v7, v84, v80, s100
    v_perm_b32 v84, v84, v80, s101
    v_mov_b32_e64 v80, v7
    v_perm_b32 v7, v85, v81, s100
    v_perm_b32 v85, v85, v81, s101
    v_mov_b32_e64 v81, v7
    v_perm_b32 v7, v86, v82, s100
    v_perm_b32 v86, v86, v82, s101
    v_mov_b32_e64 v82, v7
    v_perm_b32 v7, v87, v83, s100
    v_perm_b32 v87, v87, v83, s101
    v_mov_b32_e64 v83, v7
    v_perm_b32 v7, v116, v112, s100
    v_perm_b32 v116, v116, v112, s101
L_pad2:
    s_cbranch_execz L_pad6
    v_mov_b32 v112, v7
    v_perm_b32 v7, v117, v113, s100
    v_perm_b32 v117, v117, v113, s101
    v_mov_b32_e64 v113, v7
    v_perm_b32 v7, v118, v114, s100
    v_perm_b32 v118, v118, v114, s101
    v_mov_b32_e64 v114, v7
    v_perm_b32 v7, v119, v115, s100
    v_perm_b32 v119, v119, v115, s101
    v_mov_b32_e64 v115, v7
    s_cmp_lg_u32 s76, 2
    s_cbranch_scc1 Lf2_29
    s_mov_b64 exec, 0xffff
    s_mov_b32 s85, 1
    s_mov_b32 s101, 0
    s_branch Lb_31
Lspin_30:
    s_add_u32 s85, s85, 1
    s_cmp_gt_u32 s85, 400000
    s_cbranch_scc1 L_end
    s_add_u32 s101, s101, 128
    s_min_u32 s101, s101, 384
Lb_31:
    buffer_load_dword v52, v61, s[36:39], s101 offen sc1
    s_waitcnt vmcnt(0)
    v_cmp_ne_u32_e64 vcc, s75, v52
    s_cbranch_vccnz Lspin_30
    s_mov_b64 exec, -1
Lf2_29:
    s_barrier
    s_waitcnt vmcnt(0)
    s_mov_b32 s100, 0x05040100
    s_mov_b32 s101, 0x07060302
    v_perm_b32 v7, v92, v88, s100
    v_perm_b32 v92, v92, v88, s101
    v_mov_b32_e64 v88, v7
    v_perm_b32 v7, v93, v89, s100
    v_perm_b32 v93, v93, v89, s101
    v_mov_b32_e64 v89, v7
    v_perm_b32 v7, v94, v90, s100
    v_perm_b32 v94, v94, v90, s101
    v_mov_b32_e64 v90, v7
    v_perm_b32 v7, v95, v91, s100
    v_perm_b32 v95, v95, v91, s101
    v_mov_b32_e64 v91, v7
    v_perm_b32 v7, v124, v120, s100
    v_perm_b32 v124, v124, v120, s101
    v_mov_b32_e64 v120, v7
    v_perm_b32 v7, v125, v121, s100
    v_perm_b32 v125, v125, v121, s101
    v_mov_b32_e64 v121, v7
    v_perm_b32 v7, v126, v122, s100
    v_perm_b32 v126, v126, v122, s101
    v_mov_b32_e64 v122, v7
    v_perm_b32 v7, v127, v123, s100
    v_perm_b32 v127, v127, v123, s101
    v_mov_b32 v123, v7
    v_lshrrev_b32 v8, 3, v2
    v_and_b32 v9, 7, v2
    v_lshlrev_b32 v10, 4, v9
    v_lshl_add_u32 v11, v8, 13, v10
    v_and_b32 v12, 15, v2
    v_lshlrev_b32 v12, 13, v12
    v_lshl_add_u32 v13, v8, 9, v10
    v_lshl_add_u32 v14, v9, 3, v8
    s_lshl_b32 s80, s74, 2
    s_add_u32 s80, s80, s76
    s_lshl_b32 s78, s80, 9
    s_add_u32 s78, s78, 524288
    s_add_u32 s79, s78, 65536
    s_add_u32 s81, s73, s76
    s_and_b32 s81, s81, 3
    s_andn2_b32 s100, s73, 3
    s_or_b32 s81, s81, s100
    s_lshl_b32 s81, s81, 13
    s_lshl_b32 s80, s80, 9
    s_add_u32 s80, s80, s81
    s_add_u32 s80, s80, 655360
    s_lshl_b32 s81, s73, 13
    s_add_u32 s81, s81, 655360
    s_lshl_b32 s64, s76, 7
    s_add_u32 s64, s64, s81
    s_add_u32 s65, s64, 4096
    v_lshrrev_b32 v50, 5, v2
    v_lshl_add_u32 v50, v9, 1, v50
    s_lshl_b32 s82, s76, 5
    s_add_u32 s82, s82, 163456
    v_lshl_add_u32 v50, v50, 1, s82
    v_lshlrev_b32 v27, 4, v8
    v_add_u32 v51, 163456, v27
    v_lshlrev_b32 v49, 2, v14
    v_lshlrev_b32 v15, 3, v14
    v_mov_b32 v26, 163360
    s_mul_i32 s66, s74, 56
    s_add_u32 s66, s66, s73
    s_lshl_b32 s66, s66, 10
    s_lshl_b32 s82, s76, 8
    s_add_u32 s66, s66, s82
    s_add_u32 s66, s66, 1114112
    s_barrier
    buffer_load_dwordx4 v[56:59], v4, s[36:39], s94 offen sc1
    s_mov_b32 s100, 0
    s_nop 0
    buffer_load_dwordx4 v[128:131], v245, s[56:59], s100 offen nt
    s_mov_b32 s100, 2048
    buffer_load_dwordx4 v[132:135], v245, s[56:59], s100 offen nt
    s_mov_b32 s100, 4096
    buffer_load_dwordx4 v[136:139], v245, s[56:59], s100 offen nt
    s_mov_b32 s100, 6144
    buffer_load_dwordx4 v[140:143], v245, s[56:59], s100 offen nt
    s_mov_b32 s100, 8192
    buffer_load_dwordx4 v[144:147], v245, s[56:59], s100 offen nt
    s_barrier
    s_waitcnt vmcnt(0)
    s_mov_b32 s100, 0x05040100
    s_mov_b32 s101, 0x07060302
    v_perm_b32 v7, v132, v128, s100
    v_perm_b32 v132, v132, v128, s101
    v_mov_b32_e64 v128, v7
    v_perm_b32 v7, v133, v129, s100
    v_perm_b32 v133, v133, v129, s101
    v_mov_b32_e64 v129, v7
    v_perm_b32 v7, v134, v130, s100
    v_perm_b32 v134, v134, v130, s101
    v_mov_b32_e64 v130, v7
    v_perm_b32 v7, v135, v131, s100
    v_perm_b32 v135, v135, v131, s101
    v_mov_b32_e64 v131, v7
    v_perm_b32 v7, v140, v136, s100
    v_perm_b32 v140, v140, v136, s101
    v_mov_b32_e64 v136, v7
    v_perm_b32 v7, v141, v137, s100
    v_perm_b32 v141, v141, v137, s101
    v_mov_b32_e64 v137, v7
    v_perm_b32 v7, v142, v138, s100
    v_perm_b32 v142, v142, v138, s101
    v_mov_b32_e64 v138, v7
    v_perm_b32 v7, v143, v139, s100
    v_perm_b32 v143, v143, v139, s101
    v_mov_b32 v139, v7
    s_barrier
    s_mov_b32 s100, 10240
    buffer_load_dwordx4 v[148:151], v245, s[56:59], s100 offen nt
    s_mov_b32 s100, 12288
    buffer_load_dwordx4 v[152:155], v245, s[56:59], s100 offen nt
    s_mov_b32 s100, 14336
    buffer_load_dwordx4 v[156:159], v245, s[56:59], s100 offen nt
    s_and_b32 s79, s2, 7
    s_lshl_b32 s79, s79, 9
    s_add_u32 s79, s79, 524288
    s_mov_b64 exec, 0xffff
    s_mov_b32 s85, 1
    s_sleep 20
    s_branch Lb_33
Lspin_32:
    s_add_u32 s85, s85, 1
    s_cmp_gt_u32 s85, 400000
    s_cbranch_scc1 L_end
    s_or_b32 s79, s79, 4096
Lb_33:
    buffer_load_dwordx2 v[24:25], v12, s[36:39], s79 offen offset:128 sc1
    s_waitcnt vmcnt(0)
    v_cmp_ne_u32 vcc, s75, v25
    s_cbranch_vccnz Lspin_32
    v_max_f32_dpp v24, v24, v24 row_ror:8 row_mask:0xf bank_mask:0xf
    s_nop 1
    v_max_f32_dpp v24, v24, v24 row_ror:4 row_mask:0xf bank_mask:0xf
    s_nop 1
    v_max_f32_dpp v24, v24, v24 row_ror:2 row_mask:0xf bank_mask:0xf
    s_nop 1
    v_max_f32_dpp v24, v24, v24 row_ror:1 row_mask:0xf bank_mask:0xf
    s_nop 0
    v_readfirstlane_b32 s97, v24
    s_mov_b64 exec, -1
    s_nop 0
    v_mov_b32 v24, s97
    s_cmp_ge_u32 s73, 56
    s_cbranch_scc1 L_red
    s_bfe_u32 s79, s97, 0x40007
    s_lshl_b32 s79, s79, 13
    s_add_u32 s78, s78, s79
    buffer_load_dwordx4 v[20:23], v27, s[36:39], s78 offen sc1
    ds_write_b32 v26, v24
    s_mov_b32 s85, 1
    s_mov_b32 s100, 0x05040100
    s_mov_b32 s101, 0x07060302
    v_perm_b32 v7, v148, v144, s100
    v_perm_b32 v148, v148, v144, s101
    v_mov_b32 v144, v7
    v_perm_b32 v7, v149, v145, s100
    v_perm_b32 v149, v149, v145, s101
    v_mov_b32_e64 v145, v7
    v_perm_b32 v7, v150, v146, s100
    v_perm_b32 v150, v150, v146, s101
    v_mov_b32_e64 v146, v7
    v_perm_b32 v7, v151, v147, s100
    v_perm_b32 v151, v151, v147, s101
    v_mov_b32_e64 v147, v7
    v_perm_b32 v7, v156, v152, s100
    v_perm_b32 v156, v156, v152, s101
    v_mov_b32_e64 v152, v7
    v_perm_b32 v7, v157, v153, s100
    v_perm_b32 v157, v157, v153, s101
    v_mov_b32_e64 v153, v7
    v_perm_b32 v7, v158, v154, s100
    v_perm_b32 v158, v158, v154, s101
    v_mov_b32_e64 v154, v7
    v_perm_b32 v7, v159, v155, s100
    v_perm_b32 v159, v159, v155, s101
    v_mov_b32_e64 v155, v7
    s_branch Lb_35
Lspin_34:
    s_add_u32 s85, s85, 1
    s_cmp_gt_u32 s85, 400000
    s_cbranch_scc1 L_end
    buffer_load_dwordx4 v[20:23], v27, s[36:39], s78 offen sc1
Lb_35:
    s_waitcnt vmcnt(0) lgkmcnt(0)
    v_max3_u32 v16, v20, v21, v22
    v_max_u32 v16, v16, v23
    v_cmp_eq_u32_e64 vcc, -1, v16
    s_cbranch_vccnz Lspin_34
    v_dot2_f32_bf16 v28, v64, v20, 0
    v_dot2_f32_bf16 v29, v68, v20, 0
    v_dot2_f32_bf16 v30, v65, v20, 0
    v_dot2_f32_bf16 v31, v69, v20, 0
    v_dot2_f32_bf16 v32, v66, v20, 0
    v_dot2_f32_bf16 v33, v70, v20, 0
    v_dot2_f32_bf16 v34, v67, v20, 0
    v_dot2_f32_bf16 v35, v71, v20, 0
    v_dot2_f32_bf16 v28, v72, v21, v28
    v_dot2_f32_bf16 v29, v76, v21, v29
    v_dot2_f32_bf16 v30, v73, v21, v30
    v_dot2_f32_bf16 v31, v77, v21, v31
    v_dot2_f32_bf16 v32, v74, v21, v32
    v_dot2_f32_bf16 v33, v78, v21, v33
    v_dot2_f32_bf16 v34, v75, v21, v34
    v_dot2_f32_bf16 v35, v79, v21, v35
    v_dot2_f32_bf16 v28, v80, v22, v28
    v_dot2_f32_bf16 v29, v84, v22, v29
    v_dot2_f32_bf16 v30, v81, v22, v30
    v_dot2_f32_bf16 v31, v85, v22, v31
    v_dot2_f32_bf16 v32, v82, v22, v32
    v_dot2_f32_bf16 v33, v86, v22, v33
    v_dot2_f32_bf16 v34, v83, v22, v34
    v_dot2_f32_bf16 v35, v87, v22, v35
    v_dot2_f32_bf16 v28, v88, v23, v28
    v_dot2_f32_bf16 v29, v92, v23, v29
    v_dot2_f32_bf16 v30, v89, v23, v30
    v_dot2_f32_bf16 v31, v93, v23, v31
    v_dot2_f32_bf16 v32, v90, v23, v32
    v_dot2_f32_bf16 v33, v94, v23, v33
    v_dot2_f32_bf16 v34, v91, v23, v34
    v_dot2_f32_bf16 v35, v95, v23, v35
    v_dot2_f32_bf16 v36, v96, v20, 0
    v_dot2_f32_bf16 v37, v100, v20, 0
    v_dot2_f32_bf16 v38, v97, v20, 0
    v_dot2_f32_bf16 v39, v101, v20, 0
    v_dot2_f32_bf16 v40, v98, v20, 0
    v_dot2_f32_bf16 v41, v102, v20, 0
    v_dot2_f32_bf16 v42, v99, v20, 0
    v_dot2_f32_bf16 v43, v103, v20, 0
    v_dot2_f32_bf16 v36, v104, v21, v36
    v_dot2_f32_bf16 v37, v108, v21, v37
    v_dot2_f32_bf16 v38, v105, v21, v38
    v_dot2_f32_bf16 v39, v109, v21, v39
    v_dot2_f32_bf16 v40, v106, v21, v40
    v_dot2_f32_bf16 v41, v110, v21, v41
    v_dot2_f32_bf16 v42, v107, v21, v42
    v_dot2_f32_bf16 v43, v111, v21, v43
    v_dot2_f32_bf16 v36, v112, v22, v36
    v_dot2_f32_bf16 v37, v116, v22, v37
    v_dot2_f32_bf16 v38, v113, v22, v38
    v_dot2_f32_bf16 v39, v117, v22, v39
    v_dot2_f32_bf16 v40, v114, v22, v40
    v_dot2_f32_bf16 v41, v118, v22, v41
    v_dot2_f32_bf16 v42, v115, v22, v42
    v_dot2_f32_bf16 v43, v119, v22, v43
    v_dot2_f32_bf16 v36, v120, v23, v36
    v_dot2_f32_bf16 v37, v124, v23, v37
    v_dot2_f32_bf16 v38, v121, v23, v38
    v_dot2_f32_bf16 v39, v125, v23, v39
    v_dot2_f32_bf16 v40, v122, v23, v40
    v_dot2_f32_bf16 v41, v126, v23, v41
    v_dot2_f32_bf16 v42, v123, v23, v42
    v_dot2_f32_bf16 v43, v127, v23, v43
    v_permlane32_swap_b32 v28, v32
    v_permlane32_swap_b32 v29, v33
    v_permlane32_swap_b32 v30, v34
    v_permlane32_swap_b32 v31, v35
    v_permlane32_swap_b32 v36, v40
    v_permlane32_swap_b32 v37, v41
    v_permlane32_swap_b32 v38, v42
    v_permlane32_swap_b32 v39, v43
    v_pk_add_f32 v[28:29], v[28:29], v[32:33]
    v_pk_add_f32 v[30:31], v[30:31], v[34:35]
    v_pk_add_f32 v[36:37], v[36:37], v[40:41]
    v_pk_add_f32 v[38:39], v[38:39], v[42:43]
    v_permlane16_swap_b32 v28, v30
    v_permlane16_swap_b32 v29, v31
    v_permlane16_swap_b32 v36, v38
    v_permlane16_swap_b32 v37, v39
    v_pk_add_f32 v[28:29], v[28:29], v[30:31]
    v_pk_add_f32 v[36:37], v[36:37], v[38:39]
    s_nop 0
    v_add_f32_dpp v44, v28, v28 row_ror:8 row_mask:0xf bank_mask:0x3
    v_add_f32_dpp v45, v36, v36 row_ror:8 row_mask:0xf bank_mask:0x3
    s_nop 0
    v_add_f32_dpp v44, v29, v29 row_ror:8 row_mask:0xf bank_mask:0xc
L_pad3:
    s_cbranch_execz L_pad7
    v_add_f32_dpp v45, v37, v37 row_ror:8 row_mask:0xf bank_mask:0xc
    s_bitcmp1_b32 s99, 0
    s_cbranch_scc1 Lls_36
    buffer_store_dwordx2 v[44:45], v15, s[36:39], s80 offen sc1
    s_branch Lle_37
Lls_36:
    buffer_store_dwordx2 v[44:45], v15, s[36:39], s80 offen
Lle_37:
    s_mov_b32 s95, s80
    s_barrier
    s_mov_b32 s85, 0
Lspin_38:
    s_add_u32 s85, s85, 1
    s_cmp_gt_u32 s85, 400000
    s_cbranch_scc1 L_end
    buffer_load_dwordx4 v[16:19], v13, s[36:39], s64 offen sc1
    buffer_load_dwordx4 v[20:23], v13, s[36:39], s65 offen sc1
    s_waitcnt vmcnt(0)
    v_max3_u32 v25, v16, v18, v20
    v_max_u32 v25, v25, v22
    v_cmp_eq_u32_e64 vcc, -1, v25
    s_cbranch_vccnz Lspin_38
    v_pk_add_f32 v[16:17], v[16:17], v[20:21]
    v_pk_add_f32 v[18:19], v[18:19], v[22:23]
    s_nop 1
    v_permlane32_swap_b32 v16, v18
    v_permlane32_swap_b32_e64 v17, v19
    v_pk_add_f32 v[16:17], v[16:17], v[18:19]
    v_mov_b32 v18, v16
    v_mov_b32 v19, v17
    s_nop 0
    v_permlane16_swap_b32 v16, v18
    v_permlane16_swap_b32_e64 v17, v19
    v_pk_add_f32 v[16:17], v[16:17], v[18:19]
    s_nop 1
    v_add_f32_dpp v16, v16, v16 row_ror:8 row_mask:0xf bank_mask:0xf
    v_add_f32_dpp v17, v17, v17 row_ror:8 row_mask:0xf bank_mask:0xf
    v_cvt_pk_bf16_f32 v17, v16, v17
    v_lshlrev_b32 v16, 16, v17
    v_mul_f32 v18, 0xbfb8aa3b, v16
    v_exp_f32_e64 v18, v18
    v_and_b32 v17, 0xffff0000, v17
    v_add_f32 v18, 1.0, v18
    v_rcp_f32 v18, v18
    s_nop 0
    v_mul_f32 v16, v16, v18
    v_cvt_pk_bf16_f32 v16, v16, v16
    v_and_b32 v16, 0xffff0000, v16
    v_mul_f32_e64 v16, v16, v17
    v_cvt_pk_bf16_f32 v16, v16, v16
    ds_write_b16 v50, v16
    s_waitcnt lgkmcnt(0)
    s_barrier
    ds_read_b128 v[20:23], v51
    s_waitcnt lgkmcnt(0)
    s_nop 0
    v_dot2_f32_bf16 v28, v128, v20, 0
    v_dot2_f32_bf16 v29, v132, v20, 0
    v_dot2_f32_bf16 v30, v129, v20, 0
    v_dot2_f32_bf16 v31, v133, v20, 0
    v_dot2_f32_bf16 v32, v130, v20, 0
    v_dot2_f32_bf16 v33, v134, v20, 0
    v_dot2_f32_bf16 v34, v131, v20, 0
    v_dot2_f32_bf16 v35, v135, v20, 0
    v_dot2_f32_bf16 v28, v136, v21, v28
    v_dot2_f32_bf16 v29, v140, v21, v29
    v_dot2_f32_bf16 v30, v137, v21, v30
    v_dot2_f32_bf16 v31, v141, v21, v31
    v_dot2_f32_bf16 v32, v138, v21, v32
    v_dot2_f32_bf16 v33, v142, v21, v33
    v_dot2_f32_bf16 v34, v139, v21, v34
    v_dot2_f32_bf16 v35, v143, v21, v35
    v_dot2_f32_bf16 v28, v144, v22, v28
    v_dot2_f32_bf16 v29, v148, v22, v29
    v_dot2_f32_bf16 v30, v145, v22, v30
    v_dot2_f32_bf16 v31, v149, v22, v31
    v_dot2_f32_bf16 v32, v146, v22, v32
    v_dot2_f32_bf16 v33, v150, v22, v33
    v_dot2_f32_bf16 v34, v147, v22, v34
    v_dot2_f32_bf16 v35, v151, v22, v35
    v_dot2_f32_bf16 v28, v152, v23, v28
    v_dot2_f32_bf16 v29, v156, v23, v29
    v_dot2_f32_bf16 v30, v153, v23, v30
    v_dot2_f32_bf16 v31, v157, v23, v31
    v_dot2_f32_bf16 v32, v154, v23, v32
    v_dot2_f32_bf16 v33, v158, v23, v33
    v_dot2_f32_bf16 v34, v155, v23, v34
    v_dot2_f32_bf16 v35, v159, v23, v35
    v_permlane32_swap_b32 v28, v32
    v_permlane32_swap_b32 v29, v33
    v_permlane32_swap_b32 v30, v34
    v_permlane32_swap_b32 v31, v35
    v_pk_add_f32 v[28:29], v[28:29], v[32:33]
    v_pk_add_f32 v[30:31], v[30:31], v[34:35]
    s_nop 1
    v_permlane16_swap_b32 v28, v30
    v_permlane16_swap_b32_e64 v29, v31
    v_pk_add_f32 v[28:29], v[28:29], v[30:31]
    s_nop 1
    v_add_f32_dpp v46, v28, v28 row_ror:8 row_mask:0xf bank_mask:0x3
    s_nop 1
    v_add_f32_dpp v46, v29, v29 row_ror:8 row_mask:0xf bank_mask:0xc
    buffer_store_dword v46, v49, s[36:39], s66 offen sc1
    s_barrier
    s_branch L_fin
L_red:
    v_mov_b32 v26, 163360
    ds_write_b32 v26, v24
    s_waitcnt lgkmcnt(0)
    s_barrier
    s_barrier
    s_barrier
    s_cmp_lg_u32 s76, 0
    s_cbranch_scc1 L_fin
    s_sub_u32 s83, s0, 224
    v_lshrrev_b32_e64 v14, 4, v2
    v_lshl_add_u32 v14, v9, 2, v14
    v_lshlrev_b32 v15, 2, v14
    v_lshlrev_b32 v14, 1, v14
    s_bfe_u32 s78, s97, 0x40007
    s_lshl_b32 s78, s78, 13
    s_lshr_b32 s79, s83, 1
    s_lshl_b32 s79, s79, 9
    s_add_u32 s78, s78, s79
    s_and_b32 s79, s83, 1
    s_lshl_b32 s79, s79, 7
    s_add_u32 s78, s78, s79
    s_add_u32 s78, s78, 524544
    s_mov_b32 s85, 0
Lspin_39:
    s_add_u32 s85, s85, 1
    s_cmp_gt_u32 s85, 400000
    s_cbranch_scc1 L_end
    buffer_load_dword v46, v15, s[36:39], s78 offen sc1
    s_waitcnt vmcnt(0)
    v_cmp_eq_u32_e64 vcc, -1, v46
    s_cbranch_vccnz Lspin_39
    v_cvt_pk_bf16_f32 v47, v24, v24
    v_and_b32 v47, 0xffff0000, v47
    v_mul_f32 v47, 0xbfb8aa3b, v47
    v_exp_f32 v47, v47
    s_nop 0
    v_add_f32 v47, 1.0, v47
    v_rcp_f32_e64 v47, v47
    s_nop 0
    v_cvt_pk_bf16_f32 v47, v47, v47
    v_and_b32 v47, 0xffff0000, v47
    v_lshl_add_u32 v13, v8, 10, v10
    s_lshr_b32 s78, s83, 3
    s_mul_i32 s78, s78, 57344
    s_and_b32 s79, s83, 7
    s_lshl_b32 s79, s79, 7
    s_add_u32 s78, s78, s79
    s_add_u32 s78, s78, 1114112
    s_and_b32 s80, s97, 0x7ff
    s_lshl_b32 s80, s80, 11
    s_lshl_b32 s79, s83, 6
    s_add_u32 s80, s80, s79
    s_sleep 30
    s_mov_b32 s85, 0
Lspin_40:
    s_add_u32 s85, s85, 1
    s_cmp_gt_u32 s85, 400000
    s_cbranch_scc1 L_end
    s_add_u32 s79, s78, 0
    buffer_load_dwordx4 v[16:19], v13, s[36:39], s79 offen sc1
    s_add_u32 s79, s78, 8192
    buffer_load_dwordx4 v[20:23], v13, s[36:39], s79 offen sc1
    s_add_u32 s79, s78, 16384
    buffer_load_dwordx4 v[24:27], v13, s[36:39], s79 offen sc1
    s_add_u32 s79, s78, 24576
    buffer_load_dwordx4 v[28:31], v13, s[36:39], s79 offen sc1
    s_add_u32 s79, s78, 32768
    buffer_load_dwordx4 v[32:35], v13, s[36:39], s79 offen sc1
    s_add_u32 s79, s78, 40960
    buffer_load_dwordx4 v[36:39], v13, s[36:39], s79 offen sc1
    s_add_u32 s79, s78, 49152
    buffer_load_dwordx4 v[40:43], v13, s[36:39], s79 offen sc1
    s_waitcnt vmcnt(0)
    v_max_u32 v48, v16, v17
    v_max_u32_e64 v49, v18, v19
    v_max3_u32 v48, v48, v20, v21
    v_max3_u32 v49, v49, v22, v23
    v_max3_u32 v48, v48, v24, v25
    v_max3_u32 v49, v49, v26, v27
    v_max3_u32 v48, v48, v28, v29
    v_max3_u32 v49, v49, v30, v31
    v_max3_u32 v48, v48, v32, v33
    v_max3_u32 v49, v49, v34, v35
    v_max3_u32 v48, v48, v36, v37
    v_max3_u32 v49, v49, v38, v39
    v_max3_u32 v48, v48, v40, v41
    v_max3_u32 v49, v49, v42, v43
    v_max_u32 v48, v48, v49
    v_cmp_eq_u32_e64 vcc, -1, v48
    s_cbranch_vccnz Lspin_40
    v_pk_add_f32 v[16:17], v[16:17], v[20:21]
    v_pk_add_f32 v[24:25], v[24:25], v[28:29]
    v_pk_add_f32 v[32:33], v[32:33], v[36:37]
    v_pk_add_f32 v[16:17], v[16:17], v[24:25]
    v_pk_add_f32 v[32:33], v[32:33], v[40:41]
    v_pk_add_f32 v[16:17], v[16:17], v[32:33]
    v_pk_add_f32 v[18:19], v[18:19], v[22:23]
    v_pk_add_f32 v[26:27], v[26:27], v[30:31]
    v_pk_add_f32 v[34:35], v[34:35], v[38:39]
    v_pk_add_f32 v[18:19], v[18:19], v[26:27]
    v_pk_add_f32 v[34:35], v[34:35], v[42:43]
    v_pk_add_f32 v[18:19], v[18:19], v[34:35]
    s_nop 1
    v_permlane32_swap_b32 v16, v18
    v_permlane32_swap_b32_e64 v17, v19
    v_pk_add_f32 v[16:17], v[16:17], v[18:19]
    s_nop 1
    v_permlane16_swap_b32 v16, v17
    v_add_f32 v16, v16, v17
    s_nop 1
    v_add_f32_dpp v16, v16, v16 row_ror:8 row_mask:0xf bank_mask:0xf
    v_cvt_pk_bf16_f32 v16, v16, v16
    v_and_b32 v16, 0xffff0000, v16
    v_mul_f32_e64 v16, v16, v47
    v_cvt_pk_bf16_f32 v16, v16, v16
    v_and_b32 v16, 0xffff0000, v16
    v_add_f32_e64 v16, v16, v46
    v_cvt_pk_bf16_f32 v16, v16, v16
    s_mov_b32 exec_lo, 0x00ff00ff
    s_mov_b32 exec_hi, 0x00ff00ff
    buffer_store_short v16, v14, s[44:47], s80 offen
    s_mov_b64 exec, -1
    s_cmp_lg_u32 s0, 224
    s_cbranch_scc1 Lep_41
    s_cmp_lg_u32 s76, 0
    s_cbranch_scc1 Lep_41
    v_mov_b32 v196, s75
    v_mov_b32_e64 v197, 0
    s_mov_b64 exec, 1
    buffer_store_dword v196, v197, s[36:39], 0 offen sc1
    s_mov_b64 exec, -1
Lep_41:
    s_branch L_fin
L_padret:
    s_setpc_b64 s[90:91]
    .p2align 3
L_M:
    s_getpc_b64 s[90:91]
L_mpc:
    s_sub_u32 s90, s90, L_mpc-L_sube
    s_subb_u32 s91, s91, 0
    s_lshr_b32 s78, s2, 3
    s_lshl_b32 s78, s78, 10
    s_lshl_b32 s79, s76, 8
    s_add_u32 s78, s78, s79
    s_min_u32 s78, s78, (L_end-L_sube)
    v_lshl_add_u32 v119, v2, 2, s78
    global_load_dword v119, v119, s[90:91]
    s_setprio 1
    s_and_b32 s78, s2, 7
    s_lshr_b32 s79, s2, 3
    s_lshl_b32 s71, s78, 1
    s_and_b32 s72, s79, 1
    s_add_u32 s71, s71, s72
    s_lshr_b32 s72, s79, 1
    s_cmp_gt_u32 s70, 3
    s_cselect_b32 s78, 1, 0
    s_cmp_gt_u32 s70, 11
    s_cselect_b32 s78, 2, s78
    s_sub_u32 s78, s70, s78
    s_cmp_eq_u32 s70, 3
    s_cselect_b32 s78, 14, s78
    s_cmp_eq_u32 s70, 11
    s_cselect_b32 s78, 15, s78
    s_lshl_b32 s0, s78, 4
    s_add_u32 s0, s0, s69
    s_lshr_b32 s73, s0, 2
    s_and_b32 s74, s0, 3
    s_lshl_b32 s77, s70, 4
    s_add_u32 s77, s77, s69
    s_and_b32 s80, s76, 1
    s_lshr_b32 s81, s76, 1
    v_and_b32 v8, 15, v2
    v_lshrrev_b32 v9, 4, v2
    v_lshrrev_b32 v10, 1, v8
    s_lshl_b32 s78, s80, 13
    s_add_u32 s78, s78, 118784
    v_lshlrev_b32 v11, 7, v8
    v_add_u32 v11, s78, v11
    v_add_u32 v12, 0, v9
    v_xor_b32 v12, v12, v10
    v_lshl_add_u32 v4, v12, 4, v11
    v_add_u32 v12, 4, v9
    v_xor_b32 v12, v12, v10
    v_lshl_add_u32 v5, v12, 4, v11
    v_bfe_u32 v10, v2, 2, 2
    v_and_b32_e64 v11, 3, v2
    v_lshl_add_u32 v12, v9, 3, v10
    v_lshlrev_b32_e64 v12, 7, v12
    v_lshl_add_u32 v12, v11, 3, v12
    v_add_u32 v12, 135168, v12
    v_lshrrev_b32 v13, 1, v10
    v_and_b32 v14, 1, v9
    v_lshl_add_u32 v13, v14, 1, v13
    s_lshl_b32 s78, s81, 1
    s_add_u32 s79, s78, 0
    v_xor_b32_e64 v14, s79, v13
    v_lshl_add_u32 v6, v14, 5, v12
    s_add_u32 s79, s78, 1
    v_xor_b32 v14, s79, v13
    v_lshl_add_u32 v7, v14, 5, v12
    v_lshrrev_b32_e64 v13, 5, v2
    v_lshl_add_u32 v13, v13, 3, v10
    v_lshlrev_b32 v13, 6, v13
    v_and_b32 v14, 1, v9
    v_lshl_add_u32 v13, v14, 5, v13
    v_lshl_add_u32 v13, v11, 3, v13
    s_lshl_b32 s78, s81, 11
    s_add_u32 s78, s78, 159744
    v_add_u32 v15, s78, v13
    v_mov_b64 v[128:129], 0
    v_mov_b64 v[130:131], 0
    v_mov_b64 v[132:133], 0
    v_mov_b64 v[134:135], 0
    v_mov_b64 v[136:137], 0
    v_mov_b64 v[138:139], 0
    v_mov_b64 v[140:141], 0
    v_mov_b64 v[142:143], 0
    v_mov_b64 v[144:145], 0
    v_mov_b64 v[146:147], 0
    v_mov_b64 v[148:149], 0
    v_mov_b64 v[150:151], 0
    v_mov_b64 v[152:153], 0
    v_mov_b64 v[154:155], 0
    v_mov_b64 v[156:157], 0
    v_mov_b64 v[158:159], 0
    v_mov_b64 v[160:161], 0
    v_mov_b64 v[162:163], 0
    v_mov_b64 v[164:165], 0
    v_mov_b64 v[166:167], 0
    v_mov_b64 v[168:169], 0
    v_mov_b64 v[170:171], 0
    v_mov_b64 v[172:173], 0
    v_mov_b64 v[174:175], 0
    v_mov_b64 v[176:177], 0
    v_mov_b64 v[178:179], 0
    v_mov_b64 v[180:181], 0
    v_mov_b64 v[182:183], 0
    v_mov_b64 v[184:185], 0
    v_mov_b64 v[186:187], 0
    v_mov_b64 v[188:189], 0
    v_mov_b64 v[190:191], 0
    v_mov_b64 v[192:193], 0
    v_mov_b64 v[194:195], 0
    v_mov_b64 v[196:197], 0
    v_mov_b64 v[198:199], 0
    v_mov_b64 v[200:201], 0
    v_mov_b64 v[202:203], 0
    v_mov_b64 v[204:205], 0
    v_mov_b64 v[206:207], 0
    v_mov_b64 v[208:209], 0
    v_mov_b64 v[210:211], 0
L_pad4:
    s_cbranch_execz L_pad8
    v_mov_b64 v[212:213], 0
    v_mov_b64 v[214:215], 0
    v_mov_b64 v[216:217], 0
    v_mov_b64 v[218:219], 0
    v_mov_b64 v[220:221], 0
    v_mov_b64 v[222:223], 0
    v_mov_b64 v[104:105], 0
    v_mov_b64 v[106:107], 0
    v_mov_b64 v[108:109], 0
    v_mov_b64 v[110:111], 0
    v_and_b32 v14, 31, v2
    v_lshrrev_b32 v13, 5, v2
    s_lshl_b32 s78, s81, 14
    s_lshl_b32 s79, s80, 13
    s_add_u32 s78, s78, s79
    s_add_u32 s78, s78, 110592
    v_lshl_add_u32 v12, v14, 7, s78
    v_and_b32 v14, 7, v14
    v_xor_b32 v14, v14, v13
    v_xor_b32_e64 v13, 0, v14
    v_lshl_add_u32 v112, v13, 4, v12
    v_xor_b32_e64 v13, 2, v14
    v_lshl_add_u32 v113, v13, 4, v12
    v_xor_b32_e64 v13, 4, v14
    v_lshl_add_u32 v114, v13, 4, v12
    v_xor_b32_e64 v13, 6, v14
    v_lshl_add_u32 v115, v13, 4, v12
    s_add_u32 s79, s79, 143360
    v_lshl_add_u32 v12, v8, 7, s79
    s_lshl_b32 s78, s81, 2
    v_add_u32 v14, s78, v9
    v_and_b32 v13, 7, v8
    v_xor_b32 v14, v14, v13
    v_lshl_add_u32 v116, v14, 4, v12
    s_lshl_b32 s78, s80, 6
    v_add_u32 v10, s78, v8
    v_lshlrev_b32_e64 v11, 3, v10
    v_add_u32 v11, 159744, v11
    s_lshl_b32 s79, s81, 5
    v_add_u32 v12, s79, v8
    v_lshlrev_b32_e64 v12, 3, v12
    v_add_u32 v12, 160768, v12
    v_lshlrev_b32_e64 v13, 2, v10
    v_add_u32 v13, 162304, v13
    v_and_b32 v14, 31, v2
    v_add_u32 v14, s78, v14
    v_lshlrev_b32_e64 v14, 2, v14
    v_add_u32 v14, 162304, v14
    s_waitcnt lgkmcnt(0)
    s_load_dword s75, s[26:27], 0
    s_mov_b32 s36, s26
    s_and_b32 s37, s27, 0xffff
    s_mov_b32 s38, 0x10000000
    s_mov_b32 s39, 0x20000
    s_mov_b32 s64, s14
    s_and_b32 s65, s15, 0xffff
    s_mov_b32 s66, 0x800
    s_mov_b32 s67, 0x20000
    s_mov_b32 s44, s22
    s_and_b32 s45, s23, 0xffff
    s_mov_b32 s46, 0x400000
    s_mov_b32 s47, 0x20000
    s_lshl_b32 s78, s72, 7
    buffer_load_dword v118, off, s[64:67], s78
    s_waitcnt lgkmcnt(0)
    s_mul_i32 s75, s75, 0x9E3779B1
    s_add_u32 s75, s75, 0x7F4A7C15
    s_mov_b32 s84, 0
    s_mov_b32 s82, 2
    s_mov_b32 s83, 0xfffec000
    s_barrier
    s_nop 0
    ds_read_b128 v[16:19], v4 offset:0
    ds_read_b64_tr_b16 v[40:41], v6 offset:8192
    ds_read_b64_tr_b16 v[42:43], v6 offset:8704
    ds_read_b128 v[20:23], v4 offset:2048
    ds_read_b128 v[24:27], v4 offset:4096
    ds_read_b128 v[28:31], v4 offset:6144
    ds_read_b64_tr_b16 v[44:45], v7 offset:8192
    ds_read_b64_tr_b16 v[46:47], v7 offset:8704
    ds_read_b64_tr_b16 v[48:49], v6 offset:16384
    ds_read_b64_tr_b16 v[50:51], v6 offset:16896
    ds_read_b64_tr_b16 v[52:53], v7 offset:16384
    ds_read_b64_tr_b16 v[54:55], v7 offset:16896
    ds_read_b64_tr_b16 v[32:33], v6 offset:0
    ds_read_b64_tr_b16 v[34:35], v6 offset:512
    ds_read_b64_tr_b16 v[36:37], v7 offset:0
    ds_read_b64_tr_b16 v[38:39], v7 offset:512
    ds_read_b64_tr_b16 v[96:97], v15 offset:0
    ds_read_b64_tr_b16 v[98:99], v15 offset:1024
    ds_read_b64_tr_b16 v[100:101], v15 offset:256
    ds_read_b64_tr_b16 v[102:103], v15 offset:1280
    s_waitcnt lgkmcnt(0)
    s_nop 0
    v_mfma_f32_16x16x32_bf16 v[160:163], v[40:43], v[16:19], v[160:163]
    v_mfma_f32_16x16x32_bf16 v[176:179], v[44:47], v[16:19], v[176:179]
    v_mfma_f32_16x16x32_bf16 v[180:183], v[44:47], v[20:23], v[180:183]
    v_mfma_f32_16x16x32_bf16 v[164:167], v[40:43], v[20:23], v[164:167]
    v_mfma_f32_16x16x32_bf16 v[168:171], v[40:43], v[24:27], v[168:171]
    v_mfma_f32_16x16x32_bf16 v[184:187], v[44:47], v[24:27], v[184:187]
    v_mfma_f32_16x16x32_bf16 v[188:191], v[44:47], v[28:31], v[188:191]
    v_mfma_f32_16x16x32_bf16 v[172:175], v[40:43], v[28:31], v[172:175]
    v_mfma_f32_16x16x32_bf16 v[204:207], v[48:51], v[28:31], v[204:207]
    v_mfma_f32_16x16x32_bf16 v[220:223], v[52:55], v[28:31], v[220:223]
    v_mfma_f32_16x16x32_bf16 v[216:219], v[52:55], v[24:27], v[216:219]
    v_mfma_f32_16x16x32_bf16 v[200:203], v[48:51], v[24:27], v[200:203]
    v_mfma_f32_16x16x32_bf16 v[196:199], v[48:51], v[20:23], v[196:199]
    v_mfma_f32_16x16x32_bf16 v[212:215], v[52:55], v[20:23], v[212:215]
    v_mfma_f32_16x16x32_bf16 v[208:211], v[52:55], v[16:19], v[208:211]
    v_mfma_f32_16x16x32_bf16 v[192:195], v[48:51], v[16:19], v[192:195]
    v_mfma_f32_16x16x32_bf16 v[128:131], v[32:35], v[16:19], v[128:131]
    v_mfma_f32_16x16x32_bf16 v[144:147], v[36:39], v[16:19], v[144:147]
    v_mfma_f32_16x16x32_bf16 v[148:151], v[36:39], v[20:23], v[148:151]
    v_mfma_f32_16x16x32_bf16 v[132:135], v[32:35], v[20:23], v[132:135]
    v_mfma_f32_16x16x32_bf16 v[136:139], v[32:35], v[24:27], v[136:139]
    v_mfma_f32_16x16x32_bf16 v[152:155], v[36:39], v[24:27], v[152:155]
    v_mfma_f32_16x16x32_bf16 v[156:159], v[36:39], v[28:31], v[156:159]
    v_mfma_f32_16x16x32_bf16 v[140:143], v[32:35], v[28:31], v[140:143]
    ds_read_b128 v[56:59], v5 offset:0
    ds_read_b64_tr_b16 v[80:81], v6 offset:12288
    ds_read_b64_tr_b16 v[82:83], v6 offset:12800
    ds_read_b128 v[60:63], v5 offset:2048
    ds_read_b128 v[64:67], v5 offset:4096
    ds_read_b128 v[68:71], v5 offset:6144
    ds_read_b64_tr_b16 v[84:85], v7 offset:12288
    ds_read_b64_tr_b16 v[86:87], v7 offset:12800
    ds_read_b64_tr_b16 v[88:89], v6 offset:20480
    ds_read_b64_tr_b16 v[90:91], v6 offset:20992
    ds_read_b64_tr_b16 v[92:93], v7 offset:20480
    ds_read_b64_tr_b16 v[94:95], v7 offset:20992
    ds_read_b64_tr_b16 v[72:73], v6 offset:4096
    ds_read_b64_tr_b16 v[74:75], v6 offset:4608
    ds_read_b64_tr_b16 v[76:77], v7 offset:4096
    ds_read_b64_tr_b16 v[78:79], v7 offset:4608
    s_add_u32 s84, s84, 1
    s_cmp_eq_u32 s82, 2
    s_cselect_b32 s78, s83, 40960
    s_cselect_b32 s82, -1, s82
    s_add_u32 s82, s82, 1
    v_add_u32 v4, s78, v4
    v_add_u32 v5, s78, v5
    v_add_u32 v6, s78, v6
    v_add_u32_e64 v7, s78, v7
    s_waitcnt vmcnt(0) lgkmcnt(0)
    v_mfma_f32_16x16x32_bf16 v[160:163], v[80:83], v[56:59], v[160:163]
    v_mfma_f32_16x16x32_bf16 v[176:179], v[84:87], v[56:59], v[176:179]
    v_mfma_f32_16x16x32_bf16 v[180:183], v[84:87], v[60:63], v[180:183]
    v_mfma_f32_16x16x32_bf16 v[164:167], v[80:83], v[60:63], v[164:167]
    v_mfma_f32_16x16x32_bf16 v[168:171], v[80:83], v[64:67], v[168:171]
    v_mfma_f32_16x16x32_bf16 v[184:187], v[84:87], v[64:67], v[184:187]
    v_mfma_f32_16x16x32_bf16 v[188:191], v[84:87], v[68:71], v[188:191]
    v_mfma_f32_16x16x32_bf16 v[172:175], v[80:83], v[68:71], v[172:175]
    v_mfma_f32_16x16x32_bf16 v[204:207], v[88:91], v[68:71], v[204:207]
    v_mfma_f32_16x16x32_bf16 v[220:223], v[92:95], v[68:71], v[220:223]
    v_mfma_f32_16x16x32_bf16 v[216:219], v[92:95], v[64:67], v[216:219]
    v_mfma_f32_16x16x32_bf16 v[200:203], v[88:91], v[64:67], v[200:203]
    v_mfma_f32_16x16x32_bf16 v[196:199], v[88:91], v[60:63], v[196:199]
    v_mfma_f32_16x16x32_bf16 v[212:215], v[92:95], v[60:63], v[212:215]
    v_mfma_f32_16x16x32_bf16 v[208:211], v[92:95], v[56:59], v[208:211]
    v_mfma_f32_16x16x32_bf16 v[192:195], v[88:91], v[56:59], v[192:195]
    v_mfma_f32_16x16x32_bf16 v[128:131], v[72:75], v[56:59], v[128:131]
    v_mfma_f32_16x16x32_bf16 v[144:147], v[76:79], v[56:59], v[144:147]
    v_mfma_f32_16x16x32_bf16 v[148:151], v[76:79], v[60:63], v[148:151]
    v_mfma_f32_16x16x32_bf16 v[132:135], v[72:75], v[60:63], v[132:135]
    v_mfma_f32_16x16x32_bf16 v[136:139], v[72:75], v[64:67], v[136:139]
    v_mfma_f32_16x16x32_bf16 v[152:155], v[76:79], v[64:67], v[152:155]
    v_mfma_f32_16x16x32_bf16 v[156:159], v[76:79], v[68:71], v[156:159]
    v_mfma_f32_16x16x32_bf16 v[140:143], v[72:75], v[68:71], v[140:143]
    s_barrier
    s_nop 0
    ds_read_b128 v[16:19], v4 offset:0
    ds_read_b64_tr_b16 v[40:41], v6 offset:8192
    ds_read_b64_tr_b16 v[42:43], v6 offset:8704
    ds_read_b128 v[20:23], v4 offset:2048
    ds_read_b128 v[24:27], v4 offset:4096
    ds_read_b128 v[28:31], v4 offset:6144
    ds_read_b64_tr_b16 v[44:45], v7 offset:8192
    ds_read_b64_tr_b16 v[46:47], v7 offset:8704
    ds_read_b64_tr_b16 v[48:49], v6 offset:16384
    ds_read_b64_tr_b16 v[50:51], v6 offset:16896
    ds_read_b64_tr_b16 v[52:53], v7 offset:16384
    ds_read_b64_tr_b16 v[54:55], v7 offset:16896
    ds_read_b64_tr_b16 v[32:33], v6 offset:0
    ds_read_b64_tr_b16 v[34:35], v6 offset:512
    ds_read_b64_tr_b16 v[36:37], v7 offset:0
    ds_read_b64_tr_b16 v[38:39], v7 offset:512
    s_waitcnt lgkmcnt(0)
    s_nop 0
    v_mfma_f32_16x16x32_bf16 v[160:163], v[40:43], v[16:19], v[160:163]
    v_mfma_f32_16x16x32_bf16 v[176:179], v[44:47], v[16:19], v[176:179]
    v_mfma_f32_16x16x32_bf16 v[180:183], v[44:47], v[20:23], v[180:183]
    v_mfma_f32_16x16x32_bf16 v[164:167], v[40:43], v[20:23], v[164:167]
    v_mfma_f32_16x16x32_bf16 v[168:171], v[40:43], v[24:27], v[168:171]
    v_mfma_f32_16x16x32_bf16 v[184:187], v[44:47], v[24:27], v[184:187]
    v_mfma_f32_16x16x32_bf16 v[188:191], v[44:47], v[28:31], v[188:191]
    v_mfma_f32_16x16x32_bf16 v[172:175], v[40:43], v[28:31], v[172:175]
    v_mfma_f32_16x16x32_bf16 v[204:207], v[48:51], v[28:31], v[204:207]
    v_mfma_f32_16x16x32_bf16 v[220:223], v[52:55], v[28:31], v[220:223]
    v_mfma_f32_16x16x32_bf16 v[216:219], v[52:55], v[24:27], v[216:219]
    v_mfma_f32_16x16x32_bf16 v[200:203], v[48:51], v[24:27], v[200:203]
    v_mfma_f32_16x16x32_bf16 v[196:199], v[48:51], v[20:23], v[196:199]
    v_mfma_f32_16x16x32_bf16 v[212:215], v[52:55], v[20:23], v[212:215]
    v_mfma_f32_16x16x32_bf16 v[208:211], v[52:55], v[16:19], v[208:211]
    v_mfma_f32_16x16x32_bf16 v[192:195], v[48:51], v[16:19], v[192:195]
    v_mfma_f32_16x16x32_bf16 v[128:131], v[32:35], v[16:19], v[128:131]
    v_mfma_f32_16x16x32_bf16 v[144:147], v[36:39], v[16:19], v[144:147]
    v_mfma_f32_16x16x32_bf16 v[148:151], v[36:39], v[20:23], v[148:151]
    v_mfma_f32_16x16x32_bf16 v[132:135], v[32:35], v[20:23], v[132:135]
    v_mfma_f32_16x16x32_bf16 v[136:139], v[32:35], v[24:27], v[136:139]
    v_mfma_f32_16x16x32_bf16 v[152:155], v[36:39], v[24:27], v[152:155]
    v_mfma_f32_16x16x32_bf16 v[156:159], v[36:39], v[28:31], v[156:159]
    v_mfma_f32_16x16x32_bf16 v[140:143], v[32:35], v[28:31], v[140:143]
    ds_read_b128 v[56:59], v5 offset:0
    ds_read_b64_tr_b16 v[80:81], v6 offset:12288
    ds_read_b64_tr_b16 v[82:83], v6 offset:12800
    ds_read_b128 v[60:63], v5 offset:2048
    ds_read_b128 v[64:67], v5 offset:4096
    ds_read_b128 v[68:71], v5 offset:6144
    ds_read_b64_tr_b16 v[84:85], v7 offset:12288
    ds_read_b64_tr_b16 v[86:87], v7 offset:12800
    ds_read_b64_tr_b16 v[88:89], v6 offset:20480
    ds_read_b64_tr_b16 v[90:91], v6 offset:20992
    ds_read_b64_tr_b16 v[92:93], v7 offset:20480
    ds_read_b64_tr_b16 v[94:95], v7 offset:20992
    ds_read_b64_tr_b16 v[72:73], v6 offset:4096
    ds_read_b64_tr_b16 v[74:75], v6 offset:4608
    ds_read_b64_tr_b16 v[76:77], v7 offset:4096
    ds_read_b64_tr_b16 v[78:79], v7 offset:4608
    s_add_u32 s84, s84, 1
    s_cmp_eq_u32 s82, 2
    s_cselect_b32 s78, s83, 40960
    s_cselect_b32 s82, -1, s82
    s_add_u32 s82, s82, 1
    v_add_u32 v4, s78, v4
    v_add_u32 v5, s78, v5
    v_add_u32 v6, s78, v6
    v_add_u32_e64 v7, s78, v7
    s_waitcnt vmcnt(0) lgkmcnt(0)
    v_mfma_f32_16x16x32_bf16 v[160:163], v[80:83], v[56:59], v[160:163]
    v_mfma_f32_16x16x32_bf16 v[176:179], v[84:87], v[56:59], v[176:179]
    v_mfma_f32_16x16x32_bf16 v[180:183], v[84:87], v[60:63], v[180:183]
    v_mfma_f32_16x16x32_bf16 v[164:167], v[80:83], v[60:63], v[164:167]
    v_mfma_f32_16x16x32_bf16 v[168:171], v[80:83], v[64:67], v[168:171]
    v_mfma_f32_16x16x32_bf16 v[184:187], v[84:87], v[64:67], v[184:187]
    v_mfma_f32_16x16x32_bf16 v[188:191], v[84:87], v[68:71], v[188:191]
    v_mfma_f32_16x16x32_bf16 v[172:175], v[80:83], v[68:71], v[172:175]
    v_mfma_f32_16x16x32_bf16 v[204:207], v[88:91], v[68:71], v[204:207]
    v_mfma_f32_16x16x32_bf16 v[220:223], v[92:95], v[68:71], v[220:223]
    v_mfma_f32_16x16x32_bf16 v[216:219], v[92:95], v[64:67], v[216:219]
    v_mfma_f32_16x16x32_bf16 v[200:203], v[88:91], v[64:67], v[200:203]
    v_mfma_f32_16x16x32_bf16 v[196:199], v[88:91], v[60:63], v[196:199]
    v_mfma_f32_16x16x32_bf16 v[212:215], v[92:95], v[60:63], v[212:215]
    v_mfma_f32_16x16x32_bf16 v[208:211], v[92:95], v[56:59], v[208:211]
    v_mfma_f32_16x16x32_bf16 v[192:195], v[88:91], v[56:59], v[192:195]
    v_mfma_f32_16x16x32_bf16 v[128:131], v[72:75], v[56:59], v[128:131]
    v_mfma_f32_16x16x32_bf16 v[144:147], v[76:79], v[56:59], v[144:147]
    v_mfma_f32_16x16x32_bf16 v[148:151], v[76:79], v[60:63], v[148:151]
    v_mfma_f32_16x16x32_bf16 v[132:135], v[72:75], v[60:63], v[132:135]
    v_mfma_f32_16x16x32_bf16 v[136:139], v[72:75], v[64:67], v[136:139]
    v_mfma_f32_16x16x32_bf16 v[152:155], v[76:79], v[64:67], v[152:155]
    v_mfma_f32_16x16x32_bf16 v[156:159], v[76:79], v[68:71], v[156:159]
    v_mfma_f32_16x16x32_bf16 v[140:143], v[72:75], v[68:71], v[140:143]
    s_mov_b64 exec, 0
    s_cmp_lg_u32 s76, 0
    s_cbranch_scc1 Lt_42
    s_call_b64 s[90:91], L_pad0
Lt_42:
    s_cmp_lg_u32 s76, 1
    s_cbranch_scc1 Lt_43
    s_call_b64 s[90:91], L_pad1
Lt_43:
    s_cmp_lg_u32 s76, 2
    s_cbranch_scc1 Lt_44
    s_call_b64 s[90:91], L_pad2
Lt_44:
    s_cmp_lg_u32 s76, 3
    s_cbranch_scc1 Lt_45
    s_call_b64 s[90:91], L_pad3
Lt_45:
    s_mov_b64 exec, -1
    s_barrier
    s_nop 0
    ds_read_b128 v[16:19], v4 offset:0
    ds_read_b64_tr_b16 v[40:41], v6 offset:8192
    ds_read_b64_tr_b16 v[42:43], v6 offset:8704
    ds_read_b128 v[20:23], v4 offset:2048
    ds_read_b128 v[24:27], v4 offset:4096
    ds_read_b128 v[28:31], v4 offset:6144
    ds_read_b64_tr_b16 v[44:45], v7 offset:8192
    ds_read_b64_tr_b16 v[46:47], v7 offset:8704
    ds_read_b64_tr_b16 v[48:49], v6 offset:16384
    ds_read_b64_tr_b16 v[50:51], v6 offset:16896
    ds_read_b64_tr_b16 v[52:53], v7 offset:16384
    ds_read_b64_tr_b16 v[54:55], v7 offset:16896
    ds_read_b64_tr_b16 v[32:33], v6 offset:0
    ds_read_b64_tr_b16 v[34:35], v6 offset:512
    ds_read_b64_tr_b16 v[36:37], v7 offset:0
L_pad5:
    s_cbranch_execz L_pad9
    ds_read_b64_tr_b16 v[38:39], v7 offset:512
    s_waitcnt lgkmcnt(0)
    v_mfma_f32_16x16x32_bf16 v[160:163], v[40:43], v[16:19], v[160:163]
    v_mfma_f32_16x16x32_bf16 v[176:179], v[44:47], v[16:19], v[176:179]
    v_mfma_f32_16x16x32_bf16 v[180:183], v[44:47], v[20:23], v[180:183]
    v_mfma_f32_16x16x32_bf16 v[164:167], v[40:43], v[20:23], v[164:167]
    v_mfma_f32_16x16x32_bf16 v[168:171], v[40:43], v[24:27], v[168:171]
    v_mfma_f32_16x16x32_bf16 v[184:187], v[44:47], v[24:27], v[184:187]
    v_mfma_f32_16x16x32_bf16 v[188:191], v[44:47], v[28:31], v[188:191]
    v_mfma_f32_16x16x32_bf16 v[172:175], v[40:43], v[28:31], v[172:175]
    v_mfma_f32_16x16x32_bf16 v[204:207], v[48:51], v[28:31], v[204:207]
    v_mfma_f32_16x16x32_bf16 v[220:223], v[52:55], v[28:31], v[220:223]
    v_mfma_f32_16x16x32_bf16 v[216:219], v[52:55], v[24:27], v[216:219]
    v_mfma_f32_16x16x32_bf16 v[200:203], v[48:51], v[24:27], v[200:203]
    v_mfma_f32_16x16x32_bf16 v[196:199], v[48:51], v[20:23], v[196:199]
    v_mfma_f32_16x16x32_bf16 v[212:215], v[52:55], v[20:23], v[212:215]
    v_mfma_f32_16x16x32_bf16 v[208:211], v[52:55], v[16:19], v[208:211]
    v_mfma_f32_16x16x32_bf16 v[192:195], v[48:51], v[16:19], v[192:195]
    v_mfma_f32_16x16x32_bf16 v[128:131], v[32:35], v[16:19], v[128:131]
    v_mfma_f32_16x16x32_bf16 v[144:147], v[36:39], v[16:19], v[144:147]
    v_mfma_f32_16x16x32_bf16 v[148:151], v[36:39], v[20:23], v[148:151]
    v_mfma_f32_16x16x32_bf16 v[132:135], v[32:35], v[20:23], v[132:135]
    v_mfma_f32_16x16x32_bf16 v[136:139], v[32:35], v[24:27], v[136:139]
    v_mfma_f32_16x16x32_bf16 v[152:155], v[36:39], v[24:27], v[152:155]
    v_mfma_f32_16x16x32_bf16 v[156:159], v[36:39], v[28:31], v[156:159]
    v_mfma_f32_16x16x32_bf16 v[140:143], v[32:35], v[28:31], v[140:143]
    ds_read_b128 v[56:59], v5 offset:0
    ds_read_b64_tr_b16 v[80:81], v6 offset:12288
    ds_read_b64_tr_b16 v[82:83], v6 offset:12800
    ds_read_b128 v[60:63], v5 offset:2048
    ds_read_b128 v[64:67], v5 offset:4096
    ds_read_b128 v[68:71], v5 offset:6144
    ds_read_b64_tr_b16 v[84:85], v7 offset:12288
    ds_read_b64_tr_b16 v[86:87], v7 offset:12800
    ds_read_b64_tr_b16 v[88:89], v6 offset:20480
    ds_read_b64_tr_b16 v[90:91], v6 offset:20992
    ds_read_b64_tr_b16 v[92:93], v7 offset:20480
    ds_read_b64_tr_b16 v[94:95], v7 offset:20992
    ds_read_b64_tr_b16 v[72:73], v6 offset:4096
    ds_read_b64_tr_b16 v[74:75], v6 offset:4608
    ds_read_b64_tr_b16 v[76:77], v7 offset:4096
    ds_read_b64_tr_b16 v[78:79], v7 offset:4608
    s_add_u32 s84, s84, 1
    s_cmp_eq_u32 s82, 2
    s_cselect_b32 s78, s83, 40960
    s_cselect_b32 s82, -1, s82
    s_add_u32 s82, s82, 1
    v_add_u32 v4, s78, v4
    v_add_u32 v5, s78, v5
    v_add_u32 v6, s78, v6
    v_add_u32_e64 v7, s78, v7
    s_waitcnt vmcnt(0) lgkmcnt(0)
    v_mfma_f32_16x16x32_bf16 v[160:163], v[80:83], v[56:59], v[160:163]
    v_mfma_f32_16x16x32_bf16 v[176:179], v[84:87], v[56:59], v[176:179]
    v_mfma_f32_16x16x32_bf16 v[180:183], v[84:87], v[60:63], v[180:183]
    v_mfma_f32_16x16x32_bf16 v[164:167], v[80:83], v[60:63], v[164:167]
    v_mfma_f32_16x16x32_bf16 v[168:171], v[80:83], v[64:67], v[168:171]
    v_mfma_f32_16x16x32_bf16 v[184:187], v[84:87], v[64:67], v[184:187]
    v_mfma_f32_16x16x32_bf16 v[188:191], v[84:87], v[68:71], v[188:191]
    v_mfma_f32_16x16x32_bf16 v[172:175], v[80:83], v[68:71], v[172:175]
    v_mfma_f32_16x16x32_bf16 v[204:207], v[88:91], v[68:71], v[204:207]
    v_mfma_f32_16x16x32_bf16 v[220:223], v[92:95], v[68:71], v[220:223]
    v_mfma_f32_16x16x32_bf16 v[216:219], v[92:95], v[64:67], v[216:219]
    v_mfma_f32_16x16x32_bf16 v[200:203], v[88:91], v[64:67], v[200:203]
    v_mfma_f32_16x16x32_bf16 v[196:199], v[88:91], v[60:63], v[196:199]
    v_mfma_f32_16x16x32_bf16 v[212:215], v[92:95], v[60:63], v[212:215]
    v_mfma_f32_16x16x32_bf16 v[208:211], v[92:95], v[56:59], v[208:211]
    v_mfma_f32_16x16x32_bf16 v[192:195], v[88:91], v[56:59], v[192:195]
    v_mfma_f32_16x16x32_bf16 v[128:131], v[72:75], v[56:59], v[128:131]
    v_mfma_f32_16x16x32_bf16 v[144:147], v[76:79], v[56:59], v[144:147]
    v_mfma_f32_16x16x32_bf16 v[148:151], v[76:79], v[60:63], v[148:151]
    v_mfma_f32_16x16x32_bf16 v[132:135], v[72:75], v[60:63], v[132:135]
    v_mfma_f32_16x16x32_bf16 v[136:139], v[72:75], v[64:67], v[136:139]
    v_mfma_f32_16x16x32_bf16 v[152:155], v[76:79], v[64:67], v[152:155]
    v_mfma_f32_16x16x32_bf16 v[156:159], v[76:79], v[68:71], v[156:159]
    v_mfma_f32_16x16x32_bf16 v[140:143], v[72:75], v[68:71], v[140:143]
    s_barrier
    s_nop 0
    ds_read_b128 v[16:19], v4 offset:0
    ds_read_b64_tr_b16 v[40:41], v6 offset:8192
    ds_read_b64_tr_b16 v[42:43], v6 offset:8704
    ds_read_b128 v[20:23], v4 offset:2048
    ds_read_b128 v[24:27], v4 offset:4096
    ds_read_b128 v[28:31], v4 offset:6144
    ds_read_b64_tr_b16 v[44:45], v7 offset:8192
    ds_read_b64_tr_b16 v[46:47], v7 offset:8704
    ds_read_b64_tr_b16 v[48:49], v6 offset:16384
    ds_read_b64_tr_b16 v[50:51], v6 offset:16896
    ds_read_b64_tr_b16 v[52:53], v7 offset:16384
    ds_read_b64_tr_b16 v[54:55], v7 offset:16896
    ds_read_b64_tr_b16 v[32:33], v6 offset:0
    ds_read_b64_tr_b16 v[34:35], v6 offset:512
    ds_read_b64_tr_b16 v[36:37], v7 offset:0
    ds_read_b64_tr_b16 v[38:39], v7 offset:512
    .p2align 3
L_Mloop:
    s_waitcnt lgkmcnt(0)
    s_nop 0
    v_mfma_f32_16x16x32_bf16 v[160:163], v[40:43], v[16:19], v[160:163]
    ds_read_b128 v[56:59], v5 offset:0
    v_mfma_f32_16x16x32_bf16 v[176:179], v[44:47], v[16:19], v[176:179]
    ds_read_b64_tr_b16 v[80:81], v6 offset:12288
    v_mfma_f32_16x16x32_bf16 v[180:183], v[44:47], v[20:23], v[180:183]
    ds_read_b64_tr_b16 v[82:83], v6 offset:12800
    v_mfma_f32_16x16x32_bf16 v[164:167], v[40:43], v[20:23], v[164:167]
    ds_read_b128 v[60:63], v5 offset:2048
    v_mfma_f32_16x16x32_bf16 v[168:171], v[40:43], v[24:27], v[168:171]
    ds_read_b128 v[64:67], v5 offset:4096
    v_mfma_f32_16x16x32_bf16 v[184:187], v[44:47], v[24:27], v[184:187]
    ds_read_b128 v[68:71], v5 offset:6144
    v_mfma_f32_16x16x32_bf16 v[188:191], v[44:47], v[28:31], v[188:191]
    ds_read_b64_tr_b16 v[84:85], v7 offset:12288
    v_mfma_f32_16x16x32_bf16 v[172:175], v[40:43], v[28:31], v[172:175]
    ds_read_b64_tr_b16 v[86:87], v7 offset:12800
    v_mfma_f32_16x16x32_bf16 v[204:207], v[48:51], v[28:31], v[204:207]
    ds_read_b64_tr_b16 v[88:89], v6 offset:20480
    v_mfma_f32_16x16x32_bf16 v[220:223], v[52:55], v[28:31], v[220:223]
    ds_read_b64_tr_b16 v[90:91], v6 offset:20992
    v_mfma_f32_16x16x32_bf16 v[216:219], v[52:55], v[24:27], v[216:219]
    ds_read_b64_tr_b16 v[92:93], v7 offset:20480
    v_mfma_f32_16x16x32_bf16 v[200:203], v[48:51], v[24:27], v[200:203]
    ds_read_b64_tr_b16 v[94:95], v7 offset:20992
    v_mfma_f32_16x16x32_bf16 v[196:199], v[48:51], v[20:23], v[196:199]
    ds_read_b64_tr_b16 v[72:73], v6 offset:4096
    v_mfma_f32_16x16x32_bf16 v[212:215], v[52:55], v[20:23], v[212:215]
    ds_read_b64_tr_b16 v[74:75], v6 offset:4608
    v_mfma_f32_16x16x32_bf16 v[208:211], v[52:55], v[16:19], v[208:211]
    ds_read_b64_tr_b16 v[76:77], v7 offset:4096
    v_mfma_f32_16x16x32_bf16 v[192:195], v[48:51], v[16:19], v[192:195]
    ds_read_b64_tr_b16 v[78:79], v7 offset:4608
    v_mfma_f32_16x16x32_bf16 v[128:131], v[32:35], v[16:19], v[128:131]
    s_add_u32 s84, s84, 1
    s_cmp_eq_u32 s82, 2
    s_cselect_b32 s78, s83, 40960
    s_cselect_b32 s82, -1, s82
    s_add_u32 s82, s82, 1
    v_mfma_f32_16x16x32_bf16 v[144:147], v[36:39], v[16:19], v[144:147]
    v_add_u32 v4, s78, v4
    v_add_u32 v5, s78, v5
    v_mfma_f32_16x16x32_bf16 v[148:151], v[36:39], v[20:23], v[148:151]
    v_add_u32 v6, s78, v6
    v_add_u32 v7, s78, v7
    v_mfma_f32_16x16x32_bf16 v[132:135], v[32:35], v[20:23], v[132:135]
    v_mfma_f32_16x16x32_bf16 v[136:139], v[32:35], v[24:27], v[136:139]
    v_mfma_f32_16x16x32_bf16 v[152:155], v[36:39], v[24:27], v[152:155]
    v_mfma_f32_16x16x32_bf16 v[156:159], v[36:39], v[28:31], v[156:159]
    v_mfma_f32_16x16x32_bf16 v[140:143], v[32:35], v[28:31], v[140:143]
    s_waitcnt vmcnt(0) lgkmcnt(0)
    v_mfma_f32_16x16x32_bf16 v[160:163], v[80:83], v[56:59], v[160:163]
    v_mfma_f32_16x16x32_bf16 v[176:179], v[84:87], v[56:59], v[176:179]
    s_barrier
    s_cmp_eq_u32 s84, 16
    s_cbranch_scc1 L_Mtail
    v_mfma_f32_16x16x32_bf16 v[180:183], v[84:87], v[60:63], v[180:183]
    ds_read_b128 v[16:19], v4 offset:0
    v_mfma_f32_16x16x32_bf16 v[164:167], v[80:83], v[60:63], v[164:167]
    ds_read_b64_tr_b16 v[40:41], v6 offset:8192
    v_mfma_f32_16x16x32_bf16 v[168:171], v[80:83], v[64:67], v[168:171]
    ds_read_b64_tr_b16 v[42:43], v6 offset:8704
    v_mfma_f32_16x16x32_bf16 v[184:187], v[84:87], v[64:67], v[184:187]
    ds_read_b128 v[20:23], v4 offset:2048
    v_mfma_f32_16x16x32_bf16 v[188:191], v[84:87], v[68:71], v[188:191]
    ds_read_b128 v[24:27], v4 offset:4096
    v_mfma_f32_16x16x32_bf16 v[172:175], v[80:83], v[68:71], v[172:175]
    ds_read_b128 v[28:31], v4 offset:6144
    v_mfma_f32_16x16x32_bf16 v[204:207], v[88:91], v[68:71], v[204:207]
    ds_read_b64_tr_b16 v[44:45], v7 offset:8192
    v_mfma_f32_16x16x32_bf16 v[220:223], v[92:95], v[68:71], v[220:223]
    ds_read_b64_tr_b16 v[46:47], v7 offset:8704
    v_mfma_f32_16x16x32_bf16 v[216:219], v[92:95], v[64:67], v[216:219]
    ds_read_b64_tr_b16 v[48:49], v6 offset:16384
    v_mfma_f32_16x16x32_bf16 v[200:203], v[88:91], v[64:67], v[200:203]
    ds_read_b64_tr_b16 v[50:51], v6 offset:16896
    v_mfma_f32_16x16x32_bf16 v[196:199], v[88:91], v[60:63], v[196:199]
    ds_read_b64_tr_b16 v[52:53], v7 offset:16384
    v_mfma_f32_16x16x32_bf16 v[212:215], v[92:95], v[60:63], v[212:215]
    ds_read_b64_tr_b16 v[54:55], v7 offset:16896
    v_mfma_f32_16x16x32_bf16 v[208:211], v[92:95], v[56:59], v[208:211]
    ds_read_b64_tr_b16 v[32:33], v6 offset:0
    v_mfma_f32_16x16x32_bf16 v[192:195], v[88:91], v[56:59], v[192:195]
    ds_read_b64_tr_b16 v[34:35], v6 offset:512
    v_mfma_f32_16x16x32_bf16 v[128:131], v[72:75], v[56:59], v[128:131]
    ds_read_b64_tr_b16 v[36:37], v7 offset:0
    v_mfma_f32_16x16x32_bf16 v[144:147], v[76:79], v[56:59], v[144:147]
    ds_read_b64_tr_b16 v[38:39], v7 offset:512
    v_mfma_f32_16x16x32_bf16 v[148:151], v[76:79], v[60:63], v[148:151]
    v_mfma_f32_16x16x32_bf16 v[132:135], v[72:75], v[60:63], v[132:135]
    v_mfma_f32_16x16x32_bf16 v[136:139], v[72:75], v[64:67], v[136:139]
    v_mfma_f32_16x16x32_bf16 v[152:155], v[76:79], v[64:67], v[152:155]
    v_mfma_f32_16x16x32_bf16 v[156:159], v[76:79], v[68:71], v[156:159]
    v_mfma_f32_16x16x32_bf16 v[140:143], v[72:75], v[68:71], v[140:143]
    s_branch L_Mloop
    .p2align 3
L_Mtail:
    s_mov_b64 exec, 0xffff
    ds_read_b64 v[104:105], v11 offset:0
    ds_read_b64 v[106:107], v11 offset:128
    ds_read_b64 v[108:109], v11 offset:256
    ds_read_b64 v[110:111], v11 offset:384
    s_mov_b64 exec, -1
    s_nop 0
    v_mfma_f32_16x16x32_bf16 v[180:183], v[84:87], v[60:63], v[180:183]
    ds_read_b64 v[20:21], v12 offset:512
    v_mfma_f32_16x16x32_bf16 v[164:167], v[80:83], v[60:63], v[164:167]
    ds_read_b64 v[22:23], v12 offset:640
    v_mfma_f32_16x16x32_bf16 v[168:171], v[80:83], v[64:67], v[168:171]
    ds_read_b64 v[24:25], v12 offset:1024
    v_mfma_f32_16x16x32_bf16 v[184:187], v[84:87], v[64:67], v[184:187]
    ds_read_b64 v[26:27], v12 offset:1152
    v_mfma_f32_16x16x32_bf16 v[188:191], v[84:87], v[68:71], v[188:191]
    ds_read_b64 v[16:17], v12 offset:0
    v_mfma_f32_16x16x32_bf16 v[172:175], v[80:83], v[68:71], v[172:175]
    ds_read_b64 v[18:19], v12 offset:128
    v_mfma_f32_16x16x32_bf16 v[204:207], v[88:91], v[68:71], v[204:207]
    ds_read2_b32 v[32:33], v14 offset0:0 offset1:32
    v_mfma_f32_16x16x32_bf16 v[220:223], v[92:95], v[68:71], v[220:223]
    ds_read_b32 v28, v13 offset:0
    v_mfma_f32_16x16x32_bf16 v[216:219], v[92:95], v[64:67], v[216:219]
    ds_read_b32 v30, v13 offset:64
    v_mfma_f32_16x16x32_bf16 v[200:203], v[88:91], v[64:67], v[200:203]
    ds_read_b32 v44, v13 offset:128
    v_mfma_f32_16x16x32_bf16 v[196:199], v[88:91], v[60:63], v[196:199]
    ds_read_b32 v46, v13 offset:192
    v_mfma_f32_16x16x32_bf16 v[212:215], v[92:95], v[60:63], v[212:215]
    v_mfma_f32_16x16x32_bf16 v[208:211], v[92:95], v[56:59], v[208:211]
    v_mfma_f32_16x16x32_bf16 v[192:195], v[88:91], v[56:59], v[192:195]
    s_waitcnt lgkmcnt(0)
    s_nop 0
    v_mfma_f32_16x16x16_bf16 v[160:163], v[20:21], v[104:105], v[160:163]
    v_mfma_f32_16x16x16_bf16 v[176:179], v[22:23], v[104:105], v[176:179]
    v_mfma_f32_16x16x16_bf16 v[164:167], v[20:21], v[106:107], v[164:167]
    v_mfma_f32_16x16x16_bf16 v[180:183], v[22:23], v[106:107], v[180:183]
    v_mfma_f32_16x16x16_bf16 v[168:171], v[20:21], v[108:109], v[168:171]
    v_mfma_f32_16x16x16_bf16 v[184:187], v[22:23], v[108:109], v[184:187]
    v_mfma_f32_16x16x16_bf16 v[172:175], v[20:21], v[110:111], v[172:175]
    v_mfma_f32_16x16x16_bf16 v[188:191], v[22:23], v[110:111], v[188:191]
    v_mul_f32 v34, 0x3fb8aa3b, v32
    v_mul_f32 v48, 0x3fb8aa3b, v33
    v_mfma_f32_16x16x16_bf16 v[192:195], v[24:25], v[104:105], v[192:195]
    v_mfma_f32_16x16x16_bf16 v[208:211], v[26:27], v[104:105], v[208:211]
    v_mfma_f32_16x16x16_bf16 v[196:199], v[24:25], v[106:107], v[196:199]
    v_cvt_pk_bf16_f32 v160, v160, v161
    v_cvt_pk_bf16_f32 v161, v162, v163
    v_cvt_pk_bf16_f32 v162, v176, v177
    v_cvt_pk_bf16_f32 v163, v178, v179
    v_mfma_f32_16x16x16_bf16 v[212:215], v[26:27], v[106:107], v[212:215]
    v_cvt_pk_bf16_f32 v164, v164, v165
    v_cvt_pk_bf16_f32 v165, v166, v167
    v_cvt_pk_bf16_f32 v166, v180, v181
    v_cvt_pk_bf16_f32 v167, v182, v183
    v_mfma_f32_16x16x16_bf16 v[200:203], v[24:25], v[108:109], v[200:203]
    v_cvt_pk_bf16_f32 v168, v168, v169
    v_cvt_pk_bf16_f32 v169, v170, v171
    v_cvt_pk_bf16_f32 v170, v184, v185
    v_cvt_pk_bf16_f32 v171, v186, v187
    v_mfma_f32_16x16x16_bf16 v[216:219], v[26:27], v[108:109], v[216:219]
    v_cvt_pk_bf16_f32 v172, v172, v173
    v_cvt_pk_bf16_f32 v173, v174, v175
    v_cvt_pk_bf16_f32 v174, v188, v189
    v_cvt_pk_bf16_f32 v175, v190, v191
    v_mfma_f32_16x16x16_bf16 v[204:207], v[24:25], v[110:111], v[204:207]
    v_permlane16_swap_b32 v160, v164
    v_permlane16_swap_b32 v161, v165
    v_permlane16_swap_b32 v162, v166
    v_permlane16_swap_b32 v163, v167
    v_mfma_f32_16x16x16_bf16 v[220:223], v[26:27], v[110:111], v[220:223]
    v_permlane16_swap_b32 v168, v172
    v_permlane16_swap_b32 v169, v173
    v_permlane16_swap_b32 v170, v174
    v_permlane16_swap_b32 v171, v175
    v_mfma_f32_32x32x16_bf16 v[224:239], v[96:99], v[160:163], 0
    v_mfma_f32_32x32x16_bf16 v[224:239], v[100:103], v[164:167], v[224:239]
    v_mfma_f32_32x32x16_bf16 v[240:255], v[96:99], v[168:171], 0
    v_mfma_f32_32x32x16_bf16 v[240:255], v[100:103], v[172:175], v[240:255]
    v_pk_mul_f32 v[192:193], v[192:193], v[28:29] op_sel_hi:[1,0]
    v_pk_mul_f32 v[194:195], v[194:195], v[28:29] op_sel_hi:[1,0]
    v_pk_mul_f32 v[208:209], v[208:209], v[28:29] op_sel_hi:[1,0]
    v_pk_mul_f32 v[210:211], v[210:211], v[28:29] op_sel_hi:[1,0]
L_pad6:
    s_cbranch_execz L_pad10
    s_nop 0
    v_cvt_pk_bf16_f32 v192, v192, v193
    v_cvt_pk_bf16_f32 v193, v194, v195
    v_cvt_pk_bf16_f32 v194, v208, v209
    v_cvt_pk_bf16_f32 v195, v210, v211
    v_pk_mul_f32 v[196:197], v[196:197], v[30:31] op_sel_hi:[1,0]
    v_pk_mul_f32 v[198:199], v[198:199], v[30:31] op_sel_hi:[1,0]
    v_pk_mul_f32 v[212:213], v[212:213], v[30:31] op_sel_hi:[1,0]
    v_pk_mul_f32 v[214:215], v[214:215], v[30:31] op_sel_hi:[1,0]
    v_cvt_pk_bf16_f32 v196, v196, v197
    v_cvt_pk_bf16_f32 v197, v198, v199
    v_cvt_pk_bf16_f32 v198, v212, v213
    v_cvt_pk_bf16_f32 v199, v214, v215
    v_pk_mul_f32 v[200:201], v[200:201], v[44:45] op_sel_hi:[1,0]
    v_pk_mul_f32 v[202:203], v[202:203], v[44:45] op_sel_hi:[1,0]
    v_pk_mul_f32 v[216:217], v[216:217], v[44:45] op_sel_hi:[1,0]
    v_pk_mul_f32 v[218:219], v[218:219], v[44:45] op_sel_hi:[1,0]
    v_cvt_pk_bf16_f32 v200, v200, v201
    v_cvt_pk_bf16_f32 v201, v202, v203
    v_cvt_pk_bf16_f32 v202, v216, v217
    v_cvt_pk_bf16_f32 v203, v218, v219
    v_pk_mul_f32 v[204:205], v[204:205], v[46:47] op_sel_hi:[1,0]
    v_pk_mul_f32 v[206:207], v[206:207], v[46:47] op_sel_hi:[1,0]
    v_pk_mul_f32 v[220:221], v[220:221], v[46:47] op_sel_hi:[1,0]
    v_pk_mul_f32 v[222:223], v[222:223], v[46:47] op_sel_hi:[1,0]
    v_cvt_pk_bf16_f32 v204, v204, v205
    v_cvt_pk_bf16_f32 v205, v206, v207
    v_cvt_pk_bf16_f32 v206, v220, v221
    v_cvt_pk_bf16_f32 v207, v222, v223
    v_mfma_f32_16x16x32_bf16 v[128:131], v[72:75], v[56:59], v[128:131]
    v_max3_f32 v36, v224, v225, v226
    v_max3_f32 v38, -v224, -v225, -v226
    v_max3_f32 v36, v36, v227, v228
    v_max3_f32 v38, v38, -v227, -v228
    v_mfma_f32_16x16x32_bf16 v[144:147], v[76:79], v[56:59], v[144:147]
    v_max3_f32 v36, v36, v229, v230
    v_max3_f32 v38, v38, -v229, -v230
    v_max3_f32 v36, v36, v231, v232
    v_max3_f32 v38, v38, -v231, -v232
    v_mfma_f32_16x16x32_bf16 v[148:151], v[76:79], v[60:63], v[148:151]
    v_max3_f32 v36, v36, v233, v234
    v_max3_f32 v38, v38, -v233, -v234
    v_max3_f32 v36, v36, v235, v236
    v_max3_f32 v38, v38, -v235, -v236
    v_mfma_f32_16x16x32_bf16 v[132:135], v[72:75], v[60:63], v[132:135]
    v_max3_f32 v36, v36, v237, v238
    v_max3_f32 v38, v38, -v237, -v238
    v_max_f32_e64 v36, v36, v239
    v_max_f32 v38, v38, -v239
    v_mfma_f32_16x16x32_bf16 v[136:139], v[72:75], v[64:67], v[136:139]
    v_max3_f32 v37, v240, v241, v242
    v_max3_f32 v39, -v240, -v241, -v242
    v_max3_f32 v37, v37, v243, v244
    v_max3_f32 v39, v39, -v243, -v244
    v_mfma_f32_16x16x32_bf16 v[152:155], v[76:79], v[64:67], v[152:155]
    v_max3_f32 v37, v37, v245, v246
    v_max3_f32 v39, v39, -v245, -v246
    v_max3_f32 v37, v37, v247, v248
    v_max3_f32 v39, v39, -v247, -v248
    v_mfma_f32_16x16x32_bf16 v[156:159], v[76:79], v[68:71], v[156:159]
    v_max3_f32 v37, v37, v249, v250
    v_max3_f32 v39, v39, -v249, -v250
    v_max3_f32 v37, v37, v251, v252
    v_max3_f32 v39, v39, -v251, -v252
    v_mfma_f32_16x16x32_bf16 v[140:143], v[72:75], v[68:71], v[140:143]
    v_max3_f32 v37, v37, v253, v254
    v_max3_f32 v39, v39, -v253, -v254
    v_max_f32_e64 v37, v37, v255
    v_max_f32 v39, v39, -v255
    v_permlane32_swap_b32 v36, v38
    s_nop 0
    v_permlane32_swap_b32 v37, v39
    v_max_f32 v36, v36, v38
    v_max_f32_e64 v37, v37, v39
    v_mul_f32 v36, -v36, v34
    v_mul_f32 v37, -v37, v48
    v_mov_b32 v38, v36
    v_mov_b32 v39, v37
    s_nop 0
    v_permlane32_swap_b32 v36, v38
    v_permlane32_swap_b32_e64 v37, v39
    v_pk_fma_f32 v[60:61], v[224:225], v[34:35], v[36:37] op_sel_hi:[1,0,0]
    v_pk_fma_f32 v[62:63], v[226:227], v[34:35], v[36:37] op_sel_hi:[1,0,0]
    v_pk_fma_f32 v[64:65], v[228:229], v[34:35], v[36:37] op_sel_hi:[1,0,0]
    v_pk_fma_f32 v[66:67], v[230:231], v[34:35], v[36:37] op_sel_hi:[1,0,0]
    v_pk_fma_f32 v[68:69], v[232:233], v[34:35], v[36:37] op_sel_hi:[1,0,0]
    v_pk_fma_f32 v[70:71], v[234:235], v[34:35], v[36:37] op_sel_hi:[1,0,0]
    v_pk_fma_f32 v[72:73], v[236:237], v[34:35], v[36:37] op_sel_hi:[1,0,0]
    v_pk_fma_f32 v[74:75], v[238:239], v[34:35], v[36:37] op_sel_hi:[1,0,0]
    v_pk_fma_f32 v[76:77], v[224:225], v[34:35], v[38:39] op_sel_hi:[1,0,0] neg_lo:[1,0,0] neg_hi:[1,0,0]
    v_pk_fma_f32 v[78:79], v[226:227], v[34:35], v[38:39] op_sel_hi:[1,0,0] neg_lo:[1,0,0] neg_hi:[1,0,0]
    v_pk_fma_f32 v[80:81], v[228:229], v[34:35], v[38:39] op_sel_hi:[1,0,0] neg_lo:[1,0,0] neg_hi:[1,0,0]
    v_pk_fma_f32 v[82:83], v[230:231], v[34:35], v[38:39] op_sel_hi:[1,0,0] neg_lo:[1,0,0] neg_hi:[1,0,0]
    v_pk_fma_f32 v[84:85], v[232:233], v[34:35], v[38:39] op_sel_hi:[1,0,0] neg_lo:[1,0,0] neg_hi:[1,0,0]
    v_pk_fma_f32 v[86:87], v[234:235], v[34:35], v[38:39] op_sel_hi:[1,0,0] neg_lo:[1,0,0] neg_hi:[1,0,0]
    v_pk_fma_f32 v[88:89], v[236:237], v[34:35], v[38:39] op_sel_hi:[1,0,0] neg_lo:[1,0,0] neg_hi:[1,0,0]
    v_pk_fma_f32 v[90:91], v[238:239], v[34:35], v[38:39] op_sel_hi:[1,0,0] neg_lo:[1,0,0] neg_hi:[1,0,0]
    v_exp_f32 v60, v60
    v_exp_f32 v61, v61
    v_exp_f32 v62, v62
    v_exp_f32 v63, v63
    v_exp_f32 v64, v64
    v_exp_f32 v65, v65
    v_exp_f32 v66, v66
    v_exp_f32 v67, v67
    v_exp_f32 v68, v68
    v_exp_f32 v69, v69
    v_exp_f32 v70, v70
    v_exp_f32 v71, v71
    v_exp_f32 v72, v72
    v_exp_f32 v73, v73
    v_exp_f32 v74, v74
    v_exp_f32 v75, v75
    v_exp_f32 v76, v76
    v_exp_f32 v77, v77
    v_exp_f32 v78, v78
    v_exp_f32 v79, v79
    v_exp_f32 v80, v80
    v_exp_f32 v81, v81
    v_exp_f32 v82, v82
    v_exp_f32 v83, v83
    v_exp_f32 v84, v84
    v_exp_f32 v85, v85
    v_exp_f32 v86, v86
    v_exp_f32 v87, v87
    v_exp_f32 v88, v88
    v_exp_f32 v89, v89
    v_exp_f32 v90, v90
    v_exp_f32 v91, v91
    v_pk_add_f32 v[40:41], v[60:61], v[62:63]
    v_pk_add_f32 v[42:43], v[76:77], v[78:79]
    v_pk_add_f32 v[40:41], v[40:41], v[64:65]
    v_pk_add_f32 v[42:43], v[42:43], v[80:81]
    v_pk_add_f32 v[40:41], v[40:41], v[66:67]
    v_pk_add_f32 v[42:43], v[42:43], v[82:83]
    v_pk_add_f32 v[40:41], v[40:41], v[68:69]
    v_pk_add_f32 v[42:43], v[42:43], v[84:85]
    v_pk_add_f32 v[40:41], v[40:41], v[70:71]
    v_pk_add_f32 v[42:43], v[42:43], v[86:87]
    v_pk_add_f32 v[40:41], v[40:41], v[72:73]
    v_pk_add_f32 v[42:43], v[42:43], v[88:89]
    v_pk_add_f32 v[40:41], v[40:41], v[74:75]
    v_pk_add_f32 v[42:43], v[42:43], v[90:91]
    v_add_f32 v40, v40, v41
    v_add_f32 v42, v42, v43
    s_nop 1
    v_permlane32_swap_b32 v40, v42
    v_add_f32 v40, v40, v42
    v_rcp_f32 v40, v40
    s_nop 0
    v_mov_b32 v42, v40
    s_nop 1
    v_permlane32_swap_b32 v40, v42
    v_pk_mul_f32 v[60:61], v[60:61], v[40:41] op_sel_hi:[1,0]
    v_pk_mul_f32 v[62:63], v[62:63], v[40:41] op_sel_hi:[1,0]
    v_pk_mul_f32 v[64:65], v[64:65], v[40:41] op_sel_hi:[1,0]
    v_pk_mul_f32 v[66:67], v[66:67], v[40:41] op_sel_hi:[1,0]
    v_cvt_pk_bf16_f32 v160, v60, v61
    v_cvt_pk_bf16_f32 v161, v62, v63
    v_cvt_pk_bf16_f32 v162, v64, v65
    v_cvt_pk_bf16_f32 v163, v66, v67
    v_pk_mul_f32 v[68:69], v[68:69], v[40:41] op_sel_hi:[1,0]
    v_pk_mul_f32 v[70:71], v[70:71], v[40:41] op_sel_hi:[1,0]
    v_pk_mul_f32 v[72:73], v[72:73], v[40:41] op_sel_hi:[1,0]
    v_pk_mul_f32 v[74:75], v[74:75], v[40:41] op_sel_hi:[1,0]
    v_cvt_pk_bf16_f32 v166, v68, v69
    v_cvt_pk_bf16_f32 v167, v70, v71
    v_cvt_pk_bf16_f32 v164, v72, v73
    v_cvt_pk_bf16_f32 v165, v74, v75
    v_pk_mul_f32 v[76:77], v[76:77], v[42:43] op_sel_hi:[1,0]
    v_pk_mul_f32 v[78:79], v[78:79], v[42:43] op_sel_hi:[1,0]
    v_pk_mul_f32 v[80:81], v[80:81], v[42:43] op_sel_hi:[1,0]
    v_pk_mul_f32 v[82:83], v[82:83], v[42:43] op_sel_hi:[1,0]
    v_cvt_pk_bf16_f32 v168, v76, v77
    v_cvt_pk_bf16_f32 v169, v78, v79
    v_cvt_pk_bf16_f32 v170, v80, v81
    v_cvt_pk_bf16_f32 v171, v82, v83
    v_pk_mul_f32 v[84:85], v[84:85], v[42:43] op_sel_hi:[1,0]
    v_pk_mul_f32 v[86:87], v[86:87], v[42:43] op_sel_hi:[1,0]
    v_pk_mul_f32 v[88:89], v[88:89], v[42:43] op_sel_hi:[1,0]
    v_pk_mul_f32 v[90:91], v[90:91], v[42:43] op_sel_hi:[1,0]
    v_cvt_pk_bf16_f32 v174, v84, v85
    v_cvt_pk_bf16_f32 v175, v86, v87
    v_cvt_pk_bf16_f32 v172, v88, v89
    v_cvt_pk_bf16_f32 v173, v90, v91
    v_pk_fma_f32 v[60:61], v[240:241], v[48:49], v[36:37] op_sel:[0,0,1] op_sel_hi:[1,0,1]
    v_pk_fma_f32 v[62:63], v[242:243], v[48:49], v[36:37] op_sel:[0,0,1] op_sel_hi:[1,0,1]
    v_pk_fma_f32 v[64:65], v[244:245], v[48:49], v[36:37] op_sel:[0,0,1] op_sel_hi:[1,0,1]
    v_pk_fma_f32 v[66:67], v[246:247], v[48:49], v[36:37] op_sel:[0,0,1] op_sel_hi:[1,0,1]
    v_pk_fma_f32 v[68:69], v[248:249], v[48:49], v[36:37] op_sel:[0,0,1] op_sel_hi:[1,0,1]
    v_pk_fma_f32 v[70:71], v[250:251], v[48:49], v[36:37] op_sel:[0,0,1] op_sel_hi:[1,0,1]
    v_pk_fma_f32 v[72:73], v[252:253], v[48:49], v[36:37] op_sel:[0,0,1] op_sel_hi:[1,0,1]
    v_pk_fma_f32 v[74:75], v[254:255], v[48:49], v[36:37] op_sel:[0,0,1] op_sel_hi:[1,0,1]
    v_pk_fma_f32 v[76:77], v[240:241], v[48:49], v[38:39] op_sel:[0,0,1] op_sel_hi:[1,0,1] neg_lo:[1,0,0] neg_hi:[1,0,0]
    v_pk_fma_f32 v[78:79], v[242:243], v[48:49], v[38:39] op_sel:[0,0,1] op_sel_hi:[1,0,1] neg_lo:[1,0,0] neg_hi:[1,0,0]
    v_pk_fma_f32 v[80:81], v[244:245], v[48:49], v[38:39] op_sel:[0,0,1] op_sel_hi:[1,0,1] neg_lo:[1,0,0] neg_hi:[1,0,0]
    v_pk_fma_f32 v[82:83], v[246:247], v[48:49], v[38:39] op_sel:[0,0,1] op_sel_hi:[1,0,1] neg_lo:[1,0,0] neg_hi:[1,0,0]
    v_pk_fma_f32 v[84:85], v[248:249], v[48:49], v[38:39] op_sel:[0,0,1] op_sel_hi:[1,0,1] neg_lo:[1,0,0] neg_hi:[1,0,0]
    v_pk_fma_f32 v[86:87], v[250:251], v[48:49], v[38:39] op_sel:[0,0,1] op_sel_hi:[1,0,1] neg_lo:[1,0,0] neg_hi:[1,0,0]
    v_pk_fma_f32 v[88:89], v[252:253], v[48:49], v[38:39] op_sel:[0,0,1] op_sel_hi:[1,0,1] neg_lo:[1,0,0] neg_hi:[1,0,0]
    v_pk_fma_f32 v[90:91], v[254:255], v[48:49], v[38:39] op_sel:[0,0,1] op_sel_hi:[1,0,1] neg_lo:[1,0,0] neg_hi:[1,0,0]
    v_exp_f32 v60, v60
    v_exp_f32 v61, v61
    v_exp_f32 v62, v62
    v_exp_f32 v63, v63
    ds_write_b128 v116, v[192:195] offset:0
    v_exp_f32 v64, v64
    v_exp_f32 v65, v65
    v_exp_f32 v66, v66
    v_exp_f32 v67, v67
    ds_write_b128 v116, v[196:199] offset:2048
    v_exp_f32 v68, v68
    v_exp_f32 v69, v69
    v_exp_f32 v70, v70
    v_exp_f32 v71, v71
    ds_write_b128 v116, v[200:203] offset:4096
    v_exp_f32 v72, v72
    v_exp_f32 v73, v73
    v_exp_f32 v74, v74
    v_exp_f32 v75, v75
    ds_write_b128 v116, v[204:207] offset:6144
    v_exp_f32 v76, v76
    v_exp_f32 v77, v77
    v_exp_f32 v78, v78
    v_exp_f32 v79, v79
    ds_write_b128 v112, v[160:163] offset:0
    v_exp_f32 v80, v80
    v_exp_f32 v81, v81
    v_exp_f32 v82, v82
    v_exp_f32 v83, v83
    ds_write_b128 v113, v[164:167] offset:0
    v_exp_f32 v84, v84
    v_exp_f32 v85, v85
    v_exp_f32 v86, v86
    v_exp_f32 v87, v87
    ds_write_b128 v114, v[168:171] offset:0
    v_exp_f32 v88, v88
    v_exp_f32 v89, v89
    v_exp_f32 v90, v90
    v_exp_f32 v91, v91
    ds_write_b128 v115, v[172:175] offset:0
    v_pk_add_f32 v[40:41], v[60:61], v[62:63]
    v_pk_add_f32 v[42:43], v[76:77], v[78:79]
    v_pk_add_f32 v[40:41], v[40:41], v[64:65]
    v_pk_add_f32 v[42:43], v[42:43], v[80:81]
    v_pk_add_f32 v[40:41], v[40:41], v[66:67]
    v_pk_add_f32 v[42:43], v[42:43], v[82:83]
    v_pk_add_f32 v[40:41], v[40:41], v[68:69]
    v_pk_add_f32 v[42:43], v[42:43], v[84:85]
    v_pk_add_f32 v[40:41], v[40:41], v[70:71]
    v_pk_add_f32 v[42:43], v[42:43], v[86:87]
    v_pk_add_f32 v[40:41], v[40:41], v[72:73]
    v_pk_add_f32 v[42:43], v[42:43], v[88:89]
    v_pk_add_f32 v[40:41], v[40:41], v[74:75]
    v_pk_add_f32 v[42:43], v[42:43], v[90:91]
    v_add_f32 v40, v40, v41
    v_add_f32 v42, v42, v43
    s_nop 1
    v_permlane32_swap_b32 v40, v42
    v_add_f32 v40, v40, v42
    v_rcp_f32 v40, v40
    s_nop 0
    v_mov_b32 v42, v40
    s_nop 1
    v_permlane32_swap_b32 v40, v42
    v_pk_mul_f32 v[60:61], v[60:61], v[40:41] op_sel_hi:[1,0]
    v_pk_mul_f32 v[62:63], v[62:63], v[40:41] op_sel_hi:[1,0]
    v_pk_mul_f32 v[64:65], v[64:65], v[40:41] op_sel_hi:[1,0]
    v_pk_mul_f32 v[66:67], v[66:67], v[40:41] op_sel_hi:[1,0]
    v_cvt_pk_bf16_f32 v176, v60, v61
    v_cvt_pk_bf16_f32 v177, v62, v63
    v_cvt_pk_bf16_f32 v178, v64, v65
    v_cvt_pk_bf16_f32 v179, v66, v67
    ds_write_b128 v112, v[176:179] offset:4096
    v_pk_mul_f32 v[68:69], v[68:69], v[40:41] op_sel_hi:[1,0]
    v_pk_mul_f32 v[70:71], v[70:71], v[40:41] op_sel_hi:[1,0]
    v_pk_mul_f32 v[72:73], v[72:73], v[40:41] op_sel_hi:[1,0]
    v_pk_mul_f32 v[74:75], v[74:75], v[40:41] op_sel_hi:[1,0]
    v_cvt_pk_bf16_f32 v182, v68, v69
    v_cvt_pk_bf16_f32 v183, v70, v71
    v_cvt_pk_bf16_f32 v180, v72, v73
    v_cvt_pk_bf16_f32 v181, v74, v75
    ds_write_b128 v113, v[180:183] offset:4096
    v_pk_mul_f32 v[76:77], v[76:77], v[42:43] op_sel_hi:[1,0]
    v_pk_mul_f32 v[78:79], v[78:79], v[42:43] op_sel_hi:[1,0]
    v_pk_mul_f32 v[80:81], v[80:81], v[42:43] op_sel_hi:[1,0]
    v_pk_mul_f32 v[82:83], v[82:83], v[42:43] op_sel_hi:[1,0]
    v_cvt_pk_bf16_f32 v184, v76, v77
    v_cvt_pk_bf16_f32 v185, v78, v79
    v_cvt_pk_bf16_f32 v186, v80, v81
    v_cvt_pk_bf16_f32 v187, v82, v83
    ds_write_b128 v114, v[184:187] offset:4096
    v_pk_mul_f32 v[84:85], v[84:85], v[42:43] op_sel_hi:[1,0]
    v_pk_mul_f32 v[86:87], v[86:87], v[42:43] op_sel_hi:[1,0]
    v_pk_mul_f32 v[88:89], v[88:89], v[42:43] op_sel_hi:[1,0]
    v_pk_mul_f32 v[90:91], v[90:91], v[42:43] op_sel_hi:[1,0]
    v_cvt_pk_bf16_f32 v190, v84, v85
    v_cvt_pk_bf16_f32 v191, v86, v87
    v_cvt_pk_bf16_f32 v188, v88, v89
    v_cvt_pk_bf16_f32 v189, v90, v91
    ds_write_b128 v115, v[188:191] offset:4096
    s_waitcnt lgkmcnt(0)
    s_barrier
L_pad7:
    s_cbranch_execz L_padret
    s_setprio 0
    v_mfma_f32_16x16x16_bf16 v[128:131], v[16:17], v[104:105], v[128:131]
    v_mfma_f32_16x16x16_bf16 v[144:147], v[18:19], v[104:105], v[144:147]
    v_mfma_f32_16x16x16_bf16 v[132:135], v[16:17], v[106:107], v[132:135]
    v_mfma_f32_16x16x16_bf16 v[148:151], v[18:19], v[106:107], v[148:151]
    v_mfma_f32_16x16x16_bf16 v[136:139], v[16:17], v[108:109], v[136:139]
    v_mfma_f32_16x16x16_bf16 v[152:155], v[18:19], v[108:109], v[152:155]
    v_mfma_f32_16x16x16_bf16 v[140:143], v[16:17], v[110:111], v[140:143]
    v_mfma_f32_16x16x16_bf16 v[156:159], v[18:19], v[110:111], v[156:159]
    v_lshrrev_b32 v11, 5, v2
    s_lshl_b32 s78, s81, 7
    s_add_u32 s78, s78, 162944
    v_lshl_add_u32 v10, v11, 4, s78
    v_and_b32 v13, 1, v2
    v_cmp_eq_u32 vcc, 1, v13
    v_mov_b32 v13, 162816
    v_and_b32 v12, 31, v2
    v_cndmask_b32 v10, v10, v13, vcc
    v_lshlrev_b32_e64 v12, 4, v12
    v_lshl_add_u32 v11, v11, 10, v12
    v_lshlrev_b32_e64 v14, 4, v2
    v_cvt_pk_bf16_f32 v128, v128, v129
    v_cvt_pk_bf16_f32 v129, v130, v131
    v_cvt_pk_bf16_f32 v130, v144, v145
    v_cvt_pk_bf16_f32 v131, v146, v147
    v_cvt_pk_bf16_f32 v132, v132, v133
    v_cvt_pk_bf16_f32 v133, v134, v135
    v_cvt_pk_bf16_f32 v134, v148, v149
    v_cvt_pk_bf16_f32 v135, v150, v151
    v_cvt_pk_bf16_f32 v136, v136, v137
    v_cvt_pk_bf16_f32 v137, v138, v139
    v_cvt_pk_bf16_f32 v138, v152, v153
    v_cvt_pk_bf16_f32 v139, v154, v155
    v_cvt_pk_bf16_f32 v140, v140, v141
    v_cvt_pk_bf16_f32 v141, v142, v143
    v_cvt_pk_bf16_f32 v142, v156, v157
    v_cvt_pk_bf16_f32 v143, v158, v159
    v_permlane16_swap_b32 v128, v132
    v_permlane16_swap_b32 v129, v133
    v_permlane16_swap_b32 v130, v134
    v_permlane16_swap_b32 v131, v135
    v_permlane16_swap_b32 v136, v140
    v_permlane16_swap_b32 v137, v141
    v_permlane16_swap_b32 v138, v142
    v_permlane16_swap_b32 v139, v143
    v_mfma_f32_32x32x16_bf16 v[224:239], v[96:99], v[128:131], 0
    v_mfma_f32_32x32x16_bf16 v[224:239], v[100:103], v[132:135], v[224:239]
    v_mfma_f32_32x32x16_bf16 v[240:255], v[96:99], v[136:139], 0
    v_mfma_f32_32x32x16_bf16 v[240:255], v[100:103], v[140:143], v[240:255]
    s_lshl_b32 s94, s70, 14
    s_lshl_b32 s79, s81, 13
    s_add_u32 s94, s94, s79
    s_add_u32 s94, s94, 8388608
    s_add_u32 s95, s94, 4096
    s_lshl_b32 s78, s69, 1
    s_add_u32 s78, s78, s80
    s_lshl_b32 s78, s78, 6
    s_lshl_b32 s79, s70, 1
    s_add_u32 s78, s78, s79
    s_add_u32 s78, s78, s81
    s_lshl_b32 s78, s78, 11
    s_add_u32 s96, s78, 4194304
    s_add_u32 s97, s96, 65536
    v_max3_f32 v36, v224, v225, v226
    v_max3_f32 v38, -v224, -v225, -v226
    v_max3_f32 v36, v36, v227, v228
    v_max3_f32 v38, v38, -v227, -v228
    v_max3_f32 v36, v36, v229, v230
    v_max3_f32 v38, v38, -v229, -v230
    v_max3_f32 v36, v36, v231, v232
    v_max3_f32 v38, v38, -v231, -v232
    v_max3_f32 v36, v36, v233, v234
    v_max3_f32 v38, v38, -v233, -v234
    v_max3_f32 v36, v36, v235, v236
    v_max3_f32 v38, v38, -v235, -v236
    v_max3_f32 v36, v36, v237, v238
    v_max3_f32 v38, v38, -v237, -v238
    v_max_f32_e64 v36, v36, v239
    v_max_f32 v38, v38, -v239
    v_max3_f32 v37, v240, v241, v242
    v_max3_f32 v39, -v240, -v241, -v242
    v_max3_f32 v37, v37, v243, v244
    v_max3_f32 v39, v39, -v243, -v244
    v_max3_f32 v37, v37, v245, v246
    v_max3_f32 v39, v39, -v245, -v246
    v_max3_f32 v37, v37, v247, v248
    v_max3_f32 v39, v39, -v247, -v248
    v_max3_f32 v37, v37, v249, v250
    v_max3_f32 v39, v39, -v249, -v250
    v_max3_f32 v37, v37, v251, v252
    v_max3_f32 v39, v39, -v251, -v252
    v_max3_f32 v37, v37, v253, v254
    v_max3_f32 v39, v39, -v253, -v254
    v_max_f32_e64 v37, v37, v255
    v_max_f32 v39, v39, -v255
    v_permlane32_swap_b32 v36, v38
    s_nop 0
    v_permlane32_swap_b32 v37, v39
    v_max_f32 v36, v36, v38
    v_max_f32_e64 v37, v37, v39
    v_mul_f32 v36, -v36, v34
    v_mul_f32 v37, -v37, v48
    v_mov_b32 v38, v36
    v_mov_b32 v39, v37
    s_nop 0
    v_permlane32_swap_b32 v36, v38
    v_permlane32_swap_b32_e64 v37, v39
    v_pk_fma_f32 v[60:61], v[224:225], v[34:35], v[36:37] op_sel_hi:[1,0,0]
    v_pk_fma_f32 v[62:63], v[226:227], v[34:35], v[36:37] op_sel_hi:[1,0,0]
    v_pk_fma_f32 v[64:65], v[228:229], v[34:35], v[36:37] op_sel_hi:[1,0,0]
    v_pk_fma_f32 v[66:67], v[230:231], v[34:35], v[36:37] op_sel_hi:[1,0,0]
    v_pk_fma_f32 v[68:69], v[232:233], v[34:35], v[36:37] op_sel_hi:[1,0,0]
    v_pk_fma_f32 v[70:71], v[234:235], v[34:35], v[36:37] op_sel_hi:[1,0,0]
    v_pk_fma_f32 v[72:73], v[236:237], v[34:35], v[36:37] op_sel_hi:[1,0,0]
    v_pk_fma_f32 v[74:75], v[238:239], v[34:35], v[36:37] op_sel_hi:[1,0,0]
    v_pk_fma_f32 v[76:77], v[224:225], v[34:35], v[38:39] op_sel_hi:[1,0,0] neg_lo:[1,0,0] neg_hi:[1,0,0]
    v_pk_fma_f32 v[78:79], v[226:227], v[34:35], v[38:39] op_sel_hi:[1,0,0] neg_lo:[1,0,0] neg_hi:[1,0,0]
    v_pk_fma_f32 v[80:81], v[228:229], v[34:35], v[38:39] op_sel_hi:[1,0,0] neg_lo:[1,0,0] neg_hi:[1,0,0]
    v_pk_fma_f32 v[82:83], v[230:231], v[34:35], v[38:39] op_sel_hi:[1,0,0] neg_lo:[1,0,0] neg_hi:[1,0,0]
    v_pk_fma_f32 v[84:85], v[232:233], v[34:35], v[38:39] op_sel_hi:[1,0,0] neg_lo:[1,0,0] neg_hi:[1,0,0]
    v_pk_fma_f32 v[86:87], v[234:235], v[34:35], v[38:39] op_sel_hi:[1,0,0] neg_lo:[1,0,0] neg_hi:[1,0,0]
    v_pk_fma_f32 v[88:89], v[236:237], v[34:35], v[38:39] op_sel_hi:[1,0,0] neg_lo:[1,0,0] neg_hi:[1,0,0]
    v_pk_fma_f32 v[90:91], v[238:239], v[34:35], v[38:39] op_sel_hi:[1,0,0] neg_lo:[1,0,0] neg_hi:[1,0,0]
    v_exp_f32 v60, v60
    v_exp_f32 v61, v61
    v_exp_f32 v62, v62
    v_exp_f32 v63, v63
    v_exp_f32 v64, v64
    v_exp_f32 v65, v65
    v_exp_f32 v66, v66
    v_exp_f32 v67, v67
    v_exp_f32 v68, v68
    v_exp_f32 v69, v69
    v_exp_f32 v70, v70
    v_exp_f32 v71, v71
    v_exp_f32 v72, v72
    v_exp_f32 v73, v73
    v_exp_f32 v74, v74
    v_exp_f32 v75, v75
    v_exp_f32 v76, v76
    v_exp_f32 v77, v77
    v_exp_f32 v78, v78
    v_exp_f32 v79, v79
    v_exp_f32 v80, v80
    v_exp_f32 v81, v81
    v_exp_f32 v82, v82
    v_exp_f32 v83, v83
    v_exp_f32 v84, v84
    v_exp_f32 v85, v85
    v_exp_f32 v86, v86
    v_exp_f32 v87, v87
    v_exp_f32 v88, v88
    v_exp_f32 v89, v89
    v_exp_f32 v90, v90
    v_exp_f32 v91, v91
    v_cvt_pk_bf16_f32 v160, v60, v61
    v_cvt_pk_bf16_f32 v161, v62, v63
    v_cvt_pk_bf16_f32 v162, v64, v65
    v_cvt_pk_bf16_f32 v163, v66, v67
    v_cvt_pk_bf16_f32 v164, v68, v69
    v_cvt_pk_bf16_f32 v165, v70, v71
    v_cvt_pk_bf16_f32 v166, v72, v73
    v_cvt_pk_bf16_f32 v167, v74, v75
    v_cvt_pk_bf16_f32 v168, v76, v77
    v_cvt_pk_bf16_f32 v169, v78, v79
    v_cvt_pk_bf16_f32 v170, v80, v81
    v_cvt_pk_bf16_f32 v171, v82, v83
    v_cvt_pk_bf16_f32 v172, v84, v85
    v_cvt_pk_bf16_f32 v173, v86, v87
    v_cvt_pk_bf16_f32 v174, v88, v89
    v_cvt_pk_bf16_f32 v175, v90, v91
    v_pk_fma_f32 v[60:61], v[240:241], v[48:49], v[36:37] op_sel:[0,0,1] op_sel_hi:[1,0,1]
    v_pk_fma_f32 v[62:63], v[242:243], v[48:49], v[36:37] op_sel:[0,0,1] op_sel_hi:[1,0,1]
    v_pk_fma_f32 v[64:65], v[244:245], v[48:49], v[36:37] op_sel:[0,0,1] op_sel_hi:[1,0,1]
    v_pk_fma_f32 v[66:67], v[246:247], v[48:49], v[36:37] op_sel:[0,0,1] op_sel_hi:[1,0,1]
    v_pk_fma_f32 v[68:69], v[248:249], v[48:49], v[36:37] op_sel:[0,0,1] op_sel_hi:[1,0,1]
    v_pk_fma_f32 v[70:71], v[250:251], v[48:49], v[36:37] op_sel:[0,0,1] op_sel_hi:[1,0,1]
    v_pk_fma_f32 v[72:73], v[252:253], v[48:49], v[36:37] op_sel:[0,0,1] op_sel_hi:[1,0,1]
    v_pk_fma_f32 v[74:75], v[254:255], v[48:49], v[36:37] op_sel:[0,0,1] op_sel_hi:[1,0,1]
    v_pk_fma_f32 v[76:77], v[240:241], v[48:49], v[38:39] op_sel:[0,0,1] op_sel_hi:[1,0,1] neg_lo:[1,0,0] neg_hi:[1,0,0]
    v_pk_fma_f32 v[78:79], v[242:243], v[48:49], v[38:39] op_sel:[0,0,1] op_sel_hi:[1,0,1] neg_lo:[1,0,0] neg_hi:[1,0,0]
    v_pk_fma_f32 v[80:81], v[244:245], v[48:49], v[38:39] op_sel:[0,0,1] op_sel_hi:[1,0,1] neg_lo:[1,0,0] neg_hi:[1,0,0]
    v_pk_fma_f32 v[82:83], v[246:247], v[48:49], v[38:39] op_sel:[0,0,1] op_sel_hi:[1,0,1] neg_lo:[1,0,0] neg_hi:[1,0,0]
    v_pk_fma_f32 v[84:85], v[248:249], v[48:49], v[38:39] op_sel:[0,0,1] op_sel_hi:[1,0,1] neg_lo:[1,0,0] neg_hi:[1,0,0]
    v_pk_fma_f32 v[86:87], v[250:251], v[48:49], v[38:39] op_sel:[0,0,1] op_sel_hi:[1,0,1] neg_lo:[1,0,0] neg_hi:[1,0,0]
    v_pk_fma_f32 v[88:89], v[252:253], v[48:49], v[38:39] op_sel:[0,0,1] op_sel_hi:[1,0,1] neg_lo:[1,0,0] neg_hi:[1,0,0]
    v_pk_fma_f32 v[90:91], v[254:255], v[48:49], v[38:39] op_sel:[0,0,1] op_sel_hi:[1,0,1] neg_lo:[1,0,0] neg_hi:[1,0,0]
    v_exp_f32 v60, v60
    v_exp_f32 v61, v61
    v_exp_f32 v62, v62
    v_exp_f32 v63, v63
    v_exp_f32 v64, v64
    v_exp_f32 v65, v65
    v_exp_f32 v66, v66
    v_exp_f32 v67, v67
    v_exp_f32 v68, v68
    v_exp_f32 v69, v69
    v_exp_f32 v70, v70
    v_exp_f32 v71, v71
    v_exp_f32 v72, v72
    v_exp_f32 v73, v73
    v_exp_f32 v74, v74
    v_exp_f32 v75, v75
    v_exp_f32 v76, v76
    v_exp_f32 v77, v77
    v_exp_f32 v78, v78
    v_exp_f32 v79, v79
    v_exp_f32 v80, v80
    v_exp_f32 v81, v81
    v_exp_f32 v82, v82
    v_exp_f32 v83, v83
    v_exp_f32 v84, v84
    v_exp_f32 v85, v85
    v_exp_f32 v86, v86
    v_exp_f32 v87, v87
    v_exp_f32 v88, v88
    v_exp_f32 v89, v89
    v_exp_f32 v90, v90
    v_exp_f32 v91, v91
    v_cvt_pk_bf16_f32 v176, v60, v61
    v_cvt_pk_bf16_f32 v177, v62, v63
    v_cvt_pk_bf16_f32 v178, v64, v65
    v_cvt_pk_bf16_f32 v179, v66, v67
    v_cvt_pk_bf16_f32 v180, v68, v69
    v_cvt_pk_bf16_f32 v181, v70, v71
    v_cvt_pk_bf16_f32 v182, v72, v73
    v_cvt_pk_bf16_f32 v183, v74, v75
    v_cvt_pk_bf16_f32 v184, v76, v77
    v_cvt_pk_bf16_f32 v185, v78, v79
    v_cvt_pk_bf16_f32 v186, v80, v81
    v_cvt_pk_bf16_f32 v187, v82, v83
    v_cvt_pk_bf16_f32 v188, v84, v85
    v_cvt_pk_bf16_f32 v189, v86, v87
    v_cvt_pk_bf16_f32 v190, v88, v89
    v_cvt_pk_bf16_f32 v191, v90, v91
    s_barrier
    s_setprio 1
    ds_read_b128 v[16:19], v10 offset:0
    ds_read_b128 v[20:23], v10 offset:32
    ds_read_b128 v[24:27], v10 offset:64
    ds_read_b128 v[28:31], v10 offset:96
    s_waitcnt lgkmcnt(3)
    v_mfma_f32_32x32x16_bf16 v[224:239], v[16:19], v[160:163], 0
    s_waitcnt lgkmcnt(2)
    v_mfma_f32_32x32x16_bf16 v[224:239], v[20:23], v[164:167], v[224:239]
    buffer_load_dwordx4 v[96:99], v11, s[36:39], s94 offen offset:0 sc1
    buffer_load_dwordx4 v[100:103], v11, s[36:39], s94 offen offset:2048 sc1
    buffer_load_dwordx4 v[104:107], v11, s[36:39], s95 offen offset:0 sc1
    buffer_load_dwordx4 v[108:111], v11, s[36:39], s95 offen offset:2048 sc1
    s_waitcnt lgkmcnt(1)
    v_mfma_f32_32x32x16_bf16 v[240:255], v[24:27], v[168:171], 0
    s_waitcnt lgkmcnt(0)
    v_mfma_f32_32x32x16_bf16 v[240:255], v[28:31], v[172:175], v[240:255]
    v_mfma_f32_32x32x16_bf16 v[192:207], v[16:19], v[176:179], 0
    v_mfma_f32_32x32x16_bf16 v[192:207], v[20:23], v[180:183], v[192:207]
    v_mfma_f32_32x32x16_bf16 v[208:223], v[24:27], v[184:187], 0
    v_mfma_f32_32x32x16_bf16 v[208:223], v[28:31], v[188:191], v[208:223]
    s_mov_b32 s85, 0
    s_branch L_kvchk
L_kvspin:
    s_add_u32 s85, s85, 1
    s_cmp_gt_u32 s85, 400000
    s_cbranch_scc1 L_end
    buffer_load_dwordx4 v[96:99], v11, s[36:39], s94 offen offset:0 sc1
    buffer_load_dwordx4 v[100:103], v11, s[36:39], s94 offen offset:2048 sc1
    buffer_load_dwordx4 v[104:107], v11, s[36:39], s95 offen offset:0 sc1
    buffer_load_dwordx4 v[108:111], v11, s[36:39], s95 offen offset:2048 sc1
L_kvchk:
    s_waitcnt vmcnt(0)
    s_nop 0
    v_mfma_f32_32x32x16_bf16 v[60:75], v[96:99], v[160:163], 0
    v_max3_u32 v13, v96, v97, v98
    v_max3_u32 v10, v99, v100, v101
    v_max3_u32 v13, v13, v102, v103
    v_max3_u32 v10, v10, v104, v105
    v_max3_u32 v13, v13, v106, v107
    v_mfma_f32_32x32x16_bf16 v[60:75], v[100:103], v[164:167], v[60:75]
    v_max3_u32 v10, v10, v108, v109
    v_max3_u32 v13, v13, v110, v111
    v_max_u32 v13, v13, v10
    v_cmp_eq_u32_e64 vcc, -1, v13
    s_cbranch_vccnz L_kvspin
    v_mfma_f32_32x32x16_bf16 v[76:91], v[104:107], v[168:171], 0
    v_rcp_f32 v36, v225
    v_rcp_f32 v40, v193
    v_rcp_f32 v38, v241
    v_rcp_f32 v42, v209
    v_mfma_f32_32x32x16_bf16 v[76:91], v[108:111], v[172:175], v[76:91]
    v_mov_b32 v44, 0x358637bd
    v_mov_b32 v45, 0x358637bd
    v_fmac_f32 v44, v224, v36
    v_fmac_f32 v45, v192, v40
    v_fmac_f32 v44, v240, v38
    v_fmac_f32 v45, v208, v42
    v_mfma_f32_32x32x16_bf16 v[128:143], v[96:99], v[176:179], 0
    v_rcp_f32 v44, v44
    v_rcp_f32 v45, v45
    v_mul_f32 v36, v36, v44
    v_mul_f32 v40, v40, v45
    v_mfma_f32_32x32x16_bf16 v[128:143], v[100:103], v[180:183], v[128:143]
    v_mul_f32 v38, v38, v44
    v_mul_f32 v42, v42, v45
    v_mul_f32 v60, v60, v36
    v_mul_f32 v61, v61, v36
    v_mul_f32 v62, v62, v36
    v_mul_f32 v63, v63, v36
    v_mfma_f32_32x32x16_bf16 v[144:159], v[104:107], v[184:187], 0
    v_mul_f32 v64, v64, v36
    v_mul_f32 v65, v65, v36
    v_mul_f32 v66, v66, v36
    v_mul_f32 v67, v67, v36
    v_mul_f32 v68, v68, v36
    v_mul_f32 v69, v69, v36
    v_mfma_f32_32x32x16_bf16 v[144:159], v[108:111], v[188:191], v[144:159]
    v_mul_f32 v70, v70, v36
    v_mul_f32 v71, v71, v36
    v_mul_f32 v72, v72, v36
    v_mul_f32 v73, v73, v36
    v_mul_f32 v74, v74, v36
    v_mul_f32 v75, v75, v36
    v_pk_fma_f32 v[60:61], v[76:77], v[38:39], v[60:61] op_sel_hi:[1,0,1]
    v_pk_fma_f32 v[62:63], v[78:79], v[38:39], v[62:63] op_sel_hi:[1,0,1]
    v_pk_fma_f32 v[64:65], v[80:81], v[38:39], v[64:65] op_sel_hi:[1,0,1]
    v_pk_fma_f32 v[66:67], v[82:83], v[38:39], v[66:67] op_sel_hi:[1,0,1]
    v_cvt_pk_bf16_f32 v16, v60, v61
    v_cvt_pk_bf16_f32 v17, v62, v63
    v_cvt_pk_bf16_f32 v18, v64, v65
    v_cvt_pk_bf16_f32 v19, v66, v67
L_pad8:
    s_cbranch_execz L_padret
    s_nop 0
    buffer_store_dwordx4 v[16:19], v14, s[36:39], s96 offen offset:0 sc1
    v_pk_fma_f32 v[68:69], v[84:85], v[38:39], v[68:69] op_sel_hi:[1,0,1]
    v_pk_fma_f32 v[70:71], v[86:87], v[38:39], v[70:71] op_sel_hi:[1,0,1]
    v_pk_fma_f32 v[72:73], v[88:89], v[38:39], v[72:73] op_sel_hi:[1,0,1]
    v_pk_fma_f32 v[74:75], v[90:91], v[38:39], v[74:75] op_sel_hi:[1,0,1]
    v_cvt_pk_bf16_f32 v20, v68, v69
    v_cvt_pk_bf16_f32 v21, v70, v71
    v_cvt_pk_bf16_f32 v22, v72, v73
    v_cvt_pk_bf16_f32 v23, v74, v75
    buffer_store_dwordx4 v[20:23], v14, s[36:39], s96 offen offset:1024 sc1
    v_pk_mul_f32 v[128:129], v[128:129], v[40:41] op_sel_hi:[1,0]
    v_pk_mul_f32 v[130:131], v[130:131], v[40:41] op_sel_hi:[1,0]
    v_pk_mul_f32 v[132:133], v[132:133], v[40:41] op_sel_hi:[1,0]
    v_pk_mul_f32 v[134:135], v[134:135], v[40:41] op_sel_hi:[1,0]
    v_pk_fma_f32 v[128:129], v[144:145], v[42:43], v[128:129] op_sel_hi:[1,0,1]
    v_pk_fma_f32 v[130:131], v[146:147], v[42:43], v[130:131] op_sel_hi:[1,0,1]
    v_pk_fma_f32 v[132:133], v[148:149], v[42:43], v[132:133] op_sel_hi:[1,0,1]
    v_pk_fma_f32 v[134:135], v[150:151], v[42:43], v[134:135] op_sel_hi:[1,0,1]
    v_cvt_pk_bf16_f32 v24, v128, v129
    v_cvt_pk_bf16_f32 v25, v130, v131
    v_cvt_pk_bf16_f32 v26, v132, v133
    v_cvt_pk_bf16_f32 v27, v134, v135
    buffer_store_dwordx4 v[24:27], v14, s[36:39], s97 offen offset:0 sc1
    v_pk_mul_f32 v[136:137], v[136:137], v[40:41] op_sel_hi:[1,0]
    v_pk_mul_f32 v[138:139], v[138:139], v[40:41] op_sel_hi:[1,0]
    v_pk_mul_f32 v[140:141], v[140:141], v[40:41] op_sel_hi:[1,0]
    v_pk_mul_f32 v[142:143], v[142:143], v[40:41] op_sel_hi:[1,0]
    v_pk_fma_f32 v[136:137], v[152:153], v[42:43], v[136:137] op_sel_hi:[1,0,1]
    v_pk_fma_f32 v[138:139], v[154:155], v[42:43], v[138:139] op_sel_hi:[1,0,1]
    v_pk_fma_f32 v[140:141], v[156:157], v[42:43], v[140:141] op_sel_hi:[1,0,1]
    v_pk_fma_f32 v[142:143], v[158:159], v[42:43], v[142:143] op_sel_hi:[1,0,1]
    v_cvt_pk_bf16_f32 v28, v136, v137
    v_cvt_pk_bf16_f32 v29, v138, v139
    v_cvt_pk_bf16_f32 v30, v140, v141
    v_cvt_pk_bf16_f32 v31, v142, v143
    buffer_store_dwordx4 v[28:31], v14, s[36:39], s97 offen offset:1024 sc1
    v_and_b32 v8, 31, v2
    v_lshrrev_b32 v9, 5, v2
    v_lshlrev_b32 v10, 3, v9
    s_lshl_b32 s78, s72, 7
    buffer_load_dwordx2 v[32:33], v10, s[64:67], s78 offen offset:0
    buffer_load_dwordx2 v[34:35], v10, s[64:67], s78 offen offset:16
    buffer_load_dwordx2 v[36:37], v10, s[64:67], s78 offen offset:32
    buffer_load_dwordx2 v[38:39], v10, s[64:67], s78 offen offset:48
    buffer_load_dwordx2 v[40:41], v10, s[64:67], s78 offen offset:64
    buffer_load_dwordx2 v[42:43], v10, s[64:67], s78 offen offset:80
    buffer_load_dwordx2 v[44:45], v10, s[64:67], s78 offen offset:96
    buffer_load_dwordx2 v[46:47], v10, s[64:67], s78 offen offset:112
    buffer_load_dwordx4 v[48:51], v14, s[64:67], 0 offen
    buffer_load_dwordx4 v[52:55], v14, s[64:67], 0 offen offset:1024
    s_barrier
    s_lshl_b32 s78, s76, 12
    s_add_u32 s78, s78, 131072
    v_lshl_add_u32 v6, v8, 7, s78
    v_add_u32_e64 v6, v6, v10
    v_bfe_u32 v11, v8, 1, 3
    v_lshl_add_u32 v6, v11, 4, v6
    v_xor_b32 v112, 0, v6
    v_xor_b32 v113, 16, v6
    v_xor_b32 v114, 32, v6
    v_xor_b32 v115, 48, v6
    v_xor_b32_e64 v116, 64, v6
    v_xor_b32 v117, 80, v6
    v_xor_b32 v118, 96, v6
    v_xor_b32 v119, 112, v6
    v_bfe_u32 v11, v2, 2, 2
    v_lshl_add_u32 v12, v9, 2, v11
    v_lshlrev_b32 v12, 7, v12
    v_lshrrev_b32 v11, 1, v11
    v_lshl_add_u32 v12, v11, 6, v12
    v_bfe_u32 v11, v2, 4, 1
    v_lshl_add_u32 v12, v11, 5, v12
    v_and_b32_e64 v11, 3, v2
    v_lshl_add_u32 v12, v11, 3, v12
    s_lshl_b32 s82, s72, 0
    s_and_b32 s82, s82, 15
    s_lshl_b32 s78, s82, 13
    v_add_u32 v4, s78, v12
    v_xor_b32 v5, 64, v4
    s_lshl_b32 s83, s71, 2
    s_add_u32 s83, s83, s76
    s_lshl_b32 s83, s83, 16
    s_add_u32 s83, s83, 4194304
    s_lshl_b32 s82, s82, 12
    s_add_u32 s88, s82, s83
    v_lshlrev_b32_e64 v12, 4, v8
    v_lshl_add_u32 v12, v9, 14, v12
    s_lshl_b32 s94, s71, 15
    s_lshl_b32 s79, s76, 9
    s_add_u32 s94, s94, s79
    s_add_u32 s94, s94, 1572864
    s_lshl_b32 s95, s72, 11
    s_add_u32 s95, s95, s94
    s_lshl_b32 s78, s76, 5
    v_add_u32 v11, s78, v8
    v_and_b32 v13, 7, v8
    v_xor_b32 v13, v13, v9
    v_lshlrev_b32 v13, 4, v13
    v_lshl_add_u32 v13, v11, 8, v13
    v_lshlrev_b32_e64 v10, 3, v11
    v_add_u32 v10, 159744, v10
    s_lshl_b32 s78, s71, 7
    v_add_u32 v11, s78, v11
    s_waitcnt vmcnt(0)
    s_barrier
    ds_read_b64 v[96:97], v112
    ds_read_b64 v[98:99], v113
    ds_read_b64 v[100:101], v114
    ds_read_b64 v[102:103], v115
    ds_read_b64 v[104:105], v116
    ds_read_b64 v[106:107], v117
    ds_read_b64 v[108:109], v118
    ds_read_b64 v[110:111], v119
    v_lshlrev_b32_e64 v60, 16, v32
    v_and_b32 v61, 0xffff0000, v32
    v_lshlrev_b32_e64 v62, 16, v33
    v_and_b32 v63, 0xffff0000, v33
    v_lshlrev_b32_e64 v64, 16, v34
    v_and_b32 v65, 0xffff0000, v34
    v_lshlrev_b32_e64 v66, 16, v35
    v_and_b32 v67, 0xffff0000, v35
    v_lshlrev_b32_e64 v68, 16, v36
    v_and_b32 v69, 0xffff0000, v36
    v_lshlrev_b32_e64 v70, 16, v37
    v_and_b32 v71, 0xffff0000, v37
    v_lshlrev_b32_e64 v72, 16, v38
    v_and_b32 v73, 0xffff0000, v38
    v_lshlrev_b32_e64 v74, 16, v39
    v_and_b32 v75, 0xffff0000, v39
    v_lshlrev_b32_e64 v76, 16, v40
    v_and_b32 v77, 0xffff0000, v40
    v_lshlrev_b32_e64 v78, 16, v41
    v_and_b32 v79, 0xffff0000, v41
    v_lshlrev_b32_e64 v80, 16, v42
    v_and_b32 v81, 0xffff0000, v42
    v_lshlrev_b32_e64 v82, 16, v43
    v_and_b32 v83, 0xffff0000, v43
    v_lshlrev_b32_e64 v84, 16, v44
    v_and_b32 v85, 0xffff0000, v44
    v_lshlrev_b32_e64 v86, 16, v45
    v_and_b32 v87, 0xffff0000, v45
    v_lshlrev_b32_e64 v88, 16, v46
    v_and_b32 v89, 0xffff0000, v46
    v_lshlrev_b32_e64 v90, 16, v47
    v_and_b32 v91, 0xffff0000, v47
    s_mov_b32 s78, 0x3f803f80
    v_dot2_f32_bf16 v126, v48, s78, 0
    v_dot2_f32_bf16 v126, v49, s78, v126
    v_dot2_f32_bf16 v126, v50, s78, v126
    v_dot2_f32_bf16 v126, v51, s78, v126
    v_dot2_f32_bf16 v126, v52, s78, v126
    v_dot2_f32_bf16 v126, v53, s78, v126
    v_dot2_f32_bf16 v126, v54, s78, v126
    v_dot2_f32_bf16 v126, v55, s78, v126
    s_nop 2
    v_add_f32_dpp v126, v126, v126 row_ror:8 row_mask:0xf bank_mask:0xf
    s_nop 1
    v_add_f32_dpp v126, v126, v126 row_ror:4 row_mask:0xf bank_mask:0xf
    s_nop 1
    v_add_f32_dpp v126, v126, v126 row_ror:2 row_mask:0xf bank_mask:0xf
    s_nop 1
    v_add_f32_dpp v126, v126, v126 row_ror:1 row_mask:0xf bank_mask:0xf
    v_mov_b32 v127, v126
    s_nop 1
    v_permlane32_swap_b32 v126, v127
    v_add_f32 v126, v126, v127
    v_mov_b32 v127, v126
    s_nop 1
    v_permlane16_swap_b32 v126, v127
    v_add_f32 v126, v126, v127
    v_mov_b32 v44, 163328
    v_mov_b32_e64 v45, 1
    v_mov_b32 v46, 0xff800000
    v_mov_b32_e64 v47, 0
    ds_write_b64 v44, v[46:47]
    s_lshl_b32 s96, s71, 4
    s_add_u32 s96, s96, s72
    s_lshl_b32 s96, s96, 9
    s_add_u32 s96, s96, 524288
    v_mov_b32 v15, 163584
    ds_read_b32 v15, v15
    s_waitcnt lgkmcnt(0)
    v_readfirstlane_b32 s99, v15
    v_lshlrev_b32 v224, 16, v96
    v_and_b32 v225, 0xffff0000, v96
    v_lshlrev_b32_e64 v226, 16, v97
    v_and_b32 v227, 0xffff0000, v97
    v_lshlrev_b32_e64 v228, 16, v98
    v_and_b32 v229, 0xffff0000, v98
    v_lshlrev_b32_e64 v230, 16, v99
    v_and_b32 v231, 0xffff0000, v99
    v_lshlrev_b32_e64 v232, 16, v100
    v_and_b32 v233, 0xffff0000, v100
    v_lshlrev_b32_e64 v234, 16, v101
    v_and_b32 v235, 0xffff0000, v101
    v_lshlrev_b32_e64 v236, 16, v102
    v_and_b32 v237, 0xffff0000, v102
    v_lshlrev_b32_e64 v238, 16, v103
    v_and_b32 v239, 0xffff0000, v103
    v_lshlrev_b32_e64 v240, 16, v104
    v_and_b32 v241, 0xffff0000, v104
    v_lshlrev_b32_e64 v242, 16, v105
    v_and_b32 v243, 0xffff0000, v105
    v_lshlrev_b32_e64 v244, 16, v106
    v_and_b32 v245, 0xffff0000, v106
    v_lshlrev_b32_e64 v246, 16, v107
    v_and_b32 v247, 0xffff0000, v107
    v_lshlrev_b32_e64 v248, 16, v108
    v_and_b32 v249, 0xffff0000, v108
    v_lshlrev_b32_e64 v250, 16, v109
    v_and_b32 v251, 0xffff0000, v109
    v_lshlrev_b32_e64 v252, 16, v110
    v_and_b32 v253, 0xffff0000, v110
    v_lshlrev_b32_e64 v254, 16, v111
    v_and_b32 v255, 0xffff0000, v111
    s_mov_b32 s84, 0
    s_barrier
    buffer_load_dwordx4 v[160:163], v14, s[36:39], s88 offen offset:0 sc1
    ds_read_b64_tr_b16 v[128:129], v4 offset:0
    buffer_load_dwordx4 v[164:167], v14, s[36:39], s88 offen offset:1024 sc1
    ds_read_b64_tr_b16 v[130:131], v4 offset:1024
    buffer_load_dwordx4 v[168:171], v14, s[36:39], s88 offen offset:2048 sc1
    ds_read_b64_tr_b16 v[132:133], v5 offset:0
    buffer_load_dwordx4 v[172:175], v14, s[36:39], s88 offen offset:3072 sc1
    s_add_u32 s82, s82, 4096
    s_and_b32 s82, s82, 0xffff
    s_add_u32 s88, s82, s83
    s_nop 0
    ds_read_b64_tr_b16 v[134:135], v5 offset:1024
    buffer_load_dwordx4 v[176:179], v14, s[36:39], s88 offen offset:0 sc1
    ds_read_b64_tr_b16 v[136:137], v4 offset:2048
    buffer_load_dwordx4 v[180:183], v14, s[36:39], s88 offen offset:1024 sc1
    ds_read_b64_tr_b16 v[138:139], v4 offset:3072
    buffer_load_dwordx4 v[184:187], v14, s[36:39], s88 offen offset:2048 sc1
    ds_read_b64_tr_b16 v[140:141], v5 offset:2048
    buffer_load_dwordx4 v[188:191], v14, s[36:39], s88 offen offset:3072 sc1
    s_add_u32 s82, s82, 4096
    s_and_b32 s82, s82, 0xffff
    s_add_u32 s88, s82, s83
    s_nop 0
    ds_read_b64_tr_b16 v[142:143], v5 offset:3072
    buffer_load_dwordx4 v[192:195], v14, s[36:39], s88 offen offset:0 sc1
    buffer_load_dwordx4 v[196:199], v14, s[36:39], s88 offen offset:1024 sc1
    buffer_load_dwordx4 v[200:203], v14, s[36:39], s88 offen offset:2048 sc1
    buffer_load_dwordx4 v[204:207], v14, s[36:39], s88 offen offset:3072 sc1
    s_add_u32 s82, s82, 4096
    s_and_b32 s82, s82, 0xffff
    s_add_u32 s88, s82, s83
    buffer_load_dwordx4 v[208:211], v14, s[36:39], s88 offen offset:0 sc1
    buffer_load_dwordx4 v[212:215], v14, s[36:39], s88 offen offset:1024 sc1
    .p2align 3
L_G2:
    s_add_u32 s84, s84, 1
    s_waitcnt vmcnt(12) lgkmcnt(6)
    v_mfma_f32_32x32x16_bf16 v[224:239], v[128:131], v[160:163], v[224:239]
    ds_read_b64_tr_b16 v[144:145], v4 offset:4096
    ds_read_b64_tr_b16 v[146:147], v4 offset:5120
    buffer_load_dwordx4 v[216:219], v14, s[36:39], s88 offen offset:2048 sc1
    s_waitcnt lgkmcnt(6)
    v_mfma_f32_32x32x16_bf16 v[240:255], v[132:135], v[160:163], v[240:255]
    ds_read_b64_tr_b16 v[148:149], v5 offset:4096
    ds_read_b64_tr_b16 v[150:151], v5 offset:5120
    s_waitcnt lgkmcnt(6)
    v_mfma_f32_32x32x16_bf16 v[224:239], v[136:139], v[164:167], v[224:239]
    ds_read_b64_tr_b16 v[152:153], v4 offset:6144
    ds_read_b64_tr_b16 v[154:155], v4 offset:7168
    buffer_load_dwordx4 v[220:223], v14, s[36:39], s88 offen offset:3072 sc1
    s_add_u32 s82, s82, 4096
    s_and_b32 s82, s82, 0xffff
    s_add_u32 s88, s82, s83
    s_waitcnt lgkmcnt(6)
    v_mfma_f32_32x32x16_bf16 v[240:255], v[140:143], v[164:167], v[240:255]
    ds_read_b64_tr_b16 v[156:157], v5 offset:6144
    ds_read_b64_tr_b16 v[158:159], v5 offset:7168
    v_add_u32 v4, 0x2000, v4
    v_and_b32 v4, 0x1ffff, v4
    v_xor_b32 v5, 64, v4
    s_waitcnt vmcnt(12) lgkmcnt(6)
    v_mfma_f32_32x32x16_bf16 v[224:239], v[144:147], v[168:171], v[224:239]
    ds_read_b64_tr_b16 v[128:129], v4 offset:0
    ds_read_b64_tr_b16 v[130:131], v4 offset:1024
    buffer_load_dwordx4 v[160:163], v14, s[36:39], s88 offen offset:0 sc1
    s_waitcnt lgkmcnt(6)
    v_mfma_f32_32x32x16_bf16 v[240:255], v[148:151], v[168:171], v[240:255]
    ds_read_b64_tr_b16 v[132:133], v5 offset:0
    ds_read_b64_tr_b16 v[134:135], v5 offset:1024
    s_waitcnt lgkmcnt(6)
    v_mfma_f32_32x32x16_bf16 v[224:239], v[152:155], v[172:175], v[224:239]
    ds_read_b64_tr_b16 v[136:137], v4 offset:2048
    ds_read_b64_tr_b16 v[138:139], v4 offset:3072
    buffer_load_dwordx4 v[164:167], v14, s[36:39], s88 offen offset:1024 sc1
    s_waitcnt lgkmcnt(6)
    v_mfma_f32_32x32x16_bf16 v[240:255], v[156:159], v[172:175], v[240:255]
L_pad9:
    s_cbranch_execz L_padret
    ds_read_b64_tr_b16 v[140:141], v5 offset:2048
    ds_read_b64_tr_b16 v[142:143], v5 offset:3072
    s_waitcnt vmcnt(12) lgkmcnt(6)
    v_mfma_f32_32x32x16_bf16 v[224:239], v[128:131], v[176:179], v[224:239]
    ds_read_b64_tr_b16 v[144:145], v4 offset:4096
    ds_read_b64_tr_b16 v[146:147], v4 offset:5120
    buffer_load_dwordx4 v[168:171], v14, s[36:39], s88 offen offset:2048 sc1
    s_waitcnt lgkmcnt(6)
    v_mfma_f32_32x32x16_bf16 v[240:255], v[132:135], v[176:179], v[240:255]
    ds_read_b64_tr_b16 v[148:149], v5 offset:4096
    ds_read_b64_tr_b16 v[150:151], v5 offset:5120
    s_waitcnt lgkmcnt(6)
    s_nop 0
    v_mfma_f32_32x32x16_bf16 v[224:239], v[136:139], v[180:183], v[224:239]
    ds_read_b64_tr_b16 v[152:153], v4 offset:6144
    ds_read_b64_tr_b16 v[154:155], v4 offset:7168
    buffer_load_dwordx4 v[172:175], v14, s[36:39], s88 offen offset:3072 sc1
    s_add_u32 s82, s82, 4096
    s_and_b32 s82, s82, 0xffff
    s_add_u32 s88, s82, s83
    s_waitcnt lgkmcnt(6)
    v_mfma_f32_32x32x16_bf16 v[240:255], v[140:143], v[180:183], v[240:255]
    ds_read_b64_tr_b16 v[156:157], v5 offset:6144
    ds_read_b64_tr_b16 v[158:159], v5 offset:7168
    v_add_u32 v4, 0x2000, v4
    v_and_b32 v4, 0x1ffff, v4
    v_xor_b32 v5, 64, v4
    s_waitcnt vmcnt(12) lgkmcnt(6)
    v_mfma_f32_32x32x16_bf16 v[224:239], v[144:147], v[184:187], v[224:239]
    ds_read_b64_tr_b16 v[128:129], v4 offset:0
    ds_read_b64_tr_b16 v[130:131], v4 offset:1024
    buffer_load_dwordx4 v[176:179], v14, s[36:39], s88 offen offset:0 sc1
    s_waitcnt lgkmcnt(6)
    v_mfma_f32_32x32x16_bf16 v[240:255], v[148:151], v[184:187], v[240:255]
    ds_read_b64_tr_b16 v[132:133], v5 offset:0
    ds_read_b64_tr_b16 v[134:135], v5 offset:1024
    s_waitcnt lgkmcnt(6)
    v_mfma_f32_32x32x16_bf16 v[224:239], v[152:155], v[188:191], v[224:239]
    ds_read_b64_tr_b16 v[136:137], v4 offset:2048
    ds_read_b64_tr_b16 v[138:139], v4 offset:3072
    buffer_load_dwordx4 v[180:183], v14, s[36:39], s88 offen offset:1024 sc1
    s_waitcnt lgkmcnt(6)
    v_mfma_f32_32x32x16_bf16 v[240:255], v[156:159], v[188:191], v[240:255]
    ds_read_b64_tr_b16 v[140:141], v5 offset:2048
    ds_read_b64_tr_b16 v[142:143], v5 offset:3072
    s_waitcnt vmcnt(12) lgkmcnt(6)
    v_mfma_f32_32x32x16_bf16 v[224:239], v[128:131], v[192:195], v[224:239]
    ds_read_b64_tr_b16 v[144:145], v4 offset:4096
    ds_read_b64_tr_b16 v[146:147], v4 offset:5120
    buffer_load_dwordx4 v[184:187], v14, s[36:39], s88 offen offset:2048 sc1
    s_waitcnt lgkmcnt(6)
    v_mfma_f32_32x32x16_bf16 v[240:255], v[132:135], v[192:195], v[240:255]
    ds_read_b64_tr_b16 v[148:149], v5 offset:4096
    ds_read_b64_tr_b16 v[150:151], v5 offset:5120
    s_waitcnt lgkmcnt(6)
    v_mfma_f32_32x32x16_bf16 v[224:239], v[136:139], v[196:199], v[224:239]
    ds_read_b64_tr_b16 v[152:153], v4 offset:6144
    ds_read_b64_tr_b16 v[154:155], v4 offset:7168
    buffer_load_dwordx4 v[188:191], v14, s[36:39], s88 offen offset:3072 sc1
    s_add_u32 s82, s82, 4096
    s_and_b32 s82, s82, 0xffff
    s_add_u32 s88, s82, s83
    s_waitcnt lgkmcnt(6)
    v_mfma_f32_32x32x16_bf16 v[240:255], v[140:143], v[196:199], v[240:255]
    ds_read_b64_tr_b16 v[156:157], v5 offset:6144
    ds_read_b64_tr_b16 v[158:159], v5 offset:7168
    v_add_u32 v4, 0x2000, v4
    v_and_b32 v4, 0x1ffff, v4
    v_xor_b32 v5, 64, v4
    s_waitcnt vmcnt(12) lgkmcnt(6)
    v_mfma_f32_32x32x16_bf16 v[224:239], v[144:147], v[200:203], v[224:239]
    ds_read_b64_tr_b16 v[128:129], v4 offset:0
    ds_read_b64_tr_b16 v[130:131], v4 offset:1024
    buffer_load_dwordx4 v[192:195], v14, s[36:39], s88 offen offset:0 sc1
    s_waitcnt lgkmcnt(6)
    v_mfma_f32_32x32x16_bf16 v[240:255], v[148:151], v[200:203], v[240:255]
    ds_read_b64_tr_b16 v[132:133], v5 offset:0
    ds_read_b64_tr_b16 v[134:135], v5 offset:1024
    s_waitcnt lgkmcnt(6)
    v_mfma_f32_32x32x16_bf16 v[224:239], v[152:155], v[204:207], v[224:239]
    ds_read_b64_tr_b16 v[136:137], v4 offset:2048
    ds_read_b64_tr_b16 v[138:139], v4 offset:3072
    buffer_load_dwordx4 v[196:199], v14, s[36:39], s88 offen offset:1024 sc1
    s_waitcnt lgkmcnt(6)
    v_mfma_f32_32x32x16_bf16 v[240:255], v[156:159], v[204:207], v[240:255]
    ds_read_b64_tr_b16 v[140:141], v5 offset:2048
    ds_read_b64_tr_b16 v[142:143], v5 offset:3072
    s_waitcnt vmcnt(12) lgkmcnt(6)
    v_mfma_f32_32x32x16_bf16 v[224:239], v[128:131], v[208:211], v[224:239]
    ds_read_b64_tr_b16 v[144:145], v4 offset:4096
    ds_read_b64_tr_b16 v[146:147], v4 offset:5120
    buffer_load_dwordx4 v[200:203], v14, s[36:39], s88 offen offset:2048 sc1
    s_waitcnt lgkmcnt(6)
    v_mfma_f32_32x32x16_bf16 v[240:255], v[132:135], v[208:211], v[240:255]
    ds_read_b64_tr_b16 v[148:149], v5 offset:4096
    ds_read_b64_tr_b16 v[150:151], v5 offset:5120
    s_waitcnt lgkmcnt(6)
    v_mfma_f32_32x32x16_bf16 v[224:239], v[136:139], v[212:215], v[224:239]
    ds_read_b64_tr_b16 v[152:153], v4 offset:6144
    ds_read_b64_tr_b16 v[154:155], v4 offset:7168
    buffer_load_dwordx4 v[204:207], v14, s[36:39], s88 offen offset:3072 sc1
    s_add_u32 s82, s82, 4096
    s_and_b32 s82, s82, 0xffff
    s_add_u32 s88, s82, s83
    s_waitcnt lgkmcnt(6)
    v_mfma_f32_32x32x16_bf16 v[240:255], v[140:143], v[212:215], v[240:255]
    ds_read_b64_tr_b16 v[156:157], v5 offset:6144
    ds_read_b64_tr_b16 v[158:159], v5 offset:7168
    v_add_u32 v4, 0x2000, v4
    v_and_b32 v4, 0x1ffff, v4
    v_xor_b32 v5, 64, v4
    s_waitcnt vmcnt(12) lgkmcnt(6)
    v_mfma_f32_32x32x16_bf16 v[224:239], v[144:147], v[216:219], v[224:239]
    ds_read_b64_tr_b16 v[128:129], v4 offset:0
    ds_read_b64_tr_b16 v[130:131], v4 offset:1024
    buffer_load_dwordx4 v[208:211], v14, s[36:39], s88 offen offset:0 sc1
    s_waitcnt lgkmcnt(6)
    v_mfma_f32_32x32x16_bf16 v[240:255], v[148:151], v[216:219], v[240:255]
    ds_read_b64_tr_b16 v[132:133], v5 offset:0
    ds_read_b64_tr_b16 v[134:135], v5 offset:1024
    s_waitcnt lgkmcnt(6)
    v_mfma_f32_32x32x16_bf16 v[224:239], v[152:155], v[220:223], v[224:239]
    ds_read_b64_tr_b16 v[136:137], v4 offset:2048
    ds_read_b64_tr_b16 v[138:139], v4 offset:3072
    buffer_load_dwordx4 v[212:215], v14, s[36:39], s88 offen offset:1024 sc1
    s_waitcnt lgkmcnt(6)
    v_mfma_f32_32x32x16_bf16 v[240:255], v[156:159], v[220:223], v[240:255]
    ds_read_b64_tr_b16 v[140:141], v5 offset:2048
    ds_read_b64_tr_b16 v[142:143], v5 offset:3072
    s_cmp_lt_u32 s84, 3
    s_cbranch_scc1 L_G2
    s_waitcnt vmcnt(12) lgkmcnt(6)
    v_mfma_f32_32x32x16_bf16 v[224:239], v[128:131], v[160:163], v[224:239]
    ds_read_b64_tr_b16 v[144:145], v4 offset:4096
    ds_read_b64_tr_b16 v[146:147], v4 offset:5120
    buffer_load_dwordx4 v[216:219], v14, s[36:39], s88 offen offset:2048 sc1
    s_waitcnt lgkmcnt(6)
    v_mfma_f32_32x32x16_bf16 v[240:255], v[132:135], v[160:163], v[240:255]
    ds_read_b64_tr_b16 v[148:149], v5 offset:4096
    ds_read_b64_tr_b16 v[150:151], v5 offset:5120
    s_waitcnt lgkmcnt(6)
    v_mfma_f32_32x32x16_bf16 v[224:239], v[136:139], v[164:167], v[224:239]
    ds_read_b64_tr_b16 v[152:153], v4 offset:6144
    ds_read_b64_tr_b16 v[154:155], v4 offset:7168
    buffer_load_dwordx4 v[220:223], v14, s[36:39], s88 offen offset:3072 sc1
    s_add_u32 s82, s82, 4096
    s_and_b32 s82, s82, 0xffff
    s_add_u32 s88, s82, s83
    s_waitcnt lgkmcnt(6)
    v_mfma_f32_32x32x16_bf16 v[240:255], v[140:143], v[164:167], v[240:255]
    ds_read_b64_tr_b16 v[156:157], v5 offset:6144
    ds_read_b64_tr_b16 v[158:159], v5 offset:7168
    s_barrier
    v_add_u32 v4, 0x2000, v4
    v_and_b32 v4, 0x1ffff, v4
    v_xor_b32_e64 v5, 64, v4
    s_waitcnt vmcnt(12) lgkmcnt(6)
    v_mfma_f32_32x32x16_bf16 v[224:239], v[144:147], v[168:171], v[224:239]
    ds_read_b64_tr_b16 v[128:129], v4 offset:0
    ds_read_b64_tr_b16 v[130:131], v4 offset:1024
    s_waitcnt lgkmcnt(6)
    v_mfma_f32_32x32x16_bf16 v[240:255], v[148:151], v[168:171], v[240:255]
    ds_read_b64_tr_b16 v[132:133], v5 offset:0
    ds_read_b64_tr_b16 v[134:135], v5 offset:1024
    s_waitcnt lgkmcnt(6)
    v_mfma_f32_32x32x16_bf16 v[224:239], v[152:155], v[172:175], v[224:239]
    ds_read_b64_tr_b16 v[136:137], v4 offset:2048
    ds_read_b64_tr_b16 v[138:139], v4 offset:3072
    s_waitcnt lgkmcnt(6)
    v_mfma_f32_32x32x16_bf16 v[240:255], v[156:159], v[172:175], v[240:255]
    ds_read_b64_tr_b16 v[140:141], v5 offset:2048
    ds_read_b64_tr_b16 v[142:143], v5 offset:3072
    s_waitcnt vmcnt(10) lgkmcnt(6)
    v_mfma_f32_32x32x16_bf16 v[224:239], v[128:131], v[176:179], v[224:239]
    ds_read_b64_tr_b16 v[144:145], v4 offset:4096
    ds_read_b64_tr_b16 v[146:147], v4 offset:5120
    s_waitcnt lgkmcnt(6)
    v_mfma_f32_32x32x16_bf16 v[240:255], v[132:135], v[176:179], v[240:255]
    ds_read_b64_tr_b16 v[148:149], v5 offset:4096
    ds_read_b64_tr_b16 v[150:151], v5 offset:5120
    s_waitcnt lgkmcnt(6)
    v_mfma_f32_32x32x16_bf16 v[224:239], v[136:139], v[180:183], v[224:239]
    ds_read_b64_tr_b16 v[152:153], v4 offset:6144
    ds_read_b64_tr_b16 v[154:155], v4 offset:7168
    s_waitcnt lgkmcnt(6)
    v_mfma_f32_32x32x16_bf16 v[240:255], v[140:143], v[180:183], v[240:255]
    ds_read_b64_tr_b16 v[156:157], v5 offset:6144
    ds_read_b64_tr_b16 v[158:159], v5 offset:7168
    v_add_u32 v4, 0x2000, v4
    v_and_b32 v4, 0x1ffff, v4
    v_xor_b32_e64 v5, 64, v4
    s_waitcnt vmcnt(8) lgkmcnt(6)
    v_mfma_f32_32x32x16_bf16 v[224:239], v[144:147], v[184:187], v[224:239]
    ds_read_b64_tr_b16 v[128:129], v4 offset:0
    ds_read_b64_tr_b16 v[130:131], v4 offset:1024
    s_waitcnt lgkmcnt(6)
    v_mfma_f32_32x32x16_bf16 v[240:255], v[148:151], v[184:187], v[240:255]
    ds_read_b64_tr_b16 v[132:133], v5 offset:0
    ds_read_b64_tr_b16 v[134:135], v5 offset:1024
    s_waitcnt lgkmcnt(6)
    v_mfma_f32_32x32x16_bf16 v[224:239], v[152:155], v[188:191], v[224:239]
    ds_read_b64_tr_b16 v[136:137], v4 offset:2048
    ds_read_b64_tr_b16 v[138:139], v4 offset:3072
    s_waitcnt lgkmcnt(6)
    v_mfma_f32_32x32x16_bf16 v[240:255], v[156:159], v[188:191], v[240:255]
    ds_read_b64_tr_b16 v[140:141], v5 offset:2048
    ds_read_b64_tr_b16 v[142:143], v5 offset:3072
    s_waitcnt vmcnt(6) lgkmcnt(6)
    v_mfma_f32_32x32x16_bf16 v[224:239], v[128:131], v[192:195], v[224:239]
    ds_read_b64_tr_b16 v[144:145], v4 offset:4096
    ds_read_b64_tr_b16 v[146:147], v4 offset:5120
    s_waitcnt lgkmcnt(6)
    v_mfma_f32_32x32x16_bf16 v[240:255], v[132:135], v[192:195], v[240:255]
    ds_read_b64_tr_b16 v[148:149], v5 offset:4096
    ds_read_b64_tr_b16 v[150:151], v5 offset:5120
    s_waitcnt lgkmcnt(6)
    v_mfma_f32_32x32x16_bf16 v[224:239], v[136:139], v[196:199], v[224:239]
    ds_read_b64_tr_b16 v[152:153], v4 offset:6144
    ds_read_b64_tr_b16 v[154:155], v4 offset:7168
    s_waitcnt lgkmcnt(6)
    v_mfma_f32_32x32x16_bf16 v[240:255], v[140:143], v[196:199], v[240:255]
    ds_read_b64_tr_b16 v[156:157], v5 offset:6144
    ds_read_b64_tr_b16 v[158:159], v5 offset:7168
    v_add_u32 v4, 0x2000, v4
    v_and_b32 v4, 0x1ffff, v4
    v_xor_b32_e64 v5, 64, v4
    s_waitcnt vmcnt(4) lgkmcnt(6)
    v_mfma_f32_32x32x16_bf16 v[224:239], v[144:147], v[200:203], v[224:239]
    ds_read_b64_tr_b16 v[128:129], v4 offset:0
    ds_read_b64_tr_b16 v[130:131], v4 offset:1024
    s_waitcnt lgkmcnt(6)
    v_mfma_f32_32x32x16_bf16 v[240:255], v[148:151], v[200:203], v[240:255]
    ds_read_b64_tr_b16 v[132:133], v5 offset:0
    ds_read_b64_tr_b16 v[134:135], v5 offset:1024
    s_waitcnt lgkmcnt(6)
    v_mfma_f32_32x32x16_bf16 v[224:239], v[152:155], v[204:207], v[224:239]
    ds_read_b64_tr_b16 v[136:137], v4 offset:2048
    ds_read_b64_tr_b16 v[138:139], v4 offset:3072
    s_waitcnt lgkmcnt(6)
    v_mfma_f32_32x32x16_bf16 v[240:255], v[156:159], v[204:207], v[240:255]
    ds_read_b64_tr_b16 v[140:141], v5 offset:2048
    ds_read_b64_tr_b16 v[142:143], v5 offset:3072
    s_waitcnt vmcnt(2) lgkmcnt(6)
    v_mfma_f32_32x32x16_bf16 v[224:239], v[128:131], v[208:211], v[224:239]
    ds_read_b64_tr_b16 v[144:145], v4 offset:4096
    ds_read_b64_tr_b16 v[146:147], v4 offset:5120
    s_waitcnt lgkmcnt(6)
    v_mfma_f32_32x32x16_bf16 v[240:255], v[132:135], v[208:211], v[240:255]
    ds_read_b64_tr_b16 v[148:149], v5 offset:4096
    ds_read_b64_tr_b16 v[150:151], v5 offset:5120
    s_waitcnt lgkmcnt(6)
    v_mfma_f32_32x32x16_bf16 v[224:239], v[136:139], v[212:215], v[224:239]
    ds_read_b64_tr_b16 v[152:153], v4 offset:6144
    ds_read_b64_tr_b16 v[154:155], v4 offset:7168
    s_waitcnt lgkmcnt(6)
    v_mfma_f32_32x32x16_bf16 v[240:255], v[140:143], v[212:215], v[240:255]
    ds_read_b64_tr_b16 v[156:157], v5 offset:6144
    ds_read_b64_tr_b16 v[158:159], v5 offset:7168
    s_waitcnt vmcnt(0) lgkmcnt(6)
    v_mfma_f32_32x32x16_bf16 v[224:239], v[144:147], v[216:219], v[224:239]
    s_waitcnt lgkmcnt(4)
    v_mfma_f32_32x32x16_bf16 v[240:255], v[148:151], v[216:219], v[240:255]
    s_waitcnt lgkmcnt(2)
    v_mfma_f32_32x32x16_bf16 v[224:239], v[152:155], v[220:223], v[224:239]
    s_waitcnt lgkmcnt(0)
    v_mfma_f32_32x32x16_bf16 v[240:255], v[156:159], v[220:223], v[240:255]
    s_nop 9
    v_pk_mul_f32 v[18:19], v[224:225], v[224:225]
    v_pk_mul_f32 v[20:21], v[224:225], v[60:61]
    v_pk_add_f32 v[16:17], v[224:225], v[226:227]
    v_pk_fma_f32 v[18:19], v[226:227], v[226:227], v[18:19]
    v_pk_fma_f32 v[20:21], v[226:227], v[62:63], v[20:21]
    v_pk_add_f32 v[16:17], v[16:17], v[228:229]
    v_pk_fma_f32 v[18:19], v[228:229], v[228:229], v[18:19]
    v_pk_fma_f32 v[20:21], v[228:229], v[64:65], v[20:21]
    v_pk_add_f32 v[16:17], v[16:17], v[230:231]
    v_pk_fma_f32 v[18:19], v[230:231], v[230:231], v[18:19]
    v_pk_fma_f32 v[20:21], v[230:231], v[66:67], v[20:21]
    v_pk_add_f32 v[16:17], v[16:17], v[232:233]
    v_pk_fma_f32 v[18:19], v[232:233], v[232:233], v[18:19]
    v_pk_fma_f32 v[20:21], v[232:233], v[68:69], v[20:21]
    v_pk_add_f32 v[16:17], v[16:17], v[234:235]
    v_pk_fma_f32 v[18:19], v[234:235], v[234:235], v[18:19]
    v_pk_fma_f32 v[20:21], v[234:235], v[70:71], v[20:21]
    v_pk_add_f32 v[16:17], v[16:17], v[236:237]
    v_pk_fma_f32 v[18:19], v[236:237], v[236:237], v[18:19]
    v_pk_fma_f32 v[20:21], v[236:237], v[72:73], v[20:21]
    v_pk_add_f32 v[16:17], v[16:17], v[238:239]
    v_pk_fma_f32 v[18:19], v[238:239], v[238:239], v[18:19]
L_pad10:
    s_cbranch_execz L_padret
    s_nop 0
    v_pk_fma_f32 v[20:21], v[238:239], v[74:75], v[20:21]
    v_pk_add_f32 v[16:17], v[16:17], v[240:241]
    v_pk_fma_f32 v[18:19], v[240:241], v[240:241], v[18:19]
    v_pk_fma_f32 v[20:21], v[240:241], v[76:77], v[20:21]
    v_pk_add_f32 v[16:17], v[16:17], v[242:243]
    v_pk_fma_f32 v[18:19], v[242:243], v[242:243], v[18:19]
    v_pk_fma_f32 v[20:21], v[242:243], v[78:79], v[20:21]
    v_pk_add_f32 v[16:17], v[16:17], v[244:245]
    v_pk_fma_f32 v[18:19], v[244:245], v[244:245], v[18:19]
    v_pk_fma_f32 v[20:21], v[244:245], v[80:81], v[20:21]
    v_pk_add_f32 v[16:17], v[16:17], v[246:247]
    v_pk_fma_f32 v[18:19], v[246:247], v[246:247], v[18:19]
    v_pk_fma_f32 v[20:21], v[246:247], v[82:83], v[20:21]
    v_pk_add_f32 v[16:17], v[16:17], v[248:249]
    v_pk_fma_f32 v[18:19], v[248:249], v[248:249], v[18:19]
    v_pk_fma_f32 v[20:21], v[248:249], v[84:85], v[20:21]
    v_pk_add_f32 v[16:17], v[16:17], v[250:251]
    v_pk_fma_f32 v[18:19], v[250:251], v[250:251], v[18:19]
    v_pk_fma_f32 v[20:21], v[250:251], v[86:87], v[20:21]
    v_pk_add_f32 v[16:17], v[16:17], v[252:253]
    v_pk_fma_f32 v[18:19], v[252:253], v[252:253], v[18:19]
    v_pk_fma_f32 v[20:21], v[252:253], v[88:89], v[20:21]
    v_pk_add_f32 v[16:17], v[16:17], v[254:255]
    v_pk_fma_f32 v[18:19], v[254:255], v[254:255], v[18:19]
    v_pk_fma_f32 v[20:21], v[254:255], v[90:91], v[20:21]
    v_mov_b32 v27, s75
    v_add_f32 v24, v16, v17
    v_add_f32 v25, v18, v19
    v_add_f32 v26, v20, v21
    v_mov_b32 v28, v24
    v_mov_b32 v29, v25
    v_mov_b32 v30, v26
    v_permlane32_swap_b32 v24, v28
    v_permlane32_swap_b32 v25, v29
    v_permlane32_swap_b32 v26, v30
    v_pk_add_f32 v[24:25], v[24:25], v[28:29]
    v_add_f32 v26, v26, v30
    s_mov_b32 exec_hi, 0
    s_bitcmp1_b32 s99, 1
    s_cbranch_scc1 Lls_46
    buffer_store_dwordx4 v[24:27], v14, s[36:39], s95 offen sc1
    s_branch Lle_47
Lls_46:
    buffer_store_dwordx4 v[24:27], v14, s[36:39], s95 offen
Lle_47:
    s_mov_b32 exec_hi, -1
    s_add_u32 s79, s94, 4096
    s_add_u32 s80, s94, 8192
    s_add_u32 s81, s94, 12288
    s_barrier
    v_xor_b32 v112, 0, v13
    ds_write_b128 v112, v[224:227]
    v_xor_b32_e64 v113, 32, v13
    ds_write_b128 v113, v[228:231]
    v_xor_b32_e64 v114, 64, v13
    ds_write_b128 v114, v[232:235]
    v_xor_b32 v115, 96, v13
    ds_write_b128 v115, v[236:239]
    v_xor_b32 v116, 128, v13
    ds_write_b128 v116, v[240:243]
    v_xor_b32 v117, 160, v13
    ds_write_b128 v117, v[244:247]
    buffer_load_dwordx4 v[64:67], v12, s[36:39], s94 offen offset:0 sc1
    buffer_load_dwordx4 v[68:71], v12, s[36:39], s94 offen offset:2048 sc1
    buffer_load_dwordx4 v[72:75], v12, s[36:39], s79 offen offset:0 sc1
    buffer_load_dwordx4 v[76:79], v12, s[36:39], s79 offen offset:2048 sc1
    buffer_load_dwordx4 v[80:83], v12, s[36:39], s80 offen offset:0 sc1
    buffer_load_dwordx4 v[84:87], v12, s[36:39], s80 offen offset:2048 sc1
    buffer_load_dwordx4 v[88:91], v12, s[36:39], s81 offen offset:0 sc1
    buffer_load_dwordx4 v[92:95], v12, s[36:39], s81 offen offset:2048 sc1
    v_xor_b32 v118, 192, v13
    ds_write_b128 v118, v[248:251]
    v_xor_b32 v119, 224, v13
    ds_write_b128 v119, v[252:255]
    s_mov_b32 s85, 1
    s_branch L_gchk
Lspin_48:
    s_add_u32 s85, s85, 1
    s_cmp_gt_u32 s85, 400000
    s_cbranch_scc1 L_end
    buffer_load_dwordx4 v[64:67], v12, s[36:39], s94 offen offset:0 sc1
    buffer_load_dwordx4 v[68:71], v12, s[36:39], s94 offen offset:2048 sc1
    buffer_load_dwordx4 v[72:75], v12, s[36:39], s79 offen offset:0 sc1
    buffer_load_dwordx4 v[76:79], v12, s[36:39], s79 offen offset:2048 sc1
    buffer_load_dwordx4 v[80:83], v12, s[36:39], s80 offen offset:0 sc1
    buffer_load_dwordx4 v[84:87], v12, s[36:39], s80 offen offset:2048 sc1
    buffer_load_dwordx4 v[88:91], v12, s[36:39], s81 offen offset:0 sc1
    buffer_load_dwordx4 v[92:95], v12, s[36:39], s81 offen offset:2048 sc1
L_gchk:
    s_waitcnt vmcnt(0)
    s_nop 0
    v_max3_u32 v16, v67, v71, v75
    v_max3_u32 v16, v16, v79, v83
    v_max3_u32 v16, v16, v87, v91
    v_max3_u32 v16, v16, v95, s75
    v_min3_u32 v17, v67, v71, v75
    v_min3_u32 v17, v17, v79, v83
    v_min3_u32 v17, v17, v87, v91
    v_min3_u32 v17, v17, v95, s75
    v_cmp_ne_u32_e64 vcc, v16, v17
    s_cbranch_vccnz Lspin_48
    s_barrier
    v_pk_add_f32 v[64:65], v[64:65], v[68:69]
    v_add_f32_e64 v66, v66, v70
    v_pk_add_f32 v[72:73], v[72:73], v[76:77]
    v_add_f32_e64 v74, v74, v78
    v_pk_add_f32 v[80:81], v[80:81], v[84:85]
    v_add_f32_e64 v82, v82, v86
    v_pk_add_f32 v[88:89], v[88:89], v[92:93]
    v_add_f32_e64 v90, v90, v94
    v_pk_add_f32 v[64:65], v[64:65], v[72:73]
    v_add_f32_e64 v66, v66, v74
    v_pk_add_f32 v[80:81], v[80:81], v[88:89]
    v_add_f32 v82, v82, v90
    v_add_f32 v24, v64, v80
    v_add_f32 v25, v65, v81
    v_add_f32 v26, v66, v82
    v_mov_b32 v28, v24
    v_mov_b32 v29, v25
    v_mov_b32 v30, v26
    v_permlane32_swap_b32 v24, v28
    v_permlane32_swap_b32 v25, v29
    v_permlane32_swap_b32 v26, v30
    v_pk_add_f32 v[24:25], v[24:25], v[28:29]
    v_add_f32_e64 v26, v26, v30
    v_mul_f32 v36, 0x3a800000, v24
    v_mul_f32 v40, 0x3a800000, v25
    v_fma_f32 v40, -v36, v36, v40
    v_max_f32_e64 v40, 0, v40
    v_cvt_pk_bf16_f32 v36, v36, v36
    v_and_b32 v36, 0xffff0000, v36
    v_cvt_pk_bf16_f32 v40, v40, v40
    v_and_b32 v40, 0xffff0000, v40
    v_add_f32 v40, 0x3727c5ac, v40
    v_cvt_pk_bf16_f32 v40, v40, v40
    v_and_b32 v40, 0xffff0000, v40
    v_sqrt_f32 v40, v40
    s_nop 0
    v_cvt_pk_bf16_f32 v40, v40, v40
    v_and_b32 v40, 0xffff0000, v40
    v_rcp_f32_e64 v38, v40
    v_fma_f32 v42, -v36, v126, v26
    s_mov_b32 s79, 0xfffff800
    v_mul_f32_e64 v42, v42, v38
    v_mul_f32 v39, -v36, v38
    v_and_or_b32 v42, v42, s79, v11
    s_mov_b32 exec_hi, 0
    ds_write_b64 v10, v[38:39]
    ds_max_f32 v44, v42
    s_mov_b32 exec_lo, 1
    ds_add_rtn_u32 v46, v44, v45 offset:4
    s_mov_b32 exec_lo, -1
    ds_read_b32 v20, v44
    v_lshlrev_b32 v17, 3, v2
    v_lshlrev_b32 v18, 2, v2
    v_mov_b32_e64 v21, s75
    s_mov_b32 s79, s96
    s_waitcnt lgkmcnt(0)
    v_readfirstlane_b32 s78, v46
    s_cmp_lg_u32 s78, 3
    s_cbranch_scc1 L_nocand
    s_mov_b32 exec_lo, 0xffff
    buffer_store_dwordx2 v[20:21], v17, s[36:39], s79 offen offset:128 sc1
    s_mov_b32 exec_lo, -1
    v_and_b32 v22, 127, v20
    v_and_b32 v23, 7, v20
    v_lshlrev_b32 v23, 4, v23
    v_xor_b32 v23, v23, v17
    v_lshl_add_u32 v23, v22, 8, v23
    v_lshlrev_b32_e64 v22, 3, v22
    ds_read_b64 v[24:25], v23
    v_add_u32 v22, 159744, v22
    ds_read_b64 v[26:27], v22
    s_waitcnt lgkmcnt(0)
    v_fma_f32 v28, v24, v26, v27
    v_fma_f32 v29, v25, v26, v27
    v_cvt_pk_bf16_f32 v30, v28, v29
    buffer_store_dword v30, v18, s[36:39], s79 offen sc1
    v_add_f32 v28, v28, v24
    v_add_f32_e64 v29, v29, v25
    buffer_store_dwordx2 v[28:29], v17, s[36:39], s79 offen offset:256 sc1
L_nocand:
    s_mov_b32 exec_hi, -1
    v_lshrrev_b32 v16, 3, v2
    v_and_b32 v17, 7, v2
    s_lshl_b32 s78, s76, 5
    v_add_u32 v18, s78, v16
    v_lshlrev_b32 v19, 1, v17
    v_xor_b32 v19, v19, v16
    v_lshlrev_b32 v19, 4, v19
    v_lshl_add_u32 v19, v18, 8, v19
    v_xor_b32 v32, 16, v19
    v_lshlrev_b32 v33, 3, v18
    v_add_u32 v33, 159744, v33
    ds_read_b128 v[64:67], v19 offset:0
    ds_read_b128 v[68:71], v32 offset:0
    ds_read_b64 v[96:97], v33 offset:0
    ds_read_b128 v[72:75], v19 offset:2048
    ds_read_b128 v[76:79], v32 offset:2048
    ds_read_b64 v[98:99], v33 offset:64
    ds_read_b128 v[80:83], v19 offset:4096
    ds_read_b128 v[84:87], v32 offset:4096
    ds_read_b64 v[100:101], v33 offset:128
    ds_read_b128 v[88:91], v19 offset:6144
    ds_read_b128 v[92:95], v32 offset:6144
    ds_read_b64 v[102:103], v33 offset:192
    s_lshl_b32 s78, s71, 7
    v_add_u32_e64 v18, s78, v18
    s_lshl_b32 s79, s72, 7
    v_lshl_add_u32 v19, v18, 11, s79
    v_lshl_add_u32 v19, v17, 4, v19
    v_mov_b32 v16, 163360
    s_waitcnt lgkmcnt(0)
    v_add_f32 v96, 1.0, v96
    v_pk_fma_f32 v[64:65], v[64:65], v[96:97], v[96:97] op_sel:[0,0,1] op_sel_hi:[1,0,1]
    v_pk_fma_f32 v[66:67], v[66:67], v[96:97], v[96:97] op_sel:[0,0,1] op_sel_hi:[1,0,1]
    v_pk_fma_f32 v[68:69], v[68:69], v[96:97], v[96:97] op_sel:[0,0,1] op_sel_hi:[1,0,1]
    v_pk_fma_f32 v[70:71], v[70:71], v[96:97], v[96:97] op_sel:[0,0,1] op_sel_hi:[1,0,1]
    v_cvt_pk_bf16_f32 v104, v64, v65
    v_cvt_pk_bf16_f32 v105, v66, v67
    v_cvt_pk_bf16_f32 v106, v68, v69
    v_cvt_pk_bf16_f32 v107, v70, v71
    v_add_f32_e64 v98, 1.0, v98
    v_pk_fma_f32 v[72:73], v[72:73], v[98:99], v[98:99] op_sel:[0,0,1] op_sel_hi:[1,0,1]
    v_pk_fma_f32 v[74:75], v[74:75], v[98:99], v[98:99] op_sel:[0,0,1] op_sel_hi:[1,0,1]
    v_pk_fma_f32 v[76:77], v[76:77], v[98:99], v[98:99] op_sel:[0,0,1] op_sel_hi:[1,0,1]
    v_pk_fma_f32 v[78:79], v[78:79], v[98:99], v[98:99] op_sel:[0,0,1] op_sel_hi:[1,0,1]
    v_cvt_pk_bf16_f32 v108, v72, v73
    v_cvt_pk_bf16_f32 v109, v74, v75
    v_cvt_pk_bf16_f32 v110, v76, v77
    v_cvt_pk_bf16_f32 v111, v78, v79
    v_add_f32_e64 v100, 1.0, v100
    v_pk_fma_f32 v[80:81], v[80:81], v[100:101], v[100:101] op_sel:[0,0,1] op_sel_hi:[1,0,1]
    v_pk_fma_f32 v[82:83], v[82:83], v[100:101], v[100:101] op_sel:[0,0,1] op_sel_hi:[1,0,1]
    v_pk_fma_f32 v[84:85], v[84:85], v[100:101], v[100:101] op_sel:[0,0,1] op_sel_hi:[1,0,1]
    v_pk_fma_f32 v[86:87], v[86:87], v[100:101], v[100:101] op_sel:[0,0,1] op_sel_hi:[1,0,1]
    v_cvt_pk_bf16_f32 v112, v80, v81
    v_cvt_pk_bf16_f32 v113, v82, v83
    v_cvt_pk_bf16_f32 v114, v84, v85
    v_cvt_pk_bf16_f32 v115, v86, v87
    v_add_f32_e64 v102, 1.0, v102
    v_pk_fma_f32 v[88:89], v[88:89], v[102:103], v[102:103] op_sel:[0,0,1] op_sel_hi:[1,0,1]
    v_pk_fma_f32 v[90:91], v[90:91], v[102:103], v[102:103] op_sel:[0,0,1] op_sel_hi:[1,0,1]
    v_pk_fma_f32 v[92:93], v[92:93], v[102:103], v[102:103] op_sel:[0,0,1] op_sel_hi:[1,0,1]
    v_pk_fma_f32 v[94:95], v[94:95], v[102:103], v[102:103] op_sel:[0,0,1] op_sel_hi:[1,0,1]
    v_cvt_pk_bf16_f32 v116, v88, v89
    v_cvt_pk_bf16_f32 v117, v90, v91
    v_cvt_pk_bf16_f32 v118, v92, v93
    v_cvt_pk_bf16_f32 v119, v94, v95
    s_barrier
    ds_read_b32 v17, v16
    s_waitcnt lgkmcnt(0)
    v_and_b32 v17, 0x7ff, v17
    v_sub_u32 v17, v17, v18
    s_barrier
    s_barrier
    s_mov_b32 s78, 0
    v_cmp_ne_u32_e64 vcc, 0, v17
    s_mov_b64 exec, vcc
    s_cbranch_execz Lo_49
    buffer_store_dwordx4 v[104:107], v19, s[44:47], s78 offen sc1
Lo_49:
    s_mov_b64 exec, -1
    s_mov_b32 s78, 16384
    v_cmp_ne_u32 vcc, 8, v17
    s_mov_b64 exec, vcc
    s_cbranch_execz Lo_50
    buffer_store_dwordx4 v[108:111], v19, s[44:47], s78 offen sc1
Lo_50:
    s_mov_b64 exec, -1
    s_mov_b32 s78, 32768
    v_cmp_ne_u32 vcc, 16, v17
    s_mov_b64 exec, vcc
    s_cbranch_execz Lo_51
    buffer_store_dwordx4 v[112:115], v19, s[44:47], s78 offen sc1
Lo_51:
    s_mov_b64 exec, -1
    s_mov_b32 s78, 49152
    v_cmp_ne_u32 vcc, 24, v17
    s_mov_b64 exec, vcc
    s_cbranch_execz Lo_52
    buffer_store_dwordx4 v[116:119], v19, s[44:47], s78 offen sc1
Lo_52:
    s_mov_b64 exec, -1
    s_branch L_fin
L_fin:
L_end:
    s_endpgm
.fill 64, 4, 0xbf800000
s_endpgm
.section .rodata,"a"
.p2align 6
.amdhsa_kernel sequential_preLN__linear_kernel_hedgehog__moe_arch_mod__prompt_kernel
  .amdhsa_next_free_vgpr 256
  .amdhsa_next_free_sgpr 102
  .amdhsa_accum_offset 256
  .amdhsa_group_segment_fixed_size 0
  .amdhsa_kernarg_size 96
  .amdhsa_user_sgpr_count 2
  .amdhsa_user_sgpr_kernarg_segment_ptr 1
  .amdhsa_system_sgpr_workgroup_id_x 1
  .amdhsa_float_denorm_mode_32 3
.end_amdhsa_kernel
```

```asm
; @launch grid=(256,1,1) block=(512,1,1) lds=163840
.amdgcn_target "amdgcn-amd-amdhsa--gfx950"
.text
.globl sequential_preLN__linear_kernel_hedgehog__moe_arch_mod__prompt_kernel
.p2align 8
.type sequential_preLN__linear_kernel_hedgehog__moe_arch_mod__prompt_kernel,@function
sequential_preLN__linear_kernel_hedgehog__moe_arch_mod__prompt_kernel:
    s_cmp_ge_u32 s2, 256
    s_cbranch_scc1 L_end
    s_load_dwordx16 s[4:19], s[0:1], 0
    s_load_dwordx8 s[20:27], s[0:1], 64
    v_lshrrev_b32 v1, 6, v0
    v_and_b32_e64 v2, 63, v0
    v_readfirstlane_b32 s68, v1
    s_lshr_b32 s69, s2, 4
    s_and_b32 s70, s2, 7
    s_lshl_b32 s70, s70, 1
    s_bfe_u32 s78, s2, 0x10003
    s_or_b32 s70, s70, s78
    s_and_b32 s76, s68, 3
    s_cmp_ge_u32 s68, 4
    s_cbranch_scc1 L_M
    v_lshrrev_b32 v196, 3, v2
    v_and_b32 v197, 7, v2
    v_lshrrev_b32_e64 v198, 4, v2
    s_and_b32 s80, s69, 0
    s_lshl_b32 s89, s76, 11
    s_lshl_b32 s66, s80, 10
    s_or_b32 s66, s66, s89
    s_xor_b32 s67, s66, 1024
    s_lshl_b32 s79, s70, 7
    s_movk_i32 s78, 6144
    v_mov_b32_e64 v199, s79
    v_mad_u32_u24 v199, v196, s78, v199
    s_lshl_b32 s80, s80, 2
    v_and_b32 v200, 2, v196
    v_xor_b32 v200, v200, v197
    v_xor_b32 v200, s80, v200
    v_lshl_add_u32 v199, v200, 4, v199
    s_mul_i32 s78, s66, 48
    s_mul_i32 s79, s67, 48
    v_add_u32 v6, s78, v199
    v_xor_b32 v199, 64, v199
    v_add_u32_e64 v7, s79, v199
    s_and_b32 s80, s70, 0
    s_lshl_b32 s88, s76, 12
    s_lshl_b32 s64, s80, 10
    s_or_b32 s64, s64, s88
    s_xor_b32 s65, s64, 1024
    s_lshl_b32 s80, s80, 2
    s_lshl_b32 s78, s69, 14
    s_add_u32 s78, s78, s64
    s_lshl_b32 s78, s78, 4
    v_lshl_add_u32 v199, v196, 11, s78
    v_xor_b32 v200, v198, v197
    v_xor_b32 v200, s80, v200
    v_lshl_add_u32 v4, v200, 4, v199
    v_xor_b32 v5, 16448, v4
    s_and_b32 s78, s70, 14
    s_and_b32 s79, s69, 14
    s_add_u32 s78, s78, s79
    s_sub_u32 s78, 32, s78
    s_and_b32 s78, s78, 15
    s_lshl_b32 s86, s78, 7
    s_mul_i32 s87, s78, 393216
    s_mov_b32 s30, 0x400000
    s_mov_b32 s31, 0x20000
    s_mov_b32 s34, 0x600000
    s_mov_b32 s35, 0x20000
    s_waitcnt lgkmcnt(0)
    s_mov_b32 s32, s6
    s_and_b32 s33, s7, 0xffff
    s_mov_b32 s28, s4
    s_and_b32 s29, s5, 0xffff
    s_add_u32 m0, s64, 118784
    s_nop 0
    buffer_load_dwordx4 v4, s[28:31], s86 offen offset:0  lds
    s_add_u32 m0, s66, 141312
    s_nop 0
    s_nop 0
    buffer_load_dwordx4 v6, s[32:35], s87 offen offset:2048  lds
    s_add_u32 m0, s64, 120832
    s_add_u32 s101, s86, 32768
    buffer_load_dwordx4 v4, s[28:31], s101 offen offset:0  lds
    s_add_u32 m0, s66, 151552
    s_add_u32 s101, s87, 4096
    buffer_load_dwordx4 v6, s[32:35], s101 offen offset:0  lds
    s_add_u32 m0, s66, 135168
    s_nop 0
    buffer_load_dwordx4 v6, s[32:35], s87 offen offset:0  lds
    s_add_u32 m0, s65, 118784
    s_nop 0
    buffer_load_dwordx4 v5, s[28:31], s86 offen offset:0  lds
    s_add_u32 m0, s67, 141312
    s_nop 0
    s_nop 0
    buffer_load_dwordx4 v7, s[32:35], s87 offen offset:2048  lds
    s_add_u32 m0, s65, 120832
    s_add_u32 s101, s86, 32768
    buffer_load_dwordx4 v5, s[28:31], s101 offen offset:0  lds
    s_add_u32 m0, s67, 151552
    s_add_u32 s101, s87, 4096
    buffer_load_dwordx4 v7, s[32:35], s101 offen offset:0  lds
    s_add_u32 m0, s67, 135168
    s_nop 0
    buffer_load_dwordx4 v7, s[32:35], s87 offen offset:0  lds
    s_add_u32 s86, s86, 128
    s_add_u32 s87, s87, 393216
    s_and_b32 s86, s86, 2047
    s_cselect_b32 s87, s87, 0
    s_mov_b32 s101, 40960
    s_cmp_ge_i32 s64, 0
    s_cselect_b32 s101, 0xfffec000, s101
    s_add_u32 s64, s64, s101
    s_add_u32 s65, s65, s101
    s_add_u32 s66, s66, s101
    s_add_u32 s67, s67, s101
    s_load_dword s75, s[26:27], 0
    s_mov_b32 s60, s8
    s_and_b32 s61, s9, 0xffff
    s_mov_b32 s62, 0x10000
    s_mov_b32 s63, 0x20000
    v_lshlrev_b32 v14, 4, v2
    s_lshl_b32 s78, s70, 12
    s_lshl_b32 s79, s76, 10
    s_add_u32 s78, s78, s79
    s_add_u32 m0, s79, 159744
    s_nop 0
    buffer_load_dwordx4 v14, s[60:63], s78 offen lds
    s_and_b32 s78, s2, 7
    s_lshr_b32 s79, s2, 3
    s_lshl_b32 s71, s78, 1
    s_and_b32 s72, s79, 1
    s_add_u32 s71, s71, s72
    s_lshr_b32 s72, s79, 1
    s_cmp_gt_u32 s70, 3
    s_cselect_b32 s78, 1, 0
    s_cmp_gt_u32 s70, 11
    s_cselect_b32 s78, 2, s78
    s_sub_u32 s78, s70, s78
    s_cmp_eq_u32 s70, 3
    s_cselect_b32 s78, 14, s78
    s_cmp_eq_u32 s70, 11
    s_cselect_b32 s78, 15, s78
    s_lshl_b32 s0, s78, 4
    s_add_u32 s0, s0, s69
    s_lshr_b32 s73, s0, 2
    s_and_b32 s74, s0, 3
    s_lshl_b32 s77, s70, 4
    s_add_u32 s77, s77, s69
    s_getpc_b64 s[12:13]
Lpr_1:
    s_add_u32 s12, s12, L_end-Lpr_1
    s_addc_u32 s13, s13, 0
    s_mov_b32 s36, s26
    s_and_b32 s37, s27, 0xffff
    s_mov_b32 s38, 0x10000000
    s_mov_b32 s39, 0x20000
    s_mov_b32 s40, s10
    s_and_b32 s41, s11, 0xffff
    s_mov_b32 s42, 0x200000
    s_mov_b32 s43, 0x20000
    s_mov_b32 s44, s22
    s_and_b32 s45, s23, 0xffff
    s_mov_b32 s46, 0x400000
    s_mov_b32 s47, 0x20000
    s_mov_b32 s48, s16
    s_and_b32 s49, s17, 0xffff
    s_mov_b32 s50, 0x700000
    s_mov_b32 s51, 0x20000
    s_mov_b32 s52, s18
    s_and_b32 s53, s19, 0xffff
    s_mov_b32 s54, 0x700000
    s_mov_b32 s55, 0x20000
    s_mov_b32 s56, s20
    s_and_b32 s57, s21, 0xffff
    s_mov_b32 s58, 0x700000
    s_mov_b32 s59, 0x20000
    v_mov_b32 v16, -1
    v_mov_b32 v17, -1
    v_mov_b32 v18, -1
    v_mov_b32_e64 v19, -1
    s_lshl_b32 s94, s77, 14
    s_lshl_b32 s78, s76, 12
    s_add_u32 s94, s94, s78
    s_add_u32 s94, s94, 4194304
    s_lshl_b32 s96, s77, 10
    s_add_u32 s96, s96, 8388608
    s_cmp_eq_u32 s76, 3
    s_cselect_b32 s96, s96, 0x10000000
    v_and_b32 v196, 15, v2
    v_lshrrev_b32 v197, 1, v196
    v_lshlrev_b32 v199, 7, v196
    v_add_u32 v199, s88, v199
    v_xor_b32_e64 v200, v198, v197
    v_lshl_add_u32 v60, v200, 4, v199
    v_bfe_u32 v196, v2, 2, 2
    v_and_b32_e64 v197, 3, v2
    v_lshl_add_u32 v199, v198, 3, v196
    v_lshlrev_b32_e64 v199, 7, v199
    v_lshl_add_u32 v199, v197, 3, v199
    v_lshrrev_b32 v196, 1, v196
    v_and_b32 v197, 1, v198
    v_lshl_add_u32 v196, v197, 1, v196
    s_mul_i32 s80, s76, 3
    s_add_u32 s78, s80, 0
    s_and_b32 s79, s78, 3
    s_lshr_b32 s78, s78, 2
    s_lshl_b32 s78, s78, 13
    s_add_u32 s78, s78, 16384
    v_xor_b32 v197, s79, v196
    v_lshl_add_u32 v197, v197, 5, v199
    v_add_u32_e64 v240, s78, v197
    s_add_u32 s78, s80, 1
    s_and_b32 s79, s78, 3
    s_lshr_b32 s78, s78, 2
    s_lshl_b32 s78, s78, 13
    s_add_u32 s78, s78, 16384
    v_xor_b32_e64 v197, s79, v196
    v_lshl_add_u32 v197, v197, 5, v199
    v_add_u32_e64 v241, s78, v197
    s_add_u32 s78, s80, 2
    s_and_b32 s79, s78, 3
    s_lshr_b32 s78, s78, 2
    s_lshl_b32 s78, s78, 13
    s_add_u32 s78, s78, 16384
    v_xor_b32_e64 v197, s79, v196
    v_lshl_add_u32 v197, v197, 5, v199
    v_add_u32 v242, s78, v197
    s_and_b32 s78, s70, 1
    s_lshl_b32 s78, s78, 6
    v_xor_b32 v60, s78, v60
    s_and_b32 s78, s69, 1
    s_lshl_b32 s78, s78, 12
    v_add_u32 v240, s78, v240
    v_add_u32 v241, s78, v241
    v_add_u32_e64 v242, s78, v242
    s_add_u32 m0, s64, 118784
    s_nop 0
    buffer_load_dwordx4 v4, s[28:31], s86 offen offset:0  lds
    v_lshrrev_b32 v196, 3, v2
    v_and_b32 v197, 7, v2
    v_lshlrev_b32 v199, 4, v197
    v_mul_u32_u24 v244, 57344, v196
    s_add_u32 m0, s66, 141312
    s_nop 0
    buffer_load_dwordx4 v6, s[32:35], s87 offen offset:2048  lds
    v_add_u32 v244, v244, v199
    v_lshl_add_u32 v245, v196, 14, v199
    s_lshl_b32 s78, s74, 2
    s_add_u32 s78, s78, s76
    s_add_u32 m0, s64, 120832
    s_add_u32 s101, s86, 32768
    buffer_load_dwordx4 v4, s[28:31], s101 offen offset:0  lds
    s_mul_i32 s79, s78, 458752
    s_add_u32 s80, s73, s76
    s_and_b32 s80, s80, 3
    s_andn2_b32 s100, s73, 3
    s_add_u32 m0, s66, 151552
    s_add_u32 s101, s87, 4096
    buffer_load_dwordx4 v6, s[32:35], s101 offen offset:0  lds
    s_or_b32 s80, s80, s100
    s_lshl_b32 s80, s80, 7
    s_add_u32 s79, s79, s80
    s_cmp_ge_u32 s73, 56
    s_cselect_b32 s79, 0x8000000, s79
    v_add_u32_e64 v244, s79, v244
    s_lshl_b32 s78, s78, 7
    s_add_u32 m0, s66, 135168
    s_nop 0
    buffer_load_dwordx4 v6, s[32:35], s87 offen offset:0  lds
    s_lshl_b32 s80, s73, 17
    s_add_u32 s78, s78, s80
    v_add_u32_e64 v245, s78, v245
    s_lshl_b32 s78, s72, 7
    s_add_u32 m0, s65, 118784
    s_nop 0
    buffer_load_dwordx4 v5, s[28:31], s86 offen offset:0  lds
    v_lshl_add_u32 v196, v196, 11, s78
    v_and_b32 v199, 1, v198
    v_lshlrev_b32 v199, 2, v199
    v_xor_b32 v199, v199, v197
    s_add_u32 m0, s67, 141312
    s_nop 0
    buffer_load_dwordx4 v7, s[32:35], s87 offen offset:2048  lds
    v_lshl_add_u32 v246, v199, 4, v196
    s_lshl_b32 s78, s71, 2
    s_add_u32 s78, s78, s76
    s_lshl_b32 s78, s78, 16
    v_add_u32_e64 v196, s78, v196
    s_add_u32 m0, s65, 120832
    s_add_u32 s101, s86, 32768
    buffer_load_dwordx4 v5, s[28:31], s101 offen offset:0  lds
    v_xor_b32_e64 v199, v198, v197
    v_lshl_add_u32 v247, v199, 4, v196
    v_xor_b32 v248, 64, v247
    s_lshl_b32 s78, s76, 14
    s_add_u32 m0, s67, 151552
    s_add_u32 s101, s87, 4096
    buffer_load_dwordx4 v7, s[32:35], s101 offen offset:0  lds
    v_add_u32 v246, s78, v246
    s_lshl_b32 s84, s76, 10
    s_bfe_u32 s78, s2, 0x40003
    s_lshl_b32 s78, s78, 17
    s_add_u32 m0, s67, 135168
    s_nop 0
    buffer_load_dwordx4 v7, s[32:35], s87 offen offset:0  lds
    s_add_u32 s86, s86, 128
    s_add_u32 s87, s87, 393216
    s_and_b32 s86, s86, 2047
    s_cselect_b32 s87, s87, 0
    s_mov_b32 s101, 40960
    s_cmp_ge_i32 s64, 0
    s_cselect_b32 s101, 0xfffec000, s101
    s_add_u32 s64, s64, s101
    s_add_u32 s65, s65, s101
    s_add_u32 s66, s66, s101
    s_add_u32 s67, s67, s101
    s_and_b32 s79, s72, 8
    s_add_u32 s79, s79, 3
    s_lshl_b32 s79, s79, 7
    s_add_u32 s78, s78, s79
    v_lshl_add_u32 v63, v2, 11, s78
    s_mul_i32 s100, s69, 52
    s_lshr_b32 s100, s100, 8
    s_mul_i32 s100, s100, 5
    s_sub_u32 s3, s69, s100
    s_branch L_sube
    .p2align 6
L_iss:
    s_add_u32 m0, s64, 118784
    s_nop 0
    buffer_load_dwordx4 v4, s[28:31], s86 offen offset:0  lds
    s_add_u32 m0, s66, 141312
    s_nop 0
    buffer_load_dwordx4 v6, s[32:35], s87 offen offset:2048  lds
    s_add_u32 m0, s64, 120832
    s_add_u32 s101, s86, 32768
    buffer_load_dwordx4 v4, s[28:31], s101 offen offset:0  lds
    s_add_u32 m0, s66, 151552
    s_add_u32 s101, s87, 4096
    buffer_load_dwordx4 v6, s[32:35], s101 offen offset:0  lds
    s_add_u32 m0, s66, 135168
    s_nop 0
    buffer_load_dwordx4 v6, s[32:35], s87 offen offset:0  lds
    s_add_u32 m0, s65, 118784
    s_nop 0
    buffer_load_dwordx4 v5, s[28:31], s86 offen offset:0  lds
    s_add_u32 m0, s67, 141312
    s_nop 0
    s_nop 0
    buffer_load_dwordx4 v7, s[32:35], s87 offen offset:2048  lds
    s_add_u32 m0, s65, 120832
    s_add_u32 s101, s86, 32768
    buffer_load_dwordx4 v5, s[28:31], s101 offen offset:0  lds
    s_add_u32 m0, s67, 151552
    s_add_u32 s101, s87, 4096
    buffer_load_dwordx4 v7, s[32:35], s101 offen offset:0  lds
    s_add_u32 m0, s67, 135168
    s_nop 0
    buffer_load_dwordx4 v7, s[32:35], s87 offen offset:0  lds
    s_add_u32 s86, s86, 128
    s_add_u32 s87, s87, 393216
    s_and_b32 s86, s86, 2047
    s_cselect_b32 s87, s87, 0
    s_mov_b32 s101, 40960
    s_cmp_ge_i32 s64, 0
    s_cselect_b32 s101, 0xfffec000, s101
    s_add_u32 s64, s64, s101
    s_add_u32 s65, s65, s101
    s_add_u32 s66, s66, s101
    s_add_u32 s67, s67, s101
    s_setpc_b64 s[90:91]
    .p2align 6
L_cl0:
    s_mov_b32 s100, 0
    buffer_load_dwordx4 v[64:67], v244, s[48:51], s100 offen nt
    s_mov_b32 s100, 0
    buffer_load_dwordx4 v[96:99], v244, s[52:55], s100 offen nt
    s_mov_b32 s100, 7168
    buffer_load_dwordx4 v[68:71], v244, s[48:51], s100 offen nt
    s_mov_b32 s100, 7168
    buffer_load_dwordx4 v[100:103], v244, s[52:55], s100 offen nt
    s_mov_b32 s100, 14336
    buffer_load_dwordx4 v[72:75], v244, s[48:51], s100 offen nt
    s_mov_b32 s100, 14336
    buffer_load_dwordx4 v[104:107], v244, s[52:55], s100 offen nt
    s_setpc_b64 s[90:91]
    .p2align 6
L_cl1:
    s_mov_b32 s100, 21504
    buffer_load_dwordx4 v[76:79], v244, s[48:51], s100 offen nt
    s_mov_b32 s100, 21504
    buffer_load_dwordx4 v[108:111], v244, s[52:55], s100 offen nt
    s_mov_b32 s100, 28672
    buffer_load_dwordx4 v[80:83], v244, s[48:51], s100 offen nt
    s_mov_b32 s100, 28672
    buffer_load_dwordx4 v[112:115], v244, s[52:55], s100 offen nt
    s_mov_b32 s100, 35840
    buffer_load_dwordx4 v[84:87], v244, s[48:51], s100 offen nt
    s_mov_b32 s100, 35840
    buffer_load_dwordx4 v[116:119], v244, s[52:55], s100 offen nt
    s_setpc_b64 s[90:91]
    .p2align 12
L_sube:
    s_waitcnt vmcnt(10)
    s_barrier
    s_call_b64 s[90:91], L_iss
    s_setprio 2
    v_add_u32 v196, 118784, v60
    v_add_u32 v198, 118784, v240
    v_add_u32 v199, 118784, v241
    v_add_u32 v200, 118784, v242
    ds_read_b128 v[20:23], v196 offset:0
    ds_read_b128 v[24:27], v196 offset:2048
    ds_read_b64_tr_b16 v[36:37], v198 offset:0
    ds_read_b64_tr_b16 v[38:39], v198 offset:512
    ds_read_b64_tr_b16 v[44:45], v199 offset:0
    ds_read_b64_tr_b16 v[46:47], v199 offset:512
    ds_read_b64_tr_b16 v[52:53], v200 offset:0
    ds_read_b64_tr_b16 v[54:55], v200 offset:512
    s_setprio 0
    s_waitcnt lgkmcnt(0)
    s_mul_i32 s75, s75, 0x9E3779B1
    s_add_u32 s75, s75, 0x7F4A7C15
    s_waitcnt vmcnt(10)
    s_waitcnt lgkmcnt(0)
    s_barrier
    s_call_b64 s[90:91], L_iss
    s_setprio 2
    s_nop 0
    v_add_u32 v196, 36864, v60
    v_add_u32 v198, 36864, v240
    v_add_u32 v199, 36864, v241
    v_add_u32 v200, 36864, v242
    ds_read_b128 v[28:31], v196 offset:0
    ds_read_b128 v[32:35], v196 offset:2048
    ds_read_b64_tr_b16 v[40:41], v198 offset:0
    ds_read_b64_tr_b16 v[42:43], v198 offset:512
    ds_read_b64_tr_b16 v[48:49], v199 offset:0
    ds_read_b64_tr_b16 v[50:51], v199 offset:512
    ds_read_b64_tr_b16 v[56:57], v200 offset:0
    ds_read_b64_tr_b16 v[58:59], v200 offset:512
    s_setprio 0
    s_getreg_b32 s99, hwreg(HW_REG_XCC_ID, 0, 4)
    v_mov_b32 v10, s75
    v_mov_b32 v11, s99
    v_not_b32 v12, v10
    v_mov_b32 v13, 0
    v_and_b32 v8, 15, v2
    v_lshlrev_b32 v9, 4, v8
    v_add_u32_e64 v9, s69, v9
    s_lshl_b32 s78, s70, 4
    s_lshl_b32 s79, s71, 4
    s_add_u32 s79, s79, 69088
    v_mov_b32 v202, s78
    v_mov_b32 v203, s79
    v_cmp_gt_u32 vcc, 32, v2
    s_nop 1
    v_cndmask_b32 v202, v203, v202, vcc
    v_add_u32 v8, v202, v8
    v_cmp_gt_u32 vcc, 16, v2
    s_nop 1
    v_cndmask_b32 v8, v8, v9, vcc
    v_lshlrev_b32 v8, 7, v8
    v_add_u32 v8, 4096, v8
    v_lshlrev_b32 v9, 3, v2
    s_lshl_b32 s82, s77, 7
    s_add_u32 s82, s82, 4096
    s_lshl_b32 s79, s71, 4
    s_add_u32 s79, s79, s72
    s_lshl_b32 s79, s79, 7
    s_add_u32 s79, s79, 8847360
    s_cmp_eq_u32 s76, 1
    s_cselect_b32 s82, s79, s82
    s_cmp_gt_u32 s76, 1
    s_cselect_b32 s82, 0x10000000, s82
    s_lshl_b32 s83, s77, 9
    s_add_u32 s83, s83, 8912896
    s_cmp_eq_u32 s76, 2
    s_cselect_b32 s83, s83, 0x10000000
    buffer_store_dwordx2 v[12:13], v9, s[36:39], s83 offen sc1
    s_waitcnt vmcnt(11)
    s_waitcnt lgkmcnt(0)
    s_barrier
    s_call_b64 s[90:91], L_iss
    s_waitcnt vmcnt(11)
    s_cmp_lg_u32 s3, 0
    s_cbranch_scc1 Lcs_2
    s_call_b64 s[90:91], L_cl0
Lcs_2:
    s_barrier
    s_setprio 2
    s_add_u32 m0, s64, 118784
    s_nop 0
    s_nop 0
    buffer_load_dwordx4 v4, s[28:31], s86 offen offset:0  lds
    v_mov_b32 v200, 0x3f803f80
    v_mov_b32 v201, 0x3f803f80
    v_mov_b32 v202, 0x3f803f80
    v_mov_b32 v203, 0x3f803f80
    s_add_u32 m0, s66, 141312
    s_nop 0
    s_nop 0
    buffer_load_dwordx4 v6, s[32:35], s87 offen offset:2048  lds
    v_mfma_f32_16x16x32_bf16 v[204:207], v[200:203], v[20:23], 0
    v_mfma_f32_16x16x32_bf16 v[212:215], v[20:23], v[20:23], 0
    v_mfma_f32_16x16x32_bf16 v[208:211], v[200:203], v[24:27], 0
    v_mfma_f32_16x16x32_bf16 v[216:219], v[24:27], v[24:27], 0
    s_add_u32 m0, s64, 120832
    s_add_u32 s101, s86, 32768
    buffer_load_dwordx4 v4, s[28:31], s101 offen offset:0  lds
    v_mfma_f32_16x16x32_bf16 v[220:223], v[200:203], v[36:39], 0
    v_mfma_f32_16x16x32_bf16 v[224:227], v[200:203], v[44:47], 0
    v_mfma_f32_16x16x32_bf16 v[228:231], v[200:203], v[52:55], 0
    v_mfma_f32_16x16x32_bf16 v[204:207], v[200:203], v[28:31], v[204:207]
    v_mfma_f32_16x16x32_bf16 v[212:215], v[28:31], v[28:31], v[212:215]
    s_add_u32 m0, s66, 151552
    s_add_u32 s101, s87, 4096
    buffer_load_dwordx4 v6, s[32:35], s101 offen offset:0  lds
    v_mfma_f32_16x16x32_bf16 v[208:211], v[200:203], v[32:35], v[208:211]
    v_mfma_f32_16x16x32_bf16 v[216:219], v[32:35], v[32:35], v[216:219]
    v_mfma_f32_16x16x32_bf16 v[220:223], v[200:203], v[40:43], v[220:223]
    v_mfma_f32_16x16x32_bf16 v[224:227], v[200:203], v[48:51], v[224:227]
    s_add_u32 m0, s66, 135168
    s_nop 0
    buffer_load_dwordx4 v6, s[32:35], s87 offen offset:0  lds
    v_mfma_f32_16x16x32_bf16 v[228:231], v[200:203], v[56:59], v[228:231]
    v_and_b32 v196, 3, v2
    v_cmp_eq_u32 s[90:91], 1, v196
    v_cmp_eq_u32 s[92:93], 2, v196
    v_cmp_eq_u32_e64 vcc, 3, v196
    s_add_u32 m0, s65, 118784
    s_nop 0
    buffer_load_dwordx4 v5, s[28:31], s86 offen offset:0  lds
    v_cndmask_b32 v212, v212, v213, s[90:91]
    v_cndmask_b32 v212, v212, v214, s[92:93]
    v_cndmask_b32 v205, v212, v215, vcc
    v_cndmask_b32 v216, v216, v217, s[90:91]
    s_add_u32 m0, s67, 141312
    s_nop 0
    buffer_load_dwordx4 v7, s[32:35], s87 offen offset:2048  lds
    v_cndmask_b32 v216, v216, v218, s[92:93]
    v_cndmask_b32 v209, v216, v219, vcc
    v_lshrrev_b32_e64 v196, 4, v2
    v_cmp_eq_u32 s[90:91], 1, v196
    v_cmp_eq_u32_e64 vcc, 2, v196
    s_add_u32 m0, s65, 120832
    s_add_u32 s101, s86, 32768
    buffer_load_dwordx4 v5, s[28:31], s101 offen offset:0  lds
    v_cndmask_b32 v220, v220, v224, s[90:91]
    v_cndmask_b32_e64 v220, v220, v228, vcc
    s_mul_i32 s78, s77, 768
    s_mul_i32 s79, s76, 192
    s_add_u32 m0, s67, 151552
    s_add_u32 s101, s87, 4096
    buffer_load_dwordx4 v7, s[32:35], s101 offen offset:0  lds
    s_add_u32 s78, s78, s79
    s_add_u32 s78, s78, 327680
    v_lshlrev_b32 v197, 2, v2
    s_mov_b32 exec_hi, 0xffff
    buffer_store_dword v220, v197, s[36:39], s78 offen sc1
    s_mov_b32 exec_hi, -1
    s_lshl_b32 s78, s69, 4
    s_add_u32 m0, s67, 135168
    s_nop 0
    buffer_load_dwordx4 v7, s[32:35], s87 offen offset:0  lds
    s_add_u32 s86, s86, 128
    s_add_u32 s87, s87, 393216
    s_and_b32 s86, s86, 2047
    s_cselect_b32 s87, s87, 0
    s_mov_b32 s101, 40960
    s_cmp_ge_i32 s64, 0
    s_cselect_b32 s101, 0xfffec000, s101
    s_add_u32 s64, s64, s101
    s_add_u32 s65, s65, s101
    s_add_u32 s66, s66, s101
    s_add_u32 s67, s67, s101
    s_add_u32 s78, s78, s70
    s_lshl_b32 s78, s78, 10
    s_lshl_b32 s79, s76, 8
    s_add_u32 s78, s78, s79
    buffer_store_dwordx4 v[16:19], v14, s[36:39], s96 offen offset:0 sc1
    s_add_u32 s78, s78, 65536
    v_and_b32 v198, 15, v2
    v_lshlrev_b32_e64 v198, 3, v198
    s_mov_b32 exec_lo, 0x00f0000f
    s_mov_b32 exec_hi, 0xf0000f00
    buffer_store_dwordx2 v[204:205], v198, s[36:39], s78 offen offset:0 sc1
    s_mov_b64 exec, -1
    s_mov_b32 exec_lo, 0x00f0000f
    s_mov_b32 exec_hi, 0xf0000f00
    buffer_store_dwordx2 v[208:209], v198, s[36:39], s78 offen offset:128 sc1
    s_mov_b64 exec, -1
    s_setprio 0
    s_waitcnt vmcnt(14)
    s_cmp_lg_u32 s3, 1
    s_cbranch_scc1 Lcs_3
    s_call_b64 s[90:91], L_cl0
Lcs_3:
    s_barrier
    s_call_b64 s[90:91], L_iss
    s_waitcnt vmcnt(10)
    s_cmp_lg_u32 s3, 2
    s_cbranch_scc1 Lcs_4
    s_call_b64 s[90:91], L_cl0
Lcs_4:
    s_barrier
    s_mov_b64 exec, 0xffff
    buffer_store_dwordx2 v[10:11], v9, s[36:39], s82 offen sc1
    s_mov_b64 exec, -1
    s_call_b64 s[90:91], L_iss
    s_waitcnt vmcnt(11)
    s_cmp_lg_u32 s3, 3
    s_cbranch_scc1 Lcs_5
    s_call_b64 s[90:91], L_cl0
Lcs_5:
    s_barrier
    s_call_b64 s[90:91], L_iss
    s_waitcnt vmcnt(10)
    s_cmp_lg_u32 s3, 4
    s_cbranch_scc1 Lcs_6
    s_call_b64 s[90:91], L_cl0
Lcs_6:
    s_barrier
    s_call_b64 s[90:91], L_iss
    s_waitcnt vmcnt(10)
    s_cmp_lg_u32 s3, 0
    s_cbranch_scc1 Lcs_7
    s_call_b64 s[90:91], L_cl1
Lcs_7:
    s_barrier
    s_call_b64 s[90:91], L_iss
    s_waitcnt vmcnt(10)
    s_cmp_lg_u32 s3, 1
    s_cbranch_scc1 Lcs_8
    s_call_b64 s[90:91], L_cl1
Lcs_8:
    s_barrier
    s_call_b64 s[90:91], L_iss
    s_waitcnt vmcnt(10)
    s_cmp_lg_u32 s3, 2
    s_cbranch_scc1 Lcs_9
    s_call_b64 s[90:91], L_cl1
Lcs_9:
    s_barrier
    s_call_b64 s[90:91], L_iss
    s_waitcnt vmcnt(10)
    s_cmp_lg_u32 s3, 3
    s_cbranch_scc1 Lcs_10
    s_call_b64 s[90:91], L_cl1
Lcs_10:
    s_barrier
    s_call_b64 s[90:91], L_iss
    s_waitcnt vmcnt(10)
    s_cmp_lg_u32 s3, 4
    s_cbranch_scc1 Lcs_11
    s_call_b64 s[90:91], L_cl1
Lcs_11:
    s_barrier
    s_cmp_lg_u32 s76, 0
    s_cbranch_scc1 Lpl_12
    s_mov_b32 exec_hi, 0xffff
    buffer_load_dwordx2 v[10:11], v8, s[36:39], 0 offen sc1
    s_mov_b64 exec, -1
Lpl_12:
    s_call_b64 s[90:91], L_iss
    s_cmp_lg_u32 s76, 1
    s_cbranch_scc1 Lpf_13
    s_getpc_b64 s[90:91]
Lpc_14:
    s_add_u32 s90, s90, L_phend-Lpc_14
    s_addc_u32 s91, s91, 0
    s_lshr_b32 s100, s2, 3
    s_lshl_b32 s100, s100, 10
    s_min_u32 s100, s100, (L_end-L_phend-768)
    v_add_u32 v236, s100, v14
    global_load_dword v236, v236, s[90:91]
Lpf_13:
    s_waitcnt vmcnt(10)
    s_barrier
    s_cmp_lg_u32 s76, 2
    s_cbranch_scc1 Lc4_15
    s_mov_b32 exec_hi, -1
    buffer_load_dword v238, v63, s[40:43], 0 offen
    s_mov_b64 exec, -1
Lc4_15:
    s_call_b64 s[90:91], L_iss
    s_waitcnt vmcnt(10)
    s_cmp_lg_u32 s76, 0
    s_cbranch_scc1 Lpc_16
    s_setprio 2
    s_mov_b32 exec_hi, 0xffff
    s_mov_b32 s85, 0
    s_branch Lpk_17
Lspin_18:
    s_add_u32 s85, s85, 1
    s_cmp_gt_u32 s85, 400000
    s_cbranch_scc1 L_end
    buffer_load_dwordx2 v[10:11], v8, s[36:39], 0 offen sc1
    s_waitcnt vmcnt(0)
Lpk_17:
    v_cmp_ne_u32 vcc, s75, v10
    s_cbranch_vccnz Lspin_18
    v_cmp_ne_u32 vcc, s99, v11
    s_mov_b64 exec, -1
    s_lshr_b32 s78, vcc_lo, 16
    s_cselect_b32 s78, 0, 1
    s_cmp_eq_u32 vcc_hi, 0
    s_cselect_b32 s79, 2, 0
    s_or_b32 s78, s78, s79
    s_and_b32 s78, s78, 3
    v_mov_b32_e64 v10, s78
    v_mov_b32 v11, 163584
    ds_write_b32 v11, v10
    s_setprio 0
Lpc_16:
    s_barrier
    v_lshrrev_b32 v196, 4, v2
    v_and_b32 v197, 15, v2
    v_lshlrev_b32_e64 v197, 4, v197
    v_lshl_add_u32 v198, v196, 10, v197
    s_lshl_b32 s78, s69, 14
    s_lshl_b32 s79, s76, 8
    s_add_u32 s78, s78, s79
    s_nop 0
    s_add_u32 s78, s78, 65536
    buffer_load_dwordx4 v[20:23], v198, s[36:39], s78 offen sc1
    s_add_u32 s78, s78, 4096
    buffer_load_dwordx4 v[24:27], v198, s[36:39], s78 offen sc1
    s_add_u32 s78, s78, 4096
    buffer_load_dwordx4 v[28:31], v198, s[36:39], s78 offen sc1
    s_add_u32 s78, s78, 4096
    buffer_load_dwordx4 v[32:35], v198, s[36:39], s78 offen sc1
    v_mul_u32_u24 v198, 768, v196
    v_add_u32_e64 v198, v198, v197
    s_mul_i32 s78, s70, 12288
    s_lshl_b32 s79, s76, 8
    s_add_u32 s78, s78, s79
    s_add_u32 s78, s78, 327680
    s_cmp_eq_u32 s76, 3
    s_nop 0
    s_cselect_b32 s78, 0x10000000, s78
    buffer_load_dwordx4 v[36:39], v198, s[36:39], s78 offen sc1
    s_add_u32 s78, s78, 3072
    buffer_load_dwordx4 v[40:43], v198, s[36:39], s78 offen sc1
    s_add_u32 s78, s78, 3072
    buffer_load_dwordx4 v[44:47], v198, s[36:39], s78 offen sc1
    s_add_u32 s78, s78, 3072
    buffer_load_dwordx4 v[48:51], v198, s[36:39], s78 offen sc1
    s_add_u32 m0, s84, 0
    s_mov_b32 s100, 0
    buffer_load_dwordx4 v246, s[40:43], s100 offen  lds
    s_add_u32 m0, s84, 4096
    s_mov_b32 s100, 65536
    buffer_load_dwordx4 v246, s[40:43], s100 offen  lds
    s_add_u32 m0, s84, 8192
    s_mov_b32 s100, 131072
    buffer_load_dwordx4 v246, s[40:43], s100 offen  lds
    s_add_u32 m0, s84, 12288
    s_mov_b32 s100, 196608
    buffer_load_dwordx4 v246, s[40:43], s100 offen  lds
    s_waitcnt vmcnt(12)
    s_barrier
    s_setprio 2
    s_add_u32 m0, s84, 16384
    s_mov_b32 s100, 262144
    buffer_load_dwordx4 v246, s[40:43], s100 offen  lds
    s_waitcnt vmcnt(9)
    v_add_f32 v20, v20, v24
    v_add_f32 v21, v21, v25
    v_add_f32 v22, v22, v26
    v_add_f32 v23, v23, v27
    v_add_f32 v20, v20, v28
    v_add_f32 v21, v21, v29
    s_add_u32 m0, s84, 20480
L_pad0:
    s_cbranch_execz L_pad4
    s_mov_b32 s100, 327680
    buffer_load_dwordx4 v246, s[40:43], s100 offen  lds
    v_add_f32 v22, v22, v30
    v_add_f32 v23, v23, v31
    v_add_f32 v20, v20, v32
    v_add_f32 v21, v21, v33
    v_add_f32 v22, v22, v34
    v_add_f32 v23, v23, v35
    s_nop 0
    v_permlane32_swap_b32_e64 v20, v22
    s_add_u32 m0, s84, 24576
    s_mov_b32 s100, 393216
    buffer_load_dwordx4 v246, s[40:43], s100 offen  lds
    v_permlane32_swap_b32 v21, v23
    v_add_f32 v20, v20, v22
    v_add_f32 v21, v21, v23
    v_mov_b32 v22, v20
    v_mov_b32 v23, v21
    s_nop 0
    v_permlane16_swap_b32 v20, v22
    v_permlane16_swap_b32 v21, v23
    v_add_f32_e64 v20, v20, v22
    s_add_u32 m0, s84, 28672
    s_mov_b32 s100, 458752
    buffer_load_dwordx4 v246, s[40:43], s100 offen  lds
    v_add_f32_e64 v21, v21, v23
    v_mul_f32 v24, 0x3a800000, v20
    v_mul_f32 v26, 0x3a800000, v21
    v_fma_f32 v26, -v24, v24, v26
    v_max_f32_e64 v26, 0, v26
    v_cvt_pk_bf16_f32 v24, v24, v24
    v_and_b32 v24, 0xffff0000, v24
    s_add_u32 m0, s84, 32768
    s_mov_b32 s100, 524288
    buffer_load_dwordx4 v246, s[40:43], s100 offen  lds
    v_cvt_pk_bf16_f32 v26, v26, v26
    v_and_b32 v26, 0xffff0000, v26
    v_add_f32 v26, 0x3727c5ac, v26
    v_cvt_pk_bf16_f32 v26, v26, v26
    v_and_b32 v26, 0xffff0000, v26
    v_sqrt_f32 v26, v26
    s_nop 0
    v_cvt_pk_bf16_f32 v26, v26, v26
    v_and_b32 v26, 0xffff0000, v26
    s_add_u32 m0, s84, 36864
    s_mov_b32 s100, 589824
    buffer_load_dwordx4 v246, s[40:43], s100 offen  lds
    v_rcp_f32_e64 v25, v26
    v_xor_b32 v26, 0x80000000, v24
    v_lshrrev_b32 v27, 16, v26
    v_or_b32 v26, v26, v27
    v_mov_b32 v27, 0
    v_and_b32 v196, 15, v2
    v_lshrrev_b32_e64 v197, 5, v2
    s_add_u32 m0, s84, 40960
    s_mov_b32 s100, 655360
    buffer_load_dwordx4 v246, s[40:43], s100 offen  lds
    v_lshl_add_u32 v196, v196, 1, v197
    s_lshl_b32 s78, s76, 5
    v_add_u32 v196, s78, v196
    v_lshlrev_b32_e64 v197, 3, v196
    v_add_u32 v197, 159744, v197
    v_lshlrev_b32_e64 v196, 2, v196
    v_add_u32 v196, 162304, v196
    s_add_u32 m0, s84, 45056
    s_mov_b32 s100, 720896
    buffer_load_dwordx4 v246, s[40:43], s100 offen  lds
    ds_write_b64 v197, v[26:27]
    ds_write_b32 v196, v25
    s_waitcnt vmcnt(12)
    v_add_f32 v36, v36, v40
    v_add_f32 v37, v37, v41
    v_add_f32 v38, v38, v42
    v_add_f32 v39, v39, v43
    v_add_f32 v36, v36, v44
    s_add_u32 m0, s84, 49152
    s_mov_b32 s100, 786432
    buffer_load_dwordx4 v246, s[40:43], s100 offen  lds
    v_add_f32 v37, v37, v45
    v_add_f32 v38, v38, v46
    v_add_f32 v39, v39, v47
    v_add_f32 v36, v36, v48
    v_add_f32 v37, v37, v49
    v_add_f32 v38, v38, v50
    v_add_f32_e64 v39, v39, v51
    s_add_u32 m0, s84, 53248
    s_mov_b32 s100, 851968
    buffer_load_dwordx4 v246, s[40:43], s100 offen  lds
    v_permlane32_swap_b32 v36, v38
    v_permlane32_swap_b32 v37, v39
    v_add_f32 v36, v36, v38
    v_add_f32 v37, v37, v39
    s_nop 1
    v_permlane16_swap_b32 v36, v37
    v_add_f32_e64 v36, v36, v37
    v_cvt_pk_bf16_f32 v37, v36, v36
    v_and_b32 v37, 0xffff0000, v37
    s_add_u32 m0, s84, 57344
    s_mov_b32 s100, 917504
    buffer_load_dwordx4 v246, s[40:43], s100 offen  lds
    v_sub_f32_e64 v38, v36, v37
    v_cvt_pk_bf16_f32 v38, v37, v38
    v_mov_b32 v39, 0
    v_and_b32 v196, 15, v2
    v_lshrrev_b32_e64 v197, 4, v2
    v_lshl_add_u32 v196, v196, 2, v197
    s_lshl_b32 s78, s76, 9
    s_add_u32 m0, s84, 61440
    s_mov_b32 s100, 983040
    buffer_load_dwordx4 v246, s[40:43], s100 offen  lds
    s_add_u32 s78, s78, 160768
    v_lshl_add_u32 v196, v196, 3, s78
    v_and_b32 v197, 15, v2
    v_lshlrev_b32_e64 v197, 3, v197
    v_add_u32 v197, 162816, v197
    v_mov_b32 v198, 0x3f803f80
    s_cmp_eq_u32 s76, 3
    s_cselect_b64 vcc, -1, 0
    v_cndmask_b32 v196, v196, v197, vcc
    v_cndmask_b32 v38, v38, v198, vcc
    v_cndmask_b32_e64 v39, v39, v198, vcc
    ds_write_b64 v196, v[38:39]
    s_setprio 0
    s_waitcnt lgkmcnt(0)
    s_barrier
L_phend:
    s_mov_b32 s66, s96
    s_add_u32 m0, s84, 65536
    s_mov_b32 s100, 1048576
    buffer_load_dwordx4 v246, s[40:43], s100 offen  lds
    v_lshrrev_b32 v52, 2, v2
    v_and_b32 v53, 7, v52
    v_and_b32_e64 v55, 3, v2
    s_add_u32 m0, s84, 69632
    s_mov_b32 s100, 1114112
    buffer_load_dwordx4 v246, s[40:43], s100 offen  lds
    v_xor_b32 v53, v53, v55
    v_lshlrev_b32 v52, 7, v52
    v_lshrrev_b32_e64 v55, 1, v55
    s_add_u32 m0, s84, 73728
    s_mov_b32 s100, 1179648
    buffer_load_dwordx4 v246, s[40:43], s100 offen  lds
    v_lshl_add_u32 v52, v55, 3, v52
    s_lshr_b32 s78, s76, 1
    s_and_b32 s79, s76, 1
    s_lshl_b32 s80, s79, 2
    s_add_u32 m0, s84, 77824
    s_mov_b32 s100, 1245184
    buffer_load_dwordx4 v246, s[40:43], s100 offen  lds
    s_lshl_b32 s81, s78, 2
    v_xor_b32 v55, s80, v53
    v_xor_b32 v53, s81, v53
    s_add_u32 m0, s84, 81920
    s_mov_b32 s100, 1310720
    buffer_load_dwordx4 v246, s[40:43], s100 offen  lds
    s_lshl_b32 s80, s78, 14
    s_add_u32 s80, s80, 110592
    v_lshl_add_u32 v196, v55, 4, v52
    v_add_u32 v196, s80, v196
    s_add_u32 m0, s84, 86016
    s_mov_b32 s100, 1376256
    buffer_load_dwordx4 v246, s[40:43], s100 offen  lds
    v_lshl_add_u32 v198, v53, 4, v52
    v_add_u32 v198, 143360, v198
    v_xor_b32_e64 v197, 8, v196
    s_add_u32 m0, s84, 90112
    s_mov_b32 s100, 1441792
    buffer_load_dwordx4 v246, s[40:43], s100 offen  lds
    v_xor_b32_e64 v199, 8, v198
    v_mov_b32 v200, 0x3f803f80
    v_mov_b32 v201, 0x3f803f80
    v_mov_b32 v202, 0x3f803f80
    s_add_u32 m0, s84, 94208
    s_mov_b32 s100, 1507328
    buffer_load_dwordx4 v246, s[40:43], s100 offen  lds
    v_mov_b32 v203, 0x3f803f80
    v_lshrrev_b32 v62, 4, v2
    v_and_b32 v52, 15, v2
    s_add_u32 m0, s84, 98304
    s_mov_b32 s100, 1572864
    buffer_load_dwordx4 v246, s[40:43], s100 offen  lds
    v_lshlrev_b32_e64 v53, 4, v52
    v_lshl_add_u32 v62, v62, 13, v53
    v_lshrrev_b32_e64 v52, 3, v52
    v_lshl_add_u32 v62, v52, 8, v62
    s_add_u32 m0, s84, 102400
    s_mov_b32 s100, 1638400
    buffer_load_dwordx4 v246, s[40:43], s100 offen  lds
    v_xor_b32 v63, 256, v62
    s_lshl_b32 s78, s70, 2
    s_add_u32 s78, s78, s76
    s_add_u32 m0, s84, 106496
    s_mov_b32 s100, 1703936
    buffer_load_dwordx4 v246, s[40:43], s100 offen  lds
    s_lshl_b32 s78, s78, 15
    s_lshl_b32 s79, s69, 9
    s_add_u32 s78, s78, s79
    s_add_u32 s78, s78, 2097152
    s_mov_b32 s100, 2031616
    buffer_load_dwordx4 v[160:163], v246, s[40:43], s100 offen
    s_lshl_b32 s79, s77, 10
    s_lshl_b32 s80, s76, 6
    s_add_u32 s79, s79, s80
    s_mov_b32 s100, 1966080
    buffer_load_dwordx4 v[164:167], v246, s[40:43], s100 offen
    s_add_u32 s79, s79, 8389120
    v_lshrrev_b32 v52, 3, v2
    v_and_b32 v53, 7, v2
    v_lshlrev_b32_e64 v53, 4, v53
    s_mov_b32 s100, 1900544
    buffer_load_dwordx4 v[168:171], v246, s[40:43], s100 offen
    v_lshl_add_u32 v56, v52, 9, v53
    v_lshl_add_u32 v57, v52, 1, v53
    s_lshl_b32 s82, s70, 14
    s_mov_b32 s100, 1835008
    buffer_load_dwordx4 v[172:175], v246, s[40:43], s100 offen
    s_add_u32 s82, s82, s80
    s_add_u32 s82, s82, 8389120
    s_add_u32 s80, s80, 162944
    v_lshrrev_b32_e64 v58, 2, v2
    s_mov_b32 s100, 1769472
    buffer_load_dwordx4 v[176:179], v246, s[40:43], s100 offen
    v_and_b32 v53, 3, v2
    v_lshlrev_b32 v53, 4, v53
    v_lshl_add_u32 v58, v58, 10, v53
    s_mov_b32 s100, 0
    buffer_load_dwordx4 v[180:183], v247, s[28:31], s100 offen
    v_lshl_add_u32 v59, v52, 1, v53
    v_add_u32 v59, s80, v59
    s_lshl_b32 s64, s77, 13
    s_lshl_b32 s80, s76, 7
    s_mov_b32 s100, 16384
    buffer_load_dwordx4 v[184:187], v248, s[28:31], s100 offen
    s_add_u32 s64, s64, s80
    s_add_u32 s64, s64, 2097152
    s_add_u32 s65, s64, 4096
    s_mov_b32 s100, 32768
    buffer_load_dwordx4 v[188:191], v247, s[28:31], s100 offen
    s_lshl_b32 s81, s77, 10
    s_add_u32 s81, s81, s80
    s_add_u32 s81, s81, 8388608
    s_lshl_b32 s80, s71, 9
    s_mov_b32 s100, 49152
    buffer_load_dwordx4 v[192:195], v248, s[28:31], s100 offen
    s_add_u32 s80, s80, 8912896
    v_lshl_add_u32 v61, v2, 13, s80
    v_mov_b32 v52, 163584
    s_lshl_b32 s100, s77, 13
    s_add_u32 s100, s100, s89
    s_add_u32 s100, s100, 2097152
    buffer_load_dwordx4 v[252:255], v14, s[36:39], s100 offen offset:0 sc1
    ds_read_b32 v52, v52
    s_waitcnt lgkmcnt(0)
    v_readfirstlane_b32 s99, v52
    s_and_b32 s94, s69, 1
    s_lshl_b32 s100, s77, 13
    s_add_u32 s100, s100, s89
    s_nop 0
    s_add_u32 s100, s100, 2097152
    buffer_load_dwordx4 v[252:255], v14, s[36:39], s100 offen offset:1024 sc1
    s_mul_i32 s94, s94, 0x00010001
    s_mov_b32 s95, 0xfffefffe
    s_and_b32 s96, s75, 0x00010001
    buffer_load_dwordx4 v[252:255], v14, s[36:39], s66 offen sc1
    v_mov_b32_e64 v54, s96
    s_and_b32 s83, s75, 1
    s_lshl_b32 s83, s83, 16
    s_sub_u32 s83, 0, s83
    s_barrier
    ds_read_b64_tr_b16 v[4:5], v196 offset:0
    ds_read_b64_tr_b16 v[6:7], v196 offset:2048
    ds_read_b64_tr_b16 v[12:13], v198 offset:0
    ds_read_b64_tr_b16 v[14:15], v198 offset:2048
    ds_read_b64_tr_b16 v[8:9], v197 offset:0
    ds_read_b64_tr_b16 v[10:11], v197 offset:2048
    ds_read_b64_tr_b16 v[16:17], v199 offset:0
    ds_read_b64_tr_b16 v[18:19], v199 offset:2048
    ds_read_b64_tr_b16 v[20:21], v196 offset:4096
    ds_read_b64_tr_b16 v[22:23], v196 offset:6144
    ds_read_b64_tr_b16 v[28:29], v198 offset:4096
    ds_read_b64_tr_b16 v[30:31], v198 offset:6144
    ds_read_b64_tr_b16 v[24:25], v197 offset:4096
    ds_read_b64_tr_b16 v[26:27], v197 offset:6144
    s_waitcnt lgkmcnt(10)
    v_mfma_f32_16x16x32_bf16 v[204:207], v[4:7], v[12:15], 0
    ds_read_b64_tr_b16 v[32:33], v199 offset:4096
    ds_read_b64_tr_b16 v[34:35], v199 offset:6144
    s_waitcnt lgkmcnt(10)
    v_mfma_f32_16x16x32_bf16 v[208:211], v[8:11], v[12:15], 0
    ds_read_b64_tr_b16 v[36:37], v196 offset:8192
    ds_read_b64_tr_b16 v[38:39], v196 offset:10240
    s_waitcnt lgkmcnt(10)
    s_nop 0
    v_mfma_f32_16x16x32_bf16 v[216:219], v[8:11], v[16:19], 0
    ds_read_b64_tr_b16 v[44:45], v198 offset:8192
    ds_read_b64_tr_b16 v[46:47], v198 offset:10240
    v_mfma_f32_16x16x32_bf16 v[212:215], v[4:7], v[16:19], 0
    ds_read_b64_tr_b16 v[40:41], v197 offset:8192
    ds_read_b64_tr_b16 v[42:43], v197 offset:10240
    s_waitcnt lgkmcnt(10)
    v_mfma_f32_16x16x32_bf16 v[204:207], v[20:23], v[28:31], v[204:207]
    ds_read_b64_tr_b16 v[48:49], v199 offset:8192
    ds_read_b64_tr_b16 v[50:51], v199 offset:10240
    s_waitcnt lgkmcnt(10)
    v_mfma_f32_16x16x32_bf16 v[208:211], v[24:27], v[28:31], v[208:211]
    ds_read_b64_tr_b16 v[228:229], v196 offset:12288
    ds_read_b64_tr_b16 v[230:231], v196 offset:14336
    s_waitcnt lgkmcnt(10)
    s_nop 0
    v_mfma_f32_16x16x32_bf16 v[216:219], v[24:27], v[32:35], v[216:219]
    ds_read_b64_tr_b16 v[236:237], v198 offset:12288
L_pad1:
    s_cbranch_execz L_pad5
    ds_read_b64_tr_b16 v[238:239], v198 offset:14336
    v_mfma_f32_16x16x32_bf16 v[212:215], v[20:23], v[32:35], v[212:215]
    ds_read_b64_tr_b16 v[232:233], v197 offset:12288
    ds_read_b64_tr_b16 v[234:235], v197 offset:14336
    s_waitcnt lgkmcnt(10)
    v_mfma_f32_16x16x32_bf16 v[204:207], v[36:39], v[44:47], v[204:207]
    ds_read_b64_tr_b16 v[240:241], v199 offset:12288
    ds_read_b64_tr_b16 v[242:243], v199 offset:14336
    s_waitcnt lgkmcnt(10)
    v_mfma_f32_16x16x32_bf16 v[208:211], v[40:43], v[44:47], v[208:211]
    s_waitcnt lgkmcnt(8)
    v_mfma_f32_16x16x32_bf16 v[216:219], v[40:43], v[48:51], v[216:219]
    v_mfma_f32_16x16x32_bf16 v[212:215], v[36:39], v[48:51], v[212:215]
    s_waitcnt lgkmcnt(4)
    v_mfma_f32_16x16x32_bf16 v[204:207], v[228:231], v[236:239], v[204:207]
    s_waitcnt lgkmcnt(2)
    v_mfma_f32_16x16x32_bf16 v[208:211], v[232:235], v[236:239], v[208:211]
    s_waitcnt lgkmcnt(0)
    s_nop 0
    v_mfma_f32_16x16x32_bf16 v[216:219], v[232:235], v[240:243], v[216:219]
    v_mfma_f32_16x16x32_bf16 v[212:215], v[228:231], v[240:243], v[212:215]
    v_mfma_f32_16x16x32_bf16 v[220:223], v[4:7], v[200:203], 0
    v_mfma_f32_16x16x32_bf16 v[224:227], v[8:11], v[200:203], 0
    v_mfma_f32_16x16x32_bf16 v[220:223], v[20:23], v[200:203], v[220:223]
    v_mfma_f32_16x16x32_bf16 v[224:227], v[24:27], v[200:203], v[224:227]
    v_cvt_pk_bf16_f32 v12, v204, v205
    v_cvt_pk_bf16_f32 v13, v206, v207
    v_cvt_pk_bf16_f32 v14, v208, v209
    v_cvt_pk_bf16_f32 v15, v210, v211
    v_mfma_f32_16x16x32_bf16 v[220:223], v[36:39], v[200:203], v[220:223]
    v_add_u32_e64 v12, s94, v12
    v_and_or_b32 v12, v12, s95, v54
    v_mfma_f32_16x16x32_bf16 v[224:227], v[40:43], v[200:203], v[224:227]
    v_add_u32_e64 v13, s94, v13
    v_and_or_b32 v13, v13, s95, v54
    v_mfma_f32_16x16x32_bf16 v[220:223], v[228:231], v[200:203], v[220:223]
    v_add_u32_e64 v14, s94, v14
    v_and_or_b32 v14, v14, s95, v54
    v_mfma_f32_16x16x32_bf16 v[224:227], v[232:235], v[200:203], v[224:227]
    v_add_u32_e64 v15, s94, v15
    v_and_or_b32 v15, v15, s95, v54
    s_bitcmp1_b32 s99, 0
    s_cbranch_scc1 Lls_19
    buffer_store_dwordx4 v[12:15], v62, s[36:39], s78 offen sc1
    s_branch Lle_20
Lls_19:
    buffer_store_dwordx4 v[12:15], v62, s[36:39], s78 offen
Lle_20:
    v_cvt_pk_bf16_f32 v28, v212, v213
    v_cvt_pk_bf16_f32 v29, v214, v215
    v_cvt_pk_bf16_f32 v30, v216, v217
    v_cvt_pk_bf16_f32 v31, v218, v219
    v_add_u32 v28, s94, v28
    v_and_or_b32 v28, v28, s95, v54
    v_add_u32_e64 v29, s94, v29
    v_and_or_b32 v29, v29, s95, v54
    v_add_u32_e64 v30, s94, v30
    v_and_or_b32 v30, v30, s95, v54
    v_add_u32_e64 v31, s94, v31
    v_and_or_b32 v31, v31, s95, v54
    s_bitcmp1_b32 s99, 0
    s_cbranch_scc1 Lls_21
    buffer_store_dwordx4 v[28:31], v63, s[36:39], s78 offen sc1
    s_branch Lle_22
Lls_21:
    s_nop 0
    buffer_store_dwordx4 v[28:31], v63, s[36:39], s78 offen
Lle_22:
    v_cvt_pk_bf16_f32 v44, v220, v221
    v_cvt_pk_bf16_f32 v45, v222, v223
    v_cvt_pk_bf16_f32 v46, v224, v225
    v_cvt_pk_bf16_f32 v47, v226, v227
    s_mov_b32 exec_lo, 0x00010001
    s_mov_b32 exec_hi, 0x00010001
    s_bitcmp1_b32 s99, 0
    s_cbranch_scc1 Lls_23
    buffer_store_dwordx4 v[44:47], v2, s[36:39], s79 offen sc1
    s_branch Lle_24
Lls_23:
    buffer_store_dwordx4 v[44:47], v2, s[36:39], s79 offen
Lle_24:
    s_mov_b64 exec, -1
    s_mov_b32 s85, 0
Lspin_25:
    s_add_u32 s85, s85, 1
    s_cmp_gt_u32 s85, 400000
    s_cbranch_scc1 L_end
    buffer_load_dwordx4 v[20:23], v56, s[36:39], s64 offen sc1
    buffer_load_dwordx4 v[24:27], v56, s[36:39], s65 offen sc1
    buffer_load_dwordx4 v[16:19], v58, s[36:39], s82 offen sc1
    s_waitcnt vmcnt(0)
Lchk_26:
    v_bitop3_b32 v28, v20, v24, v54 bitop3:0x7e
    v_bitop3_b32 v29, v21, v25, v54 bitop3:0x7e
    v_bitop3_b32 v30, v22, v26, v54 bitop3:0x7e
    v_bitop3_b32 v31, v23, v27, v54 bitop3:0x7e
    v_or3_b32 v28, v28, v29, v30
    v_cmp_eq_u32 s[90:91], -1, v16
    v_or_b32_e64 v28, v28, v31
    v_and_b32 v28, 0x00010001, v28
    v_cmp_ne_u32_e64 vcc, 0, v28
    s_or_b64 vcc, vcc, s[90:91]
    s_cbranch_vccnz Lspin_25
    v_lshl_add_u32 v28, v20, 16, s83
    v_and_b32 v29, 0xfffe0000, v20
    v_lshl_add_u32 v36, v24, 16, s83
    v_and_b32 v37, 0xfffe0000, v24
    v_pk_add_f32 v[28:29], v[28:29], v[36:37]
    v_lshl_add_u32 v30, v21, 16, s83
    v_and_b32 v31, 0xfffe0000, v21
    v_lshl_add_u32 v38, v25, 16, s83
    v_and_b32 v39, 0xfffe0000, v25
    v_pk_add_f32 v[30:31], v[30:31], v[38:39]
    v_lshl_add_u32 v32, v22, 16, s83
    v_and_b32 v33, 0xfffe0000, v22
    v_lshl_add_u32 v40, v26, 16, s83
    v_and_b32 v41, 0xfffe0000, v26
    v_pk_add_f32 v[32:33], v[32:33], v[40:41]
    v_lshl_add_u32 v34, v23, 16, s83
    v_and_b32 v35, 0xfffe0000, v23
    v_lshl_add_u32 v42, v27, 16, s83
    v_and_b32 v43, 0xfffe0000, v27
    v_pk_add_f32 v[34:35], v[34:35], v[42:43]
    v_permlane32_swap_b32 v28, v32
    v_permlane32_swap_b32 v29, v33
    v_permlane32_swap_b32 v30, v34
    v_permlane32_swap_b32 v31, v35
    v_pk_add_f32 v[28:29], v[28:29], v[32:33]
    v_pk_add_f32 v[30:31], v[30:31], v[34:35]
    s_nop 1
    v_permlane16_swap_b32 v28, v30
    v_permlane16_swap_b32_e64 v29, v31
    v_pk_add_f32 v[28:29], v[28:29], v[30:31]
    s_nop 1
    v_add_f32_dpp v28, v28, v28 row_ror:8 row_mask:0xf bank_mask:0xf
    v_add_f32_dpp v29, v29, v29 row_ror:8 row_mask:0xf bank_mask:0xf
    v_cvt_pk_bf16_f32 v36, v28, v29
    s_mov_b32 exec_lo, 0x00ff00ff
    s_mov_b32 exec_hi, 0x00ff00ff
    s_bitcmp1_b32 s99, 0
    s_cbranch_scc1 Lls_27
    buffer_store_dword v36, v57, s[36:39], s81 offen sc1
    s_branch Lle_28
Lls_27:
    buffer_store_dword v36, v57, s[36:39], s81 offen
Lle_28:
    s_mov_b64 exec, -1
    v_lshlrev_b32 v28, 16, v16
    v_and_b32 v29, 0xffff0000, v16
    v_lshlrev_b32_e64 v30, 16, v17
    v_and_b32 v31, 0xffff0000, v17
    v_lshlrev_b32_e64 v32, 16, v18
    v_and_b32 v33, 0xffff0000, v18
    v_lshlrev_b32_e64 v34, 16, v19
    v_and_b32 v35, 0xffff0000, v19
    v_permlane32_swap_b32 v28, v32
    v_permlane32_swap_b32 v29, v33
    v_permlane32_swap_b32 v30, v34
    v_permlane32_swap_b32 v31, v35
    v_pk_add_f32 v[28:29], v[28:29], v[32:33]
    v_pk_add_f32 v[30:31], v[30:31], v[34:35]
    s_nop 1
    v_permlane16_swap_b32 v28, v30
    v_permlane16_swap_b32_e64 v29, v31
    v_pk_add_f32 v[28:29], v[28:29], v[30:31]
    s_nop 1
    v_add_f32_dpp v38, v28, v28 row_ror:8 row_mask:0xf bank_mask:0x3
    s_nop 1
    v_add_f32_dpp v38, v29, v29 row_ror:8 row_mask:0xf bank_mask:0xc
    s_nop 1
    v_add_f32_dpp v37, v38, v38 row_shr:4 row_mask:0xf bank_mask:0xf
    v_cvt_pk_bf16_f32 v37, v37, v37
    s_mov_b32 exec_lo, 0xf0f0f0f0
    s_mov_b32 exec_hi, 0xf0f0f0f0
    ds_write_b16 v59, v37
    s_mov_b64 exec, -1
    s_waitcnt lgkmcnt(0)
    s_barrier
    v_lshlrev_b32 v4, 4, v2
    s_lshl_b32 s78, s76, 10
    s_add_u32 s78, s78, 110592
    v_add_u32 v5, s78, v4
    s_lshl_b32 s78, s76, 12
    s_add_u32 s78, s78, 131072
    v_add_u32 v6, s78, v4
    s_lshl_b32 s100, s77, 9
    s_add_u32 s100, s100, 8912896
    v_mov_b32 v48, s75
    v_mov_b32 v49, s75
    v_lshl_add_u32 v50, v2, 3, s100
    s_lshl_b32 s83, s71, 4
    s_add_u32 s83, s83, s72
    s_lshl_b32 s78, s0, 11
    s_and_b32 s79, s76, 1
    s_lshl_b32 s79, s79, 10
    s_add_u32 s78, s78, s79
    s_add_u32 s78, s78, 655360
    s_mul_i32 s79, s74, 56
    s_add_u32 s79, s79, s73
    s_lshl_b32 s79, s79, 10
    s_add_u32 s79, s79, 1114112
    s_cmp_eq_u32 s76, 1
    s_cselect_b32 s78, s79, s78
    s_cmp_ge_u32 s73, 56
    s_cselect_b32 s78, 0x10000000, s78
    s_lshl_b32 s79, s83, 11
    s_add_u32 s79, s79, s84
    s_add_u32 s79, s79, 1572864
    s_cmp_lt_u32 s76, 2
    s_cselect_b32 s94, s79, s78
    s_lshl_b32 s79, s83, 9
    s_add_u32 s79, s79, 524288
    s_cmp_eq_u32 s76, 0
    s_cselect_b32 s78, s79, s78
    s_cselect_b32 s79, 0, -1
    v_mov_b32 v56, -1
    v_mov_b32 v57, -1
    v_mov_b32 v58, -1
    v_mov_b32_e64 v59, -1
    s_barrier
    s_mov_b32 s100, 43008
    buffer_load_dwordx4 v[88:91], v244, s[48:51], s100 offen nt
    s_mov_b32 s100, 43008
    buffer_load_dwordx4 v[120:123], v244, s[52:55], s100 offen nt
    s_mov_b32 s100, 50176
    buffer_load_dwordx4 v[92:95], v244, s[48:51], s100 offen nt
    s_mov_b32 s100, 50176
    buffer_load_dwordx4 v[124:127], v244, s[52:55], s100 offen nt
    ds_write_b128 v6, v[180:183] offset:0
    ds_write_b128 v6, v[184:187] offset:1024
    ds_write_b128 v6, v[188:191] offset:2048
    ds_write_b128 v6, v[192:195] offset:3072
    ds_write_b128 v5, v[160:163] offset:16384
    ds_write_b128 v5, v[164:167] offset:12288
    ds_write_b128 v5, v[168:171] offset:8192
    ds_write_b128 v5, v[172:175] offset:4096
    ds_write_b128 v5, v[176:179] offset:0
    s_waitcnt lgkmcnt(0)
    s_barrier
    s_cmp_lg_u32 s76, 0
    s_cbranch_scc1 Lfs_29
    buffer_store_dwordx2 v[48:49], v50, s[36:39], 0 offen sc1
Lfs_29:
    s_mov_b32 exec_hi, s79
    buffer_store_dwordx4 v[56:59], v4, s[36:39], s78 offen sc1
    s_mov_b32 exec_hi, -1
    s_mov_b32 s100, 0x05040100
    s_mov_b32 s101, 0x07060302
    v_perm_b32 v7, v68, v64, s100
    v_perm_b32 v68, v68, v64, s101
    v_mov_b32_e64 v64, v7
    v_perm_b32 v7, v69, v65, s100
    v_perm_b32 v69, v69, v65, s101
    v_mov_b32_e64 v65, v7
    v_perm_b32 v7, v70, v66, s100
    v_perm_b32 v70, v70, v66, s101
    v_mov_b32_e64 v66, v7
    v_perm_b32 v7, v71, v67, s100
    v_perm_b32 v71, v71, v67, s101
    v_mov_b32_e64 v67, v7
    v_perm_b32 v7, v100, v96, s100
    v_perm_b32 v100, v100, v96, s101
    v_mov_b32_e64 v96, v7
    v_perm_b32 v7, v101, v97, s100
    v_perm_b32 v101, v101, v97, s101
    v_mov_b32_e64 v97, v7
    v_perm_b32 v7, v102, v98, s100
    v_perm_b32 v102, v102, v98, s101
    v_mov_b32_e64 v98, v7
    v_perm_b32 v7, v103, v99, s100
    v_perm_b32 v103, v103, v99, s101
    v_mov_b32_e64 v99, v7
    v_perm_b32 v7, v76, v72, s100
    v_perm_b32 v76, v76, v72, s101
    v_mov_b32_e64 v72, v7
    v_perm_b32 v7, v77, v73, s100
    v_perm_b32 v77, v77, v73, s101
    v_mov_b32_e64 v73, v7
    v_perm_b32 v7, v78, v74, s100
    v_perm_b32 v78, v78, v74, s101
    v_mov_b32_e64 v74, v7
    v_perm_b32 v7, v79, v75, s100
    v_perm_b32 v79, v79, v75, s101
    v_mov_b32_e64 v75, v7
    v_perm_b32 v7, v108, v104, s100
    v_perm_b32 v108, v108, v104, s101
    v_mov_b32_e64 v104, v7
    v_perm_b32 v7, v109, v105, s100
    v_perm_b32 v109, v109, v105, s101
    v_mov_b32_e64 v105, v7
    v_perm_b32 v7, v110, v106, s100
    v_perm_b32 v110, v110, v106, s101
    v_mov_b32_e64 v106, v7
    v_perm_b32 v7, v111, v107, s100
    v_perm_b32 v111, v111, v107, s101
    v_mov_b32_e64 v107, v7
    v_perm_b32 v7, v84, v80, s100
    v_perm_b32 v84, v84, v80, s101
    v_mov_b32_e64 v80, v7
    v_perm_b32 v7, v85, v81, s100
    v_perm_b32 v85, v85, v81, s101
    v_mov_b32_e64 v81, v7
    v_perm_b32 v7, v86, v82, s100
    v_perm_b32 v86, v86, v82, s101
    v_mov_b32_e64 v82, v7
    v_perm_b32 v7, v87, v83, s100
    v_perm_b32 v87, v87, v83, s101
    v_mov_b32_e64 v83, v7
    v_perm_b32 v7, v116, v112, s100
    v_perm_b32 v116, v116, v112, s101
L_pad2:
    s_cbranch_execz L_pad6
    v_mov_b32 v112, v7
    v_perm_b32 v7, v117, v113, s100
    v_perm_b32 v117, v117, v113, s101
    v_mov_b32_e64 v113, v7
    v_perm_b32 v7, v118, v114, s100
    v_perm_b32 v118, v118, v114, s101
    v_mov_b32_e64 v114, v7
    v_perm_b32 v7, v119, v115, s100
    v_perm_b32 v119, v119, v115, s101
    v_mov_b32_e64 v115, v7
    s_cmp_lg_u32 s76, 2
    s_cbranch_scc1 Lf2_30
    s_mov_b64 exec, 0xffff
    s_mov_b32 s85, 1
    s_mov_b32 s101, 0
    s_branch Lb_32
Lspin_31:
    s_add_u32 s85, s85, 1
    s_cmp_gt_u32 s85, 400000
    s_cbranch_scc1 L_end
    s_add_u32 s101, s101, 128
    s_min_u32 s101, s101, 384
Lb_32:
    buffer_load_dword v52, v61, s[36:39], s101 offen sc1
    s_waitcnt vmcnt(0)
    v_cmp_ne_u32_e64 vcc, s75, v52
    s_cbranch_vccnz Lspin_31
    s_mov_b64 exec, -1
Lf2_30:
    s_barrier
    s_waitcnt vmcnt(0)
    s_mov_b32 s100, 0x05040100
    s_mov_b32 s101, 0x07060302
    v_perm_b32 v7, v92, v88, s100
    v_perm_b32 v92, v92, v88, s101
    v_mov_b32_e64 v88, v7
    v_perm_b32 v7, v93, v89, s100
    v_perm_b32 v93, v93, v89, s101
    v_mov_b32_e64 v89, v7
    v_perm_b32 v7, v94, v90, s100
    v_perm_b32 v94, v94, v90, s101
    v_mov_b32_e64 v90, v7
    v_perm_b32 v7, v95, v91, s100
    v_perm_b32 v95, v95, v91, s101
    v_mov_b32_e64 v91, v7
    v_perm_b32 v7, v124, v120, s100
    v_perm_b32 v124, v124, v120, s101
    v_mov_b32_e64 v120, v7
    v_perm_b32 v7, v125, v121, s100
    v_perm_b32 v125, v125, v121, s101
    v_mov_b32_e64 v121, v7
    v_perm_b32 v7, v126, v122, s100
    v_perm_b32 v126, v126, v122, s101
    v_mov_b32_e64 v122, v7
    v_perm_b32 v7, v127, v123, s100
    v_perm_b32 v127, v127, v123, s101
    v_mov_b32 v123, v7
    v_lshrrev_b32 v8, 3, v2
    v_and_b32 v9, 7, v2
    v_lshlrev_b32 v10, 4, v9
    v_lshl_add_u32 v11, v8, 13, v10
    v_and_b32 v12, 15, v2
    v_lshlrev_b32 v12, 13, v12
    v_lshl_add_u32 v13, v8, 9, v10
    v_lshl_add_u32 v14, v9, 3, v8
    s_lshl_b32 s80, s74, 2
    s_add_u32 s80, s80, s76
    s_lshl_b32 s78, s80, 9
    s_add_u32 s78, s78, 524288
    s_add_u32 s79, s78, 65536
    s_add_u32 s81, s73, s76
    s_and_b32 s81, s81, 3
    s_andn2_b32 s100, s73, 3
    s_or_b32 s81, s81, s100
    s_lshl_b32 s81, s81, 13
    s_lshl_b32 s80, s80, 9
    s_add_u32 s80, s80, s81
    s_add_u32 s80, s80, 655360
    s_lshl_b32 s81, s73, 13
    s_add_u32 s81, s81, 655360
    s_lshl_b32 s64, s76, 7
    s_add_u32 s64, s64, s81
    s_add_u32 s65, s64, 4096
    v_lshrrev_b32 v50, 5, v2
    v_lshl_add_u32 v50, v9, 1, v50
    s_lshl_b32 s82, s76, 5
    s_add_u32 s82, s82, 163456
    v_lshl_add_u32 v50, v50, 1, s82
    v_lshlrev_b32 v27, 4, v8
    v_add_u32 v51, 163456, v27
    v_lshlrev_b32 v49, 2, v14
    v_lshlrev_b32 v15, 3, v14
    v_mov_b32 v26, 163360
    s_mul_i32 s66, s74, 56
    s_add_u32 s66, s66, s73
    s_lshl_b32 s66, s66, 10
    s_lshl_b32 s82, s76, 8
    s_add_u32 s66, s66, s82
    s_add_u32 s66, s66, 1114112
    s_barrier
    buffer_load_dwordx4 v[56:59], v4, s[36:39], s94 offen sc1
    s_mov_b32 s100, 0
    s_nop 0
    buffer_load_dwordx4 v[128:131], v245, s[56:59], s100 offen nt
    s_mov_b32 s100, 2048
    buffer_load_dwordx4 v[132:135], v245, s[56:59], s100 offen nt
    s_mov_b32 s100, 4096
    buffer_load_dwordx4 v[136:139], v245, s[56:59], s100 offen nt
    s_mov_b32 s100, 6144
    buffer_load_dwordx4 v[140:143], v245, s[56:59], s100 offen nt
    s_mov_b32 s100, 8192
    buffer_load_dwordx4 v[144:147], v245, s[56:59], s100 offen nt
    s_barrier
    s_waitcnt vmcnt(0)
    s_mov_b32 s100, 0x05040100
    s_mov_b32 s101, 0x07060302
    v_perm_b32 v7, v132, v128, s100
    v_perm_b32 v132, v132, v128, s101
    v_mov_b32_e64 v128, v7
    v_perm_b32 v7, v133, v129, s100
    v_perm_b32 v133, v133, v129, s101
    v_mov_b32_e64 v129, v7
    v_perm_b32 v7, v134, v130, s100
    v_perm_b32 v134, v134, v130, s101
    v_mov_b32_e64 v130, v7
    v_perm_b32 v7, v135, v131, s100
    v_perm_b32 v135, v135, v131, s101
    v_mov_b32_e64 v131, v7
    v_perm_b32 v7, v140, v136, s100
    v_perm_b32 v140, v140, v136, s101
    v_mov_b32_e64 v136, v7
    v_perm_b32 v7, v141, v137, s100
    v_perm_b32 v141, v141, v137, s101
    v_mov_b32_e64 v137, v7
    v_perm_b32 v7, v142, v138, s100
    v_perm_b32 v142, v142, v138, s101
    v_mov_b32_e64 v138, v7
    v_perm_b32 v7, v143, v139, s100
    v_perm_b32 v143, v143, v139, s101
    v_mov_b32 v139, v7
    s_barrier
    s_mov_b32 s100, 10240
    buffer_load_dwordx4 v[148:151], v245, s[56:59], s100 offen nt
    s_mov_b32 s100, 12288
    buffer_load_dwordx4 v[152:155], v245, s[56:59], s100 offen nt
    s_mov_b32 s100, 14336
    buffer_load_dwordx4 v[156:159], v245, s[56:59], s100 offen nt
    s_and_b32 s79, s2, 7
    s_lshl_b32 s79, s79, 9
    s_add_u32 s79, s79, 524288
    s_mov_b64 exec, 0xffff
    s_mov_b32 s85, 1
    s_sleep 20
    s_branch Lb_34
Lspin_33:
    s_add_u32 s85, s85, 1
    s_cmp_gt_u32 s85, 400000
    s_cbranch_scc1 L_end
    s_or_b32 s79, s79, 4096
Lb_34:
    buffer_load_dwordx2 v[24:25], v12, s[36:39], s79 offen offset:128 sc1
    s_waitcnt vmcnt(0)
    v_cmp_ne_u32 vcc, s75, v25
    s_cbranch_vccnz Lspin_33
    v_max_f32_dpp v24, v24, v24 row_ror:8 row_mask:0xf bank_mask:0xf
    s_nop 1
    v_max_f32_dpp v24, v24, v24 row_ror:4 row_mask:0xf bank_mask:0xf
    s_nop 1
    v_max_f32_dpp v24, v24, v24 row_ror:2 row_mask:0xf bank_mask:0xf
    s_nop 1
    v_max_f32_dpp v24, v24, v24 row_ror:1 row_mask:0xf bank_mask:0xf
    s_nop 0
    v_readfirstlane_b32 s97, v24
    s_mov_b64 exec, -1
    s_nop 0
    v_mov_b32 v24, s97
    s_cmp_ge_u32 s73, 56
    s_cbranch_scc1 L_red
    s_bfe_u32 s79, s97, 0x40007
    s_lshl_b32 s79, s79, 13
    s_add_u32 s78, s78, s79
    buffer_load_dwordx4 v[20:23], v27, s[36:39], s78 offen sc1
    ds_write_b32 v26, v24
    s_mov_b32 s85, 1
    s_mov_b32 s100, 0x05040100
    s_mov_b32 s101, 0x07060302
    v_perm_b32 v7, v148, v144, s100
    v_perm_b32 v148, v148, v144, s101
    v_mov_b32 v144, v7
    v_perm_b32 v7, v149, v145, s100
    v_perm_b32 v149, v149, v145, s101
    v_mov_b32_e64 v145, v7
    v_perm_b32 v7, v150, v146, s100
    v_perm_b32 v150, v150, v146, s101
    v_mov_b32_e64 v146, v7
    v_perm_b32 v7, v151, v147, s100
    v_perm_b32 v151, v151, v147, s101
    v_mov_b32_e64 v147, v7
    v_perm_b32 v7, v156, v152, s100
    v_perm_b32 v156, v156, v152, s101
    v_mov_b32_e64 v152, v7
    v_perm_b32 v7, v157, v153, s100
    v_perm_b32 v157, v157, v153, s101
    v_mov_b32_e64 v153, v7
    v_perm_b32 v7, v158, v154, s100
    v_perm_b32 v158, v158, v154, s101
    v_mov_b32_e64 v154, v7
    v_perm_b32 v7, v159, v155, s100
    v_perm_b32 v159, v159, v155, s101
    v_mov_b32_e64 v155, v7
    s_branch Lb_36
Lspin_35:
    s_add_u32 s85, s85, 1
    s_cmp_gt_u32 s85, 400000
    s_cbranch_scc1 L_end
    buffer_load_dwordx4 v[20:23], v27, s[36:39], s78 offen sc1
Lb_36:
    s_waitcnt vmcnt(0) lgkmcnt(0)
    v_max3_u32 v16, v20, v21, v22
    v_max_u32 v16, v16, v23
    v_cmp_eq_u32_e64 vcc, -1, v16
    s_cbranch_vccnz Lspin_35
    v_dot2_f32_bf16 v28, v64, v20, 0
    v_dot2_f32_bf16 v29, v68, v20, 0
    v_dot2_f32_bf16 v30, v65, v20, 0
    v_dot2_f32_bf16 v31, v69, v20, 0
    v_dot2_f32_bf16 v32, v66, v20, 0
    v_dot2_f32_bf16 v33, v70, v20, 0
    v_dot2_f32_bf16 v34, v67, v20, 0
    v_dot2_f32_bf16 v35, v71, v20, 0
    v_dot2_f32_bf16 v28, v72, v21, v28
    v_dot2_f32_bf16 v29, v76, v21, v29
    v_dot2_f32_bf16 v30, v73, v21, v30
    v_dot2_f32_bf16 v31, v77, v21, v31
    v_dot2_f32_bf16 v32, v74, v21, v32
    v_dot2_f32_bf16 v33, v78, v21, v33
    v_dot2_f32_bf16 v34, v75, v21, v34
    v_dot2_f32_bf16 v35, v79, v21, v35
    v_dot2_f32_bf16 v28, v80, v22, v28
    v_dot2_f32_bf16 v29, v84, v22, v29
    v_dot2_f32_bf16 v30, v81, v22, v30
    v_dot2_f32_bf16 v31, v85, v22, v31
    v_dot2_f32_bf16 v32, v82, v22, v32
    v_dot2_f32_bf16 v33, v86, v22, v33
    v_dot2_f32_bf16 v34, v83, v22, v34
    v_dot2_f32_bf16 v35, v87, v22, v35
    v_dot2_f32_bf16 v28, v88, v23, v28
    v_dot2_f32_bf16 v29, v92, v23, v29
    v_dot2_f32_bf16 v30, v89, v23, v30
    v_dot2_f32_bf16 v31, v93, v23, v31
    v_dot2_f32_bf16 v32, v90, v23, v32
    v_dot2_f32_bf16 v33, v94, v23, v33
    v_dot2_f32_bf16 v34, v91, v23, v34
    v_dot2_f32_bf16 v35, v95, v23, v35
    v_dot2_f32_bf16 v36, v96, v20, 0
    v_dot2_f32_bf16 v37, v100, v20, 0
    v_dot2_f32_bf16 v38, v97, v20, 0
    v_dot2_f32_bf16 v39, v101, v20, 0
    v_dot2_f32_bf16 v40, v98, v20, 0
    v_dot2_f32_bf16 v41, v102, v20, 0
    v_dot2_f32_bf16 v42, v99, v20, 0
    v_dot2_f32_bf16 v43, v103, v20, 0
    v_dot2_f32_bf16 v36, v104, v21, v36
    v_dot2_f32_bf16 v37, v108, v21, v37
    v_dot2_f32_bf16 v38, v105, v21, v38
    v_dot2_f32_bf16 v39, v109, v21, v39
    v_dot2_f32_bf16 v40, v106, v21, v40
    v_dot2_f32_bf16 v41, v110, v21, v41
    v_dot2_f32_bf16 v42, v107, v21, v42
    v_dot2_f32_bf16 v43, v111, v21, v43
    v_dot2_f32_bf16 v36, v112, v22, v36
    v_dot2_f32_bf16 v37, v116, v22, v37
    v_dot2_f32_bf16 v38, v113, v22, v38
    v_dot2_f32_bf16 v39, v117, v22, v39
    v_dot2_f32_bf16 v40, v114, v22, v40
    v_dot2_f32_bf16 v41, v118, v22, v41
    v_dot2_f32_bf16 v42, v115, v22, v42
    v_dot2_f32_bf16 v43, v119, v22, v43
    v_dot2_f32_bf16 v36, v120, v23, v36
    v_dot2_f32_bf16 v37, v124, v23, v37
    v_dot2_f32_bf16 v38, v121, v23, v38
    v_dot2_f32_bf16 v39, v125, v23, v39
    v_dot2_f32_bf16 v40, v122, v23, v40
    v_dot2_f32_bf16 v41, v126, v23, v41
    v_dot2_f32_bf16 v42, v123, v23, v42
    v_dot2_f32_bf16 v43, v127, v23, v43
    v_permlane32_swap_b32 v28, v32
    v_permlane32_swap_b32 v29, v33
    v_permlane32_swap_b32 v30, v34
    v_permlane32_swap_b32 v31, v35
    v_permlane32_swap_b32 v36, v40
    v_permlane32_swap_b32 v37, v41
    v_permlane32_swap_b32 v38, v42
    v_permlane32_swap_b32 v39, v43
    v_pk_add_f32 v[28:29], v[28:29], v[32:33]
    v_pk_add_f32 v[30:31], v[30:31], v[34:35]
    v_pk_add_f32 v[36:37], v[36:37], v[40:41]
    v_pk_add_f32 v[38:39], v[38:39], v[42:43]
    v_permlane16_swap_b32 v28, v30
    v_permlane16_swap_b32 v29, v31
    v_permlane16_swap_b32 v36, v38
    v_permlane16_swap_b32 v37, v39
    v_pk_add_f32 v[28:29], v[28:29], v[30:31]
    v_pk_add_f32 v[36:37], v[36:37], v[38:39]
    s_nop 0
    v_add_f32_dpp v44, v28, v28 row_ror:8 row_mask:0xf bank_mask:0x3
    v_add_f32_dpp v45, v36, v36 row_ror:8 row_mask:0xf bank_mask:0x3
    s_nop 0
    v_add_f32_dpp v44, v29, v29 row_ror:8 row_mask:0xf bank_mask:0xc
L_pad3:
    s_cbranch_execz L_pad7
    v_add_f32_dpp v45, v37, v37 row_ror:8 row_mask:0xf bank_mask:0xc
    s_bitcmp1_b32 s99, 0
    s_cbranch_scc1 Lls_37
    buffer_store_dwordx2 v[44:45], v15, s[36:39], s80 offen sc1
    s_branch Lle_38
Lls_37:
    buffer_store_dwordx2 v[44:45], v15, s[36:39], s80 offen
Lle_38:
    s_mov_b32 s95, s80
    s_barrier
    s_mov_b32 s85, 0
Lspin_39:
    s_add_u32 s85, s85, 1
    s_cmp_gt_u32 s85, 400000
    s_cbranch_scc1 L_end
    buffer_load_dwordx4 v[16:19], v13, s[36:39], s64 offen sc1
    buffer_load_dwordx4 v[20:23], v13, s[36:39], s65 offen sc1
    s_waitcnt vmcnt(0)
    v_max3_u32 v25, v16, v18, v20
    v_max_u32 v25, v25, v22
    v_cmp_eq_u32_e64 vcc, -1, v25
    s_cbranch_vccnz Lspin_39
    v_pk_add_f32 v[16:17], v[16:17], v[20:21]
    v_pk_add_f32 v[18:19], v[18:19], v[22:23]
    s_nop 1
    v_permlane32_swap_b32 v16, v18
    v_permlane32_swap_b32_e64 v17, v19
    v_pk_add_f32 v[16:17], v[16:17], v[18:19]
    v_mov_b32 v18, v16
    v_mov_b32 v19, v17
    s_nop 0
    v_permlane16_swap_b32 v16, v18
    v_permlane16_swap_b32_e64 v17, v19
    v_pk_add_f32 v[16:17], v[16:17], v[18:19]
    s_nop 1
    v_add_f32_dpp v16, v16, v16 row_ror:8 row_mask:0xf bank_mask:0xf
    v_add_f32_dpp v17, v17, v17 row_ror:8 row_mask:0xf bank_mask:0xf
    v_cvt_pk_bf16_f32 v17, v16, v17
    v_lshlrev_b32 v16, 16, v17
    v_mul_f32 v18, 0xbfb8aa3b, v16
    v_exp_f32_e64 v18, v18
    v_and_b32 v17, 0xffff0000, v17
    v_add_f32 v18, 1.0, v18
    v_rcp_f32 v18, v18
    s_nop 0
    v_mul_f32 v16, v16, v18
    v_cvt_pk_bf16_f32 v16, v16, v16
    v_and_b32 v16, 0xffff0000, v16
    v_mul_f32_e64 v16, v16, v17
    v_cvt_pk_bf16_f32 v16, v16, v16
    ds_write_b16 v50, v16
    s_waitcnt lgkmcnt(0)
    s_barrier
    ds_read_b128 v[20:23], v51
    s_waitcnt lgkmcnt(0)
    s_nop 0
    v_dot2_f32_bf16 v28, v128, v20, 0
    v_dot2_f32_bf16 v29, v132, v20, 0
    v_dot2_f32_bf16 v30, v129, v20, 0
    v_dot2_f32_bf16 v31, v133, v20, 0
    v_dot2_f32_bf16 v32, v130, v20, 0
    v_dot2_f32_bf16 v33, v134, v20, 0
    v_dot2_f32_bf16 v34, v131, v20, 0
    v_dot2_f32_bf16 v35, v135, v20, 0
    v_dot2_f32_bf16 v28, v136, v21, v28
    v_dot2_f32_bf16 v29, v140, v21, v29
    v_dot2_f32_bf16 v30, v137, v21, v30
    v_dot2_f32_bf16 v31, v141, v21, v31
    v_dot2_f32_bf16 v32, v138, v21, v32
    v_dot2_f32_bf16 v33, v142, v21, v33
    v_dot2_f32_bf16 v34, v139, v21, v34
    v_dot2_f32_bf16 v35, v143, v21, v35
    v_dot2_f32_bf16 v28, v144, v22, v28
    v_dot2_f32_bf16 v29, v148, v22, v29
    v_dot2_f32_bf16 v30, v145, v22, v30
    v_dot2_f32_bf16 v31, v149, v22, v31
    v_dot2_f32_bf16 v32, v146, v22, v32
    v_dot2_f32_bf16 v33, v150, v22, v33
    v_dot2_f32_bf16 v34, v147, v22, v34
    v_dot2_f32_bf16 v35, v151, v22, v35
    v_dot2_f32_bf16 v28, v152, v23, v28
    v_dot2_f32_bf16 v29, v156, v23, v29
    v_dot2_f32_bf16 v30, v153, v23, v30
    v_dot2_f32_bf16 v31, v157, v23, v31
    v_dot2_f32_bf16 v32, v154, v23, v32
    v_dot2_f32_bf16 v33, v158, v23, v33
    v_dot2_f32_bf16 v34, v155, v23, v34
    v_dot2_f32_bf16 v35, v159, v23, v35
    v_permlane32_swap_b32 v28, v32
    v_permlane32_swap_b32 v29, v33
    v_permlane32_swap_b32 v30, v34
    v_permlane32_swap_b32 v31, v35
    v_pk_add_f32 v[28:29], v[28:29], v[32:33]
    v_pk_add_f32 v[30:31], v[30:31], v[34:35]
    s_nop 1
    v_permlane16_swap_b32 v28, v30
    v_permlane16_swap_b32_e64 v29, v31
    v_pk_add_f32 v[28:29], v[28:29], v[30:31]
    s_nop 1
    v_add_f32_dpp v46, v28, v28 row_ror:8 row_mask:0xf bank_mask:0x3
    s_nop 1
    v_add_f32_dpp v46, v29, v29 row_ror:8 row_mask:0xf bank_mask:0xc
    buffer_store_dword v46, v49, s[36:39], s66 offen sc1
    s_barrier
    s_branch L_fin
L_red:
    v_mov_b32 v26, 163360
    ds_write_b32 v26, v24
    s_waitcnt lgkmcnt(0)
    s_barrier
    s_barrier
    s_barrier
    s_cmp_lg_u32 s76, 0
    s_cbranch_scc1 L_fin
    s_sub_u32 s83, s0, 224
    v_lshrrev_b32_e64 v14, 4, v2
    v_lshl_add_u32 v14, v9, 2, v14
    v_lshlrev_b32 v15, 2, v14
    v_lshlrev_b32 v14, 1, v14
    s_bfe_u32 s78, s97, 0x40007
    s_lshl_b32 s78, s78, 13
    s_lshr_b32 s79, s83, 1
    s_lshl_b32 s79, s79, 9
    s_add_u32 s78, s78, s79
    s_and_b32 s79, s83, 1
    s_lshl_b32 s79, s79, 7
    s_add_u32 s78, s78, s79
    s_add_u32 s78, s78, 524544
    s_mov_b32 s85, 0
Lspin_40:
    s_add_u32 s85, s85, 1
    s_cmp_gt_u32 s85, 400000
    s_cbranch_scc1 L_end
    buffer_load_dword v46, v15, s[36:39], s78 offen sc1
    s_waitcnt vmcnt(0)
    v_cmp_eq_u32_e64 vcc, -1, v46
    s_cbranch_vccnz Lspin_40
    v_cvt_pk_bf16_f32 v47, v24, v24
    v_and_b32 v47, 0xffff0000, v47
    v_mul_f32 v47, 0xbfb8aa3b, v47
    v_exp_f32 v47, v47
    s_nop 0
    v_add_f32 v47, 1.0, v47
    v_rcp_f32_e64 v47, v47
    s_nop 0
    v_cvt_pk_bf16_f32 v47, v47, v47
    v_and_b32 v47, 0xffff0000, v47
    v_lshl_add_u32 v13, v8, 10, v10
    s_lshr_b32 s78, s83, 3
    s_mul_i32 s78, s78, 57344
    s_and_b32 s79, s83, 7
    s_lshl_b32 s79, s79, 7
    s_add_u32 s78, s78, s79
    s_add_u32 s78, s78, 1114112
    s_and_b32 s80, s97, 0x7ff
    s_lshl_b32 s80, s80, 11
    s_lshl_b32 s79, s83, 6
    s_add_u32 s80, s80, s79
    s_sleep 30
    s_mov_b32 s85, 0
Lspin_41:
    s_add_u32 s85, s85, 1
    s_cmp_gt_u32 s85, 400000
    s_cbranch_scc1 L_end
    s_add_u32 s79, s78, 0
    buffer_load_dwordx4 v[16:19], v13, s[36:39], s79 offen sc1
    s_add_u32 s79, s78, 8192
    buffer_load_dwordx4 v[20:23], v13, s[36:39], s79 offen sc1
    s_add_u32 s79, s78, 16384
    buffer_load_dwordx4 v[24:27], v13, s[36:39], s79 offen sc1
    s_add_u32 s79, s78, 24576
    buffer_load_dwordx4 v[28:31], v13, s[36:39], s79 offen sc1
    s_add_u32 s79, s78, 32768
    buffer_load_dwordx4 v[32:35], v13, s[36:39], s79 offen sc1
    s_add_u32 s79, s78, 40960
    buffer_load_dwordx4 v[36:39], v13, s[36:39], s79 offen sc1
    s_add_u32 s79, s78, 49152
    buffer_load_dwordx4 v[40:43], v13, s[36:39], s79 offen sc1
    s_waitcnt vmcnt(0)
    v_max_u32 v48, v16, v17
    v_max_u32_e64 v49, v18, v19
    v_max3_u32 v48, v48, v20, v21
    v_max3_u32 v49, v49, v22, v23
    v_max3_u32 v48, v48, v24, v25
    v_max3_u32 v49, v49, v26, v27
    v_max3_u32 v48, v48, v28, v29
    v_max3_u32 v49, v49, v30, v31
    v_max3_u32 v48, v48, v32, v33
    v_max3_u32 v49, v49, v34, v35
    v_max3_u32 v48, v48, v36, v37
    v_max3_u32 v49, v49, v38, v39
    v_max3_u32 v48, v48, v40, v41
    v_max3_u32 v49, v49, v42, v43
    v_max_u32 v48, v48, v49
    v_cmp_eq_u32_e64 vcc, -1, v48
    s_cbranch_vccnz Lspin_41
    v_pk_add_f32 v[16:17], v[16:17], v[20:21]
    v_pk_add_f32 v[24:25], v[24:25], v[28:29]
    v_pk_add_f32 v[32:33], v[32:33], v[36:37]
    v_pk_add_f32 v[16:17], v[16:17], v[24:25]
    v_pk_add_f32 v[32:33], v[32:33], v[40:41]
    v_pk_add_f32 v[16:17], v[16:17], v[32:33]
    v_pk_add_f32 v[18:19], v[18:19], v[22:23]
    v_pk_add_f32 v[26:27], v[26:27], v[30:31]
    v_pk_add_f32 v[34:35], v[34:35], v[38:39]
    v_pk_add_f32 v[18:19], v[18:19], v[26:27]
    v_pk_add_f32 v[34:35], v[34:35], v[42:43]
    v_pk_add_f32 v[18:19], v[18:19], v[34:35]
    s_nop 1
    v_permlane32_swap_b32 v16, v18
    v_permlane32_swap_b32_e64 v17, v19
    v_pk_add_f32 v[16:17], v[16:17], v[18:19]
    s_nop 1
    v_permlane16_swap_b32 v16, v17
    v_add_f32 v16, v16, v17
    s_nop 1
    v_add_f32_dpp v16, v16, v16 row_ror:8 row_mask:0xf bank_mask:0xf
    v_cvt_pk_bf16_f32 v16, v16, v16
    v_and_b32 v16, 0xffff0000, v16
    v_mul_f32_e64 v16, v16, v47
    v_cvt_pk_bf16_f32 v16, v16, v16
    v_and_b32 v16, 0xffff0000, v16
    v_add_f32_e64 v16, v16, v46
    v_cvt_pk_bf16_f32 v16, v16, v16
    s_mov_b32 exec_lo, 0x00ff00ff
    s_mov_b32 exec_hi, 0x00ff00ff
    buffer_store_short v16, v14, s[44:47], s80 offen
    s_mov_b64 exec, -1
    s_cmp_lg_u32 s0, 224
    s_cbranch_scc1 Lep_42
    s_cmp_lg_u32 s76, 0
    s_cbranch_scc1 Lep_42
    v_mov_b32 v196, s75
    v_mov_b32_e64 v197, 0
    s_mov_b64 exec, 1
    buffer_store_dword v196, v197, s[36:39], 0 offen sc1
    s_mov_b64 exec, -1
Lep_42:
    s_branch L_fin
L_padret:
    s_setpc_b64 s[12:13]
    .p2align 3
L_M:
    s_getpc_b64 s[90:91]
L_mpc:
    s_sub_u32 s90, s90, L_mpc-L_sube
    s_subb_u32 s91, s91, 0
    s_lshr_b32 s78, s2, 3
    s_lshl_b32 s78, s78, 10
    s_lshl_b32 s79, s76, 8
    s_add_u32 s78, s78, s79
    s_min_u32 s78, s78, (L_end-L_sube)
    v_lshl_add_u32 v119, v2, 2, s78
    global_load_dword v119, v119, s[90:91]
    s_setprio 1
    s_and_b32 s78, s2, 7
    s_lshr_b32 s79, s2, 3
    s_lshl_b32 s71, s78, 1
    s_and_b32 s72, s79, 1
    s_add_u32 s71, s71, s72
    s_lshr_b32 s72, s79, 1
    s_cmp_gt_u32 s70, 3
    s_cselect_b32 s78, 1, 0
    s_cmp_gt_u32 s70, 11
    s_cselect_b32 s78, 2, s78
    s_sub_u32 s78, s70, s78
    s_cmp_eq_u32 s70, 3
    s_cselect_b32 s78, 14, s78
    s_cmp_eq_u32 s70, 11
    s_cselect_b32 s78, 15, s78
    s_lshl_b32 s0, s78, 4
    s_add_u32 s0, s0, s69
    s_lshr_b32 s73, s0, 2
    s_and_b32 s74, s0, 3
    s_lshl_b32 s77, s70, 4
    s_add_u32 s77, s77, s69
    s_and_b32 s80, s76, 1
    s_lshr_b32 s81, s76, 1
    v_and_b32 v8, 15, v2
    v_lshrrev_b32 v9, 4, v2
    v_lshrrev_b32 v10, 1, v8
    s_lshl_b32 s78, s80, 13
    s_add_u32 s78, s78, 118784
    v_lshlrev_b32 v11, 7, v8
    v_add_u32 v11, s78, v11
    v_add_u32 v12, 0, v9
    v_xor_b32 v12, v12, v10
    v_lshl_add_u32 v4, v12, 4, v11
    v_add_u32 v12, 4, v9
    v_xor_b32 v12, v12, v10
    v_lshl_add_u32 v5, v12, 4, v11
    v_bfe_u32 v10, v2, 2, 2
    v_and_b32_e64 v11, 3, v2
    v_lshl_add_u32 v12, v9, 3, v10
    v_lshlrev_b32_e64 v12, 7, v12
    v_lshl_add_u32 v12, v11, 3, v12
    v_add_u32 v12, 135168, v12
    v_lshrrev_b32 v13, 1, v10
    v_and_b32 v14, 1, v9
    v_lshl_add_u32 v13, v14, 1, v13
    s_lshl_b32 s78, s81, 1
    s_add_u32 s79, s78, 0
    v_xor_b32_e64 v14, s79, v13
    v_lshl_add_u32 v6, v14, 5, v12
    s_add_u32 s79, s78, 1
    v_xor_b32 v14, s79, v13
    v_lshl_add_u32 v7, v14, 5, v12
    v_lshrrev_b32_e64 v13, 5, v2
    v_lshl_add_u32 v13, v13, 3, v10
    v_lshlrev_b32 v13, 6, v13
    v_and_b32 v14, 1, v9
    v_lshl_add_u32 v13, v14, 5, v13
    v_lshl_add_u32 v13, v11, 3, v13
    s_lshl_b32 s78, s81, 11
    s_add_u32 s78, s78, 159744
    v_add_u32 v15, s78, v13
    v_mov_b64 v[128:129], 0
    v_mov_b64 v[130:131], 0
    v_mov_b64 v[132:133], 0
    v_mov_b64 v[134:135], 0
    v_mov_b64 v[136:137], 0
    v_mov_b64 v[138:139], 0
    v_mov_b64 v[140:141], 0
    v_mov_b64 v[142:143], 0
    v_mov_b64 v[144:145], 0
    v_mov_b64 v[146:147], 0
    v_mov_b64 v[148:149], 0
    v_mov_b64 v[150:151], 0
    v_mov_b64 v[152:153], 0
    v_mov_b64 v[154:155], 0
    v_mov_b64 v[156:157], 0
    v_mov_b64 v[158:159], 0
    v_mov_b64 v[160:161], 0
    v_mov_b64 v[162:163], 0
    v_mov_b64 v[164:165], 0
    v_mov_b64 v[166:167], 0
    v_mov_b64 v[168:169], 0
    v_mov_b64 v[170:171], 0
    v_mov_b64 v[172:173], 0
    v_mov_b64 v[174:175], 0
    v_mov_b64 v[176:177], 0
    v_mov_b64 v[178:179], 0
    v_mov_b64 v[180:181], 0
    v_mov_b64 v[182:183], 0
    v_mov_b64 v[184:185], 0
    v_mov_b64 v[186:187], 0
    v_mov_b64 v[188:189], 0
    v_mov_b64 v[190:191], 0
    v_mov_b64 v[192:193], 0
    v_mov_b64 v[194:195], 0
    v_mov_b64 v[196:197], 0
    v_mov_b64 v[198:199], 0
    v_mov_b64 v[200:201], 0
    v_mov_b64 v[202:203], 0
    v_mov_b64 v[204:205], 0
    v_mov_b64 v[206:207], 0
    v_mov_b64 v[208:209], 0
    v_mov_b64 v[210:211], 0
L_pad4:
    s_cbranch_execz L_pad8
    v_mov_b64 v[212:213], 0
    v_mov_b64 v[214:215], 0
    v_mov_b64 v[216:217], 0
    v_mov_b64 v[218:219], 0
    v_mov_b64 v[220:221], 0
    v_mov_b64 v[222:223], 0
    v_mov_b64 v[104:105], 0
    v_mov_b64 v[106:107], 0
    v_mov_b64 v[108:109], 0
    v_mov_b64 v[110:111], 0
    v_and_b32 v14, 31, v2
    v_lshrrev_b32 v13, 5, v2
    s_lshl_b32 s78, s81, 14
    s_lshl_b32 s79, s80, 13
    s_add_u32 s78, s78, s79
    s_add_u32 s78, s78, 110592
    v_lshl_add_u32 v12, v14, 7, s78
    v_and_b32 v14, 7, v14
    v_xor_b32 v14, v14, v13
    v_xor_b32_e64 v13, 0, v14
    v_lshl_add_u32 v112, v13, 4, v12
    v_xor_b32_e64 v13, 2, v14
    v_lshl_add_u32 v113, v13, 4, v12
    v_xor_b32_e64 v13, 4, v14
    v_lshl_add_u32 v114, v13, 4, v12
    v_xor_b32_e64 v13, 6, v14
    v_lshl_add_u32 v115, v13, 4, v12
    s_add_u32 s79, s79, 143360
    v_lshl_add_u32 v12, v8, 7, s79
    s_lshl_b32 s78, s81, 2
    v_add_u32 v14, s78, v9
    v_and_b32 v13, 7, v8
    v_xor_b32 v14, v14, v13
    v_lshl_add_u32 v116, v14, 4, v12
    s_lshl_b32 s78, s80, 6
    v_add_u32 v10, s78, v8
    v_lshlrev_b32_e64 v11, 3, v10
    v_add_u32 v11, 159744, v11
    s_lshl_b32 s79, s81, 5
    v_add_u32 v12, s79, v8
    v_lshlrev_b32_e64 v12, 3, v12
    v_add_u32 v12, 160768, v12
    v_lshlrev_b32_e64 v13, 2, v10
    v_add_u32 v13, 162304, v13
    v_and_b32 v14, 31, v2
    v_add_u32 v14, s78, v14
    v_lshlrev_b32_e64 v14, 2, v14
    v_add_u32 v14, 162304, v14
    s_waitcnt lgkmcnt(0)
    s_load_dword s75, s[26:27], 0
    s_getpc_b64 s[12:13]
Lpr_43:
    s_add_u32 s12, s12, L_end-Lpr_43
    s_addc_u32 s13, s13, 0
    s_mov_b32 s36, s26
    s_and_b32 s37, s27, 0xffff
    s_mov_b32 s38, 0x10000000
    s_mov_b32 s39, 0x20000
    s_mov_b32 s64, s14
    s_and_b32 s65, s15, 0xffff
    s_mov_b32 s66, 0x800
    s_mov_b32 s67, 0x20000
    s_mov_b32 s44, s22
    s_and_b32 s45, s23, 0xffff
    s_mov_b32 s46, 0x400000
    s_mov_b32 s47, 0x20000
    s_lshl_b32 s78, s72, 7
    buffer_load_dword v118, off, s[64:67], s78
    s_waitcnt lgkmcnt(0)
    s_mul_i32 s75, s75, 0x9E3779B1
    s_add_u32 s75, s75, 0x7F4A7C15
    s_mov_b32 s84, 0
    s_mov_b32 s82, 2
    s_mov_b32 s83, 0xfffec000
    s_barrier
    s_nop 0
    ds_read_b128 v[16:19], v4 offset:0
    ds_read_b64_tr_b16 v[40:41], v6 offset:8192
    ds_read_b64_tr_b16 v[42:43], v6 offset:8704
    ds_read_b128 v[20:23], v4 offset:2048
    ds_read_b128 v[24:27], v4 offset:4096
    ds_read_b128 v[28:31], v4 offset:6144
    ds_read_b64_tr_b16 v[44:45], v7 offset:8192
    ds_read_b64_tr_b16 v[46:47], v7 offset:8704
    ds_read_b64_tr_b16 v[48:49], v6 offset:16384
    ds_read_b64_tr_b16 v[50:51], v6 offset:16896
    ds_read_b64_tr_b16 v[52:53], v7 offset:16384
    ds_read_b64_tr_b16 v[54:55], v7 offset:16896
    ds_read_b64_tr_b16 v[32:33], v6 offset:0
    ds_read_b64_tr_b16 v[34:35], v6 offset:512
    ds_read_b64_tr_b16 v[36:37], v7 offset:0
    ds_read_b64_tr_b16 v[38:39], v7 offset:512
    ds_read_b64_tr_b16 v[96:97], v15 offset:0
    ds_read_b64_tr_b16 v[98:99], v15 offset:1024
    ds_read_b64_tr_b16 v[100:101], v15 offset:256
    ds_read_b64_tr_b16 v[102:103], v15 offset:1280
    s_waitcnt lgkmcnt(0)
    s_nop 0
    v_mfma_f32_16x16x32_bf16 v[160:163], v[40:43], v[16:19], v[160:163]
    v_mfma_f32_16x16x32_bf16 v[176:179], v[44:47], v[16:19], v[176:179]
    v_mfma_f32_16x16x32_bf16 v[180:183], v[44:47], v[20:23], v[180:183]
    v_mfma_f32_16x16x32_bf16 v[164:167], v[40:43], v[20:23], v[164:167]
    v_mfma_f32_16x16x32_bf16 v[168:171], v[40:43], v[24:27], v[168:171]
    v_mfma_f32_16x16x32_bf16 v[184:187], v[44:47], v[24:27], v[184:187]
    v_mfma_f32_16x16x32_bf16 v[188:191], v[44:47], v[28:31], v[188:191]
    v_mfma_f32_16x16x32_bf16 v[172:175], v[40:43], v[28:31], v[172:175]
    v_mfma_f32_16x16x32_bf16 v[204:207], v[48:51], v[28:31], v[204:207]
    v_mfma_f32_16x16x32_bf16 v[220:223], v[52:55], v[28:31], v[220:223]
    v_mfma_f32_16x16x32_bf16 v[216:219], v[52:55], v[24:27], v[216:219]
    v_mfma_f32_16x16x32_bf16 v[200:203], v[48:51], v[24:27], v[200:203]
    v_mfma_f32_16x16x32_bf16 v[196:199], v[48:51], v[20:23], v[196:199]
    v_mfma_f32_16x16x32_bf16 v[212:215], v[52:55], v[20:23], v[212:215]
    v_mfma_f32_16x16x32_bf16 v[208:211], v[52:55], v[16:19], v[208:211]
    v_mfma_f32_16x16x32_bf16 v[192:195], v[48:51], v[16:19], v[192:195]
    v_mfma_f32_16x16x32_bf16 v[128:131], v[32:35], v[16:19], v[128:131]
    v_mfma_f32_16x16x32_bf16 v[144:147], v[36:39], v[16:19], v[144:147]
    v_mfma_f32_16x16x32_bf16 v[148:151], v[36:39], v[20:23], v[148:151]
    v_mfma_f32_16x16x32_bf16 v[132:135], v[32:35], v[20:23], v[132:135]
    v_mfma_f32_16x16x32_bf16 v[136:139], v[32:35], v[24:27], v[136:139]
    v_mfma_f32_16x16x32_bf16 v[152:155], v[36:39], v[24:27], v[152:155]
    v_mfma_f32_16x16x32_bf16 v[156:159], v[36:39], v[28:31], v[156:159]
    v_mfma_f32_16x16x32_bf16 v[140:143], v[32:35], v[28:31], v[140:143]
    ds_read_b128 v[56:59], v5 offset:0
    ds_read_b64_tr_b16 v[80:81], v6 offset:12288
    ds_read_b64_tr_b16 v[82:83], v6 offset:12800
    ds_read_b128 v[60:63], v5 offset:2048
    ds_read_b128 v[64:67], v5 offset:4096
    ds_read_b128 v[68:71], v5 offset:6144
    ds_read_b64_tr_b16 v[84:85], v7 offset:12288
    ds_read_b64_tr_b16 v[86:87], v7 offset:12800
    ds_read_b64_tr_b16 v[88:89], v6 offset:20480
    ds_read_b64_tr_b16 v[90:91], v6 offset:20992
    ds_read_b64_tr_b16 v[92:93], v7 offset:20480
    ds_read_b64_tr_b16 v[94:95], v7 offset:20992
    ds_read_b64_tr_b16 v[72:73], v6 offset:4096
    ds_read_b64_tr_b16 v[74:75], v6 offset:4608
    ds_read_b64_tr_b16 v[76:77], v7 offset:4096
    ds_read_b64_tr_b16 v[78:79], v7 offset:4608
    s_add_u32 s84, s84, 1
    s_cmp_eq_u32 s82, 2
    s_cselect_b32 s78, s83, 40960
    s_cselect_b32 s82, -1, s82
    s_add_u32 s82, s82, 1
    v_add_u32 v4, s78, v4
    v_add_u32 v5, s78, v5
    v_add_u32 v6, s78, v6
    v_add_u32_e64 v7, s78, v7
    s_waitcnt vmcnt(0) lgkmcnt(0)
    v_mfma_f32_16x16x32_bf16 v[160:163], v[80:83], v[56:59], v[160:163]
    v_mfma_f32_16x16x32_bf16 v[176:179], v[84:87], v[56:59], v[176:179]
    v_mfma_f32_16x16x32_bf16 v[180:183], v[84:87], v[60:63], v[180:183]
    v_mfma_f32_16x16x32_bf16 v[164:167], v[80:83], v[60:63], v[164:167]
    v_mfma_f32_16x16x32_bf16 v[168:171], v[80:83], v[64:67], v[168:171]
    v_mfma_f32_16x16x32_bf16 v[184:187], v[84:87], v[64:67], v[184:187]
    v_mfma_f32_16x16x32_bf16 v[188:191], v[84:87], v[68:71], v[188:191]
    v_mfma_f32_16x16x32_bf16 v[172:175], v[80:83], v[68:71], v[172:175]
    v_mfma_f32_16x16x32_bf16 v[204:207], v[88:91], v[68:71], v[204:207]
    v_mfma_f32_16x16x32_bf16 v[220:223], v[92:95], v[68:71], v[220:223]
    v_mfma_f32_16x16x32_bf16 v[216:219], v[92:95], v[64:67], v[216:219]
    v_mfma_f32_16x16x32_bf16 v[200:203], v[88:91], v[64:67], v[200:203]
    v_mfma_f32_16x16x32_bf16 v[196:199], v[88:91], v[60:63], v[196:199]
    v_mfma_f32_16x16x32_bf16 v[212:215], v[92:95], v[60:63], v[212:215]
    v_mfma_f32_16x16x32_bf16 v[208:211], v[92:95], v[56:59], v[208:211]
    v_mfma_f32_16x16x32_bf16 v[192:195], v[88:91], v[56:59], v[192:195]
    v_mfma_f32_16x16x32_bf16 v[128:131], v[72:75], v[56:59], v[128:131]
    v_mfma_f32_16x16x32_bf16 v[144:147], v[76:79], v[56:59], v[144:147]
    v_mfma_f32_16x16x32_bf16 v[148:151], v[76:79], v[60:63], v[148:151]
    v_mfma_f32_16x16x32_bf16 v[132:135], v[72:75], v[60:63], v[132:135]
    v_mfma_f32_16x16x32_bf16 v[136:139], v[72:75], v[64:67], v[136:139]
    v_mfma_f32_16x16x32_bf16 v[152:155], v[76:79], v[64:67], v[152:155]
    v_mfma_f32_16x16x32_bf16 v[156:159], v[76:79], v[68:71], v[156:159]
    v_mfma_f32_16x16x32_bf16 v[140:143], v[72:75], v[68:71], v[140:143]
    s_barrier
    s_nop 0
    ds_read_b128 v[16:19], v4 offset:0
    ds_read_b64_tr_b16 v[40:41], v6 offset:8192
    ds_read_b64_tr_b16 v[42:43], v6 offset:8704
    ds_read_b128 v[20:23], v4 offset:2048
    ds_read_b128 v[24:27], v4 offset:4096
    ds_read_b128 v[28:31], v4 offset:6144
    ds_read_b64_tr_b16 v[44:45], v7 offset:8192
    ds_read_b64_tr_b16 v[46:47], v7 offset:8704
    ds_read_b64_tr_b16 v[48:49], v6 offset:16384
    ds_read_b64_tr_b16 v[50:51], v6 offset:16896
    ds_read_b64_tr_b16 v[52:53], v7 offset:16384
    ds_read_b64_tr_b16 v[54:55], v7 offset:16896
    ds_read_b64_tr_b16 v[32:33], v6 offset:0
    ds_read_b64_tr_b16 v[34:35], v6 offset:512
    ds_read_b64_tr_b16 v[36:37], v7 offset:0
    ds_read_b64_tr_b16 v[38:39], v7 offset:512
    s_waitcnt lgkmcnt(0)
    s_nop 0
    v_mfma_f32_16x16x32_bf16 v[160:163], v[40:43], v[16:19], v[160:163]
    v_mfma_f32_16x16x32_bf16 v[176:179], v[44:47], v[16:19], v[176:179]
    v_mfma_f32_16x16x32_bf16 v[180:183], v[44:47], v[20:23], v[180:183]
    v_mfma_f32_16x16x32_bf16 v[164:167], v[40:43], v[20:23], v[164:167]
    v_mfma_f32_16x16x32_bf16 v[168:171], v[40:43], v[24:27], v[168:171]
    v_mfma_f32_16x16x32_bf16 v[184:187], v[44:47], v[24:27], v[184:187]
    v_mfma_f32_16x16x32_bf16 v[188:191], v[44:47], v[28:31], v[188:191]
    v_mfma_f32_16x16x32_bf16 v[172:175], v[40:43], v[28:31], v[172:175]
    v_mfma_f32_16x16x32_bf16 v[204:207], v[48:51], v[28:31], v[204:207]
    v_mfma_f32_16x16x32_bf16 v[220:223], v[52:55], v[28:31], v[220:223]
    v_mfma_f32_16x16x32_bf16 v[216:219], v[52:55], v[24:27], v[216:219]
    v_mfma_f32_16x16x32_bf16 v[200:203], v[48:51], v[24:27], v[200:203]
    v_mfma_f32_16x16x32_bf16 v[196:199], v[48:51], v[20:23], v[196:199]
    v_mfma_f32_16x16x32_bf16 v[212:215], v[52:55], v[20:23], v[212:215]
    v_mfma_f32_16x16x32_bf16 v[208:211], v[52:55], v[16:19], v[208:211]
    v_mfma_f32_16x16x32_bf16 v[192:195], v[48:51], v[16:19], v[192:195]
    v_mfma_f32_16x16x32_bf16 v[128:131], v[32:35], v[16:19], v[128:131]
    v_mfma_f32_16x16x32_bf16 v[144:147], v[36:39], v[16:19], v[144:147]
    v_mfma_f32_16x16x32_bf16 v[148:151], v[36:39], v[20:23], v[148:151]
    v_mfma_f32_16x16x32_bf16 v[132:135], v[32:35], v[20:23], v[132:135]
    v_mfma_f32_16x16x32_bf16 v[136:139], v[32:35], v[24:27], v[136:139]
    v_mfma_f32_16x16x32_bf16 v[152:155], v[36:39], v[24:27], v[152:155]
    v_mfma_f32_16x16x32_bf16 v[156:159], v[36:39], v[28:31], v[156:159]
    v_mfma_f32_16x16x32_bf16 v[140:143], v[32:35], v[28:31], v[140:143]
    ds_read_b128 v[56:59], v5 offset:0
    ds_read_b64_tr_b16 v[80:81], v6 offset:12288
    ds_read_b64_tr_b16 v[82:83], v6 offset:12800
    ds_read_b128 v[60:63], v5 offset:2048
    ds_read_b128 v[64:67], v5 offset:4096
    ds_read_b128 v[68:71], v5 offset:6144
    ds_read_b64_tr_b16 v[84:85], v7 offset:12288
    ds_read_b64_tr_b16 v[86:87], v7 offset:12800
    ds_read_b64_tr_b16 v[88:89], v6 offset:20480
    ds_read_b64_tr_b16 v[90:91], v6 offset:20992
    ds_read_b64_tr_b16 v[92:93], v7 offset:20480
    ds_read_b64_tr_b16 v[94:95], v7 offset:20992
    ds_read_b64_tr_b16 v[72:73], v6 offset:4096
    ds_read_b64_tr_b16 v[74:75], v6 offset:4608
    ds_read_b64_tr_b16 v[76:77], v7 offset:4096
    ds_read_b64_tr_b16 v[78:79], v7 offset:4608
    s_add_u32 s84, s84, 1
    s_cmp_eq_u32 s82, 2
    s_cselect_b32 s78, s83, 40960
    s_cselect_b32 s82, -1, s82
    s_add_u32 s82, s82, 1
    v_add_u32 v4, s78, v4
    v_add_u32 v5, s78, v5
    v_add_u32 v6, s78, v6
    v_add_u32_e64 v7, s78, v7
    s_waitcnt vmcnt(0) lgkmcnt(0)
    v_mfma_f32_16x16x32_bf16 v[160:163], v[80:83], v[56:59], v[160:163]
    v_mfma_f32_16x16x32_bf16 v[176:179], v[84:87], v[56:59], v[176:179]
    v_mfma_f32_16x16x32_bf16 v[180:183], v[84:87], v[60:63], v[180:183]
    v_mfma_f32_16x16x32_bf16 v[164:167], v[80:83], v[60:63], v[164:167]
    v_mfma_f32_16x16x32_bf16 v[168:171], v[80:83], v[64:67], v[168:171]
    v_mfma_f32_16x16x32_bf16 v[184:187], v[84:87], v[64:67], v[184:187]
    v_mfma_f32_16x16x32_bf16 v[188:191], v[84:87], v[68:71], v[188:191]
    v_mfma_f32_16x16x32_bf16 v[172:175], v[80:83], v[68:71], v[172:175]
    v_mfma_f32_16x16x32_bf16 v[204:207], v[88:91], v[68:71], v[204:207]
    v_mfma_f32_16x16x32_bf16 v[220:223], v[92:95], v[68:71], v[220:223]
    v_mfma_f32_16x16x32_bf16 v[216:219], v[92:95], v[64:67], v[216:219]
    v_mfma_f32_16x16x32_bf16 v[200:203], v[88:91], v[64:67], v[200:203]
    v_mfma_f32_16x16x32_bf16 v[196:199], v[88:91], v[60:63], v[196:199]
    v_mfma_f32_16x16x32_bf16 v[212:215], v[92:95], v[60:63], v[212:215]
    v_mfma_f32_16x16x32_bf16 v[208:211], v[92:95], v[56:59], v[208:211]
    v_mfma_f32_16x16x32_bf16 v[192:195], v[88:91], v[56:59], v[192:195]
    v_mfma_f32_16x16x32_bf16 v[128:131], v[72:75], v[56:59], v[128:131]
    v_mfma_f32_16x16x32_bf16 v[144:147], v[76:79], v[56:59], v[144:147]
    v_mfma_f32_16x16x32_bf16 v[148:151], v[76:79], v[60:63], v[148:151]
    v_mfma_f32_16x16x32_bf16 v[132:135], v[72:75], v[60:63], v[132:135]
    v_mfma_f32_16x16x32_bf16 v[136:139], v[72:75], v[64:67], v[136:139]
    v_mfma_f32_16x16x32_bf16 v[152:155], v[76:79], v[64:67], v[152:155]
    v_mfma_f32_16x16x32_bf16 v[156:159], v[76:79], v[68:71], v[156:159]
    v_mfma_f32_16x16x32_bf16 v[140:143], v[72:75], v[68:71], v[140:143]
    s_mov_b64 exec, 0
    s_cmp_lg_u32 s76, 0
    s_cbranch_scc1 Lt_44
    s_call_b64 s[12:13], L_pad0
Lt_44:
    s_cmp_lg_u32 s76, 1
    s_cbranch_scc1 Lt_45
    s_call_b64 s[12:13], L_pad1
Lt_45:
    s_cmp_lg_u32 s76, 2
    s_cbranch_scc1 Lt_46
    s_call_b64 s[12:13], L_pad2
Lt_46:
    s_cmp_lg_u32 s76, 3
    s_cbranch_scc1 Lt_47
    s_call_b64 s[12:13], L_pad3
Lt_47:
    s_mov_b64 exec, -1
    s_barrier
    s_nop 0
    ds_read_b128 v[16:19], v4 offset:0
    ds_read_b64_tr_b16 v[40:41], v6 offset:8192
    ds_read_b64_tr_b16 v[42:43], v6 offset:8704
    ds_read_b128 v[20:23], v4 offset:2048
    ds_read_b128 v[24:27], v4 offset:4096
    ds_read_b128 v[28:31], v4 offset:6144
    ds_read_b64_tr_b16 v[44:45], v7 offset:8192
    ds_read_b64_tr_b16 v[46:47], v7 offset:8704
    ds_read_b64_tr_b16 v[48:49], v6 offset:16384
    ds_read_b64_tr_b16 v[50:51], v6 offset:16896
    ds_read_b64_tr_b16 v[52:53], v7 offset:16384
    ds_read_b64_tr_b16 v[54:55], v7 offset:16896
    ds_read_b64_tr_b16 v[32:33], v6 offset:0
L_pad5:
    s_cbranch_execz L_pad9
    ds_read_b64_tr_b16 v[34:35], v6 offset:512
    ds_read_b64_tr_b16 v[36:37], v7 offset:0
    ds_read_b64_tr_b16 v[38:39], v7 offset:512
    s_waitcnt lgkmcnt(0)
    v_mfma_f32_16x16x32_bf16 v[160:163], v[40:43], v[16:19], v[160:163]
    v_mfma_f32_16x16x32_bf16 v[176:179], v[44:47], v[16:19], v[176:179]
    v_mfma_f32_16x16x32_bf16 v[180:183], v[44:47], v[20:23], v[180:183]
    v_mfma_f32_16x16x32_bf16 v[164:167], v[40:43], v[20:23], v[164:167]
    v_mfma_f32_16x16x32_bf16 v[168:171], v[40:43], v[24:27], v[168:171]
    v_mfma_f32_16x16x32_bf16 v[184:187], v[44:47], v[24:27], v[184:187]
    v_mfma_f32_16x16x32_bf16 v[188:191], v[44:47], v[28:31], v[188:191]
    v_mfma_f32_16x16x32_bf16 v[172:175], v[40:43], v[28:31], v[172:175]
    v_mfma_f32_16x16x32_bf16 v[204:207], v[48:51], v[28:31], v[204:207]
    v_mfma_f32_16x16x32_bf16 v[220:223], v[52:55], v[28:31], v[220:223]
    v_mfma_f32_16x16x32_bf16 v[216:219], v[52:55], v[24:27], v[216:219]
    v_mfma_f32_16x16x32_bf16 v[200:203], v[48:51], v[24:27], v[200:203]
    v_mfma_f32_16x16x32_bf16 v[196:199], v[48:51], v[20:23], v[196:199]
    v_mfma_f32_16x16x32_bf16 v[212:215], v[52:55], v[20:23], v[212:215]
    v_mfma_f32_16x16x32_bf16 v[208:211], v[52:55], v[16:19], v[208:211]
    v_mfma_f32_16x16x32_bf16 v[192:195], v[48:51], v[16:19], v[192:195]
    v_mfma_f32_16x16x32_bf16 v[128:131], v[32:35], v[16:19], v[128:131]
    v_mfma_f32_16x16x32_bf16 v[144:147], v[36:39], v[16:19], v[144:147]
    v_mfma_f32_16x16x32_bf16 v[148:151], v[36:39], v[20:23], v[148:151]
    v_mfma_f32_16x16x32_bf16 v[132:135], v[32:35], v[20:23], v[132:135]
    v_mfma_f32_16x16x32_bf16 v[136:139], v[32:35], v[24:27], v[136:139]
    v_mfma_f32_16x16x32_bf16 v[152:155], v[36:39], v[24:27], v[152:155]
    v_mfma_f32_16x16x32_bf16 v[156:159], v[36:39], v[28:31], v[156:159]
    v_mfma_f32_16x16x32_bf16 v[140:143], v[32:35], v[28:31], v[140:143]
    ds_read_b128 v[56:59], v5 offset:0
    ds_read_b64_tr_b16 v[80:81], v6 offset:12288
    ds_read_b64_tr_b16 v[82:83], v6 offset:12800
    ds_read_b128 v[60:63], v5 offset:2048
    ds_read_b128 v[64:67], v5 offset:4096
    ds_read_b128 v[68:71], v5 offset:6144
    ds_read_b64_tr_b16 v[84:85], v7 offset:12288
    ds_read_b64_tr_b16 v[86:87], v7 offset:12800
    ds_read_b64_tr_b16 v[88:89], v6 offset:20480
    ds_read_b64_tr_b16 v[90:91], v6 offset:20992
    ds_read_b64_tr_b16 v[92:93], v7 offset:20480
    ds_read_b64_tr_b16 v[94:95], v7 offset:20992
    ds_read_b64_tr_b16 v[72:73], v6 offset:4096
    ds_read_b64_tr_b16 v[74:75], v6 offset:4608
    ds_read_b64_tr_b16 v[76:77], v7 offset:4096
    ds_read_b64_tr_b16 v[78:79], v7 offset:4608
    s_add_u32 s84, s84, 1
    s_cmp_eq_u32 s82, 2
    s_cselect_b32 s78, s83, 40960
    s_cselect_b32 s82, -1, s82
    s_add_u32 s82, s82, 1
    v_add_u32 v4, s78, v4
    v_add_u32 v5, s78, v5
    v_add_u32 v6, s78, v6
    v_add_u32_e64 v7, s78, v7
    s_waitcnt vmcnt(0) lgkmcnt(0)
    v_mfma_f32_16x16x32_bf16 v[160:163], v[80:83], v[56:59], v[160:163]
    v_mfma_f32_16x16x32_bf16 v[176:179], v[84:87], v[56:59], v[176:179]
    v_mfma_f32_16x16x32_bf16 v[180:183], v[84:87], v[60:63], v[180:183]
    v_mfma_f32_16x16x32_bf16 v[164:167], v[80:83], v[60:63], v[164:167]
    v_mfma_f32_16x16x32_bf16 v[168:171], v[80:83], v[64:67], v[168:171]
    v_mfma_f32_16x16x32_bf16 v[184:187], v[84:87], v[64:67], v[184:187]
    v_mfma_f32_16x16x32_bf16 v[188:191], v[84:87], v[68:71], v[188:191]
    v_mfma_f32_16x16x32_bf16 v[172:175], v[80:83], v[68:71], v[172:175]
    v_mfma_f32_16x16x32_bf16 v[204:207], v[88:91], v[68:71], v[204:207]
    v_mfma_f32_16x16x32_bf16 v[220:223], v[92:95], v[68:71], v[220:223]
    v_mfma_f32_16x16x32_bf16 v[216:219], v[92:95], v[64:67], v[216:219]
    v_mfma_f32_16x16x32_bf16 v[200:203], v[88:91], v[64:67], v[200:203]
    v_mfma_f32_16x16x32_bf16 v[196:199], v[88:91], v[60:63], v[196:199]
    v_mfma_f32_16x16x32_bf16 v[212:215], v[92:95], v[60:63], v[212:215]
    v_mfma_f32_16x16x32_bf16 v[208:211], v[92:95], v[56:59], v[208:211]
    v_mfma_f32_16x16x32_bf16 v[192:195], v[88:91], v[56:59], v[192:195]
    v_mfma_f32_16x16x32_bf16 v[128:131], v[72:75], v[56:59], v[128:131]
    v_mfma_f32_16x16x32_bf16 v[144:147], v[76:79], v[56:59], v[144:147]
    v_mfma_f32_16x16x32_bf16 v[148:151], v[76:79], v[60:63], v[148:151]
    v_mfma_f32_16x16x32_bf16 v[132:135], v[72:75], v[60:63], v[132:135]
    v_mfma_f32_16x16x32_bf16 v[136:139], v[72:75], v[64:67], v[136:139]
    v_mfma_f32_16x16x32_bf16 v[152:155], v[76:79], v[64:67], v[152:155]
    v_mfma_f32_16x16x32_bf16 v[156:159], v[76:79], v[68:71], v[156:159]
    v_mfma_f32_16x16x32_bf16 v[140:143], v[72:75], v[68:71], v[140:143]
    s_barrier
    s_nop 0
    ds_read_b128 v[16:19], v4 offset:0
    ds_read_b64_tr_b16 v[40:41], v6 offset:8192
    ds_read_b64_tr_b16 v[42:43], v6 offset:8704
    ds_read_b128 v[20:23], v4 offset:2048
    ds_read_b128 v[24:27], v4 offset:4096
    ds_read_b128 v[28:31], v4 offset:6144
    ds_read_b64_tr_b16 v[44:45], v7 offset:8192
    ds_read_b64_tr_b16 v[46:47], v7 offset:8704
    ds_read_b64_tr_b16 v[48:49], v6 offset:16384
    ds_read_b64_tr_b16 v[50:51], v6 offset:16896
    ds_read_b64_tr_b16 v[52:53], v7 offset:16384
    ds_read_b64_tr_b16 v[54:55], v7 offset:16896
    ds_read_b64_tr_b16 v[32:33], v6 offset:0
    ds_read_b64_tr_b16 v[34:35], v6 offset:512
    ds_read_b64_tr_b16 v[36:37], v7 offset:0
    ds_read_b64_tr_b16 v[38:39], v7 offset:512
    .p2align 3
L_Mloop:
    s_waitcnt lgkmcnt(0)
    s_nop 0
    v_mfma_f32_16x16x32_bf16 v[160:163], v[40:43], v[16:19], v[160:163]
    ds_read_b128 v[56:59], v5 offset:0
    v_mfma_f32_16x16x32_bf16 v[176:179], v[44:47], v[16:19], v[176:179]
    ds_read_b64_tr_b16 v[80:81], v6 offset:12288
    v_mfma_f32_16x16x32_bf16 v[180:183], v[44:47], v[20:23], v[180:183]
    ds_read_b64_tr_b16 v[82:83], v6 offset:12800
    v_mfma_f32_16x16x32_bf16 v[164:167], v[40:43], v[20:23], v[164:167]
    ds_read_b128 v[60:63], v5 offset:2048
    v_mfma_f32_16x16x32_bf16 v[168:171], v[40:43], v[24:27], v[168:171]
    ds_read_b128 v[64:67], v5 offset:4096
    v_mfma_f32_16x16x32_bf16 v[184:187], v[44:47], v[24:27], v[184:187]
    ds_read_b128 v[68:71], v5 offset:6144
    v_mfma_f32_16x16x32_bf16 v[188:191], v[44:47], v[28:31], v[188:191]
    ds_read_b64_tr_b16 v[84:85], v7 offset:12288
    v_mfma_f32_16x16x32_bf16 v[172:175], v[40:43], v[28:31], v[172:175]
    ds_read_b64_tr_b16 v[86:87], v7 offset:12800
    v_mfma_f32_16x16x32_bf16 v[204:207], v[48:51], v[28:31], v[204:207]
    ds_read_b64_tr_b16 v[88:89], v6 offset:20480
    v_mfma_f32_16x16x32_bf16 v[220:223], v[52:55], v[28:31], v[220:223]
    ds_read_b64_tr_b16 v[90:91], v6 offset:20992
    v_mfma_f32_16x16x32_bf16 v[216:219], v[52:55], v[24:27], v[216:219]
    ds_read_b64_tr_b16 v[92:93], v7 offset:20480
    v_mfma_f32_16x16x32_bf16 v[200:203], v[48:51], v[24:27], v[200:203]
    ds_read_b64_tr_b16 v[94:95], v7 offset:20992
    v_mfma_f32_16x16x32_bf16 v[196:199], v[48:51], v[20:23], v[196:199]
    ds_read_b64_tr_b16 v[72:73], v6 offset:4096
    v_mfma_f32_16x16x32_bf16 v[212:215], v[52:55], v[20:23], v[212:215]
    ds_read_b64_tr_b16 v[74:75], v6 offset:4608
    v_mfma_f32_16x16x32_bf16 v[208:211], v[52:55], v[16:19], v[208:211]
    ds_read_b64_tr_b16 v[76:77], v7 offset:4096
    v_mfma_f32_16x16x32_bf16 v[192:195], v[48:51], v[16:19], v[192:195]
    ds_read_b64_tr_b16 v[78:79], v7 offset:4608
    v_mfma_f32_16x16x32_bf16 v[128:131], v[32:35], v[16:19], v[128:131]
    s_add_u32 s84, s84, 1
    s_cmp_eq_u32 s82, 2
    s_cselect_b32 s78, s83, 40960
    s_cselect_b32 s82, -1, s82
    s_add_u32 s82, s82, 1
    v_mfma_f32_16x16x32_bf16 v[144:147], v[36:39], v[16:19], v[144:147]
    v_add_u32 v4, s78, v4
    v_add_u32 v5, s78, v5
    v_mfma_f32_16x16x32_bf16 v[148:151], v[36:39], v[20:23], v[148:151]
    v_add_u32 v6, s78, v6
    v_add_u32 v7, s78, v7
    v_mfma_f32_16x16x32_bf16 v[132:135], v[32:35], v[20:23], v[132:135]
    v_mfma_f32_16x16x32_bf16 v[136:139], v[32:35], v[24:27], v[136:139]
    v_mfma_f32_16x16x32_bf16 v[152:155], v[36:39], v[24:27], v[152:155]
    v_mfma_f32_16x16x32_bf16 v[156:159], v[36:39], v[28:31], v[156:159]
    v_mfma_f32_16x16x32_bf16 v[140:143], v[32:35], v[28:31], v[140:143]
    s_waitcnt vmcnt(0) lgkmcnt(0)
    v_mfma_f32_16x16x32_bf16 v[160:163], v[80:83], v[56:59], v[160:163]
    v_mfma_f32_16x16x32_bf16 v[176:179], v[84:87], v[56:59], v[176:179]
    s_barrier
    s_cmp_eq_u32 s84, 16
    s_cbranch_scc1 L_Mtail
    v_mfma_f32_16x16x32_bf16 v[180:183], v[84:87], v[60:63], v[180:183]
    ds_read_b128 v[16:19], v4 offset:0
    v_mfma_f32_16x16x32_bf16 v[164:167], v[80:83], v[60:63], v[164:167]
    ds_read_b64_tr_b16 v[40:41], v6 offset:8192
    v_mfma_f32_16x16x32_bf16 v[168:171], v[80:83], v[64:67], v[168:171]
    ds_read_b64_tr_b16 v[42:43], v6 offset:8704
    v_mfma_f32_16x16x32_bf16 v[184:187], v[84:87], v[64:67], v[184:187]
    ds_read_b128 v[20:23], v4 offset:2048
    v_mfma_f32_16x16x32_bf16 v[188:191], v[84:87], v[68:71], v[188:191]
    ds_read_b128 v[24:27], v4 offset:4096
    v_mfma_f32_16x16x32_bf16 v[172:175], v[80:83], v[68:71], v[172:175]
    ds_read_b128 v[28:31], v4 offset:6144
    v_mfma_f32_16x16x32_bf16 v[204:207], v[88:91], v[68:71], v[204:207]
    ds_read_b64_tr_b16 v[44:45], v7 offset:8192
    v_mfma_f32_16x16x32_bf16 v[220:223], v[92:95], v[68:71], v[220:223]
    ds_read_b64_tr_b16 v[46:47], v7 offset:8704
    v_mfma_f32_16x16x32_bf16 v[216:219], v[92:95], v[64:67], v[216:219]
    ds_read_b64_tr_b16 v[48:49], v6 offset:16384
    v_mfma_f32_16x16x32_bf16 v[200:203], v[88:91], v[64:67], v[200:203]
    ds_read_b64_tr_b16 v[50:51], v6 offset:16896
    v_mfma_f32_16x16x32_bf16 v[196:199], v[88:91], v[60:63], v[196:199]
    ds_read_b64_tr_b16 v[52:53], v7 offset:16384
    v_mfma_f32_16x16x32_bf16 v[212:215], v[92:95], v[60:63], v[212:215]
    ds_read_b64_tr_b16 v[54:55], v7 offset:16896
    v_mfma_f32_16x16x32_bf16 v[208:211], v[92:95], v[56:59], v[208:211]
    ds_read_b64_tr_b16 v[32:33], v6 offset:0
    v_mfma_f32_16x16x32_bf16 v[192:195], v[88:91], v[56:59], v[192:195]
    ds_read_b64_tr_b16 v[34:35], v6 offset:512
    v_mfma_f32_16x16x32_bf16 v[128:131], v[72:75], v[56:59], v[128:131]
    ds_read_b64_tr_b16 v[36:37], v7 offset:0
    v_mfma_f32_16x16x32_bf16 v[144:147], v[76:79], v[56:59], v[144:147]
    ds_read_b64_tr_b16 v[38:39], v7 offset:512
    v_mfma_f32_16x16x32_bf16 v[148:151], v[76:79], v[60:63], v[148:151]
    v_mfma_f32_16x16x32_bf16 v[132:135], v[72:75], v[60:63], v[132:135]
    v_mfma_f32_16x16x32_bf16 v[136:139], v[72:75], v[64:67], v[136:139]
    v_mfma_f32_16x16x32_bf16 v[152:155], v[76:79], v[64:67], v[152:155]
    v_mfma_f32_16x16x32_bf16 v[156:159], v[76:79], v[68:71], v[156:159]
    v_mfma_f32_16x16x32_bf16 v[140:143], v[72:75], v[68:71], v[140:143]
    s_branch L_Mloop
    .p2align 3
L_Mtail:
    s_mov_b64 exec, 0xffff
    ds_read_b64 v[104:105], v11 offset:0
    ds_read_b64 v[106:107], v11 offset:128
    ds_read_b64 v[108:109], v11 offset:256
    ds_read_b64 v[110:111], v11 offset:384
    s_mov_b64 exec, -1
    s_nop 0
    v_mfma_f32_16x16x32_bf16 v[180:183], v[84:87], v[60:63], v[180:183]
    ds_read_b64 v[20:21], v12 offset:512
    v_mfma_f32_16x16x32_bf16 v[164:167], v[80:83], v[60:63], v[164:167]
    ds_read_b64 v[22:23], v12 offset:640
    v_mfma_f32_16x16x32_bf16 v[168:171], v[80:83], v[64:67], v[168:171]
    ds_read_b64 v[24:25], v12 offset:1024
    v_mfma_f32_16x16x32_bf16 v[184:187], v[84:87], v[64:67], v[184:187]
    ds_read_b64 v[26:27], v12 offset:1152
    v_mfma_f32_16x16x32_bf16 v[188:191], v[84:87], v[68:71], v[188:191]
    ds_read_b64 v[16:17], v12 offset:0
    v_mfma_f32_16x16x32_bf16 v[172:175], v[80:83], v[68:71], v[172:175]
    ds_read_b64 v[18:19], v12 offset:128
    v_mfma_f32_16x16x32_bf16 v[204:207], v[88:91], v[68:71], v[204:207]
    ds_read2_b32 v[32:33], v14 offset0:0 offset1:32
    v_mfma_f32_16x16x32_bf16 v[220:223], v[92:95], v[68:71], v[220:223]
    ds_read_b32 v28, v13 offset:0
    v_mfma_f32_16x16x32_bf16 v[216:219], v[92:95], v[64:67], v[216:219]
    ds_read_b32 v30, v13 offset:64
    v_mfma_f32_16x16x32_bf16 v[200:203], v[88:91], v[64:67], v[200:203]
    ds_read_b32 v44, v13 offset:128
    v_mfma_f32_16x16x32_bf16 v[196:199], v[88:91], v[60:63], v[196:199]
    ds_read_b32 v46, v13 offset:192
    v_mfma_f32_16x16x32_bf16 v[212:215], v[92:95], v[60:63], v[212:215]
    v_mfma_f32_16x16x32_bf16 v[208:211], v[92:95], v[56:59], v[208:211]
    v_mfma_f32_16x16x32_bf16 v[192:195], v[88:91], v[56:59], v[192:195]
    s_waitcnt lgkmcnt(0)
    s_nop 0
    v_mfma_f32_16x16x16_bf16 v[160:163], v[20:21], v[104:105], v[160:163]
    v_mfma_f32_16x16x16_bf16 v[176:179], v[22:23], v[104:105], v[176:179]
    v_mfma_f32_16x16x16_bf16 v[164:167], v[20:21], v[106:107], v[164:167]
    v_mfma_f32_16x16x16_bf16 v[180:183], v[22:23], v[106:107], v[180:183]
    v_mfma_f32_16x16x16_bf16 v[168:171], v[20:21], v[108:109], v[168:171]
    v_mfma_f32_16x16x16_bf16 v[184:187], v[22:23], v[108:109], v[184:187]
    v_mfma_f32_16x16x16_bf16 v[172:175], v[20:21], v[110:111], v[172:175]
    v_mfma_f32_16x16x16_bf16 v[188:191], v[22:23], v[110:111], v[188:191]
    v_mul_f32 v34, 0x3fb8aa3b, v32
    v_mul_f32 v48, 0x3fb8aa3b, v33
    v_mfma_f32_16x16x16_bf16 v[192:195], v[24:25], v[104:105], v[192:195]
    v_mfma_f32_16x16x16_bf16 v[208:211], v[26:27], v[104:105], v[208:211]
    v_mfma_f32_16x16x16_bf16 v[196:199], v[24:25], v[106:107], v[196:199]
    v_cvt_pk_bf16_f32 v160, v160, v161
    v_cvt_pk_bf16_f32 v161, v162, v163
    v_cvt_pk_bf16_f32 v162, v176, v177
    v_cvt_pk_bf16_f32 v163, v178, v179
    v_mfma_f32_16x16x16_bf16 v[212:215], v[26:27], v[106:107], v[212:215]
    v_cvt_pk_bf16_f32 v164, v164, v165
    v_cvt_pk_bf16_f32 v165, v166, v167
    v_cvt_pk_bf16_f32 v166, v180, v181
    v_cvt_pk_bf16_f32 v167, v182, v183
    v_mfma_f32_16x16x16_bf16 v[200:203], v[24:25], v[108:109], v[200:203]
    v_cvt_pk_bf16_f32 v168, v168, v169
    v_cvt_pk_bf16_f32 v169, v170, v171
    v_cvt_pk_bf16_f32 v170, v184, v185
    v_cvt_pk_bf16_f32 v171, v186, v187
    v_mfma_f32_16x16x16_bf16 v[216:219], v[26:27], v[108:109], v[216:219]
    v_cvt_pk_bf16_f32 v172, v172, v173
    v_cvt_pk_bf16_f32 v173, v174, v175
    v_cvt_pk_bf16_f32 v174, v188, v189
    v_cvt_pk_bf16_f32 v175, v190, v191
    v_mfma_f32_16x16x16_bf16 v[204:207], v[24:25], v[110:111], v[204:207]
    v_permlane16_swap_b32 v160, v164
    v_permlane16_swap_b32 v161, v165
    v_permlane16_swap_b32 v162, v166
    v_permlane16_swap_b32 v163, v167
    v_mfma_f32_16x16x16_bf16 v[220:223], v[26:27], v[110:111], v[220:223]
    v_permlane16_swap_b32 v168, v172
    v_permlane16_swap_b32 v169, v173
    v_permlane16_swap_b32 v170, v174
    v_permlane16_swap_b32 v171, v175
    v_mfma_f32_32x32x16_bf16 v[224:239], v[96:99], v[160:163], 0
    v_mfma_f32_32x32x16_bf16 v[224:239], v[100:103], v[164:167], v[224:239]
    v_mfma_f32_32x32x16_bf16 v[240:255], v[96:99], v[168:171], 0
    v_mfma_f32_32x32x16_bf16 v[240:255], v[100:103], v[172:175], v[240:255]
    v_pk_mul_f32 v[192:193], v[192:193], v[28:29] op_sel_hi:[1,0]
    v_pk_mul_f32 v[194:195], v[194:195], v[28:29] op_sel_hi:[1,0]
L_pad6:
    s_cbranch_execz L_pad10
    s_nop 0
    v_pk_mul_f32 v[208:209], v[208:209], v[28:29] op_sel_hi:[1,0]
    v_pk_mul_f32 v[210:211], v[210:211], v[28:29] op_sel_hi:[1,0]
    v_cvt_pk_bf16_f32 v192, v192, v193
    v_cvt_pk_bf16_f32 v193, v194, v195
    v_cvt_pk_bf16_f32 v194, v208, v209
    v_cvt_pk_bf16_f32 v195, v210, v211
    v_pk_mul_f32 v[196:197], v[196:197], v[30:31] op_sel_hi:[1,0]
    v_pk_mul_f32 v[198:199], v[198:199], v[30:31] op_sel_hi:[1,0]
    v_pk_mul_f32 v[212:213], v[212:213], v[30:31] op_sel_hi:[1,0]
    v_pk_mul_f32 v[214:215], v[214:215], v[30:31] op_sel_hi:[1,0]
    v_cvt_pk_bf16_f32 v196, v196, v197
    v_cvt_pk_bf16_f32 v197, v198, v199
    v_cvt_pk_bf16_f32 v198, v212, v213
    v_cvt_pk_bf16_f32 v199, v214, v215
    v_pk_mul_f32 v[200:201], v[200:201], v[44:45] op_sel_hi:[1,0]
    v_pk_mul_f32 v[202:203], v[202:203], v[44:45] op_sel_hi:[1,0]
    v_pk_mul_f32 v[216:217], v[216:217], v[44:45] op_sel_hi:[1,0]
    v_pk_mul_f32 v[218:219], v[218:219], v[44:45] op_sel_hi:[1,0]
    v_cvt_pk_bf16_f32 v200, v200, v201
    v_cvt_pk_bf16_f32 v201, v202, v203
    v_cvt_pk_bf16_f32 v202, v216, v217
    v_cvt_pk_bf16_f32 v203, v218, v219
    v_pk_mul_f32 v[204:205], v[204:205], v[46:47] op_sel_hi:[1,0]
    v_pk_mul_f32 v[206:207], v[206:207], v[46:47] op_sel_hi:[1,0]
    v_pk_mul_f32 v[220:221], v[220:221], v[46:47] op_sel_hi:[1,0]
    v_pk_mul_f32 v[222:223], v[222:223], v[46:47] op_sel_hi:[1,0]
    v_cvt_pk_bf16_f32 v204, v204, v205
    v_cvt_pk_bf16_f32 v205, v206, v207
    v_cvt_pk_bf16_f32 v206, v220, v221
    v_cvt_pk_bf16_f32 v207, v222, v223
    v_mfma_f32_16x16x32_bf16 v[128:131], v[72:75], v[56:59], v[128:131]
    v_max3_f32 v36, v224, v225, v226
    v_max3_f32 v38, -v224, -v225, -v226
    v_max3_f32 v36, v36, v227, v228
    v_max3_f32 v38, v38, -v227, -v228
    v_mfma_f32_16x16x32_bf16 v[144:147], v[76:79], v[56:59], v[144:147]
    v_max3_f32 v36, v36, v229, v230
    v_max3_f32 v38, v38, -v229, -v230
    v_max3_f32 v36, v36, v231, v232
    v_max3_f32 v38, v38, -v231, -v232
    v_mfma_f32_16x16x32_bf16 v[148:151], v[76:79], v[60:63], v[148:151]
    v_max3_f32 v36, v36, v233, v234
    v_max3_f32 v38, v38, -v233, -v234
    v_max3_f32 v36, v36, v235, v236
    v_max3_f32 v38, v38, -v235, -v236
    v_mfma_f32_16x16x32_bf16 v[132:135], v[72:75], v[60:63], v[132:135]
    v_max3_f32 v36, v36, v237, v238
    v_max3_f32 v38, v38, -v237, -v238
    v_max_f32_e64 v36, v36, v239
    v_max_f32 v38, v38, -v239
    v_mfma_f32_16x16x32_bf16 v[136:139], v[72:75], v[64:67], v[136:139]
    v_max3_f32 v37, v240, v241, v242
    v_max3_f32 v39, -v240, -v241, -v242
    v_max3_f32 v37, v37, v243, v244
    v_max3_f32 v39, v39, -v243, -v244
    v_mfma_f32_16x16x32_bf16 v[152:155], v[76:79], v[64:67], v[152:155]
    v_max3_f32 v37, v37, v245, v246
    v_max3_f32 v39, v39, -v245, -v246
    v_max3_f32 v37, v37, v247, v248
    v_max3_f32 v39, v39, -v247, -v248
    v_mfma_f32_16x16x32_bf16 v[156:159], v[76:79], v[68:71], v[156:159]
    v_max3_f32 v37, v37, v249, v250
    v_max3_f32 v39, v39, -v249, -v250
    v_max3_f32 v37, v37, v251, v252
    v_max3_f32 v39, v39, -v251, -v252
    v_mfma_f32_16x16x32_bf16 v[140:143], v[72:75], v[68:71], v[140:143]
    v_max3_f32 v37, v37, v253, v254
    v_max3_f32 v39, v39, -v253, -v254
    v_max_f32_e64 v37, v37, v255
    v_max_f32 v39, v39, -v255
    v_permlane32_swap_b32 v36, v38
    s_nop 0
    v_permlane32_swap_b32 v37, v39
    v_max_f32 v36, v36, v38
    v_max_f32_e64 v37, v37, v39
    v_mul_f32 v36, -v36, v34
    v_mul_f32 v37, -v37, v48
    v_mov_b32 v38, v36
    v_mov_b32 v39, v37
    s_nop 0
    v_permlane32_swap_b32 v36, v38
    v_permlane32_swap_b32_e64 v37, v39
    v_pk_fma_f32 v[60:61], v[224:225], v[34:35], v[36:37] op_sel_hi:[1,0,0]
    v_pk_fma_f32 v[62:63], v[226:227], v[34:35], v[36:37] op_sel_hi:[1,0,0]
    v_pk_fma_f32 v[64:65], v[228:229], v[34:35], v[36:37] op_sel_hi:[1,0,0]
    v_pk_fma_f32 v[66:67], v[230:231], v[34:35], v[36:37] op_sel_hi:[1,0,0]
    v_pk_fma_f32 v[68:69], v[232:233], v[34:35], v[36:37] op_sel_hi:[1,0,0]
    v_pk_fma_f32 v[70:71], v[234:235], v[34:35], v[36:37] op_sel_hi:[1,0,0]
    v_pk_fma_f32 v[72:73], v[236:237], v[34:35], v[36:37] op_sel_hi:[1,0,0]
    v_pk_fma_f32 v[74:75], v[238:239], v[34:35], v[36:37] op_sel_hi:[1,0,0]
    v_pk_fma_f32 v[76:77], v[224:225], v[34:35], v[38:39] op_sel_hi:[1,0,0] neg_lo:[1,0,0] neg_hi:[1,0,0]
    v_pk_fma_f32 v[78:79], v[226:227], v[34:35], v[38:39] op_sel_hi:[1,0,0] neg_lo:[1,0,0] neg_hi:[1,0,0]
    v_pk_fma_f32 v[80:81], v[228:229], v[34:35], v[38:39] op_sel_hi:[1,0,0] neg_lo:[1,0,0] neg_hi:[1,0,0]
    v_pk_fma_f32 v[82:83], v[230:231], v[34:35], v[38:39] op_sel_hi:[1,0,0] neg_lo:[1,0,0] neg_hi:[1,0,0]
    v_pk_fma_f32 v[84:85], v[232:233], v[34:35], v[38:39] op_sel_hi:[1,0,0] neg_lo:[1,0,0] neg_hi:[1,0,0]
    v_pk_fma_f32 v[86:87], v[234:235], v[34:35], v[38:39] op_sel_hi:[1,0,0] neg_lo:[1,0,0] neg_hi:[1,0,0]
    v_pk_fma_f32 v[88:89], v[236:237], v[34:35], v[38:39] op_sel_hi:[1,0,0] neg_lo:[1,0,0] neg_hi:[1,0,0]
    v_pk_fma_f32 v[90:91], v[238:239], v[34:35], v[38:39] op_sel_hi:[1,0,0] neg_lo:[1,0,0] neg_hi:[1,0,0]
    v_exp_f32 v60, v60
    v_exp_f32 v61, v61
    v_exp_f32 v62, v62
    v_exp_f32 v63, v63
    v_exp_f32 v64, v64
    v_exp_f32 v65, v65
    v_exp_f32 v66, v66
    v_exp_f32 v67, v67
    v_exp_f32 v68, v68
    v_exp_f32 v69, v69
    v_exp_f32 v70, v70
    v_exp_f32 v71, v71
    v_exp_f32 v72, v72
    v_exp_f32 v73, v73
    v_exp_f32 v74, v74
    v_exp_f32 v75, v75
    v_exp_f32 v76, v76
    v_exp_f32 v77, v77
    v_exp_f32 v78, v78
    v_exp_f32 v79, v79
    v_exp_f32 v80, v80
    v_exp_f32 v81, v81
    v_exp_f32 v82, v82
    v_exp_f32 v83, v83
    v_exp_f32 v84, v84
    v_exp_f32 v85, v85
    v_exp_f32 v86, v86
    v_exp_f32 v87, v87
    v_exp_f32 v88, v88
    v_exp_f32 v89, v89
    v_exp_f32 v90, v90
    v_exp_f32 v91, v91
    v_pk_add_f32 v[40:41], v[60:61], v[62:63]
    v_pk_add_f32 v[42:43], v[76:77], v[78:79]
    v_pk_add_f32 v[40:41], v[40:41], v[64:65]
    v_pk_add_f32 v[42:43], v[42:43], v[80:81]
    v_pk_add_f32 v[40:41], v[40:41], v[66:67]
    v_pk_add_f32 v[42:43], v[42:43], v[82:83]
    v_pk_add_f32 v[40:41], v[40:41], v[68:69]
    v_pk_add_f32 v[42:43], v[42:43], v[84:85]
    v_pk_add_f32 v[40:41], v[40:41], v[70:71]
    v_pk_add_f32 v[42:43], v[42:43], v[86:87]
    v_pk_add_f32 v[40:41], v[40:41], v[72:73]
    v_pk_add_f32 v[42:43], v[42:43], v[88:89]
    v_pk_add_f32 v[40:41], v[40:41], v[74:75]
    v_pk_add_f32 v[42:43], v[42:43], v[90:91]
    v_add_f32 v40, v40, v41
    v_add_f32 v42, v42, v43
    s_nop 1
    v_permlane32_swap_b32 v40, v42
    v_add_f32 v40, v40, v42
    v_rcp_f32 v40, v40
    s_nop 0
    v_mov_b32 v42, v40
    s_nop 1
    v_permlane32_swap_b32 v40, v42
    v_pk_mul_f32 v[60:61], v[60:61], v[40:41] op_sel_hi:[1,0]
    v_pk_mul_f32 v[62:63], v[62:63], v[40:41] op_sel_hi:[1,0]
    v_pk_mul_f32 v[64:65], v[64:65], v[40:41] op_sel_hi:[1,0]
    v_pk_mul_f32 v[66:67], v[66:67], v[40:41] op_sel_hi:[1,0]
    v_cvt_pk_bf16_f32 v160, v60, v61
    v_cvt_pk_bf16_f32 v161, v62, v63
    v_cvt_pk_bf16_f32 v162, v64, v65
    v_cvt_pk_bf16_f32 v163, v66, v67
    v_pk_mul_f32 v[68:69], v[68:69], v[40:41] op_sel_hi:[1,0]
    v_pk_mul_f32 v[70:71], v[70:71], v[40:41] op_sel_hi:[1,0]
    v_pk_mul_f32 v[72:73], v[72:73], v[40:41] op_sel_hi:[1,0]
    v_pk_mul_f32 v[74:75], v[74:75], v[40:41] op_sel_hi:[1,0]
    v_cvt_pk_bf16_f32 v166, v68, v69
    v_cvt_pk_bf16_f32 v167, v70, v71
    v_cvt_pk_bf16_f32 v164, v72, v73
    v_cvt_pk_bf16_f32 v165, v74, v75
    v_pk_mul_f32 v[76:77], v[76:77], v[42:43] op_sel_hi:[1,0]
    v_pk_mul_f32 v[78:79], v[78:79], v[42:43] op_sel_hi:[1,0]
    v_pk_mul_f32 v[80:81], v[80:81], v[42:43] op_sel_hi:[1,0]
    v_pk_mul_f32 v[82:83], v[82:83], v[42:43] op_sel_hi:[1,0]
    v_cvt_pk_bf16_f32 v168, v76, v77
    v_cvt_pk_bf16_f32 v169, v78, v79
    v_cvt_pk_bf16_f32 v170, v80, v81
    v_cvt_pk_bf16_f32 v171, v82, v83
    v_pk_mul_f32 v[84:85], v[84:85], v[42:43] op_sel_hi:[1,0]
    v_pk_mul_f32 v[86:87], v[86:87], v[42:43] op_sel_hi:[1,0]
    v_pk_mul_f32 v[88:89], v[88:89], v[42:43] op_sel_hi:[1,0]
    v_pk_mul_f32 v[90:91], v[90:91], v[42:43] op_sel_hi:[1,0]
    v_cvt_pk_bf16_f32 v174, v84, v85
    v_cvt_pk_bf16_f32 v175, v86, v87
    v_cvt_pk_bf16_f32 v172, v88, v89
    v_cvt_pk_bf16_f32 v173, v90, v91
    v_pk_fma_f32 v[60:61], v[240:241], v[48:49], v[36:37] op_sel:[0,0,1] op_sel_hi:[1,0,1]
    v_pk_fma_f32 v[62:63], v[242:243], v[48:49], v[36:37] op_sel:[0,0,1] op_sel_hi:[1,0,1]
    v_pk_fma_f32 v[64:65], v[244:245], v[48:49], v[36:37] op_sel:[0,0,1] op_sel_hi:[1,0,1]
    v_pk_fma_f32 v[66:67], v[246:247], v[48:49], v[36:37] op_sel:[0,0,1] op_sel_hi:[1,0,1]
    v_pk_fma_f32 v[68:69], v[248:249], v[48:49], v[36:37] op_sel:[0,0,1] op_sel_hi:[1,0,1]
    v_pk_fma_f32 v[70:71], v[250:251], v[48:49], v[36:37] op_sel:[0,0,1] op_sel_hi:[1,0,1]
    v_pk_fma_f32 v[72:73], v[252:253], v[48:49], v[36:37] op_sel:[0,0,1] op_sel_hi:[1,0,1]
    v_pk_fma_f32 v[74:75], v[254:255], v[48:49], v[36:37] op_sel:[0,0,1] op_sel_hi:[1,0,1]
    v_pk_fma_f32 v[76:77], v[240:241], v[48:49], v[38:39] op_sel:[0,0,1] op_sel_hi:[1,0,1] neg_lo:[1,0,0] neg_hi:[1,0,0]
    v_pk_fma_f32 v[78:79], v[242:243], v[48:49], v[38:39] op_sel:[0,0,1] op_sel_hi:[1,0,1] neg_lo:[1,0,0] neg_hi:[1,0,0]
    v_pk_fma_f32 v[80:81], v[244:245], v[48:49], v[38:39] op_sel:[0,0,1] op_sel_hi:[1,0,1] neg_lo:[1,0,0] neg_hi:[1,0,0]
    v_pk_fma_f32 v[82:83], v[246:247], v[48:49], v[38:39] op_sel:[0,0,1] op_sel_hi:[1,0,1] neg_lo:[1,0,0] neg_hi:[1,0,0]
    v_pk_fma_f32 v[84:85], v[248:249], v[48:49], v[38:39] op_sel:[0,0,1] op_sel_hi:[1,0,1] neg_lo:[1,0,0] neg_hi:[1,0,0]
    v_pk_fma_f32 v[86:87], v[250:251], v[48:49], v[38:39] op_sel:[0,0,1] op_sel_hi:[1,0,1] neg_lo:[1,0,0] neg_hi:[1,0,0]
    v_pk_fma_f32 v[88:89], v[252:253], v[48:49], v[38:39] op_sel:[0,0,1] op_sel_hi:[1,0,1] neg_lo:[1,0,0] neg_hi:[1,0,0]
    v_pk_fma_f32 v[90:91], v[254:255], v[48:49], v[38:39] op_sel:[0,0,1] op_sel_hi:[1,0,1] neg_lo:[1,0,0] neg_hi:[1,0,0]
    v_exp_f32 v60, v60
    v_exp_f32 v61, v61
    v_exp_f32 v62, v62
    v_exp_f32 v63, v63
    ds_write_b128 v116, v[192:195] offset:0
    v_exp_f32 v64, v64
    v_exp_f32 v65, v65
    v_exp_f32 v66, v66
    v_exp_f32 v67, v67
    ds_write_b128 v116, v[196:199] offset:2048
    v_exp_f32 v68, v68
    v_exp_f32 v69, v69
    v_exp_f32 v70, v70
    v_exp_f32 v71, v71
    ds_write_b128 v116, v[200:203] offset:4096
    v_exp_f32 v72, v72
    v_exp_f32 v73, v73
    v_exp_f32 v74, v74
    v_exp_f32 v75, v75
    ds_write_b128 v116, v[204:207] offset:6144
    v_exp_f32 v76, v76
    v_exp_f32 v77, v77
    v_exp_f32 v78, v78
    v_exp_f32 v79, v79
    ds_write_b128 v112, v[160:163] offset:0
    v_exp_f32 v80, v80
    v_exp_f32 v81, v81
    v_exp_f32 v82, v82
    v_exp_f32 v83, v83
    ds_write_b128 v113, v[164:167] offset:0
    v_exp_f32 v84, v84
    v_exp_f32 v85, v85
    v_exp_f32 v86, v86
    v_exp_f32 v87, v87
    ds_write_b128 v114, v[168:171] offset:0
    v_exp_f32 v88, v88
    v_exp_f32 v89, v89
    v_exp_f32 v90, v90
    v_exp_f32 v91, v91
    ds_write_b128 v115, v[172:175] offset:0
    v_pk_add_f32 v[40:41], v[60:61], v[62:63]
    v_pk_add_f32 v[42:43], v[76:77], v[78:79]
    v_pk_add_f32 v[40:41], v[40:41], v[64:65]
    v_pk_add_f32 v[42:43], v[42:43], v[80:81]
    v_pk_add_f32 v[40:41], v[40:41], v[66:67]
    v_pk_add_f32 v[42:43], v[42:43], v[82:83]
    v_pk_add_f32 v[40:41], v[40:41], v[68:69]
    v_pk_add_f32 v[42:43], v[42:43], v[84:85]
    v_pk_add_f32 v[40:41], v[40:41], v[70:71]
    v_pk_add_f32 v[42:43], v[42:43], v[86:87]
    v_pk_add_f32 v[40:41], v[40:41], v[72:73]
    v_pk_add_f32 v[42:43], v[42:43], v[88:89]
    v_pk_add_f32 v[40:41], v[40:41], v[74:75]
    v_pk_add_f32 v[42:43], v[42:43], v[90:91]
    v_add_f32 v40, v40, v41
    v_add_f32 v42, v42, v43
    s_nop 1
    v_permlane32_swap_b32 v40, v42
    v_add_f32 v40, v40, v42
    v_rcp_f32 v40, v40
    s_nop 0
    v_mov_b32 v42, v40
    s_nop 1
    v_permlane32_swap_b32 v40, v42
    v_pk_mul_f32 v[60:61], v[60:61], v[40:41] op_sel_hi:[1,0]
    v_pk_mul_f32 v[62:63], v[62:63], v[40:41] op_sel_hi:[1,0]
    v_pk_mul_f32 v[64:65], v[64:65], v[40:41] op_sel_hi:[1,0]
    v_pk_mul_f32 v[66:67], v[66:67], v[40:41] op_sel_hi:[1,0]
    v_cvt_pk_bf16_f32 v176, v60, v61
    v_cvt_pk_bf16_f32 v177, v62, v63
    v_cvt_pk_bf16_f32 v178, v64, v65
    v_cvt_pk_bf16_f32 v179, v66, v67
    ds_write_b128 v112, v[176:179] offset:4096
    v_pk_mul_f32 v[68:69], v[68:69], v[40:41] op_sel_hi:[1,0]
    v_pk_mul_f32 v[70:71], v[70:71], v[40:41] op_sel_hi:[1,0]
    v_pk_mul_f32 v[72:73], v[72:73], v[40:41] op_sel_hi:[1,0]
    v_pk_mul_f32 v[74:75], v[74:75], v[40:41] op_sel_hi:[1,0]
    v_cvt_pk_bf16_f32 v182, v68, v69
    v_cvt_pk_bf16_f32 v183, v70, v71
    v_cvt_pk_bf16_f32 v180, v72, v73
    v_cvt_pk_bf16_f32 v181, v74, v75
    ds_write_b128 v113, v[180:183] offset:4096
    v_pk_mul_f32 v[76:77], v[76:77], v[42:43] op_sel_hi:[1,0]
    v_pk_mul_f32 v[78:79], v[78:79], v[42:43] op_sel_hi:[1,0]
    v_pk_mul_f32 v[80:81], v[80:81], v[42:43] op_sel_hi:[1,0]
    v_pk_mul_f32 v[82:83], v[82:83], v[42:43] op_sel_hi:[1,0]
    v_cvt_pk_bf16_f32 v184, v76, v77
    v_cvt_pk_bf16_f32 v185, v78, v79
    v_cvt_pk_bf16_f32 v186, v80, v81
    v_cvt_pk_bf16_f32 v187, v82, v83
    ds_write_b128 v114, v[184:187] offset:4096
    v_pk_mul_f32 v[84:85], v[84:85], v[42:43] op_sel_hi:[1,0]
    v_pk_mul_f32 v[86:87], v[86:87], v[42:43] op_sel_hi:[1,0]
    v_pk_mul_f32 v[88:89], v[88:89], v[42:43] op_sel_hi:[1,0]
    v_pk_mul_f32 v[90:91], v[90:91], v[42:43] op_sel_hi:[1,0]
    v_cvt_pk_bf16_f32 v190, v84, v85
    v_cvt_pk_bf16_f32 v191, v86, v87
    v_cvt_pk_bf16_f32 v188, v88, v89
    v_cvt_pk_bf16_f32 v189, v90, v91
L_pad7:
    s_cbranch_execz L_padret
    ds_write_b128 v115, v[188:191] offset:4096
    s_waitcnt lgkmcnt(0)
    s_barrier
    s_setprio 0
    v_mfma_f32_16x16x16_bf16 v[128:131], v[16:17], v[104:105], v[128:131]
    v_mfma_f32_16x16x16_bf16 v[144:147], v[18:19], v[104:105], v[144:147]
    v_mfma_f32_16x16x16_bf16 v[132:135], v[16:17], v[106:107], v[132:135]
    v_mfma_f32_16x16x16_bf16 v[148:151], v[18:19], v[106:107], v[148:151]
    v_mfma_f32_16x16x16_bf16 v[136:139], v[16:17], v[108:109], v[136:139]
    v_mfma_f32_16x16x16_bf16 v[152:155], v[18:19], v[108:109], v[152:155]
    v_mfma_f32_16x16x16_bf16 v[140:143], v[16:17], v[110:111], v[140:143]
    v_mfma_f32_16x16x16_bf16 v[156:159], v[18:19], v[110:111], v[156:159]
    v_lshrrev_b32 v11, 5, v2
    s_lshl_b32 s78, s81, 7
    s_add_u32 s78, s78, 162944
    v_lshl_add_u32 v10, v11, 4, s78
    v_and_b32 v13, 1, v2
    v_cmp_eq_u32 vcc, 1, v13
    v_mov_b32 v13, 162816
    v_and_b32 v12, 31, v2
    v_cndmask_b32 v10, v10, v13, vcc
    v_lshlrev_b32_e64 v12, 4, v12
    v_lshl_add_u32 v11, v11, 10, v12
    v_lshlrev_b32_e64 v14, 4, v2
    v_cvt_pk_bf16_f32 v128, v128, v129
    v_cvt_pk_bf16_f32 v129, v130, v131
    v_cvt_pk_bf16_f32 v130, v144, v145
    v_cvt_pk_bf16_f32 v131, v146, v147
    v_cvt_pk_bf16_f32 v132, v132, v133
    v_cvt_pk_bf16_f32 v133, v134, v135
    v_cvt_pk_bf16_f32 v134, v148, v149
    v_cvt_pk_bf16_f32 v135, v150, v151
    v_cvt_pk_bf16_f32 v136, v136, v137
    v_cvt_pk_bf16_f32 v137, v138, v139
    v_cvt_pk_bf16_f32 v138, v152, v153
    v_cvt_pk_bf16_f32 v139, v154, v155
    v_cvt_pk_bf16_f32 v140, v140, v141
    v_cvt_pk_bf16_f32 v141, v142, v143
    v_cvt_pk_bf16_f32 v142, v156, v157
    v_cvt_pk_bf16_f32 v143, v158, v159
    v_permlane16_swap_b32 v128, v132
    v_permlane16_swap_b32 v129, v133
    v_permlane16_swap_b32 v130, v134
    v_permlane16_swap_b32 v131, v135
    v_permlane16_swap_b32 v136, v140
    v_permlane16_swap_b32 v137, v141
    v_permlane16_swap_b32 v138, v142
    v_permlane16_swap_b32 v139, v143
    v_mfma_f32_32x32x16_bf16 v[224:239], v[96:99], v[128:131], 0
    v_mfma_f32_32x32x16_bf16 v[224:239], v[100:103], v[132:135], v[224:239]
    v_mfma_f32_32x32x16_bf16 v[240:255], v[96:99], v[136:139], 0
    v_mfma_f32_32x32x16_bf16 v[240:255], v[100:103], v[140:143], v[240:255]
    s_lshl_b32 s94, s70, 14
    s_lshl_b32 s79, s81, 13
    s_add_u32 s94, s94, s79
    s_add_u32 s94, s94, 8388608
    s_add_u32 s95, s94, 4096
    s_lshl_b32 s78, s69, 1
    s_add_u32 s78, s78, s80
    s_lshl_b32 s78, s78, 6
    s_lshl_b32 s79, s70, 1
    s_add_u32 s78, s78, s79
    s_add_u32 s78, s78, s81
    s_lshl_b32 s78, s78, 11
    s_add_u32 s96, s78, 4194304
    s_add_u32 s97, s96, 65536
    v_max3_f32 v36, v224, v225, v226
    v_max3_f32 v38, -v224, -v225, -v226
    v_max3_f32 v36, v36, v227, v228
    v_max3_f32 v38, v38, -v227, -v228
    v_max3_f32 v36, v36, v229, v230
    v_max3_f32 v38, v38, -v229, -v230
    v_max3_f32 v36, v36, v231, v232
    v_max3_f32 v38, v38, -v231, -v232
    v_max3_f32 v36, v36, v233, v234
    v_max3_f32 v38, v38, -v233, -v234
    v_max3_f32 v36, v36, v235, v236
    v_max3_f32 v38, v38, -v235, -v236
    v_max3_f32 v36, v36, v237, v238
    v_max3_f32 v38, v38, -v237, -v238
    v_max_f32_e64 v36, v36, v239
    v_max_f32 v38, v38, -v239
    v_max3_f32 v37, v240, v241, v242
    v_max3_f32 v39, -v240, -v241, -v242
    v_max3_f32 v37, v37, v243, v244
    v_max3_f32 v39, v39, -v243, -v244
    v_max3_f32 v37, v37, v245, v246
    v_max3_f32 v39, v39, -v245, -v246
    v_max3_f32 v37, v37, v247, v248
    v_max3_f32 v39, v39, -v247, -v248
    v_max3_f32 v37, v37, v249, v250
    v_max3_f32 v39, v39, -v249, -v250
    v_max3_f32 v37, v37, v251, v252
    v_max3_f32 v39, v39, -v251, -v252
    v_max3_f32 v37, v37, v253, v254
    v_max3_f32 v39, v39, -v253, -v254
    v_max_f32_e64 v37, v37, v255
    v_max_f32 v39, v39, -v255
    v_permlane32_swap_b32 v36, v38
    s_nop 0
    v_permlane32_swap_b32 v37, v39
    v_max_f32 v36, v36, v38
    v_max_f32_e64 v37, v37, v39
    v_mul_f32 v36, -v36, v34
    v_mul_f32 v37, -v37, v48
    v_mov_b32 v38, v36
    v_mov_b32 v39, v37
    s_nop 0
    v_permlane32_swap_b32 v36, v38
    v_permlane32_swap_b32_e64 v37, v39
    v_pk_fma_f32 v[60:61], v[224:225], v[34:35], v[36:37] op_sel_hi:[1,0,0]
    v_pk_fma_f32 v[62:63], v[226:227], v[34:35], v[36:37] op_sel_hi:[1,0,0]
    v_pk_fma_f32 v[64:65], v[228:229], v[34:35], v[36:37] op_sel_hi:[1,0,0]
    v_pk_fma_f32 v[66:67], v[230:231], v[34:35], v[36:37] op_sel_hi:[1,0,0]
    v_pk_fma_f32 v[68:69], v[232:233], v[34:35], v[36:37] op_sel_hi:[1,0,0]
    v_pk_fma_f32 v[70:71], v[234:235], v[34:35], v[36:37] op_sel_hi:[1,0,0]
    v_pk_fma_f32 v[72:73], v[236:237], v[34:35], v[36:37] op_sel_hi:[1,0,0]
    v_pk_fma_f32 v[74:75], v[238:239], v[34:35], v[36:37] op_sel_hi:[1,0,0]
    v_pk_fma_f32 v[76:77], v[224:225], v[34:35], v[38:39] op_sel_hi:[1,0,0] neg_lo:[1,0,0] neg_hi:[1,0,0]
    v_pk_fma_f32 v[78:79], v[226:227], v[34:35], v[38:39] op_sel_hi:[1,0,0] neg_lo:[1,0,0] neg_hi:[1,0,0]
    v_pk_fma_f32 v[80:81], v[228:229], v[34:35], v[38:39] op_sel_hi:[1,0,0] neg_lo:[1,0,0] neg_hi:[1,0,0]
    v_pk_fma_f32 v[82:83], v[230:231], v[34:35], v[38:39] op_sel_hi:[1,0,0] neg_lo:[1,0,0] neg_hi:[1,0,0]
    v_pk_fma_f32 v[84:85], v[232:233], v[34:35], v[38:39] op_sel_hi:[1,0,0] neg_lo:[1,0,0] neg_hi:[1,0,0]
    v_pk_fma_f32 v[86:87], v[234:235], v[34:35], v[38:39] op_sel_hi:[1,0,0] neg_lo:[1,0,0] neg_hi:[1,0,0]
    v_pk_fma_f32 v[88:89], v[236:237], v[34:35], v[38:39] op_sel_hi:[1,0,0] neg_lo:[1,0,0] neg_hi:[1,0,0]
    v_pk_fma_f32 v[90:91], v[238:239], v[34:35], v[38:39] op_sel_hi:[1,0,0] neg_lo:[1,0,0] neg_hi:[1,0,0]
    v_exp_f32 v60, v60
    v_exp_f32 v61, v61
    v_exp_f32 v62, v62
    v_exp_f32 v63, v63
    v_exp_f32 v64, v64
    v_exp_f32 v65, v65
    v_exp_f32 v66, v66
    v_exp_f32 v67, v67
    v_exp_f32 v68, v68
    v_exp_f32 v69, v69
    v_exp_f32 v70, v70
    v_exp_f32 v71, v71
    v_exp_f32 v72, v72
    v_exp_f32 v73, v73
    v_exp_f32 v74, v74
    v_exp_f32 v75, v75
    v_exp_f32 v76, v76
    v_exp_f32 v77, v77
    v_exp_f32 v78, v78
    v_exp_f32 v79, v79
    v_exp_f32 v80, v80
    v_exp_f32 v81, v81
    v_exp_f32 v82, v82
    v_exp_f32 v83, v83
    v_exp_f32 v84, v84
    v_exp_f32 v85, v85
    v_exp_f32 v86, v86
    v_exp_f32 v87, v87
    v_exp_f32 v88, v88
    v_exp_f32 v89, v89
    v_exp_f32 v90, v90
    v_exp_f32 v91, v91
    v_cvt_pk_bf16_f32 v160, v60, v61
    v_cvt_pk_bf16_f32 v161, v62, v63
    v_cvt_pk_bf16_f32 v162, v64, v65
    v_cvt_pk_bf16_f32 v163, v66, v67
    v_cvt_pk_bf16_f32 v164, v68, v69
    v_cvt_pk_bf16_f32 v165, v70, v71
    v_cvt_pk_bf16_f32 v166, v72, v73
    v_cvt_pk_bf16_f32 v167, v74, v75
    v_cvt_pk_bf16_f32 v168, v76, v77
    v_cvt_pk_bf16_f32 v169, v78, v79
    v_cvt_pk_bf16_f32 v170, v80, v81
    v_cvt_pk_bf16_f32 v171, v82, v83
    v_cvt_pk_bf16_f32 v172, v84, v85
    v_cvt_pk_bf16_f32 v173, v86, v87
    v_cvt_pk_bf16_f32 v174, v88, v89
    v_cvt_pk_bf16_f32 v175, v90, v91
    v_pk_fma_f32 v[60:61], v[240:241], v[48:49], v[36:37] op_sel:[0,0,1] op_sel_hi:[1,0,1]
    v_pk_fma_f32 v[62:63], v[242:243], v[48:49], v[36:37] op_sel:[0,0,1] op_sel_hi:[1,0,1]
    v_pk_fma_f32 v[64:65], v[244:245], v[48:49], v[36:37] op_sel:[0,0,1] op_sel_hi:[1,0,1]
    v_pk_fma_f32 v[66:67], v[246:247], v[48:49], v[36:37] op_sel:[0,0,1] op_sel_hi:[1,0,1]
    v_pk_fma_f32 v[68:69], v[248:249], v[48:49], v[36:37] op_sel:[0,0,1] op_sel_hi:[1,0,1]
    v_pk_fma_f32 v[70:71], v[250:251], v[48:49], v[36:37] op_sel:[0,0,1] op_sel_hi:[1,0,1]
    v_pk_fma_f32 v[72:73], v[252:253], v[48:49], v[36:37] op_sel:[0,0,1] op_sel_hi:[1,0,1]
    v_pk_fma_f32 v[74:75], v[254:255], v[48:49], v[36:37] op_sel:[0,0,1] op_sel_hi:[1,0,1]
    v_pk_fma_f32 v[76:77], v[240:241], v[48:49], v[38:39] op_sel:[0,0,1] op_sel_hi:[1,0,1] neg_lo:[1,0,0] neg_hi:[1,0,0]
    v_pk_fma_f32 v[78:79], v[242:243], v[48:49], v[38:39] op_sel:[0,0,1] op_sel_hi:[1,0,1] neg_lo:[1,0,0] neg_hi:[1,0,0]
    v_pk_fma_f32 v[80:81], v[244:245], v[48:49], v[38:39] op_sel:[0,0,1] op_sel_hi:[1,0,1] neg_lo:[1,0,0] neg_hi:[1,0,0]
    v_pk_fma_f32 v[82:83], v[246:247], v[48:49], v[38:39] op_sel:[0,0,1] op_sel_hi:[1,0,1] neg_lo:[1,0,0] neg_hi:[1,0,0]
    v_pk_fma_f32 v[84:85], v[248:249], v[48:49], v[38:39] op_sel:[0,0,1] op_sel_hi:[1,0,1] neg_lo:[1,0,0] neg_hi:[1,0,0]
    v_pk_fma_f32 v[86:87], v[250:251], v[48:49], v[38:39] op_sel:[0,0,1] op_sel_hi:[1,0,1] neg_lo:[1,0,0] neg_hi:[1,0,0]
    v_pk_fma_f32 v[88:89], v[252:253], v[48:49], v[38:39] op_sel:[0,0,1] op_sel_hi:[1,0,1] neg_lo:[1,0,0] neg_hi:[1,0,0]
    v_pk_fma_f32 v[90:91], v[254:255], v[48:49], v[38:39] op_sel:[0,0,1] op_sel_hi:[1,0,1] neg_lo:[1,0,0] neg_hi:[1,0,0]
    v_exp_f32 v60, v60
    v_exp_f32 v61, v61
    v_exp_f32 v62, v62
    v_exp_f32 v63, v63
    v_exp_f32 v64, v64
    v_exp_f32 v65, v65
    v_exp_f32 v66, v66
    v_exp_f32 v67, v67
    v_exp_f32 v68, v68
    v_exp_f32 v69, v69
    v_exp_f32 v70, v70
    v_exp_f32 v71, v71
    v_exp_f32 v72, v72
    v_exp_f32 v73, v73
    v_exp_f32 v74, v74
    v_exp_f32 v75, v75
    v_exp_f32 v76, v76
    v_exp_f32 v77, v77
    v_exp_f32 v78, v78
    v_exp_f32 v79, v79
    v_exp_f32 v80, v80
    v_exp_f32 v81, v81
    v_exp_f32 v82, v82
    v_exp_f32 v83, v83
    v_exp_f32 v84, v84
    v_exp_f32 v85, v85
    v_exp_f32 v86, v86
    v_exp_f32 v87, v87
    v_exp_f32 v88, v88
    v_exp_f32 v89, v89
    v_exp_f32 v90, v90
    v_exp_f32 v91, v91
    v_cvt_pk_bf16_f32 v176, v60, v61
    v_cvt_pk_bf16_f32 v177, v62, v63
    v_cvt_pk_bf16_f32 v178, v64, v65
    v_cvt_pk_bf16_f32 v179, v66, v67
    v_cvt_pk_bf16_f32 v180, v68, v69
    v_cvt_pk_bf16_f32 v181, v70, v71
    v_cvt_pk_bf16_f32 v182, v72, v73
    v_cvt_pk_bf16_f32 v183, v74, v75
    v_cvt_pk_bf16_f32 v184, v76, v77
    v_cvt_pk_bf16_f32 v185, v78, v79
    v_cvt_pk_bf16_f32 v186, v80, v81
    v_cvt_pk_bf16_f32 v187, v82, v83
    v_cvt_pk_bf16_f32 v188, v84, v85
    v_cvt_pk_bf16_f32 v189, v86, v87
    v_cvt_pk_bf16_f32 v190, v88, v89
    v_cvt_pk_bf16_f32 v191, v90, v91
    s_barrier
    s_setprio 1
    ds_read_b128 v[16:19], v10 offset:0
    ds_read_b128 v[20:23], v10 offset:32
    ds_read_b128 v[24:27], v10 offset:64
    ds_read_b128 v[28:31], v10 offset:96
    s_waitcnt lgkmcnt(3)
    v_mfma_f32_32x32x16_bf16 v[224:239], v[16:19], v[160:163], 0
    s_waitcnt lgkmcnt(2)
    v_mfma_f32_32x32x16_bf16 v[224:239], v[20:23], v[164:167], v[224:239]
    buffer_load_dwordx4 v[96:99], v11, s[36:39], s94 offen offset:0 sc1
    buffer_load_dwordx4 v[100:103], v11, s[36:39], s94 offen offset:2048 sc1
    buffer_load_dwordx4 v[104:107], v11, s[36:39], s95 offen offset:0 sc1
    buffer_load_dwordx4 v[108:111], v11, s[36:39], s95 offen offset:2048 sc1
    s_waitcnt lgkmcnt(1)
    v_mfma_f32_32x32x16_bf16 v[240:255], v[24:27], v[168:171], 0
    s_waitcnt lgkmcnt(0)
    v_mfma_f32_32x32x16_bf16 v[240:255], v[28:31], v[172:175], v[240:255]
    v_mfma_f32_32x32x16_bf16 v[192:207], v[16:19], v[176:179], 0
    v_mfma_f32_32x32x16_bf16 v[192:207], v[20:23], v[180:183], v[192:207]
    v_mfma_f32_32x32x16_bf16 v[208:223], v[24:27], v[184:187], 0
    v_mfma_f32_32x32x16_bf16 v[208:223], v[28:31], v[188:191], v[208:223]
    s_mov_b32 s85, 0
    s_branch L_kvchk
L_kvspin:
    s_add_u32 s85, s85, 1
    s_cmp_gt_u32 s85, 400000
    s_cbranch_scc1 L_end
    buffer_load_dwordx4 v[96:99], v11, s[36:39], s94 offen offset:0 sc1
    buffer_load_dwordx4 v[100:103], v11, s[36:39], s94 offen offset:2048 sc1
    buffer_load_dwordx4 v[104:107], v11, s[36:39], s95 offen offset:0 sc1
    buffer_load_dwordx4 v[108:111], v11, s[36:39], s95 offen offset:2048 sc1
L_kvchk:
    s_waitcnt vmcnt(0)
    s_nop 0
    v_mfma_f32_32x32x16_bf16 v[60:75], v[96:99], v[160:163], 0
    v_max3_u32 v13, v96, v97, v98
    v_max3_u32 v10, v99, v100, v101
    v_max3_u32 v13, v13, v102, v103
    v_max3_u32 v10, v10, v104, v105
    v_max3_u32 v13, v13, v106, v107
    v_mfma_f32_32x32x16_bf16 v[60:75], v[100:103], v[164:167], v[60:75]
    v_max3_u32 v10, v10, v108, v109
    v_max3_u32 v13, v13, v110, v111
    v_max_u32 v13, v13, v10
    v_cmp_eq_u32_e64 vcc, -1, v13
    s_cbranch_vccnz L_kvspin
    v_mfma_f32_32x32x16_bf16 v[76:91], v[104:107], v[168:171], 0
    v_rcp_f32 v36, v225
    v_rcp_f32 v40, v193
    v_rcp_f32 v38, v241
    v_rcp_f32 v42, v209
    v_mfma_f32_32x32x16_bf16 v[76:91], v[108:111], v[172:175], v[76:91]
    v_mov_b32 v44, 0x358637bd
    v_mov_b32 v45, 0x358637bd
    v_fmac_f32 v44, v224, v36
    v_fmac_f32 v45, v192, v40
    v_fmac_f32 v44, v240, v38
    v_fmac_f32 v45, v208, v42
    v_mfma_f32_32x32x16_bf16 v[128:143], v[96:99], v[176:179], 0
    v_rcp_f32 v44, v44
    v_rcp_f32 v45, v45
    v_mul_f32 v36, v36, v44
    v_mul_f32 v40, v40, v45
    v_mfma_f32_32x32x16_bf16 v[128:143], v[100:103], v[180:183], v[128:143]
    v_mul_f32 v38, v38, v44
    v_mul_f32 v42, v42, v45
    v_mul_f32 v60, v60, v36
    v_mul_f32 v61, v61, v36
    v_mul_f32 v62, v62, v36
    v_mul_f32 v63, v63, v36
    v_mfma_f32_32x32x16_bf16 v[144:159], v[104:107], v[184:187], 0
    v_mul_f32 v64, v64, v36
    v_mul_f32 v65, v65, v36
    v_mul_f32 v66, v66, v36
    v_mul_f32 v67, v67, v36
    v_mul_f32 v68, v68, v36
    v_mul_f32 v69, v69, v36
    v_mfma_f32_32x32x16_bf16 v[144:159], v[108:111], v[188:191], v[144:159]
    v_mul_f32 v70, v70, v36
    v_mul_f32 v71, v71, v36
    v_mul_f32 v72, v72, v36
    v_mul_f32 v73, v73, v36
    v_mul_f32 v74, v74, v36
    v_mul_f32 v75, v75, v36
    v_pk_fma_f32 v[60:61], v[76:77], v[38:39], v[60:61] op_sel_hi:[1,0,1]
    v_pk_fma_f32 v[62:63], v[78:79], v[38:39], v[62:63] op_sel_hi:[1,0,1]
    v_pk_fma_f32 v[64:65], v[80:81], v[38:39], v[64:65] op_sel_hi:[1,0,1]
    v_pk_fma_f32 v[66:67], v[82:83], v[38:39], v[66:67] op_sel_hi:[1,0,1]
    v_cvt_pk_bf16_f32 v16, v60, v61
    v_cvt_pk_bf16_f32 v17, v62, v63
L_pad8:
    s_cbranch_execz L_padret
    s_nop 0
    v_cvt_pk_bf16_f32 v18, v64, v65
    v_cvt_pk_bf16_f32 v19, v66, v67
    buffer_store_dwordx4 v[16:19], v14, s[36:39], s96 offen offset:0 sc1
    v_pk_fma_f32 v[68:69], v[84:85], v[38:39], v[68:69] op_sel_hi:[1,0,1]
    v_pk_fma_f32 v[70:71], v[86:87], v[38:39], v[70:71] op_sel_hi:[1,0,1]
    v_pk_fma_f32 v[72:73], v[88:89], v[38:39], v[72:73] op_sel_hi:[1,0,1]
    v_pk_fma_f32 v[74:75], v[90:91], v[38:39], v[74:75] op_sel_hi:[1,0,1]
    v_cvt_pk_bf16_f32 v20, v68, v69
    v_cvt_pk_bf16_f32 v21, v70, v71
    v_cvt_pk_bf16_f32 v22, v72, v73
    v_cvt_pk_bf16_f32 v23, v74, v75
    buffer_store_dwordx4 v[20:23], v14, s[36:39], s96 offen offset:1024 sc1
    v_pk_mul_f32 v[128:129], v[128:129], v[40:41] op_sel_hi:[1,0]
    v_pk_mul_f32 v[130:131], v[130:131], v[40:41] op_sel_hi:[1,0]
    v_pk_mul_f32 v[132:133], v[132:133], v[40:41] op_sel_hi:[1,0]
    v_pk_mul_f32 v[134:135], v[134:135], v[40:41] op_sel_hi:[1,0]
    v_pk_fma_f32 v[128:129], v[144:145], v[42:43], v[128:129] op_sel_hi:[1,0,1]
    v_pk_fma_f32 v[130:131], v[146:147], v[42:43], v[130:131] op_sel_hi:[1,0,1]
    v_pk_fma_f32 v[132:133], v[148:149], v[42:43], v[132:133] op_sel_hi:[1,0,1]
    v_pk_fma_f32 v[134:135], v[150:151], v[42:43], v[134:135] op_sel_hi:[1,0,1]
    v_cvt_pk_bf16_f32 v24, v128, v129
    v_cvt_pk_bf16_f32 v25, v130, v131
    v_cvt_pk_bf16_f32 v26, v132, v133
    v_cvt_pk_bf16_f32 v27, v134, v135
    buffer_store_dwordx4 v[24:27], v14, s[36:39], s97 offen offset:0 sc1
    v_pk_mul_f32 v[136:137], v[136:137], v[40:41] op_sel_hi:[1,0]
    v_pk_mul_f32 v[138:139], v[138:139], v[40:41] op_sel_hi:[1,0]
    v_pk_mul_f32 v[140:141], v[140:141], v[40:41] op_sel_hi:[1,0]
    v_pk_mul_f32 v[142:143], v[142:143], v[40:41] op_sel_hi:[1,0]
    v_pk_fma_f32 v[136:137], v[152:153], v[42:43], v[136:137] op_sel_hi:[1,0,1]
    v_pk_fma_f32 v[138:139], v[154:155], v[42:43], v[138:139] op_sel_hi:[1,0,1]
    v_pk_fma_f32 v[140:141], v[156:157], v[42:43], v[140:141] op_sel_hi:[1,0,1]
    v_pk_fma_f32 v[142:143], v[158:159], v[42:43], v[142:143] op_sel_hi:[1,0,1]
    v_cvt_pk_bf16_f32 v28, v136, v137
    v_cvt_pk_bf16_f32 v29, v138, v139
    v_cvt_pk_bf16_f32 v30, v140, v141
    v_cvt_pk_bf16_f32 v31, v142, v143
    buffer_store_dwordx4 v[28:31], v14, s[36:39], s97 offen offset:1024 sc1
    v_and_b32 v8, 31, v2
    v_lshrrev_b32 v9, 5, v2
    v_lshlrev_b32 v10, 3, v9
    s_lshl_b32 s78, s72, 7
    buffer_load_dwordx2 v[32:33], v10, s[64:67], s78 offen offset:0
    buffer_load_dwordx2 v[34:35], v10, s[64:67], s78 offen offset:16
    buffer_load_dwordx2 v[36:37], v10, s[64:67], s78 offen offset:32
    buffer_load_dwordx2 v[38:39], v10, s[64:67], s78 offen offset:48
    buffer_load_dwordx2 v[40:41], v10, s[64:67], s78 offen offset:64
    buffer_load_dwordx2 v[42:43], v10, s[64:67], s78 offen offset:80
    buffer_load_dwordx2 v[44:45], v10, s[64:67], s78 offen offset:96
    buffer_load_dwordx2 v[46:47], v10, s[64:67], s78 offen offset:112
    buffer_load_dwordx4 v[48:51], v14, s[64:67], 0 offen
    buffer_load_dwordx4 v[52:55], v14, s[64:67], 0 offen offset:1024
    s_barrier
    s_lshl_b32 s78, s76, 12
    s_add_u32 s78, s78, 131072
    v_lshl_add_u32 v6, v8, 7, s78
    v_add_u32_e64 v6, v6, v10
    v_bfe_u32 v11, v8, 1, 3
    v_lshl_add_u32 v6, v11, 4, v6
    v_xor_b32 v112, 0, v6
    v_xor_b32 v113, 16, v6
    v_xor_b32 v114, 32, v6
    v_xor_b32 v115, 48, v6
    v_xor_b32_e64 v116, 64, v6
    v_xor_b32 v117, 80, v6
    v_xor_b32 v118, 96, v6
    v_xor_b32 v119, 112, v6
    v_bfe_u32 v11, v2, 2, 2
    v_lshl_add_u32 v12, v9, 2, v11
    v_lshlrev_b32 v12, 7, v12
    v_lshrrev_b32 v11, 1, v11
    v_lshl_add_u32 v12, v11, 6, v12
    v_bfe_u32 v11, v2, 4, 1
    v_lshl_add_u32 v12, v11, 5, v12
    v_and_b32_e64 v11, 3, v2
    v_lshl_add_u32 v12, v11, 3, v12
    s_lshl_b32 s82, s72, 0
    s_and_b32 s82, s82, 15
    s_lshl_b32 s78, s82, 13
    v_add_u32 v4, s78, v12
    v_xor_b32 v5, 64, v4
    s_lshl_b32 s83, s71, 2
    s_add_u32 s83, s83, s76
    s_lshl_b32 s83, s83, 16
    s_add_u32 s83, s83, 4194304
    s_lshl_b32 s82, s82, 12
    s_add_u32 s88, s82, s83
    v_lshlrev_b32_e64 v12, 4, v8
    v_lshl_add_u32 v12, v9, 14, v12
    s_lshl_b32 s94, s71, 15
    s_lshl_b32 s79, s76, 9
    s_add_u32 s94, s94, s79
    s_add_u32 s94, s94, 1572864
    s_lshl_b32 s95, s72, 11
    s_add_u32 s95, s95, s94
    s_lshl_b32 s78, s76, 5
    v_add_u32 v11, s78, v8
    v_and_b32 v13, 7, v8
    v_xor_b32 v13, v13, v9
    v_lshlrev_b32 v13, 4, v13
    v_lshl_add_u32 v13, v11, 8, v13
    v_lshlrev_b32_e64 v10, 3, v11
    v_add_u32 v10, 159744, v10
    s_lshl_b32 s78, s71, 7
    v_add_u32 v11, s78, v11
    s_waitcnt vmcnt(0)
    s_barrier
    ds_read_b64 v[96:97], v112
    ds_read_b64 v[98:99], v113
    ds_read_b64 v[100:101], v114
    ds_read_b64 v[102:103], v115
    ds_read_b64 v[104:105], v116
    ds_read_b64 v[106:107], v117
    ds_read_b64 v[108:109], v118
    ds_read_b64 v[110:111], v119
    v_lshlrev_b32_e64 v60, 16, v32
    v_and_b32 v61, 0xffff0000, v32
    v_lshlrev_b32_e64 v62, 16, v33
    v_and_b32 v63, 0xffff0000, v33
    v_lshlrev_b32_e64 v64, 16, v34
    v_and_b32 v65, 0xffff0000, v34
    v_lshlrev_b32_e64 v66, 16, v35
    v_and_b32 v67, 0xffff0000, v35
    v_lshlrev_b32_e64 v68, 16, v36
    v_and_b32 v69, 0xffff0000, v36
    v_lshlrev_b32_e64 v70, 16, v37
    v_and_b32 v71, 0xffff0000, v37
    v_lshlrev_b32_e64 v72, 16, v38
    v_and_b32 v73, 0xffff0000, v38
    v_lshlrev_b32_e64 v74, 16, v39
    v_and_b32 v75, 0xffff0000, v39
    v_lshlrev_b32_e64 v76, 16, v40
    v_and_b32 v77, 0xffff0000, v40
    v_lshlrev_b32_e64 v78, 16, v41
    v_and_b32 v79, 0xffff0000, v41
    v_lshlrev_b32_e64 v80, 16, v42
    v_and_b32 v81, 0xffff0000, v42
    v_lshlrev_b32_e64 v82, 16, v43
    v_and_b32 v83, 0xffff0000, v43
    v_lshlrev_b32_e64 v84, 16, v44
    v_and_b32 v85, 0xffff0000, v44
    v_lshlrev_b32_e64 v86, 16, v45
    v_and_b32 v87, 0xffff0000, v45
    v_lshlrev_b32_e64 v88, 16, v46
    v_and_b32 v89, 0xffff0000, v46
    v_lshlrev_b32_e64 v90, 16, v47
    v_and_b32 v91, 0xffff0000, v47
    s_mov_b32 s78, 0x3f803f80
    v_dot2_f32_bf16 v126, v48, s78, 0
    v_dot2_f32_bf16 v126, v49, s78, v126
    v_dot2_f32_bf16 v126, v50, s78, v126
    v_dot2_f32_bf16 v126, v51, s78, v126
    v_dot2_f32_bf16 v126, v52, s78, v126
    v_dot2_f32_bf16 v126, v53, s78, v126
    v_dot2_f32_bf16 v126, v54, s78, v126
    v_dot2_f32_bf16 v126, v55, s78, v126
    s_nop 2
    v_add_f32_dpp v126, v126, v126 row_ror:8 row_mask:0xf bank_mask:0xf
    s_nop 1
    v_add_f32_dpp v126, v126, v126 row_ror:4 row_mask:0xf bank_mask:0xf
    s_nop 1
    v_add_f32_dpp v126, v126, v126 row_ror:2 row_mask:0xf bank_mask:0xf
    s_nop 1
    v_add_f32_dpp v126, v126, v126 row_ror:1 row_mask:0xf bank_mask:0xf
    v_mov_b32 v127, v126
    s_nop 1
    v_permlane32_swap_b32 v126, v127
    v_add_f32 v126, v126, v127
    v_mov_b32 v127, v126
    s_nop 1
    v_permlane16_swap_b32 v126, v127
    v_add_f32 v126, v126, v127
    v_mov_b32 v44, 163328
    v_mov_b32_e64 v45, 1
    v_mov_b32 v46, 0xff800000
    v_mov_b32_e64 v47, 0
    ds_write_b64 v44, v[46:47]
    s_lshl_b32 s96, s71, 4
    s_add_u32 s96, s96, s72
    s_lshl_b32 s96, s96, 9
    s_add_u32 s96, s96, 524288
    v_mov_b32 v15, 163584
    ds_read_b32 v15, v15
    s_waitcnt lgkmcnt(0)
    v_readfirstlane_b32 s99, v15
    v_lshlrev_b32 v224, 16, v96
    v_and_b32 v225, 0xffff0000, v96
    v_lshlrev_b32_e64 v226, 16, v97
    v_and_b32 v227, 0xffff0000, v97
    v_lshlrev_b32_e64 v228, 16, v98
    v_and_b32 v229, 0xffff0000, v98
    v_lshlrev_b32_e64 v230, 16, v99
    v_and_b32 v231, 0xffff0000, v99
    v_lshlrev_b32_e64 v232, 16, v100
    v_and_b32 v233, 0xffff0000, v100
    v_lshlrev_b32_e64 v234, 16, v101
    v_and_b32 v235, 0xffff0000, v101
    v_lshlrev_b32_e64 v236, 16, v102
    v_and_b32 v237, 0xffff0000, v102
    v_lshlrev_b32_e64 v238, 16, v103
    v_and_b32 v239, 0xffff0000, v103
    v_lshlrev_b32_e64 v240, 16, v104
    v_and_b32 v241, 0xffff0000, v104
    v_lshlrev_b32_e64 v242, 16, v105
    v_and_b32 v243, 0xffff0000, v105
    v_lshlrev_b32_e64 v244, 16, v106
    v_and_b32 v245, 0xffff0000, v106
    v_lshlrev_b32_e64 v246, 16, v107
    v_and_b32 v247, 0xffff0000, v107
    v_lshlrev_b32_e64 v248, 16, v108
    v_and_b32 v249, 0xffff0000, v108
    v_lshlrev_b32_e64 v250, 16, v109
    v_and_b32 v251, 0xffff0000, v109
    v_lshlrev_b32_e64 v252, 16, v110
    v_and_b32 v253, 0xffff0000, v110
    v_lshlrev_b32_e64 v254, 16, v111
    v_and_b32 v255, 0xffff0000, v111
    s_mov_b32 s84, 0
    s_barrier
    buffer_load_dwordx4 v[160:163], v14, s[36:39], s88 offen offset:0 sc1
    ds_read_b64_tr_b16 v[128:129], v4 offset:0
    buffer_load_dwordx4 v[164:167], v14, s[36:39], s88 offen offset:1024 sc1
    ds_read_b64_tr_b16 v[130:131], v4 offset:1024
    buffer_load_dwordx4 v[168:171], v14, s[36:39], s88 offen offset:2048 sc1
    ds_read_b64_tr_b16 v[132:133], v5 offset:0
    buffer_load_dwordx4 v[172:175], v14, s[36:39], s88 offen offset:3072 sc1
    s_add_u32 s82, s82, 4096
    s_and_b32 s82, s82, 0xffff
    s_add_u32 s88, s82, s83
    s_nop 0
    ds_read_b64_tr_b16 v[134:135], v5 offset:1024
    buffer_load_dwordx4 v[176:179], v14, s[36:39], s88 offen offset:0 sc1
    ds_read_b64_tr_b16 v[136:137], v4 offset:2048
    buffer_load_dwordx4 v[180:183], v14, s[36:39], s88 offen offset:1024 sc1
    ds_read_b64_tr_b16 v[138:139], v4 offset:3072
    buffer_load_dwordx4 v[184:187], v14, s[36:39], s88 offen offset:2048 sc1
    ds_read_b64_tr_b16 v[140:141], v5 offset:2048
    buffer_load_dwordx4 v[188:191], v14, s[36:39], s88 offen offset:3072 sc1
    s_add_u32 s82, s82, 4096
    s_and_b32 s82, s82, 0xffff
    s_add_u32 s88, s82, s83
    s_nop 0
    ds_read_b64_tr_b16 v[142:143], v5 offset:3072
    buffer_load_dwordx4 v[192:195], v14, s[36:39], s88 offen offset:0 sc1
    buffer_load_dwordx4 v[196:199], v14, s[36:39], s88 offen offset:1024 sc1
    buffer_load_dwordx4 v[200:203], v14, s[36:39], s88 offen offset:2048 sc1
    buffer_load_dwordx4 v[204:207], v14, s[36:39], s88 offen offset:3072 sc1
    s_add_u32 s82, s82, 4096
    s_and_b32 s82, s82, 0xffff
    s_add_u32 s88, s82, s83
    buffer_load_dwordx4 v[208:211], v14, s[36:39], s88 offen offset:0 sc1
    buffer_load_dwordx4 v[212:215], v14, s[36:39], s88 offen offset:1024 sc1
    .p2align 3
L_G2:
    s_add_u32 s84, s84, 1
    s_waitcnt vmcnt(12) lgkmcnt(6)
    v_mfma_f32_32x32x16_bf16 v[224:239], v[128:131], v[160:163], v[224:239]
    ds_read_b64_tr_b16 v[144:145], v4 offset:4096
    ds_read_b64_tr_b16 v[146:147], v4 offset:5120
    buffer_load_dwordx4 v[216:219], v14, s[36:39], s88 offen offset:2048 sc1
    s_waitcnt lgkmcnt(6)
    v_mfma_f32_32x32x16_bf16 v[240:255], v[132:135], v[160:163], v[240:255]
    ds_read_b64_tr_b16 v[148:149], v5 offset:4096
    ds_read_b64_tr_b16 v[150:151], v5 offset:5120
    s_waitcnt lgkmcnt(6)
    v_mfma_f32_32x32x16_bf16 v[224:239], v[136:139], v[164:167], v[224:239]
    ds_read_b64_tr_b16 v[152:153], v4 offset:6144
    ds_read_b64_tr_b16 v[154:155], v4 offset:7168
    buffer_load_dwordx4 v[220:223], v14, s[36:39], s88 offen offset:3072 sc1
    s_add_u32 s82, s82, 4096
    s_and_b32 s82, s82, 0xffff
    s_add_u32 s88, s82, s83
    s_waitcnt lgkmcnt(6)
    v_mfma_f32_32x32x16_bf16 v[240:255], v[140:143], v[164:167], v[240:255]
    ds_read_b64_tr_b16 v[156:157], v5 offset:6144
    ds_read_b64_tr_b16 v[158:159], v5 offset:7168
    v_add_u32 v4, 0x2000, v4
    v_and_b32 v4, 0x1ffff, v4
    v_xor_b32 v5, 64, v4
    s_waitcnt vmcnt(12) lgkmcnt(6)
    v_mfma_f32_32x32x16_bf16 v[224:239], v[144:147], v[168:171], v[224:239]
    ds_read_b64_tr_b16 v[128:129], v4 offset:0
    ds_read_b64_tr_b16 v[130:131], v4 offset:1024
    buffer_load_dwordx4 v[160:163], v14, s[36:39], s88 offen offset:0 sc1
    s_waitcnt lgkmcnt(6)
    v_mfma_f32_32x32x16_bf16 v[240:255], v[148:151], v[168:171], v[240:255]
    ds_read_b64_tr_b16 v[132:133], v5 offset:0
    ds_read_b64_tr_b16 v[134:135], v5 offset:1024
    s_waitcnt lgkmcnt(6)
    v_mfma_f32_32x32x16_bf16 v[224:239], v[152:155], v[172:175], v[224:239]
    ds_read_b64_tr_b16 v[136:137], v4 offset:2048
    ds_read_b64_tr_b16 v[138:139], v4 offset:3072
L_pad9:
    s_cbranch_execz L_padret
    buffer_load_dwordx4 v[164:167], v14, s[36:39], s88 offen offset:1024 sc1
    s_waitcnt lgkmcnt(6)
    v_mfma_f32_32x32x16_bf16 v[240:255], v[156:159], v[172:175], v[240:255]
    ds_read_b64_tr_b16 v[140:141], v5 offset:2048
    ds_read_b64_tr_b16 v[142:143], v5 offset:3072
    s_waitcnt vmcnt(12) lgkmcnt(6)
    v_mfma_f32_32x32x16_bf16 v[224:239], v[128:131], v[176:179], v[224:239]
    ds_read_b64_tr_b16 v[144:145], v4 offset:4096
    ds_read_b64_tr_b16 v[146:147], v4 offset:5120
    buffer_load_dwordx4 v[168:171], v14, s[36:39], s88 offen offset:2048 sc1
    s_waitcnt lgkmcnt(6)
    v_mfma_f32_32x32x16_bf16 v[240:255], v[132:135], v[176:179], v[240:255]
    ds_read_b64_tr_b16 v[148:149], v5 offset:4096
    ds_read_b64_tr_b16 v[150:151], v5 offset:5120
    s_waitcnt lgkmcnt(6)
    s_nop 0
    v_mfma_f32_32x32x16_bf16 v[224:239], v[136:139], v[180:183], v[224:239]
    ds_read_b64_tr_b16 v[152:153], v4 offset:6144
    ds_read_b64_tr_b16 v[154:155], v4 offset:7168
    buffer_load_dwordx4 v[172:175], v14, s[36:39], s88 offen offset:3072 sc1
    s_add_u32 s82, s82, 4096
    s_and_b32 s82, s82, 0xffff
    s_add_u32 s88, s82, s83
    s_waitcnt lgkmcnt(6)
    v_mfma_f32_32x32x16_bf16 v[240:255], v[140:143], v[180:183], v[240:255]
    ds_read_b64_tr_b16 v[156:157], v5 offset:6144
    ds_read_b64_tr_b16 v[158:159], v5 offset:7168
    v_add_u32 v4, 0x2000, v4
    v_and_b32 v4, 0x1ffff, v4
    v_xor_b32 v5, 64, v4
    s_waitcnt vmcnt(12) lgkmcnt(6)
    v_mfma_f32_32x32x16_bf16 v[224:239], v[144:147], v[184:187], v[224:239]
    ds_read_b64_tr_b16 v[128:129], v4 offset:0
    ds_read_b64_tr_b16 v[130:131], v4 offset:1024
    buffer_load_dwordx4 v[176:179], v14, s[36:39], s88 offen offset:0 sc1
    s_waitcnt lgkmcnt(6)
    v_mfma_f32_32x32x16_bf16 v[240:255], v[148:151], v[184:187], v[240:255]
    ds_read_b64_tr_b16 v[132:133], v5 offset:0
    ds_read_b64_tr_b16 v[134:135], v5 offset:1024
    s_waitcnt lgkmcnt(6)
    v_mfma_f32_32x32x16_bf16 v[224:239], v[152:155], v[188:191], v[224:239]
    ds_read_b64_tr_b16 v[136:137], v4 offset:2048
    ds_read_b64_tr_b16 v[138:139], v4 offset:3072
    buffer_load_dwordx4 v[180:183], v14, s[36:39], s88 offen offset:1024 sc1
    s_waitcnt lgkmcnt(6)
    v_mfma_f32_32x32x16_bf16 v[240:255], v[156:159], v[188:191], v[240:255]
    ds_read_b64_tr_b16 v[140:141], v5 offset:2048
    ds_read_b64_tr_b16 v[142:143], v5 offset:3072
    s_waitcnt vmcnt(12) lgkmcnt(6)
    v_mfma_f32_32x32x16_bf16 v[224:239], v[128:131], v[192:195], v[224:239]
    ds_read_b64_tr_b16 v[144:145], v4 offset:4096
    ds_read_b64_tr_b16 v[146:147], v4 offset:5120
    buffer_load_dwordx4 v[184:187], v14, s[36:39], s88 offen offset:2048 sc1
    s_waitcnt lgkmcnt(6)
    v_mfma_f32_32x32x16_bf16 v[240:255], v[132:135], v[192:195], v[240:255]
    ds_read_b64_tr_b16 v[148:149], v5 offset:4096
    ds_read_b64_tr_b16 v[150:151], v5 offset:5120
    s_waitcnt lgkmcnt(6)
    v_mfma_f32_32x32x16_bf16 v[224:239], v[136:139], v[196:199], v[224:239]
    ds_read_b64_tr_b16 v[152:153], v4 offset:6144
    ds_read_b64_tr_b16 v[154:155], v4 offset:7168
    buffer_load_dwordx4 v[188:191], v14, s[36:39], s88 offen offset:3072 sc1
    s_add_u32 s82, s82, 4096
    s_and_b32 s82, s82, 0xffff
    s_add_u32 s88, s82, s83
    s_waitcnt lgkmcnt(6)
    v_mfma_f32_32x32x16_bf16 v[240:255], v[140:143], v[196:199], v[240:255]
    ds_read_b64_tr_b16 v[156:157], v5 offset:6144
    ds_read_b64_tr_b16 v[158:159], v5 offset:7168
    v_add_u32 v4, 0x2000, v4
    v_and_b32 v4, 0x1ffff, v4
    v_xor_b32 v5, 64, v4
    s_waitcnt vmcnt(12) lgkmcnt(6)
    v_mfma_f32_32x32x16_bf16 v[224:239], v[144:147], v[200:203], v[224:239]
    ds_read_b64_tr_b16 v[128:129], v4 offset:0
    ds_read_b64_tr_b16 v[130:131], v4 offset:1024
    buffer_load_dwordx4 v[192:195], v14, s[36:39], s88 offen offset:0 sc1
    s_waitcnt lgkmcnt(6)
    v_mfma_f32_32x32x16_bf16 v[240:255], v[148:151], v[200:203], v[240:255]
    ds_read_b64_tr_b16 v[132:133], v5 offset:0
    ds_read_b64_tr_b16 v[134:135], v5 offset:1024
    s_waitcnt lgkmcnt(6)
    v_mfma_f32_32x32x16_bf16 v[224:239], v[152:155], v[204:207], v[224:239]
    ds_read_b64_tr_b16 v[136:137], v4 offset:2048
    ds_read_b64_tr_b16 v[138:139], v4 offset:3072
    buffer_load_dwordx4 v[196:199], v14, s[36:39], s88 offen offset:1024 sc1
    s_waitcnt lgkmcnt(6)
    v_mfma_f32_32x32x16_bf16 v[240:255], v[156:159], v[204:207], v[240:255]
    ds_read_b64_tr_b16 v[140:141], v5 offset:2048
    ds_read_b64_tr_b16 v[142:143], v5 offset:3072
    s_waitcnt vmcnt(12) lgkmcnt(6)
    v_mfma_f32_32x32x16_bf16 v[224:239], v[128:131], v[208:211], v[224:239]
    ds_read_b64_tr_b16 v[144:145], v4 offset:4096
    ds_read_b64_tr_b16 v[146:147], v4 offset:5120
    buffer_load_dwordx4 v[200:203], v14, s[36:39], s88 offen offset:2048 sc1
    s_waitcnt lgkmcnt(6)
    v_mfma_f32_32x32x16_bf16 v[240:255], v[132:135], v[208:211], v[240:255]
    ds_read_b64_tr_b16 v[148:149], v5 offset:4096
    ds_read_b64_tr_b16 v[150:151], v5 offset:5120
    s_waitcnt lgkmcnt(6)
    v_mfma_f32_32x32x16_bf16 v[224:239], v[136:139], v[212:215], v[224:239]
    ds_read_b64_tr_b16 v[152:153], v4 offset:6144
    ds_read_b64_tr_b16 v[154:155], v4 offset:7168
    buffer_load_dwordx4 v[204:207], v14, s[36:39], s88 offen offset:3072 sc1
    s_add_u32 s82, s82, 4096
    s_and_b32 s82, s82, 0xffff
    s_add_u32 s88, s82, s83
    s_waitcnt lgkmcnt(6)
    v_mfma_f32_32x32x16_bf16 v[240:255], v[140:143], v[212:215], v[240:255]
    ds_read_b64_tr_b16 v[156:157], v5 offset:6144
    ds_read_b64_tr_b16 v[158:159], v5 offset:7168
    v_add_u32 v4, 0x2000, v4
    v_and_b32 v4, 0x1ffff, v4
    v_xor_b32 v5, 64, v4
    s_waitcnt vmcnt(12) lgkmcnt(6)
    v_mfma_f32_32x32x16_bf16 v[224:239], v[144:147], v[216:219], v[224:239]
    ds_read_b64_tr_b16 v[128:129], v4 offset:0
    ds_read_b64_tr_b16 v[130:131], v4 offset:1024
    buffer_load_dwordx4 v[208:211], v14, s[36:39], s88 offen offset:0 sc1
    s_waitcnt lgkmcnt(6)
    v_mfma_f32_32x32x16_bf16 v[240:255], v[148:151], v[216:219], v[240:255]
    ds_read_b64_tr_b16 v[132:133], v5 offset:0
    ds_read_b64_tr_b16 v[134:135], v5 offset:1024
    s_waitcnt lgkmcnt(6)
    v_mfma_f32_32x32x16_bf16 v[224:239], v[152:155], v[220:223], v[224:239]
    ds_read_b64_tr_b16 v[136:137], v4 offset:2048
    ds_read_b64_tr_b16 v[138:139], v4 offset:3072
    buffer_load_dwordx4 v[212:215], v14, s[36:39], s88 offen offset:1024 sc1
    s_waitcnt lgkmcnt(6)
    v_mfma_f32_32x32x16_bf16 v[240:255], v[156:159], v[220:223], v[240:255]
    ds_read_b64_tr_b16 v[140:141], v5 offset:2048
    ds_read_b64_tr_b16 v[142:143], v5 offset:3072
    s_cmp_lt_u32 s84, 3
    s_cbranch_scc1 L_G2
    s_waitcnt vmcnt(12) lgkmcnt(6)
    v_mfma_f32_32x32x16_bf16 v[224:239], v[128:131], v[160:163], v[224:239]
    ds_read_b64_tr_b16 v[144:145], v4 offset:4096
    ds_read_b64_tr_b16 v[146:147], v4 offset:5120
    buffer_load_dwordx4 v[216:219], v14, s[36:39], s88 offen offset:2048 sc1
    s_waitcnt lgkmcnt(6)
    v_mfma_f32_32x32x16_bf16 v[240:255], v[132:135], v[160:163], v[240:255]
    ds_read_b64_tr_b16 v[148:149], v5 offset:4096
    ds_read_b64_tr_b16 v[150:151], v5 offset:5120
    s_waitcnt lgkmcnt(6)
    v_mfma_f32_32x32x16_bf16 v[224:239], v[136:139], v[164:167], v[224:239]
    ds_read_b64_tr_b16 v[152:153], v4 offset:6144
    ds_read_b64_tr_b16 v[154:155], v4 offset:7168
    buffer_load_dwordx4 v[220:223], v14, s[36:39], s88 offen offset:3072 sc1
    s_add_u32 s82, s82, 4096
    s_and_b32 s82, s82, 0xffff
    s_add_u32 s88, s82, s83
    s_waitcnt lgkmcnt(6)
    v_mfma_f32_32x32x16_bf16 v[240:255], v[140:143], v[164:167], v[240:255]
    ds_read_b64_tr_b16 v[156:157], v5 offset:6144
    ds_read_b64_tr_b16 v[158:159], v5 offset:7168
    s_barrier
    v_add_u32 v4, 0x2000, v4
    v_and_b32 v4, 0x1ffff, v4
    v_xor_b32_e64 v5, 64, v4
    s_waitcnt vmcnt(12) lgkmcnt(6)
    v_mfma_f32_32x32x16_bf16 v[224:239], v[144:147], v[168:171], v[224:239]
    ds_read_b64_tr_b16 v[128:129], v4 offset:0
    ds_read_b64_tr_b16 v[130:131], v4 offset:1024
    s_waitcnt lgkmcnt(6)
    v_mfma_f32_32x32x16_bf16 v[240:255], v[148:151], v[168:171], v[240:255]
    ds_read_b64_tr_b16 v[132:133], v5 offset:0
    ds_read_b64_tr_b16 v[134:135], v5 offset:1024
    s_waitcnt lgkmcnt(6)
    v_mfma_f32_32x32x16_bf16 v[224:239], v[152:155], v[172:175], v[224:239]
    ds_read_b64_tr_b16 v[136:137], v4 offset:2048
    ds_read_b64_tr_b16 v[138:139], v4 offset:3072
    s_waitcnt lgkmcnt(6)
    v_mfma_f32_32x32x16_bf16 v[240:255], v[156:159], v[172:175], v[240:255]
    ds_read_b64_tr_b16 v[140:141], v5 offset:2048
    ds_read_b64_tr_b16 v[142:143], v5 offset:3072
    s_waitcnt vmcnt(10) lgkmcnt(6)
    v_mfma_f32_32x32x16_bf16 v[224:239], v[128:131], v[176:179], v[224:239]
    ds_read_b64_tr_b16 v[144:145], v4 offset:4096
    ds_read_b64_tr_b16 v[146:147], v4 offset:5120
    s_waitcnt lgkmcnt(6)
    v_mfma_f32_32x32x16_bf16 v[240:255], v[132:135], v[176:179], v[240:255]
    ds_read_b64_tr_b16 v[148:149], v5 offset:4096
    ds_read_b64_tr_b16 v[150:151], v5 offset:5120
    s_waitcnt lgkmcnt(6)
    v_mfma_f32_32x32x16_bf16 v[224:239], v[136:139], v[180:183], v[224:239]
    ds_read_b64_tr_b16 v[152:153], v4 offset:6144
    ds_read_b64_tr_b16 v[154:155], v4 offset:7168
    s_waitcnt lgkmcnt(6)
    v_mfma_f32_32x32x16_bf16 v[240:255], v[140:143], v[180:183], v[240:255]
    ds_read_b64_tr_b16 v[156:157], v5 offset:6144
    ds_read_b64_tr_b16 v[158:159], v5 offset:7168
    v_add_u32 v4, 0x2000, v4
    v_and_b32 v4, 0x1ffff, v4
    v_xor_b32_e64 v5, 64, v4
    s_waitcnt vmcnt(8) lgkmcnt(6)
    v_mfma_f32_32x32x16_bf16 v[224:239], v[144:147], v[184:187], v[224:239]
    ds_read_b64_tr_b16 v[128:129], v4 offset:0
    ds_read_b64_tr_b16 v[130:131], v4 offset:1024
    s_waitcnt lgkmcnt(6)
    v_mfma_f32_32x32x16_bf16 v[240:255], v[148:151], v[184:187], v[240:255]
    ds_read_b64_tr_b16 v[132:133], v5 offset:0
    ds_read_b64_tr_b16 v[134:135], v5 offset:1024
    s_waitcnt lgkmcnt(6)
    v_mfma_f32_32x32x16_bf16 v[224:239], v[152:155], v[188:191], v[224:239]
    ds_read_b64_tr_b16 v[136:137], v4 offset:2048
    ds_read_b64_tr_b16 v[138:139], v4 offset:3072
    s_waitcnt lgkmcnt(6)
    v_mfma_f32_32x32x16_bf16 v[240:255], v[156:159], v[188:191], v[240:255]
    ds_read_b64_tr_b16 v[140:141], v5 offset:2048
    ds_read_b64_tr_b16 v[142:143], v5 offset:3072
    s_waitcnt vmcnt(6) lgkmcnt(6)
    v_mfma_f32_32x32x16_bf16 v[224:239], v[128:131], v[192:195], v[224:239]
    ds_read_b64_tr_b16 v[144:145], v4 offset:4096
    ds_read_b64_tr_b16 v[146:147], v4 offset:5120
    s_waitcnt lgkmcnt(6)
    v_mfma_f32_32x32x16_bf16 v[240:255], v[132:135], v[192:195], v[240:255]
    ds_read_b64_tr_b16 v[148:149], v5 offset:4096
    ds_read_b64_tr_b16 v[150:151], v5 offset:5120
    s_waitcnt lgkmcnt(6)
    v_mfma_f32_32x32x16_bf16 v[224:239], v[136:139], v[196:199], v[224:239]
    ds_read_b64_tr_b16 v[152:153], v4 offset:6144
    ds_read_b64_tr_b16 v[154:155], v4 offset:7168
    s_waitcnt lgkmcnt(6)
    v_mfma_f32_32x32x16_bf16 v[240:255], v[140:143], v[196:199], v[240:255]
    ds_read_b64_tr_b16 v[156:157], v5 offset:6144
    ds_read_b64_tr_b16 v[158:159], v5 offset:7168
    v_add_u32 v4, 0x2000, v4
    v_and_b32 v4, 0x1ffff, v4
    v_xor_b32_e64 v5, 64, v4
    s_waitcnt vmcnt(4) lgkmcnt(6)
    v_mfma_f32_32x32x16_bf16 v[224:239], v[144:147], v[200:203], v[224:239]
    ds_read_b64_tr_b16 v[128:129], v4 offset:0
    ds_read_b64_tr_b16 v[130:131], v4 offset:1024
    s_waitcnt lgkmcnt(6)
    v_mfma_f32_32x32x16_bf16 v[240:255], v[148:151], v[200:203], v[240:255]
    ds_read_b64_tr_b16 v[132:133], v5 offset:0
    ds_read_b64_tr_b16 v[134:135], v5 offset:1024
    s_waitcnt lgkmcnt(6)
    v_mfma_f32_32x32x16_bf16 v[224:239], v[152:155], v[204:207], v[224:239]
    ds_read_b64_tr_b16 v[136:137], v4 offset:2048
    ds_read_b64_tr_b16 v[138:139], v4 offset:3072
    s_waitcnt lgkmcnt(6)
    v_mfma_f32_32x32x16_bf16 v[240:255], v[156:159], v[204:207], v[240:255]
    ds_read_b64_tr_b16 v[140:141], v5 offset:2048
    ds_read_b64_tr_b16 v[142:143], v5 offset:3072
    s_waitcnt vmcnt(2) lgkmcnt(6)
    v_mfma_f32_32x32x16_bf16 v[224:239], v[128:131], v[208:211], v[224:239]
    ds_read_b64_tr_b16 v[144:145], v4 offset:4096
    ds_read_b64_tr_b16 v[146:147], v4 offset:5120
    s_waitcnt lgkmcnt(6)
    v_mfma_f32_32x32x16_bf16 v[240:255], v[132:135], v[208:211], v[240:255]
    ds_read_b64_tr_b16 v[148:149], v5 offset:4096
    ds_read_b64_tr_b16 v[150:151], v5 offset:5120
    s_waitcnt lgkmcnt(6)
    v_mfma_f32_32x32x16_bf16 v[224:239], v[136:139], v[212:215], v[224:239]
    ds_read_b64_tr_b16 v[152:153], v4 offset:6144
    ds_read_b64_tr_b16 v[154:155], v4 offset:7168
    s_waitcnt lgkmcnt(6)
    v_mfma_f32_32x32x16_bf16 v[240:255], v[140:143], v[212:215], v[240:255]
    ds_read_b64_tr_b16 v[156:157], v5 offset:6144
    ds_read_b64_tr_b16 v[158:159], v5 offset:7168
    s_waitcnt vmcnt(0) lgkmcnt(6)
    v_mfma_f32_32x32x16_bf16 v[224:239], v[144:147], v[216:219], v[224:239]
    s_waitcnt lgkmcnt(4)
    v_mfma_f32_32x32x16_bf16 v[240:255], v[148:151], v[216:219], v[240:255]
    s_waitcnt lgkmcnt(2)
    v_mfma_f32_32x32x16_bf16 v[224:239], v[152:155], v[220:223], v[224:239]
    s_waitcnt lgkmcnt(0)
    v_mfma_f32_32x32x16_bf16 v[240:255], v[156:159], v[220:223], v[240:255]
    s_nop 9
    v_pk_mul_f32 v[18:19], v[224:225], v[224:225]
    v_pk_mul_f32 v[20:21], v[224:225], v[60:61]
    v_pk_add_f32 v[16:17], v[224:225], v[226:227]
    v_pk_fma_f32 v[18:19], v[226:227], v[226:227], v[18:19]
    v_pk_fma_f32 v[20:21], v[226:227], v[62:63], v[20:21]
    v_pk_add_f32 v[16:17], v[16:17], v[228:229]
    v_pk_fma_f32 v[18:19], v[228:229], v[228:229], v[18:19]
    v_pk_fma_f32 v[20:21], v[228:229], v[64:65], v[20:21]
    v_pk_add_f32 v[16:17], v[16:17], v[230:231]
    v_pk_fma_f32 v[18:19], v[230:231], v[230:231], v[18:19]
    v_pk_fma_f32 v[20:21], v[230:231], v[66:67], v[20:21]
    v_pk_add_f32 v[16:17], v[16:17], v[232:233]
    v_pk_fma_f32 v[18:19], v[232:233], v[232:233], v[18:19]
    v_pk_fma_f32 v[20:21], v[232:233], v[68:69], v[20:21]
    v_pk_add_f32 v[16:17], v[16:17], v[234:235]
    v_pk_fma_f32 v[18:19], v[234:235], v[234:235], v[18:19]
    v_pk_fma_f32 v[20:21], v[234:235], v[70:71], v[20:21]
    v_pk_add_f32 v[16:17], v[16:17], v[236:237]
    v_pk_fma_f32 v[18:19], v[236:237], v[236:237], v[18:19]
    v_pk_fma_f32 v[20:21], v[236:237], v[72:73], v[20:21]
L_pad10:
    s_cbranch_execz L_padret
    s_nop 0
    v_pk_add_f32 v[16:17], v[16:17], v[238:239]
    v_pk_fma_f32 v[18:19], v[238:239], v[238:239], v[18:19]
    v_pk_fma_f32 v[20:21], v[238:239], v[74:75], v[20:21]
    v_pk_add_f32 v[16:17], v[16:17], v[240:241]
    v_pk_fma_f32 v[18:19], v[240:241], v[240:241], v[18:19]
    v_pk_fma_f32 v[20:21], v[240:241], v[76:77], v[20:21]
    v_pk_add_f32 v[16:17], v[16:17], v[242:243]
    v_pk_fma_f32 v[18:19], v[242:243], v[242:243], v[18:19]
    v_pk_fma_f32 v[20:21], v[242:243], v[78:79], v[20:21]
    v_pk_add_f32 v[16:17], v[16:17], v[244:245]
    v_pk_fma_f32 v[18:19], v[244:245], v[244:245], v[18:19]
    v_pk_fma_f32 v[20:21], v[244:245], v[80:81], v[20:21]
    v_pk_add_f32 v[16:17], v[16:17], v[246:247]
    v_pk_fma_f32 v[18:19], v[246:247], v[246:247], v[18:19]
    v_pk_fma_f32 v[20:21], v[246:247], v[82:83], v[20:21]
    v_pk_add_f32 v[16:17], v[16:17], v[248:249]
    v_pk_fma_f32 v[18:19], v[248:249], v[248:249], v[18:19]
    v_pk_fma_f32 v[20:21], v[248:249], v[84:85], v[20:21]
    v_pk_add_f32 v[16:17], v[16:17], v[250:251]
    v_pk_fma_f32 v[18:19], v[250:251], v[250:251], v[18:19]
    v_pk_fma_f32 v[20:21], v[250:251], v[86:87], v[20:21]
    v_pk_add_f32 v[16:17], v[16:17], v[252:253]
    v_pk_fma_f32 v[18:19], v[252:253], v[252:253], v[18:19]
    v_pk_fma_f32 v[20:21], v[252:253], v[88:89], v[20:21]
    v_pk_add_f32 v[16:17], v[16:17], v[254:255]
    v_pk_fma_f32 v[18:19], v[254:255], v[254:255], v[18:19]
    v_pk_fma_f32 v[20:21], v[254:255], v[90:91], v[20:21]
    v_mov_b32 v27, s75
    v_add_f32 v24, v16, v17
    v_add_f32 v25, v18, v19
    v_add_f32 v26, v20, v21
    v_mov_b32 v28, v24
    v_mov_b32 v29, v25
    v_mov_b32 v30, v26
    v_permlane32_swap_b32 v24, v28
    v_permlane32_swap_b32 v25, v29
    v_permlane32_swap_b32 v26, v30
    v_pk_add_f32 v[24:25], v[24:25], v[28:29]
    v_add_f32 v26, v26, v30
    s_mov_b32 exec_hi, 0
    s_bitcmp1_b32 s99, 1
    s_cbranch_scc1 Lls_48
    buffer_store_dwordx4 v[24:27], v14, s[36:39], s95 offen sc1
    s_branch Lle_49
Lls_48:
    buffer_store_dwordx4 v[24:27], v14, s[36:39], s95 offen
Lle_49:
    s_mov_b32 exec_hi, -1
    s_add_u32 s79, s94, 4096
    s_add_u32 s80, s94, 8192
    s_add_u32 s81, s94, 12288
    s_barrier
    v_xor_b32 v112, 0, v13
    ds_write_b128 v112, v[224:227]
    v_xor_b32_e64 v113, 32, v13
    ds_write_b128 v113, v[228:231]
    v_xor_b32_e64 v114, 64, v13
    ds_write_b128 v114, v[232:235]
    v_xor_b32 v115, 96, v13
    ds_write_b128 v115, v[236:239]
    v_xor_b32 v116, 128, v13
    ds_write_b128 v116, v[240:243]
    v_xor_b32 v117, 160, v13
    ds_write_b128 v117, v[244:247]
    buffer_load_dwordx4 v[64:67], v12, s[36:39], s94 offen offset:0 sc1
    buffer_load_dwordx4 v[68:71], v12, s[36:39], s94 offen offset:2048 sc1
    buffer_load_dwordx4 v[72:75], v12, s[36:39], s79 offen offset:0 sc1
    buffer_load_dwordx4 v[76:79], v12, s[36:39], s79 offen offset:2048 sc1
    buffer_load_dwordx4 v[80:83], v12, s[36:39], s80 offen offset:0 sc1
    buffer_load_dwordx4 v[84:87], v12, s[36:39], s80 offen offset:2048 sc1
    buffer_load_dwordx4 v[88:91], v12, s[36:39], s81 offen offset:0 sc1
    buffer_load_dwordx4 v[92:95], v12, s[36:39], s81 offen offset:2048 sc1
    v_xor_b32 v118, 192, v13
    ds_write_b128 v118, v[248:251]
    v_xor_b32 v119, 224, v13
    ds_write_b128 v119, v[252:255]
    s_mov_b32 s85, 1
    s_branch L_gchk
Lspin_50:
    s_add_u32 s85, s85, 1
    s_cmp_gt_u32 s85, 400000
    s_cbranch_scc1 L_end
    buffer_load_dwordx4 v[64:67], v12, s[36:39], s94 offen offset:0 sc1
    buffer_load_dwordx4 v[68:71], v12, s[36:39], s94 offen offset:2048 sc1
    buffer_load_dwordx4 v[72:75], v12, s[36:39], s79 offen offset:0 sc1
    buffer_load_dwordx4 v[76:79], v12, s[36:39], s79 offen offset:2048 sc1
    buffer_load_dwordx4 v[80:83], v12, s[36:39], s80 offen offset:0 sc1
    buffer_load_dwordx4 v[84:87], v12, s[36:39], s80 offen offset:2048 sc1
    buffer_load_dwordx4 v[88:91], v12, s[36:39], s81 offen offset:0 sc1
    buffer_load_dwordx4 v[92:95], v12, s[36:39], s81 offen offset:2048 sc1
L_gchk:
    s_waitcnt vmcnt(0)
    s_nop 0
    v_max3_u32 v16, v67, v71, v75
    v_max3_u32 v16, v16, v79, v83
    v_max3_u32 v16, v16, v87, v91
    v_max3_u32 v16, v16, v95, s75
    v_min3_u32 v17, v67, v71, v75
    v_min3_u32 v17, v17, v79, v83
    v_min3_u32 v17, v17, v87, v91
    v_min3_u32 v17, v17, v95, s75
    v_cmp_ne_u32_e64 vcc, v16, v17
    s_cbranch_vccnz Lspin_50
    s_barrier
    v_pk_add_f32 v[64:65], v[64:65], v[68:69]
    v_add_f32_e64 v66, v66, v70
    v_pk_add_f32 v[72:73], v[72:73], v[76:77]
    v_add_f32_e64 v74, v74, v78
    v_pk_add_f32 v[80:81], v[80:81], v[84:85]
    v_add_f32_e64 v82, v82, v86
    v_pk_add_f32 v[88:89], v[88:89], v[92:93]
    v_add_f32_e64 v90, v90, v94
    v_pk_add_f32 v[64:65], v[64:65], v[72:73]
    v_add_f32_e64 v66, v66, v74
    v_pk_add_f32 v[80:81], v[80:81], v[88:89]
    v_add_f32 v82, v82, v90
    v_add_f32 v24, v64, v80
    v_add_f32 v25, v65, v81
    v_add_f32 v26, v66, v82
    v_mov_b32 v28, v24
    v_mov_b32 v29, v25
    v_mov_b32 v30, v26
    v_permlane32_swap_b32 v24, v28
    v_permlane32_swap_b32 v25, v29
    v_permlane32_swap_b32 v26, v30
    v_pk_add_f32 v[24:25], v[24:25], v[28:29]
    v_add_f32_e64 v26, v26, v30
    v_mul_f32 v36, 0x3a800000, v24
    v_mul_f32 v40, 0x3a800000, v25
    v_fma_f32 v40, -v36, v36, v40
    v_max_f32_e64 v40, 0, v40
    v_cvt_pk_bf16_f32 v36, v36, v36
    v_and_b32 v36, 0xffff0000, v36
    v_cvt_pk_bf16_f32 v40, v40, v40
    v_and_b32 v40, 0xffff0000, v40
    v_add_f32 v40, 0x3727c5ac, v40
    v_cvt_pk_bf16_f32 v40, v40, v40
    v_and_b32 v40, 0xffff0000, v40
    v_sqrt_f32 v40, v40
    s_nop 0
    v_cvt_pk_bf16_f32 v40, v40, v40
    v_and_b32 v40, 0xffff0000, v40
    v_rcp_f32_e64 v38, v40
    v_fma_f32 v42, -v36, v126, v26
    s_mov_b32 s79, 0xfffff800
    v_mul_f32_e64 v42, v42, v38
    v_mul_f32 v39, -v36, v38
    v_and_or_b32 v42, v42, s79, v11
    s_mov_b32 exec_hi, 0
    ds_write_b64 v10, v[38:39]
    ds_max_f32 v44, v42
    s_mov_b32 exec_lo, 1
    ds_add_rtn_u32 v46, v44, v45 offset:4
    s_mov_b32 exec_lo, -1
    ds_read_b32 v20, v44
    v_lshlrev_b32 v17, 3, v2
    v_lshlrev_b32 v18, 2, v2
    v_mov_b32_e64 v21, s75
    s_mov_b32 s79, s96
    s_waitcnt lgkmcnt(0)
    v_readfirstlane_b32 s78, v46
    s_cmp_lg_u32 s78, 3
    s_cbranch_scc1 L_nocand
    s_mov_b32 exec_lo, 0xffff
    buffer_store_dwordx2 v[20:21], v17, s[36:39], s79 offen offset:128 sc1
    s_mov_b32 exec_lo, -1
    v_and_b32 v22, 127, v20
    v_and_b32 v23, 7, v20
    v_lshlrev_b32 v23, 4, v23
    v_xor_b32 v23, v23, v17
    v_lshl_add_u32 v23, v22, 8, v23
    v_lshlrev_b32_e64 v22, 3, v22
    ds_read_b64 v[24:25], v23
    v_add_u32 v22, 159744, v22
    ds_read_b64 v[26:27], v22
    s_waitcnt lgkmcnt(0)
    v_fma_f32 v28, v24, v26, v27
    v_fma_f32 v29, v25, v26, v27
    v_cvt_pk_bf16_f32 v30, v28, v29
    buffer_store_dword v30, v18, s[36:39], s79 offen sc1
    v_add_f32 v28, v28, v24
    v_add_f32_e64 v29, v29, v25
    buffer_store_dwordx2 v[28:29], v17, s[36:39], s79 offen offset:256 sc1
L_nocand:
    s_mov_b32 exec_hi, -1
    v_lshrrev_b32 v16, 3, v2
    v_and_b32 v17, 7, v2
    s_lshl_b32 s78, s76, 5
    v_add_u32 v18, s78, v16
    v_lshlrev_b32 v19, 1, v17
    v_xor_b32 v19, v19, v16
    v_lshlrev_b32 v19, 4, v19
    v_lshl_add_u32 v19, v18, 8, v19
    v_xor_b32 v32, 16, v19
    v_lshlrev_b32 v33, 3, v18
    v_add_u32 v33, 159744, v33
    ds_read_b128 v[64:67], v19 offset:0
    ds_read_b128 v[68:71], v32 offset:0
    ds_read_b64 v[96:97], v33 offset:0
    ds_read_b128 v[72:75], v19 offset:2048
    ds_read_b128 v[76:79], v32 offset:2048
    ds_read_b64 v[98:99], v33 offset:64
    ds_read_b128 v[80:83], v19 offset:4096
    ds_read_b128 v[84:87], v32 offset:4096
    ds_read_b64 v[100:101], v33 offset:128
    ds_read_b128 v[88:91], v19 offset:6144
    ds_read_b128 v[92:95], v32 offset:6144
    ds_read_b64 v[102:103], v33 offset:192
    s_lshl_b32 s78, s71, 7
    v_add_u32_e64 v18, s78, v18
    s_lshl_b32 s79, s72, 7
    v_lshl_add_u32 v19, v18, 11, s79
    v_lshl_add_u32 v19, v17, 4, v19
    v_mov_b32 v16, 163360
    s_waitcnt lgkmcnt(0)
    v_add_f32 v96, 1.0, v96
    v_pk_fma_f32 v[64:65], v[64:65], v[96:97], v[96:97] op_sel:[0,0,1] op_sel_hi:[1,0,1]
    v_pk_fma_f32 v[66:67], v[66:67], v[96:97], v[96:97] op_sel:[0,0,1] op_sel_hi:[1,0,1]
    v_pk_fma_f32 v[68:69], v[68:69], v[96:97], v[96:97] op_sel:[0,0,1] op_sel_hi:[1,0,1]
    v_pk_fma_f32 v[70:71], v[70:71], v[96:97], v[96:97] op_sel:[0,0,1] op_sel_hi:[1,0,1]
    v_cvt_pk_bf16_f32 v104, v64, v65
    v_cvt_pk_bf16_f32 v105, v66, v67
    v_cvt_pk_bf16_f32 v106, v68, v69
    v_cvt_pk_bf16_f32 v107, v70, v71
    v_add_f32_e64 v98, 1.0, v98
    v_pk_fma_f32 v[72:73], v[72:73], v[98:99], v[98:99] op_sel:[0,0,1] op_sel_hi:[1,0,1]
    v_pk_fma_f32 v[74:75], v[74:75], v[98:99], v[98:99] op_sel:[0,0,1] op_sel_hi:[1,0,1]
    v_pk_fma_f32 v[76:77], v[76:77], v[98:99], v[98:99] op_sel:[0,0,1] op_sel_hi:[1,0,1]
    v_pk_fma_f32 v[78:79], v[78:79], v[98:99], v[98:99] op_sel:[0,0,1] op_sel_hi:[1,0,1]
    v_cvt_pk_bf16_f32 v108, v72, v73
    v_cvt_pk_bf16_f32 v109, v74, v75
    v_cvt_pk_bf16_f32 v110, v76, v77
    v_cvt_pk_bf16_f32 v111, v78, v79
    v_add_f32_e64 v100, 1.0, v100
    v_pk_fma_f32 v[80:81], v[80:81], v[100:101], v[100:101] op_sel:[0,0,1] op_sel_hi:[1,0,1]
    v_pk_fma_f32 v[82:83], v[82:83], v[100:101], v[100:101] op_sel:[0,0,1] op_sel_hi:[1,0,1]
    v_pk_fma_f32 v[84:85], v[84:85], v[100:101], v[100:101] op_sel:[0,0,1] op_sel_hi:[1,0,1]
    v_pk_fma_f32 v[86:87], v[86:87], v[100:101], v[100:101] op_sel:[0,0,1] op_sel_hi:[1,0,1]
    v_cvt_pk_bf16_f32 v112, v80, v81
    v_cvt_pk_bf16_f32 v113, v82, v83
    v_cvt_pk_bf16_f32 v114, v84, v85
    v_cvt_pk_bf16_f32 v115, v86, v87
    v_add_f32_e64 v102, 1.0, v102
    v_pk_fma_f32 v[88:89], v[88:89], v[102:103], v[102:103] op_sel:[0,0,1] op_sel_hi:[1,0,1]
    v_pk_fma_f32 v[90:91], v[90:91], v[102:103], v[102:103] op_sel:[0,0,1] op_sel_hi:[1,0,1]
    v_pk_fma_f32 v[92:93], v[92:93], v[102:103], v[102:103] op_sel:[0,0,1] op_sel_hi:[1,0,1]
    v_pk_fma_f32 v[94:95], v[94:95], v[102:103], v[102:103] op_sel:[0,0,1] op_sel_hi:[1,0,1]
    v_cvt_pk_bf16_f32 v116, v88, v89
    v_cvt_pk_bf16_f32 v117, v90, v91
    v_cvt_pk_bf16_f32 v118, v92, v93
    v_cvt_pk_bf16_f32 v119, v94, v95
    s_barrier
    ds_read_b32 v17, v16
    s_waitcnt lgkmcnt(0)
    v_and_b32 v17, 0x7ff, v17
    v_sub_u32 v17, v17, v18
    s_barrier
    s_barrier
    s_mov_b32 s78, 0
    v_cmp_ne_u32_e64 vcc, 0, v17
    s_mov_b64 exec, vcc
    s_cbranch_execz Lo_51
    buffer_store_dwordx4 v[104:107], v19, s[44:47], s78 offen sc1
Lo_51:
    s_mov_b64 exec, -1
    s_mov_b32 s78, 16384
    v_cmp_ne_u32 vcc, 8, v17
    s_mov_b64 exec, vcc
    s_cbranch_execz Lo_52
    buffer_store_dwordx4 v[108:111], v19, s[44:47], s78 offen sc1
Lo_52:
    s_mov_b64 exec, -1
    s_mov_b32 s78, 32768
    v_cmp_ne_u32 vcc, 16, v17
    s_mov_b64 exec, vcc
    s_cbranch_execz Lo_53
    buffer_store_dwordx4 v[112:115], v19, s[44:47], s78 offen sc1
Lo_53:
    s_mov_b64 exec, -1
    s_mov_b32 s78, 49152
    v_cmp_ne_u32 vcc, 24, v17
    s_mov_b64 exec, vcc
    s_cbranch_execz Lo_54
    buffer_store_dwordx4 v[116:119], v19, s[44:47], s78 offen sc1
Lo_54:
    s_mov_b64 exec, -1
    s_branch L_fin
L_fin:
L_end:
    s_endpgm
.fill 64, 4, 0xbf800000
s_endpgm
.section .rodata,"a"
.p2align 6
.amdhsa_kernel sequential_preLN__linear_kernel_hedgehog__moe_arch_mod__prompt_kernel
  .amdhsa_next_free_vgpr 256
  .amdhsa_next_free_sgpr 102
  .amdhsa_accum_offset 256
  .amdhsa_group_segment_fixed_size 0
  .amdhsa_kernarg_size 96
  .amdhsa_user_sgpr_count 2
  .amdhsa_user_sgpr_kernarg_segment_ptr 1
  .amdhsa_system_sgpr_workgroup_id_x 1
  .amdhsa_float_denorm_mode_32 3
.end_amdhsa_kernel
```

```asm
; @launch grid=(256,1,1) block=(512,1,1) lds=163840
.amdgcn_target "amdgcn-amd-amdhsa--gfx950"
.text
.globl sequential_preLN__linear_kernel_hedgehog__moe_arch_mod__prompt_kernel
.p2align 8
.type sequential_preLN__linear_kernel_hedgehog__moe_arch_mod__prompt_kernel,@function
sequential_preLN__linear_kernel_hedgehog__moe_arch_mod__prompt_kernel:
    s_cmp_ge_u32 s2, 256
    s_cbranch_scc1 L_end
    s_load_dwordx16 s[4:19], s[0:1], 0
    s_load_dwordx8 s[20:27], s[0:1], 64
    v_lshrrev_b32 v1, 6, v0
    v_and_b32_e64 v2, 63, v0
    v_readfirstlane_b32 s68, v1
    s_lshr_b32 s69, s2, 4
    s_and_b32 s70, s2, 7
    s_lshl_b32 s70, s70, 1
    s_bfe_u32 s78, s2, 0x10003
    s_or_b32 s70, s70, s78
    s_and_b32 s76, s68, 3
    s_cmp_ge_u32 s68, 4
    s_cbranch_scc1 L_M
    v_lshrrev_b32 v196, 3, v2
    v_and_b32 v197, 7, v2
    v_lshrrev_b32_e64 v198, 4, v2
    s_and_b32 s80, s69, 0
    s_lshl_b32 s89, s76, 11
    s_lshl_b32 s66, s80, 10
    s_or_b32 s66, s66, s89
    s_xor_b32 s67, s66, 1024
    s_lshl_b32 s79, s70, 7
    s_movk_i32 s78, 6144
    v_mov_b32_e64 v199, s79
    v_mad_u32_u24 v199, v196, s78, v199
    s_lshl_b32 s80, s80, 2
    v_and_b32 v200, 2, v196
    v_xor_b32 v200, v200, v197
    v_xor_b32 v200, s80, v200
    v_lshl_add_u32 v199, v200, 4, v199
    s_mul_i32 s78, s66, 48
    s_mul_i32 s79, s67, 48
    v_add_u32 v6, s78, v199
    v_xor_b32 v199, 64, v199
    v_add_u32_e64 v7, s79, v199
    s_and_b32 s80, s70, 0
    s_lshl_b32 s88, s76, 12
    s_lshl_b32 s64, s80, 10
    s_or_b32 s64, s64, s88
    s_xor_b32 s65, s64, 1024
    s_lshl_b32 s80, s80, 2
    s_lshl_b32 s78, s69, 14
    s_add_u32 s78, s78, s64
    s_lshl_b32 s78, s78, 4
    v_lshl_add_u32 v199, v196, 11, s78
    v_xor_b32 v200, v198, v197
    v_xor_b32 v200, s80, v200
    v_lshl_add_u32 v4, v200, 4, v199
    v_xor_b32 v5, 16448, v4
    s_and_b32 s78, s70, 14
    s_and_b32 s79, s69, 14
    s_add_u32 s78, s78, s79
    s_sub_u32 s78, 32, s78
    s_and_b32 s78, s78, 15
    s_lshl_b32 s86, s78, 7
    s_mul_i32 s87, s78, 393216
    s_mov_b32 s30, 0x400000
    s_mov_b32 s31, 0x20000
    s_mov_b32 s34, 0x600000
    s_mov_b32 s35, 0x20000
    s_waitcnt lgkmcnt(0)
    s_mov_b32 s32, s6
    s_and_b32 s33, s7, 0xffff
    s_mov_b32 s28, s4
    s_and_b32 s29, s5, 0xffff
    s_add_u32 m0, s64, 118784
    s_nop 0
    buffer_load_dwordx4 v4, s[28:31], s86 offen offset:0  lds
    s_add_u32 m0, s66, 141312
    s_nop 0
    s_nop 0
    buffer_load_dwordx4 v6, s[32:35], s87 offen offset:2048  lds
    s_add_u32 m0, s64, 120832
    s_add_u32 s101, s86, 32768
    buffer_load_dwordx4 v4, s[28:31], s101 offen offset:0  lds
    s_add_u32 m0, s66, 151552
    s_add_u32 s101, s87, 4096
    buffer_load_dwordx4 v6, s[32:35], s101 offen offset:0  lds
    s_add_u32 m0, s66, 135168
    s_nop 0
    buffer_load_dwordx4 v6, s[32:35], s87 offen offset:0  lds
    s_add_u32 m0, s65, 118784
    s_nop 0
    buffer_load_dwordx4 v5, s[28:31], s86 offen offset:0  lds
    s_add_u32 m0, s67, 141312
    s_nop 0
    s_nop 0
    buffer_load_dwordx4 v7, s[32:35], s87 offen offset:2048  lds
    s_add_u32 m0, s65, 120832
    s_add_u32 s101, s86, 32768
    buffer_load_dwordx4 v5, s[28:31], s101 offen offset:0  lds
    s_add_u32 m0, s67, 151552
    s_add_u32 s101, s87, 4096
    buffer_load_dwordx4 v7, s[32:35], s101 offen offset:0  lds
    s_add_u32 m0, s67, 135168
    s_nop 0
    buffer_load_dwordx4 v7, s[32:35], s87 offen offset:0  lds
    s_add_u32 s86, s86, 128
    s_add_u32 s87, s87, 393216
    s_and_b32 s86, s86, 2047
    s_cselect_b32 s87, s87, 0
    s_mov_b32 s101, 40960
    s_cmp_ge_i32 s64, 0
    s_cselect_b32 s101, 0xfffec000, s101
    s_add_u32 s64, s64, s101
    s_add_u32 s65, s65, s101
    s_add_u32 s66, s66, s101
    s_add_u32 s67, s67, s101
    s_load_dword s75, s[26:27], 0
    s_mov_b32 s60, s8
    s_and_b32 s61, s9, 0xffff
    s_mov_b32 s62, 0x10000
    s_mov_b32 s63, 0x20000
    v_lshlrev_b32 v14, 4, v2
    s_lshl_b32 s78, s70, 12
    s_lshl_b32 s79, s76, 10
    s_add_u32 s78, s78, s79
    s_add_u32 m0, s79, 159744
    s_nop 0
    buffer_load_dwordx4 v14, s[60:63], s78 offen lds
    s_and_b32 s78, s2, 7
    s_lshr_b32 s79, s2, 3
    s_lshl_b32 s71, s78, 1
    s_and_b32 s72, s79, 1
    s_add_u32 s71, s71, s72
    s_lshr_b32 s72, s79, 1
    s_cmp_gt_u32 s70, 3
    s_cselect_b32 s78, 1, 0
    s_cmp_gt_u32 s70, 11
    s_cselect_b32 s78, 2, s78
    s_sub_u32 s78, s70, s78
    s_cmp_eq_u32 s70, 3
    s_cselect_b32 s78, 14, s78
    s_cmp_eq_u32 s70, 11
    s_cselect_b32 s78, 15, s78
    s_lshl_b32 s0, s78, 4
    s_add_u32 s0, s0, s69
    s_lshr_b32 s73, s0, 2
    s_and_b32 s74, s0, 3
    s_lshl_b32 s77, s70, 4
    s_add_u32 s77, s77, s69
    s_getpc_b64 s[12:13]
Lpr_1:
    s_add_u32 s12, s12, L_end-Lpr_1
    s_addc_u32 s13, s13, 0
    s_mov_b32 s36, s26
    s_and_b32 s37, s27, 0xffff
    s_mov_b32 s38, 0x10000000
    s_mov_b32 s39, 0x20000
    s_mov_b32 s40, s10
    s_and_b32 s41, s11, 0xffff
    s_mov_b32 s42, 0x200000
    s_mov_b32 s43, 0x20000
    s_mov_b32 s44, s22
    s_and_b32 s45, s23, 0xffff
    s_mov_b32 s46, 0x400000
    s_mov_b32 s47, 0x20000
    s_mov_b32 s48, s16
    s_and_b32 s49, s17, 0xffff
    s_mov_b32 s50, 0x700000
    s_mov_b32 s51, 0x20000
    s_mov_b32 s52, s18
    s_and_b32 s53, s19, 0xffff
    s_mov_b32 s54, 0x700000
    s_mov_b32 s55, 0x20000
    s_mov_b32 s56, s20
    s_and_b32 s57, s21, 0xffff
    s_mov_b32 s58, 0x700000
    s_mov_b32 s59, 0x20000
    v_mov_b32 v16, -1
    v_mov_b32 v17, -1
    v_mov_b32 v18, -1
    v_mov_b32_e64 v19, -1
    s_lshl_b32 s94, s77, 14
    s_lshl_b32 s78, s76, 12
    s_add_u32 s94, s94, s78
    s_add_u32 s94, s94, 4194304
    s_lshl_b32 s96, s77, 10
    s_add_u32 s96, s96, 8388608
    s_cmp_eq_u32 s76, 3
    s_cselect_b32 s96, s96, 0x10000000
    v_and_b32 v196, 15, v2
    v_lshrrev_b32 v197, 1, v196
    v_lshlrev_b32 v199, 7, v196
    v_add_u32 v199, s88, v199
    v_xor_b32_e64 v200, v198, v197
    v_lshl_add_u32 v60, v200, 4, v199
    v_bfe_u32 v196, v2, 2, 2
    v_and_b32_e64 v197, 3, v2
    v_lshl_add_u32 v199, v198, 3, v196
    v_lshlrev_b32_e64 v199, 7, v199
    v_lshl_add_u32 v199, v197, 3, v199
    v_lshrrev_b32 v196, 1, v196
    v_and_b32 v197, 1, v198
    v_lshl_add_u32 v196, v197, 1, v196
    s_mul_i32 s80, s76, 3
    s_add_u32 s78, s80, 0
    s_and_b32 s79, s78, 3
    s_lshr_b32 s78, s78, 2
    s_lshl_b32 s78, s78, 13
    s_add_u32 s78, s78, 16384
    v_xor_b32 v197, s79, v196
    v_lshl_add_u32 v197, v197, 5, v199
    v_add_u32_e64 v240, s78, v197
    s_add_u32 s78, s80, 1
    s_and_b32 s79, s78, 3
    s_lshr_b32 s78, s78, 2
    s_lshl_b32 s78, s78, 13
    s_add_u32 s78, s78, 16384
    v_xor_b32_e64 v197, s79, v196
    v_lshl_add_u32 v197, v197, 5, v199
    v_add_u32_e64 v241, s78, v197
    s_add_u32 s78, s80, 2
    s_and_b32 s79, s78, 3
    s_lshr_b32 s78, s78, 2
    s_lshl_b32 s78, s78, 13
    s_add_u32 s78, s78, 16384
    v_xor_b32_e64 v197, s79, v196
    v_lshl_add_u32 v197, v197, 5, v199
    v_add_u32 v242, s78, v197
    s_and_b32 s78, s70, 1
    s_lshl_b32 s78, s78, 6
    v_xor_b32 v60, s78, v60
    s_and_b32 s78, s69, 1
    s_lshl_b32 s78, s78, 12
    v_add_u32 v240, s78, v240
    v_add_u32 v241, s78, v241
    v_add_u32_e64 v242, s78, v242
    s_add_u32 m0, s64, 118784
    s_nop 0
    buffer_load_dwordx4 v4, s[28:31], s86 offen offset:0  lds
    v_lshrrev_b32 v196, 3, v2
    v_and_b32 v197, 7, v2
    v_lshlrev_b32 v199, 4, v197
    v_mul_u32_u24 v244, 57344, v196
    s_add_u32 m0, s66, 141312
    s_nop 0
    buffer_load_dwordx4 v6, s[32:35], s87 offen offset:2048  lds
    v_add_u32 v244, v244, v199
    v_lshl_add_u32 v245, v196, 14, v199
    s_lshl_b32 s78, s74, 2
    s_add_u32 s78, s78, s76
    s_add_u32 m0, s64, 120832
    s_add_u32 s101, s86, 32768
    buffer_load_dwordx4 v4, s[28:31], s101 offen offset:0  lds
    s_mul_i32 s79, s78, 458752
    s_add_u32 s80, s73, s76
    s_and_b32 s80, s80, 3
    s_andn2_b32 s100, s73, 3
    s_add_u32 m0, s66, 151552
    s_add_u32 s101, s87, 4096
    buffer_load_dwordx4 v6, s[32:35], s101 offen offset:0  lds
    s_or_b32 s80, s80, s100
    s_lshl_b32 s80, s80, 7
    s_add_u32 s79, s79, s80
    s_cmp_ge_u32 s73, 56
    s_cselect_b32 s79, 0x8000000, s79
    v_add_u32_e64 v244, s79, v244
    s_lshl_b32 s78, s78, 7
    s_add_u32 m0, s66, 135168
    s_nop 0
    buffer_load_dwordx4 v6, s[32:35], s87 offen offset:0  lds
    s_lshl_b32 s80, s73, 17
    s_add_u32 s78, s78, s80
    v_add_u32_e64 v245, s78, v245
    s_lshl_b32 s78, s72, 7
    s_add_u32 m0, s65, 118784
    s_nop 0
    buffer_load_dwordx4 v5, s[28:31], s86 offen offset:0  lds
    v_lshl_add_u32 v196, v196, 11, s78
    v_and_b32 v199, 1, v198
    v_lshlrev_b32 v199, 2, v199
    v_xor_b32 v199, v199, v197
    s_add_u32 m0, s67, 141312
    s_nop 0
    buffer_load_dwordx4 v7, s[32:35], s87 offen offset:2048  lds
    v_lshl_add_u32 v246, v199, 4, v196
    s_lshl_b32 s78, s71, 2
    s_add_u32 s78, s78, s76
    s_lshl_b32 s78, s78, 16
    v_add_u32_e64 v196, s78, v196
    s_add_u32 m0, s65, 120832
    s_add_u32 s101, s86, 32768
    buffer_load_dwordx4 v5, s[28:31], s101 offen offset:0  lds
    v_xor_b32_e64 v199, v198, v197
    v_lshl_add_u32 v247, v199, 4, v196
    v_xor_b32 v248, 64, v247
    s_lshl_b32 s78, s76, 14
    s_add_u32 m0, s67, 151552
    s_add_u32 s101, s87, 4096
    buffer_load_dwordx4 v7, s[32:35], s101 offen offset:0  lds
    v_add_u32 v246, s78, v246
    s_lshl_b32 s84, s76, 10
    s_bfe_u32 s78, s2, 0x40003
    s_lshl_b32 s78, s78, 17
    s_add_u32 m0, s67, 135168
    s_nop 0
    buffer_load_dwordx4 v7, s[32:35], s87 offen offset:0  lds
    s_add_u32 s86, s86, 128
    s_add_u32 s87, s87, 393216
    s_and_b32 s86, s86, 2047
    s_cselect_b32 s87, s87, 0
    s_mov_b32 s101, 40960
    s_cmp_ge_i32 s64, 0
    s_cselect_b32 s101, 0xfffec000, s101
    s_add_u32 s64, s64, s101
    s_add_u32 s65, s65, s101
    s_add_u32 s66, s66, s101
    s_add_u32 s67, s67, s101
    s_and_b32 s79, s72, 8
    s_add_u32 s79, s79, 3
    s_lshl_b32 s79, s79, 7
    s_add_u32 s78, s78, s79
    v_lshl_add_u32 v63, v2, 11, s78
    s_mov_b32 s92, 0x2140321
    s_mov_b32 s93, 0x4320143
    s_lshl_b32 s100, s69, 2
    s_lshr_b64 s[92:93], s[92:93], s100
    s_and_b32 s3, s92, 15
    s_branch L_sube
    .p2align 6
L_iss:
    s_add_u32 m0, s64, 118784
    s_nop 0
    buffer_load_dwordx4 v4, s[28:31], s86 offen offset:0  lds
    s_add_u32 m0, s66, 141312
    s_nop 0
    buffer_load_dwordx4 v6, s[32:35], s87 offen offset:2048  lds
    s_add_u32 m0, s64, 120832
    s_add_u32 s101, s86, 32768
    buffer_load_dwordx4 v4, s[28:31], s101 offen offset:0  lds
    s_add_u32 m0, s66, 151552
    s_add_u32 s101, s87, 4096
    buffer_load_dwordx4 v6, s[32:35], s101 offen offset:0  lds
    s_add_u32 m0, s66, 135168
    s_nop 0
    buffer_load_dwordx4 v6, s[32:35], s87 offen offset:0  lds
    s_add_u32 m0, s65, 118784
    s_nop 0
    buffer_load_dwordx4 v5, s[28:31], s86 offen offset:0  lds
    s_add_u32 m0, s67, 141312
    s_nop 0
    s_nop 0
    buffer_load_dwordx4 v7, s[32:35], s87 offen offset:2048  lds
    s_add_u32 m0, s65, 120832
    s_add_u32 s101, s86, 32768
    buffer_load_dwordx4 v5, s[28:31], s101 offen offset:0  lds
    s_add_u32 m0, s67, 151552
    s_add_u32 s101, s87, 4096
    buffer_load_dwordx4 v7, s[32:35], s101 offen offset:0  lds
    s_add_u32 m0, s67, 135168
    s_nop 0
    buffer_load_dwordx4 v7, s[32:35], s87 offen offset:0  lds
    s_add_u32 s86, s86, 128
    s_add_u32 s87, s87, 393216
    s_and_b32 s86, s86, 2047
    s_cselect_b32 s87, s87, 0
    s_mov_b32 s101, 40960
    s_cmp_ge_i32 s64, 0
    s_cselect_b32 s101, 0xfffec000, s101
    s_add_u32 s64, s64, s101
    s_add_u32 s65, s65, s101
    s_add_u32 s66, s66, s101
    s_add_u32 s67, s67, s101
    s_setpc_b64 s[90:91]
    .p2align 6
L_cl0:
    s_mov_b32 s100, 0
    buffer_load_dwordx4 v[64:67], v244, s[48:51], s100 offen nt
    s_mov_b32 s100, 0
    buffer_load_dwordx4 v[96:99], v244, s[52:55], s100 offen nt
    s_mov_b32 s100, 7168
    buffer_load_dwordx4 v[68:71], v244, s[48:51], s100 offen nt
    s_mov_b32 s100, 7168
    buffer_load_dwordx4 v[100:103], v244, s[52:55], s100 offen nt
    s_mov_b32 s100, 14336
    buffer_load_dwordx4 v[72:75], v244, s[48:51], s100 offen nt
    s_mov_b32 s100, 14336
    buffer_load_dwordx4 v[104:107], v244, s[52:55], s100 offen nt
    s_setpc_b64 s[90:91]
    .p2align 6
L_cl1:
    s_mov_b32 s100, 21504
    buffer_load_dwordx4 v[76:79], v244, s[48:51], s100 offen nt
    s_mov_b32 s100, 21504
    buffer_load_dwordx4 v[108:111], v244, s[52:55], s100 offen nt
    s_mov_b32 s100, 28672
    buffer_load_dwordx4 v[80:83], v244, s[48:51], s100 offen nt
    s_mov_b32 s100, 28672
    buffer_load_dwordx4 v[112:115], v244, s[52:55], s100 offen nt
    s_mov_b32 s100, 35840
    buffer_load_dwordx4 v[84:87], v244, s[48:51], s100 offen nt
    s_mov_b32 s100, 35840
    buffer_load_dwordx4 v[116:119], v244, s[52:55], s100 offen nt
    s_setpc_b64 s[90:91]
    .p2align 12
L_sube:
    s_waitcnt vmcnt(10)
    s_barrier
    s_call_b64 s[90:91], L_iss
    s_setprio 2
    v_add_u32 v196, 118784, v60
    v_add_u32 v198, 118784, v240
    v_add_u32 v199, 118784, v241
    v_add_u32 v200, 118784, v242
    ds_read_b128 v[20:23], v196 offset:0
    ds_read_b128 v[24:27], v196 offset:2048
    ds_read_b64_tr_b16 v[36:37], v198 offset:0
    ds_read_b64_tr_b16 v[38:39], v198 offset:512
    ds_read_b64_tr_b16 v[44:45], v199 offset:0
    ds_read_b64_tr_b16 v[46:47], v199 offset:512
    ds_read_b64_tr_b16 v[52:53], v200 offset:0
    ds_read_b64_tr_b16 v[54:55], v200 offset:512
    s_setprio 0
    s_waitcnt lgkmcnt(0)
    s_mul_i32 s75, s75, 0x9E3779B1
    s_add_u32 s75, s75, 0x7F4A7C15
    s_waitcnt vmcnt(10)
    s_waitcnt lgkmcnt(0)
    s_barrier
    s_call_b64 s[90:91], L_iss
    s_setprio 2
    s_nop 0
    v_add_u32 v196, 36864, v60
    v_add_u32 v198, 36864, v240
    v_add_u32 v199, 36864, v241
    v_add_u32 v200, 36864, v242
    ds_read_b128 v[28:31], v196 offset:0
    ds_read_b128 v[32:35], v196 offset:2048
    ds_read_b64_tr_b16 v[40:41], v198 offset:0
    ds_read_b64_tr_b16 v[42:43], v198 offset:512
    ds_read_b64_tr_b16 v[48:49], v199 offset:0
    ds_read_b64_tr_b16 v[50:51], v199 offset:512
    ds_read_b64_tr_b16 v[56:57], v200 offset:0
    ds_read_b64_tr_b16 v[58:59], v200 offset:512
    s_setprio 0
    s_getreg_b32 s99, hwreg(HW_REG_XCC_ID, 0, 4)
    v_mov_b32 v10, s75
    v_mov_b32 v11, s99
    v_not_b32 v12, v10
    v_mov_b32 v13, 0
    v_and_b32 v8, 15, v2
    v_lshlrev_b32 v9, 4, v8
    v_add_u32 v9, s69, v9
    s_lshl_b32 s78, s70, 4
    s_xor_b32 s79, s78, 16
    v_mov_b32 v202, s78
    v_mov_b32 v203, s79
    v_cmp_gt_u32 vcc, 32, v2
    s_nop 1
    v_cndmask_b32 v202, v203, v202, vcc
    v_add_u32 v8, v202, v8
    v_cmp_gt_u32 vcc, 16, v2
    s_nop 1
    v_cndmask_b32 v8, v8, v9, vcc
    v_lshlrev_b32_e64 v8, 7, v8
    v_add_u32 v8, 4096, v8
    v_lshlrev_b32 v9, 3, v2
    s_lshl_b32 s82, s77, 7
    s_add_u32 s82, s82, 4096
    s_cmp_gt_u32 s76, 0
    s_cselect_b32 s82, 0x10000000, s82
    s_lshl_b32 s83, s77, 9
    s_add_u32 s83, s83, 8912896
    s_cmp_eq_u32 s76, 2
    s_cselect_b32 s83, s83, 0x10000000
    buffer_store_dwordx2 v[12:13], v9, s[36:39], s83 offen sc1
    s_waitcnt vmcnt(11)
    s_waitcnt lgkmcnt(0)
    s_barrier
    s_call_b64 s[90:91], L_iss
    s_waitcnt vmcnt(11)
    s_cmp_lg_u32 s3, 0
    s_cbranch_scc1 Lcs_2
    s_call_b64 s[90:91], L_cl0
Lcs_2:
    s_barrier
    s_setprio 2
    s_add_u32 m0, s64, 118784
    s_nop 0
    buffer_load_dwordx4 v4, s[28:31], s86 offen offset:0  lds
    v_mov_b32 v200, 0x3f803f80
    v_mov_b32 v201, 0x3f803f80
    v_mov_b32 v202, 0x3f803f80
    v_mov_b32 v203, 0x3f803f80
    s_add_u32 m0, s66, 141312
    s_nop 0
    s_nop 0
    buffer_load_dwordx4 v6, s[32:35], s87 offen offset:2048  lds
    v_mfma_f32_16x16x32_bf16 v[204:207], v[200:203], v[20:23], 0
    v_mfma_f32_16x16x32_bf16 v[212:215], v[20:23], v[20:23], 0
    v_mfma_f32_16x16x32_bf16 v[208:211], v[200:203], v[24:27], 0
    v_mfma_f32_16x16x32_bf16 v[216:219], v[24:27], v[24:27], 0
    s_add_u32 m0, s64, 120832
    s_add_u32 s101, s86, 32768
    buffer_load_dwordx4 v4, s[28:31], s101 offen offset:0  lds
    v_mfma_f32_16x16x32_bf16 v[220:223], v[200:203], v[36:39], 0
    v_mfma_f32_16x16x32_bf16 v[224:227], v[200:203], v[44:47], 0
    v_mfma_f32_16x16x32_bf16 v[228:231], v[200:203], v[52:55], 0
    v_mfma_f32_16x16x32_bf16 v[204:207], v[200:203], v[28:31], v[204:207]
    v_mfma_f32_16x16x32_bf16 v[212:215], v[28:31], v[28:31], v[212:215]
    s_add_u32 m0, s66, 151552
    s_add_u32 s101, s87, 4096
    buffer_load_dwordx4 v6, s[32:35], s101 offen offset:0  lds
    v_mfma_f32_16x16x32_bf16 v[208:211], v[200:203], v[32:35], v[208:211]
    v_mfma_f32_16x16x32_bf16 v[216:219], v[32:35], v[32:35], v[216:219]
    v_mfma_f32_16x16x32_bf16 v[220:223], v[200:203], v[40:43], v[220:223]
    v_mfma_f32_16x16x32_bf16 v[224:227], v[200:203], v[48:51], v[224:227]
    s_add_u32 m0, s66, 135168
    s_nop 0
    buffer_load_dwordx4 v6, s[32:35], s87 offen offset:0  lds
    v_mfma_f32_16x16x32_bf16 v[228:231], v[200:203], v[56:59], v[228:231]
    v_and_b32 v196, 3, v2
    v_cmp_eq_u32 s[90:91], 1, v196
    v_cmp_eq_u32 s[92:93], 2, v196
    v_cmp_eq_u32_e64 vcc, 3, v196
    s_add_u32 m0, s65, 118784
    s_nop 0
    buffer_load_dwordx4 v5, s[28:31], s86 offen offset:0  lds
    v_cndmask_b32 v212, v212, v213, s[90:91]
    v_cndmask_b32 v212, v212, v214, s[92:93]
    v_cndmask_b32 v205, v212, v215, vcc
    v_cndmask_b32 v216, v216, v217, s[90:91]
    s_add_u32 m0, s67, 141312
    s_nop 0
    buffer_load_dwordx4 v7, s[32:35], s87 offen offset:2048  lds
    v_cndmask_b32 v216, v216, v218, s[92:93]
    v_cndmask_b32 v209, v216, v219, vcc
    v_lshrrev_b32_e64 v196, 4, v2
    v_cmp_eq_u32 s[90:91], 1, v196
    v_cmp_eq_u32_e64 vcc, 2, v196
    s_add_u32 m0, s65, 120832
    s_add_u32 s101, s86, 32768
    buffer_load_dwordx4 v5, s[28:31], s101 offen offset:0  lds
    v_cndmask_b32 v220, v220, v224, s[90:91]
    v_cndmask_b32_e64 v220, v220, v228, vcc
    s_mul_i32 s78, s77, 768
    s_mul_i32 s79, s76, 192
    s_add_u32 m0, s67, 151552
    s_add_u32 s101, s87, 4096
    buffer_load_dwordx4 v7, s[32:35], s101 offen offset:0  lds
    s_add_u32 s78, s78, s79
    s_add_u32 s78, s78, 327680
    v_lshlrev_b32 v197, 2, v2
    s_mov_b32 exec_hi, 0xffff
    buffer_store_dword v220, v197, s[36:39], s78 offen sc1
    s_mov_b32 exec_hi, -1
    s_lshl_b32 s78, s69, 4
    s_add_u32 m0, s67, 135168
    s_nop 0
    buffer_load_dwordx4 v7, s[32:35], s87 offen offset:0  lds
    s_add_u32 s86, s86, 128
    s_add_u32 s87, s87, 393216
    s_and_b32 s86, s86, 2047
    s_cselect_b32 s87, s87, 0
    s_mov_b32 s101, 40960
    s_cmp_ge_i32 s64, 0
    s_cselect_b32 s101, 0xfffec000, s101
    s_add_u32 s64, s64, s101
    s_add_u32 s65, s65, s101
    s_add_u32 s66, s66, s101
    s_add_u32 s67, s67, s101
    s_add_u32 s78, s78, s70
    s_lshl_b32 s78, s78, 10
    s_lshl_b32 s79, s76, 8
    s_add_u32 s78, s78, s79
    buffer_store_dwordx4 v[16:19], v14, s[36:39], s96 offen offset:0 sc1
    s_add_u32 s78, s78, 65536
    v_and_b32 v198, 15, v2
    v_lshlrev_b32_e64 v198, 3, v198
    s_mov_b32 exec_lo, 0x00f0000f
    s_mov_b32 exec_hi, 0xf0000f00
    buffer_store_dwordx2 v[204:205], v198, s[36:39], s78 offen offset:0 sc1
    s_mov_b64 exec, -1
    s_mov_b32 exec_lo, 0x00f0000f
    s_mov_b32 exec_hi, 0xf0000f00
    buffer_store_dwordx2 v[208:209], v198, s[36:39], s78 offen offset:128 sc1
    s_mov_b64 exec, -1
    s_setprio 0
    s_waitcnt vmcnt(14)
    s_cmp_lg_u32 s3, 1
    s_cbranch_scc1 Lcs_3
    s_call_b64 s[90:91], L_cl0
Lcs_3:
    s_barrier
    s_call_b64 s[90:91], L_iss
    s_waitcnt vmcnt(10)
    s_cmp_lg_u32 s3, 2
    s_cbranch_scc1 Lcs_4
    s_call_b64 s[90:91], L_cl0
Lcs_4:
    s_barrier
    s_mov_b64 exec, 0xffff
    buffer_store_dwordx2 v[10:11], v9, s[36:39], s82 offen sc1
    s_mov_b64 exec, -1
    s_call_b64 s[90:91], L_iss
    s_waitcnt vmcnt(11)
    s_cmp_lg_u32 s3, 3
    s_cbranch_scc1 Lcs_5
    s_call_b64 s[90:91], L_cl0
Lcs_5:
    s_barrier
    s_call_b64 s[90:91], L_iss
    s_waitcnt vmcnt(10)
    s_cmp_lg_u32 s3, 4
    s_cbranch_scc1 Lcs_6
    s_call_b64 s[90:91], L_cl0
Lcs_6:
    s_barrier
    s_call_b64 s[90:91], L_iss
    s_waitcnt vmcnt(10)
    s_cmp_lg_u32 s3, 0
    s_cbranch_scc1 Lcs_7
    s_call_b64 s[90:91], L_cl1
Lcs_7:
    s_barrier
    s_call_b64 s[90:91], L_iss
    s_waitcnt vmcnt(10)
    s_cmp_lg_u32 s3, 1
    s_cbranch_scc1 Lcs_8
    s_call_b64 s[90:91], L_cl1
Lcs_8:
    s_barrier
    s_call_b64 s[90:91], L_iss
    s_waitcnt vmcnt(10)
    s_cmp_lg_u32 s3, 2
    s_cbranch_scc1 Lcs_9
    s_call_b64 s[90:91], L_cl1
Lcs_9:
    s_barrier
    s_call_b64 s[90:91], L_iss
    s_waitcnt vmcnt(10)
    s_cmp_lg_u32 s3, 3
    s_cbranch_scc1 Lcs_10
    s_call_b64 s[90:91], L_cl1
Lcs_10:
    s_barrier
    s_call_b64 s[90:91], L_iss
    s_waitcnt vmcnt(10)
    s_cmp_lg_u32 s3, 4
    s_cbranch_scc1 Lcs_11
    s_call_b64 s[90:91], L_cl1
Lcs_11:
    s_barrier
    s_cmp_lg_u32 s76, 0
    s_cbranch_scc1 Lpl_12
    s_mov_b32 exec_hi, 0xffff
    buffer_load_dwordx2 v[10:11], v8, s[36:39], 0 offen sc1
    s_mov_b64 exec, -1
Lpl_12:
    s_call_b64 s[90:91], L_iss
    s_cmp_lg_u32 s76, 1
    s_cbranch_scc1 Lpf_13
    s_getpc_b64 s[90:91]
Lpc_14:
    s_add_u32 s90, s90, L_phend-Lpc_14
    s_addc_u32 s91, s91, 0
    s_lshr_b32 s100, s2, 3
    s_lshl_b32 s100, s100, 10
    s_min_u32 s100, s100, (L_end-L_phend-768)
    v_add_u32 v236, s100, v14
    global_load_dword v236, v236, s[90:91]
Lpf_13:
    s_waitcnt vmcnt(10)
    s_barrier
    s_cmp_lg_u32 s76, 2
    s_cbranch_scc1 Lc4_15
    s_mov_b32 exec_hi, -1
    buffer_load_dword v238, v63, s[40:43], 0 offen
    s_mov_b64 exec, -1
Lc4_15:
    s_call_b64 s[90:91], L_iss
    s_waitcnt vmcnt(10)
    s_cmp_lg_u32 s76, 0
    s_cbranch_scc1 Lpc_16
    s_setprio 2
    s_mov_b32 exec_hi, 0xffff
    s_mov_b32 s85, 0
Lpk_17:
    v_cmp_ne_u32 vcc, s75, v10
    s_cbranch_vccnz Lspin_18
    v_cmp_ne_u32 vcc, s99, v11
    s_mov_b64 exec, -1
    s_lshr_b32 s78, vcc_lo, 16
    s_cselect_b32 s78, 0, 3
    s_cmp_eq_u32 vcc_hi, 0
    s_cselect_b32 s79, 3, 1
    s_and_b32 s78, s78, s79
    s_and_b32 s78, s78, 3
    v_mov_b32_e64 v10, s78
    v_mov_b32 v11, 163584
    ds_write_b32 v11, v10
    s_setprio 0
Lpc_16:
    s_barrier
    v_lshrrev_b32 v196, 4, v2
    v_and_b32 v197, 15, v2
    v_lshlrev_b32_e64 v197, 4, v197
    v_lshl_add_u32 v198, v196, 10, v197
    s_lshl_b32 s78, s69, 14
    s_lshl_b32 s79, s76, 8
    s_add_u32 s78, s78, s79
    s_nop 0
    s_add_u32 s78, s78, 65536
    buffer_load_dwordx4 v[20:23], v198, s[36:39], s78 offen sc1
    s_add_u32 s78, s78, 4096
    buffer_load_dwordx4 v[24:27], v198, s[36:39], s78 offen sc1
    s_add_u32 s78, s78, 4096
    buffer_load_dwordx4 v[28:31], v198, s[36:39], s78 offen sc1
    s_add_u32 s78, s78, 4096
    buffer_load_dwordx4 v[32:35], v198, s[36:39], s78 offen sc1
    v_mul_u32_u24 v198, 768, v196
    v_add_u32_e64 v198, v198, v197
    s_mul_i32 s78, s70, 12288
    s_lshl_b32 s79, s76, 8
    s_add_u32 s78, s78, s79
    s_add_u32 s78, s78, 327680
    s_cmp_eq_u32 s76, 3
    s_nop 0
    s_cselect_b32 s78, 0x10000000, s78
    buffer_load_dwordx4 v[36:39], v198, s[36:39], s78 offen sc1
    s_add_u32 s78, s78, 3072
    buffer_load_dwordx4 v[40:43], v198, s[36:39], s78 offen sc1
    s_add_u32 s78, s78, 3072
    buffer_load_dwordx4 v[44:47], v198, s[36:39], s78 offen sc1
    s_add_u32 s78, s78, 3072
    buffer_load_dwordx4 v[48:51], v198, s[36:39], s78 offen sc1
    s_add_u32 m0, s84, 0
    s_mov_b32 s100, 0
    buffer_load_dwordx4 v246, s[40:43], s100 offen  lds
    s_add_u32 m0, s84, 4096
    s_mov_b32 s100, 65536
    buffer_load_dwordx4 v246, s[40:43], s100 offen  lds
    s_add_u32 m0, s84, 8192
    s_mov_b32 s100, 131072
    buffer_load_dwordx4 v246, s[40:43], s100 offen  lds
    s_add_u32 m0, s84, 12288
    s_mov_b32 s100, 196608
    buffer_load_dwordx4 v246, s[40:43], s100 offen  lds
    s_waitcnt vmcnt(12)
    s_barrier
    s_setprio 2
    s_add_u32 m0, s84, 16384
    s_mov_b32 s100, 262144
    buffer_load_dwordx4 v246, s[40:43], s100 offen  lds
    s_waitcnt vmcnt(9)
    v_add_f32 v20, v20, v24
    v_add_f32 v21, v21, v25
    v_add_f32 v22, v22, v26
    v_add_f32 v23, v23, v27
    v_add_f32 v20, v20, v28
    v_add_f32 v21, v21, v29
    s_add_u32 m0, s84, 20480
    s_mov_b32 s100, 327680
    buffer_load_dwordx4 v246, s[40:43], s100 offen  lds
    v_add_f32 v22, v22, v30
    v_add_f32 v23, v23, v31
    v_add_f32 v20, v20, v32
    v_add_f32 v21, v21, v33
    v_add_f32 v22, v22, v34
    v_add_f32 v23, v23, v35
    s_nop 0
    v_permlane32_swap_b32 v20, v22
    s_add_u32 m0, s84, 24576
    s_mov_b32 s100, 393216
    buffer_load_dwordx4 v246, s[40:43], s100 offen  lds
L_pad0:
    s_cbranch_execz L_pad4
    v_permlane32_swap_b32 v21, v23
    v_add_f32 v20, v20, v22
    v_add_f32 v21, v21, v23
    v_mov_b32 v22, v20
    v_mov_b32 v23, v21
    s_nop 0
    v_permlane16_swap_b32 v20, v22
    v_permlane16_swap_b32 v21, v23
    v_add_f32 v20, v20, v22
    s_add_u32 m0, s84, 28672
    s_mov_b32 s100, 458752
    buffer_load_dwordx4 v246, s[40:43], s100 offen  lds
    v_add_f32_e64 v21, v21, v23
    v_mul_f32 v24, 0x3a800000, v20
    v_mul_f32 v26, 0x3a800000, v21
    v_fma_f32 v26, -v24, v24, v26
    v_max_f32_e64 v26, 0, v26
    v_cvt_pk_bf16_f32 v24, v24, v24
    v_and_b32 v24, 0xffff0000, v24
    s_add_u32 m0, s84, 32768
    s_mov_b32 s100, 524288
    buffer_load_dwordx4 v246, s[40:43], s100 offen  lds
    v_cvt_pk_bf16_f32 v26, v26, v26
    v_and_b32 v26, 0xffff0000, v26
    v_add_f32 v26, 0x3727c5ac, v26
    v_cvt_pk_bf16_f32 v26, v26, v26
    v_and_b32 v26, 0xffff0000, v26
    v_sqrt_f32 v26, v26
    s_nop 0
    v_cvt_pk_bf16_f32 v26, v26, v26
    v_and_b32 v26, 0xffff0000, v26
    s_add_u32 m0, s84, 36864
    s_mov_b32 s100, 589824
    buffer_load_dwordx4 v246, s[40:43], s100 offen  lds
    v_rcp_f32_e64 v25, v26
    v_xor_b32 v26, 0x80000000, v24
    v_lshrrev_b32 v27, 16, v26
    v_or_b32 v26, v26, v27
    v_mov_b32 v27, 0
    v_and_b32 v196, 15, v2
    v_lshrrev_b32_e64 v197, 5, v2
    s_add_u32 m0, s84, 40960
    s_mov_b32 s100, 655360
    buffer_load_dwordx4 v246, s[40:43], s100 offen  lds
    v_lshl_add_u32 v196, v196, 1, v197
    s_lshl_b32 s78, s76, 5
    v_add_u32 v196, s78, v196
    v_lshlrev_b32_e64 v197, 3, v196
    v_add_u32 v197, 159744, v197
    v_lshlrev_b32_e64 v196, 2, v196
    v_add_u32 v196, 162304, v196
    s_add_u32 m0, s84, 45056
    s_mov_b32 s100, 720896
    buffer_load_dwordx4 v246, s[40:43], s100 offen  lds
    ds_write_b64 v197, v[26:27]
    ds_write_b32 v196, v25
    s_waitcnt vmcnt(12)
    v_add_f32 v36, v36, v40
    v_add_f32 v37, v37, v41
    v_add_f32 v38, v38, v42
    v_add_f32 v39, v39, v43
    v_add_f32 v36, v36, v44
    s_add_u32 m0, s84, 49152
    s_mov_b32 s100, 786432
    buffer_load_dwordx4 v246, s[40:43], s100 offen  lds
    v_add_f32 v37, v37, v45
    v_add_f32 v38, v38, v46
    v_add_f32 v39, v39, v47
    v_add_f32 v36, v36, v48
    v_add_f32 v37, v37, v49
    v_add_f32 v38, v38, v50
    v_add_f32_e64 v39, v39, v51
    s_add_u32 m0, s84, 53248
    s_mov_b32 s100, 851968
    buffer_load_dwordx4 v246, s[40:43], s100 offen  lds
    v_permlane32_swap_b32 v36, v38
    v_permlane32_swap_b32 v37, v39
    v_add_f32 v36, v36, v38
    v_add_f32 v37, v37, v39
    s_nop 1
    v_permlane16_swap_b32 v36, v37
    v_add_f32_e64 v36, v36, v37
    v_cvt_pk_bf16_f32 v37, v36, v36
    v_and_b32 v37, 0xffff0000, v37
    s_add_u32 m0, s84, 57344
    s_mov_b32 s100, 917504
    buffer_load_dwordx4 v246, s[40:43], s100 offen  lds
    v_sub_f32_e64 v38, v36, v37
    v_cvt_pk_bf16_f32 v38, v37, v38
    v_mov_b32 v39, 0
    v_and_b32 v196, 15, v2
    v_lshrrev_b32_e64 v197, 4, v2
    v_lshl_add_u32 v196, v196, 2, v197
    s_lshl_b32 s78, s76, 9
    s_add_u32 m0, s84, 61440
    s_mov_b32 s100, 983040
    buffer_load_dwordx4 v246, s[40:43], s100 offen  lds
    s_add_u32 s78, s78, 160768
    v_lshl_add_u32 v196, v196, 3, s78
    v_and_b32 v197, 15, v2
    v_lshlrev_b32_e64 v197, 3, v197
    v_add_u32 v197, 162816, v197
    v_mov_b32 v198, 0x3f803f80
    s_cmp_eq_u32 s76, 3
    s_cselect_b64 vcc, -1, 0
    v_cndmask_b32 v196, v196, v197, vcc
    v_cndmask_b32 v38, v38, v198, vcc
    v_cndmask_b32_e64 v39, v39, v198, vcc
    ds_write_b64 v196, v[38:39]
    s_setprio 0
    s_waitcnt lgkmcnt(0)
    s_barrier
L_phend:
    s_mov_b32 s66, s96
    s_add_u32 m0, s84, 65536
    s_mov_b32 s100, 1048576
    buffer_load_dwordx4 v246, s[40:43], s100 offen  lds
    v_lshrrev_b32 v52, 2, v2
    v_and_b32 v53, 7, v52
    v_and_b32_e64 v55, 3, v2
    s_add_u32 m0, s84, 69632
    s_mov_b32 s100, 1114112
    buffer_load_dwordx4 v246, s[40:43], s100 offen  lds
    v_xor_b32 v53, v53, v55
    v_lshlrev_b32 v52, 7, v52
    v_lshrrev_b32_e64 v55, 1, v55
    s_add_u32 m0, s84, 73728
    s_mov_b32 s100, 1179648
    buffer_load_dwordx4 v246, s[40:43], s100 offen  lds
    v_lshl_add_u32 v52, v55, 3, v52
    s_lshr_b32 s78, s76, 1
    s_and_b32 s79, s76, 1
    s_lshl_b32 s80, s79, 2
    s_add_u32 m0, s84, 77824
    s_mov_b32 s100, 1245184
    buffer_load_dwordx4 v246, s[40:43], s100 offen  lds
    s_lshl_b32 s81, s78, 2
    v_xor_b32 v55, s80, v53
    v_xor_b32 v53, s81, v53
    s_add_u32 m0, s84, 81920
    s_mov_b32 s100, 1310720
    buffer_load_dwordx4 v246, s[40:43], s100 offen  lds
    s_lshl_b32 s80, s78, 14
    s_add_u32 s80, s80, 110592
    v_lshl_add_u32 v196, v55, 4, v52
    v_add_u32 v196, s80, v196
    s_add_u32 m0, s84, 86016
    s_mov_b32 s100, 1376256
    buffer_load_dwordx4 v246, s[40:43], s100 offen  lds
    v_lshl_add_u32 v198, v53, 4, v52
    v_add_u32 v198, 143360, v198
    v_xor_b32_e64 v197, 8, v196
    s_add_u32 m0, s84, 90112
    s_mov_b32 s100, 1441792
    buffer_load_dwordx4 v246, s[40:43], s100 offen  lds
    v_xor_b32_e64 v199, 8, v198
    v_mov_b32 v200, 0x3f803f80
    v_mov_b32 v201, 0x3f803f80
    v_mov_b32 v202, 0x3f803f80
    s_add_u32 m0, s84, 94208
    s_mov_b32 s100, 1507328
    buffer_load_dwordx4 v246, s[40:43], s100 offen  lds
    v_mov_b32 v203, 0x3f803f80
    v_lshrrev_b32 v62, 4, v2
    v_and_b32 v52, 15, v2
    s_add_u32 m0, s84, 98304
    s_mov_b32 s100, 1572864
    buffer_load_dwordx4 v246, s[40:43], s100 offen  lds
    v_lshlrev_b32_e64 v53, 4, v52
    v_lshl_add_u32 v62, v62, 13, v53
    v_lshrrev_b32_e64 v52, 3, v52
    v_lshl_add_u32 v62, v52, 8, v62
    s_add_u32 m0, s84, 102400
    s_mov_b32 s100, 1638400
    buffer_load_dwordx4 v246, s[40:43], s100 offen  lds
    v_xor_b32 v63, 256, v62
    s_lshl_b32 s78, s70, 2
    s_add_u32 s78, s78, s76
    s_add_u32 m0, s84, 106496
    s_mov_b32 s100, 1703936
    buffer_load_dwordx4 v246, s[40:43], s100 offen  lds
    s_lshl_b32 s78, s78, 15
    s_lshl_b32 s79, s69, 9
    s_add_u32 s78, s78, s79
    s_add_u32 s78, s78, 2097152
    s_mov_b32 s100, 2031616
    buffer_load_dwordx4 v[160:163], v246, s[40:43], s100 offen
    s_lshl_b32 s79, s77, 10
    s_lshl_b32 s80, s76, 6
    s_add_u32 s79, s79, s80
    s_mov_b32 s100, 1966080
    buffer_load_dwordx4 v[164:167], v246, s[40:43], s100 offen
    s_add_u32 s79, s79, 8389120
    v_lshrrev_b32 v52, 3, v2
    v_and_b32 v53, 7, v2
    v_lshlrev_b32_e64 v53, 4, v53
    s_mov_b32 s100, 1900544
    buffer_load_dwordx4 v[168:171], v246, s[40:43], s100 offen
    v_lshl_add_u32 v56, v52, 9, v53
    v_lshl_add_u32 v57, v52, 1, v53
    s_lshl_b32 s82, s70, 14
    s_mov_b32 s100, 1835008
    buffer_load_dwordx4 v[172:175], v246, s[40:43], s100 offen
    s_add_u32 s82, s82, s80
    s_add_u32 s82, s82, 8389120
    s_add_u32 s80, s80, 162944
    v_lshrrev_b32_e64 v58, 2, v2
    s_mov_b32 s100, 1769472
    buffer_load_dwordx4 v[176:179], v246, s[40:43], s100 offen
    v_and_b32 v53, 3, v2
    v_lshlrev_b32 v53, 4, v53
    v_lshl_add_u32 v58, v58, 10, v53
    s_mov_b32 s100, 0
    buffer_load_dwordx4 v[180:183], v247, s[28:31], s100 offen
    v_lshl_add_u32 v59, v52, 1, v53
    v_add_u32 v59, s80, v59
    s_lshl_b32 s64, s77, 13
    s_lshl_b32 s80, s76, 7
    s_mov_b32 s100, 16384
    buffer_load_dwordx4 v[184:187], v248, s[28:31], s100 offen
    s_add_u32 s64, s64, s80
    s_add_u32 s64, s64, 2097152
    s_add_u32 s65, s64, 4096
    s_mov_b32 s100, 32768
    buffer_load_dwordx4 v[188:191], v247, s[28:31], s100 offen
    s_lshl_b32 s81, s77, 10
    s_add_u32 s81, s81, s80
    s_add_u32 s81, s81, 8388608
    s_lshl_b32 s80, s71, 9
    s_mov_b32 s100, 49152
    buffer_load_dwordx4 v[192:195], v248, s[28:31], s100 offen
    s_add_u32 s80, s80, 8912896
    v_lshl_add_u32 v61, v2, 13, s80
    v_mov_b32 v52, 163584
    s_lshl_b32 s100, s77, 13
    s_add_u32 s100, s100, s89
    s_add_u32 s100, s100, 2097152
    buffer_load_dwordx4 v[252:255], v14, s[36:39], s100 offen offset:0 sc1
    ds_read_b32 v52, v52
    s_waitcnt lgkmcnt(0)
    v_readfirstlane_b32 s99, v52
    s_and_b32 s94, s69, 1
    s_lshl_b32 s100, s77, 13
    s_add_u32 s100, s100, s89
    s_nop 0
    s_add_u32 s100, s100, 2097152
    buffer_load_dwordx4 v[252:255], v14, s[36:39], s100 offen offset:1024 sc1
    s_mul_i32 s94, s94, 0x00010001
    s_mov_b32 s95, 0xfffefffe
    s_and_b32 s96, s75, 0x00010001
    buffer_load_dwordx4 v[252:255], v14, s[36:39], s66 offen sc1
    v_mov_b32_e64 v54, s96
    s_and_b32 s83, s75, 1
    s_lshl_b32 s83, s83, 16
    s_sub_u32 s83, 0, s83
    s_barrier
    ds_read_b64_tr_b16 v[4:5], v196 offset:0
    ds_read_b64_tr_b16 v[6:7], v196 offset:2048
    ds_read_b64_tr_b16 v[12:13], v198 offset:0
    ds_read_b64_tr_b16 v[14:15], v198 offset:2048
    ds_read_b64_tr_b16 v[8:9], v197 offset:0
    ds_read_b64_tr_b16 v[10:11], v197 offset:2048
    ds_read_b64_tr_b16 v[16:17], v199 offset:0
    ds_read_b64_tr_b16 v[18:19], v199 offset:2048
    ds_read_b64_tr_b16 v[20:21], v196 offset:4096
    ds_read_b64_tr_b16 v[22:23], v196 offset:6144
    ds_read_b64_tr_b16 v[28:29], v198 offset:4096
    ds_read_b64_tr_b16 v[30:31], v198 offset:6144
    ds_read_b64_tr_b16 v[24:25], v197 offset:4096
    ds_read_b64_tr_b16 v[26:27], v197 offset:6144
    s_waitcnt lgkmcnt(10)
    v_mfma_f32_16x16x32_bf16 v[204:207], v[4:7], v[12:15], 0
    ds_read_b64_tr_b16 v[32:33], v199 offset:4096
    ds_read_b64_tr_b16 v[34:35], v199 offset:6144
    s_waitcnt lgkmcnt(10)
    v_mfma_f32_16x16x32_bf16 v[208:211], v[8:11], v[12:15], 0
    ds_read_b64_tr_b16 v[36:37], v196 offset:8192
    ds_read_b64_tr_b16 v[38:39], v196 offset:10240
    s_waitcnt lgkmcnt(10)
    s_nop 0
    v_mfma_f32_16x16x32_bf16 v[216:219], v[8:11], v[16:19], 0
    ds_read_b64_tr_b16 v[44:45], v198 offset:8192
    ds_read_b64_tr_b16 v[46:47], v198 offset:10240
    v_mfma_f32_16x16x32_bf16 v[212:215], v[4:7], v[16:19], 0
    ds_read_b64_tr_b16 v[40:41], v197 offset:8192
    ds_read_b64_tr_b16 v[42:43], v197 offset:10240
    s_waitcnt lgkmcnt(10)
    v_mfma_f32_16x16x32_bf16 v[204:207], v[20:23], v[28:31], v[204:207]
    ds_read_b64_tr_b16 v[48:49], v199 offset:8192
    ds_read_b64_tr_b16 v[50:51], v199 offset:10240
    s_waitcnt lgkmcnt(10)
    v_mfma_f32_16x16x32_bf16 v[208:211], v[24:27], v[28:31], v[208:211]
    ds_read_b64_tr_b16 v[228:229], v196 offset:12288
    ds_read_b64_tr_b16 v[230:231], v196 offset:14336
    s_waitcnt lgkmcnt(10)
    s_nop 0
    v_mfma_f32_16x16x32_bf16 v[216:219], v[24:27], v[32:35], v[216:219]
    ds_read_b64_tr_b16 v[236:237], v198 offset:12288
    ds_read_b64_tr_b16 v[238:239], v198 offset:14336
    v_mfma_f32_16x16x32_bf16 v[212:215], v[20:23], v[32:35], v[212:215]
    ds_read_b64_tr_b16 v[232:233], v197 offset:12288
    ds_read_b64_tr_b16 v[234:235], v197 offset:14336
    s_waitcnt lgkmcnt(10)
    v_mfma_f32_16x16x32_bf16 v[204:207], v[36:39], v[44:47], v[204:207]
    ds_read_b64_tr_b16 v[240:241], v199 offset:12288
    ds_read_b64_tr_b16 v[242:243], v199 offset:14336
    s_waitcnt lgkmcnt(10)
    v_mfma_f32_16x16x32_bf16 v[208:211], v[40:43], v[44:47], v[208:211]
    s_waitcnt lgkmcnt(8)
    v_mfma_f32_16x16x32_bf16 v[216:219], v[40:43], v[48:51], v[216:219]
L_pad1:
    s_cbranch_execz L_pad5
    v_mfma_f32_16x16x32_bf16 v[212:215], v[36:39], v[48:51], v[212:215]
    s_waitcnt lgkmcnt(4)
    v_mfma_f32_16x16x32_bf16 v[204:207], v[228:231], v[236:239], v[204:207]
    s_waitcnt lgkmcnt(2)
    v_mfma_f32_16x16x32_bf16 v[208:211], v[232:235], v[236:239], v[208:211]
    s_waitcnt lgkmcnt(0)
    s_nop 0
    v_mfma_f32_16x16x32_bf16 v[216:219], v[232:235], v[240:243], v[216:219]
    v_mfma_f32_16x16x32_bf16 v[212:215], v[228:231], v[240:243], v[212:215]
    v_mfma_f32_16x16x32_bf16 v[220:223], v[4:7], v[200:203], 0
    v_mfma_f32_16x16x32_bf16 v[224:227], v[8:11], v[200:203], 0
    v_mfma_f32_16x16x32_bf16 v[220:223], v[20:23], v[200:203], v[220:223]
    v_mfma_f32_16x16x32_bf16 v[224:227], v[24:27], v[200:203], v[224:227]
    v_cvt_pk_bf16_f32 v12, v204, v205
    v_cvt_pk_bf16_f32 v13, v206, v207
    v_cvt_pk_bf16_f32 v14, v208, v209
    v_cvt_pk_bf16_f32 v15, v210, v211
    v_mfma_f32_16x16x32_bf16 v[220:223], v[36:39], v[200:203], v[220:223]
    v_add_u32_e64 v12, s94, v12
    v_and_or_b32 v12, v12, s95, v54
    v_mfma_f32_16x16x32_bf16 v[224:227], v[40:43], v[200:203], v[224:227]
    v_add_u32_e64 v13, s94, v13
    v_and_or_b32 v13, v13, s95, v54
    v_mfma_f32_16x16x32_bf16 v[220:223], v[228:231], v[200:203], v[220:223]
    v_add_u32_e64 v14, s94, v14
    v_and_or_b32 v14, v14, s95, v54
    v_mfma_f32_16x16x32_bf16 v[224:227], v[232:235], v[200:203], v[224:227]
    v_add_u32_e64 v15, s94, v15
    v_and_or_b32 v15, v15, s95, v54
    s_bitcmp1_b32 s99, 0
    s_cbranch_scc0 Lls_19
    buffer_store_dwordx4 v[12:15], v62, s[36:39], s78 offen
Lle_20:
    v_cvt_pk_bf16_f32 v28, v212, v213
    v_cvt_pk_bf16_f32 v29, v214, v215
    v_cvt_pk_bf16_f32 v30, v216, v217
    v_cvt_pk_bf16_f32 v31, v218, v219
    v_add_u32_e64 v28, s94, v28
    v_and_or_b32 v28, v28, s95, v54
    v_add_u32_e64 v29, s94, v29
    v_and_or_b32 v29, v29, s95, v54
    v_add_u32_e64 v30, s94, v30
    v_and_or_b32 v30, v30, s95, v54
    v_add_u32_e64 v31, s94, v31
    v_and_or_b32 v31, v31, s95, v54
    s_bitcmp1_b32 s99, 0
    s_cbranch_scc0 Lls_21
    buffer_store_dwordx4 v[28:31], v63, s[36:39], s78 offen
Lle_22:
    v_cvt_pk_bf16_f32 v44, v220, v221
    v_cvt_pk_bf16_f32 v45, v222, v223
    v_cvt_pk_bf16_f32 v46, v224, v225
    v_cvt_pk_bf16_f32 v47, v226, v227
    s_mov_b32 exec_lo, 0x00010001
    s_mov_b32 exec_hi, 0x00010001
    s_bitcmp1_b32 s99, 0
    s_cbranch_scc0 Lls_23
    buffer_store_dwordx4 v[44:47], v2, s[36:39], s79 offen
Lle_24:
    s_mov_b64 exec, -1
    s_mov_b32 s85, 0
Lspin_25:
    buffer_load_dwordx4 v[20:23], v56, s[36:39], s64 offen sc1
    buffer_load_dwordx4 v[24:27], v56, s[36:39], s65 offen sc1
    buffer_load_dwordx4 v[16:19], v58, s[36:39], s82 offen sc1
    s_add_u32 s85, s85, 1
    s_cmp_gt_u32 s85, 400000
    s_cbranch_scc1 L_end
    s_waitcnt vmcnt(0)
    s_nop 0
    v_bitop3_b32 v28, v20, v24, v54 bitop3:0x7e
    v_bitop3_b32 v29, v21, v25, v54 bitop3:0x7e
    v_bitop3_b32 v30, v22, v26, v54 bitop3:0x7e
    v_bitop3_b32 v31, v23, v27, v54 bitop3:0x7e
    v_or3_b32 v28, v28, v29, v30
    v_cmp_eq_u32 s[90:91], -1, v16
    v_or_b32_e64 v28, v28, v31
    v_and_b32 v28, 0x00010001, v28
    v_cmp_ne_u32_e64 vcc, 0, v28
    s_or_b64 vcc, vcc, s[90:91]
    s_cbranch_vccnz Lspin_25
    v_lshl_add_u32 v28, v20, 16, s83
    v_and_b32 v29, 0xfffe0000, v20
    v_lshl_add_u32 v36, v24, 16, s83
    v_and_b32 v37, 0xfffe0000, v24
    v_pk_add_f32 v[28:29], v[28:29], v[36:37]
    v_lshl_add_u32 v30, v21, 16, s83
    v_and_b32 v31, 0xfffe0000, v21
    v_lshl_add_u32 v38, v25, 16, s83
    v_and_b32 v39, 0xfffe0000, v25
    v_pk_add_f32 v[30:31], v[30:31], v[38:39]
    v_lshl_add_u32 v32, v22, 16, s83
    v_and_b32 v33, 0xfffe0000, v22
    v_lshl_add_u32 v40, v26, 16, s83
    v_and_b32 v41, 0xfffe0000, v26
    v_pk_add_f32 v[32:33], v[32:33], v[40:41]
    v_lshl_add_u32 v34, v23, 16, s83
    v_and_b32 v35, 0xfffe0000, v23
    v_lshl_add_u32 v42, v27, 16, s83
    v_and_b32 v43, 0xfffe0000, v27
    v_pk_add_f32 v[34:35], v[34:35], v[42:43]
    v_permlane32_swap_b32 v28, v32
    v_permlane32_swap_b32 v29, v33
    v_permlane32_swap_b32 v30, v34
    v_permlane32_swap_b32 v31, v35
    v_pk_add_f32 v[28:29], v[28:29], v[32:33]
    v_pk_add_f32 v[30:31], v[30:31], v[34:35]
    s_nop 1
    v_permlane16_swap_b32 v28, v30
    v_permlane16_swap_b32_e64 v29, v31
    v_pk_add_f32 v[28:29], v[28:29], v[30:31]
    s_nop 1
    v_add_f32_dpp v28, v28, v28 row_ror:8 row_mask:0xf bank_mask:0xf
    v_add_f32_dpp v29, v29, v29 row_ror:8 row_mask:0xf bank_mask:0xf
    v_cvt_pk_bf16_f32 v36, v28, v29
    s_mov_b32 exec_lo, 0x00ff00ff
    s_mov_b32 exec_hi, 0x00ff00ff
    s_bitcmp1_b32 s99, 0
    s_cbranch_scc0 Lls_26
    buffer_store_dword v36, v57, s[36:39], s81 offen
Lle_27:
    s_mov_b64 exec, -1
    v_lshlrev_b32_e64 v28, 16, v16
    v_and_b32 v29, 0xffff0000, v16
    v_lshlrev_b32_e64 v30, 16, v17
    v_and_b32 v31, 0xffff0000, v17
    v_lshlrev_b32_e64 v32, 16, v18
    v_and_b32 v33, 0xffff0000, v18
    v_lshlrev_b32_e64 v34, 16, v19
    v_and_b32 v35, 0xffff0000, v19
    v_permlane32_swap_b32 v28, v32
    v_permlane32_swap_b32 v29, v33
    v_permlane32_swap_b32 v30, v34
    v_permlane32_swap_b32 v31, v35
    v_pk_add_f32 v[28:29], v[28:29], v[32:33]
    v_pk_add_f32 v[30:31], v[30:31], v[34:35]
    s_nop 1
    v_permlane16_swap_b32 v28, v30
    v_permlane16_swap_b32_e64 v29, v31
    v_pk_add_f32 v[28:29], v[28:29], v[30:31]
    s_nop 1
    v_add_f32_dpp v38, v28, v28 row_ror:8 row_mask:0xf bank_mask:0x3
    s_nop 1
    v_add_f32_dpp v38, v29, v29 row_ror:8 row_mask:0xf bank_mask:0xc
    s_nop 1
    v_add_f32_dpp v37, v38, v38 row_shr:4 row_mask:0xf bank_mask:0xf
    v_cvt_pk_bf16_f32 v37, v37, v37
    s_mov_b32 exec_lo, 0xf0f0f0f0
    s_mov_b32 exec_hi, 0xf0f0f0f0
    ds_write_b16 v59, v37
    s_mov_b64 exec, -1
    s_waitcnt lgkmcnt(0)
    s_barrier
    v_lshlrev_b32 v4, 4, v2
    s_lshl_b32 s78, s76, 10
    s_add_u32 s78, s78, 110592
    v_add_u32 v5, s78, v4
    s_lshl_b32 s78, s76, 12
    s_add_u32 s78, s78, 131072
    v_add_u32 v6, s78, v4
    s_lshl_b32 s100, s77, 9
    s_add_u32 s100, s100, 8912896
    v_mov_b32 v48, s75
    v_mov_b32 v49, s75
    v_lshl_add_u32 v50, v2, 3, s100
    s_lshl_b32 s83, s71, 4
    s_add_u32 s83, s83, s72
    s_lshl_b32 s78, s0, 11
    s_and_b32 s79, s76, 1
    s_lshl_b32 s79, s79, 10
    s_add_u32 s78, s78, s79
    s_add_u32 s78, s78, 655360
    s_mul_i32 s79, s74, 56
    s_add_u32 s79, s79, s73
    s_lshl_b32 s79, s79, 10
    s_add_u32 s79, s79, 1114112
    s_cmp_eq_u32 s76, 1
    s_cselect_b32 s78, s79, s78
    s_cmp_ge_u32 s73, 56
    s_cselect_b32 s78, 0x10000000, s78
    s_lshl_b32 s79, s83, 11
    s_add_u32 s79, s79, s84
    s_add_u32 s79, s79, 1572864
    s_cmp_lt_u32 s76, 2
    s_cselect_b32 s94, s79, s78
    s_lshl_b32 s79, s83, 9
    s_add_u32 s79, s79, 524288
    s_cmp_eq_u32 s76, 0
    s_cselect_b32 s78, s79, s78
    s_cselect_b32 s79, 0, -1
    v_mov_b32 v56, -1
    v_mov_b32 v57, -1
    v_mov_b32 v58, -1
    v_mov_b32_e64 v59, -1
    s_barrier
    s_mov_b32 s100, 43008
    buffer_load_dwordx4 v[88:91], v244, s[48:51], s100 offen nt
    s_mov_b32 s100, 43008
    buffer_load_dwordx4 v[120:123], v244, s[52:55], s100 offen nt
    s_mov_b32 s100, 50176
    buffer_load_dwordx4 v[92:95], v244, s[48:51], s100 offen nt
    s_mov_b32 s100, 50176
    buffer_load_dwordx4 v[124:127], v244, s[52:55], s100 offen nt
    ds_write_b128 v6, v[180:183] offset:0
    ds_write_b128 v6, v[184:187] offset:1024
    ds_write_b128 v6, v[188:191] offset:2048
    ds_write_b128 v6, v[192:195] offset:3072
    ds_write_b128 v5, v[160:163] offset:16384
    ds_write_b128 v5, v[164:167] offset:12288
    ds_write_b128 v5, v[168:171] offset:8192
    ds_write_b128 v5, v[172:175] offset:4096
    ds_write_b128 v5, v[176:179] offset:0
    s_waitcnt lgkmcnt(0)
    s_barrier
    s_cmp_lg_u32 s76, 0
    s_cbranch_scc1 Lfs_28
    buffer_store_dwordx2 v[48:49], v50, s[36:39], 0 offen sc1
Lfs_28:
    s_mov_b32 exec_hi, s79
    buffer_store_dwordx4 v[56:59], v4, s[36:39], s78 offen sc1
    s_mov_b32 exec_hi, -1
    s_mov_b32 s100, 0x05040100
    s_mov_b32 s101, 0x07060302
    v_perm_b32 v7, v68, v64, s100
    v_perm_b32 v68, v68, v64, s101
    v_mov_b32_e64 v64, v7
    v_perm_b32 v7, v69, v65, s100
    v_perm_b32 v69, v69, v65, s101
    v_mov_b32_e64 v65, v7
    v_perm_b32 v7, v70, v66, s100
    v_perm_b32 v70, v70, v66, s101
    v_mov_b32_e64 v66, v7
    v_perm_b32 v7, v71, v67, s100
    v_perm_b32 v71, v71, v67, s101
    v_mov_b32_e64 v67, v7
    v_perm_b32 v7, v100, v96, s100
    v_perm_b32 v100, v100, v96, s101
    v_mov_b32_e64 v96, v7
    v_perm_b32 v7, v101, v97, s100
    v_perm_b32 v101, v101, v97, s101
    v_mov_b32_e64 v97, v7
    v_perm_b32 v7, v102, v98, s100
    v_perm_b32 v102, v102, v98, s101
    v_mov_b32_e64 v98, v7
    v_perm_b32 v7, v103, v99, s100
    v_perm_b32 v103, v103, v99, s101
    v_mov_b32_e64 v99, v7
    v_perm_b32 v7, v76, v72, s100
    v_perm_b32 v76, v76, v72, s101
    v_mov_b32_e64 v72, v7
    v_perm_b32 v7, v77, v73, s100
    v_perm_b32 v77, v77, v73, s101
    v_mov_b32_e64 v73, v7
    v_perm_b32 v7, v78, v74, s100
    v_perm_b32 v78, v78, v74, s101
    v_mov_b32_e64 v74, v7
    v_perm_b32 v7, v79, v75, s100
    v_perm_b32 v79, v79, v75, s101
    v_mov_b32_e64 v75, v7
    v_perm_b32 v7, v108, v104, s100
    v_perm_b32 v108, v108, v104, s101
    v_mov_b32_e64 v104, v7
    v_perm_b32 v7, v109, v105, s100
    v_perm_b32 v109, v109, v105, s101
    v_mov_b32_e64 v105, v7
    v_perm_b32 v7, v110, v106, s100
    v_perm_b32 v110, v110, v106, s101
    v_mov_b32_e64 v106, v7
    v_perm_b32 v7, v111, v107, s100
    v_perm_b32 v111, v111, v107, s101
    v_mov_b32_e64 v107, v7
    v_perm_b32 v7, v84, v80, s100
    v_perm_b32 v84, v84, v80, s101
    v_mov_b32_e64 v80, v7
    v_perm_b32 v7, v85, v81, s100
    v_perm_b32 v85, v85, v81, s101
    v_mov_b32_e64 v81, v7
    v_perm_b32 v7, v86, v82, s100
    v_perm_b32 v86, v86, v82, s101
    v_mov_b32_e64 v82, v7
    v_perm_b32 v7, v87, v83, s100
    v_perm_b32 v87, v87, v83, s101
    v_mov_b32_e64 v83, v7
    v_perm_b32 v7, v116, v112, s100
    v_perm_b32 v116, v116, v112, s101
    v_mov_b32_e64 v112, v7
    v_perm_b32 v7, v117, v113, s100
    v_perm_b32 v117, v117, v113, s101
    v_mov_b32_e64 v113, v7
    v_perm_b32 v7, v118, v114, s100
    v_perm_b32 v118, v118, v114, s101
    v_mov_b32_e64 v114, v7
    v_perm_b32 v7, v119, v115, s100
    v_perm_b32 v119, v119, v115, s101
    v_mov_b32_e64 v115, v7
    s_cmp_lg_u32 s76, 2
    s_cbranch_scc1 Lf2_29
    s_mov_b64 exec, 0xffff
    s_mov_b32 s101, 0
    s_mov_b32 s85, 0
Lspin_30:
    buffer_load_dword v52, v61, s[36:39], s101 offen sc1
    s_add_u32 s101, s101, 128
L_pad2:
    s_cbranch_execz L_pad6
    s_min_u32 s101, s101, 384
    s_add_u32 s85, s85, 1
    s_cmp_gt_u32 s85, 400000
    s_cbranch_scc1 L_end
    s_waitcnt vmcnt(0)
    v_cmp_ne_u32_e64 vcc, s75, v52
    s_cbranch_vccnz Lspin_30
    s_mov_b64 exec, -1
Lf2_29:
    s_barrier
    s_waitcnt vmcnt(0)
    s_mov_b32 s100, 0x05040100
    s_mov_b32 s101, 0x07060302
    v_perm_b32 v7, v92, v88, s100
    v_perm_b32 v92, v92, v88, s101
    v_mov_b32_e64 v88, v7
    v_perm_b32 v7, v93, v89, s100
    v_perm_b32 v93, v93, v89, s101
    v_mov_b32_e64 v89, v7
    v_perm_b32 v7, v94, v90, s100
    v_perm_b32 v94, v94, v90, s101
    v_mov_b32_e64 v90, v7
    v_perm_b32 v7, v95, v91, s100
    v_perm_b32 v95, v95, v91, s101
    v_mov_b32_e64 v91, v7
    v_perm_b32 v7, v124, v120, s100
    v_perm_b32 v124, v124, v120, s101
    v_mov_b32_e64 v120, v7
    v_perm_b32 v7, v125, v121, s100
    v_perm_b32 v125, v125, v121, s101
    v_mov_b32_e64 v121, v7
    v_perm_b32 v7, v126, v122, s100
    v_perm_b32 v126, v126, v122, s101
    v_mov_b32_e64 v122, v7
    v_perm_b32 v7, v127, v123, s100
    v_perm_b32 v127, v127, v123, s101
    v_mov_b32 v123, v7
    v_lshrrev_b32 v8, 3, v2
    v_and_b32 v9, 7, v2
    v_lshlrev_b32 v10, 4, v9
    v_lshl_add_u32 v11, v8, 13, v10
    v_and_b32 v12, 15, v2
    v_lshlrev_b32 v12, 13, v12
    v_lshl_add_u32 v13, v8, 9, v10
    v_lshl_add_u32 v14, v9, 3, v8
    s_lshl_b32 s80, s74, 2
    s_add_u32 s80, s80, s76
    s_lshl_b32 s78, s80, 9
    s_add_u32 s78, s78, 524288
    s_add_u32 s79, s78, 65536
    s_add_u32 s81, s73, s76
    s_and_b32 s81, s81, 3
    s_andn2_b32 s100, s73, 3
    s_or_b32 s81, s81, s100
    s_lshl_b32 s81, s81, 13
    s_lshl_b32 s80, s80, 9
    s_add_u32 s80, s80, s81
    s_add_u32 s80, s80, 655360
    s_lshl_b32 s81, s73, 13
    s_add_u32 s81, s81, 655360
    v_add_u32 v47, 0x10000, v11
    s_lshl_b32 s64, s76, 7
    s_add_u32 s64, s64, s81
    s_add_u32 s65, s64, 4096
    v_lshrrev_b32 v50, 5, v2
    v_lshl_add_u32 v50, v9, 1, v50
    s_lshl_b32 s82, s76, 5
    s_add_u32 s82, s82, 163456
    v_lshl_add_u32 v50, v50, 1, s82
    v_lshlrev_b32 v27, 4, v8
    v_add_u32 v51, 163456, v27
    v_lshlrev_b32 v49, 2, v14
    v_lshlrev_b32 v15, 3, v14
    v_mov_b32 v26, 163360
    s_mul_i32 s66, s74, 56
    s_add_u32 s66, s66, s73
    s_lshl_b32 s66, s66, 10
    s_lshl_b32 s82, s76, 8
    s_add_u32 s66, s66, s82
    s_add_u32 s66, s66, 1114112
    s_barrier
    buffer_load_dwordx4 v[56:59], v4, s[36:39], s94 offen sc1
    s_mov_b32 s100, 0
    s_nop 0
    buffer_load_dwordx4 v[128:131], v245, s[56:59], s100 offen nt
    s_mov_b32 s100, 2048
    buffer_load_dwordx4 v[132:135], v245, s[56:59], s100 offen nt
    s_mov_b32 s100, 4096
    buffer_load_dwordx4 v[136:139], v245, s[56:59], s100 offen nt
    s_mov_b32 s100, 6144
    buffer_load_dwordx4 v[140:143], v245, s[56:59], s100 offen nt
    s_mov_b32 s100, 8192
    buffer_load_dwordx4 v[144:147], v245, s[56:59], s100 offen nt
    s_barrier
    s_waitcnt vmcnt(0)
    s_mov_b32 s100, 0x05040100
    s_mov_b32 s101, 0x07060302
    v_perm_b32 v7, v132, v128, s100
    v_perm_b32 v132, v132, v128, s101
    v_mov_b32_e64 v128, v7
    v_perm_b32 v7, v133, v129, s100
    v_perm_b32 v133, v133, v129, s101
    v_mov_b32_e64 v129, v7
    v_perm_b32 v7, v134, v130, s100
    v_perm_b32 v134, v134, v130, s101
    v_mov_b32_e64 v130, v7
    v_perm_b32 v7, v135, v131, s100
    v_perm_b32 v135, v135, v131, s101
    v_mov_b32_e64 v131, v7
    v_perm_b32 v7, v140, v136, s100
    v_perm_b32 v140, v140, v136, s101
    v_mov_b32_e64 v136, v7
    v_perm_b32 v7, v141, v137, s100
    v_perm_b32 v141, v141, v137, s101
    v_mov_b32_e64 v137, v7
    v_perm_b32 v7, v142, v138, s100
    v_perm_b32 v142, v142, v138, s101
    v_mov_b32_e64 v138, v7
    v_perm_b32 v7, v143, v139, s100
    v_perm_b32 v143, v143, v139, s101
    v_mov_b32 v139, v7
    s_barrier
    s_mov_b32 s100, 10240
    buffer_load_dwordx4 v[148:151], v245, s[56:59], s100 offen nt
    s_mov_b32 s100, 12288
    buffer_load_dwordx4 v[152:155], v245, s[56:59], s100 offen nt
    s_mov_b32 s100, 14336
    buffer_load_dwordx4 v[156:159], v245, s[56:59], s100 offen nt
    s_and_b32 s79, s2, 7
    s_lshl_b32 s79, s79, 9
    s_add_u32 s79, s79, 524288
    s_mov_b64 exec, 0xffff
    s_sleep 20
    s_mov_b32 s85, 0
Lspin_31:
    buffer_load_dwordx2 v[24:25], v12, s[36:39], s79 offen offset:128 sc1
    s_or_b32 s79, s79, 4096
    s_add_u32 s85, s85, 1
    s_cmp_gt_u32 s85, 400000
    s_cbranch_scc1 L_end
    s_waitcnt vmcnt(0)
    v_cmp_ne_u32_e64 vcc, s75, v25
    s_cbranch_vccnz Lspin_31
    v_max_f32_dpp v24, v24, v24 row_ror:8 row_mask:0xf bank_mask:0xf
    s_nop 1
    v_max_f32_dpp v24, v24, v24 row_ror:4 row_mask:0xf bank_mask:0xf
    s_nop 1
    v_max_f32_dpp v24, v24, v24 row_ror:2 row_mask:0xf bank_mask:0xf
    s_nop 1
    v_max_f32_dpp v24, v24, v24 row_ror:1 row_mask:0xf bank_mask:0xf
    s_nop 0
    v_readfirstlane_b32 s97, v24
    s_mov_b64 exec, -1
    s_nop 0
    v_mov_b32 v24, s97
    s_cmp_ge_u32 s73, 56
    s_cbranch_scc1 L_red
    s_bfe_u32 s79, s97, 0x40007
    s_lshl_b32 s79, s79, 13
    s_add_u32 s78, s78, s79
    buffer_load_dwordx4 v[20:23], v27, s[36:39], s78 offen sc1
    ds_write_b32 v26, v24
    s_mov_b32 s85, 1
    s_mov_b32 s100, 0x05040100
    s_mov_b32 s101, 0x07060302
    v_perm_b32 v7, v148, v144, s100
    v_perm_b32 v148, v148, v144, s101
    v_mov_b32 v144, v7
    v_perm_b32 v7, v149, v145, s100
    v_perm_b32 v149, v149, v145, s101
    v_mov_b32_e64 v145, v7
    v_perm_b32 v7, v150, v146, s100
    v_perm_b32 v150, v150, v146, s101
    v_mov_b32_e64 v146, v7
    v_perm_b32 v7, v151, v147, s100
    v_perm_b32 v151, v151, v147, s101
    v_mov_b32_e64 v147, v7
    v_perm_b32 v7, v156, v152, s100
    v_perm_b32 v156, v156, v152, s101
    v_mov_b32_e64 v152, v7
    v_perm_b32 v7, v157, v153, s100
    v_perm_b32 v157, v157, v153, s101
    v_mov_b32_e64 v153, v7
    v_perm_b32 v7, v158, v154, s100
    v_perm_b32 v158, v158, v154, s101
    v_mov_b32_e64 v154, v7
    v_perm_b32 v7, v159, v155, s100
    v_perm_b32 v159, v159, v155, s101
    v_mov_b32 v155, v7
Lb_33:
    s_waitcnt vmcnt(0) lgkmcnt(0)
    v_max3_u32 v16, v20, v21, v22
    v_max_u32 v16, v16, v23
    v_cmp_eq_u32_e64 vcc, -1, v16
    s_cbranch_vccnz Lspin_32
    v_dot2_f32_bf16 v28, v64, v20, 0
    v_dot2_f32_bf16 v29, v68, v20, 0
    v_dot2_f32_bf16 v30, v65, v20, 0
    v_dot2_f32_bf16 v31, v69, v20, 0
    v_dot2_f32_bf16 v32, v66, v20, 0
    v_dot2_f32_bf16 v33, v70, v20, 0
    v_dot2_f32_bf16 v34, v67, v20, 0
    v_dot2_f32_bf16 v35, v71, v20, 0
    v_dot2_f32_bf16 v28, v72, v21, v28
    v_dot2_f32_bf16 v29, v76, v21, v29
    v_dot2_f32_bf16 v30, v73, v21, v30
    v_dot2_f32_bf16 v31, v77, v21, v31
    v_dot2_f32_bf16 v32, v74, v21, v32
    v_dot2_f32_bf16 v33, v78, v21, v33
    v_dot2_f32_bf16 v34, v75, v21, v34
    v_dot2_f32_bf16 v35, v79, v21, v35
    v_dot2_f32_bf16 v28, v80, v22, v28
    v_dot2_f32_bf16 v29, v84, v22, v29
    v_dot2_f32_bf16 v30, v81, v22, v30
    v_dot2_f32_bf16 v31, v85, v22, v31
    v_dot2_f32_bf16 v32, v82, v22, v32
    v_dot2_f32_bf16 v33, v86, v22, v33
    v_dot2_f32_bf16 v34, v83, v22, v34
    v_dot2_f32_bf16 v35, v87, v22, v35
    v_dot2_f32_bf16 v28, v88, v23, v28
    v_dot2_f32_bf16 v29, v92, v23, v29
    v_dot2_f32_bf16 v30, v89, v23, v30
    v_dot2_f32_bf16 v31, v93, v23, v31
    v_dot2_f32_bf16 v32, v90, v23, v32
    v_dot2_f32_bf16 v33, v94, v23, v33
    v_dot2_f32_bf16 v34, v91, v23, v34
    v_dot2_f32_bf16 v35, v95, v23, v35
    v_dot2_f32_bf16 v36, v96, v20, 0
    v_dot2_f32_bf16 v37, v100, v20, 0
    v_dot2_f32_bf16 v38, v97, v20, 0
    v_dot2_f32_bf16 v39, v101, v20, 0
    v_dot2_f32_bf16 v40, v98, v20, 0
    v_dot2_f32_bf16 v41, v102, v20, 0
    v_dot2_f32_bf16 v42, v99, v20, 0
    v_dot2_f32_bf16 v43, v103, v20, 0
    v_dot2_f32_bf16 v36, v104, v21, v36
    v_dot2_f32_bf16 v37, v108, v21, v37
    v_dot2_f32_bf16 v38, v105, v21, v38
    v_dot2_f32_bf16 v39, v109, v21, v39
    v_dot2_f32_bf16 v40, v106, v21, v40
    v_dot2_f32_bf16 v41, v110, v21, v41
    v_dot2_f32_bf16 v42, v107, v21, v42
    v_dot2_f32_bf16 v43, v111, v21, v43
    v_dot2_f32_bf16 v36, v112, v22, v36
    v_dot2_f32_bf16 v37, v116, v22, v37
    v_dot2_f32_bf16 v38, v113, v22, v38
    v_dot2_f32_bf16 v39, v117, v22, v39
    v_dot2_f32_bf16 v40, v114, v22, v40
    v_dot2_f32_bf16 v41, v118, v22, v41
    v_dot2_f32_bf16 v42, v115, v22, v42
    v_dot2_f32_bf16 v43, v119, v22, v43
    v_dot2_f32_bf16 v36, v120, v23, v36
    v_dot2_f32_bf16 v37, v124, v23, v37
    v_dot2_f32_bf16 v38, v121, v23, v38
    v_dot2_f32_bf16 v39, v125, v23, v39
    v_dot2_f32_bf16 v40, v122, v23, v40
    v_dot2_f32_bf16 v41, v126, v23, v41
    v_dot2_f32_bf16 v42, v123, v23, v42
    v_dot2_f32_bf16 v43, v127, v23, v43
    v_permlane32_swap_b32 v28, v32
    v_permlane32_swap_b32 v29, v33
    v_permlane32_swap_b32 v30, v34
    v_permlane32_swap_b32 v31, v35
    v_permlane32_swap_b32 v36, v40
    v_permlane32_swap_b32 v37, v41
    v_permlane32_swap_b32 v38, v42
    v_permlane32_swap_b32 v39, v43
    v_pk_add_f32 v[28:29], v[28:29], v[32:33]
    v_pk_add_f32 v[30:31], v[30:31], v[34:35]
    v_pk_add_f32 v[36:37], v[36:37], v[40:41]
    v_pk_add_f32 v[38:39], v[38:39], v[42:43]
    v_permlane16_swap_b32 v28, v30
    v_permlane16_swap_b32 v29, v31
    v_permlane16_swap_b32 v36, v38
    v_permlane16_swap_b32 v37, v39
    v_pk_add_f32 v[28:29], v[28:29], v[30:31]
    v_pk_add_f32 v[36:37], v[36:37], v[38:39]
    s_nop 0
    v_add_f32_dpp v44, v28, v28 row_ror:8 row_mask:0xf bank_mask:0x3
    v_add_f32_dpp v45, v36, v36 row_ror:8 row_mask:0xf bank_mask:0x3
    s_nop 0
    v_add_f32_dpp v44, v29, v29 row_ror:8 row_mask:0xf bank_mask:0xc
    v_add_f32_dpp v45, v37, v37 row_ror:8 row_mask:0xf bank_mask:0xc
    s_bitcmp1_b32 s99, 1
    s_cbranch_scc0 Lls_34
    buffer_store_dwordx2 v[44:45], v15, s[36:39], s80 offen
Lle_35:
    s_mov_b32 s95, s80
    s_barrier
    s_mov_b32 s85, 0
Lspin_36:
    buffer_load_dwordx4 v[16:19], v13, s[36:39], s64 offen sc1
    buffer_load_dwordx4 v[20:23], v13, s[36:39], s65 offen sc1
    s_add_u32 s85, s85, 1
    s_cmp_gt_u32 s85, 400000
    s_cbranch_scc1 L_end
    s_waitcnt vmcnt(0)
    v_max3_u32 v25, v16, v18, v20
    v_max_u32 v25, v25, v22
    v_cmp_eq_u32_e64 vcc, -1, v25
    s_cbranch_vccnz Lspin_36
    v_pk_add_f32 v[16:17], v[16:17], v[20:21]
    v_pk_add_f32 v[18:19], v[18:19], v[22:23]
    s_nop 1
    v_permlane32_swap_b32 v16, v18
    v_permlane32_swap_b32_e64 v17, v19
    v_pk_add_f32 v[16:17], v[16:17], v[18:19]
    v_mov_b32 v18, v16
    v_mov_b32 v19, v17
L_pad3:
    s_cbranch_execz L_pad7
    s_nop 0
    v_permlane16_swap_b32 v16, v18
    v_permlane16_swap_b32 v17, v19
    v_pk_add_f32 v[16:17], v[16:17], v[18:19]
    s_nop 1
    v_add_f32_dpp v16, v16, v16 row_ror:8 row_mask:0xf bank_mask:0xf
    v_add_f32_dpp v17, v17, v17 row_ror:8 row_mask:0xf bank_mask:0xf
    v_cvt_pk_bf16_f32 v17, v16, v17
    v_lshlrev_b32 v16, 16, v17
    v_mul_f32 v18, 0xbfb8aa3b, v16
    v_exp_f32_e64 v18, v18
    v_and_b32 v17, 0xffff0000, v17
    v_add_f32 v18, 1.0, v18
    v_rcp_f32 v18, v18
    s_nop 0
    v_mul_f32 v16, v16, v18
    v_cvt_pk_bf16_f32 v16, v16, v16
    v_and_b32 v16, 0xffff0000, v16
    v_mul_f32_e64 v16, v16, v17
    v_cvt_pk_bf16_f32 v16, v16, v16
    ds_write_b16 v50, v16
    s_waitcnt lgkmcnt(0)
    s_barrier
    ds_read_b128 v[20:23], v51
    s_waitcnt lgkmcnt(0)
    s_nop 0
    v_dot2_f32_bf16 v28, v128, v20, 0
    v_dot2_f32_bf16 v29, v132, v20, 0
    v_dot2_f32_bf16 v30, v129, v20, 0
    v_dot2_f32_bf16 v31, v133, v20, 0
    v_dot2_f32_bf16 v32, v130, v20, 0
    v_dot2_f32_bf16 v33, v134, v20, 0
    v_dot2_f32_bf16 v34, v131, v20, 0
    v_dot2_f32_bf16 v35, v135, v20, 0
    v_dot2_f32_bf16 v28, v136, v21, v28
    v_dot2_f32_bf16 v29, v140, v21, v29
    v_dot2_f32_bf16 v30, v137, v21, v30
    v_dot2_f32_bf16 v31, v141, v21, v31
    v_dot2_f32_bf16 v32, v138, v21, v32
    v_dot2_f32_bf16 v33, v142, v21, v33
    v_dot2_f32_bf16 v34, v139, v21, v34
    v_dot2_f32_bf16 v35, v143, v21, v35
    v_dot2_f32_bf16 v28, v144, v22, v28
    v_dot2_f32_bf16 v29, v148, v22, v29
    v_dot2_f32_bf16 v30, v145, v22, v30
    v_dot2_f32_bf16 v31, v149, v22, v31
    v_dot2_f32_bf16 v32, v146, v22, v32
    v_dot2_f32_bf16 v33, v150, v22, v33
    v_dot2_f32_bf16 v34, v147, v22, v34
    v_dot2_f32_bf16 v35, v151, v22, v35
    v_dot2_f32_bf16 v28, v152, v23, v28
    v_dot2_f32_bf16 v29, v156, v23, v29
    v_dot2_f32_bf16 v30, v153, v23, v30
    v_dot2_f32_bf16 v31, v157, v23, v31
    v_dot2_f32_bf16 v32, v154, v23, v32
    v_dot2_f32_bf16 v33, v158, v23, v33
    v_dot2_f32_bf16 v34, v155, v23, v34
    v_dot2_f32_bf16 v35, v159, v23, v35
    v_permlane32_swap_b32 v28, v32
    v_permlane32_swap_b32 v29, v33
    v_permlane32_swap_b32 v30, v34
    v_permlane32_swap_b32 v31, v35
    v_pk_add_f32 v[28:29], v[28:29], v[32:33]
    v_pk_add_f32 v[30:31], v[30:31], v[34:35]
    s_nop 1
    v_permlane16_swap_b32 v28, v30
    v_permlane16_swap_b32_e64 v29, v31
    v_pk_add_f32 v[28:29], v[28:29], v[30:31]
    s_nop 1
    v_add_f32_dpp v46, v28, v28 row_ror:8 row_mask:0xf bank_mask:0x3
    s_nop 1
    v_add_f32_dpp v46, v29, v29 row_ror:8 row_mask:0xf bank_mask:0xc
    buffer_store_dword v46, v49, s[36:39], s66 offen sc1
    s_barrier
    s_branch L_fin
L_red:
    v_mov_b32 v26, 163360
    ds_write_b32 v26, v24
    s_waitcnt lgkmcnt(0)
    s_barrier
    s_barrier
    s_barrier
    s_cmp_lg_u32 s76, 0
    s_cbranch_scc1 L_fin
    s_sub_u32 s83, s0, 224
    v_lshrrev_b32_e64 v14, 4, v2
    v_lshl_add_u32 v14, v9, 2, v14
    v_lshlrev_b32 v15, 2, v14
    v_lshlrev_b32 v14, 1, v14
    s_bfe_u32 s78, s97, 0x40007
    s_lshl_b32 s78, s78, 13
    s_lshr_b32 s79, s83, 1
    s_lshl_b32 s79, s79, 9
    s_add_u32 s78, s78, s79
    s_and_b32 s79, s83, 1
    s_lshl_b32 s79, s79, 7
    s_add_u32 s78, s78, s79
    s_add_u32 s78, s78, 524544
    s_mov_b32 s85, 0
Lspin_37:
    buffer_load_dword v46, v15, s[36:39], s78 offen sc1
    s_add_u32 s85, s85, 1
    s_cmp_gt_u32 s85, 400000
    s_cbranch_scc1 L_end
    s_waitcnt vmcnt(0)
    v_cmp_eq_u32_e64 vcc, -1, v46
    s_cbranch_vccnz Lspin_37
    v_cvt_pk_bf16_f32 v47, v24, v24
    v_and_b32 v47, 0xffff0000, v47
    v_mul_f32 v47, 0xbfb8aa3b, v47
    v_exp_f32 v47, v47
    s_nop 0
    v_add_f32 v47, 1.0, v47
    v_rcp_f32_e64 v47, v47
    s_nop 0
    v_cvt_pk_bf16_f32 v47, v47, v47
    v_and_b32 v47, 0xffff0000, v47
    v_lshl_add_u32 v13, v8, 10, v10
    s_lshr_b32 s78, s83, 3
    s_mul_i32 s78, s78, 57344
    s_and_b32 s79, s83, 7
    s_lshl_b32 s79, s79, 7
    s_add_u32 s78, s78, s79
    s_add_u32 s78, s78, 1114112
    s_and_b32 s80, s97, 0x7ff
    s_lshl_b32 s80, s80, 11
    s_lshl_b32 s79, s83, 6
    s_add_u32 s80, s80, s79
    s_sleep 30
    s_mov_b32 s85, 0
Lspin_38:
    s_add_u32 s79, s78, 0
    buffer_load_dwordx4 v[16:19], v13, s[36:39], s79 offen sc1
    s_add_u32 s79, s78, 8192
    buffer_load_dwordx4 v[20:23], v13, s[36:39], s79 offen sc1
    s_add_u32 s79, s78, 16384
    buffer_load_dwordx4 v[24:27], v13, s[36:39], s79 offen sc1
    s_add_u32 s79, s78, 24576
    buffer_load_dwordx4 v[28:31], v13, s[36:39], s79 offen sc1
    s_add_u32 s79, s78, 32768
    buffer_load_dwordx4 v[32:35], v13, s[36:39], s79 offen sc1
    s_add_u32 s79, s78, 40960
    buffer_load_dwordx4 v[36:39], v13, s[36:39], s79 offen sc1
    s_add_u32 s79, s78, 49152
    buffer_load_dwordx4 v[40:43], v13, s[36:39], s79 offen sc1
    s_add_u32 s85, s85, 1
    s_cmp_gt_u32 s85, 400000
    s_cbranch_scc1 L_end
    s_waitcnt vmcnt(0)
    v_max_u32 v48, v16, v17
    v_max_u32_e64 v49, v18, v19
    v_max3_u32 v48, v48, v20, v21
    v_max3_u32 v49, v49, v22, v23
    v_max3_u32 v48, v48, v24, v25
    v_max3_u32 v49, v49, v26, v27
    v_max3_u32 v48, v48, v28, v29
    v_max3_u32 v49, v49, v30, v31
    v_max3_u32 v48, v48, v32, v33
    v_max3_u32 v49, v49, v34, v35
    v_max3_u32 v48, v48, v36, v37
    v_max3_u32 v49, v49, v38, v39
    v_max3_u32 v48, v48, v40, v41
    v_max3_u32 v49, v49, v42, v43
    v_max_u32 v48, v48, v49
    v_cmp_eq_u32_e64 vcc, -1, v48
    s_cbranch_vccnz Lspin_38
    v_pk_add_f32 v[16:17], v[16:17], v[20:21]
    v_pk_add_f32 v[24:25], v[24:25], v[28:29]
    v_pk_add_f32 v[32:33], v[32:33], v[36:37]
    v_pk_add_f32 v[16:17], v[16:17], v[24:25]
    v_pk_add_f32 v[32:33], v[32:33], v[40:41]
    v_pk_add_f32 v[16:17], v[16:17], v[32:33]
    v_pk_add_f32 v[18:19], v[18:19], v[22:23]
    v_pk_add_f32 v[26:27], v[26:27], v[30:31]
    v_pk_add_f32 v[34:35], v[34:35], v[38:39]
    v_pk_add_f32 v[18:19], v[18:19], v[26:27]
    v_pk_add_f32 v[34:35], v[34:35], v[42:43]
    v_pk_add_f32 v[18:19], v[18:19], v[34:35]
    s_nop 1
    v_permlane32_swap_b32 v16, v18
    v_permlane32_swap_b32_e64 v17, v19
    v_pk_add_f32 v[16:17], v[16:17], v[18:19]
    s_nop 1
    v_permlane16_swap_b32 v16, v17
    v_add_f32 v16, v16, v17
    s_nop 1
    v_add_f32_dpp v16, v16, v16 row_ror:8 row_mask:0xf bank_mask:0xf
    v_cvt_pk_bf16_f32 v16, v16, v16
    v_and_b32 v16, 0xffff0000, v16
    v_mul_f32_e64 v16, v16, v47
    v_cvt_pk_bf16_f32 v16, v16, v16
    v_and_b32 v16, 0xffff0000, v16
    v_add_f32_e64 v16, v16, v46
    v_cvt_pk_bf16_f32 v16, v16, v16
    s_mov_b32 exec_lo, 0x00ff00ff
    s_mov_b32 exec_hi, 0x00ff00ff
    buffer_store_short v16, v14, s[44:47], s80 offen
    s_mov_b64 exec, -1
    s_cmp_lg_u32 s0, 224
    s_cbranch_scc1 Lep_39
    s_cmp_lg_u32 s76, 0
    s_cbranch_scc1 Lep_39
    v_mov_b32 v196, s75
    v_mov_b32_e64 v197, 0
    s_mov_b64 exec, 1
    buffer_store_dword v196, v197, s[36:39], 0 offen sc1
    s_mov_b64 exec, -1
Lep_39:
    s_branch L_fin
L_pad4:
    s_cbranch_execz L_pad8
    s_endpgm
Lspin_18:
    buffer_load_dwordx2 v[10:11], v8, s[36:39], 0 offen sc1
    s_add_u32 s85, s85, 1
    s_cmp_gt_u32 s85, 400000
    s_cbranch_scc1 L_end
    s_waitcnt vmcnt(0)
    s_branch Lpk_17
Lls_19:
    buffer_store_dwordx4 v[12:15], v62, s[36:39], s78 offen sc1
    s_nop 1
    s_branch Lle_20
Lls_21:
    buffer_store_dwordx4 v[28:31], v63, s[36:39], s78 offen sc1
    s_nop 1
    s_branch Lle_22
Lls_23:
    buffer_store_dwordx4 v[44:47], v2, s[36:39], s79 offen sc1
    s_nop 1
    s_branch Lle_24
Lls_26:
    buffer_store_dword v36, v57, s[36:39], s81 offen sc1
    s_nop 1
    s_branch Lle_27
Lspin_32:
    buffer_load_dwordx4 v[20:23], v27, s[36:39], s78 offen sc1
    s_add_u32 s85, s85, 1
    s_cmp_gt_u32 s85, 400000
    s_cbranch_scc1 L_end
    s_branch Lb_33
Lls_34:
    buffer_store_dwordx2 v[44:45], v15, s[36:39], s80 offen sc1
    s_nop 1
    s_branch Lle_35
L_padret:
    s_setpc_b64 s[12:13]
    .p2align 3
L_M:
    s_getpc_b64 s[90:91]
L_mpc:
    s_sub_u32 s90, s90, L_mpc-L_sube
    s_subb_u32 s91, s91, 0
    s_lshr_b32 s78, s2, 3
    s_lshl_b32 s78, s78, 10
    s_lshl_b32 s79, s76, 8
    s_add_u32 s78, s78, s79
    s_min_u32 s78, s78, (L_end-L_sube)
    v_lshl_add_u32 v119, v2, 2, s78
    global_load_dword v119, v119, s[90:91]
    s_setprio 1
    s_and_b32 s78, s2, 7
    s_lshr_b32 s79, s2, 3
    s_lshl_b32 s71, s78, 1
    s_and_b32 s72, s79, 1
    s_add_u32 s71, s71, s72
    s_lshr_b32 s72, s79, 1
    s_cmp_gt_u32 s70, 3
    s_cselect_b32 s78, 1, 0
    s_cmp_gt_u32 s70, 11
    s_cselect_b32 s78, 2, s78
    s_sub_u32 s78, s70, s78
    s_cmp_eq_u32 s70, 3
    s_cselect_b32 s78, 14, s78
    s_cmp_eq_u32 s70, 11
    s_cselect_b32 s78, 15, s78
    s_lshl_b32 s0, s78, 4
    s_add_u32 s0, s0, s69
    s_lshr_b32 s73, s0, 2
    s_and_b32 s74, s0, 3
    s_lshl_b32 s77, s70, 4
    s_add_u32 s77, s77, s69
    s_and_b32 s80, s76, 1
    s_lshr_b32 s81, s76, 1
    v_and_b32 v8, 15, v2
    v_lshrrev_b32 v9, 4, v2
    v_lshrrev_b32 v10, 1, v8
    s_lshl_b32 s78, s80, 13
    s_add_u32 s78, s78, 118784
    v_lshlrev_b32 v11, 7, v8
    v_add_u32 v11, s78, v11
    v_add_u32 v12, 0, v9
    v_xor_b32 v12, v12, v10
    v_lshl_add_u32 v4, v12, 4, v11
    v_add_u32 v12, 4, v9
    v_xor_b32 v12, v12, v10
    v_lshl_add_u32 v5, v12, 4, v11
    v_bfe_u32 v10, v2, 2, 2
    v_and_b32_e64 v11, 3, v2
    v_lshl_add_u32 v12, v9, 3, v10
    v_lshlrev_b32_e64 v12, 7, v12
    v_lshl_add_u32 v12, v11, 3, v12
    v_add_u32 v12, 135168, v12
    v_lshrrev_b32 v13, 1, v10
    v_and_b32 v14, 1, v9
    v_lshl_add_u32 v13, v14, 1, v13
    s_lshl_b32 s78, s81, 1
    s_add_u32 s79, s78, 0
    v_xor_b32_e64 v14, s79, v13
    v_lshl_add_u32 v6, v14, 5, v12
    s_add_u32 s79, s78, 1
    v_xor_b32 v14, s79, v13
    v_lshl_add_u32 v7, v14, 5, v12
    v_lshrrev_b32_e64 v13, 5, v2
    v_lshl_add_u32 v13, v13, 3, v10
    v_lshlrev_b32 v13, 6, v13
    v_and_b32 v14, 1, v9
    v_lshl_add_u32 v13, v14, 5, v13
    v_lshl_add_u32 v13, v11, 3, v13
    s_lshl_b32 s78, s81, 11
    s_add_u32 s78, s78, 159744
    v_add_u32 v15, s78, v13
    v_mov_b64 v[128:129], 0
    v_mov_b64 v[130:131], 0
    v_mov_b64 v[132:133], 0
    v_mov_b64 v[134:135], 0
    v_mov_b64 v[136:137], 0
    v_mov_b64 v[138:139], 0
    v_mov_b64 v[140:141], 0
    v_mov_b64 v[142:143], 0
    v_mov_b64 v[144:145], 0
    v_mov_b64 v[146:147], 0
    v_mov_b64 v[148:149], 0
    v_mov_b64 v[150:151], 0
    v_mov_b64 v[152:153], 0
    v_mov_b64 v[154:155], 0
    v_mov_b64 v[156:157], 0
    v_mov_b64 v[158:159], 0
    v_mov_b64 v[160:161], 0
    v_mov_b64 v[162:163], 0
    v_mov_b64 v[164:165], 0
    v_mov_b64 v[166:167], 0
    v_mov_b64 v[168:169], 0
    v_mov_b64 v[170:171], 0
    v_mov_b64 v[172:173], 0
    v_mov_b64 v[174:175], 0
    v_mov_b64 v[176:177], 0
    v_mov_b64 v[178:179], 0
    v_mov_b64 v[180:181], 0
    v_mov_b64 v[182:183], 0
    v_mov_b64 v[184:185], 0
    v_mov_b64 v[186:187], 0
    v_mov_b64 v[188:189], 0
    v_mov_b64 v[190:191], 0
    v_mov_b64 v[192:193], 0
    v_mov_b64 v[194:195], 0
    v_mov_b64 v[196:197], 0
    v_mov_b64 v[198:199], 0
    v_mov_b64 v[200:201], 0
    v_mov_b64 v[202:203], 0
    v_mov_b64 v[204:205], 0
    v_mov_b64 v[206:207], 0
    v_mov_b64 v[208:209], 0
    v_mov_b64 v[210:211], 0
    v_mov_b64 v[212:213], 0
    v_mov_b64 v[214:215], 0
    v_mov_b64 v[216:217], 0
    v_mov_b64 v[218:219], 0
L_pad5:
    s_cbranch_execz L_pad9
    v_mov_b64 v[220:221], 0
    v_mov_b64 v[222:223], 0
    v_mov_b64 v[104:105], 0
    v_mov_b64 v[106:107], 0
    v_mov_b64 v[108:109], 0
    v_mov_b64 v[110:111], 0
    v_and_b32 v14, 31, v2
    v_lshrrev_b32 v13, 5, v2
    s_lshl_b32 s78, s81, 14
    s_lshl_b32 s79, s80, 13
    s_add_u32 s78, s78, s79
    s_add_u32 s78, s78, 110592
    v_lshl_add_u32 v12, v14, 7, s78
    v_and_b32 v14, 7, v14
    v_xor_b32 v14, v14, v13
    v_xor_b32_e64 v13, 0, v14
    v_lshl_add_u32 v112, v13, 4, v12
    v_xor_b32_e64 v13, 2, v14
    v_lshl_add_u32 v113, v13, 4, v12
    v_xor_b32_e64 v13, 4, v14
    v_lshl_add_u32 v114, v13, 4, v12
    v_xor_b32_e64 v13, 6, v14
    v_lshl_add_u32 v115, v13, 4, v12
    s_add_u32 s79, s79, 143360
    v_lshl_add_u32 v12, v8, 7, s79
    s_lshl_b32 s78, s81, 2
    v_add_u32 v14, s78, v9
    v_and_b32 v13, 7, v8
    v_xor_b32 v14, v14, v13
    v_lshl_add_u32 v116, v14, 4, v12
    s_lshl_b32 s78, s80, 6
    v_add_u32 v10, s78, v8
    v_lshlrev_b32_e64 v11, 3, v10
    v_add_u32 v11, 159744, v11
    s_lshl_b32 s79, s81, 5
    v_add_u32 v12, s79, v8
    v_lshlrev_b32_e64 v12, 3, v12
    v_add_u32 v12, 160768, v12
    v_lshlrev_b32_e64 v13, 2, v10
    v_add_u32 v13, 162304, v13
    v_and_b32 v14, 31, v2
    v_add_u32 v14, s78, v14
    v_lshlrev_b32_e64 v14, 2, v14
    v_add_u32 v14, 162304, v14
    s_waitcnt lgkmcnt(0)
    s_load_dword s75, s[26:27], 0
    s_getpc_b64 s[12:13]
Lpr_40:
    s_add_u32 s12, s12, L_end-Lpr_40
    s_addc_u32 s13, s13, 0
    s_mov_b32 s36, s26
    s_and_b32 s37, s27, 0xffff
    s_mov_b32 s38, 0x10000000
    s_mov_b32 s39, 0x20000
    s_mov_b32 s64, s14
    s_and_b32 s65, s15, 0xffff
    s_mov_b32 s66, 0x800
    s_mov_b32 s67, 0x20000
    s_mov_b32 s44, s22
    s_and_b32 s45, s23, 0xffff
    s_mov_b32 s46, 0x400000
    s_mov_b32 s47, 0x20000
    s_lshl_b32 s78, s72, 7
    buffer_load_dword v118, off, s[64:67], s78
    s_waitcnt lgkmcnt(0)
    s_mul_i32 s75, s75, 0x9E3779B1
    s_add_u32 s75, s75, 0x7F4A7C15
    s_mov_b32 s84, 0
    s_mov_b32 s82, 2
    s_mov_b32 s83, 0xfffec000
    s_barrier
    s_nop 0
    ds_read_b128 v[16:19], v4 offset:0
    ds_read_b64_tr_b16 v[40:41], v6 offset:8192
    ds_read_b64_tr_b16 v[42:43], v6 offset:8704
    ds_read_b128 v[20:23], v4 offset:2048
    ds_read_b128 v[24:27], v4 offset:4096
    ds_read_b128 v[28:31], v4 offset:6144
    ds_read_b64_tr_b16 v[44:45], v7 offset:8192
    ds_read_b64_tr_b16 v[46:47], v7 offset:8704
    ds_read_b64_tr_b16 v[48:49], v6 offset:16384
    ds_read_b64_tr_b16 v[50:51], v6 offset:16896
    ds_read_b64_tr_b16 v[52:53], v7 offset:16384
    ds_read_b64_tr_b16 v[54:55], v7 offset:16896
    ds_read_b64_tr_b16 v[32:33], v6 offset:0
    ds_read_b64_tr_b16 v[34:35], v6 offset:512
    ds_read_b64_tr_b16 v[36:37], v7 offset:0
    ds_read_b64_tr_b16 v[38:39], v7 offset:512
    ds_read_b64_tr_b16 v[96:97], v15 offset:0
    ds_read_b64_tr_b16 v[98:99], v15 offset:1024
    ds_read_b64_tr_b16 v[100:101], v15 offset:256
    ds_read_b64_tr_b16 v[102:103], v15 offset:1280
    s_waitcnt lgkmcnt(0)
    s_nop 0
    v_mfma_f32_16x16x32_bf16 v[160:163], v[40:43], v[16:19], v[160:163]
    v_mfma_f32_16x16x32_bf16 v[176:179], v[44:47], v[16:19], v[176:179]
    v_mfma_f32_16x16x32_bf16 v[180:183], v[44:47], v[20:23], v[180:183]
    v_mfma_f32_16x16x32_bf16 v[164:167], v[40:43], v[20:23], v[164:167]
    v_mfma_f32_16x16x32_bf16 v[168:171], v[40:43], v[24:27], v[168:171]
    v_mfma_f32_16x16x32_bf16 v[184:187], v[44:47], v[24:27], v[184:187]
    v_mfma_f32_16x16x32_bf16 v[188:191], v[44:47], v[28:31], v[188:191]
    v_mfma_f32_16x16x32_bf16 v[172:175], v[40:43], v[28:31], v[172:175]
    v_mfma_f32_16x16x32_bf16 v[204:207], v[48:51], v[28:31], v[204:207]
    v_mfma_f32_16x16x32_bf16 v[220:223], v[52:55], v[28:31], v[220:223]
    v_mfma_f32_16x16x32_bf16 v[216:219], v[52:55], v[24:27], v[216:219]
    v_mfma_f32_16x16x32_bf16 v[200:203], v[48:51], v[24:27], v[200:203]
    v_mfma_f32_16x16x32_bf16 v[196:199], v[48:51], v[20:23], v[196:199]
    v_mfma_f32_16x16x32_bf16 v[212:215], v[52:55], v[20:23], v[212:215]
    v_mfma_f32_16x16x32_bf16 v[208:211], v[52:55], v[16:19], v[208:211]
    v_mfma_f32_16x16x32_bf16 v[192:195], v[48:51], v[16:19], v[192:195]
    v_mfma_f32_16x16x32_bf16 v[128:131], v[32:35], v[16:19], v[128:131]
    v_mfma_f32_16x16x32_bf16 v[144:147], v[36:39], v[16:19], v[144:147]
    v_mfma_f32_16x16x32_bf16 v[148:151], v[36:39], v[20:23], v[148:151]
    v_mfma_f32_16x16x32_bf16 v[132:135], v[32:35], v[20:23], v[132:135]
    v_mfma_f32_16x16x32_bf16 v[136:139], v[32:35], v[24:27], v[136:139]
    v_mfma_f32_16x16x32_bf16 v[152:155], v[36:39], v[24:27], v[152:155]
    v_mfma_f32_16x16x32_bf16 v[156:159], v[36:39], v[28:31], v[156:159]
    v_mfma_f32_16x16x32_bf16 v[140:143], v[32:35], v[28:31], v[140:143]
    ds_read_b128 v[56:59], v5 offset:0
    ds_read_b64_tr_b16 v[80:81], v6 offset:12288
    ds_read_b64_tr_b16 v[82:83], v6 offset:12800
    ds_read_b128 v[60:63], v5 offset:2048
    ds_read_b128 v[64:67], v5 offset:4096
    ds_read_b128 v[68:71], v5 offset:6144
    ds_read_b64_tr_b16 v[84:85], v7 offset:12288
    ds_read_b64_tr_b16 v[86:87], v7 offset:12800
    ds_read_b64_tr_b16 v[88:89], v6 offset:20480
    ds_read_b64_tr_b16 v[90:91], v6 offset:20992
    ds_read_b64_tr_b16 v[92:93], v7 offset:20480
    ds_read_b64_tr_b16 v[94:95], v7 offset:20992
    ds_read_b64_tr_b16 v[72:73], v6 offset:4096
    ds_read_b64_tr_b16 v[74:75], v6 offset:4608
    ds_read_b64_tr_b16 v[76:77], v7 offset:4096
    ds_read_b64_tr_b16 v[78:79], v7 offset:4608
    s_add_u32 s84, s84, 1
    s_cmp_eq_u32 s82, 2
    s_cselect_b32 s78, s83, 40960
    s_cselect_b32 s82, -1, s82
    s_add_u32 s82, s82, 1
    v_add_u32 v4, s78, v4
    v_add_u32 v5, s78, v5
    v_add_u32 v6, s78, v6
    v_add_u32_e64 v7, s78, v7
    s_waitcnt vmcnt(0) lgkmcnt(0)
    v_mfma_f32_16x16x32_bf16 v[160:163], v[80:83], v[56:59], v[160:163]
    v_mfma_f32_16x16x32_bf16 v[176:179], v[84:87], v[56:59], v[176:179]
    v_mfma_f32_16x16x32_bf16 v[180:183], v[84:87], v[60:63], v[180:183]
    v_mfma_f32_16x16x32_bf16 v[164:167], v[80:83], v[60:63], v[164:167]
    v_mfma_f32_16x16x32_bf16 v[168:171], v[80:83], v[64:67], v[168:171]
    v_mfma_f32_16x16x32_bf16 v[184:187], v[84:87], v[64:67], v[184:187]
    v_mfma_f32_16x16x32_bf16 v[188:191], v[84:87], v[68:71], v[188:191]
    v_mfma_f32_16x16x32_bf16 v[172:175], v[80:83], v[68:71], v[172:175]
    v_mfma_f32_16x16x32_bf16 v[204:207], v[88:91], v[68:71], v[204:207]
    v_mfma_f32_16x16x32_bf16 v[220:223], v[92:95], v[68:71], v[220:223]
    v_mfma_f32_16x16x32_bf16 v[216:219], v[92:95], v[64:67], v[216:219]
    v_mfma_f32_16x16x32_bf16 v[200:203], v[88:91], v[64:67], v[200:203]
    v_mfma_f32_16x16x32_bf16 v[196:199], v[88:91], v[60:63], v[196:199]
    v_mfma_f32_16x16x32_bf16 v[212:215], v[92:95], v[60:63], v[212:215]
    v_mfma_f32_16x16x32_bf16 v[208:211], v[92:95], v[56:59], v[208:211]
    v_mfma_f32_16x16x32_bf16 v[192:195], v[88:91], v[56:59], v[192:195]
    v_mfma_f32_16x16x32_bf16 v[128:131], v[72:75], v[56:59], v[128:131]
    v_mfma_f32_16x16x32_bf16 v[144:147], v[76:79], v[56:59], v[144:147]
    v_mfma_f32_16x16x32_bf16 v[148:151], v[76:79], v[60:63], v[148:151]
    v_mfma_f32_16x16x32_bf16 v[132:135], v[72:75], v[60:63], v[132:135]
    v_mfma_f32_16x16x32_bf16 v[136:139], v[72:75], v[64:67], v[136:139]
    v_mfma_f32_16x16x32_bf16 v[152:155], v[76:79], v[64:67], v[152:155]
    v_mfma_f32_16x16x32_bf16 v[156:159], v[76:79], v[68:71], v[156:159]
    v_mfma_f32_16x16x32_bf16 v[140:143], v[72:75], v[68:71], v[140:143]
    s_barrier
    s_nop 0
    ds_read_b128 v[16:19], v4 offset:0
    ds_read_b64_tr_b16 v[40:41], v6 offset:8192
    ds_read_b64_tr_b16 v[42:43], v6 offset:8704
    ds_read_b128 v[20:23], v4 offset:2048
    ds_read_b128 v[24:27], v4 offset:4096
    ds_read_b128 v[28:31], v4 offset:6144
    ds_read_b64_tr_b16 v[44:45], v7 offset:8192
    ds_read_b64_tr_b16 v[46:47], v7 offset:8704
    ds_read_b64_tr_b16 v[48:49], v6 offset:16384
    ds_read_b64_tr_b16 v[50:51], v6 offset:16896
    ds_read_b64_tr_b16 v[52:53], v7 offset:16384
    ds_read_b64_tr_b16 v[54:55], v7 offset:16896
    ds_read_b64_tr_b16 v[32:33], v6 offset:0
    ds_read_b64_tr_b16 v[34:35], v6 offset:512
    ds_read_b64_tr_b16 v[36:37], v7 offset:0
    ds_read_b64_tr_b16 v[38:39], v7 offset:512
    s_waitcnt lgkmcnt(0)
    s_nop 0
    v_mfma_f32_16x16x32_bf16 v[160:163], v[40:43], v[16:19], v[160:163]
    v_mfma_f32_16x16x32_bf16 v[176:179], v[44:47], v[16:19], v[176:179]
    v_mfma_f32_16x16x32_bf16 v[180:183], v[44:47], v[20:23], v[180:183]
    v_mfma_f32_16x16x32_bf16 v[164:167], v[40:43], v[20:23], v[164:167]
    v_mfma_f32_16x16x32_bf16 v[168:171], v[40:43], v[24:27], v[168:171]
    v_mfma_f32_16x16x32_bf16 v[184:187], v[44:47], v[24:27], v[184:187]
    v_mfma_f32_16x16x32_bf16 v[188:191], v[44:47], v[28:31], v[188:191]
    v_mfma_f32_16x16x32_bf16 v[172:175], v[40:43], v[28:31], v[172:175]
    v_mfma_f32_16x16x32_bf16 v[204:207], v[48:51], v[28:31], v[204:207]
    v_mfma_f32_16x16x32_bf16 v[220:223], v[52:55], v[28:31], v[220:223]
    v_mfma_f32_16x16x32_bf16 v[216:219], v[52:55], v[24:27], v[216:219]
    v_mfma_f32_16x16x32_bf16 v[200:203], v[48:51], v[24:27], v[200:203]
    v_mfma_f32_16x16x32_bf16 v[196:199], v[48:51], v[20:23], v[196:199]
    v_mfma_f32_16x16x32_bf16 v[212:215], v[52:55], v[20:23], v[212:215]
    v_mfma_f32_16x16x32_bf16 v[208:211], v[52:55], v[16:19], v[208:211]
    v_mfma_f32_16x16x32_bf16 v[192:195], v[48:51], v[16:19], v[192:195]
    v_mfma_f32_16x16x32_bf16 v[128:131], v[32:35], v[16:19], v[128:131]
    v_mfma_f32_16x16x32_bf16 v[144:147], v[36:39], v[16:19], v[144:147]
    v_mfma_f32_16x16x32_bf16 v[148:151], v[36:39], v[20:23], v[148:151]
    v_mfma_f32_16x16x32_bf16 v[132:135], v[32:35], v[20:23], v[132:135]
    v_mfma_f32_16x16x32_bf16 v[136:139], v[32:35], v[24:27], v[136:139]
    v_mfma_f32_16x16x32_bf16 v[152:155], v[36:39], v[24:27], v[152:155]
    v_mfma_f32_16x16x32_bf16 v[156:159], v[36:39], v[28:31], v[156:159]
    v_mfma_f32_16x16x32_bf16 v[140:143], v[32:35], v[28:31], v[140:143]
    ds_read_b128 v[56:59], v5 offset:0
    ds_read_b64_tr_b16 v[80:81], v6 offset:12288
    ds_read_b64_tr_b16 v[82:83], v6 offset:12800
    ds_read_b128 v[60:63], v5 offset:2048
    ds_read_b128 v[64:67], v5 offset:4096
    ds_read_b128 v[68:71], v5 offset:6144
    ds_read_b64_tr_b16 v[84:85], v7 offset:12288
    ds_read_b64_tr_b16 v[86:87], v7 offset:12800
    ds_read_b64_tr_b16 v[88:89], v6 offset:20480
    ds_read_b64_tr_b16 v[90:91], v6 offset:20992
    ds_read_b64_tr_b16 v[92:93], v7 offset:20480
    ds_read_b64_tr_b16 v[94:95], v7 offset:20992
    ds_read_b64_tr_b16 v[72:73], v6 offset:4096
    ds_read_b64_tr_b16 v[74:75], v6 offset:4608
    ds_read_b64_tr_b16 v[76:77], v7 offset:4096
    ds_read_b64_tr_b16 v[78:79], v7 offset:4608
    s_add_u32 s84, s84, 1
    s_cmp_eq_u32 s82, 2
    s_cselect_b32 s78, s83, 40960
    s_cselect_b32 s82, -1, s82
    s_add_u32 s82, s82, 1
    v_add_u32 v4, s78, v4
    v_add_u32 v5, s78, v5
    v_add_u32 v6, s78, v6
    v_add_u32_e64 v7, s78, v7
    s_waitcnt vmcnt(0) lgkmcnt(0)
    v_mfma_f32_16x16x32_bf16 v[160:163], v[80:83], v[56:59], v[160:163]
    v_mfma_f32_16x16x32_bf16 v[176:179], v[84:87], v[56:59], v[176:179]
    v_mfma_f32_16x16x32_bf16 v[180:183], v[84:87], v[60:63], v[180:183]
    v_mfma_f32_16x16x32_bf16 v[164:167], v[80:83], v[60:63], v[164:167]
    v_mfma_f32_16x16x32_bf16 v[168:171], v[80:83], v[64:67], v[168:171]
    v_mfma_f32_16x16x32_bf16 v[184:187], v[84:87], v[64:67], v[184:187]
    v_mfma_f32_16x16x32_bf16 v[188:191], v[84:87], v[68:71], v[188:191]
    v_mfma_f32_16x16x32_bf16 v[172:175], v[80:83], v[68:71], v[172:175]
    v_mfma_f32_16x16x32_bf16 v[204:207], v[88:91], v[68:71], v[204:207]
    v_mfma_f32_16x16x32_bf16 v[220:223], v[92:95], v[68:71], v[220:223]
    v_mfma_f32_16x16x32_bf16 v[216:219], v[92:95], v[64:67], v[216:219]
    v_mfma_f32_16x16x32_bf16 v[200:203], v[88:91], v[64:67], v[200:203]
    v_mfma_f32_16x16x32_bf16 v[196:199], v[88:91], v[60:63], v[196:199]
    v_mfma_f32_16x16x32_bf16 v[212:215], v[92:95], v[60:63], v[212:215]
    v_mfma_f32_16x16x32_bf16 v[208:211], v[92:95], v[56:59], v[208:211]
    v_mfma_f32_16x16x32_bf16 v[192:195], v[88:91], v[56:59], v[192:195]
    v_mfma_f32_16x16x32_bf16 v[128:131], v[72:75], v[56:59], v[128:131]
    v_mfma_f32_16x16x32_bf16 v[144:147], v[76:79], v[56:59], v[144:147]
    v_mfma_f32_16x16x32_bf16 v[148:151], v[76:79], v[60:63], v[148:151]
    v_mfma_f32_16x16x32_bf16 v[132:135], v[72:75], v[60:63], v[132:135]
    v_mfma_f32_16x16x32_bf16 v[136:139], v[72:75], v[64:67], v[136:139]
    v_mfma_f32_16x16x32_bf16 v[152:155], v[76:79], v[64:67], v[152:155]
    v_mfma_f32_16x16x32_bf16 v[156:159], v[76:79], v[68:71], v[156:159]
    v_mfma_f32_16x16x32_bf16 v[140:143], v[72:75], v[68:71], v[140:143]
    s_mov_b64 exec, 0
    s_cmp_lg_u32 s76, 0
    s_cbranch_scc1 Lt_41
    s_call_b64 s[12:13], L_pad0
Lt_41:
    s_cmp_lg_u32 s76, 1
    s_cbranch_scc1 Lt_42
    s_call_b64 s[12:13], L_pad1
Lt_42:
    s_cmp_lg_u32 s76, 2
    s_cbranch_scc1 Lt_43
    s_call_b64 s[12:13], L_pad2
Lt_43:
    s_cmp_lg_u32 s76, 3
    s_cbranch_scc1 Lt_44
    s_call_b64 s[12:13], L_pad3
Lt_44:
    s_mov_b64 exec, -1
    s_barrier
    s_nop 0
    ds_read_b128 v[16:19], v4 offset:0
    ds_read_b64_tr_b16 v[40:41], v6 offset:8192
    ds_read_b64_tr_b16 v[42:43], v6 offset:8704
    ds_read_b128 v[20:23], v4 offset:2048
    ds_read_b128 v[24:27], v4 offset:4096
    ds_read_b128 v[28:31], v4 offset:6144
    ds_read_b64_tr_b16 v[44:45], v7 offset:8192
    ds_read_b64_tr_b16 v[46:47], v7 offset:8704
    ds_read_b64_tr_b16 v[48:49], v6 offset:16384
    ds_read_b64_tr_b16 v[50:51], v6 offset:16896
    ds_read_b64_tr_b16 v[52:53], v7 offset:16384
    ds_read_b64_tr_b16 v[54:55], v7 offset:16896
    ds_read_b64_tr_b16 v[32:33], v6 offset:0
    ds_read_b64_tr_b16 v[34:35], v6 offset:512
    ds_read_b64_tr_b16 v[36:37], v7 offset:0
L_pad6:
    s_cbranch_execz L_pad10
    ds_read_b64_tr_b16 v[38:39], v7 offset:512
    s_waitcnt lgkmcnt(0)
    v_mfma_f32_16x16x32_bf16 v[160:163], v[40:43], v[16:19], v[160:163]
    v_mfma_f32_16x16x32_bf16 v[176:179], v[44:47], v[16:19], v[176:179]
    v_mfma_f32_16x16x32_bf16 v[180:183], v[44:47], v[20:23], v[180:183]
    v_mfma_f32_16x16x32_bf16 v[164:167], v[40:43], v[20:23], v[164:167]
    v_mfma_f32_16x16x32_bf16 v[168:171], v[40:43], v[24:27], v[168:171]
    v_mfma_f32_16x16x32_bf16 v[184:187], v[44:47], v[24:27], v[184:187]
    v_mfma_f32_16x16x32_bf16 v[188:191], v[44:47], v[28:31], v[188:191]
    v_mfma_f32_16x16x32_bf16 v[172:175], v[40:43], v[28:31], v[172:175]
    v_mfma_f32_16x16x32_bf16 v[204:207], v[48:51], v[28:31], v[204:207]
    v_mfma_f32_16x16x32_bf16 v[220:223], v[52:55], v[28:31], v[220:223]
    v_mfma_f32_16x16x32_bf16 v[216:219], v[52:55], v[24:27], v[216:219]
    v_mfma_f32_16x16x32_bf16 v[200:203], v[48:51], v[24:27], v[200:203]
    v_mfma_f32_16x16x32_bf16 v[196:199], v[48:51], v[20:23], v[196:199]
    v_mfma_f32_16x16x32_bf16 v[212:215], v[52:55], v[20:23], v[212:215]
    v_mfma_f32_16x16x32_bf16 v[208:211], v[52:55], v[16:19], v[208:211]
    v_mfma_f32_16x16x32_bf16 v[192:195], v[48:51], v[16:19], v[192:195]
    v_mfma_f32_16x16x32_bf16 v[128:131], v[32:35], v[16:19], v[128:131]
    v_mfma_f32_16x16x32_bf16 v[144:147], v[36:39], v[16:19], v[144:147]
    v_mfma_f32_16x16x32_bf16 v[148:151], v[36:39], v[20:23], v[148:151]
    v_mfma_f32_16x16x32_bf16 v[132:135], v[32:35], v[20:23], v[132:135]
    v_mfma_f32_16x16x32_bf16 v[136:139], v[32:35], v[24:27], v[136:139]
    v_mfma_f32_16x16x32_bf16 v[152:155], v[36:39], v[24:27], v[152:155]
    v_mfma_f32_16x16x32_bf16 v[156:159], v[36:39], v[28:31], v[156:159]
    v_mfma_f32_16x16x32_bf16 v[140:143], v[32:35], v[28:31], v[140:143]
    ds_read_b128 v[56:59], v5 offset:0
    ds_read_b64_tr_b16 v[80:81], v6 offset:12288
    ds_read_b64_tr_b16 v[82:83], v6 offset:12800
    ds_read_b128 v[60:63], v5 offset:2048
    ds_read_b128 v[64:67], v5 offset:4096
    ds_read_b128 v[68:71], v5 offset:6144
    ds_read_b64_tr_b16 v[84:85], v7 offset:12288
    ds_read_b64_tr_b16 v[86:87], v7 offset:12800
    ds_read_b64_tr_b16 v[88:89], v6 offset:20480
    ds_read_b64_tr_b16 v[90:91], v6 offset:20992
    ds_read_b64_tr_b16 v[92:93], v7 offset:20480
    ds_read_b64_tr_b16 v[94:95], v7 offset:20992
    ds_read_b64_tr_b16 v[72:73], v6 offset:4096
    ds_read_b64_tr_b16 v[74:75], v6 offset:4608
    ds_read_b64_tr_b16 v[76:77], v7 offset:4096
    ds_read_b64_tr_b16 v[78:79], v7 offset:4608
    s_add_u32 s84, s84, 1
    s_cmp_eq_u32 s82, 2
    s_cselect_b32 s78, s83, 40960
    s_cselect_b32 s82, -1, s82
    s_add_u32 s82, s82, 1
    v_add_u32 v4, s78, v4
    v_add_u32 v5, s78, v5
    v_add_u32 v6, s78, v6
    v_add_u32_e64 v7, s78, v7
    s_waitcnt vmcnt(0) lgkmcnt(0)
    v_mfma_f32_16x16x32_bf16 v[160:163], v[80:83], v[56:59], v[160:163]
    v_mfma_f32_16x16x32_bf16 v[176:179], v[84:87], v[56:59], v[176:179]
    v_mfma_f32_16x16x32_bf16 v[180:183], v[84:87], v[60:63], v[180:183]
    v_mfma_f32_16x16x32_bf16 v[164:167], v[80:83], v[60:63], v[164:167]
    v_mfma_f32_16x16x32_bf16 v[168:171], v[80:83], v[64:67], v[168:171]
    v_mfma_f32_16x16x32_bf16 v[184:187], v[84:87], v[64:67], v[184:187]
    v_mfma_f32_16x16x32_bf16 v[188:191], v[84:87], v[68:71], v[188:191]
    v_mfma_f32_16x16x32_bf16 v[172:175], v[80:83], v[68:71], v[172:175]
    v_mfma_f32_16x16x32_bf16 v[204:207], v[88:91], v[68:71], v[204:207]
    v_mfma_f32_16x16x32_bf16 v[220:223], v[92:95], v[68:71], v[220:223]
    v_mfma_f32_16x16x32_bf16 v[216:219], v[92:95], v[64:67], v[216:219]
    v_mfma_f32_16x16x32_bf16 v[200:203], v[88:91], v[64:67], v[200:203]
    v_mfma_f32_16x16x32_bf16 v[196:199], v[88:91], v[60:63], v[196:199]
    v_mfma_f32_16x16x32_bf16 v[212:215], v[92:95], v[60:63], v[212:215]
    v_mfma_f32_16x16x32_bf16 v[208:211], v[92:95], v[56:59], v[208:211]
    v_mfma_f32_16x16x32_bf16 v[192:195], v[88:91], v[56:59], v[192:195]
    v_mfma_f32_16x16x32_bf16 v[128:131], v[72:75], v[56:59], v[128:131]
    v_mfma_f32_16x16x32_bf16 v[144:147], v[76:79], v[56:59], v[144:147]
    v_mfma_f32_16x16x32_bf16 v[148:151], v[76:79], v[60:63], v[148:151]
    v_mfma_f32_16x16x32_bf16 v[132:135], v[72:75], v[60:63], v[132:135]
    v_mfma_f32_16x16x32_bf16 v[136:139], v[72:75], v[64:67], v[136:139]
    v_mfma_f32_16x16x32_bf16 v[152:155], v[76:79], v[64:67], v[152:155]
    v_mfma_f32_16x16x32_bf16 v[156:159], v[76:79], v[68:71], v[156:159]
    v_mfma_f32_16x16x32_bf16 v[140:143], v[72:75], v[68:71], v[140:143]
    s_barrier
    s_nop 0
    ds_read_b128 v[16:19], v4 offset:0
    ds_read_b64_tr_b16 v[40:41], v6 offset:8192
    ds_read_b64_tr_b16 v[42:43], v6 offset:8704
    ds_read_b128 v[20:23], v4 offset:2048
    ds_read_b128 v[24:27], v4 offset:4096
    ds_read_b128 v[28:31], v4 offset:6144
    ds_read_b64_tr_b16 v[44:45], v7 offset:8192
    ds_read_b64_tr_b16 v[46:47], v7 offset:8704
    ds_read_b64_tr_b16 v[48:49], v6 offset:16384
    ds_read_b64_tr_b16 v[50:51], v6 offset:16896
    ds_read_b64_tr_b16 v[52:53], v7 offset:16384
    ds_read_b64_tr_b16 v[54:55], v7 offset:16896
    ds_read_b64_tr_b16 v[32:33], v6 offset:0
    ds_read_b64_tr_b16 v[34:35], v6 offset:512
    ds_read_b64_tr_b16 v[36:37], v7 offset:0
    ds_read_b64_tr_b16 v[38:39], v7 offset:512
    .p2align 3
L_Mloop:
    s_waitcnt lgkmcnt(0)
    s_nop 0
    v_mfma_f32_16x16x32_bf16 v[160:163], v[40:43], v[16:19], v[160:163]
    ds_read_b128 v[56:59], v5 offset:0
    v_mfma_f32_16x16x32_bf16 v[176:179], v[44:47], v[16:19], v[176:179]
    ds_read_b64_tr_b16 v[80:81], v6 offset:12288
    v_mfma_f32_16x16x32_bf16 v[180:183], v[44:47], v[20:23], v[180:183]
    ds_read_b64_tr_b16 v[82:83], v6 offset:12800
    v_mfma_f32_16x16x32_bf16 v[164:167], v[40:43], v[20:23], v[164:167]
    ds_read_b128 v[60:63], v5 offset:2048
    v_mfma_f32_16x16x32_bf16 v[168:171], v[40:43], v[24:27], v[168:171]
    ds_read_b128 v[64:67], v5 offset:4096
    v_mfma_f32_16x16x32_bf16 v[184:187], v[44:47], v[24:27], v[184:187]
    ds_read_b128 v[68:71], v5 offset:6144
    v_mfma_f32_16x16x32_bf16 v[188:191], v[44:47], v[28:31], v[188:191]
    ds_read_b64_tr_b16 v[84:85], v7 offset:12288
    v_mfma_f32_16x16x32_bf16 v[172:175], v[40:43], v[28:31], v[172:175]
    ds_read_b64_tr_b16 v[86:87], v7 offset:12800
    v_mfma_f32_16x16x32_bf16 v[204:207], v[48:51], v[28:31], v[204:207]
    ds_read_b64_tr_b16 v[88:89], v6 offset:20480
    v_mfma_f32_16x16x32_bf16 v[220:223], v[52:55], v[28:31], v[220:223]
    ds_read_b64_tr_b16 v[90:91], v6 offset:20992
    v_mfma_f32_16x16x32_bf16 v[216:219], v[52:55], v[24:27], v[216:219]
    ds_read_b64_tr_b16 v[92:93], v7 offset:20480
    v_mfma_f32_16x16x32_bf16 v[200:203], v[48:51], v[24:27], v[200:203]
    ds_read_b64_tr_b16 v[94:95], v7 offset:20992
    v_mfma_f32_16x16x32_bf16 v[196:199], v[48:51], v[20:23], v[196:199]
    ds_read_b64_tr_b16 v[72:73], v6 offset:4096
    v_mfma_f32_16x16x32_bf16 v[212:215], v[52:55], v[20:23], v[212:215]
    ds_read_b64_tr_b16 v[74:75], v6 offset:4608
    v_mfma_f32_16x16x32_bf16 v[208:211], v[52:55], v[16:19], v[208:211]
    ds_read_b64_tr_b16 v[76:77], v7 offset:4096
    v_mfma_f32_16x16x32_bf16 v[192:195], v[48:51], v[16:19], v[192:195]
    ds_read_b64_tr_b16 v[78:79], v7 offset:4608
    v_mfma_f32_16x16x32_bf16 v[128:131], v[32:35], v[16:19], v[128:131]
    s_add_u32 s84, s84, 1
    s_cmp_eq_u32 s82, 2
    s_cselect_b32 s78, s83, 40960
    s_cselect_b32 s82, -1, s82
    s_add_u32 s82, s82, 1
    v_mfma_f32_16x16x32_bf16 v[144:147], v[36:39], v[16:19], v[144:147]
    v_add_u32 v4, s78, v4
    v_add_u32 v5, s78, v5
    v_mfma_f32_16x16x32_bf16 v[148:151], v[36:39], v[20:23], v[148:151]
    v_add_u32 v6, s78, v6
    v_add_u32 v7, s78, v7
    v_mfma_f32_16x16x32_bf16 v[132:135], v[32:35], v[20:23], v[132:135]
    v_mfma_f32_16x16x32_bf16 v[136:139], v[32:35], v[24:27], v[136:139]
    v_mfma_f32_16x16x32_bf16 v[152:155], v[36:39], v[24:27], v[152:155]
    v_mfma_f32_16x16x32_bf16 v[156:159], v[36:39], v[28:31], v[156:159]
    v_mfma_f32_16x16x32_bf16 v[140:143], v[32:35], v[28:31], v[140:143]
    s_waitcnt vmcnt(0) lgkmcnt(0)
    v_mfma_f32_16x16x32_bf16 v[160:163], v[80:83], v[56:59], v[160:163]
    v_mfma_f32_16x16x32_bf16 v[176:179], v[84:87], v[56:59], v[176:179]
    s_barrier
    s_cmp_eq_u32 s84, 16
    s_cbranch_scc1 L_Mtail
    v_mfma_f32_16x16x32_bf16 v[180:183], v[84:87], v[60:63], v[180:183]
    ds_read_b128 v[16:19], v4 offset:0
    v_mfma_f32_16x16x32_bf16 v[164:167], v[80:83], v[60:63], v[164:167]
    ds_read_b64_tr_b16 v[40:41], v6 offset:8192
    v_mfma_f32_16x16x32_bf16 v[168:171], v[80:83], v[64:67], v[168:171]
    ds_read_b64_tr_b16 v[42:43], v6 offset:8704
    v_mfma_f32_16x16x32_bf16 v[184:187], v[84:87], v[64:67], v[184:187]
    ds_read_b128 v[20:23], v4 offset:2048
    v_mfma_f32_16x16x32_bf16 v[188:191], v[84:87], v[68:71], v[188:191]
    ds_read_b128 v[24:27], v4 offset:4096
    v_mfma_f32_16x16x32_bf16 v[172:175], v[80:83], v[68:71], v[172:175]
    ds_read_b128 v[28:31], v4 offset:6144
    v_mfma_f32_16x16x32_bf16 v[204:207], v[88:91], v[68:71], v[204:207]
    ds_read_b64_tr_b16 v[44:45], v7 offset:8192
    v_mfma_f32_16x16x32_bf16 v[220:223], v[92:95], v[68:71], v[220:223]
    ds_read_b64_tr_b16 v[46:47], v7 offset:8704
    v_mfma_f32_16x16x32_bf16 v[216:219], v[92:95], v[64:67], v[216:219]
    ds_read_b64_tr_b16 v[48:49], v6 offset:16384
    v_mfma_f32_16x16x32_bf16 v[200:203], v[88:91], v[64:67], v[200:203]
    ds_read_b64_tr_b16 v[50:51], v6 offset:16896
    v_mfma_f32_16x16x32_bf16 v[196:199], v[88:91], v[60:63], v[196:199]
    ds_read_b64_tr_b16 v[52:53], v7 offset:16384
    v_mfma_f32_16x16x32_bf16 v[212:215], v[92:95], v[60:63], v[212:215]
    ds_read_b64_tr_b16 v[54:55], v7 offset:16896
    v_mfma_f32_16x16x32_bf16 v[208:211], v[92:95], v[56:59], v[208:211]
    ds_read_b64_tr_b16 v[32:33], v6 offset:0
    v_mfma_f32_16x16x32_bf16 v[192:195], v[88:91], v[56:59], v[192:195]
    ds_read_b64_tr_b16 v[34:35], v6 offset:512
    v_mfma_f32_16x16x32_bf16 v[128:131], v[72:75], v[56:59], v[128:131]
    ds_read_b64_tr_b16 v[36:37], v7 offset:0
    v_mfma_f32_16x16x32_bf16 v[144:147], v[76:79], v[56:59], v[144:147]
    ds_read_b64_tr_b16 v[38:39], v7 offset:512
    v_mfma_f32_16x16x32_bf16 v[148:151], v[76:79], v[60:63], v[148:151]
    v_mfma_f32_16x16x32_bf16 v[132:135], v[72:75], v[60:63], v[132:135]
    v_mfma_f32_16x16x32_bf16 v[136:139], v[72:75], v[64:67], v[136:139]
    v_mfma_f32_16x16x32_bf16 v[152:155], v[76:79], v[64:67], v[152:155]
    v_mfma_f32_16x16x32_bf16 v[156:159], v[76:79], v[68:71], v[156:159]
    v_mfma_f32_16x16x32_bf16 v[140:143], v[72:75], v[68:71], v[140:143]
    s_branch L_Mloop
    .p2align 3
L_Mtail:
    s_mov_b64 exec, 0xffff
    ds_read_b64 v[104:105], v11 offset:0
    ds_read_b64 v[106:107], v11 offset:128
    ds_read_b64 v[108:109], v11 offset:256
    ds_read_b64 v[110:111], v11 offset:384
    s_mov_b64 exec, -1
    s_nop 0
    v_mfma_f32_16x16x32_bf16 v[180:183], v[84:87], v[60:63], v[180:183]
    ds_read_b64 v[20:21], v12 offset:512
    v_mfma_f32_16x16x32_bf16 v[164:167], v[80:83], v[60:63], v[164:167]
    ds_read_b64 v[22:23], v12 offset:640
    v_mfma_f32_16x16x32_bf16 v[168:171], v[80:83], v[64:67], v[168:171]
    ds_read_b64 v[24:25], v12 offset:1024
    v_mfma_f32_16x16x32_bf16 v[184:187], v[84:87], v[64:67], v[184:187]
    ds_read_b64 v[26:27], v12 offset:1152
    v_mfma_f32_16x16x32_bf16 v[188:191], v[84:87], v[68:71], v[188:191]
    ds_read_b64 v[16:17], v12 offset:0
    v_mfma_f32_16x16x32_bf16 v[172:175], v[80:83], v[68:71], v[172:175]
    ds_read_b64 v[18:19], v12 offset:128
    v_mfma_f32_16x16x32_bf16 v[204:207], v[88:91], v[68:71], v[204:207]
    ds_read2_b32 v[32:33], v14 offset0:0 offset1:32
    v_mfma_f32_16x16x32_bf16 v[220:223], v[92:95], v[68:71], v[220:223]
    ds_read_b32 v28, v13 offset:0
    v_mfma_f32_16x16x32_bf16 v[216:219], v[92:95], v[64:67], v[216:219]
    ds_read_b32 v30, v13 offset:64
    v_mfma_f32_16x16x32_bf16 v[200:203], v[88:91], v[64:67], v[200:203]
    ds_read_b32 v44, v13 offset:128
    v_mfma_f32_16x16x32_bf16 v[196:199], v[88:91], v[60:63], v[196:199]
    ds_read_b32 v46, v13 offset:192
    v_mfma_f32_16x16x32_bf16 v[212:215], v[92:95], v[60:63], v[212:215]
    v_mfma_f32_16x16x32_bf16 v[208:211], v[92:95], v[56:59], v[208:211]
    v_mfma_f32_16x16x32_bf16 v[192:195], v[88:91], v[56:59], v[192:195]
    s_waitcnt lgkmcnt(0)
    s_nop 0
    v_mfma_f32_16x16x16_bf16 v[160:163], v[20:21], v[104:105], v[160:163]
    v_mfma_f32_16x16x16_bf16 v[176:179], v[22:23], v[104:105], v[176:179]
    v_mfma_f32_16x16x16_bf16 v[164:167], v[20:21], v[106:107], v[164:167]
    v_mfma_f32_16x16x16_bf16 v[180:183], v[22:23], v[106:107], v[180:183]
    v_mfma_f32_16x16x16_bf16 v[168:171], v[20:21], v[108:109], v[168:171]
    v_mfma_f32_16x16x16_bf16 v[184:187], v[22:23], v[108:109], v[184:187]
    v_mfma_f32_16x16x16_bf16 v[172:175], v[20:21], v[110:111], v[172:175]
    v_mfma_f32_16x16x16_bf16 v[188:191], v[22:23], v[110:111], v[188:191]
    v_mul_f32 v34, 0x3fb8aa3b, v32
    v_mul_f32 v48, 0x3fb8aa3b, v33
    v_mfma_f32_16x16x16_bf16 v[192:195], v[24:25], v[104:105], v[192:195]
    v_mfma_f32_16x16x16_bf16 v[208:211], v[26:27], v[104:105], v[208:211]
    v_mfma_f32_16x16x16_bf16 v[196:199], v[24:25], v[106:107], v[196:199]
    v_cvt_pk_bf16_f32 v160, v160, v161
    v_cvt_pk_bf16_f32 v161, v162, v163
    v_cvt_pk_bf16_f32 v162, v176, v177
    v_cvt_pk_bf16_f32 v163, v178, v179
    v_mfma_f32_16x16x16_bf16 v[212:215], v[26:27], v[106:107], v[212:215]
    v_cvt_pk_bf16_f32 v164, v164, v165
    v_cvt_pk_bf16_f32 v165, v166, v167
    v_cvt_pk_bf16_f32 v166, v180, v181
    v_cvt_pk_bf16_f32 v167, v182, v183
    v_mfma_f32_16x16x16_bf16 v[200:203], v[24:25], v[108:109], v[200:203]
    v_cvt_pk_bf16_f32 v168, v168, v169
    v_cvt_pk_bf16_f32 v169, v170, v171
    v_cvt_pk_bf16_f32 v170, v184, v185
    v_cvt_pk_bf16_f32 v171, v186, v187
    v_mfma_f32_16x16x16_bf16 v[216:219], v[26:27], v[108:109], v[216:219]
    v_cvt_pk_bf16_f32 v172, v172, v173
    v_cvt_pk_bf16_f32 v173, v174, v175
    v_cvt_pk_bf16_f32 v174, v188, v189
    v_cvt_pk_bf16_f32 v175, v190, v191
    v_mfma_f32_16x16x16_bf16 v[204:207], v[24:25], v[110:111], v[204:207]
    v_permlane16_swap_b32 v160, v164
    v_permlane16_swap_b32 v161, v165
    v_permlane16_swap_b32 v162, v166
    v_permlane16_swap_b32 v163, v167
    v_mfma_f32_16x16x16_bf16 v[220:223], v[26:27], v[110:111], v[220:223]
    v_permlane16_swap_b32 v168, v172
    v_permlane16_swap_b32 v169, v173
    v_permlane16_swap_b32 v170, v174
    v_permlane16_swap_b32 v171, v175
    v_mfma_f32_32x32x16_bf16 v[224:239], v[96:99], v[160:163], 0
    v_mfma_f32_32x32x16_bf16 v[224:239], v[100:103], v[164:167], v[224:239]
    v_mfma_f32_32x32x16_bf16 v[240:255], v[96:99], v[168:171], 0
    v_mfma_f32_32x32x16_bf16 v[240:255], v[100:103], v[172:175], v[240:255]
    v_pk_mul_f32 v[192:193], v[192:193], v[28:29] op_sel_hi:[1,0]
    v_pk_mul_f32 v[194:195], v[194:195], v[28:29] op_sel_hi:[1,0]
    v_pk_mul_f32 v[208:209], v[208:209], v[28:29] op_sel_hi:[1,0]
    v_pk_mul_f32 v[210:211], v[210:211], v[28:29] op_sel_hi:[1,0]
L_pad7:
    s_cbranch_execz L_pad11
    s_nop 0
    v_cvt_pk_bf16_f32 v192, v192, v193
    v_cvt_pk_bf16_f32 v193, v194, v195
    v_cvt_pk_bf16_f32 v194, v208, v209
    v_cvt_pk_bf16_f32 v195, v210, v211
    v_pk_mul_f32 v[196:197], v[196:197], v[30:31] op_sel_hi:[1,0]
    v_pk_mul_f32 v[198:199], v[198:199], v[30:31] op_sel_hi:[1,0]
    v_pk_mul_f32 v[212:213], v[212:213], v[30:31] op_sel_hi:[1,0]
    v_pk_mul_f32 v[214:215], v[214:215], v[30:31] op_sel_hi:[1,0]
    v_cvt_pk_bf16_f32 v196, v196, v197
    v_cvt_pk_bf16_f32 v197, v198, v199
    v_cvt_pk_bf16_f32 v198, v212, v213
    v_cvt_pk_bf16_f32 v199, v214, v215
    v_pk_mul_f32 v[200:201], v[200:201], v[44:45] op_sel_hi:[1,0]
    v_pk_mul_f32 v[202:203], v[202:203], v[44:45] op_sel_hi:[1,0]
    v_pk_mul_f32 v[216:217], v[216:217], v[44:45] op_sel_hi:[1,0]
    v_pk_mul_f32 v[218:219], v[218:219], v[44:45] op_sel_hi:[1,0]
    v_cvt_pk_bf16_f32 v200, v200, v201
    v_cvt_pk_bf16_f32 v201, v202, v203
    v_cvt_pk_bf16_f32 v202, v216, v217
    v_cvt_pk_bf16_f32 v203, v218, v219
    v_pk_mul_f32 v[204:205], v[204:205], v[46:47] op_sel_hi:[1,0]
    v_pk_mul_f32 v[206:207], v[206:207], v[46:47] op_sel_hi:[1,0]
    v_pk_mul_f32 v[220:221], v[220:221], v[46:47] op_sel_hi:[1,0]
    v_pk_mul_f32 v[222:223], v[222:223], v[46:47] op_sel_hi:[1,0]
    v_cvt_pk_bf16_f32 v204, v204, v205
    v_cvt_pk_bf16_f32 v205, v206, v207
    v_cvt_pk_bf16_f32 v206, v220, v221
    v_cvt_pk_bf16_f32 v207, v222, v223
    v_mfma_f32_16x16x32_bf16 v[128:131], v[72:75], v[56:59], v[128:131]
    v_max3_f32 v36, v224, v225, v226
    v_max3_f32 v38, -v224, -v225, -v226
    v_max3_f32 v36, v36, v227, v228
    v_max3_f32 v38, v38, -v227, -v228
    v_mfma_f32_16x16x32_bf16 v[144:147], v[76:79], v[56:59], v[144:147]
    v_max3_f32 v36, v36, v229, v230
    v_max3_f32 v38, v38, -v229, -v230
    v_max3_f32 v36, v36, v231, v232
    v_max3_f32 v38, v38, -v231, -v232
    v_mfma_f32_16x16x32_bf16 v[148:151], v[76:79], v[60:63], v[148:151]
    v_max3_f32 v36, v36, v233, v234
    v_max3_f32 v38, v38, -v233, -v234
    v_max3_f32 v36, v36, v235, v236
    v_max3_f32 v38, v38, -v235, -v236
    v_mfma_f32_16x16x32_bf16 v[132:135], v[72:75], v[60:63], v[132:135]
    v_max3_f32 v36, v36, v237, v238
    v_max3_f32 v38, v38, -v237, -v238
    v_max_f32_e64 v36, v36, v239
    v_max_f32 v38, v38, -v239
    v_mfma_f32_16x16x32_bf16 v[136:139], v[72:75], v[64:67], v[136:139]
    v_max3_f32 v37, v240, v241, v242
    v_max3_f32 v39, -v240, -v241, -v242
    v_max3_f32 v37, v37, v243, v244
    v_max3_f32 v39, v39, -v243, -v244
    v_mfma_f32_16x16x32_bf16 v[152:155], v[76:79], v[64:67], v[152:155]
    v_max3_f32 v37, v37, v245, v246
    v_max3_f32 v39, v39, -v245, -v246
    v_max3_f32 v37, v37, v247, v248
    v_max3_f32 v39, v39, -v247, -v248
    v_mfma_f32_16x16x32_bf16 v[156:159], v[76:79], v[68:71], v[156:159]
    v_max3_f32 v37, v37, v249, v250
    v_max3_f32 v39, v39, -v249, -v250
    v_max3_f32 v37, v37, v251, v252
    v_max3_f32 v39, v39, -v251, -v252
    v_mfma_f32_16x16x32_bf16 v[140:143], v[72:75], v[68:71], v[140:143]
    v_max3_f32 v37, v37, v253, v254
    v_max3_f32 v39, v39, -v253, -v254
    v_max_f32_e64 v37, v37, v255
    v_max_f32 v39, v39, -v255
    v_permlane32_swap_b32 v36, v38
    s_nop 0
    v_permlane32_swap_b32 v37, v39
    v_max_f32 v36, v36, v38
    v_max_f32_e64 v37, v37, v39
    v_mul_f32 v36, -v36, v34
    v_mul_f32 v37, -v37, v48
    v_mov_b32 v38, v36
    v_mov_b32 v39, v37
    s_nop 0
    v_permlane32_swap_b32 v36, v38
    v_permlane32_swap_b32_e64 v37, v39
    v_pk_fma_f32 v[60:61], v[224:225], v[34:35], v[36:37] op_sel_hi:[1,0,0]
    v_pk_fma_f32 v[62:63], v[226:227], v[34:35], v[36:37] op_sel_hi:[1,0,0]
    v_pk_fma_f32 v[64:65], v[228:229], v[34:35], v[36:37] op_sel_hi:[1,0,0]
    v_pk_fma_f32 v[66:67], v[230:231], v[34:35], v[36:37] op_sel_hi:[1,0,0]
    v_pk_fma_f32 v[68:69], v[232:233], v[34:35], v[36:37] op_sel_hi:[1,0,0]
    v_pk_fma_f32 v[70:71], v[234:235], v[34:35], v[36:37] op_sel_hi:[1,0,0]
    v_pk_fma_f32 v[72:73], v[236:237], v[34:35], v[36:37] op_sel_hi:[1,0,0]
    v_pk_fma_f32 v[74:75], v[238:239], v[34:35], v[36:37] op_sel_hi:[1,0,0]
    v_pk_fma_f32 v[76:77], v[224:225], v[34:35], v[38:39] op_sel_hi:[1,0,0] neg_lo:[1,0,0] neg_hi:[1,0,0]
    v_pk_fma_f32 v[78:79], v[226:227], v[34:35], v[38:39] op_sel_hi:[1,0,0] neg_lo:[1,0,0] neg_hi:[1,0,0]
    v_pk_fma_f32 v[80:81], v[228:229], v[34:35], v[38:39] op_sel_hi:[1,0,0] neg_lo:[1,0,0] neg_hi:[1,0,0]
    v_pk_fma_f32 v[82:83], v[230:231], v[34:35], v[38:39] op_sel_hi:[1,0,0] neg_lo:[1,0,0] neg_hi:[1,0,0]
    v_pk_fma_f32 v[84:85], v[232:233], v[34:35], v[38:39] op_sel_hi:[1,0,0] neg_lo:[1,0,0] neg_hi:[1,0,0]
    v_pk_fma_f32 v[86:87], v[234:235], v[34:35], v[38:39] op_sel_hi:[1,0,0] neg_lo:[1,0,0] neg_hi:[1,0,0]
    v_pk_fma_f32 v[88:89], v[236:237], v[34:35], v[38:39] op_sel_hi:[1,0,0] neg_lo:[1,0,0] neg_hi:[1,0,0]
    v_pk_fma_f32 v[90:91], v[238:239], v[34:35], v[38:39] op_sel_hi:[1,0,0] neg_lo:[1,0,0] neg_hi:[1,0,0]
    v_exp_f32 v60, v60
    v_exp_f32 v61, v61
    v_exp_f32 v62, v62
    v_exp_f32 v63, v63
    v_exp_f32 v64, v64
    v_exp_f32 v65, v65
    v_exp_f32 v66, v66
    v_exp_f32 v67, v67
    v_exp_f32 v68, v68
    v_exp_f32 v69, v69
    v_exp_f32 v70, v70
    v_exp_f32 v71, v71
    v_exp_f32 v72, v72
    v_exp_f32 v73, v73
    v_exp_f32 v74, v74
    v_exp_f32 v75, v75
    v_exp_f32 v76, v76
    v_exp_f32 v77, v77
    v_exp_f32 v78, v78
    v_exp_f32 v79, v79
    v_exp_f32 v80, v80
    v_exp_f32 v81, v81
    v_exp_f32 v82, v82
    v_exp_f32 v83, v83
    v_exp_f32 v84, v84
    v_exp_f32 v85, v85
    v_exp_f32 v86, v86
    v_exp_f32 v87, v87
    v_exp_f32 v88, v88
    v_exp_f32 v89, v89
    v_exp_f32 v90, v90
    v_exp_f32 v91, v91
    v_pk_add_f32 v[40:41], v[60:61], v[62:63]
    v_pk_add_f32 v[42:43], v[76:77], v[78:79]
    v_pk_add_f32 v[40:41], v[40:41], v[64:65]
    v_pk_add_f32 v[42:43], v[42:43], v[80:81]
    v_pk_add_f32 v[40:41], v[40:41], v[66:67]
    v_pk_add_f32 v[42:43], v[42:43], v[82:83]
    v_pk_add_f32 v[40:41], v[40:41], v[68:69]
    v_pk_add_f32 v[42:43], v[42:43], v[84:85]
    v_pk_add_f32 v[40:41], v[40:41], v[70:71]
    v_pk_add_f32 v[42:43], v[42:43], v[86:87]
    v_pk_add_f32 v[40:41], v[40:41], v[72:73]
    v_pk_add_f32 v[42:43], v[42:43], v[88:89]
    v_pk_add_f32 v[40:41], v[40:41], v[74:75]
    v_pk_add_f32 v[42:43], v[42:43], v[90:91]
    v_add_f32 v40, v40, v41
    v_add_f32 v42, v42, v43
    s_nop 1
    v_permlane32_swap_b32 v40, v42
    v_add_f32 v40, v40, v42
    v_rcp_f32 v40, v40
    s_nop 0
    v_mov_b32 v42, v40
    s_nop 1
    v_permlane32_swap_b32 v40, v42
    v_pk_mul_f32 v[60:61], v[60:61], v[40:41] op_sel_hi:[1,0]
    v_pk_mul_f32 v[62:63], v[62:63], v[40:41] op_sel_hi:[1,0]
    v_pk_mul_f32 v[64:65], v[64:65], v[40:41] op_sel_hi:[1,0]
    v_pk_mul_f32 v[66:67], v[66:67], v[40:41] op_sel_hi:[1,0]
    v_cvt_pk_bf16_f32 v160, v60, v61
    v_cvt_pk_bf16_f32 v161, v62, v63
    v_cvt_pk_bf16_f32 v162, v64, v65
    v_cvt_pk_bf16_f32 v163, v66, v67
    v_pk_mul_f32 v[68:69], v[68:69], v[40:41] op_sel_hi:[1,0]
    v_pk_mul_f32 v[70:71], v[70:71], v[40:41] op_sel_hi:[1,0]
    v_pk_mul_f32 v[72:73], v[72:73], v[40:41] op_sel_hi:[1,0]
    v_pk_mul_f32 v[74:75], v[74:75], v[40:41] op_sel_hi:[1,0]
    v_cvt_pk_bf16_f32 v166, v68, v69
    v_cvt_pk_bf16_f32 v167, v70, v71
    v_cvt_pk_bf16_f32 v164, v72, v73
    v_cvt_pk_bf16_f32 v165, v74, v75
    v_pk_mul_f32 v[76:77], v[76:77], v[42:43] op_sel_hi:[1,0]
    v_pk_mul_f32 v[78:79], v[78:79], v[42:43] op_sel_hi:[1,0]
    v_pk_mul_f32 v[80:81], v[80:81], v[42:43] op_sel_hi:[1,0]
    v_pk_mul_f32 v[82:83], v[82:83], v[42:43] op_sel_hi:[1,0]
    v_cvt_pk_bf16_f32 v168, v76, v77
    v_cvt_pk_bf16_f32 v169, v78, v79
    v_cvt_pk_bf16_f32 v170, v80, v81
    v_cvt_pk_bf16_f32 v171, v82, v83
    v_pk_mul_f32 v[84:85], v[84:85], v[42:43] op_sel_hi:[1,0]
    v_pk_mul_f32 v[86:87], v[86:87], v[42:43] op_sel_hi:[1,0]
    v_pk_mul_f32 v[88:89], v[88:89], v[42:43] op_sel_hi:[1,0]
    v_pk_mul_f32 v[90:91], v[90:91], v[42:43] op_sel_hi:[1,0]
    v_cvt_pk_bf16_f32 v174, v84, v85
    v_cvt_pk_bf16_f32 v175, v86, v87
    v_cvt_pk_bf16_f32 v172, v88, v89
    v_cvt_pk_bf16_f32 v173, v90, v91
    v_pk_fma_f32 v[60:61], v[240:241], v[48:49], v[36:37] op_sel:[0,0,1] op_sel_hi:[1,0,1]
    v_pk_fma_f32 v[62:63], v[242:243], v[48:49], v[36:37] op_sel:[0,0,1] op_sel_hi:[1,0,1]
    v_pk_fma_f32 v[64:65], v[244:245], v[48:49], v[36:37] op_sel:[0,0,1] op_sel_hi:[1,0,1]
    v_pk_fma_f32 v[66:67], v[246:247], v[48:49], v[36:37] op_sel:[0,0,1] op_sel_hi:[1,0,1]
    v_pk_fma_f32 v[68:69], v[248:249], v[48:49], v[36:37] op_sel:[0,0,1] op_sel_hi:[1,0,1]
    v_pk_fma_f32 v[70:71], v[250:251], v[48:49], v[36:37] op_sel:[0,0,1] op_sel_hi:[1,0,1]
    v_pk_fma_f32 v[72:73], v[252:253], v[48:49], v[36:37] op_sel:[0,0,1] op_sel_hi:[1,0,1]
    v_pk_fma_f32 v[74:75], v[254:255], v[48:49], v[36:37] op_sel:[0,0,1] op_sel_hi:[1,0,1]
    v_pk_fma_f32 v[76:77], v[240:241], v[48:49], v[38:39] op_sel:[0,0,1] op_sel_hi:[1,0,1] neg_lo:[1,0,0] neg_hi:[1,0,0]
    v_pk_fma_f32 v[78:79], v[242:243], v[48:49], v[38:39] op_sel:[0,0,1] op_sel_hi:[1,0,1] neg_lo:[1,0,0] neg_hi:[1,0,0]
    v_pk_fma_f32 v[80:81], v[244:245], v[48:49], v[38:39] op_sel:[0,0,1] op_sel_hi:[1,0,1] neg_lo:[1,0,0] neg_hi:[1,0,0]
    v_pk_fma_f32 v[82:83], v[246:247], v[48:49], v[38:39] op_sel:[0,0,1] op_sel_hi:[1,0,1] neg_lo:[1,0,0] neg_hi:[1,0,0]
    v_pk_fma_f32 v[84:85], v[248:249], v[48:49], v[38:39] op_sel:[0,0,1] op_sel_hi:[1,0,1] neg_lo:[1,0,0] neg_hi:[1,0,0]
    v_pk_fma_f32 v[86:87], v[250:251], v[48:49], v[38:39] op_sel:[0,0,1] op_sel_hi:[1,0,1] neg_lo:[1,0,0] neg_hi:[1,0,0]
    v_pk_fma_f32 v[88:89], v[252:253], v[48:49], v[38:39] op_sel:[0,0,1] op_sel_hi:[1,0,1] neg_lo:[1,0,0] neg_hi:[1,0,0]
    v_pk_fma_f32 v[90:91], v[254:255], v[48:49], v[38:39] op_sel:[0,0,1] op_sel_hi:[1,0,1] neg_lo:[1,0,0] neg_hi:[1,0,0]
    v_exp_f32 v60, v60
    v_exp_f32 v61, v61
    v_exp_f32 v62, v62
    v_exp_f32 v63, v63
    ds_write_b128 v116, v[192:195] offset:0
    v_exp_f32 v64, v64
    v_exp_f32 v65, v65
    v_exp_f32 v66, v66
    v_exp_f32 v67, v67
    ds_write_b128 v116, v[196:199] offset:2048
    v_exp_f32 v68, v68
    v_exp_f32 v69, v69
    v_exp_f32 v70, v70
    v_exp_f32 v71, v71
    ds_write_b128 v116, v[200:203] offset:4096
    v_exp_f32 v72, v72
    v_exp_f32 v73, v73
    v_exp_f32 v74, v74
    v_exp_f32 v75, v75
    ds_write_b128 v116, v[204:207] offset:6144
    v_exp_f32 v76, v76
    v_exp_f32 v77, v77
    v_exp_f32 v78, v78
    v_exp_f32 v79, v79
    ds_write_b128 v112, v[160:163] offset:0
    v_exp_f32 v80, v80
    v_exp_f32 v81, v81
    v_exp_f32 v82, v82
    v_exp_f32 v83, v83
    ds_write_b128 v113, v[164:167] offset:0
    v_exp_f32 v84, v84
    v_exp_f32 v85, v85
    v_exp_f32 v86, v86
    v_exp_f32 v87, v87
    ds_write_b128 v114, v[168:171] offset:0
    v_exp_f32 v88, v88
    v_exp_f32 v89, v89
    v_exp_f32 v90, v90
    v_exp_f32 v91, v91
    ds_write_b128 v115, v[172:175] offset:0
    v_pk_add_f32 v[40:41], v[60:61], v[62:63]
    v_pk_add_f32 v[42:43], v[76:77], v[78:79]
    v_pk_add_f32 v[40:41], v[40:41], v[64:65]
    v_pk_add_f32 v[42:43], v[42:43], v[80:81]
    v_pk_add_f32 v[40:41], v[40:41], v[66:67]
    v_pk_add_f32 v[42:43], v[42:43], v[82:83]
    v_pk_add_f32 v[40:41], v[40:41], v[68:69]
    v_pk_add_f32 v[42:43], v[42:43], v[84:85]
    v_pk_add_f32 v[40:41], v[40:41], v[70:71]
    v_pk_add_f32 v[42:43], v[42:43], v[86:87]
    v_pk_add_f32 v[40:41], v[40:41], v[72:73]
    v_pk_add_f32 v[42:43], v[42:43], v[88:89]
    v_pk_add_f32 v[40:41], v[40:41], v[74:75]
    v_pk_add_f32 v[42:43], v[42:43], v[90:91]
    v_add_f32 v40, v40, v41
    v_add_f32 v42, v42, v43
    s_nop 1
    v_permlane32_swap_b32 v40, v42
    v_add_f32 v40, v40, v42
    v_rcp_f32 v40, v40
    s_nop 0
    v_mov_b32 v42, v40
    s_nop 1
    v_permlane32_swap_b32 v40, v42
    v_pk_mul_f32 v[60:61], v[60:61], v[40:41] op_sel_hi:[1,0]
    v_pk_mul_f32 v[62:63], v[62:63], v[40:41] op_sel_hi:[1,0]
    v_pk_mul_f32 v[64:65], v[64:65], v[40:41] op_sel_hi:[1,0]
    v_pk_mul_f32 v[66:67], v[66:67], v[40:41] op_sel_hi:[1,0]
    v_cvt_pk_bf16_f32 v176, v60, v61
    v_cvt_pk_bf16_f32 v177, v62, v63
    v_cvt_pk_bf16_f32 v178, v64, v65
    v_cvt_pk_bf16_f32 v179, v66, v67
    ds_write_b128 v112, v[176:179] offset:4096
    v_pk_mul_f32 v[68:69], v[68:69], v[40:41] op_sel_hi:[1,0]
    v_pk_mul_f32 v[70:71], v[70:71], v[40:41] op_sel_hi:[1,0]
    v_pk_mul_f32 v[72:73], v[72:73], v[40:41] op_sel_hi:[1,0]
    v_pk_mul_f32 v[74:75], v[74:75], v[40:41] op_sel_hi:[1,0]
    v_cvt_pk_bf16_f32 v182, v68, v69
    v_cvt_pk_bf16_f32 v183, v70, v71
    v_cvt_pk_bf16_f32 v180, v72, v73
    v_cvt_pk_bf16_f32 v181, v74, v75
    ds_write_b128 v113, v[180:183] offset:4096
    v_pk_mul_f32 v[76:77], v[76:77], v[42:43] op_sel_hi:[1,0]
    v_pk_mul_f32 v[78:79], v[78:79], v[42:43] op_sel_hi:[1,0]
    v_pk_mul_f32 v[80:81], v[80:81], v[42:43] op_sel_hi:[1,0]
    v_pk_mul_f32 v[82:83], v[82:83], v[42:43] op_sel_hi:[1,0]
    v_cvt_pk_bf16_f32 v184, v76, v77
    v_cvt_pk_bf16_f32 v185, v78, v79
    v_cvt_pk_bf16_f32 v186, v80, v81
    v_cvt_pk_bf16_f32 v187, v82, v83
    ds_write_b128 v114, v[184:187] offset:4096
    v_pk_mul_f32 v[84:85], v[84:85], v[42:43] op_sel_hi:[1,0]
    v_pk_mul_f32 v[86:87], v[86:87], v[42:43] op_sel_hi:[1,0]
    v_pk_mul_f32 v[88:89], v[88:89], v[42:43] op_sel_hi:[1,0]
    v_pk_mul_f32 v[90:91], v[90:91], v[42:43] op_sel_hi:[1,0]
    v_cvt_pk_bf16_f32 v190, v84, v85
    v_cvt_pk_bf16_f32 v191, v86, v87
    v_cvt_pk_bf16_f32 v188, v88, v89
    v_cvt_pk_bf16_f32 v189, v90, v91
    ds_write_b128 v115, v[188:191] offset:4096
    s_waitcnt lgkmcnt(0)
    s_barrier
L_pad8:
    s_cbranch_execz L_pad12
    s_setprio 0
    v_mfma_f32_16x16x16_bf16 v[128:131], v[16:17], v[104:105], v[128:131]
    v_mfma_f32_16x16x16_bf16 v[144:147], v[18:19], v[104:105], v[144:147]
    v_mfma_f32_16x16x16_bf16 v[132:135], v[16:17], v[106:107], v[132:135]
    v_mfma_f32_16x16x16_bf16 v[148:151], v[18:19], v[106:107], v[148:151]
    v_mfma_f32_16x16x16_bf16 v[136:139], v[16:17], v[108:109], v[136:139]
    v_mfma_f32_16x16x16_bf16 v[152:155], v[18:19], v[108:109], v[152:155]
    v_mfma_f32_16x16x16_bf16 v[140:143], v[16:17], v[110:111], v[140:143]
    v_mfma_f32_16x16x16_bf16 v[156:159], v[18:19], v[110:111], v[156:159]
    v_lshrrev_b32 v11, 5, v2
    s_lshl_b32 s78, s81, 7
    s_add_u32 s78, s78, 162944
    v_lshl_add_u32 v10, v11, 4, s78
    v_and_b32 v13, 1, v2
    v_cmp_eq_u32 vcc, 1, v13
    v_mov_b32 v13, 162816
    v_and_b32 v12, 31, v2
    v_cndmask_b32 v10, v10, v13, vcc
    v_lshlrev_b32_e64 v12, 4, v12
    v_lshl_add_u32 v11, v11, 10, v12
    v_lshlrev_b32_e64 v14, 4, v2
    v_cvt_pk_bf16_f32 v128, v128, v129
    v_cvt_pk_bf16_f32 v129, v130, v131
    v_cvt_pk_bf16_f32 v130, v144, v145
    v_cvt_pk_bf16_f32 v131, v146, v147
    v_cvt_pk_bf16_f32 v132, v132, v133
    v_cvt_pk_bf16_f32 v133, v134, v135
    v_cvt_pk_bf16_f32 v134, v148, v149
    v_cvt_pk_bf16_f32 v135, v150, v151
    v_cvt_pk_bf16_f32 v136, v136, v137
    v_cvt_pk_bf16_f32 v137, v138, v139
    v_cvt_pk_bf16_f32 v138, v152, v153
    v_cvt_pk_bf16_f32 v139, v154, v155
    v_cvt_pk_bf16_f32 v140, v140, v141
    v_cvt_pk_bf16_f32 v141, v142, v143
    v_cvt_pk_bf16_f32 v142, v156, v157
    v_cvt_pk_bf16_f32 v143, v158, v159
    v_permlane16_swap_b32 v128, v132
    v_permlane16_swap_b32 v129, v133
    v_permlane16_swap_b32 v130, v134
    v_permlane16_swap_b32 v131, v135
    v_permlane16_swap_b32 v136, v140
    v_permlane16_swap_b32 v137, v141
    v_permlane16_swap_b32 v138, v142
    v_permlane16_swap_b32 v139, v143
    v_mfma_f32_32x32x16_bf16 v[224:239], v[96:99], v[128:131], 0
    v_mfma_f32_32x32x16_bf16 v[224:239], v[100:103], v[132:135], v[224:239]
    v_mfma_f32_32x32x16_bf16 v[240:255], v[96:99], v[136:139], 0
    v_mfma_f32_32x32x16_bf16 v[240:255], v[100:103], v[140:143], v[240:255]
    s_lshl_b32 s94, s70, 14
    s_lshl_b32 s79, s81, 13
    s_add_u32 s94, s94, s79
    s_add_u32 s94, s94, 8388608
    s_add_u32 s95, s94, 4096
    s_lshl_b32 s78, s69, 1
    s_add_u32 s78, s78, s80
    s_lshl_b32 s78, s78, 6
    s_lshl_b32 s79, s70, 1
    s_add_u32 s78, s78, s79
    s_add_u32 s78, s78, s81
    s_lshl_b32 s78, s78, 11
    s_add_u32 s96, s78, 4194304
    s_add_u32 s97, s96, 65536
    v_max3_f32 v36, v224, v225, v226
    v_max3_f32 v38, -v224, -v225, -v226
    v_max3_f32 v36, v36, v227, v228
    v_max3_f32 v38, v38, -v227, -v228
    v_max3_f32 v36, v36, v229, v230
    v_max3_f32 v38, v38, -v229, -v230
    v_max3_f32 v36, v36, v231, v232
    v_max3_f32 v38, v38, -v231, -v232
    v_max3_f32 v36, v36, v233, v234
    v_max3_f32 v38, v38, -v233, -v234
    v_max3_f32 v36, v36, v235, v236
    v_max3_f32 v38, v38, -v235, -v236
    v_max3_f32 v36, v36, v237, v238
    v_max3_f32 v38, v38, -v237, -v238
    v_max_f32_e64 v36, v36, v239
    v_max_f32 v38, v38, -v239
    v_max3_f32 v37, v240, v241, v242
    v_max3_f32 v39, -v240, -v241, -v242
    v_max3_f32 v37, v37, v243, v244
    v_max3_f32 v39, v39, -v243, -v244
    v_max3_f32 v37, v37, v245, v246
    v_max3_f32 v39, v39, -v245, -v246
    v_max3_f32 v37, v37, v247, v248
    v_max3_f32 v39, v39, -v247, -v248
    v_max3_f32 v37, v37, v249, v250
    v_max3_f32 v39, v39, -v249, -v250
    v_max3_f32 v37, v37, v251, v252
    v_max3_f32 v39, v39, -v251, -v252
    v_max3_f32 v37, v37, v253, v254
    v_max3_f32 v39, v39, -v253, -v254
    v_max_f32_e64 v37, v37, v255
    v_max_f32 v39, v39, -v255
    v_permlane32_swap_b32 v36, v38
    s_nop 0
    v_permlane32_swap_b32 v37, v39
    v_max_f32 v36, v36, v38
    v_max_f32_e64 v37, v37, v39
    v_mul_f32 v36, -v36, v34
    v_mul_f32 v37, -v37, v48
    v_mov_b32 v38, v36
    v_mov_b32 v39, v37
    s_nop 0
    v_permlane32_swap_b32 v36, v38
    v_permlane32_swap_b32_e64 v37, v39
    v_pk_fma_f32 v[60:61], v[224:225], v[34:35], v[36:37] op_sel_hi:[1,0,0]
    v_pk_fma_f32 v[62:63], v[226:227], v[34:35], v[36:37] op_sel_hi:[1,0,0]
    v_pk_fma_f32 v[64:65], v[228:229], v[34:35], v[36:37] op_sel_hi:[1,0,0]
    v_pk_fma_f32 v[66:67], v[230:231], v[34:35], v[36:37] op_sel_hi:[1,0,0]
    v_pk_fma_f32 v[68:69], v[232:233], v[34:35], v[36:37] op_sel_hi:[1,0,0]
    v_pk_fma_f32 v[70:71], v[234:235], v[34:35], v[36:37] op_sel_hi:[1,0,0]
    v_pk_fma_f32 v[72:73], v[236:237], v[34:35], v[36:37] op_sel_hi:[1,0,0]
    v_pk_fma_f32 v[74:75], v[238:239], v[34:35], v[36:37] op_sel_hi:[1,0,0]
    v_pk_fma_f32 v[76:77], v[224:225], v[34:35], v[38:39] op_sel_hi:[1,0,0] neg_lo:[1,0,0] neg_hi:[1,0,0]
    v_pk_fma_f32 v[78:79], v[226:227], v[34:35], v[38:39] op_sel_hi:[1,0,0] neg_lo:[1,0,0] neg_hi:[1,0,0]
    v_pk_fma_f32 v[80:81], v[228:229], v[34:35], v[38:39] op_sel_hi:[1,0,0] neg_lo:[1,0,0] neg_hi:[1,0,0]
    v_pk_fma_f32 v[82:83], v[230:231], v[34:35], v[38:39] op_sel_hi:[1,0,0] neg_lo:[1,0,0] neg_hi:[1,0,0]
    v_pk_fma_f32 v[84:85], v[232:233], v[34:35], v[38:39] op_sel_hi:[1,0,0] neg_lo:[1,0,0] neg_hi:[1,0,0]
    v_pk_fma_f32 v[86:87], v[234:235], v[34:35], v[38:39] op_sel_hi:[1,0,0] neg_lo:[1,0,0] neg_hi:[1,0,0]
    v_pk_fma_f32 v[88:89], v[236:237], v[34:35], v[38:39] op_sel_hi:[1,0,0] neg_lo:[1,0,0] neg_hi:[1,0,0]
    v_pk_fma_f32 v[90:91], v[238:239], v[34:35], v[38:39] op_sel_hi:[1,0,0] neg_lo:[1,0,0] neg_hi:[1,0,0]
    v_exp_f32 v60, v60
    v_exp_f32 v61, v61
    v_exp_f32 v62, v62
    v_exp_f32 v63, v63
    v_exp_f32 v64, v64
    v_exp_f32 v65, v65
    v_exp_f32 v66, v66
    v_exp_f32 v67, v67
    v_exp_f32 v68, v68
    v_exp_f32 v69, v69
    v_exp_f32 v70, v70
    v_exp_f32 v71, v71
    v_exp_f32 v72, v72
    v_exp_f32 v73, v73
    v_exp_f32 v74, v74
    v_exp_f32 v75, v75
    v_exp_f32 v76, v76
    v_exp_f32 v77, v77
    v_exp_f32 v78, v78
    v_exp_f32 v79, v79
    v_exp_f32 v80, v80
    v_exp_f32 v81, v81
    v_exp_f32 v82, v82
    v_exp_f32 v83, v83
    v_exp_f32 v84, v84
    v_exp_f32 v85, v85
    v_exp_f32 v86, v86
    v_exp_f32 v87, v87
    v_exp_f32 v88, v88
    v_exp_f32 v89, v89
    v_exp_f32 v90, v90
    v_exp_f32 v91, v91
    v_cvt_pk_bf16_f32 v160, v60, v61
    v_cvt_pk_bf16_f32 v161, v62, v63
    v_cvt_pk_bf16_f32 v162, v64, v65
    v_cvt_pk_bf16_f32 v163, v66, v67
    v_cvt_pk_bf16_f32 v164, v68, v69
    v_cvt_pk_bf16_f32 v165, v70, v71
    v_cvt_pk_bf16_f32 v166, v72, v73
    v_cvt_pk_bf16_f32 v167, v74, v75
    v_cvt_pk_bf16_f32 v168, v76, v77
    v_cvt_pk_bf16_f32 v169, v78, v79
    v_cvt_pk_bf16_f32 v170, v80, v81
    v_cvt_pk_bf16_f32 v171, v82, v83
    v_cvt_pk_bf16_f32 v172, v84, v85
    v_cvt_pk_bf16_f32 v173, v86, v87
    v_cvt_pk_bf16_f32 v174, v88, v89
    v_cvt_pk_bf16_f32 v175, v90, v91
    v_pk_fma_f32 v[60:61], v[240:241], v[48:49], v[36:37] op_sel:[0,0,1] op_sel_hi:[1,0,1]
    v_pk_fma_f32 v[62:63], v[242:243], v[48:49], v[36:37] op_sel:[0,0,1] op_sel_hi:[1,0,1]
    v_pk_fma_f32 v[64:65], v[244:245], v[48:49], v[36:37] op_sel:[0,0,1] op_sel_hi:[1,0,1]
    v_pk_fma_f32 v[66:67], v[246:247], v[48:49], v[36:37] op_sel:[0,0,1] op_sel_hi:[1,0,1]
    v_pk_fma_f32 v[68:69], v[248:249], v[48:49], v[36:37] op_sel:[0,0,1] op_sel_hi:[1,0,1]
    v_pk_fma_f32 v[70:71], v[250:251], v[48:49], v[36:37] op_sel:[0,0,1] op_sel_hi:[1,0,1]
    v_pk_fma_f32 v[72:73], v[252:253], v[48:49], v[36:37] op_sel:[0,0,1] op_sel_hi:[1,0,1]
    v_pk_fma_f32 v[74:75], v[254:255], v[48:49], v[36:37] op_sel:[0,0,1] op_sel_hi:[1,0,1]
    v_pk_fma_f32 v[76:77], v[240:241], v[48:49], v[38:39] op_sel:[0,0,1] op_sel_hi:[1,0,1] neg_lo:[1,0,0] neg_hi:[1,0,0]
    v_pk_fma_f32 v[78:79], v[242:243], v[48:49], v[38:39] op_sel:[0,0,1] op_sel_hi:[1,0,1] neg_lo:[1,0,0] neg_hi:[1,0,0]
    v_pk_fma_f32 v[80:81], v[244:245], v[48:49], v[38:39] op_sel:[0,0,1] op_sel_hi:[1,0,1] neg_lo:[1,0,0] neg_hi:[1,0,0]
    v_pk_fma_f32 v[82:83], v[246:247], v[48:49], v[38:39] op_sel:[0,0,1] op_sel_hi:[1,0,1] neg_lo:[1,0,0] neg_hi:[1,0,0]
    v_pk_fma_f32 v[84:85], v[248:249], v[48:49], v[38:39] op_sel:[0,0,1] op_sel_hi:[1,0,1] neg_lo:[1,0,0] neg_hi:[1,0,0]
    v_pk_fma_f32 v[86:87], v[250:251], v[48:49], v[38:39] op_sel:[0,0,1] op_sel_hi:[1,0,1] neg_lo:[1,0,0] neg_hi:[1,0,0]
    v_pk_fma_f32 v[88:89], v[252:253], v[48:49], v[38:39] op_sel:[0,0,1] op_sel_hi:[1,0,1] neg_lo:[1,0,0] neg_hi:[1,0,0]
    v_pk_fma_f32 v[90:91], v[254:255], v[48:49], v[38:39] op_sel:[0,0,1] op_sel_hi:[1,0,1] neg_lo:[1,0,0] neg_hi:[1,0,0]
    v_exp_f32 v60, v60
    v_exp_f32 v61, v61
    v_exp_f32 v62, v62
    v_exp_f32 v63, v63
    v_exp_f32 v64, v64
    v_exp_f32 v65, v65
    v_exp_f32 v66, v66
    v_exp_f32 v67, v67
    v_exp_f32 v68, v68
    v_exp_f32 v69, v69
    v_exp_f32 v70, v70
    v_exp_f32 v71, v71
    v_exp_f32 v72, v72
    v_exp_f32 v73, v73
    v_exp_f32 v74, v74
    v_exp_f32 v75, v75
    v_exp_f32 v76, v76
    v_exp_f32 v77, v77
    v_exp_f32 v78, v78
    v_exp_f32 v79, v79
    v_exp_f32 v80, v80
    v_exp_f32 v81, v81
    v_exp_f32 v82, v82
    v_exp_f32 v83, v83
    v_exp_f32 v84, v84
    v_exp_f32 v85, v85
    v_exp_f32 v86, v86
    v_exp_f32 v87, v87
    v_exp_f32 v88, v88
    v_exp_f32 v89, v89
    v_exp_f32 v90, v90
    v_exp_f32 v91, v91
    v_cvt_pk_bf16_f32 v176, v60, v61
    v_cvt_pk_bf16_f32 v177, v62, v63
    v_cvt_pk_bf16_f32 v178, v64, v65
    v_cvt_pk_bf16_f32 v179, v66, v67
    v_cvt_pk_bf16_f32 v180, v68, v69
    v_cvt_pk_bf16_f32 v181, v70, v71
    v_cvt_pk_bf16_f32 v182, v72, v73
    v_cvt_pk_bf16_f32 v183, v74, v75
    v_cvt_pk_bf16_f32 v184, v76, v77
    v_cvt_pk_bf16_f32 v185, v78, v79
    v_cvt_pk_bf16_f32 v186, v80, v81
    v_cvt_pk_bf16_f32 v187, v82, v83
    v_cvt_pk_bf16_f32 v188, v84, v85
    v_cvt_pk_bf16_f32 v189, v86, v87
    v_cvt_pk_bf16_f32 v190, v88, v89
    v_cvt_pk_bf16_f32 v191, v90, v91
    s_barrier
    s_setprio 1
    ds_read_b128 v[16:19], v10 offset:0
    ds_read_b128 v[20:23], v10 offset:32
    ds_read_b128 v[24:27], v10 offset:64
    ds_read_b128 v[28:31], v10 offset:96
    s_waitcnt lgkmcnt(3)
    v_mfma_f32_32x32x16_bf16 v[224:239], v[16:19], v[160:163], 0
    s_waitcnt lgkmcnt(2)
    v_mfma_f32_32x32x16_bf16 v[224:239], v[20:23], v[164:167], v[224:239]
    buffer_load_dwordx4 v[96:99], v11, s[36:39], s94 offen offset:0 sc1
    buffer_load_dwordx4 v[100:103], v11, s[36:39], s94 offen offset:2048 sc1
    buffer_load_dwordx4 v[104:107], v11, s[36:39], s95 offen offset:0 sc1
    buffer_load_dwordx4 v[108:111], v11, s[36:39], s95 offen offset:2048 sc1
    s_waitcnt lgkmcnt(1)
    v_mfma_f32_32x32x16_bf16 v[240:255], v[24:27], v[168:171], 0
    s_waitcnt lgkmcnt(0)
    v_mfma_f32_32x32x16_bf16 v[240:255], v[28:31], v[172:175], v[240:255]
    v_mfma_f32_32x32x16_bf16 v[192:207], v[16:19], v[176:179], 0
    v_mfma_f32_32x32x16_bf16 v[192:207], v[20:23], v[180:183], v[192:207]
    v_mfma_f32_32x32x16_bf16 v[208:223], v[24:27], v[184:187], 0
    v_mfma_f32_32x32x16_bf16 v[208:223], v[28:31], v[188:191], v[208:223]
    s_mov_b32 s85, 0
L_kvchk:
    s_waitcnt vmcnt(0)
    v_mfma_f32_32x32x16_bf16 v[60:75], v[96:99], v[160:163], 0
    v_max3_u32 v13, v96, v97, v98
    v_max3_u32 v10, v99, v100, v101
    v_max3_u32 v13, v13, v102, v103
    v_max3_u32 v10, v10, v104, v105
    v_max3_u32 v13, v13, v106, v107
    v_mfma_f32_32x32x16_bf16 v[60:75], v[100:103], v[164:167], v[60:75]
    v_max3_u32 v10, v10, v108, v109
    v_max3_u32 v13, v13, v110, v111
    v_max_u32 v13, v13, v10
    v_cmp_eq_u32_e64 vcc, -1, v13
    s_cbranch_vccnz L_kvspin
    v_mfma_f32_32x32x16_bf16 v[76:91], v[104:107], v[168:171], 0
    v_rcp_f32 v36, v225
    v_rcp_f32 v40, v193
    v_rcp_f32 v38, v241
    v_rcp_f32 v42, v209
    v_mfma_f32_32x32x16_bf16 v[76:91], v[108:111], v[172:175], v[76:91]
    v_mov_b32 v44, 0x358637bd
    v_mov_b32 v45, 0x358637bd
    v_fmac_f32 v44, v224, v36
    v_fmac_f32 v45, v192, v40
    v_fmac_f32 v44, v240, v38
    v_fmac_f32 v45, v208, v42
    v_mfma_f32_32x32x16_bf16 v[128:143], v[96:99], v[176:179], 0
    v_rcp_f32 v44, v44
    v_rcp_f32 v45, v45
    v_mul_f32 v36, v36, v44
    v_mul_f32 v40, v40, v45
    v_mfma_f32_32x32x16_bf16 v[128:143], v[100:103], v[180:183], v[128:143]
    v_mul_f32 v38, v38, v44
    v_mul_f32 v42, v42, v45
    v_mul_f32 v60, v60, v36
    v_mul_f32 v61, v61, v36
    v_mul_f32 v62, v62, v36
    v_mul_f32 v63, v63, v36
    v_mfma_f32_32x32x16_bf16 v[144:159], v[104:107], v[184:187], 0
    v_mul_f32 v64, v64, v36
    v_mul_f32 v65, v65, v36
    v_mul_f32 v66, v66, v36
    v_mul_f32 v67, v67, v36
    v_mul_f32 v68, v68, v36
    v_mul_f32 v69, v69, v36
    v_mfma_f32_32x32x16_bf16 v[144:159], v[108:111], v[188:191], v[144:159]
    v_mul_f32 v70, v70, v36
    v_mul_f32 v71, v71, v36
    v_mul_f32 v72, v72, v36
    v_mul_f32 v73, v73, v36
    v_mul_f32 v74, v74, v36
    v_mul_f32 v75, v75, v36
    v_pk_fma_f32 v[60:61], v[76:77], v[38:39], v[60:61] op_sel_hi:[1,0,1]
    v_pk_fma_f32 v[62:63], v[78:79], v[38:39], v[62:63] op_sel_hi:[1,0,1]
    v_pk_fma_f32 v[64:65], v[80:81], v[38:39], v[64:65] op_sel_hi:[1,0,1]
    v_pk_fma_f32 v[66:67], v[82:83], v[38:39], v[66:67] op_sel_hi:[1,0,1]
    v_cvt_pk_bf16_f32 v16, v60, v61
    v_cvt_pk_bf16_f32 v17, v62, v63
    v_cvt_pk_bf16_f32 v18, v64, v65
    v_cvt_pk_bf16_f32 v19, v66, v67
    buffer_store_dwordx4 v[16:19], v14, s[36:39], s96 offen offset:0 sc1
    v_pk_fma_f32 v[68:69], v[84:85], v[38:39], v[68:69] op_sel_hi:[1,0,1]
    v_pk_fma_f32 v[70:71], v[86:87], v[38:39], v[70:71] op_sel_hi:[1,0,1]
    v_pk_fma_f32 v[72:73], v[88:89], v[38:39], v[72:73] op_sel_hi:[1,0,1]
    v_pk_fma_f32 v[74:75], v[90:91], v[38:39], v[74:75] op_sel_hi:[1,0,1]
    v_cvt_pk_bf16_f32 v20, v68, v69
    v_cvt_pk_bf16_f32 v21, v70, v71
L_pad9:
    s_cbranch_execz L_padret
    s_nop 0
    v_cvt_pk_bf16_f32 v22, v72, v73
    v_cvt_pk_bf16_f32 v23, v74, v75
    buffer_store_dwordx4 v[20:23], v14, s[36:39], s96 offen offset:1024 sc1
    v_pk_mul_f32 v[128:129], v[128:129], v[40:41] op_sel_hi:[1,0]
    v_pk_mul_f32 v[130:131], v[130:131], v[40:41] op_sel_hi:[1,0]
    v_pk_mul_f32 v[132:133], v[132:133], v[40:41] op_sel_hi:[1,0]
    v_pk_mul_f32 v[134:135], v[134:135], v[40:41] op_sel_hi:[1,0]
    v_pk_fma_f32 v[128:129], v[144:145], v[42:43], v[128:129] op_sel_hi:[1,0,1]
    v_pk_fma_f32 v[130:131], v[146:147], v[42:43], v[130:131] op_sel_hi:[1,0,1]
    v_pk_fma_f32 v[132:133], v[148:149], v[42:43], v[132:133] op_sel_hi:[1,0,1]
    v_pk_fma_f32 v[134:135], v[150:151], v[42:43], v[134:135] op_sel_hi:[1,0,1]
    v_cvt_pk_bf16_f32 v24, v128, v129
    v_cvt_pk_bf16_f32 v25, v130, v131
    v_cvt_pk_bf16_f32 v26, v132, v133
    v_cvt_pk_bf16_f32 v27, v134, v135
    buffer_store_dwordx4 v[24:27], v14, s[36:39], s97 offen offset:0 sc1
    v_pk_mul_f32 v[136:137], v[136:137], v[40:41] op_sel_hi:[1,0]
    v_pk_mul_f32 v[138:139], v[138:139], v[40:41] op_sel_hi:[1,0]
    v_pk_mul_f32 v[140:141], v[140:141], v[40:41] op_sel_hi:[1,0]
    v_pk_mul_f32 v[142:143], v[142:143], v[40:41] op_sel_hi:[1,0]
    v_pk_fma_f32 v[136:137], v[152:153], v[42:43], v[136:137] op_sel_hi:[1,0,1]
    v_pk_fma_f32 v[138:139], v[154:155], v[42:43], v[138:139] op_sel_hi:[1,0,1]
    v_pk_fma_f32 v[140:141], v[156:157], v[42:43], v[140:141] op_sel_hi:[1,0,1]
    v_pk_fma_f32 v[142:143], v[158:159], v[42:43], v[142:143] op_sel_hi:[1,0,1]
    v_cvt_pk_bf16_f32 v28, v136, v137
    v_cvt_pk_bf16_f32 v29, v138, v139
    v_cvt_pk_bf16_f32 v30, v140, v141
    v_cvt_pk_bf16_f32 v31, v142, v143
    buffer_store_dwordx4 v[28:31], v14, s[36:39], s97 offen offset:1024 sc1
    v_and_b32 v8, 31, v2
    v_lshrrev_b32 v9, 5, v2
    v_lshlrev_b32 v10, 3, v9
    s_lshl_b32 s78, s72, 7
    buffer_load_dwordx2 v[32:33], v10, s[64:67], s78 offen offset:0
    buffer_load_dwordx2 v[34:35], v10, s[64:67], s78 offen offset:16
    buffer_load_dwordx2 v[36:37], v10, s[64:67], s78 offen offset:32
    buffer_load_dwordx2 v[38:39], v10, s[64:67], s78 offen offset:48
    buffer_load_dwordx2 v[40:41], v10, s[64:67], s78 offen offset:64
    buffer_load_dwordx2 v[42:43], v10, s[64:67], s78 offen offset:80
    buffer_load_dwordx2 v[44:45], v10, s[64:67], s78 offen offset:96
    buffer_load_dwordx2 v[46:47], v10, s[64:67], s78 offen offset:112
    buffer_load_dwordx4 v[48:51], v14, s[64:67], 0 offen
    buffer_load_dwordx4 v[52:55], v14, s[64:67], 0 offen offset:1024
    s_barrier
    s_lshl_b32 s78, s76, 12
    s_add_u32 s78, s78, 131072
    v_lshl_add_u32 v6, v8, 7, s78
    v_add_u32_e64 v6, v6, v10
    v_bfe_u32 v11, v8, 1, 3
    v_lshl_add_u32 v6, v11, 4, v6
    v_xor_b32 v112, 0, v6
    v_xor_b32 v113, 16, v6
    v_xor_b32 v114, 32, v6
    v_xor_b32 v115, 48, v6
    v_xor_b32_e64 v116, 64, v6
    v_xor_b32 v117, 80, v6
    v_xor_b32 v118, 96, v6
    v_xor_b32 v119, 112, v6
    v_bfe_u32 v11, v2, 2, 2
    v_lshl_add_u32 v12, v9, 2, v11
    v_lshlrev_b32 v12, 7, v12
    v_lshrrev_b32 v11, 1, v11
    v_lshl_add_u32 v12, v11, 6, v12
    v_bfe_u32 v11, v2, 4, 1
    v_lshl_add_u32 v12, v11, 5, v12
    v_and_b32_e64 v11, 3, v2
    v_lshl_add_u32 v12, v11, 3, v12
    s_lshl_b32 s82, s72, 0
    s_and_b32 s82, s82, 15
    s_lshl_b32 s78, s82, 13
    v_add_u32 v4, s78, v12
    v_xor_b32 v5, 64, v4
    s_lshl_b32 s83, s71, 2
    s_add_u32 s83, s83, s76
    s_lshl_b32 s83, s83, 16
    s_add_u32 s83, s83, 4194304
    s_lshl_b32 s82, s82, 12
    s_add_u32 s88, s82, s83
    v_lshlrev_b32_e64 v12, 4, v8
    v_lshl_add_u32 v12, v9, 14, v12
    s_lshl_b32 s94, s71, 15
    s_lshl_b32 s79, s76, 9
    s_add_u32 s94, s94, s79
    s_add_u32 s94, s94, 1572864
    s_lshl_b32 s95, s72, 11
    s_add_u32 s95, s95, s94
    s_lshl_b32 s78, s76, 5
    v_add_u32 v11, s78, v8
    v_and_b32 v13, 7, v8
    v_xor_b32 v13, v13, v9
    v_lshlrev_b32 v13, 4, v13
    v_lshl_add_u32 v13, v11, 8, v13
    v_lshlrev_b32_e64 v10, 3, v11
    v_add_u32 v10, 159744, v10
    s_lshl_b32 s78, s71, 7
    v_add_u32 v11, s78, v11
    s_waitcnt vmcnt(0)
    s_barrier
    ds_read_b64 v[96:97], v112
    ds_read_b64 v[98:99], v113
    ds_read_b64 v[100:101], v114
    ds_read_b64 v[102:103], v115
    ds_read_b64 v[104:105], v116
    ds_read_b64 v[106:107], v117
    ds_read_b64 v[108:109], v118
    ds_read_b64 v[110:111], v119
    v_lshlrev_b32_e64 v60, 16, v32
    v_and_b32 v61, 0xffff0000, v32
    v_lshlrev_b32_e64 v62, 16, v33
    v_and_b32 v63, 0xffff0000, v33
    v_lshlrev_b32_e64 v64, 16, v34
    v_and_b32 v65, 0xffff0000, v34
    v_lshlrev_b32_e64 v66, 16, v35
    v_and_b32 v67, 0xffff0000, v35
    v_lshlrev_b32_e64 v68, 16, v36
    v_and_b32 v69, 0xffff0000, v36
    v_lshlrev_b32_e64 v70, 16, v37
    v_and_b32 v71, 0xffff0000, v37
    v_lshlrev_b32_e64 v72, 16, v38
    v_and_b32 v73, 0xffff0000, v38
    v_lshlrev_b32_e64 v74, 16, v39
    v_and_b32 v75, 0xffff0000, v39
    v_lshlrev_b32_e64 v76, 16, v40
    v_and_b32 v77, 0xffff0000, v40
    v_lshlrev_b32_e64 v78, 16, v41
    v_and_b32 v79, 0xffff0000, v41
    v_lshlrev_b32_e64 v80, 16, v42
    v_and_b32 v81, 0xffff0000, v42
    v_lshlrev_b32_e64 v82, 16, v43
    v_and_b32 v83, 0xffff0000, v43
    v_lshlrev_b32_e64 v84, 16, v44
    v_and_b32 v85, 0xffff0000, v44
    v_lshlrev_b32_e64 v86, 16, v45
    v_and_b32 v87, 0xffff0000, v45
    v_lshlrev_b32_e64 v88, 16, v46
    v_and_b32 v89, 0xffff0000, v46
    v_lshlrev_b32_e64 v90, 16, v47
    v_and_b32 v91, 0xffff0000, v47
    s_mov_b32 s78, 0x3f803f80
    v_dot2_f32_bf16 v126, v48, s78, 0
    v_dot2_f32_bf16 v126, v49, s78, v126
    v_dot2_f32_bf16 v126, v50, s78, v126
    v_dot2_f32_bf16 v126, v51, s78, v126
    v_dot2_f32_bf16 v126, v52, s78, v126
    v_dot2_f32_bf16 v126, v53, s78, v126
    v_dot2_f32_bf16 v126, v54, s78, v126
    v_dot2_f32_bf16 v126, v55, s78, v126
    s_nop 2
    v_add_f32_dpp v126, v126, v126 row_ror:8 row_mask:0xf bank_mask:0xf
    s_nop 1
    v_add_f32_dpp v126, v126, v126 row_ror:4 row_mask:0xf bank_mask:0xf
    s_nop 1
    v_add_f32_dpp v126, v126, v126 row_ror:2 row_mask:0xf bank_mask:0xf
    s_nop 1
    v_add_f32_dpp v126, v126, v126 row_ror:1 row_mask:0xf bank_mask:0xf
    v_mov_b32 v127, v126
    s_nop 1
    v_permlane32_swap_b32 v126, v127
    v_add_f32 v126, v126, v127
    v_mov_b32 v127, v126
    s_nop 1
    v_permlane16_swap_b32 v126, v127
    v_add_f32 v126, v126, v127
    v_mov_b32 v44, 163328
    v_mov_b32_e64 v45, 1
    v_mov_b32 v46, 0xff800000
    v_mov_b32_e64 v47, 0
    ds_write_b64 v44, v[46:47]
    s_lshl_b32 s96, s71, 4
    s_add_u32 s96, s96, s72
    s_lshl_b32 s96, s96, 9
    s_add_u32 s96, s96, 524288
    v_mov_b32 v15, 163584
    ds_read_b32 v15, v15
    s_waitcnt lgkmcnt(0)
    v_readfirstlane_b32 s99, v15
    v_lshlrev_b32 v224, 16, v96
    v_and_b32 v225, 0xffff0000, v96
    v_lshlrev_b32_e64 v226, 16, v97
    v_and_b32 v227, 0xffff0000, v97
    v_lshlrev_b32_e64 v228, 16, v98
    v_and_b32 v229, 0xffff0000, v98
    v_lshlrev_b32_e64 v230, 16, v99
    v_and_b32 v231, 0xffff0000, v99
    v_lshlrev_b32_e64 v232, 16, v100
    v_and_b32 v233, 0xffff0000, v100
    v_lshlrev_b32_e64 v234, 16, v101
    v_and_b32 v235, 0xffff0000, v101
    v_lshlrev_b32_e64 v236, 16, v102
    v_and_b32 v237, 0xffff0000, v102
    v_lshlrev_b32_e64 v238, 16, v103
    v_and_b32 v239, 0xffff0000, v103
    v_lshlrev_b32_e64 v240, 16, v104
    v_and_b32 v241, 0xffff0000, v104
    v_lshlrev_b32_e64 v242, 16, v105
    v_and_b32 v243, 0xffff0000, v105
    v_lshlrev_b32_e64 v244, 16, v106
    v_and_b32 v245, 0xffff0000, v106
    v_lshlrev_b32_e64 v246, 16, v107
    v_and_b32 v247, 0xffff0000, v107
    v_lshlrev_b32_e64 v248, 16, v108
    v_and_b32 v249, 0xffff0000, v108
    v_lshlrev_b32_e64 v250, 16, v109
    v_and_b32 v251, 0xffff0000, v109
    v_lshlrev_b32_e64 v252, 16, v110
    v_and_b32 v253, 0xffff0000, v110
    v_lshlrev_b32_e64 v254, 16, v111
    v_and_b32 v255, 0xffff0000, v111
    s_mov_b32 s84, 0
    s_barrier
    buffer_load_dwordx4 v[160:163], v14, s[36:39], s88 offen offset:0 sc1
    ds_read_b64_tr_b16 v[128:129], v4 offset:0
    buffer_load_dwordx4 v[164:167], v14, s[36:39], s88 offen offset:1024 sc1
    ds_read_b64_tr_b16 v[130:131], v4 offset:1024
    buffer_load_dwordx4 v[168:171], v14, s[36:39], s88 offen offset:2048 sc1
    ds_read_b64_tr_b16 v[132:133], v5 offset:0
    buffer_load_dwordx4 v[172:175], v14, s[36:39], s88 offen offset:3072 sc1
    s_add_u32 s82, s82, 4096
    s_and_b32 s82, s82, 0xffff
    s_add_u32 s88, s82, s83
    s_nop 0
    ds_read_b64_tr_b16 v[134:135], v5 offset:1024
    buffer_load_dwordx4 v[176:179], v14, s[36:39], s88 offen offset:0 sc1
    ds_read_b64_tr_b16 v[136:137], v4 offset:2048
    buffer_load_dwordx4 v[180:183], v14, s[36:39], s88 offen offset:1024 sc1
    ds_read_b64_tr_b16 v[138:139], v4 offset:3072
    buffer_load_dwordx4 v[184:187], v14, s[36:39], s88 offen offset:2048 sc1
    ds_read_b64_tr_b16 v[140:141], v5 offset:2048
    buffer_load_dwordx4 v[188:191], v14, s[36:39], s88 offen offset:3072 sc1
    s_add_u32 s82, s82, 4096
    s_and_b32 s82, s82, 0xffff
    s_add_u32 s88, s82, s83
    s_nop 0
    ds_read_b64_tr_b16 v[142:143], v5 offset:3072
    buffer_load_dwordx4 v[192:195], v14, s[36:39], s88 offen offset:0 sc1
    buffer_load_dwordx4 v[196:199], v14, s[36:39], s88 offen offset:1024 sc1
    buffer_load_dwordx4 v[200:203], v14, s[36:39], s88 offen offset:2048 sc1
    buffer_load_dwordx4 v[204:207], v14, s[36:39], s88 offen offset:3072 sc1
    s_add_u32 s82, s82, 4096
    s_and_b32 s82, s82, 0xffff
    s_add_u32 s88, s82, s83
    buffer_load_dwordx4 v[208:211], v14, s[36:39], s88 offen offset:0 sc1
    buffer_load_dwordx4 v[212:215], v14, s[36:39], s88 offen offset:1024 sc1
    .p2align 3
L_G2:
    s_add_u32 s84, s84, 1
    s_waitcnt vmcnt(12) lgkmcnt(6)
    v_mfma_f32_32x32x16_bf16 v[224:239], v[128:131], v[160:163], v[224:239]
    ds_read_b64_tr_b16 v[144:145], v4 offset:4096
    ds_read_b64_tr_b16 v[146:147], v4 offset:5120
    buffer_load_dwordx4 v[216:219], v14, s[36:39], s88 offen offset:2048 sc1
    s_waitcnt lgkmcnt(6)
    v_mfma_f32_32x32x16_bf16 v[240:255], v[132:135], v[160:163], v[240:255]
    ds_read_b64_tr_b16 v[148:149], v5 offset:4096
    ds_read_b64_tr_b16 v[150:151], v5 offset:5120
    s_waitcnt lgkmcnt(6)
    v_mfma_f32_32x32x16_bf16 v[224:239], v[136:139], v[164:167], v[224:239]
    ds_read_b64_tr_b16 v[152:153], v4 offset:6144
    ds_read_b64_tr_b16 v[154:155], v4 offset:7168
    buffer_load_dwordx4 v[220:223], v14, s[36:39], s88 offen offset:3072 sc1
    s_add_u32 s82, s82, 4096
    s_and_b32 s82, s82, 0xffff
    s_add_u32 s88, s82, s83
    s_waitcnt lgkmcnt(6)
    v_mfma_f32_32x32x16_bf16 v[240:255], v[140:143], v[164:167], v[240:255]
    ds_read_b64_tr_b16 v[156:157], v5 offset:6144
    ds_read_b64_tr_b16 v[158:159], v5 offset:7168
    v_add_u32 v4, 0x2000, v4
    v_and_b32 v4, 0x1ffff, v4
    v_xor_b32 v5, 64, v4
    s_waitcnt vmcnt(12) lgkmcnt(6)
    v_mfma_f32_32x32x16_bf16 v[224:239], v[144:147], v[168:171], v[224:239]
    ds_read_b64_tr_b16 v[128:129], v4 offset:0
    ds_read_b64_tr_b16 v[130:131], v4 offset:1024
    buffer_load_dwordx4 v[160:163], v14, s[36:39], s88 offen offset:0 sc1
    s_waitcnt lgkmcnt(6)
    v_mfma_f32_32x32x16_bf16 v[240:255], v[148:151], v[168:171], v[240:255]
    ds_read_b64_tr_b16 v[132:133], v5 offset:0
    ds_read_b64_tr_b16 v[134:135], v5 offset:1024
    s_waitcnt lgkmcnt(6)
    v_mfma_f32_32x32x16_bf16 v[224:239], v[152:155], v[172:175], v[224:239]
    ds_read_b64_tr_b16 v[136:137], v4 offset:2048
    ds_read_b64_tr_b16 v[138:139], v4 offset:3072
    buffer_load_dwordx4 v[164:167], v14, s[36:39], s88 offen offset:1024 sc1
    s_waitcnt lgkmcnt(6)
    v_mfma_f32_32x32x16_bf16 v[240:255], v[156:159], v[172:175], v[240:255]
    ds_read_b64_tr_b16 v[140:141], v5 offset:2048
    ds_read_b64_tr_b16 v[142:143], v5 offset:3072
    s_waitcnt vmcnt(12) lgkmcnt(6)
    v_mfma_f32_32x32x16_bf16 v[224:239], v[128:131], v[176:179], v[224:239]
    ds_read_b64_tr_b16 v[144:145], v4 offset:4096
    ds_read_b64_tr_b16 v[146:147], v4 offset:5120
    buffer_load_dwordx4 v[168:171], v14, s[36:39], s88 offen offset:2048 sc1
L_pad10:
    s_cbranch_execz L_padret
    s_waitcnt lgkmcnt(6)
    v_mfma_f32_32x32x16_bf16 v[240:255], v[132:135], v[176:179], v[240:255]
    ds_read_b64_tr_b16 v[148:149], v5 offset:4096
    ds_read_b64_tr_b16 v[150:151], v5 offset:5120
    s_waitcnt lgkmcnt(6)
    s_nop 0
    v_mfma_f32_32x32x16_bf16 v[224:239], v[136:139], v[180:183], v[224:239]
    ds_read_b64_tr_b16 v[152:153], v4 offset:6144
    ds_read_b64_tr_b16 v[154:155], v4 offset:7168
    buffer_load_dwordx4 v[172:175], v14, s[36:39], s88 offen offset:3072 sc1
    s_add_u32 s82, s82, 4096
    s_and_b32 s82, s82, 0xffff
    s_add_u32 s88, s82, s83
    s_waitcnt lgkmcnt(6)
    v_mfma_f32_32x32x16_bf16 v[240:255], v[140:143], v[180:183], v[240:255]
    ds_read_b64_tr_b16 v[156:157], v5 offset:6144
    ds_read_b64_tr_b16 v[158:159], v5 offset:7168
    v_add_u32 v4, 0x2000, v4
    v_and_b32 v4, 0x1ffff, v4
    v_xor_b32 v5, 64, v4
    s_waitcnt vmcnt(12) lgkmcnt(6)
    v_mfma_f32_32x32x16_bf16 v[224:239], v[144:147], v[184:187], v[224:239]
    ds_read_b64_tr_b16 v[128:129], v4 offset:0
    ds_read_b64_tr_b16 v[130:131], v4 offset:1024
    buffer_load_dwordx4 v[176:179], v14, s[36:39], s88 offen offset:0 sc1
    s_waitcnt lgkmcnt(6)
    v_mfma_f32_32x32x16_bf16 v[240:255], v[148:151], v[184:187], v[240:255]
    ds_read_b64_tr_b16 v[132:133], v5 offset:0
    ds_read_b64_tr_b16 v[134:135], v5 offset:1024
    s_waitcnt lgkmcnt(6)
    v_mfma_f32_32x32x16_bf16 v[224:239], v[152:155], v[188:191], v[224:239]
    ds_read_b64_tr_b16 v[136:137], v4 offset:2048
    ds_read_b64_tr_b16 v[138:139], v4 offset:3072
    buffer_load_dwordx4 v[180:183], v14, s[36:39], s88 offen offset:1024 sc1
    s_waitcnt lgkmcnt(6)
    v_mfma_f32_32x32x16_bf16 v[240:255], v[156:159], v[188:191], v[240:255]
    ds_read_b64_tr_b16 v[140:141], v5 offset:2048
    ds_read_b64_tr_b16 v[142:143], v5 offset:3072
    s_waitcnt vmcnt(12) lgkmcnt(6)
    v_mfma_f32_32x32x16_bf16 v[224:239], v[128:131], v[192:195], v[224:239]
    ds_read_b64_tr_b16 v[144:145], v4 offset:4096
    ds_read_b64_tr_b16 v[146:147], v4 offset:5120
    buffer_load_dwordx4 v[184:187], v14, s[36:39], s88 offen offset:2048 sc1
    s_waitcnt lgkmcnt(6)
    v_mfma_f32_32x32x16_bf16 v[240:255], v[132:135], v[192:195], v[240:255]
    ds_read_b64_tr_b16 v[148:149], v5 offset:4096
    ds_read_b64_tr_b16 v[150:151], v5 offset:5120
    s_waitcnt lgkmcnt(6)
    v_mfma_f32_32x32x16_bf16 v[224:239], v[136:139], v[196:199], v[224:239]
    ds_read_b64_tr_b16 v[152:153], v4 offset:6144
    ds_read_b64_tr_b16 v[154:155], v4 offset:7168
    buffer_load_dwordx4 v[188:191], v14, s[36:39], s88 offen offset:3072 sc1
    s_add_u32 s82, s82, 4096
    s_and_b32 s82, s82, 0xffff
    s_add_u32 s88, s82, s83
    s_waitcnt lgkmcnt(6)
    v_mfma_f32_32x32x16_bf16 v[240:255], v[140:143], v[196:199], v[240:255]
    ds_read_b64_tr_b16 v[156:157], v5 offset:6144
    ds_read_b64_tr_b16 v[158:159], v5 offset:7168
    v_add_u32 v4, 0x2000, v4
    v_and_b32 v4, 0x1ffff, v4
    v_xor_b32 v5, 64, v4
    s_waitcnt vmcnt(12) lgkmcnt(6)
    v_mfma_f32_32x32x16_bf16 v[224:239], v[144:147], v[200:203], v[224:239]
    ds_read_b64_tr_b16 v[128:129], v4 offset:0
    ds_read_b64_tr_b16 v[130:131], v4 offset:1024
    buffer_load_dwordx4 v[192:195], v14, s[36:39], s88 offen offset:0 sc1
    s_waitcnt lgkmcnt(6)
    v_mfma_f32_32x32x16_bf16 v[240:255], v[148:151], v[200:203], v[240:255]
    ds_read_b64_tr_b16 v[132:133], v5 offset:0
    ds_read_b64_tr_b16 v[134:135], v5 offset:1024
    s_waitcnt lgkmcnt(6)
    v_mfma_f32_32x32x16_bf16 v[224:239], v[152:155], v[204:207], v[224:239]
    ds_read_b64_tr_b16 v[136:137], v4 offset:2048
    ds_read_b64_tr_b16 v[138:139], v4 offset:3072
    buffer_load_dwordx4 v[196:199], v14, s[36:39], s88 offen offset:1024 sc1
    s_waitcnt lgkmcnt(6)
    v_mfma_f32_32x32x16_bf16 v[240:255], v[156:159], v[204:207], v[240:255]
    ds_read_b64_tr_b16 v[140:141], v5 offset:2048
    ds_read_b64_tr_b16 v[142:143], v5 offset:3072
    s_waitcnt vmcnt(12) lgkmcnt(6)
    v_mfma_f32_32x32x16_bf16 v[224:239], v[128:131], v[208:211], v[224:239]
    ds_read_b64_tr_b16 v[144:145], v4 offset:4096
    ds_read_b64_tr_b16 v[146:147], v4 offset:5120
    buffer_load_dwordx4 v[200:203], v14, s[36:39], s88 offen offset:2048 sc1
    s_waitcnt lgkmcnt(6)
    v_mfma_f32_32x32x16_bf16 v[240:255], v[132:135], v[208:211], v[240:255]
    ds_read_b64_tr_b16 v[148:149], v5 offset:4096
    ds_read_b64_tr_b16 v[150:151], v5 offset:5120
    s_waitcnt lgkmcnt(6)
    v_mfma_f32_32x32x16_bf16 v[224:239], v[136:139], v[212:215], v[224:239]
    ds_read_b64_tr_b16 v[152:153], v4 offset:6144
    ds_read_b64_tr_b16 v[154:155], v4 offset:7168
    buffer_load_dwordx4 v[204:207], v14, s[36:39], s88 offen offset:3072 sc1
    s_add_u32 s82, s82, 4096
    s_and_b32 s82, s82, 0xffff
    s_add_u32 s88, s82, s83
    s_waitcnt lgkmcnt(6)
    v_mfma_f32_32x32x16_bf16 v[240:255], v[140:143], v[212:215], v[240:255]
    ds_read_b64_tr_b16 v[156:157], v5 offset:6144
    ds_read_b64_tr_b16 v[158:159], v5 offset:7168
    v_add_u32 v4, 0x2000, v4
    v_and_b32 v4, 0x1ffff, v4
    v_xor_b32 v5, 64, v4
    s_waitcnt vmcnt(12) lgkmcnt(6)
    v_mfma_f32_32x32x16_bf16 v[224:239], v[144:147], v[216:219], v[224:239]
    ds_read_b64_tr_b16 v[128:129], v4 offset:0
    ds_read_b64_tr_b16 v[130:131], v4 offset:1024
    buffer_load_dwordx4 v[208:211], v14, s[36:39], s88 offen offset:0 sc1
    s_waitcnt lgkmcnt(6)
    v_mfma_f32_32x32x16_bf16 v[240:255], v[148:151], v[216:219], v[240:255]
    ds_read_b64_tr_b16 v[132:133], v5 offset:0
    ds_read_b64_tr_b16 v[134:135], v5 offset:1024
    s_waitcnt lgkmcnt(6)
    v_mfma_f32_32x32x16_bf16 v[224:239], v[152:155], v[220:223], v[224:239]
    ds_read_b64_tr_b16 v[136:137], v4 offset:2048
    ds_read_b64_tr_b16 v[138:139], v4 offset:3072
    buffer_load_dwordx4 v[212:215], v14, s[36:39], s88 offen offset:1024 sc1
    s_waitcnt lgkmcnt(6)
    v_mfma_f32_32x32x16_bf16 v[240:255], v[156:159], v[220:223], v[240:255]
    ds_read_b64_tr_b16 v[140:141], v5 offset:2048
    ds_read_b64_tr_b16 v[142:143], v5 offset:3072
    s_cmp_lt_u32 s84, 3
    s_cbranch_scc1 L_G2
    s_waitcnt vmcnt(12) lgkmcnt(6)
    v_mfma_f32_32x32x16_bf16 v[224:239], v[128:131], v[160:163], v[224:239]
    ds_read_b64_tr_b16 v[144:145], v4 offset:4096
    ds_read_b64_tr_b16 v[146:147], v4 offset:5120
    buffer_load_dwordx4 v[216:219], v14, s[36:39], s88 offen offset:2048 sc1
    s_waitcnt lgkmcnt(6)
    v_mfma_f32_32x32x16_bf16 v[240:255], v[132:135], v[160:163], v[240:255]
    ds_read_b64_tr_b16 v[148:149], v5 offset:4096
    ds_read_b64_tr_b16 v[150:151], v5 offset:5120
    s_waitcnt lgkmcnt(6)
    v_mfma_f32_32x32x16_bf16 v[224:239], v[136:139], v[164:167], v[224:239]
    ds_read_b64_tr_b16 v[152:153], v4 offset:6144
    ds_read_b64_tr_b16 v[154:155], v4 offset:7168
    buffer_load_dwordx4 v[220:223], v14, s[36:39], s88 offen offset:3072 sc1
    s_add_u32 s82, s82, 4096
    s_and_b32 s82, s82, 0xffff
    s_add_u32 s88, s82, s83
    s_waitcnt lgkmcnt(6)
    v_mfma_f32_32x32x16_bf16 v[240:255], v[140:143], v[164:167], v[240:255]
    ds_read_b64_tr_b16 v[156:157], v5 offset:6144
    ds_read_b64_tr_b16 v[158:159], v5 offset:7168
    s_barrier
    v_add_u32 v4, 0x2000, v4
    v_and_b32 v4, 0x1ffff, v4
    v_xor_b32_e64 v5, 64, v4
    s_waitcnt vmcnt(12) lgkmcnt(6)
    v_mfma_f32_32x32x16_bf16 v[224:239], v[144:147], v[168:171], v[224:239]
    ds_read_b64_tr_b16 v[128:129], v4 offset:0
    ds_read_b64_tr_b16 v[130:131], v4 offset:1024
    s_waitcnt lgkmcnt(6)
    v_mfma_f32_32x32x16_bf16 v[240:255], v[148:151], v[168:171], v[240:255]
    ds_read_b64_tr_b16 v[132:133], v5 offset:0
    ds_read_b64_tr_b16 v[134:135], v5 offset:1024
    s_waitcnt lgkmcnt(6)
    v_mfma_f32_32x32x16_bf16 v[224:239], v[152:155], v[172:175], v[224:239]
    ds_read_b64_tr_b16 v[136:137], v4 offset:2048
    ds_read_b64_tr_b16 v[138:139], v4 offset:3072
    s_waitcnt lgkmcnt(6)
    v_mfma_f32_32x32x16_bf16 v[240:255], v[156:159], v[172:175], v[240:255]
    ds_read_b64_tr_b16 v[140:141], v5 offset:2048
    ds_read_b64_tr_b16 v[142:143], v5 offset:3072
    s_waitcnt vmcnt(10) lgkmcnt(6)
    v_mfma_f32_32x32x16_bf16 v[224:239], v[128:131], v[176:179], v[224:239]
    ds_read_b64_tr_b16 v[144:145], v4 offset:4096
    ds_read_b64_tr_b16 v[146:147], v4 offset:5120
    s_waitcnt lgkmcnt(6)
    v_mfma_f32_32x32x16_bf16 v[240:255], v[132:135], v[176:179], v[240:255]
    ds_read_b64_tr_b16 v[148:149], v5 offset:4096
    ds_read_b64_tr_b16 v[150:151], v5 offset:5120
    s_waitcnt lgkmcnt(6)
    v_mfma_f32_32x32x16_bf16 v[224:239], v[136:139], v[180:183], v[224:239]
    ds_read_b64_tr_b16 v[152:153], v4 offset:6144
    ds_read_b64_tr_b16 v[154:155], v4 offset:7168
    s_waitcnt lgkmcnt(6)
    v_mfma_f32_32x32x16_bf16 v[240:255], v[140:143], v[180:183], v[240:255]
    ds_read_b64_tr_b16 v[156:157], v5 offset:6144
    ds_read_b64_tr_b16 v[158:159], v5 offset:7168
    v_add_u32 v4, 0x2000, v4
    v_and_b32 v4, 0x1ffff, v4
    v_xor_b32_e64 v5, 64, v4
    s_waitcnt vmcnt(8) lgkmcnt(6)
    v_mfma_f32_32x32x16_bf16 v[224:239], v[144:147], v[184:187], v[224:239]
    ds_read_b64_tr_b16 v[128:129], v4 offset:0
    ds_read_b64_tr_b16 v[130:131], v4 offset:1024
    s_waitcnt lgkmcnt(6)
    v_mfma_f32_32x32x16_bf16 v[240:255], v[148:151], v[184:187], v[240:255]
    ds_read_b64_tr_b16 v[132:133], v5 offset:0
    ds_read_b64_tr_b16 v[134:135], v5 offset:1024
    s_waitcnt lgkmcnt(6)
    v_mfma_f32_32x32x16_bf16 v[224:239], v[152:155], v[188:191], v[224:239]
    ds_read_b64_tr_b16 v[136:137], v4 offset:2048
    ds_read_b64_tr_b16 v[138:139], v4 offset:3072
    s_waitcnt lgkmcnt(6)
    v_mfma_f32_32x32x16_bf16 v[240:255], v[156:159], v[188:191], v[240:255]
    ds_read_b64_tr_b16 v[140:141], v5 offset:2048
    ds_read_b64_tr_b16 v[142:143], v5 offset:3072
    s_waitcnt vmcnt(6) lgkmcnt(6)
    v_mfma_f32_32x32x16_bf16 v[224:239], v[128:131], v[192:195], v[224:239]
    ds_read_b64_tr_b16 v[144:145], v4 offset:4096
    ds_read_b64_tr_b16 v[146:147], v4 offset:5120
    s_waitcnt lgkmcnt(6)
    v_mfma_f32_32x32x16_bf16 v[240:255], v[132:135], v[192:195], v[240:255]
    ds_read_b64_tr_b16 v[148:149], v5 offset:4096
    ds_read_b64_tr_b16 v[150:151], v5 offset:5120
    s_waitcnt lgkmcnt(6)
    v_mfma_f32_32x32x16_bf16 v[224:239], v[136:139], v[196:199], v[224:239]
    ds_read_b64_tr_b16 v[152:153], v4 offset:6144
    ds_read_b64_tr_b16 v[154:155], v4 offset:7168
    s_waitcnt lgkmcnt(6)
    v_mfma_f32_32x32x16_bf16 v[240:255], v[140:143], v[196:199], v[240:255]
    ds_read_b64_tr_b16 v[156:157], v5 offset:6144
    ds_read_b64_tr_b16 v[158:159], v5 offset:7168
    v_add_u32 v4, 0x2000, v4
    v_and_b32 v4, 0x1ffff, v4
    v_xor_b32_e64 v5, 64, v4
    s_waitcnt vmcnt(4) lgkmcnt(6)
    v_mfma_f32_32x32x16_bf16 v[224:239], v[144:147], v[200:203], v[224:239]
    ds_read_b64_tr_b16 v[128:129], v4 offset:0
    ds_read_b64_tr_b16 v[130:131], v4 offset:1024
    s_waitcnt lgkmcnt(6)
    v_mfma_f32_32x32x16_bf16 v[240:255], v[148:151], v[200:203], v[240:255]
    ds_read_b64_tr_b16 v[132:133], v5 offset:0
    ds_read_b64_tr_b16 v[134:135], v5 offset:1024
    s_waitcnt lgkmcnt(6)
    v_mfma_f32_32x32x16_bf16 v[224:239], v[152:155], v[204:207], v[224:239]
    ds_read_b64_tr_b16 v[136:137], v4 offset:2048
    ds_read_b64_tr_b16 v[138:139], v4 offset:3072
    s_waitcnt lgkmcnt(6)
    v_mfma_f32_32x32x16_bf16 v[240:255], v[156:159], v[204:207], v[240:255]
    ds_read_b64_tr_b16 v[140:141], v5 offset:2048
    ds_read_b64_tr_b16 v[142:143], v5 offset:3072
    s_waitcnt vmcnt(2) lgkmcnt(6)
    v_mfma_f32_32x32x16_bf16 v[224:239], v[128:131], v[208:211], v[224:239]
    ds_read_b64_tr_b16 v[144:145], v4 offset:4096
    ds_read_b64_tr_b16 v[146:147], v4 offset:5120
    s_waitcnt lgkmcnt(6)
    v_mfma_f32_32x32x16_bf16 v[240:255], v[132:135], v[208:211], v[240:255]
    ds_read_b64_tr_b16 v[148:149], v5 offset:4096
    ds_read_b64_tr_b16 v[150:151], v5 offset:5120
    s_waitcnt lgkmcnt(6)
    v_mfma_f32_32x32x16_bf16 v[224:239], v[136:139], v[212:215], v[224:239]
    ds_read_b64_tr_b16 v[152:153], v4 offset:6144
    ds_read_b64_tr_b16 v[154:155], v4 offset:7168
    s_waitcnt lgkmcnt(6)
    v_mfma_f32_32x32x16_bf16 v[240:255], v[140:143], v[212:215], v[240:255]
    ds_read_b64_tr_b16 v[156:157], v5 offset:6144
    ds_read_b64_tr_b16 v[158:159], v5 offset:7168
    s_waitcnt vmcnt(0) lgkmcnt(6)
    v_mfma_f32_32x32x16_bf16 v[224:239], v[144:147], v[216:219], v[224:239]
    s_waitcnt lgkmcnt(4)
    v_mfma_f32_32x32x16_bf16 v[240:255], v[148:151], v[216:219], v[240:255]
    s_waitcnt lgkmcnt(2)
    v_mfma_f32_32x32x16_bf16 v[224:239], v[152:155], v[220:223], v[224:239]
    s_waitcnt lgkmcnt(0)
    v_mfma_f32_32x32x16_bf16 v[240:255], v[156:159], v[220:223], v[240:255]
    s_nop 9
    v_pk_mul_f32 v[18:19], v[224:225], v[224:225]
    v_pk_mul_f32 v[20:21], v[224:225], v[60:61]
    v_pk_add_f32 v[16:17], v[224:225], v[226:227]
    v_pk_fma_f32 v[18:19], v[226:227], v[226:227], v[18:19]
    v_pk_fma_f32 v[20:21], v[226:227], v[62:63], v[20:21]
    v_pk_add_f32 v[16:17], v[16:17], v[228:229]
    v_pk_fma_f32 v[18:19], v[228:229], v[228:229], v[18:19]
    v_pk_fma_f32 v[20:21], v[228:229], v[64:65], v[20:21]
    v_pk_add_f32 v[16:17], v[16:17], v[230:231]
    v_pk_fma_f32 v[18:19], v[230:231], v[230:231], v[18:19]
    v_pk_fma_f32 v[20:21], v[230:231], v[66:67], v[20:21]
    v_pk_add_f32 v[16:17], v[16:17], v[232:233]
    v_pk_fma_f32 v[18:19], v[232:233], v[232:233], v[18:19]
    v_pk_fma_f32 v[20:21], v[232:233], v[68:69], v[20:21]
    v_pk_add_f32 v[16:17], v[16:17], v[234:235]
    v_pk_fma_f32 v[18:19], v[234:235], v[234:235], v[18:19]
    v_pk_fma_f32 v[20:21], v[234:235], v[70:71], v[20:21]
    v_pk_add_f32 v[16:17], v[16:17], v[236:237]
    v_pk_fma_f32 v[18:19], v[236:237], v[236:237], v[18:19]
    v_pk_fma_f32 v[20:21], v[236:237], v[72:73], v[20:21]
    v_pk_add_f32 v[16:17], v[16:17], v[238:239]
    v_pk_fma_f32 v[18:19], v[238:239], v[238:239], v[18:19]
    v_pk_fma_f32 v[20:21], v[238:239], v[74:75], v[20:21]
    v_pk_add_f32 v[16:17], v[16:17], v[240:241]
    v_pk_fma_f32 v[18:19], v[240:241], v[240:241], v[18:19]
    v_pk_fma_f32 v[20:21], v[240:241], v[76:77], v[20:21]
    v_pk_add_f32 v[16:17], v[16:17], v[242:243]
    v_pk_fma_f32 v[18:19], v[242:243], v[242:243], v[18:19]
    v_pk_fma_f32 v[20:21], v[242:243], v[78:79], v[20:21]
L_pad11:
    s_cbranch_execz L_padret
    s_nop 0
    v_pk_add_f32 v[16:17], v[16:17], v[244:245]
    v_pk_fma_f32 v[18:19], v[244:245], v[244:245], v[18:19]
    v_pk_fma_f32 v[20:21], v[244:245], v[80:81], v[20:21]
    v_pk_add_f32 v[16:17], v[16:17], v[246:247]
    v_pk_fma_f32 v[18:19], v[246:247], v[246:247], v[18:19]
    v_pk_fma_f32 v[20:21], v[246:247], v[82:83], v[20:21]
    v_pk_add_f32 v[16:17], v[16:17], v[248:249]
    v_pk_fma_f32 v[18:19], v[248:249], v[248:249], v[18:19]
    v_pk_fma_f32 v[20:21], v[248:249], v[84:85], v[20:21]
    v_pk_add_f32 v[16:17], v[16:17], v[250:251]
    v_pk_fma_f32 v[18:19], v[250:251], v[250:251], v[18:19]
    v_pk_fma_f32 v[20:21], v[250:251], v[86:87], v[20:21]
    v_pk_add_f32 v[16:17], v[16:17], v[252:253]
    v_pk_fma_f32 v[18:19], v[252:253], v[252:253], v[18:19]
    v_pk_fma_f32 v[20:21], v[252:253], v[88:89], v[20:21]
    v_pk_add_f32 v[16:17], v[16:17], v[254:255]
    v_pk_fma_f32 v[18:19], v[254:255], v[254:255], v[18:19]
    v_pk_fma_f32 v[20:21], v[254:255], v[90:91], v[20:21]
    v_mov_b32 v27, s75
    v_add_f32 v24, v16, v17
    v_add_f32 v25, v18, v19
    v_add_f32 v26, v20, v21
    v_mov_b32 v28, v24
    v_mov_b32 v29, v25
    v_mov_b32 v30, v26
    v_permlane32_swap_b32 v24, v28
    v_permlane32_swap_b32 v25, v29
    v_permlane32_swap_b32 v26, v30
    v_pk_add_f32 v[24:25], v[24:25], v[28:29]
    v_add_f32 v26, v26, v30
    s_mov_b32 exec_hi, 0
    s_bitcmp1_b32 s99, 0
    s_cbranch_scc0 Lls_45
    buffer_store_dwordx4 v[24:27], v14, s[36:39], s95 offen
Lle_46:
    s_mov_b32 exec_hi, -1
    s_add_u32 s79, s94, 4096
    s_add_u32 s80, s94, 8192
    s_add_u32 s81, s94, 12288
    s_barrier
    v_xor_b32_e64 v112, 0, v13
    ds_write_b128 v112, v[224:227]
    v_xor_b32_e64 v113, 32, v13
    ds_write_b128 v113, v[228:231]
    v_xor_b32_e64 v114, 64, v13
    ds_write_b128 v114, v[232:235]
    v_xor_b32 v115, 96, v13
    ds_write_b128 v115, v[236:239]
    v_xor_b32 v116, 128, v13
    ds_write_b128 v116, v[240:243]
    v_xor_b32 v117, 160, v13
    ds_write_b128 v117, v[244:247]
    buffer_load_dwordx4 v[64:67], v12, s[36:39], s94 offen offset:0 sc1
    buffer_load_dwordx4 v[68:71], v12, s[36:39], s94 offen offset:2048 sc1
    buffer_load_dwordx4 v[72:75], v12, s[36:39], s79 offen offset:0 sc1
    buffer_load_dwordx4 v[76:79], v12, s[36:39], s79 offen offset:2048 sc1
    buffer_load_dwordx4 v[80:83], v12, s[36:39], s80 offen offset:0 sc1
    buffer_load_dwordx4 v[84:87], v12, s[36:39], s80 offen offset:2048 sc1
    buffer_load_dwordx4 v[88:91], v12, s[36:39], s81 offen offset:0 sc1
    buffer_load_dwordx4 v[92:95], v12, s[36:39], s81 offen offset:2048 sc1
    v_xor_b32 v118, 192, v13
    ds_write_b128 v118, v[248:251]
    v_xor_b32 v119, 224, v13
    ds_write_b128 v119, v[252:255]
    s_mov_b32 s85, 1
L_gchk:
    s_waitcnt vmcnt(0)
    v_max3_u32 v16, v67, v71, v75
    v_max3_u32 v16, v16, v79, v83
    v_max3_u32 v16, v16, v87, v91
    v_max3_u32 v16, v16, v95, s75
    v_min3_u32 v17, v67, v71, v75
    v_min3_u32 v17, v17, v79, v83
    v_min3_u32 v17, v17, v87, v91
    v_min3_u32 v17, v17, v95, s75
    v_cmp_ne_u32_e64 vcc, v16, v17
    s_cbranch_vccnz Lspin_47
    s_barrier
    v_pk_add_f32 v[64:65], v[64:65], v[68:69]
    v_add_f32_e64 v66, v66, v70
    v_pk_add_f32 v[72:73], v[72:73], v[76:77]
    v_add_f32_e64 v74, v74, v78
    v_pk_add_f32 v[80:81], v[80:81], v[84:85]
    v_add_f32_e64 v82, v82, v86
    v_pk_add_f32 v[88:89], v[88:89], v[92:93]
    v_add_f32_e64 v90, v90, v94
    v_pk_add_f32 v[64:65], v[64:65], v[72:73]
    v_add_f32_e64 v66, v66, v74
    v_pk_add_f32 v[80:81], v[80:81], v[88:89]
    v_add_f32 v82, v82, v90
    v_add_f32 v24, v64, v80
    v_add_f32 v25, v65, v81
    v_add_f32 v26, v66, v82
    v_mov_b32 v28, v24
    v_mov_b32 v29, v25
    v_mov_b32 v30, v26
    v_permlane32_swap_b32 v24, v28
    v_permlane32_swap_b32 v25, v29
    v_permlane32_swap_b32 v26, v30
    v_pk_add_f32 v[24:25], v[24:25], v[28:29]
    v_add_f32_e64 v26, v26, v30
    v_mul_f32 v36, 0x3a800000, v24
    v_mul_f32 v40, 0x3a800000, v25
    v_fma_f32 v40, -v36, v36, v40
    v_max_f32_e64 v40, 0, v40
    v_cvt_pk_bf16_f32 v36, v36, v36
    v_and_b32 v36, 0xffff0000, v36
    v_cvt_pk_bf16_f32 v40, v40, v40
    v_and_b32 v40, 0xffff0000, v40
    v_add_f32 v40, 0x3727c5ac, v40
    v_cvt_pk_bf16_f32 v40, v40, v40
    v_and_b32 v40, 0xffff0000, v40
    v_sqrt_f32 v40, v40
    s_nop 0
    v_cvt_pk_bf16_f32 v40, v40, v40
    v_and_b32 v40, 0xffff0000, v40
    v_rcp_f32_e64 v38, v40
    v_fma_f32 v42, -v36, v126, v26
    s_mov_b32 s79, 0xfffff800
    v_mul_f32_e64 v42, v42, v38
    v_mul_f32 v39, -v36, v38
    v_and_or_b32 v42, v42, s79, v11
    s_mov_b32 exec_hi, 0
    ds_write_b64 v10, v[38:39]
    ds_max_f32 v44, v42
    s_mov_b32 exec_lo, 1
    ds_add_rtn_u32 v46, v44, v45 offset:4
    s_mov_b32 exec_lo, -1
    ds_read_b32 v20, v44
    v_lshlrev_b32 v17, 3, v2
    v_lshlrev_b32 v18, 2, v2
    v_mov_b32_e64 v21, s75
    s_mov_b32 s79, s96
    s_waitcnt lgkmcnt(0)
    v_readfirstlane_b32 s78, v46
    s_cmp_lg_u32 s78, 3
    s_cbranch_scc1 L_nocand
    s_mov_b32 exec_lo, 0xffff
    buffer_store_dwordx2 v[20:21], v17, s[36:39], s79 offen offset:128 sc1
    s_mov_b32 exec_lo, -1
    v_and_b32 v22, 127, v20
    v_and_b32 v23, 7, v20
    v_lshlrev_b32 v23, 4, v23
    v_xor_b32 v23, v23, v17
    v_lshl_add_u32 v23, v22, 8, v23
    v_lshlrev_b32_e64 v22, 3, v22
    ds_read_b64 v[24:25], v23
    v_add_u32 v22, 159744, v22
    ds_read_b64 v[26:27], v22
    s_waitcnt lgkmcnt(0)
    v_fma_f32 v28, v24, v26, v27
    v_fma_f32 v29, v25, v26, v27
    v_cvt_pk_bf16_f32 v30, v28, v29
    buffer_store_dword v30, v18, s[36:39], s79 offen sc1
    v_add_f32 v28, v28, v24
    v_add_f32_e64 v29, v29, v25
    buffer_store_dwordx2 v[28:29], v17, s[36:39], s79 offen offset:256 sc1
L_nocand:
    s_mov_b32 exec_hi, -1
    v_lshrrev_b32 v16, 3, v2
    v_and_b32 v17, 7, v2
    s_lshl_b32 s78, s76, 5
    v_add_u32 v18, s78, v16
    v_lshlrev_b32 v19, 1, v17
    v_xor_b32 v19, v19, v16
    v_lshlrev_b32 v19, 4, v19
    v_lshl_add_u32 v19, v18, 8, v19
    v_xor_b32 v32, 16, v19
    v_lshlrev_b32 v33, 3, v18
    v_add_u32 v33, 159744, v33
    ds_read_b128 v[64:67], v19 offset:0
    ds_read_b128 v[68:71], v32 offset:0
    ds_read_b64 v[96:97], v33 offset:0
    ds_read_b128 v[72:75], v19 offset:2048
    ds_read_b128 v[76:79], v32 offset:2048
    ds_read_b64 v[98:99], v33 offset:64
    ds_read_b128 v[80:83], v19 offset:4096
    ds_read_b128 v[84:87], v32 offset:4096
    ds_read_b64 v[100:101], v33 offset:128
    ds_read_b128 v[88:91], v19 offset:6144
    ds_read_b128 v[92:95], v32 offset:6144
    ds_read_b64 v[102:103], v33 offset:192
    s_lshl_b32 s78, s71, 7
    v_add_u32_e64 v18, s78, v18
    s_lshl_b32 s79, s72, 7
    v_lshl_add_u32 v19, v18, 11, s79
    v_lshl_add_u32 v19, v17, 4, v19
    v_mov_b32 v16, 163360
    s_waitcnt lgkmcnt(0)
    v_add_f32 v96, 1.0, v96
    v_pk_fma_f32 v[64:65], v[64:65], v[96:97], v[96:97] op_sel:[0,0,1] op_sel_hi:[1,0,1]
    v_pk_fma_f32 v[66:67], v[66:67], v[96:97], v[96:97] op_sel:[0,0,1] op_sel_hi:[1,0,1]
    v_pk_fma_f32 v[68:69], v[68:69], v[96:97], v[96:97] op_sel:[0,0,1] op_sel_hi:[1,0,1]
    v_pk_fma_f32 v[70:71], v[70:71], v[96:97], v[96:97] op_sel:[0,0,1] op_sel_hi:[1,0,1]
    v_cvt_pk_bf16_f32 v104, v64, v65
    v_cvt_pk_bf16_f32 v105, v66, v67
    v_cvt_pk_bf16_f32 v106, v68, v69
    v_cvt_pk_bf16_f32 v107, v70, v71
    v_add_f32_e64 v98, 1.0, v98
    v_pk_fma_f32 v[72:73], v[72:73], v[98:99], v[98:99] op_sel:[0,0,1] op_sel_hi:[1,0,1]
    v_pk_fma_f32 v[74:75], v[74:75], v[98:99], v[98:99] op_sel:[0,0,1] op_sel_hi:[1,0,1]
    v_pk_fma_f32 v[76:77], v[76:77], v[98:99], v[98:99] op_sel:[0,0,1] op_sel_hi:[1,0,1]
    v_pk_fma_f32 v[78:79], v[78:79], v[98:99], v[98:99] op_sel:[0,0,1] op_sel_hi:[1,0,1]
    v_cvt_pk_bf16_f32 v108, v72, v73
    v_cvt_pk_bf16_f32 v109, v74, v75
    v_cvt_pk_bf16_f32 v110, v76, v77
    v_cvt_pk_bf16_f32 v111, v78, v79
    v_add_f32_e64 v100, 1.0, v100
    v_pk_fma_f32 v[80:81], v[80:81], v[100:101], v[100:101] op_sel:[0,0,1] op_sel_hi:[1,0,1]
    v_pk_fma_f32 v[82:83], v[82:83], v[100:101], v[100:101] op_sel:[0,0,1] op_sel_hi:[1,0,1]
    v_pk_fma_f32 v[84:85], v[84:85], v[100:101], v[100:101] op_sel:[0,0,1] op_sel_hi:[1,0,1]
    v_pk_fma_f32 v[86:87], v[86:87], v[100:101], v[100:101] op_sel:[0,0,1] op_sel_hi:[1,0,1]
    v_cvt_pk_bf16_f32 v112, v80, v81
    v_cvt_pk_bf16_f32 v113, v82, v83
    v_cvt_pk_bf16_f32 v114, v84, v85
    v_cvt_pk_bf16_f32 v115, v86, v87
    v_add_f32_e64 v102, 1.0, v102
    v_pk_fma_f32 v[88:89], v[88:89], v[102:103], v[102:103] op_sel:[0,0,1] op_sel_hi:[1,0,1]
    v_pk_fma_f32 v[90:91], v[90:91], v[102:103], v[102:103] op_sel:[0,0,1] op_sel_hi:[1,0,1]
    v_pk_fma_f32 v[92:93], v[92:93], v[102:103], v[102:103] op_sel:[0,0,1] op_sel_hi:[1,0,1]
    v_pk_fma_f32 v[94:95], v[94:95], v[102:103], v[102:103] op_sel:[0,0,1] op_sel_hi:[1,0,1]
    v_cvt_pk_bf16_f32 v116, v88, v89
    v_cvt_pk_bf16_f32 v117, v90, v91
    v_cvt_pk_bf16_f32 v118, v92, v93
    v_cvt_pk_bf16_f32 v119, v94, v95
    s_barrier
    ds_read_b32 v17, v16
    s_waitcnt lgkmcnt(0)
    v_and_b32 v17, 0x7ff, v17
    v_sub_u32 v17, v17, v18
    s_barrier
    s_barrier
    s_mov_b32 s78, 0
    v_cmp_ne_u32_e64 vcc, 0, v17
    s_mov_b64 exec, vcc
    s_cbranch_execz Lo_48
    buffer_store_dwordx4 v[104:107], v19, s[44:47], s78 offen sc1
Lo_48:
    s_mov_b64 exec, -1
    s_mov_b32 s78, 16384
    v_cmp_ne_u32 vcc, 8, v17
    s_mov_b64 exec, vcc
    s_cbranch_execz Lo_49
    buffer_store_dwordx4 v[108:111], v19, s[44:47], s78 offen sc1
Lo_49:
    s_mov_b64 exec, -1
    s_mov_b32 s78, 32768
    v_cmp_ne_u32 vcc, 16, v17
    s_mov_b64 exec, vcc
    s_cbranch_execz Lo_50
    buffer_store_dwordx4 v[112:115], v19, s[44:47], s78 offen sc1
Lo_50:
    s_mov_b64 exec, -1
    s_mov_b32 s78, 49152
    v_cmp_ne_u32 vcc, 24, v17
    s_mov_b64 exec, vcc
    s_cbranch_execz Lo_51
    buffer_store_dwordx4 v[116:119], v19, s[44:47], s78 offen sc1
Lo_51:
    s_mov_b64 exec, -1
    s_branch L_fin
L_pad12:
    s_cbranch_execz L_padret
    s_endpgm
Lspin_47:
    buffer_load_dwordx4 v[64:67], v12, s[36:39], s94 offen offset:0 sc1
    buffer_load_dwordx4 v[68:71], v12, s[36:39], s94 offen offset:2048 sc1
    buffer_load_dwordx4 v[72:75], v12, s[36:39], s79 offen offset:0 sc1
    buffer_load_dwordx4 v[76:79], v12, s[36:39], s79 offen offset:2048 sc1
    buffer_load_dwordx4 v[80:83], v12, s[36:39], s80 offen offset:0 sc1
    buffer_load_dwordx4 v[84:87], v12, s[36:39], s80 offen offset:2048 sc1
    buffer_load_dwordx4 v[88:91], v12, s[36:39], s81 offen offset:0 sc1
    buffer_load_dwordx4 v[92:95], v12, s[36:39], s81 offen offset:2048 sc1
    s_add_u32 s85, s85, 1
    s_cmp_gt_u32 s85, 400000
    s_cbranch_scc1 L_end
    s_branch L_gchk
L_kvspin:
    buffer_load_dwordx4 v[96:99], v11, s[36:39], s94 offen offset:0 sc1
    buffer_load_dwordx4 v[100:103], v11, s[36:39], s94 offen offset:2048 sc1
    buffer_load_dwordx4 v[104:107], v11, s[36:39], s95 offen offset:0 sc1
    buffer_load_dwordx4 v[108:111], v11, s[36:39], s95 offen offset:2048 sc1
    s_add_u32 s85, s85, 1
    s_cmp_gt_u32 s85, 400000
    s_cbranch_scc1 L_end
    s_nop 3
    s_branch L_kvchk
Lls_45:
    buffer_store_dwordx4 v[24:27], v14, s[36:39], s95 offen sc1
    s_nop 1
    s_branch Lle_46
L_fin:
L_end:
    s_endpgm
.fill 64, 4, 0xbf800000
s_endpgm
.section .rodata,"a"
.p2align 6
.amdhsa_kernel sequential_preLN__linear_kernel_hedgehog__moe_arch_mod__prompt_kernel
  .amdhsa_next_free_vgpr 256
  .amdhsa_next_free_sgpr 102
  .amdhsa_accum_offset 256
  .amdhsa_group_segment_fixed_size 0
  .amdhsa_kernarg_size 96
  .amdhsa_user_sgpr_count 2
  .amdhsa_user_sgpr_kernarg_segment_ptr 1
  .amdhsa_system_sgpr_workgroup_id_x 1
  .amdhsa_float_denorm_mode_32 3
.end_amdhsa_kernel
```

```asm
; @launch grid=(256,1,1) block=(512,1,1) lds=163840
.amdgcn_target "amdgcn-amd-amdhsa--gfx950"
.text
.globl sequential_preLN__linear_kernel_hedgehog__moe_arch_mod__prompt_kernel
.p2align 8
.type sequential_preLN__linear_kernel_hedgehog__moe_arch_mod__prompt_kernel,@function
sequential_preLN__linear_kernel_hedgehog__moe_arch_mod__prompt_kernel:
    s_cmp_ge_u32 s2, 256
    s_cbranch_scc1 L_end
    s_load_dwordx16 s[4:19], s[0:1], 0
    s_load_dwordx8 s[20:27], s[0:1], 64
    v_lshrrev_b32 v1, 6, v0
    v_and_b32_e64 v2, 63, v0
    v_readfirstlane_b32 s68, v1
    s_lshr_b32 s69, s2, 4
    s_and_b32 s70, s2, 7
    s_lshl_b32 s70, s70, 1
    s_bfe_u32 s78, s2, 0x10003
    s_or_b32 s70, s70, s78
    s_and_b32 s76, s68, 3
    s_cmp_ge_u32 s68, 4
    s_cbranch_scc1 L_M
    v_lshrrev_b32 v196, 3, v2
    v_and_b32 v197, 7, v2
    v_lshrrev_b32_e64 v198, 4, v2
    s_and_b32 s80, s69, 0
    s_lshl_b32 s89, s76, 11
    s_lshl_b32 s66, s80, 10
    s_or_b32 s66, s66, s89
    s_xor_b32 s67, s66, 1024
    s_lshl_b32 s79, s70, 7
    s_movk_i32 s78, 6144
    v_mov_b32_e64 v199, s79
    v_mad_u32_u24 v199, v196, s78, v199
    s_lshl_b32 s80, s80, 2
    v_and_b32 v200, 2, v196
    v_xor_b32 v200, v200, v197
    v_xor_b32 v200, s80, v200
    v_lshl_add_u32 v199, v200, 4, v199
    s_mul_i32 s78, s66, 48
    s_mul_i32 s79, s67, 48
    v_add_u32 v6, s78, v199
    v_xor_b32 v199, 64, v199
    v_add_u32_e64 v7, s79, v199
    s_and_b32 s80, s70, 0
    s_lshl_b32 s88, s76, 12
    s_lshl_b32 s64, s80, 10
    s_or_b32 s64, s64, s88
    s_xor_b32 s65, s64, 1024
    s_lshl_b32 s80, s80, 2
    s_lshl_b32 s78, s69, 14
    s_add_u32 s78, s78, s64
    s_lshl_b32 s78, s78, 4
    v_lshl_add_u32 v199, v196, 11, s78
    v_xor_b32 v200, v198, v197
    v_xor_b32 v200, s80, v200
    v_lshl_add_u32 v4, v200, 4, v199
    v_xor_b32 v5, 16448, v4
    s_and_b32 s78, s70, 14
    s_and_b32 s79, s69, 14
    s_add_u32 s78, s78, s79
    s_sub_u32 s78, 32, s78
    s_and_b32 s78, s78, 15
    s_lshl_b32 s86, s78, 7
    s_mul_i32 s87, s78, 393216
    s_mov_b32 s30, 0x400000
    s_mov_b32 s31, 0x20000
    s_mov_b32 s34, 0x600000
    s_mov_b32 s35, 0x20000
    s_waitcnt lgkmcnt(0)
    s_mov_b32 s32, s6
    s_and_b32 s33, s7, 0xffff
    s_mov_b32 s28, s4
    s_and_b32 s29, s5, 0xffff
    s_add_u32 m0, s64, 118784
    s_nop 0
    buffer_load_dwordx4 v4, s[28:31], s86 offen offset:0  lds
    s_add_u32 m0, s66, 141312
    s_nop 0
    s_nop 0
    buffer_load_dwordx4 v6, s[32:35], s87 offen offset:2048  lds
    s_add_u32 m0, s64, 120832
    s_add_u32 s101, s86, 32768
    buffer_load_dwordx4 v4, s[28:31], s101 offen offset:0  lds
    s_add_u32 m0, s66, 151552
    s_add_u32 s101, s87, 4096
    buffer_load_dwordx4 v6, s[32:35], s101 offen offset:0  lds
    s_add_u32 m0, s66, 135168
    s_nop 0
    buffer_load_dwordx4 v6, s[32:35], s87 offen offset:0  lds
    s_add_u32 m0, s65, 118784
    s_nop 0
    buffer_load_dwordx4 v5, s[28:31], s86 offen offset:0  lds
    s_add_u32 m0, s67, 141312
    s_nop 0
    s_nop 0
    buffer_load_dwordx4 v7, s[32:35], s87 offen offset:2048  lds
    s_add_u32 m0, s65, 120832
    s_add_u32 s101, s86, 32768
    buffer_load_dwordx4 v5, s[28:31], s101 offen offset:0  lds
    s_add_u32 m0, s67, 151552
    s_add_u32 s101, s87, 4096
    buffer_load_dwordx4 v7, s[32:35], s101 offen offset:0  lds
    s_add_u32 m0, s67, 135168
    s_nop 0
    buffer_load_dwordx4 v7, s[32:35], s87 offen offset:0  lds
    s_add_u32 s86, s86, 128
    s_add_u32 s87, s87, 393216
    s_and_b32 s86, s86, 2047
    s_cselect_b32 s87, s87, 0
    s_mov_b32 s101, 40960
    s_cmp_ge_i32 s64, 0
    s_cselect_b32 s101, 0xfffec000, s101
    s_add_u32 s64, s64, s101
    s_add_u32 s65, s65, s101
    s_add_u32 s66, s66, s101
    s_add_u32 s67, s67, s101
    s_load_dword s75, s[26:27], 0
    s_mov_b32 s60, s8
    s_and_b32 s61, s9, 0xffff
    s_mov_b32 s62, 0x10000
    s_mov_b32 s63, 0x20000
    v_lshlrev_b32 v14, 4, v2
    s_lshl_b32 s78, s70, 12
    s_lshl_b32 s79, s76, 10
    s_add_u32 s78, s78, s79
    s_add_u32 m0, s79, 159744
    s_nop 0
    buffer_load_dwordx4 v14, s[60:63], s78 offen lds
    s_and_b32 s78, s2, 7
    s_lshr_b32 s79, s2, 3
    s_lshl_b32 s71, s78, 1
    s_and_b32 s72, s79, 1
    s_add_u32 s71, s71, s72
    s_lshr_b32 s72, s79, 1
    s_cmp_gt_u32 s70, 3
    s_cselect_b32 s78, 1, 0
    s_cmp_gt_u32 s70, 11
    s_cselect_b32 s78, 2, s78
    s_sub_u32 s78, s70, s78
    s_cmp_eq_u32 s70, 3
    s_cselect_b32 s78, 14, s78
    s_cmp_eq_u32 s70, 11
    s_cselect_b32 s78, 15, s78
    s_lshl_b32 s0, s78, 4
    s_add_u32 s0, s0, s69
    s_lshr_b32 s73, s0, 2
    s_and_b32 s74, s0, 3
    s_lshl_b32 s77, s70, 4
    s_add_u32 s77, s77, s69
    s_getpc_b64 s[12:13]
Lpr_1:
    s_add_u32 s12, s12, L_end-Lpr_1
    s_addc_u32 s13, s13, 0
    s_mov_b32 s36, s26
    s_and_b32 s37, s27, 0xffff
    s_mov_b32 s38, 0x10000000
    s_mov_b32 s39, 0x20000
    s_mov_b32 s40, s10
    s_and_b32 s41, s11, 0xffff
    s_mov_b32 s42, 0x200000
    s_mov_b32 s43, 0x20000
    s_mov_b32 s44, s22
    s_and_b32 s45, s23, 0xffff
    s_mov_b32 s46, 0x400000
    s_mov_b32 s47, 0x20000
    s_mov_b32 s48, s16
    s_and_b32 s49, s17, 0xffff
    s_mov_b32 s50, 0x700000
    s_mov_b32 s51, 0x20000
    s_mov_b32 s52, s18
    s_and_b32 s53, s19, 0xffff
    s_mov_b32 s54, 0x700000
    s_mov_b32 s55, 0x20000
    s_mov_b32 s56, s20
    s_and_b32 s57, s21, 0xffff
    s_mov_b32 s58, 0x700000
    s_mov_b32 s59, 0x20000
    v_mov_b32 v16, -1
    v_mov_b32 v17, -1
    v_mov_b32 v18, -1
    v_mov_b32_e64 v19, -1
    s_lshl_b32 s94, s77, 14
    s_lshl_b32 s78, s76, 12
    s_add_u32 s94, s94, s78
    s_add_u32 s94, s94, 4194304
    s_lshl_b32 s96, s77, 10
    s_add_u32 s96, s96, 8388608
    s_cmp_eq_u32 s76, 3
    s_cselect_b32 s96, s96, 0x10000000
    v_and_b32 v196, 15, v2
    v_lshrrev_b32 v197, 1, v196
    v_lshlrev_b32 v199, 7, v196
    v_add_u32 v199, s88, v199
    v_xor_b32_e64 v200, v198, v197
    v_lshl_add_u32 v60, v200, 4, v199
    v_bfe_u32 v196, v2, 2, 2
    v_and_b32_e64 v197, 3, v2
    v_lshl_add_u32 v199, v198, 3, v196
    v_lshlrev_b32_e64 v199, 7, v199
    v_lshl_add_u32 v199, v197, 3, v199
    v_lshrrev_b32 v196, 1, v196
    v_and_b32 v197, 1, v198
    v_lshl_add_u32 v196, v197, 1, v196
    s_mul_i32 s80, s76, 3
    s_add_u32 s78, s80, 0
    s_and_b32 s79, s78, 3
    s_lshr_b32 s78, s78, 2
    s_lshl_b32 s78, s78, 13
    s_add_u32 s78, s78, 16384
    v_xor_b32 v197, s79, v196
    v_lshl_add_u32 v197, v197, 5, v199
    v_add_u32_e64 v240, s78, v197
    s_add_u32 s78, s80, 1
    s_and_b32 s79, s78, 3
    s_lshr_b32 s78, s78, 2
    s_lshl_b32 s78, s78, 13
    s_add_u32 s78, s78, 16384
    v_xor_b32_e64 v197, s79, v196
    v_lshl_add_u32 v197, v197, 5, v199
    v_add_u32_e64 v241, s78, v197
    s_add_u32 s78, s80, 2
    s_and_b32 s79, s78, 3
    s_lshr_b32 s78, s78, 2
    s_lshl_b32 s78, s78, 13
    s_add_u32 s78, s78, 16384
    v_xor_b32_e64 v197, s79, v196
    v_lshl_add_u32 v197, v197, 5, v199
    v_add_u32 v242, s78, v197
    s_and_b32 s78, s70, 1
    s_lshl_b32 s78, s78, 6
    v_xor_b32 v60, s78, v60
    s_and_b32 s78, s69, 1
    s_lshl_b32 s78, s78, 12
    v_add_u32 v240, s78, v240
    v_add_u32 v241, s78, v241
    v_add_u32_e64 v242, s78, v242
    s_add_u32 m0, s64, 118784
    s_nop 0
    buffer_load_dwordx4 v4, s[28:31], s86 offen offset:0  lds
    v_lshrrev_b32 v196, 3, v2
    v_and_b32 v197, 7, v2
    v_lshlrev_b32 v199, 4, v197
    v_mul_u32_u24 v244, 57344, v196
    s_add_u32 m0, s66, 141312
    s_nop 0
    buffer_load_dwordx4 v6, s[32:35], s87 offen offset:2048  lds
    v_add_u32 v244, v244, v199
    v_lshl_add_u32 v245, v196, 14, v199
    s_lshl_b32 s78, s74, 2
    s_add_u32 s78, s78, s76
    s_add_u32 m0, s64, 120832
    s_add_u32 s101, s86, 32768
    buffer_load_dwordx4 v4, s[28:31], s101 offen offset:0  lds
    s_mul_i32 s79, s78, 458752
    s_add_u32 s80, s73, s76
    s_and_b32 s80, s80, 3
    s_andn2_b32 s100, s73, 3
    s_add_u32 m0, s66, 151552
    s_add_u32 s101, s87, 4096
    buffer_load_dwordx4 v6, s[32:35], s101 offen offset:0  lds
    s_or_b32 s80, s80, s100
    s_lshl_b32 s80, s80, 7
    s_add_u32 s79, s79, s80
    s_cmp_ge_u32 s73, 56
    s_cselect_b32 s79, 0x8000000, s79
    v_add_u32_e64 v244, s79, v244
    s_lshl_b32 s78, s78, 7
    s_add_u32 m0, s66, 135168
    s_nop 0
    buffer_load_dwordx4 v6, s[32:35], s87 offen offset:0  lds
    s_lshl_b32 s80, s73, 17
    s_add_u32 s78, s78, s80
    v_add_u32_e64 v245, s78, v245
    s_lshl_b32 s78, s72, 7
    s_add_u32 m0, s65, 118784
    s_nop 0
    buffer_load_dwordx4 v5, s[28:31], s86 offen offset:0  lds
    v_lshl_add_u32 v196, v196, 11, s78
    v_and_b32 v199, 1, v198
    v_lshlrev_b32 v199, 2, v199
    v_xor_b32 v199, v199, v197
    s_add_u32 m0, s67, 141312
    s_nop 0
    buffer_load_dwordx4 v7, s[32:35], s87 offen offset:2048  lds
    v_lshl_add_u32 v246, v199, 4, v196
    s_lshl_b32 s78, s71, 2
    s_add_u32 s78, s78, s76
    s_lshl_b32 s78, s78, 16
    v_add_u32_e64 v196, s78, v196
    s_add_u32 m0, s65, 120832
    s_add_u32 s101, s86, 32768
    buffer_load_dwordx4 v5, s[28:31], s101 offen offset:0  lds
    v_xor_b32_e64 v199, v198, v197
    v_lshl_add_u32 v247, v199, 4, v196
    v_xor_b32 v248, 64, v247
    s_lshl_b32 s78, s76, 14
    s_add_u32 m0, s67, 151552
    s_add_u32 s101, s87, 4096
    buffer_load_dwordx4 v7, s[32:35], s101 offen offset:0  lds
    v_add_u32 v246, s78, v246
    s_lshl_b32 s84, s76, 10
    s_bfe_u32 s78, s2, 0x40003
    s_lshl_b32 s78, s78, 17
    s_add_u32 m0, s67, 135168
    s_nop 0
    buffer_load_dwordx4 v7, s[32:35], s87 offen offset:0  lds
    s_add_u32 s86, s86, 128
    s_add_u32 s87, s87, 393216
    s_and_b32 s86, s86, 2047
    s_cselect_b32 s87, s87, 0
    s_mov_b32 s101, 40960
    s_cmp_ge_i32 s64, 0
    s_cselect_b32 s101, 0xfffec000, s101
    s_add_u32 s64, s64, s101
    s_add_u32 s65, s65, s101
    s_add_u32 s66, s66, s101
    s_add_u32 s67, s67, s101
    s_and_b32 s79, s72, 8
    s_add_u32 s79, s79, 3
    s_lshl_b32 s79, s79, 7
    s_add_u32 s78, s78, s79
    v_lshl_add_u32 v63, v2, 11, s78
    s_mov_b32 s92, 0x2140321
    s_mov_b32 s93, 0x4320143
    s_lshl_b32 s100, s69, 2
    s_lshr_b64 s[92:93], s[92:93], s100
    s_and_b32 s3, s92, 15
    s_branch L_sube
    .p2align 6
L_iss:
    s_add_u32 m0, s64, 118784
    s_nop 0
    buffer_load_dwordx4 v4, s[28:31], s86 offen offset:0  lds
    s_add_u32 m0, s66, 141312
    s_nop 0
    buffer_load_dwordx4 v6, s[32:35], s87 offen offset:2048  lds
    s_add_u32 m0, s64, 120832
    s_add_u32 s101, s86, 32768
    buffer_load_dwordx4 v4, s[28:31], s101 offen offset:0  lds
    s_add_u32 m0, s66, 151552
    s_add_u32 s101, s87, 4096
    buffer_load_dwordx4 v6, s[32:35], s101 offen offset:0  lds
    s_add_u32 m0, s66, 135168
    s_nop 0
    buffer_load_dwordx4 v6, s[32:35], s87 offen offset:0  lds
    s_add_u32 m0, s65, 118784
    s_nop 0
    buffer_load_dwordx4 v5, s[28:31], s86 offen offset:0  lds
    s_add_u32 m0, s67, 141312
    s_nop 0
    s_nop 0
    buffer_load_dwordx4 v7, s[32:35], s87 offen offset:2048  lds
    s_add_u32 m0, s65, 120832
    s_add_u32 s101, s86, 32768
    buffer_load_dwordx4 v5, s[28:31], s101 offen offset:0  lds
    s_add_u32 m0, s67, 151552
    s_add_u32 s101, s87, 4096
    buffer_load_dwordx4 v7, s[32:35], s101 offen offset:0  lds
    s_add_u32 m0, s67, 135168
    s_nop 0
    buffer_load_dwordx4 v7, s[32:35], s87 offen offset:0  lds
    s_add_u32 s86, s86, 128
    s_add_u32 s87, s87, 393216
    s_and_b32 s86, s86, 2047
    s_cselect_b32 s87, s87, 0
    s_mov_b32 s101, 40960
    s_cmp_ge_i32 s64, 0
    s_cselect_b32 s101, 0xfffec000, s101
    s_add_u32 s64, s64, s101
    s_add_u32 s65, s65, s101
    s_add_u32 s66, s66, s101
    s_add_u32 s67, s67, s101
    s_setpc_b64 s[90:91]
    .p2align 6
L_cl0:
    s_mov_b32 s100, 0
    buffer_load_dwordx4 v[64:67], v244, s[48:51], s100 offen nt
    s_mov_b32 s100, 0
    buffer_load_dwordx4 v[96:99], v244, s[52:55], s100 offen nt
    s_mov_b32 s100, 7168
    buffer_load_dwordx4 v[68:71], v244, s[48:51], s100 offen nt
    s_mov_b32 s100, 7168
    buffer_load_dwordx4 v[100:103], v244, s[52:55], s100 offen nt
    s_mov_b32 s100, 14336
    buffer_load_dwordx4 v[72:75], v244, s[48:51], s100 offen nt
    s_mov_b32 s100, 14336
    buffer_load_dwordx4 v[104:107], v244, s[52:55], s100 offen nt
    s_setpc_b64 s[90:91]
    .p2align 6
L_cl1:
    s_mov_b32 s100, 21504
    buffer_load_dwordx4 v[76:79], v244, s[48:51], s100 offen nt
    s_mov_b32 s100, 21504
    buffer_load_dwordx4 v[108:111], v244, s[52:55], s100 offen nt
    s_mov_b32 s100, 28672
    buffer_load_dwordx4 v[80:83], v244, s[48:51], s100 offen nt
    s_mov_b32 s100, 28672
    buffer_load_dwordx4 v[112:115], v244, s[52:55], s100 offen nt
    s_mov_b32 s100, 35840
    buffer_load_dwordx4 v[84:87], v244, s[48:51], s100 offen nt
    s_mov_b32 s100, 35840
    buffer_load_dwordx4 v[116:119], v244, s[52:55], s100 offen nt
    s_setpc_b64 s[90:91]
    .p2align 12
L_sube:
    s_waitcnt vmcnt(10)
    s_barrier
    s_call_b64 s[90:91], L_iss
    s_setprio 2
    v_add_u32 v196, 118784, v60
    v_add_u32 v198, 118784, v240
    v_add_u32 v199, 118784, v241
    v_add_u32 v200, 118784, v242
    ds_read_b128 v[20:23], v196 offset:0
    ds_read_b128 v[24:27], v196 offset:2048
    ds_read_b64_tr_b16 v[36:37], v198 offset:0
    ds_read_b64_tr_b16 v[38:39], v198 offset:512
    ds_read_b64_tr_b16 v[44:45], v199 offset:0
    ds_read_b64_tr_b16 v[46:47], v199 offset:512
    ds_read_b64_tr_b16 v[52:53], v200 offset:0
    ds_read_b64_tr_b16 v[54:55], v200 offset:512
    s_setprio 0
    s_waitcnt lgkmcnt(0)
    s_mul_i32 s75, s75, 0x9E3779B1
    s_add_u32 s75, s75, 0x7F4A7C15
    s_waitcnt vmcnt(10)
    s_waitcnt lgkmcnt(0)
    s_barrier
    s_call_b64 s[90:91], L_iss
    s_setprio 2
    s_nop 0
    v_add_u32 v196, 36864, v60
    v_add_u32 v198, 36864, v240
    v_add_u32 v199, 36864, v241
    v_add_u32 v200, 36864, v242
    ds_read_b128 v[28:31], v196 offset:0
    ds_read_b128 v[32:35], v196 offset:2048
    ds_read_b64_tr_b16 v[40:41], v198 offset:0
    ds_read_b64_tr_b16 v[42:43], v198 offset:512
    ds_read_b64_tr_b16 v[48:49], v199 offset:0
    ds_read_b64_tr_b16 v[50:51], v199 offset:512
    ds_read_b64_tr_b16 v[56:57], v200 offset:0
    ds_read_b64_tr_b16 v[58:59], v200 offset:512
    s_setprio 0
    s_getreg_b32 s99, hwreg(HW_REG_XCC_ID, 0, 4)
    v_mov_b32 v10, s75
    v_mov_b32 v11, s99
    v_not_b32 v12, v10
    v_mov_b32 v13, 0
    v_and_b32 v8, 15, v2
    v_lshlrev_b32 v9, 4, v8
    v_add_u32 v9, s69, v9
    s_lshl_b32 s78, s70, 4
    s_xor_b32 s79, s78, 16
    v_mov_b32 v202, s78
    v_mov_b32 v203, s79
    v_cmp_gt_u32 vcc, 32, v2
    s_nop 1
    v_cndmask_b32 v202, v203, v202, vcc
    v_add_u32 v8, v202, v8
    v_cmp_gt_u32 vcc, 16, v2
    s_nop 1
    v_cndmask_b32 v8, v8, v9, vcc
    v_lshlrev_b32_e64 v8, 7, v8
    v_add_u32 v8, 4096, v8
    v_lshlrev_b32 v9, 3, v2
    s_lshl_b32 s82, s77, 7
    s_add_u32 s82, s82, 4096
    s_cmp_gt_u32 s76, 0
    s_cselect_b32 s82, 0x10000000, s82
    s_lshl_b32 s83, s77, 9
    s_add_u32 s83, s83, 8912896
    s_cmp_eq_u32 s76, 2
    s_cselect_b32 s83, s83, 0x10000000
    buffer_store_dwordx2 v[12:13], v9, s[36:39], s83 offen sc1
    s_waitcnt vmcnt(11)
    s_waitcnt lgkmcnt(0)
    s_barrier
    s_call_b64 s[90:91], L_iss
    s_waitcnt vmcnt(11)
    s_cmp_lg_u32 s3, 0
    s_cbranch_scc1 Lcs_2
    s_call_b64 s[90:91], L_cl0
Lcs_2:
    s_barrier
    s_setprio 2
    s_add_u32 m0, s64, 118784
    s_nop 0
    buffer_load_dwordx4 v4, s[28:31], s86 offen offset:0  lds
    v_mov_b32 v200, 0x3f803f80
    v_mov_b32 v201, 0x3f803f80
    v_mov_b32 v202, 0x3f803f80
    v_mov_b32 v203, 0x3f803f80
    s_add_u32 m0, s66, 141312
    s_nop 0
    s_nop 0
    buffer_load_dwordx4 v6, s[32:35], s87 offen offset:2048  lds
    v_mfma_f32_16x16x32_bf16 v[204:207], v[200:203], v[20:23], 0
    v_mfma_f32_16x16x32_bf16 v[212:215], v[20:23], v[20:23], 0
    v_mfma_f32_16x16x32_bf16 v[208:211], v[200:203], v[24:27], 0
    v_mfma_f32_16x16x32_bf16 v[216:219], v[24:27], v[24:27], 0
    s_add_u32 m0, s64, 120832
    s_add_u32 s101, s86, 32768
    buffer_load_dwordx4 v4, s[28:31], s101 offen offset:0  lds
    v_mfma_f32_16x16x32_bf16 v[220:223], v[200:203], v[36:39], 0
    v_mfma_f32_16x16x32_bf16 v[224:227], v[200:203], v[44:47], 0
    v_mfma_f32_16x16x32_bf16 v[228:231], v[200:203], v[52:55], 0
    v_mfma_f32_16x16x32_bf16 v[204:207], v[200:203], v[28:31], v[204:207]
    v_mfma_f32_16x16x32_bf16 v[212:215], v[28:31], v[28:31], v[212:215]
    s_add_u32 m0, s66, 151552
    s_add_u32 s101, s87, 4096
    buffer_load_dwordx4 v6, s[32:35], s101 offen offset:0  lds
    v_mfma_f32_16x16x32_bf16 v[208:211], v[200:203], v[32:35], v[208:211]
    v_mfma_f32_16x16x32_bf16 v[216:219], v[32:35], v[32:35], v[216:219]
    v_mfma_f32_16x16x32_bf16 v[220:223], v[200:203], v[40:43], v[220:223]
    v_mfma_f32_16x16x32_bf16 v[224:227], v[200:203], v[48:51], v[224:227]
    s_add_u32 m0, s66, 135168
    s_nop 0
    buffer_load_dwordx4 v6, s[32:35], s87 offen offset:0  lds
    v_mfma_f32_16x16x32_bf16 v[228:231], v[200:203], v[56:59], v[228:231]
    v_and_b32 v196, 3, v2
    v_cmp_eq_u32 s[90:91], 1, v196
    v_cmp_eq_u32 s[92:93], 2, v196
    v_cmp_eq_u32_e64 vcc, 3, v196
    s_add_u32 m0, s65, 118784
    s_nop 0
    buffer_load_dwordx4 v5, s[28:31], s86 offen offset:0  lds
    v_cndmask_b32 v212, v212, v213, s[90:91]
    v_cndmask_b32 v212, v212, v214, s[92:93]
    v_cndmask_b32 v205, v212, v215, vcc
    v_cndmask_b32 v216, v216, v217, s[90:91]
    s_add_u32 m0, s67, 141312
    s_nop 0
    buffer_load_dwordx4 v7, s[32:35], s87 offen offset:2048  lds
    v_cndmask_b32 v216, v216, v218, s[92:93]
    v_cndmask_b32 v209, v216, v219, vcc
    v_lshrrev_b32_e64 v196, 4, v2
    v_cmp_eq_u32 s[90:91], 1, v196
    v_cmp_eq_u32_e64 vcc, 2, v196
    s_add_u32 m0, s65, 120832
    s_add_u32 s101, s86, 32768
    buffer_load_dwordx4 v5, s[28:31], s101 offen offset:0  lds
    v_cndmask_b32 v220, v220, v224, s[90:91]
    v_cndmask_b32_e64 v220, v220, v228, vcc
    s_mul_i32 s78, s77, 768
    s_mul_i32 s79, s76, 192
    s_add_u32 m0, s67, 151552
    s_add_u32 s101, s87, 4096
    buffer_load_dwordx4 v7, s[32:35], s101 offen offset:0  lds
    s_add_u32 s78, s78, s79
    s_add_u32 s78, s78, 327680
    v_lshlrev_b32 v197, 2, v2
    s_mov_b32 exec_hi, 0xffff
    buffer_store_dword v220, v197, s[36:39], s78 offen sc1
    s_mov_b32 exec_hi, -1
    s_lshl_b32 s78, s69, 4
    s_add_u32 m0, s67, 135168
    s_nop 0
    buffer_load_dwordx4 v7, s[32:35], s87 offen offset:0  lds
    s_add_u32 s86, s86, 128
    s_add_u32 s87, s87, 393216
    s_and_b32 s86, s86, 2047
    s_cselect_b32 s87, s87, 0
    s_mov_b32 s101, 40960
    s_cmp_ge_i32 s64, 0
    s_cselect_b32 s101, 0xfffec000, s101
    s_add_u32 s64, s64, s101
    s_add_u32 s65, s65, s101
    s_add_u32 s66, s66, s101
    s_add_u32 s67, s67, s101
    s_add_u32 s78, s78, s70
    s_lshl_b32 s78, s78, 10
    s_lshl_b32 s79, s76, 8
    s_add_u32 s78, s78, s79
    buffer_store_dwordx4 v[16:19], v14, s[36:39], s96 offen offset:0 sc1
    s_add_u32 s78, s78, 65536
    v_and_b32 v198, 15, v2
    v_lshlrev_b32_e64 v198, 3, v198
    s_mov_b32 exec_lo, 0x00f0000f
    s_mov_b32 exec_hi, 0xf0000f00
    buffer_store_dwordx2 v[204:205], v198, s[36:39], s78 offen offset:0 sc1
    s_mov_b64 exec, -1
    s_mov_b32 exec_lo, 0x00f0000f
    s_mov_b32 exec_hi, 0xf0000f00
    buffer_store_dwordx2 v[208:209], v198, s[36:39], s78 offen offset:128 sc1
    s_mov_b64 exec, -1
    s_setprio 0
    s_waitcnt vmcnt(14)
    s_cmp_lg_u32 s3, 1
    s_cbranch_scc1 Lcs_3
    s_call_b64 s[90:91], L_cl0
Lcs_3:
    s_barrier
    s_call_b64 s[90:91], L_iss
    s_waitcnt vmcnt(10)
    s_cmp_lg_u32 s3, 2
    s_cbranch_scc1 Lcs_4
    s_call_b64 s[90:91], L_cl0
Lcs_4:
    s_barrier
    s_mov_b64 exec, 0xffff
    buffer_store_dwordx2 v[10:11], v9, s[36:39], s82 offen sc1
    s_mov_b64 exec, -1
    s_call_b64 s[90:91], L_iss
    s_waitcnt vmcnt(11)
    s_cmp_lg_u32 s3, 3
    s_cbranch_scc1 Lcs_5
    s_call_b64 s[90:91], L_cl0
Lcs_5:
    s_barrier
    s_call_b64 s[90:91], L_iss
    s_waitcnt vmcnt(10)
    s_cmp_lg_u32 s3, 4
    s_cbranch_scc1 Lcs_6
    s_call_b64 s[90:91], L_cl0
Lcs_6:
    s_barrier
    s_call_b64 s[90:91], L_iss
    s_waitcnt vmcnt(10)
    s_cmp_lg_u32 s3, 0
    s_cbranch_scc1 Lcs_7
    s_call_b64 s[90:91], L_cl1
Lcs_7:
    s_barrier
    s_call_b64 s[90:91], L_iss
    s_waitcnt vmcnt(10)
    s_cmp_lg_u32 s3, 1
    s_cbranch_scc1 Lcs_8
    s_call_b64 s[90:91], L_cl1
Lcs_8:
    s_barrier
    s_call_b64 s[90:91], L_iss
    s_waitcnt vmcnt(10)
    s_cmp_lg_u32 s3, 2
    s_cbranch_scc1 Lcs_9
    s_call_b64 s[90:91], L_cl1
Lcs_9:
    s_barrier
    s_call_b64 s[90:91], L_iss
    s_waitcnt vmcnt(10)
    s_cmp_lg_u32 s3, 3
    s_cbranch_scc1 Lcs_10
    s_call_b64 s[90:91], L_cl1
Lcs_10:
    s_barrier
    s_call_b64 s[90:91], L_iss
    s_waitcnt vmcnt(10)
    s_cmp_lg_u32 s3, 4
    s_cbranch_scc1 Lcs_11
    s_call_b64 s[90:91], L_cl1
Lcs_11:
    s_barrier
    s_cmp_lg_u32 s76, 0
    s_cbranch_scc1 Lpl_12
    s_mov_b32 exec_hi, 0xffff
    buffer_load_dwordx2 v[10:11], v8, s[36:39], 0 offen sc1
    s_mov_b64 exec, -1
Lpl_12:
    s_call_b64 s[90:91], L_iss
    s_cmp_lg_u32 s76, 1
    s_cbranch_scc1 Lpf_13
    s_getpc_b64 s[90:91]
Lpc_14:
    s_add_u32 s90, s90, L_phend-Lpc_14
    s_addc_u32 s91, s91, 0
    s_lshr_b32 s100, s2, 3
    s_lshl_b32 s100, s100, 10
    s_min_u32 s100, s100, (L_end-L_phend-768)
    v_add_u32 v236, s100, v14
    global_load_dword v236, v236, s[90:91]
Lpf_13:
    s_waitcnt vmcnt(10)
    s_barrier
    s_cmp_lg_u32 s76, 2
    s_cbranch_scc1 Lc4_15
    s_mov_b32 exec_hi, -1
    buffer_load_dword v238, v63, s[40:43], 0 offen
    s_mov_b64 exec, -1
Lc4_15:
    s_call_b64 s[90:91], L_iss
    s_waitcnt vmcnt(10)
    s_cmp_lg_u32 s76, 0
    s_cbranch_scc1 Lpc_16
    s_setprio 2
    s_mov_b32 exec_hi, 0xffff
    s_mov_b32 s85, 0
Lpk_17:
    v_cmp_ne_u32 vcc, s75, v10
    s_cbranch_vccnz Lspin_18
    v_cmp_ne_u32 vcc, s99, v11
    s_mov_b64 exec, -1
    s_lshr_b32 s78, vcc_lo, 16
    s_cselect_b32 s78, 0, 3
    s_cmp_eq_u32 vcc_hi, 0
    s_cselect_b32 s79, 3, 1
    s_and_b32 s78, s78, s79
    s_and_b32 s78, s78, 3
    v_mov_b32_e64 v10, s78
    v_mov_b32 v11, 163584
    ds_write_b32 v11, v10
    s_setprio 0
Lpc_16:
    s_barrier
    v_lshrrev_b32 v196, 4, v2
    v_and_b32 v197, 15, v2
    v_lshlrev_b32_e64 v197, 4, v197
    v_lshl_add_u32 v198, v196, 10, v197
    s_lshl_b32 s78, s69, 14
    s_lshl_b32 s79, s76, 8
    s_add_u32 s78, s78, s79
    s_nop 0
    s_add_u32 s78, s78, 65536
    buffer_load_dwordx4 v[20:23], v198, s[36:39], s78 offen sc1
    s_add_u32 s78, s78, 4096
    buffer_load_dwordx4 v[24:27], v198, s[36:39], s78 offen sc1
    s_add_u32 s78, s78, 4096
    buffer_load_dwordx4 v[28:31], v198, s[36:39], s78 offen sc1
    s_add_u32 s78, s78, 4096
    buffer_load_dwordx4 v[32:35], v198, s[36:39], s78 offen sc1
    v_mul_u32_u24 v198, 768, v196
    v_add_u32_e64 v198, v198, v197
    s_mul_i32 s78, s70, 12288
    s_lshl_b32 s79, s76, 8
    s_add_u32 s78, s78, s79
    s_add_u32 s78, s78, 327680
    s_cmp_eq_u32 s76, 3
    s_nop 0
    s_cselect_b32 s78, 0x10000000, s78
    buffer_load_dwordx4 v[36:39], v198, s[36:39], s78 offen sc1
    s_add_u32 s78, s78, 3072
    buffer_load_dwordx4 v[40:43], v198, s[36:39], s78 offen sc1
    s_add_u32 s78, s78, 3072
    buffer_load_dwordx4 v[44:47], v198, s[36:39], s78 offen sc1
    s_add_u32 s78, s78, 3072
    buffer_load_dwordx4 v[48:51], v198, s[36:39], s78 offen sc1
    s_add_u32 m0, s84, 0
    s_mov_b32 s100, 0
    buffer_load_dwordx4 v246, s[40:43], s100 offen  lds
    s_add_u32 m0, s84, 4096
    s_mov_b32 s100, 65536
    buffer_load_dwordx4 v246, s[40:43], s100 offen  lds
    s_add_u32 m0, s84, 8192
    s_mov_b32 s100, 131072
    buffer_load_dwordx4 v246, s[40:43], s100 offen  lds
    s_add_u32 m0, s84, 12288
    s_mov_b32 s100, 196608
    buffer_load_dwordx4 v246, s[40:43], s100 offen  lds
    s_waitcnt vmcnt(12)
    s_barrier
    s_setprio 2
    s_add_u32 m0, s84, 16384
    s_mov_b32 s100, 262144
    buffer_load_dwordx4 v246, s[40:43], s100 offen  lds
    s_waitcnt vmcnt(9)
    v_add_f32 v20, v20, v24
    v_add_f32 v21, v21, v25
    v_add_f32 v22, v22, v26
    v_add_f32 v23, v23, v27
    v_add_f32 v20, v20, v28
    v_add_f32 v21, v21, v29
    s_add_u32 m0, s84, 20480
    s_mov_b32 s100, 327680
    buffer_load_dwordx4 v246, s[40:43], s100 offen  lds
    v_add_f32 v22, v22, v30
    v_add_f32 v23, v23, v31
    v_add_f32 v20, v20, v32
    v_add_f32 v21, v21, v33
    v_add_f32 v22, v22, v34
    v_add_f32 v23, v23, v35
    s_nop 0
    v_permlane32_swap_b32 v20, v22
    s_add_u32 m0, s84, 24576
    s_mov_b32 s100, 393216
    buffer_load_dwordx4 v246, s[40:43], s100 offen  lds
L_pad0:
    s_cbranch_execz L_pad4
    v_permlane32_swap_b32 v21, v23
    v_add_f32 v20, v20, v22
    v_add_f32 v21, v21, v23
    v_mov_b32 v22, v20
    v_mov_b32 v23, v21
    s_nop 0
    v_permlane16_swap_b32 v20, v22
    v_permlane16_swap_b32 v21, v23
    v_add_f32 v20, v20, v22
    s_add_u32 m0, s84, 28672
    s_mov_b32 s100, 458752
    buffer_load_dwordx4 v246, s[40:43], s100 offen  lds
    v_add_f32_e64 v21, v21, v23
    v_mul_f32 v24, 0x3a800000, v20
    v_mul_f32 v26, 0x3a800000, v21
    v_fma_f32 v26, -v24, v24, v26
    v_max_f32_e64 v26, 0, v26
    v_cvt_pk_bf16_f32 v24, v24, v24
    v_and_b32 v24, 0xffff0000, v24
    s_add_u32 m0, s84, 32768
    s_mov_b32 s100, 524288
    buffer_load_dwordx4 v246, s[40:43], s100 offen  lds
    v_cvt_pk_bf16_f32 v26, v26, v26
    v_and_b32 v26, 0xffff0000, v26
    v_add_f32 v26, 0x3727c5ac, v26
    v_cvt_pk_bf16_f32 v26, v26, v26
    v_and_b32 v26, 0xffff0000, v26
    v_sqrt_f32 v26, v26
    s_nop 0
    v_cvt_pk_bf16_f32 v26, v26, v26
    v_and_b32 v26, 0xffff0000, v26
    s_add_u32 m0, s84, 36864
    s_mov_b32 s100, 589824
    buffer_load_dwordx4 v246, s[40:43], s100 offen  lds
    v_rcp_f32_e64 v25, v26
    v_xor_b32 v26, 0x80000000, v24
    v_lshrrev_b32 v27, 16, v26
    v_or_b32 v26, v26, v27
    v_mov_b32 v27, 0
    v_and_b32 v196, 15, v2
    v_lshrrev_b32_e64 v197, 5, v2
    s_add_u32 m0, s84, 40960
    s_mov_b32 s100, 655360
    buffer_load_dwordx4 v246, s[40:43], s100 offen  lds
    v_lshl_add_u32 v196, v196, 1, v197
    s_lshl_b32 s78, s76, 5
    v_add_u32 v196, s78, v196
    v_lshlrev_b32_e64 v197, 3, v196
    v_add_u32 v197, 159744, v197
    v_lshlrev_b32_e64 v196, 2, v196
    v_add_u32 v196, 162304, v196
    s_add_u32 m0, s84, 45056
    s_mov_b32 s100, 720896
    buffer_load_dwordx4 v246, s[40:43], s100 offen  lds
    ds_write_b64 v197, v[26:27]
    ds_write_b32 v196, v25
    s_waitcnt vmcnt(12)
    v_add_f32 v36, v36, v40
    v_add_f32 v37, v37, v41
    v_add_f32 v38, v38, v42
    v_add_f32 v39, v39, v43
    v_add_f32 v36, v36, v44
    s_add_u32 m0, s84, 49152
    s_mov_b32 s100, 786432
    buffer_load_dwordx4 v246, s[40:43], s100 offen  lds
    v_add_f32 v37, v37, v45
    v_add_f32 v38, v38, v46
    v_add_f32 v39, v39, v47
    v_add_f32 v36, v36, v48
    v_add_f32 v37, v37, v49
    v_add_f32 v38, v38, v50
    v_add_f32_e64 v39, v39, v51
    s_add_u32 m0, s84, 53248
    s_mov_b32 s100, 851968
    buffer_load_dwordx4 v246, s[40:43], s100 offen  lds
    v_permlane32_swap_b32 v36, v38
    v_permlane32_swap_b32 v37, v39
    v_add_f32 v36, v36, v38
    v_add_f32 v37, v37, v39
    s_nop 1
    v_permlane16_swap_b32 v36, v37
    v_add_f32_e64 v36, v36, v37
    v_cvt_pk_bf16_f32 v37, v36, v36
    v_and_b32 v37, 0xffff0000, v37
    s_add_u32 m0, s84, 57344
    s_mov_b32 s100, 917504
    buffer_load_dwordx4 v246, s[40:43], s100 offen  lds
    v_sub_f32_e64 v38, v36, v37
    v_cvt_pk_bf16_f32 v38, v37, v38
    v_mov_b32 v39, 0
    v_and_b32 v196, 15, v2
    v_lshrrev_b32_e64 v197, 4, v2
    v_lshl_add_u32 v196, v196, 2, v197
    s_lshl_b32 s78, s76, 9
    s_add_u32 m0, s84, 61440
    s_mov_b32 s100, 983040
    buffer_load_dwordx4 v246, s[40:43], s100 offen  lds
    s_add_u32 s78, s78, 160768
    v_lshl_add_u32 v196, v196, 3, s78
    v_and_b32 v197, 15, v2
    v_lshlrev_b32_e64 v197, 3, v197
    v_add_u32 v197, 162816, v197
    v_mov_b32 v198, 0x3f803f80
    s_cmp_eq_u32 s76, 3
    s_cselect_b64 vcc, -1, 0
    v_cndmask_b32 v196, v196, v197, vcc
    v_cndmask_b32 v38, v38, v198, vcc
    v_cndmask_b32_e64 v39, v39, v198, vcc
    ds_write_b64 v196, v[38:39]
    s_setprio 0
    s_waitcnt lgkmcnt(0)
    s_barrier
L_phend:
    s_mov_b32 s66, s96
    s_add_u32 m0, s84, 65536
    s_mov_b32 s100, 1048576
    buffer_load_dwordx4 v246, s[40:43], s100 offen  lds
    v_lshrrev_b32 v52, 2, v2
    v_and_b32 v53, 7, v52
    v_and_b32_e64 v55, 3, v2
    s_add_u32 m0, s84, 69632
    s_mov_b32 s100, 1114112
    buffer_load_dwordx4 v246, s[40:43], s100 offen  lds
    v_xor_b32 v53, v53, v55
    v_lshlrev_b32 v52, 7, v52
    v_lshrrev_b32_e64 v55, 1, v55
    s_add_u32 m0, s84, 73728
    s_mov_b32 s100, 1179648
    buffer_load_dwordx4 v246, s[40:43], s100 offen  lds
    v_lshl_add_u32 v52, v55, 3, v52
    s_lshr_b32 s78, s76, 1
    s_and_b32 s79, s76, 1
    s_lshl_b32 s80, s79, 2
    s_add_u32 m0, s84, 77824
    s_mov_b32 s100, 1245184
    buffer_load_dwordx4 v246, s[40:43], s100 offen  lds
    s_lshl_b32 s81, s78, 2
    v_xor_b32 v55, s80, v53
    v_xor_b32 v53, s81, v53
    s_add_u32 m0, s84, 81920
    s_mov_b32 s100, 1310720
    buffer_load_dwordx4 v246, s[40:43], s100 offen  lds
    s_lshl_b32 s80, s78, 14
    s_add_u32 s80, s80, 110592
    v_lshl_add_u32 v196, v55, 4, v52
    v_add_u32 v196, s80, v196
    s_add_u32 m0, s84, 86016
    s_mov_b32 s100, 1376256
    buffer_load_dwordx4 v246, s[40:43], s100 offen  lds
    v_lshl_add_u32 v198, v53, 4, v52
    v_add_u32 v198, 143360, v198
    v_xor_b32_e64 v197, 8, v196
    s_add_u32 m0, s84, 90112
    s_mov_b32 s100, 1441792
    buffer_load_dwordx4 v246, s[40:43], s100 offen  lds
    v_xor_b32_e64 v199, 8, v198
    v_mov_b32 v200, 0x3f803f80
    v_mov_b32 v201, 0x3f803f80
    v_mov_b32 v202, 0x3f803f80
    s_add_u32 m0, s84, 94208
    s_mov_b32 s100, 1507328
    buffer_load_dwordx4 v246, s[40:43], s100 offen  lds
    v_mov_b32 v203, 0x3f803f80
    v_lshrrev_b32 v62, 4, v2
    v_and_b32 v52, 15, v2
    s_add_u32 m0, s84, 98304
    s_mov_b32 s100, 1572864
    buffer_load_dwordx4 v246, s[40:43], s100 offen  lds
    v_lshlrev_b32_e64 v53, 4, v52
    v_lshl_add_u32 v62, v62, 13, v53
    v_lshrrev_b32_e64 v52, 3, v52
    v_lshl_add_u32 v62, v52, 8, v62
    s_add_u32 m0, s84, 102400
    s_mov_b32 s100, 1638400
    buffer_load_dwordx4 v246, s[40:43], s100 offen  lds
    v_xor_b32 v63, 256, v62
    s_lshl_b32 s78, s70, 2
    s_add_u32 s78, s78, s76
    s_add_u32 m0, s84, 106496
    s_mov_b32 s100, 1703936
    buffer_load_dwordx4 v246, s[40:43], s100 offen  lds
    s_lshl_b32 s78, s78, 15
    s_lshl_b32 s79, s69, 9
    s_add_u32 s78, s78, s79
    s_add_u32 s78, s78, 2097152
    s_mov_b32 s100, 2031616
    buffer_load_dwordx4 v[160:163], v246, s[40:43], s100 offen
    s_lshl_b32 s79, s77, 10
    s_lshl_b32 s80, s76, 6
    s_add_u32 s79, s79, s80
    s_mov_b32 s100, 1966080
    buffer_load_dwordx4 v[164:167], v246, s[40:43], s100 offen
    s_add_u32 s79, s79, 8389120
    v_lshrrev_b32 v52, 3, v2
    v_and_b32 v53, 7, v2
    v_lshlrev_b32_e64 v53, 4, v53
    s_mov_b32 s100, 1900544
    buffer_load_dwordx4 v[168:171], v246, s[40:43], s100 offen
    v_lshl_add_u32 v56, v52, 9, v53
    v_lshl_add_u32 v57, v52, 1, v53
    s_lshl_b32 s82, s70, 14
    s_mov_b32 s100, 1835008
    buffer_load_dwordx4 v[172:175], v246, s[40:43], s100 offen
    s_add_u32 s82, s82, s80
    s_add_u32 s82, s82, 8389120
    s_add_u32 s80, s80, 162944
    v_lshrrev_b32_e64 v58, 2, v2
    s_mov_b32 s100, 1769472
    buffer_load_dwordx4 v[176:179], v246, s[40:43], s100 offen
    v_and_b32 v53, 3, v2
    v_lshlrev_b32 v53, 4, v53
    v_lshl_add_u32 v58, v58, 10, v53
    s_mov_b32 s100, 0
    buffer_load_dwordx4 v[180:183], v247, s[28:31], s100 offen
    v_lshl_add_u32 v59, v52, 1, v53
    v_add_u32 v59, s80, v59
    s_lshl_b32 s64, s77, 13
    s_lshl_b32 s80, s76, 7
    s_mov_b32 s100, 16384
    buffer_load_dwordx4 v[184:187], v248, s[28:31], s100 offen
    s_add_u32 s64, s64, s80
    s_add_u32 s64, s64, 2097152
    s_add_u32 s65, s64, 4096
    s_mov_b32 s100, 32768
    buffer_load_dwordx4 v[188:191], v247, s[28:31], s100 offen
    s_lshl_b32 s81, s77, 10
    s_add_u32 s81, s81, s80
    s_add_u32 s81, s81, 8388608
    s_lshl_b32 s80, s71, 9
    s_mov_b32 s100, 49152
    buffer_load_dwordx4 v[192:195], v248, s[28:31], s100 offen
    s_add_u32 s80, s80, 8912896
    v_lshl_add_u32 v61, v2, 13, s80
    v_mov_b32 v52, 163584
    s_lshl_b32 s100, s77, 13
    s_add_u32 s100, s100, s89
    s_add_u32 s100, s100, 2097152
    buffer_load_dwordx4 v[252:255], v14, s[36:39], s100 offen offset:0 sc1
    ds_read_b32 v52, v52
    s_waitcnt lgkmcnt(0)
    v_readfirstlane_b32 s99, v52
    s_and_b32 s94, s69, 1
    s_lshl_b32 s100, s77, 13
    s_add_u32 s100, s100, s89
    s_nop 0
    s_add_u32 s100, s100, 2097152
    buffer_load_dwordx4 v[252:255], v14, s[36:39], s100 offen offset:1024 sc1
    s_mul_i32 s94, s94, 0x00010001
    s_mov_b32 s95, 0xfffefffe
    s_and_b32 s96, s75, 0x00010001
    buffer_load_dwordx4 v[252:255], v14, s[36:39], s66 offen sc1
    v_mov_b32_e64 v54, s96
    s_and_b32 s83, s75, 1
    s_lshl_b32 s83, s83, 16
    s_sub_u32 s83, 0, s83
    s_barrier
    ds_read_b64_tr_b16 v[4:5], v196 offset:0
    ds_read_b64_tr_b16 v[6:7], v196 offset:2048
    ds_read_b64_tr_b16 v[12:13], v198 offset:0
    ds_read_b64_tr_b16 v[14:15], v198 offset:2048
    ds_read_b64_tr_b16 v[8:9], v197 offset:0
    ds_read_b64_tr_b16 v[10:11], v197 offset:2048
    ds_read_b64_tr_b16 v[16:17], v199 offset:0
    ds_read_b64_tr_b16 v[18:19], v199 offset:2048
    ds_read_b64_tr_b16 v[20:21], v196 offset:4096
    ds_read_b64_tr_b16 v[22:23], v196 offset:6144
    ds_read_b64_tr_b16 v[28:29], v198 offset:4096
    ds_read_b64_tr_b16 v[30:31], v198 offset:6144
    ds_read_b64_tr_b16 v[24:25], v197 offset:4096
    ds_read_b64_tr_b16 v[26:27], v197 offset:6144
    s_waitcnt lgkmcnt(10)
    v_mfma_f32_16x16x32_bf16 v[204:207], v[4:7], v[12:15], 0
    ds_read_b64_tr_b16 v[32:33], v199 offset:4096
    ds_read_b64_tr_b16 v[34:35], v199 offset:6144
    s_waitcnt lgkmcnt(10)
    v_mfma_f32_16x16x32_bf16 v[208:211], v[8:11], v[12:15], 0
    ds_read_b64_tr_b16 v[36:37], v196 offset:8192
    ds_read_b64_tr_b16 v[38:39], v196 offset:10240
    s_waitcnt lgkmcnt(10)
    s_nop 0
    v_mfma_f32_16x16x32_bf16 v[216:219], v[8:11], v[16:19], 0
    ds_read_b64_tr_b16 v[44:45], v198 offset:8192
    ds_read_b64_tr_b16 v[46:47], v198 offset:10240
    v_mfma_f32_16x16x32_bf16 v[212:215], v[4:7], v[16:19], 0
    ds_read_b64_tr_b16 v[40:41], v197 offset:8192
    ds_read_b64_tr_b16 v[42:43], v197 offset:10240
    s_waitcnt lgkmcnt(10)
    v_mfma_f32_16x16x32_bf16 v[204:207], v[20:23], v[28:31], v[204:207]
    ds_read_b64_tr_b16 v[48:49], v199 offset:8192
    ds_read_b64_tr_b16 v[50:51], v199 offset:10240
    s_waitcnt lgkmcnt(10)
    v_mfma_f32_16x16x32_bf16 v[208:211], v[24:27], v[28:31], v[208:211]
    ds_read_b64_tr_b16 v[228:229], v196 offset:12288
    ds_read_b64_tr_b16 v[230:231], v196 offset:14336
    s_waitcnt lgkmcnt(10)
    s_nop 0
    v_mfma_f32_16x16x32_bf16 v[216:219], v[24:27], v[32:35], v[216:219]
    ds_read_b64_tr_b16 v[236:237], v198 offset:12288
    ds_read_b64_tr_b16 v[238:239], v198 offset:14336
    v_mfma_f32_16x16x32_bf16 v[212:215], v[20:23], v[32:35], v[212:215]
    ds_read_b64_tr_b16 v[232:233], v197 offset:12288
    ds_read_b64_tr_b16 v[234:235], v197 offset:14336
    s_waitcnt lgkmcnt(10)
    v_mfma_f32_16x16x32_bf16 v[204:207], v[36:39], v[44:47], v[204:207]
    ds_read_b64_tr_b16 v[240:241], v199 offset:12288
    ds_read_b64_tr_b16 v[242:243], v199 offset:14336
    s_waitcnt lgkmcnt(10)
    v_mfma_f32_16x16x32_bf16 v[208:211], v[40:43], v[44:47], v[208:211]
    s_waitcnt lgkmcnt(8)
    v_mfma_f32_16x16x32_bf16 v[216:219], v[40:43], v[48:51], v[216:219]
L_pad1:
    s_cbranch_execz L_pad5
    v_mfma_f32_16x16x32_bf16 v[212:215], v[36:39], v[48:51], v[212:215]
    s_waitcnt lgkmcnt(4)
    v_mfma_f32_16x16x32_bf16 v[204:207], v[228:231], v[236:239], v[204:207]
    s_waitcnt lgkmcnt(2)
    v_mfma_f32_16x16x32_bf16 v[208:211], v[232:235], v[236:239], v[208:211]
    s_waitcnt lgkmcnt(0)
    s_nop 0
    v_mfma_f32_16x16x32_bf16 v[216:219], v[232:235], v[240:243], v[216:219]
    v_mfma_f32_16x16x32_bf16 v[212:215], v[228:231], v[240:243], v[212:215]
    v_mfma_f32_16x16x32_bf16 v[220:223], v[4:7], v[200:203], 0
    v_mfma_f32_16x16x32_bf16 v[224:227], v[8:11], v[200:203], 0
    v_mfma_f32_16x16x32_bf16 v[220:223], v[20:23], v[200:203], v[220:223]
    v_mfma_f32_16x16x32_bf16 v[224:227], v[24:27], v[200:203], v[224:227]
    v_cvt_pk_bf16_f32 v12, v204, v205
    v_cvt_pk_bf16_f32 v13, v206, v207
    v_cvt_pk_bf16_f32 v14, v208, v209
    v_cvt_pk_bf16_f32 v15, v210, v211
    v_mfma_f32_16x16x32_bf16 v[220:223], v[36:39], v[200:203], v[220:223]
    v_add_u32_e64 v12, s94, v12
    v_and_or_b32 v12, v12, s95, v54
    v_mfma_f32_16x16x32_bf16 v[224:227], v[40:43], v[200:203], v[224:227]
    v_add_u32_e64 v13, s94, v13
    v_and_or_b32 v13, v13, s95, v54
    v_mfma_f32_16x16x32_bf16 v[220:223], v[228:231], v[200:203], v[220:223]
    v_add_u32_e64 v14, s94, v14
    v_and_or_b32 v14, v14, s95, v54
    v_mfma_f32_16x16x32_bf16 v[224:227], v[232:235], v[200:203], v[224:227]
    v_add_u32_e64 v15, s94, v15
    v_and_or_b32 v15, v15, s95, v54
    s_bitcmp1_b32 s99, 0
    s_cbranch_scc0 Lls_19
    buffer_store_dwordx4 v[12:15], v62, s[36:39], s78 offen
Lle_20:
    v_cvt_pk_bf16_f32 v28, v212, v213
    v_cvt_pk_bf16_f32 v29, v214, v215
    v_cvt_pk_bf16_f32 v30, v216, v217
    v_cvt_pk_bf16_f32 v31, v218, v219
    v_add_u32_e64 v28, s94, v28
    v_and_or_b32 v28, v28, s95, v54
    v_add_u32_e64 v29, s94, v29
    v_and_or_b32 v29, v29, s95, v54
    v_add_u32_e64 v30, s94, v30
    v_and_or_b32 v30, v30, s95, v54
    v_add_u32_e64 v31, s94, v31
    v_and_or_b32 v31, v31, s95, v54
    s_bitcmp1_b32 s99, 0
    s_cbranch_scc0 Lls_21
    buffer_store_dwordx4 v[28:31], v63, s[36:39], s78 offen
Lle_22:
    v_cvt_pk_bf16_f32 v44, v220, v221
    v_cvt_pk_bf16_f32 v45, v222, v223
    v_cvt_pk_bf16_f32 v46, v224, v225
    v_cvt_pk_bf16_f32 v47, v226, v227
    s_mov_b32 exec_lo, 0x00010001
    s_mov_b32 exec_hi, 0x00010001
    s_bitcmp1_b32 s99, 0
    s_cbranch_scc0 Lls_23
    buffer_store_dwordx4 v[44:47], v2, s[36:39], s79 offen
Lle_24:
    s_mov_b64 exec, -1
    s_mov_b32 s85, 0
Lspin_25:
    buffer_load_dwordx4 v[20:23], v56, s[36:39], s64 offen sc1
    buffer_load_dwordx4 v[24:27], v56, s[36:39], s65 offen sc1
    buffer_load_dwordx4 v[16:19], v58, s[36:39], s82 offen sc1
    s_add_u32 s85, s85, 1
    s_cmp_gt_u32 s85, 400000
    s_cbranch_scc1 L_end
    s_waitcnt vmcnt(0)
    s_nop 0
    v_bitop3_b32 v28, v20, v24, v54 bitop3:0x7e
    v_bitop3_b32 v29, v21, v25, v54 bitop3:0x7e
    v_bitop3_b32 v30, v22, v26, v54 bitop3:0x7e
    v_bitop3_b32 v31, v23, v27, v54 bitop3:0x7e
    v_or3_b32 v28, v28, v29, v30
    v_cmp_eq_u32 s[90:91], -1, v16
    v_or_b32_e64 v28, v28, v31
    v_and_b32 v28, 0x00010001, v28
    v_cmp_ne_u32_e64 vcc, 0, v28
    s_or_b64 vcc, vcc, s[90:91]
    s_cbranch_vccnz Lspin_25
    v_lshl_add_u32 v28, v20, 16, s83
    v_and_b32 v29, 0xfffe0000, v20
    v_lshl_add_u32 v36, v24, 16, s83
    v_and_b32 v37, 0xfffe0000, v24
    v_pk_add_f32 v[28:29], v[28:29], v[36:37]
    v_lshl_add_u32 v30, v21, 16, s83
    v_and_b32 v31, 0xfffe0000, v21
    v_lshl_add_u32 v38, v25, 16, s83
    v_and_b32 v39, 0xfffe0000, v25
    v_pk_add_f32 v[30:31], v[30:31], v[38:39]
    v_lshl_add_u32 v32, v22, 16, s83
    v_and_b32 v33, 0xfffe0000, v22
    v_lshl_add_u32 v40, v26, 16, s83
    v_and_b32 v41, 0xfffe0000, v26
    v_pk_add_f32 v[32:33], v[32:33], v[40:41]
    v_lshl_add_u32 v34, v23, 16, s83
    v_and_b32 v35, 0xfffe0000, v23
    v_lshl_add_u32 v42, v27, 16, s83
    v_and_b32 v43, 0xfffe0000, v27
    v_pk_add_f32 v[34:35], v[34:35], v[42:43]
    v_permlane32_swap_b32 v28, v32
    v_permlane32_swap_b32 v29, v33
    v_permlane32_swap_b32 v30, v34
    v_permlane32_swap_b32 v31, v35
    v_pk_add_f32 v[28:29], v[28:29], v[32:33]
    v_pk_add_f32 v[30:31], v[30:31], v[34:35]
    s_nop 1
    v_permlane16_swap_b32 v28, v30
    v_permlane16_swap_b32_e64 v29, v31
    v_pk_add_f32 v[28:29], v[28:29], v[30:31]
    s_nop 1
    v_add_f32_dpp v28, v28, v28 row_ror:8 row_mask:0xf bank_mask:0xf
    v_add_f32_dpp v29, v29, v29 row_ror:8 row_mask:0xf bank_mask:0xf
    v_cvt_pk_bf16_f32 v36, v28, v29
    s_mov_b32 exec_lo, 0x00ff00ff
    s_mov_b32 exec_hi, 0x00ff00ff
    s_bitcmp1_b32 s99, 0
    s_cbranch_scc0 Lls_26
    buffer_store_dword v36, v57, s[36:39], s81 offen
Lle_27:
    s_mov_b64 exec, -1
    v_lshlrev_b32_e64 v28, 16, v16
    v_and_b32 v29, 0xffff0000, v16
    v_lshlrev_b32_e64 v30, 16, v17
    v_and_b32 v31, 0xffff0000, v17
    v_lshlrev_b32_e64 v32, 16, v18
    v_and_b32 v33, 0xffff0000, v18
    v_lshlrev_b32_e64 v34, 16, v19
    v_and_b32 v35, 0xffff0000, v19
    v_permlane32_swap_b32 v28, v32
    v_permlane32_swap_b32 v29, v33
    v_permlane32_swap_b32 v30, v34
    v_permlane32_swap_b32 v31, v35
    v_pk_add_f32 v[28:29], v[28:29], v[32:33]
    v_pk_add_f32 v[30:31], v[30:31], v[34:35]
    s_nop 1
    v_permlane16_swap_b32 v28, v30
    v_permlane16_swap_b32_e64 v29, v31
    v_pk_add_f32 v[28:29], v[28:29], v[30:31]
    s_nop 1
    v_add_f32_dpp v38, v28, v28 row_ror:8 row_mask:0xf bank_mask:0x3
    s_nop 1
    v_add_f32_dpp v38, v29, v29 row_ror:8 row_mask:0xf bank_mask:0xc
    s_nop 1
    v_add_f32_dpp v37, v38, v38 row_shr:4 row_mask:0xf bank_mask:0xf
    v_cvt_pk_bf16_f32 v37, v37, v37
    s_mov_b32 exec_lo, 0xf0f0f0f0
    s_mov_b32 exec_hi, 0xf0f0f0f0
    ds_write_b16 v59, v37
    s_mov_b64 exec, -1
    s_waitcnt lgkmcnt(0)
    s_barrier
    v_lshlrev_b32 v4, 4, v2
    s_lshl_b32 s78, s76, 10
    s_add_u32 s78, s78, 110592
    v_add_u32 v5, s78, v4
    s_lshl_b32 s78, s76, 12
    s_add_u32 s78, s78, 131072
    v_add_u32 v6, s78, v4
    s_lshl_b32 s100, s77, 9
    s_add_u32 s100, s100, 8912896
    v_mov_b32 v48, s75
    v_mov_b32 v49, s75
    v_lshl_add_u32 v50, v2, 3, s100
    s_lshl_b32 s83, s71, 4
    s_add_u32 s83, s83, s72
    s_lshl_b32 s78, s77, 13
    s_and_b32 s79, s76, 1
    s_lshl_b32 s79, s79, 10
    s_add_u32 s78, s78, s79
    s_add_u32 s78, s78, 2099200
    s_mul_i32 s79, s74, 56
    s_add_u32 s79, s79, s73
    s_lshl_b32 s79, s79, 10
    s_add_u32 s79, s79, 1114112
    s_cmp_eq_u32 s76, 1
    s_cselect_b32 s78, s79, s78
    s_cmp_ge_u32 s73, 56
    s_cselect_b32 s78, 0x10000000, s78
    s_lshl_b32 s79, s83, 11
    s_add_u32 s79, s79, s84
    s_add_u32 s79, s79, 1572864
    s_cmp_lt_u32 s76, 2
    s_cselect_b32 s94, s79, s78
    s_lshl_b32 s79, s83, 9
    s_add_u32 s79, s79, 524288
    s_cmp_eq_u32 s76, 0
    s_cselect_b32 s78, s79, s78
    s_cselect_b32 s79, 0, -1
    v_mov_b32 v56, -1
    v_mov_b32 v57, -1
    v_mov_b32 v58, -1
    v_mov_b32_e64 v59, -1
    s_barrier
    s_mov_b32 s100, 43008
    buffer_load_dwordx4 v[88:91], v244, s[48:51], s100 offen nt
    s_mov_b32 s100, 43008
    buffer_load_dwordx4 v[120:123], v244, s[52:55], s100 offen nt
    s_mov_b32 s100, 50176
    buffer_load_dwordx4 v[92:95], v244, s[48:51], s100 offen nt
    s_mov_b32 s100, 50176
    buffer_load_dwordx4 v[124:127], v244, s[52:55], s100 offen nt
    ds_write_b128 v6, v[180:183] offset:0
    ds_write_b128 v6, v[184:187] offset:1024
    ds_write_b128 v6, v[188:191] offset:2048
    ds_write_b128 v6, v[192:195] offset:3072
    ds_write_b128 v5, v[160:163] offset:16384
    ds_write_b128 v5, v[164:167] offset:12288
    ds_write_b128 v5, v[168:171] offset:8192
    ds_write_b128 v5, v[172:175] offset:4096
    ds_write_b128 v5, v[176:179] offset:0
    s_waitcnt lgkmcnt(0)
    s_barrier
    s_cmp_lg_u32 s76, 0
    s_cbranch_scc1 Lfs_28
    buffer_store_dwordx2 v[48:49], v50, s[36:39], 0 offen sc1
Lfs_28:
    s_and_b32 s100, s76, 2
    s_and_b32 s101, s99, 1
    s_lshl_b32 s100, s100, s101
    s_and_b32 s100, s100, 4
    s_or_b32 s99, s99, s100
    s_mov_b32 exec_hi, s79
    s_bitcmp1_b32 s99, 2
    s_cbranch_scc0 Lls_29
    buffer_store_dwordx4 v[56:59], v4, s[36:39], s78 offen
Lle_30:
    s_mov_b32 exec_hi, -1
    s_mov_b32 s100, 0x05040100
    s_mov_b32 s101, 0x07060302
    v_perm_b32 v7, v68, v64, s100
    v_perm_b32 v68, v68, v64, s101
    v_mov_b32 v64, v7
    v_perm_b32 v7, v69, v65, s100
    v_perm_b32 v69, v69, v65, s101
    v_mov_b32_e64 v65, v7
    v_perm_b32 v7, v70, v66, s100
    v_perm_b32 v70, v70, v66, s101
    v_mov_b32_e64 v66, v7
    v_perm_b32 v7, v71, v67, s100
    v_perm_b32 v71, v71, v67, s101
    v_mov_b32_e64 v67, v7
    v_perm_b32 v7, v100, v96, s100
    v_perm_b32 v100, v100, v96, s101
    v_mov_b32_e64 v96, v7
    v_perm_b32 v7, v101, v97, s100
    v_perm_b32 v101, v101, v97, s101
    v_mov_b32_e64 v97, v7
    v_perm_b32 v7, v102, v98, s100
    v_perm_b32 v102, v102, v98, s101
    v_mov_b32_e64 v98, v7
    v_perm_b32 v7, v103, v99, s100
    v_perm_b32 v103, v103, v99, s101
    v_mov_b32_e64 v99, v7
    v_perm_b32 v7, v76, v72, s100
    v_perm_b32 v76, v76, v72, s101
    v_mov_b32_e64 v72, v7
    v_perm_b32 v7, v77, v73, s100
    v_perm_b32 v77, v77, v73, s101
    v_mov_b32_e64 v73, v7
    v_perm_b32 v7, v78, v74, s100
    v_perm_b32 v78, v78, v74, s101
    v_mov_b32_e64 v74, v7
    v_perm_b32 v7, v79, v75, s100
    v_perm_b32 v79, v79, v75, s101
    v_mov_b32_e64 v75, v7
    v_perm_b32 v7, v108, v104, s100
    v_perm_b32 v108, v108, v104, s101
    v_mov_b32_e64 v104, v7
    v_perm_b32 v7, v109, v105, s100
    v_perm_b32 v109, v109, v105, s101
    v_mov_b32_e64 v105, v7
    v_perm_b32 v7, v110, v106, s100
    v_perm_b32 v110, v110, v106, s101
    v_mov_b32_e64 v106, v7
    v_perm_b32 v7, v111, v107, s100
    v_perm_b32 v111, v111, v107, s101
    v_mov_b32_e64 v107, v7
    v_perm_b32 v7, v84, v80, s100
    v_perm_b32 v84, v84, v80, s101
    v_mov_b32_e64 v80, v7
    v_perm_b32 v7, v85, v81, s100
    v_perm_b32 v85, v85, v81, s101
    v_mov_b32_e64 v81, v7
    v_perm_b32 v7, v86, v82, s100
    v_perm_b32 v86, v86, v82, s101
    v_mov_b32_e64 v82, v7
    v_perm_b32 v7, v87, v83, s100
    v_perm_b32 v87, v87, v83, s101
    v_mov_b32_e64 v83, v7
    v_perm_b32 v7, v116, v112, s100
    v_perm_b32 v116, v116, v112, s101
    v_mov_b32_e64 v112, v7
    v_perm_b32 v7, v117, v113, s100
    v_perm_b32 v117, v117, v113, s101
    v_mov_b32_e64 v113, v7
    v_perm_b32 v7, v118, v114, s100
    v_perm_b32 v118, v118, v114, s101
    v_mov_b32_e64 v114, v7
    v_perm_b32 v7, v119, v115, s100
    v_perm_b32 v119, v119, v115, s101
    v_mov_b32_e64 v115, v7
    s_cmp_lg_u32 s76, 2
    s_cbranch_scc1 Lf2_31
    s_mov_b64 exec, 0xffff
L_pad2:
    s_cbranch_execz L_pad6
    s_mov_b32 s101, 0
    s_mov_b32 s85, 0
Lspin_32:
    buffer_load_dword v52, v61, s[36:39], s101 offen sc1
    s_add_u32 s101, s101, 128
    s_min_u32 s101, s101, 384
    s_add_u32 s85, s85, 1
    s_cmp_gt_u32 s85, 400000
    s_cbranch_scc1 L_end
    s_waitcnt vmcnt(0)
    v_cmp_ne_u32_e64 vcc, s75, v52
    s_cbranch_vccnz Lspin_32
    s_mov_b64 exec, -1
Lf2_31:
    s_barrier
    s_waitcnt vmcnt(0)
    s_mov_b32 s100, 0x05040100
    s_mov_b32 s101, 0x07060302
    v_perm_b32 v7, v92, v88, s100
    v_perm_b32 v92, v92, v88, s101
    v_mov_b32_e64 v88, v7
    v_perm_b32 v7, v93, v89, s100
    v_perm_b32 v93, v93, v89, s101
    v_mov_b32_e64 v89, v7
    v_perm_b32 v7, v94, v90, s100
    v_perm_b32 v94, v94, v90, s101
    v_mov_b32_e64 v90, v7
    v_perm_b32 v7, v95, v91, s100
    v_perm_b32 v95, v95, v91, s101
    v_mov_b32_e64 v91, v7
    v_perm_b32 v7, v124, v120, s100
    v_perm_b32 v124, v124, v120, s101
    v_mov_b32_e64 v120, v7
    v_perm_b32 v7, v125, v121, s100
    v_perm_b32 v125, v125, v121, s101
    v_mov_b32_e64 v121, v7
    v_perm_b32 v7, v126, v122, s100
    v_perm_b32 v126, v126, v122, s101
    v_mov_b32_e64 v122, v7
    v_perm_b32 v7, v127, v123, s100
    v_perm_b32 v127, v127, v123, s101
    v_mov_b32 v123, v7
    v_lshrrev_b32 v8, 3, v2
    v_and_b32 v9, 7, v2
    v_lshlrev_b32 v10, 4, v9
    v_lshl_add_u32 v11, v8, 13, v10
    v_and_b32 v12, 15, v2
    v_lshlrev_b32 v12, 13, v12
    v_and_b32_e64 v13, 3, v8
    v_lshl_add_u32 v13, v13, 9, v10
    v_lshrrev_b32_e64 v15, 2, v8
    v_lshl_add_u32 v13, v15, 13, v13
    v_lshl_add_u32 v14, v9, 3, v8
    s_lshl_b32 s80, s74, 2
    s_add_u32 s80, s80, s76
    s_lshl_b32 s78, s80, 9
    s_add_u32 s78, s78, 524288
    s_add_u32 s79, s78, 65536
    s_add_u32 s81, s73, s76
    s_and_b32 s81, s81, 3
    s_andn2_b32 s100, s73, 3
    s_or_b32 s81, s81, s100
    s_and_b32 s81, s81, 3
    s_lshl_b32 s81, s81, 2
    s_add_u32 s81, s81, s74
    s_lshl_b32 s81, s81, 13
    s_lshl_b32 s80, s76, 9
    s_add_u32 s80, s80, s81
    s_lshl_b32 s81, s70, 17
    s_add_u32 s81, s81, 2099200
    s_add_u32 s80, s80, s81
    s_and_b32 s100, s73, 3
    s_lshl_b32 s100, s100, 15
    s_add_u32 s81, s81, s100
    v_add_u32 v47, 0x10000, v11
    v_and_b32_e64 v53, 1, v54
    s_lshl_b32 s64, s76, 7
    s_add_u32 s64, s64, s81
    s_add_u32 s65, s64, 16384
    v_lshrrev_b32_e64 v50, 5, v2
    v_lshl_add_u32 v50, v9, 1, v50
    s_lshl_b32 s82, s76, 5
    s_add_u32 s82, s82, 163456
    v_lshl_add_u32 v50, v50, 1, s82
    v_lshlrev_b32 v27, 4, v8
    v_add_u32 v51, 163456, v27
    v_lshlrev_b32 v49, 2, v14
    v_lshlrev_b32 v15, 3, v14
    v_mov_b32 v26, 163360
    s_mul_i32 s66, s74, 56
    s_add_u32 s66, s66, s73
    s_lshl_b32 s66, s66, 10
    s_lshl_b32 s82, s76, 8
    s_add_u32 s66, s66, s82
    s_add_u32 s66, s66, 1114112
    s_barrier
    s_mov_b32 s100, 0
    s_nop 0
    buffer_load_dwordx4 v[128:131], v245, s[56:59], s100 offen nt
    s_mov_b32 s100, 2048
    buffer_load_dwordx4 v[132:135], v245, s[56:59], s100 offen nt
    s_mov_b32 s100, 4096
    buffer_load_dwordx4 v[136:139], v245, s[56:59], s100 offen nt
    s_mov_b32 s100, 6144
    buffer_load_dwordx4 v[140:143], v245, s[56:59], s100 offen nt
    s_mov_b32 s100, 8192
    buffer_load_dwordx4 v[144:147], v245, s[56:59], s100 offen nt
    s_barrier
    s_waitcnt vmcnt(0)
    s_mov_b32 s100, 0x05040100
    s_mov_b32 s101, 0x07060302
    v_perm_b32 v7, v132, v128, s100
    v_perm_b32 v132, v132, v128, s101
    v_mov_b32_e64 v128, v7
    v_perm_b32 v7, v133, v129, s100
    v_perm_b32 v133, v133, v129, s101
    v_mov_b32_e64 v129, v7
    v_perm_b32 v7, v134, v130, s100
    v_perm_b32 v134, v134, v130, s101
    v_mov_b32_e64 v130, v7
    v_perm_b32 v7, v135, v131, s100
    v_perm_b32 v135, v135, v131, s101
    v_mov_b32_e64 v131, v7
    v_perm_b32 v7, v140, v136, s100
    v_perm_b32 v140, v140, v136, s101
    v_mov_b32_e64 v136, v7
    v_perm_b32 v7, v141, v137, s100
    v_perm_b32 v141, v141, v137, s101
    v_mov_b32_e64 v137, v7
    v_perm_b32 v7, v142, v138, s100
    v_perm_b32 v142, v142, v138, s101
    v_mov_b32_e64 v138, v7
    v_perm_b32 v7, v143, v139, s100
    v_perm_b32 v143, v143, v139, s101
    v_mov_b32 v139, v7
    s_barrier
    s_mov_b32 s100, 10240
    buffer_load_dwordx4 v[148:151], v245, s[56:59], s100 offen nt
    s_mov_b32 s100, 12288
    buffer_load_dwordx4 v[152:155], v245, s[56:59], s100 offen nt
    s_mov_b32 s100, 14336
    buffer_load_dwordx4 v[156:159], v245, s[56:59], s100 offen nt
    s_and_b32 s79, s2, 7
    s_lshl_b32 s79, s79, 9
    s_add_u32 s79, s79, 524288
    s_mov_b64 exec, 0xffff
    s_sleep 20
    s_mov_b32 s85, 0
Lspin_33:
    buffer_load_dwordx2 v[24:25], v12, s[36:39], s79 offen offset:128 sc1
    s_or_b32 s79, s79, 4096
    s_add_u32 s85, s85, 1
    s_cmp_gt_u32 s85, 400000
    s_cbranch_scc1 L_end
    s_waitcnt vmcnt(0)
    v_cmp_ne_u32_e64 vcc, s75, v25
    s_cbranch_vccnz Lspin_33
    v_max_f32_dpp v24, v24, v24 row_ror:8 row_mask:0xf bank_mask:0xf
    s_nop 1
    v_max_f32_dpp v24, v24, v24 row_ror:4 row_mask:0xf bank_mask:0xf
    s_nop 1
    v_max_f32_dpp v24, v24, v24 row_ror:2 row_mask:0xf bank_mask:0xf
    s_nop 1
    v_max_f32_dpp v24, v24, v24 row_ror:1 row_mask:0xf bank_mask:0xf
    s_nop 0
    v_readfirstlane_b32 s97, v24
    s_mov_b64 exec, -1
    s_nop 0
    v_mov_b32 v24, s97
    s_cmp_ge_u32 s73, 56
    s_cbranch_scc1 L_red
    s_bfe_u32 s79, s97, 0x40007
    s_lshl_b32 s79, s79, 13
    s_add_u32 s78, s78, s79
    buffer_load_dwordx4 v[20:23], v27, s[36:39], s78 offen sc1
    ds_write_b32 v26, v24
    s_mov_b32 s85, 1
    s_mov_b32 s100, 0x05040100
    s_mov_b32 s101, 0x07060302
    v_perm_b32 v7, v148, v144, s100
    v_perm_b32 v148, v148, v144, s101
    v_mov_b32 v144, v7
    v_perm_b32 v7, v149, v145, s100
    v_perm_b32 v149, v149, v145, s101
    v_mov_b32_e64 v145, v7
    v_perm_b32 v7, v150, v146, s100
    v_perm_b32 v150, v150, v146, s101
    v_mov_b32_e64 v146, v7
    v_perm_b32 v7, v151, v147, s100
    v_perm_b32 v151, v151, v147, s101
    v_mov_b32_e64 v147, v7
    v_perm_b32 v7, v156, v152, s100
    v_perm_b32 v156, v156, v152, s101
    v_mov_b32_e64 v152, v7
    v_perm_b32 v7, v157, v153, s100
    v_perm_b32 v157, v157, v153, s101
    v_mov_b32_e64 v153, v7
    v_perm_b32 v7, v158, v154, s100
    v_perm_b32 v158, v158, v154, s101
    v_mov_b32_e64 v154, v7
    v_perm_b32 v7, v159, v155, s100
    v_perm_b32 v159, v159, v155, s101
    v_mov_b32 v155, v7
Lb_35:
    s_waitcnt vmcnt(0) lgkmcnt(0)
    v_max3_u32 v16, v20, v21, v22
    v_max_u32 v16, v16, v23
    v_cmp_eq_u32_e64 vcc, -1, v16
    s_cbranch_vccnz Lspin_34
    v_dot2_f32_bf16 v28, v64, v20, 0
    v_dot2_f32_bf16 v29, v68, v20, 0
    v_dot2_f32_bf16 v30, v65, v20, 0
    v_dot2_f32_bf16 v31, v69, v20, 0
    v_dot2_f32_bf16 v32, v66, v20, 0
    v_dot2_f32_bf16 v33, v70, v20, 0
    v_dot2_f32_bf16 v34, v67, v20, 0
    v_dot2_f32_bf16 v35, v71, v20, 0
    v_dot2_f32_bf16 v28, v72, v21, v28
    v_dot2_f32_bf16 v29, v76, v21, v29
    v_dot2_f32_bf16 v30, v73, v21, v30
    v_dot2_f32_bf16 v31, v77, v21, v31
    v_dot2_f32_bf16 v32, v74, v21, v32
    v_dot2_f32_bf16 v33, v78, v21, v33
    v_dot2_f32_bf16 v34, v75, v21, v34
    v_dot2_f32_bf16 v35, v79, v21, v35
    v_dot2_f32_bf16 v28, v80, v22, v28
    v_dot2_f32_bf16 v29, v84, v22, v29
    v_dot2_f32_bf16 v30, v81, v22, v30
    v_dot2_f32_bf16 v31, v85, v22, v31
    v_dot2_f32_bf16 v32, v82, v22, v32
    v_dot2_f32_bf16 v33, v86, v22, v33
    v_dot2_f32_bf16 v34, v83, v22, v34
    v_dot2_f32_bf16 v35, v87, v22, v35
    v_dot2_f32_bf16 v28, v88, v23, v28
    v_dot2_f32_bf16 v29, v92, v23, v29
    v_dot2_f32_bf16 v30, v89, v23, v30
    v_dot2_f32_bf16 v31, v93, v23, v31
    v_dot2_f32_bf16 v32, v90, v23, v32
    v_dot2_f32_bf16 v33, v94, v23, v33
    v_dot2_f32_bf16 v34, v91, v23, v34
    v_dot2_f32_bf16 v35, v95, v23, v35
    v_dot2_f32_bf16 v36, v96, v20, 0
    v_dot2_f32_bf16 v37, v100, v20, 0
    v_dot2_f32_bf16 v38, v97, v20, 0
    v_dot2_f32_bf16 v39, v101, v20, 0
    v_dot2_f32_bf16 v40, v98, v20, 0
    v_dot2_f32_bf16 v41, v102, v20, 0
    v_dot2_f32_bf16 v42, v99, v20, 0
    v_dot2_f32_bf16 v43, v103, v20, 0
    v_dot2_f32_bf16 v36, v104, v21, v36
    v_dot2_f32_bf16 v37, v108, v21, v37
    v_dot2_f32_bf16 v38, v105, v21, v38
    v_dot2_f32_bf16 v39, v109, v21, v39
    v_dot2_f32_bf16 v40, v106, v21, v40
    v_dot2_f32_bf16 v41, v110, v21, v41
    v_dot2_f32_bf16 v42, v107, v21, v42
    v_dot2_f32_bf16 v43, v111, v21, v43
    v_dot2_f32_bf16 v36, v112, v22, v36
    v_dot2_f32_bf16 v37, v116, v22, v37
    v_dot2_f32_bf16 v38, v113, v22, v38
    v_dot2_f32_bf16 v39, v117, v22, v39
    v_dot2_f32_bf16 v40, v114, v22, v40
    v_dot2_f32_bf16 v41, v118, v22, v41
    v_dot2_f32_bf16 v42, v115, v22, v42
    v_dot2_f32_bf16 v43, v119, v22, v43
    v_dot2_f32_bf16 v36, v120, v23, v36
    v_dot2_f32_bf16 v37, v124, v23, v37
    v_dot2_f32_bf16 v38, v121, v23, v38
    v_dot2_f32_bf16 v39, v125, v23, v39
    v_dot2_f32_bf16 v40, v122, v23, v40
    v_dot2_f32_bf16 v41, v126, v23, v41
    v_dot2_f32_bf16 v42, v123, v23, v42
    v_dot2_f32_bf16 v43, v127, v23, v43
    v_permlane32_swap_b32 v28, v32
    v_permlane32_swap_b32 v29, v33
    v_permlane32_swap_b32 v30, v34
    v_permlane32_swap_b32 v31, v35
    v_permlane32_swap_b32 v36, v40
    v_permlane32_swap_b32 v37, v41
    v_permlane32_swap_b32 v38, v42
    v_permlane32_swap_b32 v39, v43
    v_pk_add_f32 v[28:29], v[28:29], v[32:33]
    v_pk_add_f32 v[30:31], v[30:31], v[34:35]
    v_pk_add_f32 v[36:37], v[36:37], v[40:41]
    v_pk_add_f32 v[38:39], v[38:39], v[42:43]
    v_permlane16_swap_b32 v28, v30
    v_permlane16_swap_b32 v29, v31
    v_permlane16_swap_b32 v36, v38
    v_permlane16_swap_b32 v37, v39
    v_pk_add_f32 v[28:29], v[28:29], v[30:31]
    v_pk_add_f32 v[36:37], v[36:37], v[38:39]
    s_nop 0
    v_add_f32_dpp v44, v28, v28 row_ror:8 row_mask:0xf bank_mask:0x3
    v_add_f32_dpp v45, v36, v36 row_ror:8 row_mask:0xf bank_mask:0x3
    s_nop 0
    v_add_f32_dpp v44, v29, v29 row_ror:8 row_mask:0xf bank_mask:0xc
    v_add_f32_dpp v45, v37, v37 row_ror:8 row_mask:0xf bank_mask:0xc
    v_and_or_b32 v44, v44, -2, v53
    s_bitcmp1_b32 s99, 0
    s_cbranch_scc0 Lls_36
    buffer_store_dwordx2 v[44:45], v15, s[36:39], s80 offen
Lle_37:
    s_mov_b32 s95, s80
    s_barrier
    s_mov_b32 s85, 0
Lspin_38:
    buffer_load_dwordx4 v[16:19], v13, s[36:39], s64 offen sc1
    buffer_load_dwordx4 v[20:23], v13, s[36:39], s65 offen sc1
    s_add_u32 s85, s85, 1
    s_cmp_gt_u32 s85, 400000
L_pad3:
    s_cbranch_execz L_pad7
    s_cbranch_scc1 L_end
    s_waitcnt vmcnt(0)
    v_max3_u32 v25, v16, v18, v20
    v_max_u32 v25, v25, v22
    v_cmp_eq_u32 vcc, -1, v25
    s_cbranch_vccnz Lspin_38
    v_and_b32 v16, -2, v16
    v_and_b32 v18, -2, v18
    v_and_b32 v20, -2, v20
    v_and_b32 v22, -2, v22
    v_pk_add_f32 v[16:17], v[16:17], v[20:21]
    v_pk_add_f32 v[18:19], v[18:19], v[22:23]
    s_nop 1
    v_permlane32_swap_b32 v16, v18
    v_permlane32_swap_b32_e64 v17, v19
    v_pk_add_f32 v[16:17], v[16:17], v[18:19]
    v_mov_b32 v18, v16
    v_mov_b32 v19, v17
    s_nop 0
    v_permlane16_swap_b32 v16, v18
    v_permlane16_swap_b32_e64 v17, v19
    v_pk_add_f32 v[16:17], v[16:17], v[18:19]
    s_nop 1
    v_add_f32_dpp v16, v16, v16 row_ror:8 row_mask:0xf bank_mask:0xf
    v_add_f32_dpp v17, v17, v17 row_ror:8 row_mask:0xf bank_mask:0xf
    v_cvt_pk_bf16_f32 v17, v16, v17
    v_lshlrev_b32 v16, 16, v17
    v_mul_f32 v18, 0xbfb8aa3b, v16
    v_exp_f32_e64 v18, v18
    v_and_b32 v17, 0xffff0000, v17
    v_add_f32 v18, 1.0, v18
    v_rcp_f32 v18, v18
    s_nop 0
    v_mul_f32 v16, v16, v18
    v_cvt_pk_bf16_f32 v16, v16, v16
    v_and_b32 v16, 0xffff0000, v16
    v_mul_f32_e64 v16, v16, v17
    v_cvt_pk_bf16_f32 v16, v16, v16
    ds_write_b16 v50, v16
    s_waitcnt lgkmcnt(0)
    s_barrier
    ds_read_b128 v[20:23], v51
    s_waitcnt lgkmcnt(0)
    s_nop 0
    v_dot2_f32_bf16 v28, v128, v20, 0
    v_dot2_f32_bf16 v29, v132, v20, 0
    v_dot2_f32_bf16 v30, v129, v20, 0
    v_dot2_f32_bf16 v31, v133, v20, 0
    v_dot2_f32_bf16 v32, v130, v20, 0
    v_dot2_f32_bf16 v33, v134, v20, 0
    v_dot2_f32_bf16 v34, v131, v20, 0
    v_dot2_f32_bf16 v35, v135, v20, 0
    v_dot2_f32_bf16 v28, v136, v21, v28
    v_dot2_f32_bf16 v29, v140, v21, v29
    v_dot2_f32_bf16 v30, v137, v21, v30
    v_dot2_f32_bf16 v31, v141, v21, v31
    v_dot2_f32_bf16 v32, v138, v21, v32
    v_dot2_f32_bf16 v33, v142, v21, v33
    v_dot2_f32_bf16 v34, v139, v21, v34
    v_dot2_f32_bf16 v35, v143, v21, v35
    v_dot2_f32_bf16 v28, v144, v22, v28
    v_dot2_f32_bf16 v29, v148, v22, v29
    v_dot2_f32_bf16 v30, v145, v22, v30
    v_dot2_f32_bf16 v31, v149, v22, v31
    v_dot2_f32_bf16 v32, v146, v22, v32
    v_dot2_f32_bf16 v33, v150, v22, v33
    v_dot2_f32_bf16 v34, v147, v22, v34
    v_dot2_f32_bf16 v35, v151, v22, v35
    v_dot2_f32_bf16 v28, v152, v23, v28
    v_dot2_f32_bf16 v29, v156, v23, v29
    v_dot2_f32_bf16 v30, v153, v23, v30
    v_dot2_f32_bf16 v31, v157, v23, v31
    v_dot2_f32_bf16 v32, v154, v23, v32
    v_dot2_f32_bf16 v33, v158, v23, v33
    v_dot2_f32_bf16 v34, v155, v23, v34
    v_dot2_f32_bf16 v35, v159, v23, v35
    v_permlane32_swap_b32 v28, v32
    v_permlane32_swap_b32 v29, v33
    v_permlane32_swap_b32 v30, v34
    v_permlane32_swap_b32 v31, v35
    v_pk_add_f32 v[28:29], v[28:29], v[32:33]
    v_pk_add_f32 v[30:31], v[30:31], v[34:35]
    s_nop 1
    v_permlane16_swap_b32 v28, v30
    v_permlane16_swap_b32_e64 v29, v31
    v_pk_add_f32 v[28:29], v[28:29], v[30:31]
    s_nop 1
    v_add_f32_dpp v46, v28, v28 row_ror:8 row_mask:0xf bank_mask:0x3
    s_nop 1
    v_add_f32_dpp v46, v29, v29 row_ror:8 row_mask:0xf bank_mask:0xc
    buffer_store_dword v46, v49, s[36:39], s66 offen sc1
    s_barrier
    s_branch L_fin
L_red:
    v_mov_b32 v26, 163360
    ds_write_b32 v26, v24
    s_waitcnt lgkmcnt(0)
    s_barrier
    s_barrier
    s_barrier
    s_cmp_lg_u32 s76, 0
    s_cbranch_scc1 L_fin
    s_sub_u32 s83, s0, 224
    v_lshrrev_b32_e64 v14, 4, v2
    v_lshl_add_u32 v14, v9, 2, v14
    v_lshlrev_b32 v15, 2, v14
    v_lshlrev_b32 v14, 1, v14
    s_bfe_u32 s78, s97, 0x40007
    s_lshl_b32 s78, s78, 13
    s_lshr_b32 s79, s83, 1
    s_lshl_b32 s79, s79, 9
    s_add_u32 s78, s78, s79
    s_and_b32 s79, s83, 1
    s_lshl_b32 s79, s79, 7
    s_add_u32 s78, s78, s79
    s_add_u32 s78, s78, 524544
    s_mov_b32 s85, 0
Lspin_39:
    buffer_load_dword v46, v15, s[36:39], s78 offen sc1
    s_add_u32 s85, s85, 1
    s_cmp_gt_u32 s85, 400000
    s_cbranch_scc1 L_end
    s_waitcnt vmcnt(0)
    v_cmp_eq_u32_e64 vcc, -1, v46
    s_cbranch_vccnz Lspin_39
    v_cvt_pk_bf16_f32 v47, v24, v24
    v_and_b32 v47, 0xffff0000, v47
    v_mul_f32 v47, 0xbfb8aa3b, v47
    v_exp_f32 v47, v47
    s_nop 0
    v_add_f32 v47, 1.0, v47
    v_rcp_f32_e64 v47, v47
    s_nop 0
    v_cvt_pk_bf16_f32 v47, v47, v47
    v_and_b32 v47, 0xffff0000, v47
    v_lshl_add_u32 v13, v8, 10, v10
    s_lshr_b32 s78, s83, 3
    s_mul_i32 s78, s78, 57344
    s_and_b32 s79, s83, 7
    s_lshl_b32 s79, s79, 7
    s_add_u32 s78, s78, s79
    s_add_u32 s78, s78, 1114112
    s_and_b32 s80, s97, 0x7ff
    s_lshl_b32 s80, s80, 11
    s_lshl_b32 s79, s83, 6
    s_add_u32 s80, s80, s79
    s_sleep 30
    s_mov_b32 s85, 0
Lspin_40:
    s_add_u32 s79, s78, 0
    buffer_load_dwordx4 v[16:19], v13, s[36:39], s79 offen sc1
    s_add_u32 s79, s78, 8192
    buffer_load_dwordx4 v[20:23], v13, s[36:39], s79 offen sc1
    s_add_u32 s79, s78, 16384
    buffer_load_dwordx4 v[24:27], v13, s[36:39], s79 offen sc1
    s_add_u32 s79, s78, 24576
    buffer_load_dwordx4 v[28:31], v13, s[36:39], s79 offen sc1
    s_add_u32 s79, s78, 32768
    buffer_load_dwordx4 v[32:35], v13, s[36:39], s79 offen sc1
    s_add_u32 s79, s78, 40960
    buffer_load_dwordx4 v[36:39], v13, s[36:39], s79 offen sc1
    s_add_u32 s79, s78, 49152
    buffer_load_dwordx4 v[40:43], v13, s[36:39], s79 offen sc1
    s_add_u32 s85, s85, 1
    s_cmp_gt_u32 s85, 400000
    s_cbranch_scc1 L_end
    s_waitcnt vmcnt(0)
    v_max_u32 v48, v16, v17
    v_max_u32_e64 v49, v18, v19
    v_max3_u32 v48, v48, v20, v21
    v_max3_u32 v49, v49, v22, v23
    v_max3_u32 v48, v48, v24, v25
    v_max3_u32 v49, v49, v26, v27
    v_max3_u32 v48, v48, v28, v29
    v_max3_u32 v49, v49, v30, v31
    v_max3_u32 v48, v48, v32, v33
    v_max3_u32 v49, v49, v34, v35
    v_max3_u32 v48, v48, v36, v37
    v_max3_u32 v49, v49, v38, v39
    v_max3_u32 v48, v48, v40, v41
    v_max3_u32 v49, v49, v42, v43
    v_max_u32 v48, v48, v49
    v_cmp_eq_u32_e64 vcc, -1, v48
    s_cbranch_vccnz Lspin_40
    v_pk_add_f32 v[16:17], v[16:17], v[20:21]
    v_pk_add_f32 v[24:25], v[24:25], v[28:29]
    v_pk_add_f32 v[32:33], v[32:33], v[36:37]
    v_pk_add_f32 v[16:17], v[16:17], v[24:25]
    v_pk_add_f32 v[32:33], v[32:33], v[40:41]
    v_pk_add_f32 v[16:17], v[16:17], v[32:33]
    v_pk_add_f32 v[18:19], v[18:19], v[22:23]
    v_pk_add_f32 v[26:27], v[26:27], v[30:31]
    v_pk_add_f32 v[34:35], v[34:35], v[38:39]
    v_pk_add_f32 v[18:19], v[18:19], v[26:27]
    v_pk_add_f32 v[34:35], v[34:35], v[42:43]
    v_pk_add_f32 v[18:19], v[18:19], v[34:35]
    s_nop 1
    v_permlane32_swap_b32 v16, v18
    v_permlane32_swap_b32_e64 v17, v19
    v_pk_add_f32 v[16:17], v[16:17], v[18:19]
    s_nop 1
    v_permlane16_swap_b32 v16, v17
    v_add_f32 v16, v16, v17
    s_nop 1
    v_add_f32_dpp v16, v16, v16 row_ror:8 row_mask:0xf bank_mask:0xf
    v_cvt_pk_bf16_f32 v16, v16, v16
    v_and_b32 v16, 0xffff0000, v16
    v_mul_f32_e64 v16, v16, v47
    v_cvt_pk_bf16_f32 v16, v16, v16
    v_and_b32 v16, 0xffff0000, v16
    v_add_f32_e64 v16, v16, v46
    v_cvt_pk_bf16_f32 v16, v16, v16
    s_mov_b32 exec_lo, 0x00ff00ff
    s_mov_b32 exec_hi, 0x00ff00ff
    buffer_store_short v16, v14, s[44:47], s80 offen
    s_mov_b64 exec, -1
    s_cmp_lg_u32 s0, 224
    s_cbranch_scc1 Lep_41
    s_cmp_lg_u32 s76, 0
    s_cbranch_scc1 Lep_41
    v_mov_b32 v196, s75
    v_mov_b32_e64 v197, 0
    s_mov_b64 exec, 1
    buffer_store_dword v196, v197, s[36:39], 0 offen sc1
    s_mov_b64 exec, -1
Lep_41:
    s_branch L_fin
L_pad4:
    s_cbranch_execz L_pad8
    s_endpgm
Lspin_18:
    buffer_load_dwordx2 v[10:11], v8, s[36:39], 0 offen sc1
    s_add_u32 s85, s85, 1
    s_cmp_gt_u32 s85, 400000
    s_cbranch_scc1 L_end
    s_waitcnt vmcnt(0)
    s_branch Lpk_17
Lls_19:
    buffer_store_dwordx4 v[12:15], v62, s[36:39], s78 offen sc1
    s_nop 1
    s_branch Lle_20
Lls_21:
    buffer_store_dwordx4 v[28:31], v63, s[36:39], s78 offen sc1
    s_nop 1
    s_branch Lle_22
Lls_23:
    buffer_store_dwordx4 v[44:47], v2, s[36:39], s79 offen sc1
    s_nop 1
    s_branch Lle_24
Lls_26:
    buffer_store_dword v36, v57, s[36:39], s81 offen sc1
    s_nop 1
    s_branch Lle_27
Lls_29:
    buffer_store_dwordx4 v[56:59], v4, s[36:39], s78 offen sc1
    s_nop 1
    s_branch Lle_30
Lspin_34:
    buffer_load_dwordx4 v[20:23], v27, s[36:39], s78 offen sc1
    s_add_u32 s85, s85, 1
    s_cmp_gt_u32 s85, 400000
    s_cbranch_scc1 L_end
    s_branch Lb_35
Lls_36:
    buffer_store_dwordx2 v[44:45], v15, s[36:39], s80 offen sc1
    s_nop 1
    s_branch Lle_37
L_padret:
    s_setpc_b64 s[12:13]
    .p2align 3
L_M:
    s_getpc_b64 s[90:91]
L_mpc:
    s_sub_u32 s90, s90, L_mpc-L_sube
    s_subb_u32 s91, s91, 0
    s_lshr_b32 s78, s2, 3
    s_lshl_b32 s78, s78, 10
    s_lshl_b32 s79, s76, 8
    s_add_u32 s78, s78, s79
    s_min_u32 s78, s78, (L_end-L_sube)
    v_lshl_add_u32 v119, v2, 2, s78
    global_load_dword v119, v119, s[90:91]
    s_setprio 1
    s_and_b32 s78, s2, 7
    s_lshr_b32 s79, s2, 3
    s_lshl_b32 s71, s78, 1
    s_and_b32 s72, s79, 1
    s_add_u32 s71, s71, s72
    s_lshr_b32 s72, s79, 1
    s_cmp_gt_u32 s70, 3
    s_cselect_b32 s78, 1, 0
    s_cmp_gt_u32 s70, 11
    s_cselect_b32 s78, 2, s78
    s_sub_u32 s78, s70, s78
    s_cmp_eq_u32 s70, 3
    s_cselect_b32 s78, 14, s78
    s_cmp_eq_u32 s70, 11
    s_cselect_b32 s78, 15, s78
    s_lshl_b32 s0, s78, 4
    s_add_u32 s0, s0, s69
    s_lshr_b32 s73, s0, 2
    s_and_b32 s74, s0, 3
    s_lshl_b32 s77, s70, 4
    s_add_u32 s77, s77, s69
    s_and_b32 s80, s76, 1
    s_lshr_b32 s81, s76, 1
    v_and_b32 v8, 15, v2
    v_lshrrev_b32 v9, 4, v2
    v_lshrrev_b32 v10, 1, v8
    s_lshl_b32 s78, s80, 13
    s_add_u32 s78, s78, 118784
    v_lshlrev_b32 v11, 7, v8
    v_add_u32 v11, s78, v11
    v_add_u32 v12, 0, v9
    v_xor_b32 v12, v12, v10
    v_lshl_add_u32 v4, v12, 4, v11
    v_add_u32 v12, 4, v9
    v_xor_b32 v12, v12, v10
    v_lshl_add_u32 v5, v12, 4, v11
    v_bfe_u32 v10, v2, 2, 2
    v_and_b32_e64 v11, 3, v2
    v_lshl_add_u32 v12, v9, 3, v10
    v_lshlrev_b32_e64 v12, 7, v12
    v_lshl_add_u32 v12, v11, 3, v12
    v_add_u32 v12, 135168, v12
    v_lshrrev_b32 v13, 1, v10
    v_and_b32 v14, 1, v9
    v_lshl_add_u32 v13, v14, 1, v13
    s_lshl_b32 s78, s81, 1
    s_add_u32 s79, s78, 0
    v_xor_b32_e64 v14, s79, v13
    v_lshl_add_u32 v6, v14, 5, v12
    s_add_u32 s79, s78, 1
    v_xor_b32 v14, s79, v13
    v_lshl_add_u32 v7, v14, 5, v12
    v_lshrrev_b32_e64 v13, 5, v2
    v_lshl_add_u32 v13, v13, 3, v10
    v_lshlrev_b32 v13, 6, v13
    v_and_b32 v14, 1, v9
    v_lshl_add_u32 v13, v14, 5, v13
    v_lshl_add_u32 v13, v11, 3, v13
    s_lshl_b32 s78, s81, 11
    s_add_u32 s78, s78, 159744
    v_add_u32 v15, s78, v13
    v_mov_b64 v[128:129], 0
    v_mov_b64 v[130:131], 0
    v_mov_b64 v[132:133], 0
    v_mov_b64 v[134:135], 0
    v_mov_b64 v[136:137], 0
    v_mov_b64 v[138:139], 0
    v_mov_b64 v[140:141], 0
    v_mov_b64 v[142:143], 0
    v_mov_b64 v[144:145], 0
    v_mov_b64 v[146:147], 0
    v_mov_b64 v[148:149], 0
    v_mov_b64 v[150:151], 0
    v_mov_b64 v[152:153], 0
    v_mov_b64 v[154:155], 0
    v_mov_b64 v[156:157], 0
    v_mov_b64 v[158:159], 0
    v_mov_b64 v[160:161], 0
    v_mov_b64 v[162:163], 0
L_pad5:
    s_cbranch_execz L_pad9
    v_mov_b64 v[164:165], 0
    v_mov_b64 v[166:167], 0
    v_mov_b64 v[168:169], 0
    v_mov_b64 v[170:171], 0
    v_mov_b64 v[172:173], 0
    v_mov_b64 v[174:175], 0
    v_mov_b64 v[176:177], 0
    v_mov_b64 v[178:179], 0
    v_mov_b64 v[180:181], 0
    v_mov_b64 v[182:183], 0
    v_mov_b64 v[184:185], 0
    v_mov_b64 v[186:187], 0
    v_mov_b64 v[188:189], 0
    v_mov_b64 v[190:191], 0
    v_mov_b64 v[192:193], 0
    v_mov_b64 v[194:195], 0
    v_mov_b64 v[196:197], 0
    v_mov_b64 v[198:199], 0
    v_mov_b64 v[200:201], 0
    v_mov_b64 v[202:203], 0
    v_mov_b64 v[204:205], 0
    v_mov_b64 v[206:207], 0
    v_mov_b64 v[208:209], 0
    v_mov_b64 v[210:211], 0
    v_mov_b64 v[212:213], 0
    v_mov_b64 v[214:215], 0
    v_mov_b64 v[216:217], 0
    v_mov_b64 v[218:219], 0
    v_mov_b64 v[220:221], 0
    v_mov_b64 v[222:223], 0
    v_mov_b64 v[104:105], 0
    v_mov_b64 v[106:107], 0
    v_mov_b64 v[108:109], 0
    v_mov_b64 v[110:111], 0
    v_and_b32 v14, 31, v2
    v_lshrrev_b32 v13, 5, v2
    s_lshl_b32 s78, s81, 14
    s_lshl_b32 s79, s80, 13
    s_add_u32 s78, s78, s79
    s_add_u32 s78, s78, 110592
    v_lshl_add_u32 v12, v14, 7, s78
    v_and_b32 v14, 7, v14
    v_xor_b32 v14, v14, v13
    v_xor_b32_e64 v13, 0, v14
    v_lshl_add_u32 v112, v13, 4, v12
    v_xor_b32_e64 v13, 2, v14
    v_lshl_add_u32 v113, v13, 4, v12
    v_xor_b32_e64 v13, 4, v14
    v_lshl_add_u32 v114, v13, 4, v12
    v_xor_b32_e64 v13, 6, v14
    v_lshl_add_u32 v115, v13, 4, v12
    s_add_u32 s79, s79, 143360
    v_lshl_add_u32 v12, v8, 7, s79
    s_lshl_b32 s78, s81, 2
    v_add_u32 v14, s78, v9
    v_and_b32 v13, 7, v8
    v_xor_b32 v14, v14, v13
    v_lshl_add_u32 v116, v14, 4, v12
    s_lshl_b32 s78, s80, 6
    v_add_u32 v10, s78, v8
    v_lshlrev_b32_e64 v11, 3, v10
    v_add_u32 v11, 159744, v11
    s_lshl_b32 s79, s81, 5
    v_add_u32 v12, s79, v8
    v_lshlrev_b32_e64 v12, 3, v12
    v_add_u32 v12, 160768, v12
    v_lshlrev_b32_e64 v13, 2, v10
    v_add_u32 v13, 162304, v13
    v_and_b32 v14, 31, v2
    v_add_u32 v14, s78, v14
    v_lshlrev_b32_e64 v14, 2, v14
    v_add_u32 v14, 162304, v14
    s_waitcnt lgkmcnt(0)
    s_load_dword s75, s[26:27], 0
    s_getpc_b64 s[12:13]
Lpr_42:
    s_add_u32 s12, s12, L_end-Lpr_42
    s_addc_u32 s13, s13, 0
    s_mov_b32 s36, s26
    s_and_b32 s37, s27, 0xffff
    s_mov_b32 s38, 0x10000000
    s_mov_b32 s39, 0x20000
    s_mov_b32 s64, s14
    s_and_b32 s65, s15, 0xffff
    s_mov_b32 s66, 0x800
    s_mov_b32 s67, 0x20000
    s_mov_b32 s44, s22
    s_and_b32 s45, s23, 0xffff
    s_mov_b32 s46, 0x400000
    s_mov_b32 s47, 0x20000
    s_lshl_b32 s78, s72, 7
    buffer_load_dword v118, off, s[64:67], s78
    s_waitcnt lgkmcnt(0)
    s_mul_i32 s75, s75, 0x9E3779B1
    s_add_u32 s75, s75, 0x7F4A7C15
    s_mov_b32 s84, 0
    s_mov_b32 s82, 2
    s_mov_b32 s83, 0xfffec000
    s_barrier
    s_nop 0
    ds_read_b128 v[16:19], v4 offset:0
    ds_read_b64_tr_b16 v[40:41], v6 offset:8192
    ds_read_b64_tr_b16 v[42:43], v6 offset:8704
    ds_read_b128 v[20:23], v4 offset:2048
    ds_read_b128 v[24:27], v4 offset:4096
    ds_read_b128 v[28:31], v4 offset:6144
    ds_read_b64_tr_b16 v[44:45], v7 offset:8192
    ds_read_b64_tr_b16 v[46:47], v7 offset:8704
    ds_read_b64_tr_b16 v[48:49], v6 offset:16384
    ds_read_b64_tr_b16 v[50:51], v6 offset:16896
    ds_read_b64_tr_b16 v[52:53], v7 offset:16384
    ds_read_b64_tr_b16 v[54:55], v7 offset:16896
    ds_read_b64_tr_b16 v[32:33], v6 offset:0
    ds_read_b64_tr_b16 v[34:35], v6 offset:512
    ds_read_b64_tr_b16 v[36:37], v7 offset:0
    ds_read_b64_tr_b16 v[38:39], v7 offset:512
    ds_read_b64_tr_b16 v[96:97], v15 offset:0
    ds_read_b64_tr_b16 v[98:99], v15 offset:1024
    ds_read_b64_tr_b16 v[100:101], v15 offset:256
    ds_read_b64_tr_b16 v[102:103], v15 offset:1280
    s_waitcnt lgkmcnt(0)
    s_nop 0
    v_mfma_f32_16x16x32_bf16 v[160:163], v[40:43], v[16:19], v[160:163]
    v_mfma_f32_16x16x32_bf16 v[176:179], v[44:47], v[16:19], v[176:179]
    v_mfma_f32_16x16x32_bf16 v[180:183], v[44:47], v[20:23], v[180:183]
    v_mfma_f32_16x16x32_bf16 v[164:167], v[40:43], v[20:23], v[164:167]
    v_mfma_f32_16x16x32_bf16 v[168:171], v[40:43], v[24:27], v[168:171]
    v_mfma_f32_16x16x32_bf16 v[184:187], v[44:47], v[24:27], v[184:187]
    v_mfma_f32_16x16x32_bf16 v[188:191], v[44:47], v[28:31], v[188:191]
    v_mfma_f32_16x16x32_bf16 v[172:175], v[40:43], v[28:31], v[172:175]
    v_mfma_f32_16x16x32_bf16 v[204:207], v[48:51], v[28:31], v[204:207]
    v_mfma_f32_16x16x32_bf16 v[220:223], v[52:55], v[28:31], v[220:223]
    v_mfma_f32_16x16x32_bf16 v[216:219], v[52:55], v[24:27], v[216:219]
    v_mfma_f32_16x16x32_bf16 v[200:203], v[48:51], v[24:27], v[200:203]
    v_mfma_f32_16x16x32_bf16 v[196:199], v[48:51], v[20:23], v[196:199]
    v_mfma_f32_16x16x32_bf16 v[212:215], v[52:55], v[20:23], v[212:215]
    v_mfma_f32_16x16x32_bf16 v[208:211], v[52:55], v[16:19], v[208:211]
    v_mfma_f32_16x16x32_bf16 v[192:195], v[48:51], v[16:19], v[192:195]
    v_mfma_f32_16x16x32_bf16 v[128:131], v[32:35], v[16:19], v[128:131]
    v_mfma_f32_16x16x32_bf16 v[144:147], v[36:39], v[16:19], v[144:147]
    v_mfma_f32_16x16x32_bf16 v[148:151], v[36:39], v[20:23], v[148:151]
    v_mfma_f32_16x16x32_bf16 v[132:135], v[32:35], v[20:23], v[132:135]
    v_mfma_f32_16x16x32_bf16 v[136:139], v[32:35], v[24:27], v[136:139]
    v_mfma_f32_16x16x32_bf16 v[152:155], v[36:39], v[24:27], v[152:155]
    v_mfma_f32_16x16x32_bf16 v[156:159], v[36:39], v[28:31], v[156:159]
    v_mfma_f32_16x16x32_bf16 v[140:143], v[32:35], v[28:31], v[140:143]
    ds_read_b128 v[56:59], v5 offset:0
    ds_read_b64_tr_b16 v[80:81], v6 offset:12288
    ds_read_b64_tr_b16 v[82:83], v6 offset:12800
    ds_read_b128 v[60:63], v5 offset:2048
    ds_read_b128 v[64:67], v5 offset:4096
    ds_read_b128 v[68:71], v5 offset:6144
    ds_read_b64_tr_b16 v[84:85], v7 offset:12288
    ds_read_b64_tr_b16 v[86:87], v7 offset:12800
    ds_read_b64_tr_b16 v[88:89], v6 offset:20480
    ds_read_b64_tr_b16 v[90:91], v6 offset:20992
    ds_read_b64_tr_b16 v[92:93], v7 offset:20480
    ds_read_b64_tr_b16 v[94:95], v7 offset:20992
    ds_read_b64_tr_b16 v[72:73], v6 offset:4096
    ds_read_b64_tr_b16 v[74:75], v6 offset:4608
    ds_read_b64_tr_b16 v[76:77], v7 offset:4096
    ds_read_b64_tr_b16 v[78:79], v7 offset:4608
    s_add_u32 s84, s84, 1
    s_cmp_eq_u32 s82, 2
    s_cselect_b32 s78, s83, 40960
    s_cselect_b32 s82, -1, s82
    s_add_u32 s82, s82, 1
    v_add_u32 v4, s78, v4
    v_add_u32 v5, s78, v5
    v_add_u32 v6, s78, v6
    v_add_u32_e64 v7, s78, v7
    s_waitcnt vmcnt(0) lgkmcnt(0)
    v_mfma_f32_16x16x32_bf16 v[160:163], v[80:83], v[56:59], v[160:163]
    v_mfma_f32_16x16x32_bf16 v[176:179], v[84:87], v[56:59], v[176:179]
    v_mfma_f32_16x16x32_bf16 v[180:183], v[84:87], v[60:63], v[180:183]
    v_mfma_f32_16x16x32_bf16 v[164:167], v[80:83], v[60:63], v[164:167]
    v_mfma_f32_16x16x32_bf16 v[168:171], v[80:83], v[64:67], v[168:171]
    v_mfma_f32_16x16x32_bf16 v[184:187], v[84:87], v[64:67], v[184:187]
    v_mfma_f32_16x16x32_bf16 v[188:191], v[84:87], v[68:71], v[188:191]
    v_mfma_f32_16x16x32_bf16 v[172:175], v[80:83], v[68:71], v[172:175]
    v_mfma_f32_16x16x32_bf16 v[204:207], v[88:91], v[68:71], v[204:207]
    v_mfma_f32_16x16x32_bf16 v[220:223], v[92:95], v[68:71], v[220:223]
    v_mfma_f32_16x16x32_bf16 v[216:219], v[92:95], v[64:67], v[216:219]
    v_mfma_f32_16x16x32_bf16 v[200:203], v[88:91], v[64:67], v[200:203]
    v_mfma_f32_16x16x32_bf16 v[196:199], v[88:91], v[60:63], v[196:199]
    v_mfma_f32_16x16x32_bf16 v[212:215], v[92:95], v[60:63], v[212:215]
    v_mfma_f32_16x16x32_bf16 v[208:211], v[92:95], v[56:59], v[208:211]
    v_mfma_f32_16x16x32_bf16 v[192:195], v[88:91], v[56:59], v[192:195]
    v_mfma_f32_16x16x32_bf16 v[128:131], v[72:75], v[56:59], v[128:131]
    v_mfma_f32_16x16x32_bf16 v[144:147], v[76:79], v[56:59], v[144:147]
    v_mfma_f32_16x16x32_bf16 v[148:151], v[76:79], v[60:63], v[148:151]
    v_mfma_f32_16x16x32_bf16 v[132:135], v[72:75], v[60:63], v[132:135]
    v_mfma_f32_16x16x32_bf16 v[136:139], v[72:75], v[64:67], v[136:139]
    v_mfma_f32_16x16x32_bf16 v[152:155], v[76:79], v[64:67], v[152:155]
    v_mfma_f32_16x16x32_bf16 v[156:159], v[76:79], v[68:71], v[156:159]
    v_mfma_f32_16x16x32_bf16 v[140:143], v[72:75], v[68:71], v[140:143]
    s_barrier
    s_nop 0
    ds_read_b128 v[16:19], v4 offset:0
    ds_read_b64_tr_b16 v[40:41], v6 offset:8192
    ds_read_b64_tr_b16 v[42:43], v6 offset:8704
    ds_read_b128 v[20:23], v4 offset:2048
    ds_read_b128 v[24:27], v4 offset:4096
    ds_read_b128 v[28:31], v4 offset:6144
    ds_read_b64_tr_b16 v[44:45], v7 offset:8192
    ds_read_b64_tr_b16 v[46:47], v7 offset:8704
    ds_read_b64_tr_b16 v[48:49], v6 offset:16384
    ds_read_b64_tr_b16 v[50:51], v6 offset:16896
    ds_read_b64_tr_b16 v[52:53], v7 offset:16384
    ds_read_b64_tr_b16 v[54:55], v7 offset:16896
    ds_read_b64_tr_b16 v[32:33], v6 offset:0
    ds_read_b64_tr_b16 v[34:35], v6 offset:512
    ds_read_b64_tr_b16 v[36:37], v7 offset:0
    ds_read_b64_tr_b16 v[38:39], v7 offset:512
    s_waitcnt lgkmcnt(0)
    s_nop 0
    v_mfma_f32_16x16x32_bf16 v[160:163], v[40:43], v[16:19], v[160:163]
    v_mfma_f32_16x16x32_bf16 v[176:179], v[44:47], v[16:19], v[176:179]
    v_mfma_f32_16x16x32_bf16 v[180:183], v[44:47], v[20:23], v[180:183]
    v_mfma_f32_16x16x32_bf16 v[164:167], v[40:43], v[20:23], v[164:167]
    v_mfma_f32_16x16x32_bf16 v[168:171], v[40:43], v[24:27], v[168:171]
    v_mfma_f32_16x16x32_bf16 v[184:187], v[44:47], v[24:27], v[184:187]
    v_mfma_f32_16x16x32_bf16 v[188:191], v[44:47], v[28:31], v[188:191]
    v_mfma_f32_16x16x32_bf16 v[172:175], v[40:43], v[28:31], v[172:175]
    v_mfma_f32_16x16x32_bf16 v[204:207], v[48:51], v[28:31], v[204:207]
    v_mfma_f32_16x16x32_bf16 v[220:223], v[52:55], v[28:31], v[220:223]
    v_mfma_f32_16x16x32_bf16 v[216:219], v[52:55], v[24:27], v[216:219]
    v_mfma_f32_16x16x32_bf16 v[200:203], v[48:51], v[24:27], v[200:203]
    v_mfma_f32_16x16x32_bf16 v[196:199], v[48:51], v[20:23], v[196:199]
    v_mfma_f32_16x16x32_bf16 v[212:215], v[52:55], v[20:23], v[212:215]
    v_mfma_f32_16x16x32_bf16 v[208:211], v[52:55], v[16:19], v[208:211]
    v_mfma_f32_16x16x32_bf16 v[192:195], v[48:51], v[16:19], v[192:195]
    v_mfma_f32_16x16x32_bf16 v[128:131], v[32:35], v[16:19], v[128:131]
    v_mfma_f32_16x16x32_bf16 v[144:147], v[36:39], v[16:19], v[144:147]
    v_mfma_f32_16x16x32_bf16 v[148:151], v[36:39], v[20:23], v[148:151]
    v_mfma_f32_16x16x32_bf16 v[132:135], v[32:35], v[20:23], v[132:135]
    v_mfma_f32_16x16x32_bf16 v[136:139], v[32:35], v[24:27], v[136:139]
    v_mfma_f32_16x16x32_bf16 v[152:155], v[36:39], v[24:27], v[152:155]
    v_mfma_f32_16x16x32_bf16 v[156:159], v[36:39], v[28:31], v[156:159]
    v_mfma_f32_16x16x32_bf16 v[140:143], v[32:35], v[28:31], v[140:143]
    ds_read_b128 v[56:59], v5 offset:0
    ds_read_b64_tr_b16 v[80:81], v6 offset:12288
    ds_read_b64_tr_b16 v[82:83], v6 offset:12800
    ds_read_b128 v[60:63], v5 offset:2048
    ds_read_b128 v[64:67], v5 offset:4096
    ds_read_b128 v[68:71], v5 offset:6144
    ds_read_b64_tr_b16 v[84:85], v7 offset:12288
    ds_read_b64_tr_b16 v[86:87], v7 offset:12800
    ds_read_b64_tr_b16 v[88:89], v6 offset:20480
    ds_read_b64_tr_b16 v[90:91], v6 offset:20992
    ds_read_b64_tr_b16 v[92:93], v7 offset:20480
    ds_read_b64_tr_b16 v[94:95], v7 offset:20992
    ds_read_b64_tr_b16 v[72:73], v6 offset:4096
    ds_read_b64_tr_b16 v[74:75], v6 offset:4608
    ds_read_b64_tr_b16 v[76:77], v7 offset:4096
    ds_read_b64_tr_b16 v[78:79], v7 offset:4608
    s_add_u32 s84, s84, 1
    s_cmp_eq_u32 s82, 2
    s_cselect_b32 s78, s83, 40960
    s_cselect_b32 s82, -1, s82
    s_add_u32 s82, s82, 1
    v_add_u32 v4, s78, v4
    v_add_u32 v5, s78, v5
    v_add_u32 v6, s78, v6
    v_add_u32_e64 v7, s78, v7
    s_waitcnt vmcnt(0) lgkmcnt(0)
    v_mfma_f32_16x16x32_bf16 v[160:163], v[80:83], v[56:59], v[160:163]
    v_mfma_f32_16x16x32_bf16 v[176:179], v[84:87], v[56:59], v[176:179]
    v_mfma_f32_16x16x32_bf16 v[180:183], v[84:87], v[60:63], v[180:183]
    v_mfma_f32_16x16x32_bf16 v[164:167], v[80:83], v[60:63], v[164:167]
    v_mfma_f32_16x16x32_bf16 v[168:171], v[80:83], v[64:67], v[168:171]
    v_mfma_f32_16x16x32_bf16 v[184:187], v[84:87], v[64:67], v[184:187]
    v_mfma_f32_16x16x32_bf16 v[188:191], v[84:87], v[68:71], v[188:191]
    v_mfma_f32_16x16x32_bf16 v[172:175], v[80:83], v[68:71], v[172:175]
    v_mfma_f32_16x16x32_bf16 v[204:207], v[88:91], v[68:71], v[204:207]
    v_mfma_f32_16x16x32_bf16 v[220:223], v[92:95], v[68:71], v[220:223]
    v_mfma_f32_16x16x32_bf16 v[216:219], v[92:95], v[64:67], v[216:219]
    v_mfma_f32_16x16x32_bf16 v[200:203], v[88:91], v[64:67], v[200:203]
    v_mfma_f32_16x16x32_bf16 v[196:199], v[88:91], v[60:63], v[196:199]
    v_mfma_f32_16x16x32_bf16 v[212:215], v[92:95], v[60:63], v[212:215]
    v_mfma_f32_16x16x32_bf16 v[208:211], v[92:95], v[56:59], v[208:211]
    v_mfma_f32_16x16x32_bf16 v[192:195], v[88:91], v[56:59], v[192:195]
    v_mfma_f32_16x16x32_bf16 v[128:131], v[72:75], v[56:59], v[128:131]
    v_mfma_f32_16x16x32_bf16 v[144:147], v[76:79], v[56:59], v[144:147]
    v_mfma_f32_16x16x32_bf16 v[148:151], v[76:79], v[60:63], v[148:151]
    v_mfma_f32_16x16x32_bf16 v[132:135], v[72:75], v[60:63], v[132:135]
    v_mfma_f32_16x16x32_bf16 v[136:139], v[72:75], v[64:67], v[136:139]
    v_mfma_f32_16x16x32_bf16 v[152:155], v[76:79], v[64:67], v[152:155]
    v_mfma_f32_16x16x32_bf16 v[156:159], v[76:79], v[68:71], v[156:159]
    v_mfma_f32_16x16x32_bf16 v[140:143], v[72:75], v[68:71], v[140:143]
    s_mov_b64 exec, 0
    s_cmp_lg_u32 s76, 0
    s_cbranch_scc1 Lt_43
    s_call_b64 s[12:13], L_pad0
Lt_43:
    s_cmp_lg_u32 s76, 1
    s_cbranch_scc1 Lt_44
    s_call_b64 s[12:13], L_pad1
Lt_44:
    s_cmp_lg_u32 s76, 2
    s_cbranch_scc1 Lt_45
    s_call_b64 s[12:13], L_pad2
Lt_45:
    s_cmp_lg_u32 s76, 3
    s_cbranch_scc1 Lt_46
    s_call_b64 s[12:13], L_pad3
Lt_46:
    s_mov_b64 exec, -1
    s_barrier
    s_nop 0
    ds_read_b128 v[16:19], v4 offset:0
L_pad6:
    s_cbranch_execz L_pad10
    s_nop 0
    ds_read_b64_tr_b16 v[40:41], v6 offset:8192
    ds_read_b64_tr_b16 v[42:43], v6 offset:8704
    ds_read_b128 v[20:23], v4 offset:2048
    ds_read_b128 v[24:27], v4 offset:4096
    ds_read_b128 v[28:31], v4 offset:6144
    ds_read_b64_tr_b16 v[44:45], v7 offset:8192
    ds_read_b64_tr_b16 v[46:47], v7 offset:8704
    ds_read_b64_tr_b16 v[48:49], v6 offset:16384
    ds_read_b64_tr_b16 v[50:51], v6 offset:16896
    ds_read_b64_tr_b16 v[52:53], v7 offset:16384
    ds_read_b64_tr_b16 v[54:55], v7 offset:16896
    ds_read_b64_tr_b16 v[32:33], v6 offset:0
    ds_read_b64_tr_b16 v[34:35], v6 offset:512
    ds_read_b64_tr_b16 v[36:37], v7 offset:0
    ds_read_b64_tr_b16 v[38:39], v7 offset:512
    s_waitcnt lgkmcnt(0)
    s_nop 0
    v_mfma_f32_16x16x32_bf16 v[160:163], v[40:43], v[16:19], v[160:163]
    v_mfma_f32_16x16x32_bf16 v[176:179], v[44:47], v[16:19], v[176:179]
    v_mfma_f32_16x16x32_bf16 v[180:183], v[44:47], v[20:23], v[180:183]
    v_mfma_f32_16x16x32_bf16 v[164:167], v[40:43], v[20:23], v[164:167]
    v_mfma_f32_16x16x32_bf16 v[168:171], v[40:43], v[24:27], v[168:171]
    v_mfma_f32_16x16x32_bf16 v[184:187], v[44:47], v[24:27], v[184:187]
    v_mfma_f32_16x16x32_bf16 v[188:191], v[44:47], v[28:31], v[188:191]
    v_mfma_f32_16x16x32_bf16 v[172:175], v[40:43], v[28:31], v[172:175]
    v_mfma_f32_16x16x32_bf16 v[204:207], v[48:51], v[28:31], v[204:207]
    v_mfma_f32_16x16x32_bf16 v[220:223], v[52:55], v[28:31], v[220:223]
    v_mfma_f32_16x16x32_bf16 v[216:219], v[52:55], v[24:27], v[216:219]
    v_mfma_f32_16x16x32_bf16 v[200:203], v[48:51], v[24:27], v[200:203]
    v_mfma_f32_16x16x32_bf16 v[196:199], v[48:51], v[20:23], v[196:199]
    v_mfma_f32_16x16x32_bf16 v[212:215], v[52:55], v[20:23], v[212:215]
    v_mfma_f32_16x16x32_bf16 v[208:211], v[52:55], v[16:19], v[208:211]
    v_mfma_f32_16x16x32_bf16 v[192:195], v[48:51], v[16:19], v[192:195]
    v_mfma_f32_16x16x32_bf16 v[128:131], v[32:35], v[16:19], v[128:131]
    v_mfma_f32_16x16x32_bf16 v[144:147], v[36:39], v[16:19], v[144:147]
    v_mfma_f32_16x16x32_bf16 v[148:151], v[36:39], v[20:23], v[148:151]
    v_mfma_f32_16x16x32_bf16 v[132:135], v[32:35], v[20:23], v[132:135]
    v_mfma_f32_16x16x32_bf16 v[136:139], v[32:35], v[24:27], v[136:139]
    v_mfma_f32_16x16x32_bf16 v[152:155], v[36:39], v[24:27], v[152:155]
    v_mfma_f32_16x16x32_bf16 v[156:159], v[36:39], v[28:31], v[156:159]
    v_mfma_f32_16x16x32_bf16 v[140:143], v[32:35], v[28:31], v[140:143]
    ds_read_b128 v[56:59], v5 offset:0
    ds_read_b64_tr_b16 v[80:81], v6 offset:12288
    ds_read_b64_tr_b16 v[82:83], v6 offset:12800
    ds_read_b128 v[60:63], v5 offset:2048
    ds_read_b128 v[64:67], v5 offset:4096
    ds_read_b128 v[68:71], v5 offset:6144
    ds_read_b64_tr_b16 v[84:85], v7 offset:12288
    ds_read_b64_tr_b16 v[86:87], v7 offset:12800
    ds_read_b64_tr_b16 v[88:89], v6 offset:20480
    ds_read_b64_tr_b16 v[90:91], v6 offset:20992
    ds_read_b64_tr_b16 v[92:93], v7 offset:20480
    ds_read_b64_tr_b16 v[94:95], v7 offset:20992
    ds_read_b64_tr_b16 v[72:73], v6 offset:4096
    ds_read_b64_tr_b16 v[74:75], v6 offset:4608
    ds_read_b64_tr_b16 v[76:77], v7 offset:4096
    ds_read_b64_tr_b16 v[78:79], v7 offset:4608
    s_add_u32 s84, s84, 1
    s_cmp_eq_u32 s82, 2
    s_cselect_b32 s78, s83, 40960
    s_cselect_b32 s82, -1, s82
    s_add_u32 s82, s82, 1
    v_add_u32 v4, s78, v4
    v_add_u32 v5, s78, v5
    v_add_u32 v6, s78, v6
    v_add_u32_e64 v7, s78, v7
    s_waitcnt vmcnt(0) lgkmcnt(0)
    v_mfma_f32_16x16x32_bf16 v[160:163], v[80:83], v[56:59], v[160:163]
    v_mfma_f32_16x16x32_bf16 v[176:179], v[84:87], v[56:59], v[176:179]
    v_mfma_f32_16x16x32_bf16 v[180:183], v[84:87], v[60:63], v[180:183]
    v_mfma_f32_16x16x32_bf16 v[164:167], v[80:83], v[60:63], v[164:167]
    v_mfma_f32_16x16x32_bf16 v[168:171], v[80:83], v[64:67], v[168:171]
    v_mfma_f32_16x16x32_bf16 v[184:187], v[84:87], v[64:67], v[184:187]
    v_mfma_f32_16x16x32_bf16 v[188:191], v[84:87], v[68:71], v[188:191]
    v_mfma_f32_16x16x32_bf16 v[172:175], v[80:83], v[68:71], v[172:175]
    v_mfma_f32_16x16x32_bf16 v[204:207], v[88:91], v[68:71], v[204:207]
    v_mfma_f32_16x16x32_bf16 v[220:223], v[92:95], v[68:71], v[220:223]
    v_mfma_f32_16x16x32_bf16 v[216:219], v[92:95], v[64:67], v[216:219]
    v_mfma_f32_16x16x32_bf16 v[200:203], v[88:91], v[64:67], v[200:203]
    v_mfma_f32_16x16x32_bf16 v[196:199], v[88:91], v[60:63], v[196:199]
    v_mfma_f32_16x16x32_bf16 v[212:215], v[92:95], v[60:63], v[212:215]
    v_mfma_f32_16x16x32_bf16 v[208:211], v[92:95], v[56:59], v[208:211]
    v_mfma_f32_16x16x32_bf16 v[192:195], v[88:91], v[56:59], v[192:195]
    v_mfma_f32_16x16x32_bf16 v[128:131], v[72:75], v[56:59], v[128:131]
    v_mfma_f32_16x16x32_bf16 v[144:147], v[76:79], v[56:59], v[144:147]
    v_mfma_f32_16x16x32_bf16 v[148:151], v[76:79], v[60:63], v[148:151]
    v_mfma_f32_16x16x32_bf16 v[132:135], v[72:75], v[60:63], v[132:135]
    v_mfma_f32_16x16x32_bf16 v[136:139], v[72:75], v[64:67], v[136:139]
    v_mfma_f32_16x16x32_bf16 v[152:155], v[76:79], v[64:67], v[152:155]
    v_mfma_f32_16x16x32_bf16 v[156:159], v[76:79], v[68:71], v[156:159]
    v_mfma_f32_16x16x32_bf16 v[140:143], v[72:75], v[68:71], v[140:143]
    s_barrier
    s_nop 0
    ds_read_b128 v[16:19], v4 offset:0
    ds_read_b64_tr_b16 v[40:41], v6 offset:8192
    ds_read_b64_tr_b16 v[42:43], v6 offset:8704
    ds_read_b128 v[20:23], v4 offset:2048
    ds_read_b128 v[24:27], v4 offset:4096
    ds_read_b128 v[28:31], v4 offset:6144
    ds_read_b64_tr_b16 v[44:45], v7 offset:8192
    ds_read_b64_tr_b16 v[46:47], v7 offset:8704
    ds_read_b64_tr_b16 v[48:49], v6 offset:16384
    ds_read_b64_tr_b16 v[50:51], v6 offset:16896
    ds_read_b64_tr_b16 v[52:53], v7 offset:16384
    ds_read_b64_tr_b16 v[54:55], v7 offset:16896
    ds_read_b64_tr_b16 v[32:33], v6 offset:0
    ds_read_b64_tr_b16 v[34:35], v6 offset:512
    ds_read_b64_tr_b16 v[36:37], v7 offset:0
    ds_read_b64_tr_b16 v[38:39], v7 offset:512
    .p2align 3
L_Mloop:
    s_waitcnt lgkmcnt(0)
    s_nop 0
    v_mfma_f32_16x16x32_bf16 v[160:163], v[40:43], v[16:19], v[160:163]
    ds_read_b128 v[56:59], v5 offset:0
    v_mfma_f32_16x16x32_bf16 v[176:179], v[44:47], v[16:19], v[176:179]
    ds_read_b64_tr_b16 v[80:81], v6 offset:12288
    v_mfma_f32_16x16x32_bf16 v[180:183], v[44:47], v[20:23], v[180:183]
    ds_read_b64_tr_b16 v[82:83], v6 offset:12800
    v_mfma_f32_16x16x32_bf16 v[164:167], v[40:43], v[20:23], v[164:167]
    ds_read_b128 v[60:63], v5 offset:2048
    v_mfma_f32_16x16x32_bf16 v[168:171], v[40:43], v[24:27], v[168:171]
    ds_read_b128 v[64:67], v5 offset:4096
    v_mfma_f32_16x16x32_bf16 v[184:187], v[44:47], v[24:27], v[184:187]
    ds_read_b128 v[68:71], v5 offset:6144
    v_mfma_f32_16x16x32_bf16 v[188:191], v[44:47], v[28:31], v[188:191]
    ds_read_b64_tr_b16 v[84:85], v7 offset:12288
    v_mfma_f32_16x16x32_bf16 v[172:175], v[40:43], v[28:31], v[172:175]
    ds_read_b64_tr_b16 v[86:87], v7 offset:12800
    v_mfma_f32_16x16x32_bf16 v[204:207], v[48:51], v[28:31], v[204:207]
    ds_read_b64_tr_b16 v[88:89], v6 offset:20480
    v_mfma_f32_16x16x32_bf16 v[220:223], v[52:55], v[28:31], v[220:223]
    ds_read_b64_tr_b16 v[90:91], v6 offset:20992
    v_mfma_f32_16x16x32_bf16 v[216:219], v[52:55], v[24:27], v[216:219]
    ds_read_b64_tr_b16 v[92:93], v7 offset:20480
    v_mfma_f32_16x16x32_bf16 v[200:203], v[48:51], v[24:27], v[200:203]
    ds_read_b64_tr_b16 v[94:95], v7 offset:20992
    v_mfma_f32_16x16x32_bf16 v[196:199], v[48:51], v[20:23], v[196:199]
    ds_read_b64_tr_b16 v[72:73], v6 offset:4096
    v_mfma_f32_16x16x32_bf16 v[212:215], v[52:55], v[20:23], v[212:215]
    ds_read_b64_tr_b16 v[74:75], v6 offset:4608
    v_mfma_f32_16x16x32_bf16 v[208:211], v[52:55], v[16:19], v[208:211]
    ds_read_b64_tr_b16 v[76:77], v7 offset:4096
    v_mfma_f32_16x16x32_bf16 v[192:195], v[48:51], v[16:19], v[192:195]
    ds_read_b64_tr_b16 v[78:79], v7 offset:4608
    v_mfma_f32_16x16x32_bf16 v[128:131], v[32:35], v[16:19], v[128:131]
    s_add_u32 s84, s84, 1
    s_cmp_eq_u32 s82, 2
    s_cselect_b32 s78, s83, 40960
    s_cselect_b32 s82, -1, s82
    s_add_u32 s82, s82, 1
    v_mfma_f32_16x16x32_bf16 v[144:147], v[36:39], v[16:19], v[144:147]
    v_add_u32 v4, s78, v4
    v_add_u32 v5, s78, v5
    v_mfma_f32_16x16x32_bf16 v[148:151], v[36:39], v[20:23], v[148:151]
    v_add_u32 v6, s78, v6
    v_add_u32 v7, s78, v7
    v_mfma_f32_16x16x32_bf16 v[132:135], v[32:35], v[20:23], v[132:135]
    v_mfma_f32_16x16x32_bf16 v[136:139], v[32:35], v[24:27], v[136:139]
    v_mfma_f32_16x16x32_bf16 v[152:155], v[36:39], v[24:27], v[152:155]
    v_mfma_f32_16x16x32_bf16 v[156:159], v[36:39], v[28:31], v[156:159]
    v_mfma_f32_16x16x32_bf16 v[140:143], v[32:35], v[28:31], v[140:143]
    s_waitcnt vmcnt(0) lgkmcnt(0)
    v_mfma_f32_16x16x32_bf16 v[160:163], v[80:83], v[56:59], v[160:163]
    v_mfma_f32_16x16x32_bf16 v[176:179], v[84:87], v[56:59], v[176:179]
    s_barrier
    s_cmp_eq_u32 s84, 16
    s_cbranch_scc1 L_Mtail
    v_mfma_f32_16x16x32_bf16 v[180:183], v[84:87], v[60:63], v[180:183]
    ds_read_b128 v[16:19], v4 offset:0
    v_mfma_f32_16x16x32_bf16 v[164:167], v[80:83], v[60:63], v[164:167]
    ds_read_b64_tr_b16 v[40:41], v6 offset:8192
    v_mfma_f32_16x16x32_bf16 v[168:171], v[80:83], v[64:67], v[168:171]
    ds_read_b64_tr_b16 v[42:43], v6 offset:8704
    v_mfma_f32_16x16x32_bf16 v[184:187], v[84:87], v[64:67], v[184:187]
    ds_read_b128 v[20:23], v4 offset:2048
    v_mfma_f32_16x16x32_bf16 v[188:191], v[84:87], v[68:71], v[188:191]
    ds_read_b128 v[24:27], v4 offset:4096
    v_mfma_f32_16x16x32_bf16 v[172:175], v[80:83], v[68:71], v[172:175]
    ds_read_b128 v[28:31], v4 offset:6144
    v_mfma_f32_16x16x32_bf16 v[204:207], v[88:91], v[68:71], v[204:207]
    ds_read_b64_tr_b16 v[44:45], v7 offset:8192
    v_mfma_f32_16x16x32_bf16 v[220:223], v[92:95], v[68:71], v[220:223]
    ds_read_b64_tr_b16 v[46:47], v7 offset:8704
    v_mfma_f32_16x16x32_bf16 v[216:219], v[92:95], v[64:67], v[216:219]
    ds_read_b64_tr_b16 v[48:49], v6 offset:16384
    v_mfma_f32_16x16x32_bf16 v[200:203], v[88:91], v[64:67], v[200:203]
    ds_read_b64_tr_b16 v[50:51], v6 offset:16896
    v_mfma_f32_16x16x32_bf16 v[196:199], v[88:91], v[60:63], v[196:199]
    ds_read_b64_tr_b16 v[52:53], v7 offset:16384
    v_mfma_f32_16x16x32_bf16 v[212:215], v[92:95], v[60:63], v[212:215]
    ds_read_b64_tr_b16 v[54:55], v7 offset:16896
    v_mfma_f32_16x16x32_bf16 v[208:211], v[92:95], v[56:59], v[208:211]
    ds_read_b64_tr_b16 v[32:33], v6 offset:0
    v_mfma_f32_16x16x32_bf16 v[192:195], v[88:91], v[56:59], v[192:195]
    ds_read_b64_tr_b16 v[34:35], v6 offset:512
    v_mfma_f32_16x16x32_bf16 v[128:131], v[72:75], v[56:59], v[128:131]
    ds_read_b64_tr_b16 v[36:37], v7 offset:0
    v_mfma_f32_16x16x32_bf16 v[144:147], v[76:79], v[56:59], v[144:147]
    ds_read_b64_tr_b16 v[38:39], v7 offset:512
    v_mfma_f32_16x16x32_bf16 v[148:151], v[76:79], v[60:63], v[148:151]
    v_mfma_f32_16x16x32_bf16 v[132:135], v[72:75], v[60:63], v[132:135]
    v_mfma_f32_16x16x32_bf16 v[136:139], v[72:75], v[64:67], v[136:139]
    v_mfma_f32_16x16x32_bf16 v[152:155], v[76:79], v[64:67], v[152:155]
    v_mfma_f32_16x16x32_bf16 v[156:159], v[76:79], v[68:71], v[156:159]
    v_mfma_f32_16x16x32_bf16 v[140:143], v[72:75], v[68:71], v[140:143]
    s_branch L_Mloop
    .p2align 3
L_Mtail:
    s_mov_b64 exec, 0xffff
    ds_read_b64 v[104:105], v11 offset:0
    ds_read_b64 v[106:107], v11 offset:128
    ds_read_b64 v[108:109], v11 offset:256
    ds_read_b64 v[110:111], v11 offset:384
    s_mov_b64 exec, -1
    s_nop 0
    v_mfma_f32_16x16x32_bf16 v[180:183], v[84:87], v[60:63], v[180:183]
    ds_read_b64 v[20:21], v12 offset:512
    v_mfma_f32_16x16x32_bf16 v[164:167], v[80:83], v[60:63], v[164:167]
    ds_read_b64 v[22:23], v12 offset:640
    v_mfma_f32_16x16x32_bf16 v[168:171], v[80:83], v[64:67], v[168:171]
    ds_read_b64 v[24:25], v12 offset:1024
    v_mfma_f32_16x16x32_bf16 v[184:187], v[84:87], v[64:67], v[184:187]
    ds_read_b64 v[26:27], v12 offset:1152
    v_mfma_f32_16x16x32_bf16 v[188:191], v[84:87], v[68:71], v[188:191]
    ds_read_b64 v[16:17], v12 offset:0
    v_mfma_f32_16x16x32_bf16 v[172:175], v[80:83], v[68:71], v[172:175]
    ds_read_b64 v[18:19], v12 offset:128
    v_mfma_f32_16x16x32_bf16 v[204:207], v[88:91], v[68:71], v[204:207]
    ds_read2_b32 v[32:33], v14 offset0:0 offset1:32
    v_mfma_f32_16x16x32_bf16 v[220:223], v[92:95], v[68:71], v[220:223]
    ds_read_b32 v28, v13 offset:0
    v_mfma_f32_16x16x32_bf16 v[216:219], v[92:95], v[64:67], v[216:219]
    ds_read_b32 v30, v13 offset:64
    v_mfma_f32_16x16x32_bf16 v[200:203], v[88:91], v[64:67], v[200:203]
    ds_read_b32 v44, v13 offset:128
    v_mfma_f32_16x16x32_bf16 v[196:199], v[88:91], v[60:63], v[196:199]
    ds_read_b32 v46, v13 offset:192
    v_mfma_f32_16x16x32_bf16 v[212:215], v[92:95], v[60:63], v[212:215]
    v_mfma_f32_16x16x32_bf16 v[208:211], v[92:95], v[56:59], v[208:211]
    v_mfma_f32_16x16x32_bf16 v[192:195], v[88:91], v[56:59], v[192:195]
    s_waitcnt lgkmcnt(0)
    s_nop 0
    v_mfma_f32_16x16x16_bf16 v[160:163], v[20:21], v[104:105], v[160:163]
    v_mfma_f32_16x16x16_bf16 v[176:179], v[22:23], v[104:105], v[176:179]
    v_mfma_f32_16x16x16_bf16 v[164:167], v[20:21], v[106:107], v[164:167]
    v_mfma_f32_16x16x16_bf16 v[180:183], v[22:23], v[106:107], v[180:183]
    v_mfma_f32_16x16x16_bf16 v[168:171], v[20:21], v[108:109], v[168:171]
    v_mfma_f32_16x16x16_bf16 v[184:187], v[22:23], v[108:109], v[184:187]
    v_mfma_f32_16x16x16_bf16 v[172:175], v[20:21], v[110:111], v[172:175]
    v_mfma_f32_16x16x16_bf16 v[188:191], v[22:23], v[110:111], v[188:191]
    v_mul_f32 v34, 0x3fb8aa3b, v32
    v_mul_f32 v48, 0x3fb8aa3b, v33
    v_mfma_f32_16x16x16_bf16 v[192:195], v[24:25], v[104:105], v[192:195]
    v_mfma_f32_16x16x16_bf16 v[208:211], v[26:27], v[104:105], v[208:211]
    v_mfma_f32_16x16x16_bf16 v[196:199], v[24:25], v[106:107], v[196:199]
    v_cvt_pk_bf16_f32 v160, v160, v161
    v_cvt_pk_bf16_f32 v161, v162, v163
    v_cvt_pk_bf16_f32 v162, v176, v177
    v_cvt_pk_bf16_f32 v163, v178, v179
    v_mfma_f32_16x16x16_bf16 v[212:215], v[26:27], v[106:107], v[212:215]
    v_cvt_pk_bf16_f32 v164, v164, v165
    v_cvt_pk_bf16_f32 v165, v166, v167
    v_cvt_pk_bf16_f32 v166, v180, v181
    v_cvt_pk_bf16_f32 v167, v182, v183
    v_mfma_f32_16x16x16_bf16 v[200:203], v[24:25], v[108:109], v[200:203]
    v_cvt_pk_bf16_f32 v168, v168, v169
    v_cvt_pk_bf16_f32 v169, v170, v171
    v_cvt_pk_bf16_f32 v170, v184, v185
    v_cvt_pk_bf16_f32 v171, v186, v187
    v_mfma_f32_16x16x16_bf16 v[216:219], v[26:27], v[108:109], v[216:219]
    v_cvt_pk_bf16_f32 v172, v172, v173
    v_cvt_pk_bf16_f32 v173, v174, v175
    v_cvt_pk_bf16_f32 v174, v188, v189
L_pad7:
    s_cbranch_execz L_pad11
    v_cvt_pk_bf16_f32 v175, v190, v191
    v_mfma_f32_16x16x16_bf16 v[204:207], v[24:25], v[110:111], v[204:207]
    v_permlane16_swap_b32 v160, v164
    v_permlane16_swap_b32 v161, v165
    v_permlane16_swap_b32 v162, v166
    v_permlane16_swap_b32_e64 v163, v167
    v_mfma_f32_16x16x16_bf16 v[220:223], v[26:27], v[110:111], v[220:223]
    v_permlane16_swap_b32 v168, v172
    v_permlane16_swap_b32 v169, v173
    v_permlane16_swap_b32 v170, v174
    v_permlane16_swap_b32 v171, v175
    v_mfma_f32_32x32x16_bf16 v[224:239], v[96:99], v[160:163], 0
    v_mfma_f32_32x32x16_bf16 v[224:239], v[100:103], v[164:167], v[224:239]
    v_mfma_f32_32x32x16_bf16 v[240:255], v[96:99], v[168:171], 0
    v_mfma_f32_32x32x16_bf16 v[240:255], v[100:103], v[172:175], v[240:255]
    v_pk_mul_f32 v[192:193], v[192:193], v[28:29] op_sel_hi:[1,0]
    v_pk_mul_f32 v[194:195], v[194:195], v[28:29] op_sel_hi:[1,0]
    v_pk_mul_f32 v[208:209], v[208:209], v[28:29] op_sel_hi:[1,0]
    v_pk_mul_f32 v[210:211], v[210:211], v[28:29] op_sel_hi:[1,0]
    v_cvt_pk_bf16_f32 v192, v192, v193
    v_cvt_pk_bf16_f32 v193, v194, v195
    v_cvt_pk_bf16_f32 v194, v208, v209
    v_cvt_pk_bf16_f32 v195, v210, v211
    v_pk_mul_f32 v[196:197], v[196:197], v[30:31] op_sel_hi:[1,0]
    v_pk_mul_f32 v[198:199], v[198:199], v[30:31] op_sel_hi:[1,0]
    v_pk_mul_f32 v[212:213], v[212:213], v[30:31] op_sel_hi:[1,0]
    v_pk_mul_f32 v[214:215], v[214:215], v[30:31] op_sel_hi:[1,0]
    v_cvt_pk_bf16_f32 v196, v196, v197
    v_cvt_pk_bf16_f32 v197, v198, v199
    v_cvt_pk_bf16_f32 v198, v212, v213
    v_cvt_pk_bf16_f32 v199, v214, v215
    v_pk_mul_f32 v[200:201], v[200:201], v[44:45] op_sel_hi:[1,0]
    v_pk_mul_f32 v[202:203], v[202:203], v[44:45] op_sel_hi:[1,0]
    v_pk_mul_f32 v[216:217], v[216:217], v[44:45] op_sel_hi:[1,0]
    v_pk_mul_f32 v[218:219], v[218:219], v[44:45] op_sel_hi:[1,0]
    v_cvt_pk_bf16_f32 v200, v200, v201
    v_cvt_pk_bf16_f32 v201, v202, v203
    v_cvt_pk_bf16_f32 v202, v216, v217
    v_cvt_pk_bf16_f32 v203, v218, v219
    v_pk_mul_f32 v[204:205], v[204:205], v[46:47] op_sel_hi:[1,0]
    v_pk_mul_f32 v[206:207], v[206:207], v[46:47] op_sel_hi:[1,0]
    v_pk_mul_f32 v[220:221], v[220:221], v[46:47] op_sel_hi:[1,0]
    v_pk_mul_f32 v[222:223], v[222:223], v[46:47] op_sel_hi:[1,0]
    v_cvt_pk_bf16_f32 v204, v204, v205
    v_cvt_pk_bf16_f32 v205, v206, v207
    v_cvt_pk_bf16_f32 v206, v220, v221
    v_cvt_pk_bf16_f32 v207, v222, v223
    v_mfma_f32_16x16x32_bf16 v[128:131], v[72:75], v[56:59], v[128:131]
    v_max3_f32 v36, v224, v225, v226
    v_max3_f32 v38, -v224, -v225, -v226
    v_max3_f32 v36, v36, v227, v228
    v_max3_f32 v38, v38, -v227, -v228
    v_mfma_f32_16x16x32_bf16 v[144:147], v[76:79], v[56:59], v[144:147]
    v_max3_f32 v36, v36, v229, v230
    v_max3_f32 v38, v38, -v229, -v230
    v_max3_f32 v36, v36, v231, v232
    v_max3_f32 v38, v38, -v231, -v232
    v_mfma_f32_16x16x32_bf16 v[148:151], v[76:79], v[60:63], v[148:151]
    v_max3_f32 v36, v36, v233, v234
    v_max3_f32 v38, v38, -v233, -v234
    v_max3_f32 v36, v36, v235, v236
    v_max3_f32 v38, v38, -v235, -v236
    v_mfma_f32_16x16x32_bf16 v[132:135], v[72:75], v[60:63], v[132:135]
    v_max3_f32 v36, v36, v237, v238
    v_max3_f32 v38, v38, -v237, -v238
    v_max_f32_e64 v36, v36, v239
    v_max_f32 v38, v38, -v239
    v_mfma_f32_16x16x32_bf16 v[136:139], v[72:75], v[64:67], v[136:139]
    v_max3_f32 v37, v240, v241, v242
    v_max3_f32 v39, -v240, -v241, -v242
    v_max3_f32 v37, v37, v243, v244
    v_max3_f32 v39, v39, -v243, -v244
    v_mfma_f32_16x16x32_bf16 v[152:155], v[76:79], v[64:67], v[152:155]
    v_max3_f32 v37, v37, v245, v246
    v_max3_f32 v39, v39, -v245, -v246
    v_max3_f32 v37, v37, v247, v248
    v_max3_f32 v39, v39, -v247, -v248
    v_mfma_f32_16x16x32_bf16 v[156:159], v[76:79], v[68:71], v[156:159]
    v_max3_f32 v37, v37, v249, v250
    v_max3_f32 v39, v39, -v249, -v250
    v_max3_f32 v37, v37, v251, v252
    v_max3_f32 v39, v39, -v251, -v252
    v_mfma_f32_16x16x32_bf16 v[140:143], v[72:75], v[68:71], v[140:143]
    v_max3_f32 v37, v37, v253, v254
    v_max3_f32 v39, v39, -v253, -v254
    v_max_f32_e64 v37, v37, v255
    v_max_f32 v39, v39, -v255
    v_permlane32_swap_b32 v36, v38
    s_nop 0
    v_permlane32_swap_b32 v37, v39
    v_max_f32 v36, v36, v38
    v_max_f32_e64 v37, v37, v39
    v_mul_f32 v36, -v36, v34
    v_mul_f32 v37, -v37, v48
    v_mov_b32 v38, v36
    v_mov_b32 v39, v37
    s_nop 0
    v_permlane32_swap_b32 v36, v38
    v_permlane32_swap_b32_e64 v37, v39
    v_pk_fma_f32 v[60:61], v[224:225], v[34:35], v[36:37] op_sel_hi:[1,0,0]
    v_pk_fma_f32 v[62:63], v[226:227], v[34:35], v[36:37] op_sel_hi:[1,0,0]
    v_pk_fma_f32 v[64:65], v[228:229], v[34:35], v[36:37] op_sel_hi:[1,0,0]
    v_pk_fma_f32 v[66:67], v[230:231], v[34:35], v[36:37] op_sel_hi:[1,0,0]
    v_pk_fma_f32 v[68:69], v[232:233], v[34:35], v[36:37] op_sel_hi:[1,0,0]
    v_pk_fma_f32 v[70:71], v[234:235], v[34:35], v[36:37] op_sel_hi:[1,0,0]
    v_pk_fma_f32 v[72:73], v[236:237], v[34:35], v[36:37] op_sel_hi:[1,0,0]
    v_pk_fma_f32 v[74:75], v[238:239], v[34:35], v[36:37] op_sel_hi:[1,0,0]
    v_pk_fma_f32 v[76:77], v[224:225], v[34:35], v[38:39] op_sel_hi:[1,0,0] neg_lo:[1,0,0] neg_hi:[1,0,0]
    v_pk_fma_f32 v[78:79], v[226:227], v[34:35], v[38:39] op_sel_hi:[1,0,0] neg_lo:[1,0,0] neg_hi:[1,0,0]
    v_pk_fma_f32 v[80:81], v[228:229], v[34:35], v[38:39] op_sel_hi:[1,0,0] neg_lo:[1,0,0] neg_hi:[1,0,0]
    v_pk_fma_f32 v[82:83], v[230:231], v[34:35], v[38:39] op_sel_hi:[1,0,0] neg_lo:[1,0,0] neg_hi:[1,0,0]
    v_pk_fma_f32 v[84:85], v[232:233], v[34:35], v[38:39] op_sel_hi:[1,0,0] neg_lo:[1,0,0] neg_hi:[1,0,0]
    v_pk_fma_f32 v[86:87], v[234:235], v[34:35], v[38:39] op_sel_hi:[1,0,0] neg_lo:[1,0,0] neg_hi:[1,0,0]
    v_pk_fma_f32 v[88:89], v[236:237], v[34:35], v[38:39] op_sel_hi:[1,0,0] neg_lo:[1,0,0] neg_hi:[1,0,0]
    v_pk_fma_f32 v[90:91], v[238:239], v[34:35], v[38:39] op_sel_hi:[1,0,0] neg_lo:[1,0,0] neg_hi:[1,0,0]
    v_exp_f32 v60, v60
    v_exp_f32 v61, v61
    v_exp_f32 v62, v62
    v_exp_f32 v63, v63
    v_exp_f32 v64, v64
    v_exp_f32 v65, v65
    v_exp_f32 v66, v66
    v_exp_f32 v67, v67
    v_exp_f32 v68, v68
    v_exp_f32 v69, v69
    v_exp_f32 v70, v70
    v_exp_f32 v71, v71
    v_exp_f32 v72, v72
    v_exp_f32 v73, v73
    v_exp_f32 v74, v74
    v_exp_f32 v75, v75
    v_exp_f32 v76, v76
    v_exp_f32 v77, v77
    v_exp_f32 v78, v78
    v_exp_f32 v79, v79
    v_exp_f32 v80, v80
    v_exp_f32 v81, v81
    v_exp_f32 v82, v82
    v_exp_f32 v83, v83
    v_exp_f32 v84, v84
    v_exp_f32 v85, v85
    v_exp_f32 v86, v86
    v_exp_f32 v87, v87
    v_exp_f32 v88, v88
    v_exp_f32 v89, v89
    v_exp_f32 v90, v90
    v_exp_f32 v91, v91
    v_pk_add_f32 v[40:41], v[60:61], v[62:63]
    v_pk_add_f32 v[42:43], v[76:77], v[78:79]
    v_pk_add_f32 v[40:41], v[40:41], v[64:65]
    v_pk_add_f32 v[42:43], v[42:43], v[80:81]
    v_pk_add_f32 v[40:41], v[40:41], v[66:67]
    v_pk_add_f32 v[42:43], v[42:43], v[82:83]
    v_pk_add_f32 v[40:41], v[40:41], v[68:69]
    v_pk_add_f32 v[42:43], v[42:43], v[84:85]
    v_pk_add_f32 v[40:41], v[40:41], v[70:71]
    v_pk_add_f32 v[42:43], v[42:43], v[86:87]
    v_pk_add_f32 v[40:41], v[40:41], v[72:73]
    v_pk_add_f32 v[42:43], v[42:43], v[88:89]
    v_pk_add_f32 v[40:41], v[40:41], v[74:75]
    v_pk_add_f32 v[42:43], v[42:43], v[90:91]
    v_add_f32 v40, v40, v41
    v_add_f32 v42, v42, v43
    s_nop 1
    v_permlane32_swap_b32 v40, v42
    v_add_f32 v40, v40, v42
    v_rcp_f32 v40, v40
    s_nop 0
    v_mov_b32 v42, v40
    s_nop 1
    v_permlane32_swap_b32 v40, v42
    v_pk_mul_f32 v[60:61], v[60:61], v[40:41] op_sel_hi:[1,0]
    v_pk_mul_f32 v[62:63], v[62:63], v[40:41] op_sel_hi:[1,0]
    v_pk_mul_f32 v[64:65], v[64:65], v[40:41] op_sel_hi:[1,0]
    v_pk_mul_f32 v[66:67], v[66:67], v[40:41] op_sel_hi:[1,0]
    v_cvt_pk_bf16_f32 v160, v60, v61
    v_cvt_pk_bf16_f32 v161, v62, v63
    v_cvt_pk_bf16_f32 v162, v64, v65
    v_cvt_pk_bf16_f32 v163, v66, v67
    v_pk_mul_f32 v[68:69], v[68:69], v[40:41] op_sel_hi:[1,0]
    v_pk_mul_f32 v[70:71], v[70:71], v[40:41] op_sel_hi:[1,0]
    v_pk_mul_f32 v[72:73], v[72:73], v[40:41] op_sel_hi:[1,0]
    v_pk_mul_f32 v[74:75], v[74:75], v[40:41] op_sel_hi:[1,0]
    v_cvt_pk_bf16_f32 v166, v68, v69
    v_cvt_pk_bf16_f32 v167, v70, v71
    v_cvt_pk_bf16_f32 v164, v72, v73
    v_cvt_pk_bf16_f32 v165, v74, v75
    v_pk_mul_f32 v[76:77], v[76:77], v[42:43] op_sel_hi:[1,0]
    v_pk_mul_f32 v[78:79], v[78:79], v[42:43] op_sel_hi:[1,0]
    v_pk_mul_f32 v[80:81], v[80:81], v[42:43] op_sel_hi:[1,0]
    v_pk_mul_f32 v[82:83], v[82:83], v[42:43] op_sel_hi:[1,0]
    v_cvt_pk_bf16_f32 v168, v76, v77
    v_cvt_pk_bf16_f32 v169, v78, v79
    v_cvt_pk_bf16_f32 v170, v80, v81
    v_cvt_pk_bf16_f32 v171, v82, v83
    v_pk_mul_f32 v[84:85], v[84:85], v[42:43] op_sel_hi:[1,0]
    v_pk_mul_f32 v[86:87], v[86:87], v[42:43] op_sel_hi:[1,0]
    v_pk_mul_f32 v[88:89], v[88:89], v[42:43] op_sel_hi:[1,0]
    v_pk_mul_f32 v[90:91], v[90:91], v[42:43] op_sel_hi:[1,0]
    v_cvt_pk_bf16_f32 v174, v84, v85
    v_cvt_pk_bf16_f32 v175, v86, v87
    v_cvt_pk_bf16_f32 v172, v88, v89
    v_cvt_pk_bf16_f32 v173, v90, v91
    v_pk_fma_f32 v[60:61], v[240:241], v[48:49], v[36:37] op_sel:[0,0,1] op_sel_hi:[1,0,1]
    v_pk_fma_f32 v[62:63], v[242:243], v[48:49], v[36:37] op_sel:[0,0,1] op_sel_hi:[1,0,1]
    v_pk_fma_f32 v[64:65], v[244:245], v[48:49], v[36:37] op_sel:[0,0,1] op_sel_hi:[1,0,1]
    v_pk_fma_f32 v[66:67], v[246:247], v[48:49], v[36:37] op_sel:[0,0,1] op_sel_hi:[1,0,1]
    v_pk_fma_f32 v[68:69], v[248:249], v[48:49], v[36:37] op_sel:[0,0,1] op_sel_hi:[1,0,1]
    v_pk_fma_f32 v[70:71], v[250:251], v[48:49], v[36:37] op_sel:[0,0,1] op_sel_hi:[1,0,1]
    v_pk_fma_f32 v[72:73], v[252:253], v[48:49], v[36:37] op_sel:[0,0,1] op_sel_hi:[1,0,1]
    v_pk_fma_f32 v[74:75], v[254:255], v[48:49], v[36:37] op_sel:[0,0,1] op_sel_hi:[1,0,1]
    v_pk_fma_f32 v[76:77], v[240:241], v[48:49], v[38:39] op_sel:[0,0,1] op_sel_hi:[1,0,1] neg_lo:[1,0,0] neg_hi:[1,0,0]
    v_pk_fma_f32 v[78:79], v[242:243], v[48:49], v[38:39] op_sel:[0,0,1] op_sel_hi:[1,0,1] neg_lo:[1,0,0] neg_hi:[1,0,0]
    v_pk_fma_f32 v[80:81], v[244:245], v[48:49], v[38:39] op_sel:[0,0,1] op_sel_hi:[1,0,1] neg_lo:[1,0,0] neg_hi:[1,0,0]
    v_pk_fma_f32 v[82:83], v[246:247], v[48:49], v[38:39] op_sel:[0,0,1] op_sel_hi:[1,0,1] neg_lo:[1,0,0] neg_hi:[1,0,0]
    v_pk_fma_f32 v[84:85], v[248:249], v[48:49], v[38:39] op_sel:[0,0,1] op_sel_hi:[1,0,1] neg_lo:[1,0,0] neg_hi:[1,0,0]
    v_pk_fma_f32 v[86:87], v[250:251], v[48:49], v[38:39] op_sel:[0,0,1] op_sel_hi:[1,0,1] neg_lo:[1,0,0] neg_hi:[1,0,0]
    v_pk_fma_f32 v[88:89], v[252:253], v[48:49], v[38:39] op_sel:[0,0,1] op_sel_hi:[1,0,1] neg_lo:[1,0,0] neg_hi:[1,0,0]
    v_pk_fma_f32 v[90:91], v[254:255], v[48:49], v[38:39] op_sel:[0,0,1] op_sel_hi:[1,0,1] neg_lo:[1,0,0] neg_hi:[1,0,0]
    v_exp_f32 v60, v60
    v_exp_f32 v61, v61
    v_exp_f32 v62, v62
    v_exp_f32 v63, v63
    ds_write_b128 v116, v[192:195] offset:0
    v_exp_f32 v64, v64
    v_exp_f32 v65, v65
    v_exp_f32 v66, v66
    v_exp_f32 v67, v67
    ds_write_b128 v116, v[196:199] offset:2048
    v_exp_f32 v68, v68
    v_exp_f32 v69, v69
    v_exp_f32 v70, v70
    v_exp_f32 v71, v71
    ds_write_b128 v116, v[200:203] offset:4096
    v_exp_f32 v72, v72
    v_exp_f32 v73, v73
    v_exp_f32 v74, v74
    v_exp_f32 v75, v75
    ds_write_b128 v116, v[204:207] offset:6144
    v_exp_f32 v76, v76
    v_exp_f32 v77, v77
    v_exp_f32 v78, v78
    v_exp_f32 v79, v79
    ds_write_b128 v112, v[160:163] offset:0
    v_exp_f32 v80, v80
    v_exp_f32 v81, v81
    v_exp_f32 v82, v82
    v_exp_f32 v83, v83
    ds_write_b128 v113, v[164:167] offset:0
    v_exp_f32 v84, v84
    v_exp_f32 v85, v85
    v_exp_f32 v86, v86
    v_exp_f32 v87, v87
    ds_write_b128 v114, v[168:171] offset:0
    v_exp_f32 v88, v88
    v_exp_f32 v89, v89
    v_exp_f32 v90, v90
    v_exp_f32 v91, v91
    ds_write_b128 v115, v[172:175] offset:0
    v_pk_add_f32 v[40:41], v[60:61], v[62:63]
    v_pk_add_f32 v[42:43], v[76:77], v[78:79]
    v_pk_add_f32 v[40:41], v[40:41], v[64:65]
    v_pk_add_f32 v[42:43], v[42:43], v[80:81]
    v_pk_add_f32 v[40:41], v[40:41], v[66:67]
    v_pk_add_f32 v[42:43], v[42:43], v[82:83]
    v_pk_add_f32 v[40:41], v[40:41], v[68:69]
    v_pk_add_f32 v[42:43], v[42:43], v[84:85]
    v_pk_add_f32 v[40:41], v[40:41], v[70:71]
    v_pk_add_f32 v[42:43], v[42:43], v[86:87]
    v_pk_add_f32 v[40:41], v[40:41], v[72:73]
    v_pk_add_f32 v[42:43], v[42:43], v[88:89]
    v_pk_add_f32 v[40:41], v[40:41], v[74:75]
    v_pk_add_f32 v[42:43], v[42:43], v[90:91]
    v_add_f32 v40, v40, v41
    v_add_f32 v42, v42, v43
    s_nop 1
    v_permlane32_swap_b32 v40, v42
    v_add_f32 v40, v40, v42
    v_rcp_f32 v40, v40
    s_nop 0
    v_mov_b32 v42, v40
    s_nop 1
    v_permlane32_swap_b32 v40, v42
    v_pk_mul_f32 v[60:61], v[60:61], v[40:41] op_sel_hi:[1,0]
    v_pk_mul_f32 v[62:63], v[62:63], v[40:41] op_sel_hi:[1,0]
    v_pk_mul_f32 v[64:65], v[64:65], v[40:41] op_sel_hi:[1,0]
    v_pk_mul_f32 v[66:67], v[66:67], v[40:41] op_sel_hi:[1,0]
    v_cvt_pk_bf16_f32 v176, v60, v61
    v_cvt_pk_bf16_f32 v177, v62, v63
    v_cvt_pk_bf16_f32 v178, v64, v65
    v_cvt_pk_bf16_f32 v179, v66, v67
    ds_write_b128 v112, v[176:179] offset:4096
    v_pk_mul_f32 v[68:69], v[68:69], v[40:41] op_sel_hi:[1,0]
    v_pk_mul_f32 v[70:71], v[70:71], v[40:41] op_sel_hi:[1,0]
    v_pk_mul_f32 v[72:73], v[72:73], v[40:41] op_sel_hi:[1,0]
    v_pk_mul_f32 v[74:75], v[74:75], v[40:41] op_sel_hi:[1,0]
    v_cvt_pk_bf16_f32 v182, v68, v69
    v_cvt_pk_bf16_f32 v183, v70, v71
    v_cvt_pk_bf16_f32 v180, v72, v73
    v_cvt_pk_bf16_f32 v181, v74, v75
    ds_write_b128 v113, v[180:183] offset:4096
    v_pk_mul_f32 v[76:77], v[76:77], v[42:43] op_sel_hi:[1,0]
    v_pk_mul_f32 v[78:79], v[78:79], v[42:43] op_sel_hi:[1,0]
    v_pk_mul_f32 v[80:81], v[80:81], v[42:43] op_sel_hi:[1,0]
    v_pk_mul_f32 v[82:83], v[82:83], v[42:43] op_sel_hi:[1,0]
L_pad8:
    s_cbranch_execz L_pad12
    s_nop 0
    v_cvt_pk_bf16_f32 v184, v76, v77
    v_cvt_pk_bf16_f32 v185, v78, v79
    v_cvt_pk_bf16_f32 v186, v80, v81
    v_cvt_pk_bf16_f32 v187, v82, v83
    ds_write_b128 v114, v[184:187] offset:4096
    v_pk_mul_f32 v[84:85], v[84:85], v[42:43] op_sel_hi:[1,0]
    v_pk_mul_f32 v[86:87], v[86:87], v[42:43] op_sel_hi:[1,0]
    v_pk_mul_f32 v[88:89], v[88:89], v[42:43] op_sel_hi:[1,0]
    v_pk_mul_f32 v[90:91], v[90:91], v[42:43] op_sel_hi:[1,0]
    v_cvt_pk_bf16_f32 v190, v84, v85
    v_cvt_pk_bf16_f32 v191, v86, v87
    v_cvt_pk_bf16_f32 v188, v88, v89
    v_cvt_pk_bf16_f32 v189, v90, v91
    ds_write_b128 v115, v[188:191] offset:4096
    s_waitcnt lgkmcnt(0)
    s_barrier
    s_setprio 0
    s_nop 0
    v_mfma_f32_16x16x16_bf16 v[128:131], v[16:17], v[104:105], v[128:131]
    v_mfma_f32_16x16x16_bf16 v[144:147], v[18:19], v[104:105], v[144:147]
    v_mfma_f32_16x16x16_bf16 v[132:135], v[16:17], v[106:107], v[132:135]
    v_mfma_f32_16x16x16_bf16 v[148:151], v[18:19], v[106:107], v[148:151]
    v_mfma_f32_16x16x16_bf16 v[136:139], v[16:17], v[108:109], v[136:139]
    v_mfma_f32_16x16x16_bf16 v[152:155], v[18:19], v[108:109], v[152:155]
    v_mfma_f32_16x16x16_bf16 v[140:143], v[16:17], v[110:111], v[140:143]
    v_mfma_f32_16x16x16_bf16 v[156:159], v[18:19], v[110:111], v[156:159]
    v_lshrrev_b32 v11, 5, v2
    s_lshl_b32 s78, s81, 7
    s_add_u32 s78, s78, 162944
    v_lshl_add_u32 v10, v11, 4, s78
    v_and_b32 v13, 1, v2
    v_cmp_eq_u32 vcc, 1, v13
    v_mov_b32 v13, 162816
    v_and_b32 v12, 31, v2
    v_cndmask_b32 v10, v10, v13, vcc
    v_lshlrev_b32_e64 v12, 4, v12
    v_lshl_add_u32 v11, v11, 10, v12
    v_lshlrev_b32_e64 v14, 4, v2
    v_cvt_pk_bf16_f32 v128, v128, v129
    v_cvt_pk_bf16_f32 v129, v130, v131
    v_cvt_pk_bf16_f32 v130, v144, v145
    v_cvt_pk_bf16_f32 v131, v146, v147
    v_cvt_pk_bf16_f32 v132, v132, v133
    v_cvt_pk_bf16_f32 v133, v134, v135
    v_cvt_pk_bf16_f32 v134, v148, v149
    v_cvt_pk_bf16_f32 v135, v150, v151
    v_cvt_pk_bf16_f32 v136, v136, v137
    v_cvt_pk_bf16_f32 v137, v138, v139
    v_cvt_pk_bf16_f32 v138, v152, v153
    v_cvt_pk_bf16_f32 v139, v154, v155
    v_cvt_pk_bf16_f32 v140, v140, v141
    v_cvt_pk_bf16_f32 v141, v142, v143
    v_cvt_pk_bf16_f32 v142, v156, v157
    v_cvt_pk_bf16_f32 v143, v158, v159
    v_permlane16_swap_b32 v128, v132
    v_permlane16_swap_b32 v129, v133
    v_permlane16_swap_b32 v130, v134
    v_permlane16_swap_b32 v131, v135
    v_permlane16_swap_b32 v136, v140
    v_permlane16_swap_b32 v137, v141
    v_permlane16_swap_b32 v138, v142
    v_permlane16_swap_b32 v139, v143
    v_mfma_f32_32x32x16_bf16 v[224:239], v[96:99], v[128:131], 0
    v_mfma_f32_32x32x16_bf16 v[224:239], v[100:103], v[132:135], v[224:239]
    v_mfma_f32_32x32x16_bf16 v[240:255], v[96:99], v[136:139], 0
    v_mfma_f32_32x32x16_bf16 v[240:255], v[100:103], v[140:143], v[240:255]
    s_lshl_b32 s94, s70, 14
    s_lshl_b32 s79, s81, 13
    s_add_u32 s94, s94, s79
    s_add_u32 s94, s94, 8388608
    s_add_u32 s95, s94, 4096
    s_lshl_b32 s78, s69, 1
    s_add_u32 s78, s78, s80
    s_lshl_b32 s78, s78, 6
    s_lshl_b32 s79, s70, 1
    s_add_u32 s78, s78, s79
    s_add_u32 s78, s78, s81
    s_lshl_b32 s78, s78, 11
    s_add_u32 s96, s78, 4194304
    s_add_u32 s97, s96, 65536
    v_max3_f32 v36, v224, v225, v226
    v_max3_f32 v38, -v224, -v225, -v226
    v_max3_f32 v36, v36, v227, v228
    v_max3_f32 v38, v38, -v227, -v228
    v_max3_f32 v36, v36, v229, v230
    v_max3_f32 v38, v38, -v229, -v230
    v_max3_f32 v36, v36, v231, v232
    v_max3_f32 v38, v38, -v231, -v232
    v_max3_f32 v36, v36, v233, v234
    v_max3_f32 v38, v38, -v233, -v234
    v_max3_f32 v36, v36, v235, v236
    v_max3_f32 v38, v38, -v235, -v236
    v_max3_f32 v36, v36, v237, v238
    v_max3_f32 v38, v38, -v237, -v238
    v_max_f32_e64 v36, v36, v239
    v_max_f32 v38, v38, -v239
    v_max3_f32 v37, v240, v241, v242
    v_max3_f32 v39, -v240, -v241, -v242
    v_max3_f32 v37, v37, v243, v244
    v_max3_f32 v39, v39, -v243, -v244
    v_max3_f32 v37, v37, v245, v246
    v_max3_f32 v39, v39, -v245, -v246
    v_max3_f32 v37, v37, v247, v248
    v_max3_f32 v39, v39, -v247, -v248
    v_max3_f32 v37, v37, v249, v250
    v_max3_f32 v39, v39, -v249, -v250
    v_max3_f32 v37, v37, v251, v252
    v_max3_f32 v39, v39, -v251, -v252
    v_max3_f32 v37, v37, v253, v254
    v_max3_f32 v39, v39, -v253, -v254
    v_max_f32_e64 v37, v37, v255
    v_max_f32 v39, v39, -v255
    v_permlane32_swap_b32 v36, v38
    s_nop 0
    v_permlane32_swap_b32 v37, v39
    v_max_f32 v36, v36, v38
    v_max_f32_e64 v37, v37, v39
    v_mul_f32 v36, -v36, v34
    v_mul_f32 v37, -v37, v48
    v_mov_b32 v38, v36
    v_mov_b32 v39, v37
    s_nop 0
    v_permlane32_swap_b32 v36, v38
    v_permlane32_swap_b32_e64 v37, v39
    v_pk_fma_f32 v[60:61], v[224:225], v[34:35], v[36:37] op_sel_hi:[1,0,0]
    v_pk_fma_f32 v[62:63], v[226:227], v[34:35], v[36:37] op_sel_hi:[1,0,0]
    v_pk_fma_f32 v[64:65], v[228:229], v[34:35], v[36:37] op_sel_hi:[1,0,0]
    v_pk_fma_f32 v[66:67], v[230:231], v[34:35], v[36:37] op_sel_hi:[1,0,0]
    v_pk_fma_f32 v[68:69], v[232:233], v[34:35], v[36:37] op_sel_hi:[1,0,0]
    v_pk_fma_f32 v[70:71], v[234:235], v[34:35], v[36:37] op_sel_hi:[1,0,0]
    v_pk_fma_f32 v[72:73], v[236:237], v[34:35], v[36:37] op_sel_hi:[1,0,0]
    v_pk_fma_f32 v[74:75], v[238:239], v[34:35], v[36:37] op_sel_hi:[1,0,0]
    v_pk_fma_f32 v[76:77], v[224:225], v[34:35], v[38:39] op_sel_hi:[1,0,0] neg_lo:[1,0,0] neg_hi:[1,0,0]
    v_pk_fma_f32 v[78:79], v[226:227], v[34:35], v[38:39] op_sel_hi:[1,0,0] neg_lo:[1,0,0] neg_hi:[1,0,0]
    v_pk_fma_f32 v[80:81], v[228:229], v[34:35], v[38:39] op_sel_hi:[1,0,0] neg_lo:[1,0,0] neg_hi:[1,0,0]
    v_pk_fma_f32 v[82:83], v[230:231], v[34:35], v[38:39] op_sel_hi:[1,0,0] neg_lo:[1,0,0] neg_hi:[1,0,0]
    v_pk_fma_f32 v[84:85], v[232:233], v[34:35], v[38:39] op_sel_hi:[1,0,0] neg_lo:[1,0,0] neg_hi:[1,0,0]
    v_pk_fma_f32 v[86:87], v[234:235], v[34:35], v[38:39] op_sel_hi:[1,0,0] neg_lo:[1,0,0] neg_hi:[1,0,0]
    v_pk_fma_f32 v[88:89], v[236:237], v[34:35], v[38:39] op_sel_hi:[1,0,0] neg_lo:[1,0,0] neg_hi:[1,0,0]
    v_pk_fma_f32 v[90:91], v[238:239], v[34:35], v[38:39] op_sel_hi:[1,0,0] neg_lo:[1,0,0] neg_hi:[1,0,0]
    v_exp_f32 v60, v60
    v_exp_f32 v61, v61
    v_exp_f32 v62, v62
    v_exp_f32 v63, v63
    v_exp_f32 v64, v64
    v_exp_f32 v65, v65
    v_exp_f32 v66, v66
    v_exp_f32 v67, v67
    v_exp_f32 v68, v68
    v_exp_f32 v69, v69
    v_exp_f32 v70, v70
    v_exp_f32 v71, v71
    v_exp_f32 v72, v72
    v_exp_f32 v73, v73
    v_exp_f32 v74, v74
    v_exp_f32 v75, v75
    v_exp_f32 v76, v76
    v_exp_f32 v77, v77
    v_exp_f32 v78, v78
    v_exp_f32 v79, v79
    v_exp_f32 v80, v80
    v_exp_f32 v81, v81
    v_exp_f32 v82, v82
    v_exp_f32 v83, v83
    v_exp_f32 v84, v84
    v_exp_f32 v85, v85
    v_exp_f32 v86, v86
    v_exp_f32 v87, v87
    v_exp_f32 v88, v88
    v_exp_f32 v89, v89
    v_exp_f32 v90, v90
    v_exp_f32 v91, v91
    v_cvt_pk_bf16_f32 v160, v60, v61
    v_cvt_pk_bf16_f32 v161, v62, v63
    v_cvt_pk_bf16_f32 v162, v64, v65
    v_cvt_pk_bf16_f32 v163, v66, v67
    v_cvt_pk_bf16_f32 v164, v68, v69
    v_cvt_pk_bf16_f32 v165, v70, v71
    v_cvt_pk_bf16_f32 v166, v72, v73
    v_cvt_pk_bf16_f32 v167, v74, v75
    v_cvt_pk_bf16_f32 v168, v76, v77
    v_cvt_pk_bf16_f32 v169, v78, v79
    v_cvt_pk_bf16_f32 v170, v80, v81
    v_cvt_pk_bf16_f32 v171, v82, v83
    v_cvt_pk_bf16_f32 v172, v84, v85
    v_cvt_pk_bf16_f32 v173, v86, v87
    v_cvt_pk_bf16_f32 v174, v88, v89
    v_cvt_pk_bf16_f32 v175, v90, v91
    v_pk_fma_f32 v[60:61], v[240:241], v[48:49], v[36:37] op_sel:[0,0,1] op_sel_hi:[1,0,1]
    v_pk_fma_f32 v[62:63], v[242:243], v[48:49], v[36:37] op_sel:[0,0,1] op_sel_hi:[1,0,1]
    v_pk_fma_f32 v[64:65], v[244:245], v[48:49], v[36:37] op_sel:[0,0,1] op_sel_hi:[1,0,1]
    v_pk_fma_f32 v[66:67], v[246:247], v[48:49], v[36:37] op_sel:[0,0,1] op_sel_hi:[1,0,1]
    v_pk_fma_f32 v[68:69], v[248:249], v[48:49], v[36:37] op_sel:[0,0,1] op_sel_hi:[1,0,1]
    v_pk_fma_f32 v[70:71], v[250:251], v[48:49], v[36:37] op_sel:[0,0,1] op_sel_hi:[1,0,1]
    v_pk_fma_f32 v[72:73], v[252:253], v[48:49], v[36:37] op_sel:[0,0,1] op_sel_hi:[1,0,1]
    v_pk_fma_f32 v[74:75], v[254:255], v[48:49], v[36:37] op_sel:[0,0,1] op_sel_hi:[1,0,1]
    v_pk_fma_f32 v[76:77], v[240:241], v[48:49], v[38:39] op_sel:[0,0,1] op_sel_hi:[1,0,1] neg_lo:[1,0,0] neg_hi:[1,0,0]
    v_pk_fma_f32 v[78:79], v[242:243], v[48:49], v[38:39] op_sel:[0,0,1] op_sel_hi:[1,0,1] neg_lo:[1,0,0] neg_hi:[1,0,0]
    v_pk_fma_f32 v[80:81], v[244:245], v[48:49], v[38:39] op_sel:[0,0,1] op_sel_hi:[1,0,1] neg_lo:[1,0,0] neg_hi:[1,0,0]
    v_pk_fma_f32 v[82:83], v[246:247], v[48:49], v[38:39] op_sel:[0,0,1] op_sel_hi:[1,0,1] neg_lo:[1,0,0] neg_hi:[1,0,0]
    v_pk_fma_f32 v[84:85], v[248:249], v[48:49], v[38:39] op_sel:[0,0,1] op_sel_hi:[1,0,1] neg_lo:[1,0,0] neg_hi:[1,0,0]
    v_pk_fma_f32 v[86:87], v[250:251], v[48:49], v[38:39] op_sel:[0,0,1] op_sel_hi:[1,0,1] neg_lo:[1,0,0] neg_hi:[1,0,0]
    v_pk_fma_f32 v[88:89], v[252:253], v[48:49], v[38:39] op_sel:[0,0,1] op_sel_hi:[1,0,1] neg_lo:[1,0,0] neg_hi:[1,0,0]
    v_pk_fma_f32 v[90:91], v[254:255], v[48:49], v[38:39] op_sel:[0,0,1] op_sel_hi:[1,0,1] neg_lo:[1,0,0] neg_hi:[1,0,0]
    v_exp_f32 v60, v60
    v_exp_f32 v61, v61
    v_exp_f32 v62, v62
    v_exp_f32 v63, v63
    v_exp_f32 v64, v64
    v_exp_f32 v65, v65
    v_exp_f32 v66, v66
    v_exp_f32 v67, v67
    v_exp_f32 v68, v68
    v_exp_f32 v69, v69
    v_exp_f32 v70, v70
    v_exp_f32 v71, v71
    v_exp_f32 v72, v72
    v_exp_f32 v73, v73
    v_exp_f32 v74, v74
    v_exp_f32 v75, v75
    v_exp_f32 v76, v76
    v_exp_f32 v77, v77
    v_exp_f32 v78, v78
    v_exp_f32 v79, v79
    v_exp_f32 v80, v80
    v_exp_f32 v81, v81
    v_exp_f32 v82, v82
    v_exp_f32 v83, v83
    v_exp_f32 v84, v84
    v_exp_f32 v85, v85
    v_exp_f32 v86, v86
    v_exp_f32 v87, v87
    v_exp_f32 v88, v88
    v_exp_f32 v89, v89
    v_exp_f32 v90, v90
    v_exp_f32 v91, v91
    v_cvt_pk_bf16_f32 v176, v60, v61
    v_cvt_pk_bf16_f32 v177, v62, v63
    v_cvt_pk_bf16_f32 v178, v64, v65
    v_cvt_pk_bf16_f32 v179, v66, v67
    v_cvt_pk_bf16_f32 v180, v68, v69
    v_cvt_pk_bf16_f32 v181, v70, v71
    v_cvt_pk_bf16_f32 v182, v72, v73
    v_cvt_pk_bf16_f32 v183, v74, v75
    v_cvt_pk_bf16_f32 v184, v76, v77
    v_cvt_pk_bf16_f32 v185, v78, v79
    v_cvt_pk_bf16_f32 v186, v80, v81
    v_cvt_pk_bf16_f32 v187, v82, v83
    v_cvt_pk_bf16_f32 v188, v84, v85
    v_cvt_pk_bf16_f32 v189, v86, v87
    v_cvt_pk_bf16_f32 v190, v88, v89
    v_cvt_pk_bf16_f32 v191, v90, v91
    s_barrier
    s_setprio 1
    ds_read_b128 v[16:19], v10 offset:0
    ds_read_b128 v[20:23], v10 offset:32
    ds_read_b128 v[24:27], v10 offset:64
    ds_read_b128 v[28:31], v10 offset:96
    s_waitcnt lgkmcnt(3)
    v_mfma_f32_32x32x16_bf16 v[224:239], v[16:19], v[160:163], 0
    s_waitcnt lgkmcnt(2)
    v_mfma_f32_32x32x16_bf16 v[224:239], v[20:23], v[164:167], v[224:239]
    buffer_load_dwordx4 v[96:99], v11, s[36:39], s94 offen offset:0 sc1
    buffer_load_dwordx4 v[100:103], v11, s[36:39], s94 offen offset:2048 sc1
    buffer_load_dwordx4 v[104:107], v11, s[36:39], s95 offen offset:0 sc1
    buffer_load_dwordx4 v[108:111], v11, s[36:39], s95 offen offset:2048 sc1
    s_waitcnt lgkmcnt(1)
    v_mfma_f32_32x32x16_bf16 v[240:255], v[24:27], v[168:171], 0
    s_waitcnt lgkmcnt(0)
    v_mfma_f32_32x32x16_bf16 v[240:255], v[28:31], v[172:175], v[240:255]
    v_mfma_f32_32x32x16_bf16 v[192:207], v[16:19], v[176:179], 0
    v_mfma_f32_32x32x16_bf16 v[192:207], v[20:23], v[180:183], v[192:207]
    v_mfma_f32_32x32x16_bf16 v[208:223], v[24:27], v[184:187], 0
    v_mfma_f32_32x32x16_bf16 v[208:223], v[28:31], v[188:191], v[208:223]
    s_mov_b32 s85, 0
L_kvchk:
    s_waitcnt vmcnt(0)
    v_mfma_f32_32x32x16_bf16 v[60:75], v[96:99], v[160:163], 0
    v_max3_u32 v13, v96, v97, v98
    v_max3_u32 v10, v99, v100, v101
    v_max3_u32 v13, v13, v102, v103
    v_max3_u32 v10, v10, v104, v105
    v_max3_u32 v13, v13, v106, v107
    v_mfma_f32_32x32x16_bf16 v[60:75], v[100:103], v[164:167], v[60:75]
    v_max3_u32 v10, v10, v108, v109
    v_max3_u32 v13, v13, v110, v111
    v_max_u32 v13, v13, v10
    v_cmp_eq_u32_e64 vcc, -1, v13
    s_cbranch_vccnz L_kvspin
    v_mfma_f32_32x32x16_bf16 v[76:91], v[104:107], v[168:171], 0
    v_rcp_f32 v36, v225
    v_rcp_f32 v40, v193
    v_rcp_f32 v38, v241
    v_rcp_f32 v42, v209
    v_mfma_f32_32x32x16_bf16 v[76:91], v[108:111], v[172:175], v[76:91]
    v_mov_b32 v44, 0x358637bd
    v_mov_b32 v45, 0x358637bd
    v_fmac_f32 v44, v224, v36
    v_fmac_f32 v45, v192, v40
    v_fmac_f32 v44, v240, v38
    v_fmac_f32 v45, v208, v42
    v_mfma_f32_32x32x16_bf16 v[128:143], v[96:99], v[176:179], 0
    v_rcp_f32 v44, v44
    v_rcp_f32 v45, v45
    v_mul_f32 v36, v36, v44
    v_mul_f32 v40, v40, v45
    v_mfma_f32_32x32x16_bf16 v[128:143], v[100:103], v[180:183], v[128:143]
    v_mul_f32 v38, v38, v44
    v_mul_f32 v42, v42, v45
    v_mul_f32 v60, v60, v36
    v_mul_f32 v61, v61, v36
    v_mul_f32 v62, v62, v36
    v_mul_f32 v63, v63, v36
    v_mfma_f32_32x32x16_bf16 v[144:159], v[104:107], v[184:187], 0
    v_mul_f32 v64, v64, v36
    v_mul_f32 v65, v65, v36
    v_mul_f32 v66, v66, v36
    v_mul_f32 v67, v67, v36
    v_mul_f32 v68, v68, v36
    v_mul_f32 v69, v69, v36
    v_mfma_f32_32x32x16_bf16 v[144:159], v[108:111], v[188:191], v[144:159]
    v_mul_f32 v70, v70, v36
    v_mul_f32 v71, v71, v36
    v_mul_f32 v72, v72, v36
    v_mul_f32 v73, v73, v36
L_pad9:
    s_cbranch_execz L_padret
    v_mul_f32 v74, v74, v36
    v_mul_f32_e64 v75, v75, v36
    v_pk_fma_f32 v[60:61], v[76:77], v[38:39], v[60:61] op_sel_hi:[1,0,1]
    v_pk_fma_f32 v[62:63], v[78:79], v[38:39], v[62:63] op_sel_hi:[1,0,1]
    v_pk_fma_f32 v[64:65], v[80:81], v[38:39], v[64:65] op_sel_hi:[1,0,1]
    v_pk_fma_f32 v[66:67], v[82:83], v[38:39], v[66:67] op_sel_hi:[1,0,1]
    v_cvt_pk_bf16_f32 v16, v60, v61
    v_cvt_pk_bf16_f32 v17, v62, v63
    v_cvt_pk_bf16_f32 v18, v64, v65
    v_cvt_pk_bf16_f32 v19, v66, v67
    buffer_store_dwordx4 v[16:19], v14, s[36:39], s96 offen offset:0 sc1
    v_pk_fma_f32 v[68:69], v[84:85], v[38:39], v[68:69] op_sel_hi:[1,0,1]
    v_pk_fma_f32 v[70:71], v[86:87], v[38:39], v[70:71] op_sel_hi:[1,0,1]
    v_pk_fma_f32 v[72:73], v[88:89], v[38:39], v[72:73] op_sel_hi:[1,0,1]
    v_pk_fma_f32 v[74:75], v[90:91], v[38:39], v[74:75] op_sel_hi:[1,0,1]
    v_cvt_pk_bf16_f32 v20, v68, v69
    v_cvt_pk_bf16_f32 v21, v70, v71
    v_cvt_pk_bf16_f32 v22, v72, v73
    v_cvt_pk_bf16_f32 v23, v74, v75
    buffer_store_dwordx4 v[20:23], v14, s[36:39], s96 offen offset:1024 sc1
    v_pk_mul_f32 v[128:129], v[128:129], v[40:41] op_sel_hi:[1,0]
    v_pk_mul_f32 v[130:131], v[130:131], v[40:41] op_sel_hi:[1,0]
    v_pk_mul_f32 v[132:133], v[132:133], v[40:41] op_sel_hi:[1,0]
    v_pk_mul_f32 v[134:135], v[134:135], v[40:41] op_sel_hi:[1,0]
    v_pk_fma_f32 v[128:129], v[144:145], v[42:43], v[128:129] op_sel_hi:[1,0,1]
    v_pk_fma_f32 v[130:131], v[146:147], v[42:43], v[130:131] op_sel_hi:[1,0,1]
    v_pk_fma_f32 v[132:133], v[148:149], v[42:43], v[132:133] op_sel_hi:[1,0,1]
    v_pk_fma_f32 v[134:135], v[150:151], v[42:43], v[134:135] op_sel_hi:[1,0,1]
    v_cvt_pk_bf16_f32 v24, v128, v129
    v_cvt_pk_bf16_f32 v25, v130, v131
    v_cvt_pk_bf16_f32 v26, v132, v133
    v_cvt_pk_bf16_f32 v27, v134, v135
    buffer_store_dwordx4 v[24:27], v14, s[36:39], s97 offen offset:0 sc1
    v_pk_mul_f32 v[136:137], v[136:137], v[40:41] op_sel_hi:[1,0]
    v_pk_mul_f32 v[138:139], v[138:139], v[40:41] op_sel_hi:[1,0]
    v_pk_mul_f32 v[140:141], v[140:141], v[40:41] op_sel_hi:[1,0]
    v_pk_mul_f32 v[142:143], v[142:143], v[40:41] op_sel_hi:[1,0]
    v_pk_fma_f32 v[136:137], v[152:153], v[42:43], v[136:137] op_sel_hi:[1,0,1]
    v_pk_fma_f32 v[138:139], v[154:155], v[42:43], v[138:139] op_sel_hi:[1,0,1]
    v_pk_fma_f32 v[140:141], v[156:157], v[42:43], v[140:141] op_sel_hi:[1,0,1]
    v_pk_fma_f32 v[142:143], v[158:159], v[42:43], v[142:143] op_sel_hi:[1,0,1]
    v_cvt_pk_bf16_f32 v28, v136, v137
    v_cvt_pk_bf16_f32 v29, v138, v139
    v_cvt_pk_bf16_f32 v30, v140, v141
    v_cvt_pk_bf16_f32 v31, v142, v143
    buffer_store_dwordx4 v[28:31], v14, s[36:39], s97 offen offset:1024 sc1
    v_and_b32 v8, 31, v2
    v_lshrrev_b32 v9, 5, v2
    v_lshlrev_b32 v10, 3, v9
    s_lshl_b32 s78, s72, 7
    buffer_load_dwordx2 v[32:33], v10, s[64:67], s78 offen offset:0
    buffer_load_dwordx2 v[34:35], v10, s[64:67], s78 offen offset:16
    buffer_load_dwordx2 v[36:37], v10, s[64:67], s78 offen offset:32
    buffer_load_dwordx2 v[38:39], v10, s[64:67], s78 offen offset:48
    buffer_load_dwordx2 v[40:41], v10, s[64:67], s78 offen offset:64
    buffer_load_dwordx2 v[42:43], v10, s[64:67], s78 offen offset:80
    buffer_load_dwordx2 v[44:45], v10, s[64:67], s78 offen offset:96
    buffer_load_dwordx2 v[46:47], v10, s[64:67], s78 offen offset:112
    buffer_load_dwordx4 v[48:51], v14, s[64:67], 0 offen
    buffer_load_dwordx4 v[52:55], v14, s[64:67], 0 offen offset:1024
    s_barrier
    s_lshl_b32 s78, s76, 12
    s_add_u32 s78, s78, 131072
    v_lshl_add_u32 v6, v8, 7, s78
    v_add_u32_e64 v6, v6, v10
    v_bfe_u32 v11, v8, 1, 3
    v_lshl_add_u32 v6, v11, 4, v6
    v_xor_b32 v112, 0, v6
    v_xor_b32 v113, 16, v6
    v_xor_b32 v114, 32, v6
    v_xor_b32 v115, 48, v6
    v_xor_b32_e64 v116, 64, v6
    v_xor_b32 v117, 80, v6
    v_xor_b32 v118, 96, v6
    v_xor_b32 v119, 112, v6
    v_bfe_u32 v11, v2, 2, 2
    v_lshl_add_u32 v12, v9, 2, v11
    v_lshlrev_b32 v12, 7, v12
    v_lshrrev_b32 v11, 1, v11
    v_lshl_add_u32 v12, v11, 6, v12
    v_bfe_u32 v11, v2, 4, 1
    v_lshl_add_u32 v12, v11, 5, v12
    v_and_b32_e64 v11, 3, v2
    v_lshl_add_u32 v12, v11, 3, v12
    s_lshl_b32 s82, s72, 0
    s_and_b32 s82, s82, 15
    s_lshl_b32 s78, s82, 13
    v_add_u32 v4, s78, v12
    v_xor_b32 v5, 64, v4
    s_lshl_b32 s83, s71, 2
    s_add_u32 s83, s83, s76
    s_lshl_b32 s83, s83, 16
    s_add_u32 s83, s83, 4194304
    s_lshl_b32 s82, s82, 12
    s_add_u32 s88, s82, s83
    v_lshlrev_b32_e64 v12, 4, v8
    v_lshl_add_u32 v12, v9, 16, v12
    v_add_u32 v7, 8192, v12
    s_lshl_b32 s94, s71, 17
    s_lshl_b32 s79, s76, 9
    s_add_u32 s94, s94, s79
    s_add_u32 s94, s94, 2097152
    s_lshl_b32 s95, s72, 13
    s_add_u32 s95, s95, s94
    s_lshl_b32 s78, s76, 5
    v_add_u32 v11, s78, v8
    v_and_b32 v13, 7, v8
    v_xor_b32 v13, v13, v9
    v_lshlrev_b32 v13, 4, v13
    v_lshl_add_u32 v13, v11, 8, v13
    v_lshlrev_b32_e64 v10, 3, v11
    v_add_u32 v10, 159744, v10
    s_lshl_b32 s78, s71, 7
    v_add_u32 v11, s78, v11
    s_waitcnt vmcnt(0)
    s_barrier
    ds_read_b64 v[96:97], v112
    ds_read_b64 v[98:99], v113
    ds_read_b64 v[100:101], v114
    ds_read_b64 v[102:103], v115
    ds_read_b64 v[104:105], v116
    ds_read_b64 v[106:107], v117
    ds_read_b64 v[108:109], v118
    ds_read_b64 v[110:111], v119
    v_lshlrev_b32_e64 v60, 16, v32
    v_and_b32 v61, 0xffff0000, v32
    v_lshlrev_b32_e64 v62, 16, v33
    v_and_b32 v63, 0xffff0000, v33
    v_lshlrev_b32_e64 v64, 16, v34
    v_and_b32 v65, 0xffff0000, v34
    v_lshlrev_b32_e64 v66, 16, v35
    v_and_b32 v67, 0xffff0000, v35
    v_lshlrev_b32_e64 v68, 16, v36
    v_and_b32 v69, 0xffff0000, v36
    v_lshlrev_b32_e64 v70, 16, v37
    v_and_b32 v71, 0xffff0000, v37
    v_lshlrev_b32_e64 v72, 16, v38
    v_and_b32 v73, 0xffff0000, v38
    v_lshlrev_b32_e64 v74, 16, v39
    v_and_b32 v75, 0xffff0000, v39
    v_lshlrev_b32_e64 v76, 16, v40
    v_and_b32 v77, 0xffff0000, v40
    v_lshlrev_b32_e64 v78, 16, v41
    v_and_b32 v79, 0xffff0000, v41
    v_lshlrev_b32_e64 v80, 16, v42
    v_and_b32 v81, 0xffff0000, v42
    v_lshlrev_b32_e64 v82, 16, v43
    v_and_b32 v83, 0xffff0000, v43
    v_lshlrev_b32_e64 v84, 16, v44
    v_and_b32 v85, 0xffff0000, v44
    v_lshlrev_b32_e64 v86, 16, v45
    v_and_b32 v87, 0xffff0000, v45
    v_lshlrev_b32_e64 v88, 16, v46
    v_and_b32 v89, 0xffff0000, v46
    v_lshlrev_b32_e64 v90, 16, v47
    v_and_b32 v91, 0xffff0000, v47
    s_mov_b32 s78, 0x3f803f80
    v_dot2_f32_bf16 v126, v48, s78, 0
    v_dot2_f32_bf16 v126, v49, s78, v126
    v_dot2_f32_bf16 v126, v50, s78, v126
    v_dot2_f32_bf16 v126, v51, s78, v126
    v_dot2_f32_bf16 v126, v52, s78, v126
    v_dot2_f32_bf16 v126, v53, s78, v126
    v_dot2_f32_bf16 v126, v54, s78, v126
    v_dot2_f32_bf16 v126, v55, s78, v126
    s_nop 2
    v_add_f32_dpp v126, v126, v126 row_ror:8 row_mask:0xf bank_mask:0xf
    s_nop 1
    v_add_f32_dpp v126, v126, v126 row_ror:4 row_mask:0xf bank_mask:0xf
    s_nop 1
    v_add_f32_dpp v126, v126, v126 row_ror:2 row_mask:0xf bank_mask:0xf
    s_nop 1
    v_add_f32_dpp v126, v126, v126 row_ror:1 row_mask:0xf bank_mask:0xf
    v_mov_b32 v127, v126
    s_nop 1
    v_permlane32_swap_b32 v126, v127
    v_add_f32 v126, v126, v127
    v_mov_b32 v127, v126
    s_nop 1
    v_permlane16_swap_b32 v126, v127
    v_add_f32 v126, v126, v127
    v_mov_b32 v44, 163328
    v_mov_b32_e64 v45, 1
    v_mov_b32 v46, 0xff800000
    v_mov_b32_e64 v47, 0
    ds_write_b64 v44, v[46:47]
    s_lshl_b32 s96, s71, 4
    s_add_u32 s96, s96, s72
    s_lshl_b32 s96, s96, 9
    s_add_u32 s96, s96, 524288
    v_mov_b32 v15, 163584
    ds_read_b32 v15, v15
    s_waitcnt lgkmcnt(0)
    v_readfirstlane_b32 s99, v15
    v_lshlrev_b32 v224, 16, v96
    v_and_b32 v225, 0xffff0000, v96
    v_lshlrev_b32_e64 v226, 16, v97
    v_and_b32 v227, 0xffff0000, v97
    v_lshlrev_b32_e64 v228, 16, v98
    v_and_b32 v229, 0xffff0000, v98
    v_lshlrev_b32_e64 v230, 16, v99
    v_and_b32 v231, 0xffff0000, v99
    v_lshlrev_b32_e64 v232, 16, v100
    v_and_b32 v233, 0xffff0000, v100
    v_lshlrev_b32_e64 v234, 16, v101
    v_and_b32 v235, 0xffff0000, v101
    v_lshlrev_b32_e64 v236, 16, v102
    v_and_b32 v237, 0xffff0000, v102
    v_lshlrev_b32_e64 v238, 16, v103
    v_and_b32 v239, 0xffff0000, v103
    v_lshlrev_b32_e64 v240, 16, v104
    v_and_b32 v241, 0xffff0000, v104
    v_lshlrev_b32_e64 v242, 16, v105
    v_and_b32 v243, 0xffff0000, v105
    v_lshlrev_b32_e64 v244, 16, v106
    v_and_b32 v245, 0xffff0000, v106
    v_lshlrev_b32_e64 v246, 16, v107
    v_and_b32 v247, 0xffff0000, v107
    v_lshlrev_b32_e64 v248, 16, v108
    v_and_b32 v249, 0xffff0000, v108
    v_lshlrev_b32_e64 v250, 16, v109
    v_and_b32 v251, 0xffff0000, v109
    v_lshlrev_b32_e64 v252, 16, v110
    v_and_b32 v253, 0xffff0000, v110
    v_lshlrev_b32_e64 v254, 16, v111
    v_and_b32 v255, 0xffff0000, v111
    s_mov_b32 s84, 0
    s_barrier
    buffer_load_dwordx4 v[160:163], v14, s[36:39], s88 offen offset:0 sc1
    ds_read_b64_tr_b16 v[128:129], v4 offset:0
    buffer_load_dwordx4 v[164:167], v14, s[36:39], s88 offen offset:1024 sc1
    ds_read_b64_tr_b16 v[130:131], v4 offset:1024
    buffer_load_dwordx4 v[168:171], v14, s[36:39], s88 offen offset:2048 sc1
    ds_read_b64_tr_b16 v[132:133], v5 offset:0
    buffer_load_dwordx4 v[172:175], v14, s[36:39], s88 offen offset:3072 sc1
    s_add_u32 s82, s82, 4096
    s_and_b32 s82, s82, 0xffff
    s_add_u32 s88, s82, s83
    s_nop 0
    ds_read_b64_tr_b16 v[134:135], v5 offset:1024
    buffer_load_dwordx4 v[176:179], v14, s[36:39], s88 offen offset:0 sc1
    ds_read_b64_tr_b16 v[136:137], v4 offset:2048
    buffer_load_dwordx4 v[180:183], v14, s[36:39], s88 offen offset:1024 sc1
    ds_read_b64_tr_b16 v[138:139], v4 offset:3072
    buffer_load_dwordx4 v[184:187], v14, s[36:39], s88 offen offset:2048 sc1
    ds_read_b64_tr_b16 v[140:141], v5 offset:2048
    buffer_load_dwordx4 v[188:191], v14, s[36:39], s88 offen offset:3072 sc1
    s_add_u32 s82, s82, 4096
    s_and_b32 s82, s82, 0xffff
    s_add_u32 s88, s82, s83
    s_nop 0
    ds_read_b64_tr_b16 v[142:143], v5 offset:3072
    buffer_load_dwordx4 v[192:195], v14, s[36:39], s88 offen offset:0 sc1
    buffer_load_dwordx4 v[196:199], v14, s[36:39], s88 offen offset:1024 sc1
    buffer_load_dwordx4 v[200:203], v14, s[36:39], s88 offen offset:2048 sc1
    buffer_load_dwordx4 v[204:207], v14, s[36:39], s88 offen offset:3072 sc1
    s_add_u32 s82, s82, 4096
    s_and_b32 s82, s82, 0xffff
    s_add_u32 s88, s82, s83
    buffer_load_dwordx4 v[208:211], v14, s[36:39], s88 offen offset:0 sc1
    buffer_load_dwordx4 v[212:215], v14, s[36:39], s88 offen offset:1024 sc1
    .p2align 3
L_G2:
    s_add_u32 s84, s84, 1
    s_waitcnt vmcnt(12) lgkmcnt(6)
    v_mfma_f32_32x32x16_bf16 v[224:239], v[128:131], v[160:163], v[224:239]
    ds_read_b64_tr_b16 v[144:145], v4 offset:4096
    ds_read_b64_tr_b16 v[146:147], v4 offset:5120
    buffer_load_dwordx4 v[216:219], v14, s[36:39], s88 offen offset:2048 sc1
    s_waitcnt lgkmcnt(6)
    v_mfma_f32_32x32x16_bf16 v[240:255], v[132:135], v[160:163], v[240:255]
    ds_read_b64_tr_b16 v[148:149], v5 offset:4096
    ds_read_b64_tr_b16 v[150:151], v5 offset:5120
    s_waitcnt lgkmcnt(6)
    v_mfma_f32_32x32x16_bf16 v[224:239], v[136:139], v[164:167], v[224:239]
    ds_read_b64_tr_b16 v[152:153], v4 offset:6144
    ds_read_b64_tr_b16 v[154:155], v4 offset:7168
    buffer_load_dwordx4 v[220:223], v14, s[36:39], s88 offen offset:3072 sc1
    s_add_u32 s82, s82, 4096
    s_and_b32 s82, s82, 0xffff
    s_add_u32 s88, s82, s83
    s_waitcnt lgkmcnt(6)
    v_mfma_f32_32x32x16_bf16 v[240:255], v[140:143], v[164:167], v[240:255]
    ds_read_b64_tr_b16 v[156:157], v5 offset:6144
    ds_read_b64_tr_b16 v[158:159], v5 offset:7168
    v_add_u32 v4, 0x2000, v4
    v_and_b32 v4, 0x1ffff, v4
    v_xor_b32 v5, 64, v4
    s_waitcnt vmcnt(12) lgkmcnt(6)
    v_mfma_f32_32x32x16_bf16 v[224:239], v[144:147], v[168:171], v[224:239]
    ds_read_b64_tr_b16 v[128:129], v4 offset:0
    ds_read_b64_tr_b16 v[130:131], v4 offset:1024
L_pad10:
    s_cbranch_execz L_padret
    buffer_load_dwordx4 v[160:163], v14, s[36:39], s88 offen offset:0 sc1
    s_waitcnt lgkmcnt(6)
    v_mfma_f32_32x32x16_bf16 v[240:255], v[148:151], v[168:171], v[240:255]
    ds_read_b64_tr_b16 v[132:133], v5 offset:0
    ds_read_b64_tr_b16 v[134:135], v5 offset:1024
    s_waitcnt lgkmcnt(6)
    v_mfma_f32_32x32x16_bf16 v[224:239], v[152:155], v[172:175], v[224:239]
    ds_read_b64_tr_b16 v[136:137], v4 offset:2048
    ds_read_b64_tr_b16 v[138:139], v4 offset:3072
    buffer_load_dwordx4 v[164:167], v14, s[36:39], s88 offen offset:1024 sc1
    s_waitcnt lgkmcnt(6)
    v_mfma_f32_32x32x16_bf16 v[240:255], v[156:159], v[172:175], v[240:255]
    ds_read_b64_tr_b16 v[140:141], v5 offset:2048
    ds_read_b64_tr_b16 v[142:143], v5 offset:3072
    s_waitcnt vmcnt(12) lgkmcnt(6)
    v_mfma_f32_32x32x16_bf16 v[224:239], v[128:131], v[176:179], v[224:239]
    ds_read_b64_tr_b16 v[144:145], v4 offset:4096
    ds_read_b64_tr_b16 v[146:147], v4 offset:5120
    buffer_load_dwordx4 v[168:171], v14, s[36:39], s88 offen offset:2048 sc1
    s_waitcnt lgkmcnt(6)
    v_mfma_f32_32x32x16_bf16 v[240:255], v[132:135], v[176:179], v[240:255]
    ds_read_b64_tr_b16 v[148:149], v5 offset:4096
    ds_read_b64_tr_b16 v[150:151], v5 offset:5120
    s_waitcnt lgkmcnt(6)
    s_nop 0
    v_mfma_f32_32x32x16_bf16 v[224:239], v[136:139], v[180:183], v[224:239]
    ds_read_b64_tr_b16 v[152:153], v4 offset:6144
    ds_read_b64_tr_b16 v[154:155], v4 offset:7168
    buffer_load_dwordx4 v[172:175], v14, s[36:39], s88 offen offset:3072 sc1
    s_add_u32 s82, s82, 4096
    s_and_b32 s82, s82, 0xffff
    s_add_u32 s88, s82, s83
    s_waitcnt lgkmcnt(6)
    v_mfma_f32_32x32x16_bf16 v[240:255], v[140:143], v[180:183], v[240:255]
    ds_read_b64_tr_b16 v[156:157], v5 offset:6144
    ds_read_b64_tr_b16 v[158:159], v5 offset:7168
    v_add_u32 v4, 0x2000, v4
    v_and_b32 v4, 0x1ffff, v4
    v_xor_b32 v5, 64, v4
    s_waitcnt vmcnt(12) lgkmcnt(6)
    v_mfma_f32_32x32x16_bf16 v[224:239], v[144:147], v[184:187], v[224:239]
    ds_read_b64_tr_b16 v[128:129], v4 offset:0
    ds_read_b64_tr_b16 v[130:131], v4 offset:1024
    buffer_load_dwordx4 v[176:179], v14, s[36:39], s88 offen offset:0 sc1
    s_waitcnt lgkmcnt(6)
    v_mfma_f32_32x32x16_bf16 v[240:255], v[148:151], v[184:187], v[240:255]
    ds_read_b64_tr_b16 v[132:133], v5 offset:0
    ds_read_b64_tr_b16 v[134:135], v5 offset:1024
    s_waitcnt lgkmcnt(6)
    v_mfma_f32_32x32x16_bf16 v[224:239], v[152:155], v[188:191], v[224:239]
    ds_read_b64_tr_b16 v[136:137], v4 offset:2048
    ds_read_b64_tr_b16 v[138:139], v4 offset:3072
    buffer_load_dwordx4 v[180:183], v14, s[36:39], s88 offen offset:1024 sc1
    s_waitcnt lgkmcnt(6)
    v_mfma_f32_32x32x16_bf16 v[240:255], v[156:159], v[188:191], v[240:255]
    ds_read_b64_tr_b16 v[140:141], v5 offset:2048
    ds_read_b64_tr_b16 v[142:143], v5 offset:3072
    s_waitcnt vmcnt(12) lgkmcnt(6)
    v_mfma_f32_32x32x16_bf16 v[224:239], v[128:131], v[192:195], v[224:239]
    ds_read_b64_tr_b16 v[144:145], v4 offset:4096
    ds_read_b64_tr_b16 v[146:147], v4 offset:5120
    buffer_load_dwordx4 v[184:187], v14, s[36:39], s88 offen offset:2048 sc1
    s_waitcnt lgkmcnt(6)
    v_mfma_f32_32x32x16_bf16 v[240:255], v[132:135], v[192:195], v[240:255]
    ds_read_b64_tr_b16 v[148:149], v5 offset:4096
    ds_read_b64_tr_b16 v[150:151], v5 offset:5120
    s_waitcnt lgkmcnt(6)
    v_mfma_f32_32x32x16_bf16 v[224:239], v[136:139], v[196:199], v[224:239]
    ds_read_b64_tr_b16 v[152:153], v4 offset:6144
    ds_read_b64_tr_b16 v[154:155], v4 offset:7168
    buffer_load_dwordx4 v[188:191], v14, s[36:39], s88 offen offset:3072 sc1
    s_add_u32 s82, s82, 4096
    s_and_b32 s82, s82, 0xffff
    s_add_u32 s88, s82, s83
    s_waitcnt lgkmcnt(6)
    v_mfma_f32_32x32x16_bf16 v[240:255], v[140:143], v[196:199], v[240:255]
    ds_read_b64_tr_b16 v[156:157], v5 offset:6144
    ds_read_b64_tr_b16 v[158:159], v5 offset:7168
    v_add_u32 v4, 0x2000, v4
    v_and_b32 v4, 0x1ffff, v4
    v_xor_b32 v5, 64, v4
    s_waitcnt vmcnt(12) lgkmcnt(6)
    v_mfma_f32_32x32x16_bf16 v[224:239], v[144:147], v[200:203], v[224:239]
    ds_read_b64_tr_b16 v[128:129], v4 offset:0
    ds_read_b64_tr_b16 v[130:131], v4 offset:1024
    buffer_load_dwordx4 v[192:195], v14, s[36:39], s88 offen offset:0 sc1
    s_waitcnt lgkmcnt(6)
    v_mfma_f32_32x32x16_bf16 v[240:255], v[148:151], v[200:203], v[240:255]
    ds_read_b64_tr_b16 v[132:133], v5 offset:0
    ds_read_b64_tr_b16 v[134:135], v5 offset:1024
    s_waitcnt lgkmcnt(6)
    v_mfma_f32_32x32x16_bf16 v[224:239], v[152:155], v[204:207], v[224:239]
    ds_read_b64_tr_b16 v[136:137], v4 offset:2048
    ds_read_b64_tr_b16 v[138:139], v4 offset:3072
    buffer_load_dwordx4 v[196:199], v14, s[36:39], s88 offen offset:1024 sc1
    s_waitcnt lgkmcnt(6)
    v_mfma_f32_32x32x16_bf16 v[240:255], v[156:159], v[204:207], v[240:255]
    ds_read_b64_tr_b16 v[140:141], v5 offset:2048
    ds_read_b64_tr_b16 v[142:143], v5 offset:3072
    s_waitcnt vmcnt(12) lgkmcnt(6)
    v_mfma_f32_32x32x16_bf16 v[224:239], v[128:131], v[208:211], v[224:239]
    ds_read_b64_tr_b16 v[144:145], v4 offset:4096
    ds_read_b64_tr_b16 v[146:147], v4 offset:5120
    buffer_load_dwordx4 v[200:203], v14, s[36:39], s88 offen offset:2048 sc1
    s_waitcnt lgkmcnt(6)
    v_mfma_f32_32x32x16_bf16 v[240:255], v[132:135], v[208:211], v[240:255]
    ds_read_b64_tr_b16 v[148:149], v5 offset:4096
    ds_read_b64_tr_b16 v[150:151], v5 offset:5120
    s_waitcnt lgkmcnt(6)
    v_mfma_f32_32x32x16_bf16 v[224:239], v[136:139], v[212:215], v[224:239]
    ds_read_b64_tr_b16 v[152:153], v4 offset:6144
    ds_read_b64_tr_b16 v[154:155], v4 offset:7168
    buffer_load_dwordx4 v[204:207], v14, s[36:39], s88 offen offset:3072 sc1
    s_add_u32 s82, s82, 4096
    s_and_b32 s82, s82, 0xffff
    s_add_u32 s88, s82, s83
    s_waitcnt lgkmcnt(6)
    v_mfma_f32_32x32x16_bf16 v[240:255], v[140:143], v[212:215], v[240:255]
    ds_read_b64_tr_b16 v[156:157], v5 offset:6144
    ds_read_b64_tr_b16 v[158:159], v5 offset:7168
    v_add_u32 v4, 0x2000, v4
    v_and_b32 v4, 0x1ffff, v4
    v_xor_b32 v5, 64, v4
    s_waitcnt vmcnt(12) lgkmcnt(6)
    v_mfma_f32_32x32x16_bf16 v[224:239], v[144:147], v[216:219], v[224:239]
    ds_read_b64_tr_b16 v[128:129], v4 offset:0
    ds_read_b64_tr_b16 v[130:131], v4 offset:1024
    buffer_load_dwordx4 v[208:211], v14, s[36:39], s88 offen offset:0 sc1
    s_waitcnt lgkmcnt(6)
    v_mfma_f32_32x32x16_bf16 v[240:255], v[148:151], v[216:219], v[240:255]
    ds_read_b64_tr_b16 v[132:133], v5 offset:0
    ds_read_b64_tr_b16 v[134:135], v5 offset:1024
    s_waitcnt lgkmcnt(6)
    v_mfma_f32_32x32x16_bf16 v[224:239], v[152:155], v[220:223], v[224:239]
    ds_read_b64_tr_b16 v[136:137], v4 offset:2048
    ds_read_b64_tr_b16 v[138:139], v4 offset:3072
    buffer_load_dwordx4 v[212:215], v14, s[36:39], s88 offen offset:1024 sc1
    s_waitcnt lgkmcnt(6)
    v_mfma_f32_32x32x16_bf16 v[240:255], v[156:159], v[220:223], v[240:255]
    ds_read_b64_tr_b16 v[140:141], v5 offset:2048
    ds_read_b64_tr_b16 v[142:143], v5 offset:3072
    s_cmp_lt_u32 s84, 3
    s_cbranch_scc1 L_G2
    s_waitcnt vmcnt(12) lgkmcnt(6)
    v_mfma_f32_32x32x16_bf16 v[224:239], v[128:131], v[160:163], v[224:239]
    ds_read_b64_tr_b16 v[144:145], v4 offset:4096
    ds_read_b64_tr_b16 v[146:147], v4 offset:5120
    buffer_load_dwordx4 v[216:219], v14, s[36:39], s88 offen offset:2048 sc1
    s_waitcnt lgkmcnt(6)
    v_mfma_f32_32x32x16_bf16 v[240:255], v[132:135], v[160:163], v[240:255]
    ds_read_b64_tr_b16 v[148:149], v5 offset:4096
    ds_read_b64_tr_b16 v[150:151], v5 offset:5120
    s_waitcnt lgkmcnt(6)
    v_mfma_f32_32x32x16_bf16 v[224:239], v[136:139], v[164:167], v[224:239]
    ds_read_b64_tr_b16 v[152:153], v4 offset:6144
    ds_read_b64_tr_b16 v[154:155], v4 offset:7168
    buffer_load_dwordx4 v[220:223], v14, s[36:39], s88 offen offset:3072 sc1
    s_add_u32 s82, s82, 4096
    s_and_b32 s82, s82, 0xffff
    s_add_u32 s88, s82, s83
    s_waitcnt lgkmcnt(6)
    v_mfma_f32_32x32x16_bf16 v[240:255], v[140:143], v[164:167], v[240:255]
    ds_read_b64_tr_b16 v[156:157], v5 offset:6144
    ds_read_b64_tr_b16 v[158:159], v5 offset:7168
    s_barrier
    v_add_u32 v4, 0x2000, v4
    v_and_b32 v4, 0x1ffff, v4
    v_xor_b32_e64 v5, 64, v4
    s_waitcnt vmcnt(12) lgkmcnt(6)
    v_mfma_f32_32x32x16_bf16 v[224:239], v[144:147], v[168:171], v[224:239]
    ds_read_b64_tr_b16 v[128:129], v4 offset:0
    ds_read_b64_tr_b16 v[130:131], v4 offset:1024
    s_waitcnt lgkmcnt(6)
    v_mfma_f32_32x32x16_bf16 v[240:255], v[148:151], v[168:171], v[240:255]
    ds_read_b64_tr_b16 v[132:133], v5 offset:0
    ds_read_b64_tr_b16 v[134:135], v5 offset:1024
    s_waitcnt lgkmcnt(6)
    v_mfma_f32_32x32x16_bf16 v[224:239], v[152:155], v[172:175], v[224:239]
    ds_read_b64_tr_b16 v[136:137], v4 offset:2048
    ds_read_b64_tr_b16 v[138:139], v4 offset:3072
    s_waitcnt lgkmcnt(6)
    v_mfma_f32_32x32x16_bf16 v[240:255], v[156:159], v[172:175], v[240:255]
    ds_read_b64_tr_b16 v[140:141], v5 offset:2048
    ds_read_b64_tr_b16 v[142:143], v5 offset:3072
    s_waitcnt vmcnt(10) lgkmcnt(6)
    v_mfma_f32_32x32x16_bf16 v[224:239], v[128:131], v[176:179], v[224:239]
    ds_read_b64_tr_b16 v[144:145], v4 offset:4096
    ds_read_b64_tr_b16 v[146:147], v4 offset:5120
    s_waitcnt lgkmcnt(6)
    v_mfma_f32_32x32x16_bf16 v[240:255], v[132:135], v[176:179], v[240:255]
    ds_read_b64_tr_b16 v[148:149], v5 offset:4096
    ds_read_b64_tr_b16 v[150:151], v5 offset:5120
    s_waitcnt lgkmcnt(6)
    v_mfma_f32_32x32x16_bf16 v[224:239], v[136:139], v[180:183], v[224:239]
    ds_read_b64_tr_b16 v[152:153], v4 offset:6144
    ds_read_b64_tr_b16 v[154:155], v4 offset:7168
    s_waitcnt lgkmcnt(6)
    v_mfma_f32_32x32x16_bf16 v[240:255], v[140:143], v[180:183], v[240:255]
    ds_read_b64_tr_b16 v[156:157], v5 offset:6144
    ds_read_b64_tr_b16 v[158:159], v5 offset:7168
    v_add_u32 v4, 0x2000, v4
    v_and_b32 v4, 0x1ffff, v4
    v_xor_b32_e64 v5, 64, v4
    s_waitcnt vmcnt(8) lgkmcnt(6)
    v_mfma_f32_32x32x16_bf16 v[224:239], v[144:147], v[184:187], v[224:239]
    ds_read_b64_tr_b16 v[128:129], v4 offset:0
    ds_read_b64_tr_b16 v[130:131], v4 offset:1024
    s_waitcnt lgkmcnt(6)
    v_mfma_f32_32x32x16_bf16 v[240:255], v[148:151], v[184:187], v[240:255]
    ds_read_b64_tr_b16 v[132:133], v5 offset:0
    ds_read_b64_tr_b16 v[134:135], v5 offset:1024
    s_waitcnt lgkmcnt(6)
    v_mfma_f32_32x32x16_bf16 v[224:239], v[152:155], v[188:191], v[224:239]
    ds_read_b64_tr_b16 v[136:137], v4 offset:2048
    ds_read_b64_tr_b16 v[138:139], v4 offset:3072
    s_waitcnt lgkmcnt(6)
    v_mfma_f32_32x32x16_bf16 v[240:255], v[156:159], v[188:191], v[240:255]
    ds_read_b64_tr_b16 v[140:141], v5 offset:2048
    ds_read_b64_tr_b16 v[142:143], v5 offset:3072
    s_waitcnt vmcnt(6) lgkmcnt(6)
    v_mfma_f32_32x32x16_bf16 v[224:239], v[128:131], v[192:195], v[224:239]
    ds_read_b64_tr_b16 v[144:145], v4 offset:4096
    ds_read_b64_tr_b16 v[146:147], v4 offset:5120
    s_waitcnt lgkmcnt(6)
    v_mfma_f32_32x32x16_bf16 v[240:255], v[132:135], v[192:195], v[240:255]
    ds_read_b64_tr_b16 v[148:149], v5 offset:4096
    ds_read_b64_tr_b16 v[150:151], v5 offset:5120
    s_waitcnt lgkmcnt(6)
    v_mfma_f32_32x32x16_bf16 v[224:239], v[136:139], v[196:199], v[224:239]
    ds_read_b64_tr_b16 v[152:153], v4 offset:6144
    ds_read_b64_tr_b16 v[154:155], v4 offset:7168
    s_waitcnt lgkmcnt(6)
    v_mfma_f32_32x32x16_bf16 v[240:255], v[140:143], v[196:199], v[240:255]
    ds_read_b64_tr_b16 v[156:157], v5 offset:6144
    ds_read_b64_tr_b16 v[158:159], v5 offset:7168
    v_add_u32 v4, 0x2000, v4
    v_and_b32 v4, 0x1ffff, v4
    v_xor_b32_e64 v5, 64, v4
    s_waitcnt vmcnt(4) lgkmcnt(6)
    v_mfma_f32_32x32x16_bf16 v[224:239], v[144:147], v[200:203], v[224:239]
    ds_read_b64_tr_b16 v[128:129], v4 offset:0
    ds_read_b64_tr_b16 v[130:131], v4 offset:1024
    s_waitcnt lgkmcnt(6)
    v_mfma_f32_32x32x16_bf16 v[240:255], v[148:151], v[200:203], v[240:255]
    ds_read_b64_tr_b16 v[132:133], v5 offset:0
    ds_read_b64_tr_b16 v[134:135], v5 offset:1024
    s_waitcnt lgkmcnt(6)
    v_mfma_f32_32x32x16_bf16 v[224:239], v[152:155], v[204:207], v[224:239]
    ds_read_b64_tr_b16 v[136:137], v4 offset:2048
    ds_read_b64_tr_b16 v[138:139], v4 offset:3072
    s_waitcnt lgkmcnt(6)
    v_mfma_f32_32x32x16_bf16 v[240:255], v[156:159], v[204:207], v[240:255]
    ds_read_b64_tr_b16 v[140:141], v5 offset:2048
    ds_read_b64_tr_b16 v[142:143], v5 offset:3072
    s_waitcnt vmcnt(2) lgkmcnt(6)
    v_mfma_f32_32x32x16_bf16 v[224:239], v[128:131], v[208:211], v[224:239]
    ds_read_b64_tr_b16 v[144:145], v4 offset:4096
    ds_read_b64_tr_b16 v[146:147], v4 offset:5120
    s_waitcnt lgkmcnt(6)
    v_mfma_f32_32x32x16_bf16 v[240:255], v[132:135], v[208:211], v[240:255]
    ds_read_b64_tr_b16 v[148:149], v5 offset:4096
    ds_read_b64_tr_b16 v[150:151], v5 offset:5120
    s_waitcnt lgkmcnt(6)
    v_mfma_f32_32x32x16_bf16 v[224:239], v[136:139], v[212:215], v[224:239]
    ds_read_b64_tr_b16 v[152:153], v4 offset:6144
    ds_read_b64_tr_b16 v[154:155], v4 offset:7168
    s_waitcnt lgkmcnt(6)
    v_mfma_f32_32x32x16_bf16 v[240:255], v[140:143], v[212:215], v[240:255]
    ds_read_b64_tr_b16 v[156:157], v5 offset:6144
    ds_read_b64_tr_b16 v[158:159], v5 offset:7168
    s_waitcnt vmcnt(0) lgkmcnt(6)
    v_mfma_f32_32x32x16_bf16 v[224:239], v[144:147], v[216:219], v[224:239]
    s_waitcnt lgkmcnt(4)
    v_mfma_f32_32x32x16_bf16 v[240:255], v[148:151], v[216:219], v[240:255]
    s_waitcnt lgkmcnt(2)
    v_mfma_f32_32x32x16_bf16 v[224:239], v[152:155], v[220:223], v[224:239]
    s_waitcnt lgkmcnt(0)
    v_mfma_f32_32x32x16_bf16 v[240:255], v[156:159], v[220:223], v[240:255]
    s_nop 9
    v_pk_mul_f32 v[18:19], v[224:225], v[224:225]
    v_pk_mul_f32 v[20:21], v[224:225], v[60:61]
    v_pk_add_f32 v[16:17], v[224:225], v[226:227]
    v_pk_fma_f32 v[18:19], v[226:227], v[226:227], v[18:19]
    v_pk_fma_f32 v[20:21], v[226:227], v[62:63], v[20:21]
    v_pk_add_f32 v[16:17], v[16:17], v[228:229]
    v_pk_fma_f32 v[18:19], v[228:229], v[228:229], v[18:19]
    v_pk_fma_f32 v[20:21], v[228:229], v[64:65], v[20:21]
    v_pk_add_f32 v[16:17], v[16:17], v[230:231]
    v_pk_fma_f32 v[18:19], v[230:231], v[230:231], v[18:19]
    v_pk_fma_f32 v[20:21], v[230:231], v[66:67], v[20:21]
    v_pk_add_f32 v[16:17], v[16:17], v[232:233]
L_pad11:
    s_cbranch_execz L_padret
    s_nop 0
    v_pk_fma_f32 v[18:19], v[232:233], v[232:233], v[18:19]
    v_pk_fma_f32 v[20:21], v[232:233], v[68:69], v[20:21]
    v_pk_add_f32 v[16:17], v[16:17], v[234:235]
    v_pk_fma_f32 v[18:19], v[234:235], v[234:235], v[18:19]
    v_pk_fma_f32 v[20:21], v[234:235], v[70:71], v[20:21]
    v_pk_add_f32 v[16:17], v[16:17], v[236:237]
    v_pk_fma_f32 v[18:19], v[236:237], v[236:237], v[18:19]
    v_pk_fma_f32 v[20:21], v[236:237], v[72:73], v[20:21]
    v_pk_add_f32 v[16:17], v[16:17], v[238:239]
    v_pk_fma_f32 v[18:19], v[238:239], v[238:239], v[18:19]
    v_pk_fma_f32 v[20:21], v[238:239], v[74:75], v[20:21]
    v_pk_add_f32 v[16:17], v[16:17], v[240:241]
    v_pk_fma_f32 v[18:19], v[240:241], v[240:241], v[18:19]
    v_pk_fma_f32 v[20:21], v[240:241], v[76:77], v[20:21]
    v_pk_add_f32 v[16:17], v[16:17], v[242:243]
    v_pk_fma_f32 v[18:19], v[242:243], v[242:243], v[18:19]
    v_pk_fma_f32 v[20:21], v[242:243], v[78:79], v[20:21]
    v_pk_add_f32 v[16:17], v[16:17], v[244:245]
    v_pk_fma_f32 v[18:19], v[244:245], v[244:245], v[18:19]
    v_pk_fma_f32 v[20:21], v[244:245], v[80:81], v[20:21]
    v_pk_add_f32 v[16:17], v[16:17], v[246:247]
    v_pk_fma_f32 v[18:19], v[246:247], v[246:247], v[18:19]
    v_pk_fma_f32 v[20:21], v[246:247], v[82:83], v[20:21]
    v_pk_add_f32 v[16:17], v[16:17], v[248:249]
    v_pk_fma_f32 v[18:19], v[248:249], v[248:249], v[18:19]
    v_pk_fma_f32 v[20:21], v[248:249], v[84:85], v[20:21]
    v_pk_add_f32 v[16:17], v[16:17], v[250:251]
    v_pk_fma_f32 v[18:19], v[250:251], v[250:251], v[18:19]
    v_pk_fma_f32 v[20:21], v[250:251], v[86:87], v[20:21]
    v_pk_add_f32 v[16:17], v[16:17], v[252:253]
    v_pk_fma_f32 v[18:19], v[252:253], v[252:253], v[18:19]
    v_pk_fma_f32 v[20:21], v[252:253], v[88:89], v[20:21]
    v_pk_add_f32 v[16:17], v[16:17], v[254:255]
    v_pk_fma_f32 v[18:19], v[254:255], v[254:255], v[18:19]
    v_pk_fma_f32 v[20:21], v[254:255], v[90:91], v[20:21]
    v_mov_b32 v27, s75
    v_add_f32 v24, v16, v17
    v_add_f32 v25, v18, v19
    v_add_f32 v26, v20, v21
    v_mov_b32 v28, v24
    v_mov_b32 v29, v25
    v_mov_b32 v30, v26
    v_permlane32_swap_b32 v24, v28
    v_permlane32_swap_b32 v25, v29
    v_permlane32_swap_b32 v26, v30
    v_pk_add_f32 v[24:25], v[24:25], v[28:29]
    v_add_f32 v26, v26, v30
    s_mov_b32 exec_hi, 0
    s_bitcmp1_b32 s99, 0
    s_cbranch_scc0 Lls_47
    buffer_store_dwordx4 v[24:27], v14, s[36:39], s95 offen
Lle_48:
    s_mov_b32 exec_hi, -1
    s_add_u32 s79, s94, 16384
    s_add_u32 s80, s94, 32768
    s_add_u32 s81, s94, 49152
    s_barrier
    v_xor_b32_e64 v112, 0, v13
    ds_write_b128 v112, v[224:227]
    v_xor_b32_e64 v113, 32, v13
    ds_write_b128 v113, v[228:231]
    v_xor_b32_e64 v114, 64, v13
    ds_write_b128 v114, v[232:235]
    buffer_load_dwordx4 v[64:67], v12, s[36:39], s94 offen offset:0 sc1
    buffer_load_dwordx4 v[68:71], v7, s[36:39], s94 offen offset:0 sc1
    buffer_load_dwordx4 v[72:75], v12, s[36:39], s79 offen offset:0 sc1
    buffer_load_dwordx4 v[76:79], v7, s[36:39], s79 offen offset:0 sc1
    buffer_load_dwordx4 v[80:83], v12, s[36:39], s80 offen offset:0 sc1
    buffer_load_dwordx4 v[84:87], v7, s[36:39], s80 offen offset:0 sc1
    buffer_load_dwordx4 v[88:91], v12, s[36:39], s81 offen offset:0 sc1
    buffer_load_dwordx4 v[92:95], v7, s[36:39], s81 offen offset:0 sc1
    v_xor_b32 v115, 96, v13
    ds_write_b128 v115, v[236:239]
    v_xor_b32 v116, 128, v13
    ds_write_b128 v116, v[240:243]
    v_xor_b32 v117, 160, v13
    ds_write_b128 v117, v[244:247]
    v_xor_b32 v118, 192, v13
    ds_write_b128 v118, v[248:251]
    v_xor_b32 v119, 224, v13
    ds_write_b128 v119, v[252:255]
    s_mov_b32 s85, 1
L_gchk:
    s_waitcnt vmcnt(0)
    v_max3_u32 v16, v67, v71, v75
    v_max3_u32 v16, v16, v79, v83
    v_max3_u32 v16, v16, v87, v91
    v_max3_u32 v16, v16, v95, s75
    v_min3_u32 v17, v67, v71, v75
    v_min3_u32 v17, v17, v79, v83
    v_min3_u32 v17, v17, v87, v91
    v_min3_u32 v17, v17, v95, s75
    v_cmp_ne_u32_e64 vcc, v16, v17
    s_cbranch_vccnz Lspin_49
    s_barrier
    v_pk_add_f32 v[64:65], v[64:65], v[68:69]
    v_add_f32_e64 v66, v66, v70
    v_pk_add_f32 v[72:73], v[72:73], v[76:77]
    v_add_f32_e64 v74, v74, v78
    v_pk_add_f32 v[80:81], v[80:81], v[84:85]
    v_add_f32_e64 v82, v82, v86
    v_pk_add_f32 v[88:89], v[88:89], v[92:93]
    v_add_f32_e64 v90, v90, v94
    v_pk_add_f32 v[64:65], v[64:65], v[72:73]
    v_add_f32_e64 v66, v66, v74
    v_pk_add_f32 v[80:81], v[80:81], v[88:89]
    v_add_f32 v82, v82, v90
    v_add_f32 v24, v64, v80
    v_add_f32 v25, v65, v81
    v_add_f32 v26, v66, v82
    v_mov_b32 v28, v24
    v_mov_b32 v29, v25
    v_mov_b32 v30, v26
    v_permlane32_swap_b32 v24, v28
    v_permlane32_swap_b32 v25, v29
    v_permlane32_swap_b32 v26, v30
    v_pk_add_f32 v[24:25], v[24:25], v[28:29]
    v_add_f32_e64 v26, v26, v30
    v_mul_f32 v36, 0x3a800000, v24
    v_mul_f32 v40, 0x3a800000, v25
    v_fma_f32 v40, -v36, v36, v40
    v_max_f32_e64 v40, 0, v40
    v_cvt_pk_bf16_f32 v36, v36, v36
    v_and_b32 v36, 0xffff0000, v36
    v_cvt_pk_bf16_f32 v40, v40, v40
    v_and_b32 v40, 0xffff0000, v40
    v_add_f32 v40, 0x3727c5ac, v40
    v_cvt_pk_bf16_f32 v40, v40, v40
    v_and_b32 v40, 0xffff0000, v40
    v_sqrt_f32 v40, v40
    s_nop 0
    v_cvt_pk_bf16_f32 v40, v40, v40
    v_and_b32 v40, 0xffff0000, v40
    v_rcp_f32_e64 v38, v40
    v_fma_f32 v42, -v36, v126, v26
    s_mov_b32 s79, 0xfffff800
    v_mul_f32_e64 v42, v42, v38
    v_mul_f32 v39, -v36, v38
    v_and_or_b32 v42, v42, s79, v11
    s_mov_b32 exec_hi, 0
    ds_write_b64 v10, v[38:39]
    ds_max_f32 v44, v42
    s_mov_b32 exec_lo, 1
    ds_add_rtn_u32 v46, v44, v45 offset:4
    s_mov_b32 exec_lo, -1
    ds_read_b32 v20, v44
    v_lshlrev_b32 v17, 3, v2
    v_lshlrev_b32 v18, 2, v2
    v_mov_b32_e64 v21, s75
    s_mov_b32 s79, s96
    s_waitcnt lgkmcnt(0)
    v_readfirstlane_b32 s78, v46
    s_cmp_lg_u32 s78, 3
    s_cbranch_scc1 L_nocand
    s_mov_b32 exec_lo, 0xffff
    buffer_store_dwordx2 v[20:21], v17, s[36:39], s79 offen offset:128 sc1
    s_mov_b32 exec_lo, -1
    v_and_b32 v22, 127, v20
    v_and_b32 v23, 7, v20
    v_lshlrev_b32 v23, 4, v23
    v_xor_b32 v23, v23, v17
    v_lshl_add_u32 v23, v22, 8, v23
    v_lshlrev_b32_e64 v22, 3, v22
    ds_read_b64 v[24:25], v23
    v_add_u32 v22, 159744, v22
    ds_read_b64 v[26:27], v22
    s_waitcnt lgkmcnt(0)
    v_fma_f32 v28, v24, v26, v27
    v_fma_f32 v29, v25, v26, v27
    v_cvt_pk_bf16_f32 v30, v28, v29
    buffer_store_dword v30, v18, s[36:39], s79 offen sc1
    v_add_f32 v28, v28, v24
    v_add_f32_e64 v29, v29, v25
    buffer_store_dwordx2 v[28:29], v17, s[36:39], s79 offen offset:256 sc1
L_nocand:
    s_mov_b32 exec_hi, -1
    v_lshrrev_b32 v16, 3, v2
    v_and_b32 v17, 7, v2
    s_lshl_b32 s78, s76, 5
    v_add_u32 v18, s78, v16
    v_lshlrev_b32 v19, 1, v17
    v_xor_b32 v19, v19, v16
    v_lshlrev_b32 v19, 4, v19
    v_lshl_add_u32 v19, v18, 8, v19
    v_xor_b32 v32, 16, v19
    v_lshlrev_b32 v33, 3, v18
    v_add_u32 v33, 159744, v33
    ds_read_b128 v[64:67], v19 offset:0
    ds_read_b128 v[68:71], v32 offset:0
    ds_read_b64 v[96:97], v33 offset:0
    ds_read_b128 v[72:75], v19 offset:2048
    ds_read_b128 v[76:79], v32 offset:2048
    ds_read_b64 v[98:99], v33 offset:64
    ds_read_b128 v[80:83], v19 offset:4096
    ds_read_b128 v[84:87], v32 offset:4096
    ds_read_b64 v[100:101], v33 offset:128
    ds_read_b128 v[88:91], v19 offset:6144
    ds_read_b128 v[92:95], v32 offset:6144
    ds_read_b64 v[102:103], v33 offset:192
    s_lshl_b32 s78, s71, 7
    v_add_u32_e64 v18, s78, v18
    s_lshl_b32 s79, s72, 7
    v_lshl_add_u32 v19, v18, 11, s79
    v_lshl_add_u32 v19, v17, 4, v19
    v_mov_b32 v16, 163360
    s_waitcnt lgkmcnt(0)
    v_add_f32 v96, 1.0, v96
    v_pk_fma_f32 v[64:65], v[64:65], v[96:97], v[96:97] op_sel:[0,0,1] op_sel_hi:[1,0,1]
    v_pk_fma_f32 v[66:67], v[66:67], v[96:97], v[96:97] op_sel:[0,0,1] op_sel_hi:[1,0,1]
    v_pk_fma_f32 v[68:69], v[68:69], v[96:97], v[96:97] op_sel:[0,0,1] op_sel_hi:[1,0,1]
    v_pk_fma_f32 v[70:71], v[70:71], v[96:97], v[96:97] op_sel:[0,0,1] op_sel_hi:[1,0,1]
    v_cvt_pk_bf16_f32 v104, v64, v65
    v_cvt_pk_bf16_f32 v105, v66, v67
    v_cvt_pk_bf16_f32 v106, v68, v69
    v_cvt_pk_bf16_f32 v107, v70, v71
    v_add_f32_e64 v98, 1.0, v98
    v_pk_fma_f32 v[72:73], v[72:73], v[98:99], v[98:99] op_sel:[0,0,1] op_sel_hi:[1,0,1]
    v_pk_fma_f32 v[74:75], v[74:75], v[98:99], v[98:99] op_sel:[0,0,1] op_sel_hi:[1,0,1]
    v_pk_fma_f32 v[76:77], v[76:77], v[98:99], v[98:99] op_sel:[0,0,1] op_sel_hi:[1,0,1]
    v_pk_fma_f32 v[78:79], v[78:79], v[98:99], v[98:99] op_sel:[0,0,1] op_sel_hi:[1,0,1]
    v_cvt_pk_bf16_f32 v108, v72, v73
    v_cvt_pk_bf16_f32 v109, v74, v75
    v_cvt_pk_bf16_f32 v110, v76, v77
    v_cvt_pk_bf16_f32 v111, v78, v79
    v_add_f32_e64 v100, 1.0, v100
    v_pk_fma_f32 v[80:81], v[80:81], v[100:101], v[100:101] op_sel:[0,0,1] op_sel_hi:[1,0,1]
    v_pk_fma_f32 v[82:83], v[82:83], v[100:101], v[100:101] op_sel:[0,0,1] op_sel_hi:[1,0,1]
    v_pk_fma_f32 v[84:85], v[84:85], v[100:101], v[100:101] op_sel:[0,0,1] op_sel_hi:[1,0,1]
    v_pk_fma_f32 v[86:87], v[86:87], v[100:101], v[100:101] op_sel:[0,0,1] op_sel_hi:[1,0,1]
    v_cvt_pk_bf16_f32 v112, v80, v81
    v_cvt_pk_bf16_f32 v113, v82, v83
    v_cvt_pk_bf16_f32 v114, v84, v85
    v_cvt_pk_bf16_f32 v115, v86, v87
    v_add_f32_e64 v102, 1.0, v102
    v_pk_fma_f32 v[88:89], v[88:89], v[102:103], v[102:103] op_sel:[0,0,1] op_sel_hi:[1,0,1]
    v_pk_fma_f32 v[90:91], v[90:91], v[102:103], v[102:103] op_sel:[0,0,1] op_sel_hi:[1,0,1]
    v_pk_fma_f32 v[92:93], v[92:93], v[102:103], v[102:103] op_sel:[0,0,1] op_sel_hi:[1,0,1]
    v_pk_fma_f32 v[94:95], v[94:95], v[102:103], v[102:103] op_sel:[0,0,1] op_sel_hi:[1,0,1]
    v_cvt_pk_bf16_f32 v116, v88, v89
    v_cvt_pk_bf16_f32 v117, v90, v91
    v_cvt_pk_bf16_f32 v118, v92, v93
    v_cvt_pk_bf16_f32 v119, v94, v95
    s_barrier
    ds_read_b32 v17, v16
    s_waitcnt lgkmcnt(0)
    v_and_b32 v17, 0x7ff, v17
    v_sub_u32 v17, v17, v18
    s_barrier
    s_mov_b32 s78, 0
    v_cmp_ne_u32 vcc, 0, v17
    s_mov_b64 exec, vcc
    s_cbranch_execz Lo_50
    buffer_store_dwordx4 v[104:107], v19, s[44:47], s78 offen sc1
Lo_50:
    s_mov_b64 exec, -1
    s_mov_b32 s78, 16384
    v_cmp_ne_u32 vcc, 8, v17
    s_mov_b64 exec, vcc
    s_cbranch_execz Lo_51
    buffer_store_dwordx4 v[108:111], v19, s[44:47], s78 offen sc1
Lo_51:
    s_mov_b64 exec, -1
    s_barrier
    s_mov_b32 s78, 32768
    v_cmp_ne_u32_e64 vcc, 16, v17
    s_mov_b64 exec, vcc
    s_cbranch_execz Lo_52
    buffer_store_dwordx4 v[112:115], v19, s[44:47], s78 offen sc1
Lo_52:
    s_mov_b64 exec, -1
    s_mov_b32 s78, 49152
    v_cmp_ne_u32 vcc, 24, v17
    s_mov_b64 exec, vcc
    s_cbranch_execz Lo_53
    buffer_store_dwordx4 v[116:119], v19, s[44:47], s78 offen sc1
Lo_53:
    s_mov_b64 exec, -1
    s_branch L_fin
L_pad12:
    s_cbranch_execz L_padret
    s_endpgm
Lspin_49:
    buffer_load_dwordx4 v[64:67], v12, s[36:39], s94 offen offset:0 sc1
    buffer_load_dwordx4 v[68:71], v7, s[36:39], s94 offen offset:0 sc1
    buffer_load_dwordx4 v[72:75], v12, s[36:39], s79 offen offset:0 sc1
    buffer_load_dwordx4 v[76:79], v7, s[36:39], s79 offen offset:0 sc1
    buffer_load_dwordx4 v[80:83], v12, s[36:39], s80 offen offset:0 sc1
    buffer_load_dwordx4 v[84:87], v7, s[36:39], s80 offen offset:0 sc1
    buffer_load_dwordx4 v[88:91], v12, s[36:39], s81 offen offset:0 sc1
    buffer_load_dwordx4 v[92:95], v7, s[36:39], s81 offen offset:0 sc1
    s_add_u32 s85, s85, 1
    s_cmp_gt_u32 s85, 400000
    s_cbranch_scc1 L_end
    s_branch L_gchk
L_kvspin:
    buffer_load_dwordx4 v[96:99], v11, s[36:39], s94 offen offset:0 sc1
    buffer_load_dwordx4 v[100:103], v11, s[36:39], s94 offen offset:2048 sc1
    buffer_load_dwordx4 v[104:107], v11, s[36:39], s95 offen offset:0 sc1
    buffer_load_dwordx4 v[108:111], v11, s[36:39], s95 offen offset:2048 sc1
    s_add_u32 s85, s85, 1
    s_cmp_gt_u32 s85, 400000
    s_cbranch_scc1 L_end
    s_nop 3
    s_branch L_kvchk
Lls_47:
    buffer_store_dwordx4 v[24:27], v14, s[36:39], s95 offen sc1
    s_nop 1
    s_branch Lle_48
L_fin:
L_end:
    s_endpgm
.fill 64, 4, 0xbf800000
s_endpgm
.section .rodata,"a"
.p2align 6
.amdhsa_kernel sequential_preLN__linear_kernel_hedgehog__moe_arch_mod__prompt_kernel
  .amdhsa_next_free_vgpr 256
  .amdhsa_next_free_sgpr 102
  .amdhsa_accum_offset 256
  .amdhsa_group_segment_fixed_size 0
  .amdhsa_kernarg_size 96
  .amdhsa_user_sgpr_count 2
  .amdhsa_user_sgpr_kernarg_segment_ptr 1
  .amdhsa_system_sgpr_workgroup_id_x 1
  .amdhsa_float_denorm_mode_32 3
.end_amdhsa_kernel
```

```asm
; @launch grid=(256,1,1) block=(512,1,1) lds=163840
.amdgcn_target "amdgcn-amd-amdhsa--gfx950"
.text
.globl sequential_preLN__linear_kernel_hedgehog__moe_arch_mod__prompt_kernel
.p2align 8
.type sequential_preLN__linear_kernel_hedgehog__moe_arch_mod__prompt_kernel,@function
sequential_preLN__linear_kernel_hedgehog__moe_arch_mod__prompt_kernel:
    s_cmp_ge_u32 s2, 256
    s_cbranch_scc1 L_end
    s_load_dwordx16 s[4:19], s[0:1], 0
    s_load_dwordx8 s[20:27], s[0:1], 64
    v_lshrrev_b32 v1, 6, v0
    v_and_b32_e64 v2, 63, v0
    v_readfirstlane_b32 s68, v1
    s_lshr_b32 s69, s2, 4
    s_and_b32 s70, s2, 7
    s_lshl_b32 s70, s70, 1
    s_bfe_u32 s78, s2, 0x10003
    s_or_b32 s70, s70, s78
    s_and_b32 s76, s68, 3
    s_cmp_ge_u32 s68, 4
    s_cbranch_scc1 L_M
    v_lshrrev_b32 v196, 3, v2
    v_and_b32 v197, 7, v2
    v_lshrrev_b32_e64 v198, 4, v2
    s_and_b32 s80, s69, 0
    s_lshl_b32 s89, s76, 11
    s_lshl_b32 s66, s80, 10
    s_or_b32 s66, s66, s89
    s_xor_b32 s67, s66, 1024
    s_lshl_b32 s79, s70, 7
    s_movk_i32 s78, 6144
    v_mov_b32_e64 v199, s79
    v_mad_u32_u24 v199, v196, s78, v199
    s_lshl_b32 s80, s80, 2
    v_and_b32 v200, 2, v196
    v_xor_b32 v200, v200, v197
    v_xor_b32 v200, s80, v200
    v_lshl_add_u32 v199, v200, 4, v199
    s_mul_i32 s78, s66, 48
    s_mul_i32 s79, s67, 48
    v_add_u32 v6, s78, v199
    v_xor_b32 v199, 64, v199
    v_add_u32_e64 v7, s79, v199
    s_and_b32 s80, s70, 0
    s_lshl_b32 s88, s76, 12
    s_lshl_b32 s64, s80, 10
    s_or_b32 s64, s64, s88
    s_xor_b32 s65, s64, 1024
    s_lshl_b32 s80, s80, 2
    s_lshl_b32 s78, s69, 14
    s_add_u32 s78, s78, s64
    s_lshl_b32 s78, s78, 4
    v_lshl_add_u32 v199, v196, 11, s78
    v_xor_b32 v200, v198, v197
    v_xor_b32 v200, s80, v200
    v_lshl_add_u32 v4, v200, 4, v199
    v_xor_b32 v5, 16448, v4
    s_and_b32 s78, s70, 14
    s_and_b32 s79, s69, 14
    s_add_u32 s78, s78, s79
    s_sub_u32 s78, 32, s78
    s_and_b32 s78, s78, 15
    s_lshl_b32 s86, s78, 7
    s_mul_i32 s87, s78, 393216
    s_mov_b32 s30, 0x400000
    s_mov_b32 s31, 0x20000
    s_mov_b32 s34, 0x600000
    s_mov_b32 s35, 0x20000
    s_waitcnt lgkmcnt(0)
    s_mov_b32 s32, s6
    s_and_b32 s33, s7, 0xffff
    s_mov_b32 s28, s4
    s_and_b32 s29, s5, 0xffff
    s_add_u32 m0, s64, 118784
    s_nop 0
    buffer_load_dwordx4 v4, s[28:31], s86 offen offset:0  lds
    s_add_u32 m0, s66, 141312
    s_nop 0
    s_nop 0
    buffer_load_dwordx4 v6, s[32:35], s87 offen offset:2048  lds
    s_add_u32 m0, s64, 120832
    s_add_u32 s101, s86, 32768
    buffer_load_dwordx4 v4, s[28:31], s101 offen offset:0  lds
    s_add_u32 m0, s66, 151552
    s_add_u32 s101, s87, 4096
    buffer_load_dwordx4 v6, s[32:35], s101 offen offset:0  lds
    s_add_u32 m0, s66, 135168
    s_nop 0
    buffer_load_dwordx4 v6, s[32:35], s87 offen offset:0  lds
    s_add_u32 m0, s65, 118784
    s_nop 0
    buffer_load_dwordx4 v5, s[28:31], s86 offen offset:0  lds
    s_add_u32 m0, s67, 141312
    s_nop 0
    s_nop 0
    buffer_load_dwordx4 v7, s[32:35], s87 offen offset:2048  lds
    s_add_u32 m0, s65, 120832
    s_add_u32 s101, s86, 32768
    buffer_load_dwordx4 v5, s[28:31], s101 offen offset:0  lds
    s_add_u32 m0, s67, 151552
    s_add_u32 s101, s87, 4096
    buffer_load_dwordx4 v7, s[32:35], s101 offen offset:0  lds
    s_add_u32 m0, s67, 135168
    s_nop 0
    buffer_load_dwordx4 v7, s[32:35], s87 offen offset:0  lds
    s_add_u32 s86, s86, 128
    s_add_u32 s87, s87, 393216
    s_and_b32 s86, s86, 2047
    s_cselect_b32 s87, s87, 0
    s_mov_b32 s101, 40960
    s_cmp_ge_i32 s64, 0
    s_cselect_b32 s101, 0xfffec000, s101
    s_add_u32 s64, s64, s101
    s_add_u32 s65, s65, s101
    s_add_u32 s66, s66, s101
    s_add_u32 s67, s67, s101
    s_load_dword s75, s[26:27], 0
    s_mov_b32 s60, s8
    s_and_b32 s61, s9, 0xffff
    s_mov_b32 s62, 0x10000
    s_mov_b32 s63, 0x20000
    v_lshlrev_b32 v14, 4, v2
    s_lshl_b32 s78, s70, 12
    s_lshl_b32 s79, s76, 10
    s_add_u32 s78, s78, s79
    s_add_u32 m0, s79, 159744
    s_nop 0
    buffer_load_dwordx4 v14, s[60:63], s78 offen lds
    s_and_b32 s78, s2, 7
    s_lshr_b32 s79, s2, 3
    s_lshl_b32 s71, s78, 1
    s_and_b32 s72, s79, 1
    s_add_u32 s71, s71, s72
    s_lshr_b32 s72, s79, 1
    s_cmp_gt_u32 s70, 3
    s_cselect_b32 s78, 1, 0
    s_cmp_gt_u32 s70, 11
    s_cselect_b32 s78, 2, s78
    s_sub_u32 s78, s70, s78
    s_cmp_eq_u32 s70, 3
    s_cselect_b32 s78, 14, s78
    s_cmp_eq_u32 s70, 11
    s_cselect_b32 s78, 15, s78
    s_lshl_b32 s0, s78, 4
    s_add_u32 s0, s0, s69
    s_lshr_b32 s73, s0, 2
    s_and_b32 s74, s0, 3
    s_lshl_b32 s77, s70, 4
    s_add_u32 s77, s77, s69
    s_getpc_b64 s[12:13]
Lpr_1:
    s_add_u32 s12, s12, L_end-Lpr_1
    s_addc_u32 s13, s13, 0
    s_mov_b32 s36, s26
    s_and_b32 s37, s27, 0xffff
    s_mov_b32 s38, 0x10000000
    s_mov_b32 s39, 0x20000
    s_mov_b32 s40, s10
    s_and_b32 s41, s11, 0xffff
    s_mov_b32 s42, 0x200000
    s_mov_b32 s43, 0x20000
    s_mov_b32 s44, s22
    s_and_b32 s45, s23, 0xffff
    s_mov_b32 s46, 0x400000
    s_mov_b32 s47, 0x20000
    s_mov_b32 s48, s16
    s_and_b32 s49, s17, 0xffff
    s_mov_b32 s50, 0x700000
    s_mov_b32 s51, 0x20000
    s_mov_b32 s52, s18
    s_and_b32 s53, s19, 0xffff
    s_mov_b32 s54, 0x700000
    s_mov_b32 s55, 0x20000
    s_mov_b32 s56, s20
    s_and_b32 s57, s21, 0xffff
    s_mov_b32 s58, 0x700000
    s_mov_b32 s59, 0x20000
    v_mov_b32 v16, -1
    v_mov_b32 v17, -1
    v_mov_b32 v18, -1
    v_mov_b32_e64 v19, -1
    s_lshl_b32 s94, s77, 14
    s_lshl_b32 s78, s76, 12
    s_add_u32 s94, s94, s78
    s_add_u32 s94, s94, 4194304
    s_lshl_b32 s96, s77, 10
    s_add_u32 s96, s96, 8388608
    s_cmp_eq_u32 s76, 3
    s_cselect_b32 s96, s96, 0x10000000
    v_and_b32 v196, 15, v2
    v_lshrrev_b32 v197, 1, v196
    v_lshlrev_b32 v199, 7, v196
    v_add_u32 v199, s88, v199
    v_xor_b32_e64 v200, v198, v197
    v_lshl_add_u32 v60, v200, 4, v199
    v_bfe_u32 v196, v2, 2, 2
    v_and_b32_e64 v197, 3, v2
    v_lshl_add_u32 v199, v198, 3, v196
    v_lshlrev_b32_e64 v199, 7, v199
    v_lshl_add_u32 v199, v197, 3, v199
    v_lshrrev_b32 v196, 1, v196
    v_and_b32 v197, 1, v198
    v_lshl_add_u32 v196, v197, 1, v196
    s_mul_i32 s80, s76, 3
    s_add_u32 s78, s80, 0
    s_and_b32 s79, s78, 3
    s_lshr_b32 s78, s78, 2
    s_lshl_b32 s78, s78, 13
    s_add_u32 s78, s78, 16384
    v_xor_b32 v197, s79, v196
    v_lshl_add_u32 v197, v197, 5, v199
    v_add_u32_e64 v240, s78, v197
    s_add_u32 s78, s80, 1
    s_and_b32 s79, s78, 3
    s_lshr_b32 s78, s78, 2
    s_lshl_b32 s78, s78, 13
    s_add_u32 s78, s78, 16384
    v_xor_b32_e64 v197, s79, v196
    v_lshl_add_u32 v197, v197, 5, v199
    v_add_u32_e64 v241, s78, v197
    s_add_u32 s78, s80, 2
    s_and_b32 s79, s78, 3
    s_lshr_b32 s78, s78, 2
    s_lshl_b32 s78, s78, 13
    s_add_u32 s78, s78, 16384
    v_xor_b32_e64 v197, s79, v196
    v_lshl_add_u32 v197, v197, 5, v199
    v_add_u32 v242, s78, v197
    s_and_b32 s78, s70, 1
    s_lshl_b32 s78, s78, 6
    v_xor_b32 v60, s78, v60
    s_and_b32 s78, s69, 1
    s_lshl_b32 s78, s78, 12
    v_add_u32 v240, s78, v240
    v_add_u32 v241, s78, v241
    v_add_u32_e64 v242, s78, v242
    s_add_u32 m0, s64, 118784
    s_nop 0
    buffer_load_dwordx4 v4, s[28:31], s86 offen offset:0  lds
    v_lshrrev_b32 v196, 3, v2
    v_and_b32 v197, 7, v2
    v_lshlrev_b32 v199, 4, v197
    v_mul_u32_u24 v244, 57344, v196
    s_add_u32 m0, s66, 141312
    s_nop 0
    buffer_load_dwordx4 v6, s[32:35], s87 offen offset:2048  lds
    v_add_u32 v244, v244, v199
    v_lshl_add_u32 v245, v196, 14, v199
    s_lshl_b32 s78, s74, 2
    s_add_u32 s78, s78, s76
    s_add_u32 m0, s64, 120832
    s_add_u32 s101, s86, 32768
    buffer_load_dwordx4 v4, s[28:31], s101 offen offset:0  lds
    s_mul_i32 s79, s78, 458752
    s_add_u32 s80, s73, s76
    s_and_b32 s80, s80, 3
    s_andn2_b32 s100, s73, 3
    s_add_u32 m0, s66, 151552
    s_add_u32 s101, s87, 4096
    buffer_load_dwordx4 v6, s[32:35], s101 offen offset:0  lds
    s_or_b32 s80, s80, s100
    s_lshl_b32 s80, s80, 7
    s_add_u32 s79, s79, s80
    s_cmp_ge_u32 s73, 56
    s_cselect_b32 s79, 0x8000000, s79
    v_add_u32_e64 v244, s79, v244
    s_lshl_b32 s78, s78, 7
    s_add_u32 m0, s66, 135168
    s_nop 0
    buffer_load_dwordx4 v6, s[32:35], s87 offen offset:0  lds
    s_lshl_b32 s80, s73, 17
    s_add_u32 s78, s78, s80
    v_add_u32_e64 v245, s78, v245
    s_lshl_b32 s78, s72, 7
    s_add_u32 m0, s65, 118784
    s_nop 0
    buffer_load_dwordx4 v5, s[28:31], s86 offen offset:0  lds
    v_lshl_add_u32 v196, v196, 11, s78
    v_and_b32 v199, 1, v198
    v_lshlrev_b32 v199, 2, v199
    v_xor_b32 v199, v199, v197
    s_add_u32 m0, s67, 141312
    s_nop 0
    buffer_load_dwordx4 v7, s[32:35], s87 offen offset:2048  lds
    v_lshl_add_u32 v246, v199, 4, v196
    s_lshl_b32 s78, s71, 2
    s_add_u32 s78, s78, s76
    s_lshl_b32 s78, s78, 16
    v_add_u32_e64 v196, s78, v196
    s_add_u32 m0, s65, 120832
    s_add_u32 s101, s86, 32768
    buffer_load_dwordx4 v5, s[28:31], s101 offen offset:0  lds
    v_xor_b32_e64 v199, v198, v197
    v_lshl_add_u32 v247, v199, 4, v196
    v_xor_b32 v248, 64, v247
    s_lshl_b32 s78, s76, 14
    s_add_u32 m0, s67, 151552
    s_add_u32 s101, s87, 4096
    buffer_load_dwordx4 v7, s[32:35], s101 offen offset:0  lds
    v_add_u32 v246, s78, v246
    s_lshl_b32 s84, s76, 10
    s_bfe_u32 s78, s2, 0x40003
    s_lshl_b32 s78, s78, 17
    s_add_u32 m0, s67, 135168
    s_nop 0
    buffer_load_dwordx4 v7, s[32:35], s87 offen offset:0  lds
    s_add_u32 s86, s86, 128
    s_add_u32 s87, s87, 393216
    s_and_b32 s86, s86, 2047
    s_cselect_b32 s87, s87, 0
    s_mov_b32 s101, 40960
    s_cmp_ge_i32 s64, 0
    s_cselect_b32 s101, 0xfffec000, s101
    s_add_u32 s64, s64, s101
    s_add_u32 s65, s65, s101
    s_add_u32 s66, s66, s101
    s_add_u32 s67, s67, s101
    s_and_b32 s79, s72, 8
    s_add_u32 s79, s79, 3
    s_lshl_b32 s79, s79, 7
    s_add_u32 s78, s78, s79
    v_lshl_add_u32 v63, v2, 11, s78
    s_lshl_b32 s100, s69, 2
    s_mov_b32 s92, 0x24362543
    s_mov_b32 s93, 0x26542365
    s_lshr_b64 s[92:93], s[92:93], s100
    s_and_b32 s3, s92, 15
    s_mov_b32 s92, 0x798b7a98
    s_mov_b32 s93, 0x7ba978ba
    s_lshr_b64 s[92:93], s[92:93], s100
    s_and_b32 s97, s92, 15
    s_branch L_sube
    .p2align 6
L_iss:
    s_add_u32 m0, s64, 118784
    s_nop 0
    buffer_load_dwordx4 v4, s[28:31], s86 offen offset:0  lds
    s_add_u32 m0, s66, 141312
    s_nop 0
    buffer_load_dwordx4 v6, s[32:35], s87 offen offset:2048  lds
    s_add_u32 m0, s64, 120832
    s_add_u32 s101, s86, 32768
    buffer_load_dwordx4 v4, s[28:31], s101 offen offset:0  lds
    s_add_u32 m0, s66, 151552
    s_add_u32 s101, s87, 4096
    buffer_load_dwordx4 v6, s[32:35], s101 offen offset:0  lds
    s_add_u32 m0, s66, 135168
    s_nop 0
    buffer_load_dwordx4 v6, s[32:35], s87 offen offset:0  lds
    s_add_u32 m0, s65, 118784
    s_nop 0
    buffer_load_dwordx4 v5, s[28:31], s86 offen offset:0  lds
    s_add_u32 m0, s67, 141312
    s_nop 0
    s_nop 0
    buffer_load_dwordx4 v7, s[32:35], s87 offen offset:2048  lds
    s_add_u32 m0, s65, 120832
    s_add_u32 s101, s86, 32768
    buffer_load_dwordx4 v5, s[28:31], s101 offen offset:0  lds
    s_add_u32 m0, s67, 151552
    s_add_u32 s101, s87, 4096
    buffer_load_dwordx4 v7, s[32:35], s101 offen offset:0  lds
    s_add_u32 m0, s67, 135168
    s_nop 0
    buffer_load_dwordx4 v7, s[32:35], s87 offen offset:0  lds
    s_add_u32 s86, s86, 128
    s_add_u32 s87, s87, 393216
    s_and_b32 s86, s86, 2047
    s_cselect_b32 s87, s87, 0
    s_mov_b32 s101, 40960
    s_cmp_ge_i32 s64, 0
    s_cselect_b32 s101, 0xfffec000, s101
    s_add_u32 s64, s64, s101
    s_add_u32 s65, s65, s101
    s_add_u32 s66, s66, s101
    s_add_u32 s67, s67, s101
    s_setpc_b64 s[90:91]
    .p2align 6
L_cl0:
    s_mov_b32 s100, 0
    buffer_load_dwordx4 v[64:67], v244, s[48:51], s100 offen nt
    s_mov_b32 s100, 0
    buffer_load_dwordx4 v[96:99], v244, s[52:55], s100 offen nt
    s_mov_b32 s100, 7168
    buffer_load_dwordx4 v[68:71], v244, s[48:51], s100 offen nt
    s_mov_b32 s100, 7168
    buffer_load_dwordx4 v[100:103], v244, s[52:55], s100 offen nt
    s_mov_b32 s100, 14336
    buffer_load_dwordx4 v[72:75], v244, s[48:51], s100 offen nt
    s_mov_b32 s100, 14336
    buffer_load_dwordx4 v[104:107], v244, s[52:55], s100 offen nt
    s_setpc_b64 s[90:91]
    .p2align 6
L_cl1:
    s_mov_b32 s100, 21504
    buffer_load_dwordx4 v[76:79], v244, s[48:51], s100 offen nt
    s_mov_b32 s100, 21504
    buffer_load_dwordx4 v[108:111], v244, s[52:55], s100 offen nt
    s_mov_b32 s100, 28672
    buffer_load_dwordx4 v[80:83], v244, s[48:51], s100 offen nt
    s_mov_b32 s100, 28672
    buffer_load_dwordx4 v[112:115], v244, s[52:55], s100 offen nt
    s_mov_b32 s100, 35840
    buffer_load_dwordx4 v[84:87], v244, s[48:51], s100 offen nt
    s_mov_b32 s100, 35840
    buffer_load_dwordx4 v[116:119], v244, s[52:55], s100 offen nt
    s_setpc_b64 s[90:91]
    .p2align 12
L_sube:
    s_waitcnt vmcnt(10)
    s_barrier
    s_call_b64 s[90:91], L_iss
    s_setprio 2
    v_add_u32 v196, 118784, v60
    v_add_u32 v198, 118784, v240
    v_add_u32 v199, 118784, v241
    v_add_u32 v200, 118784, v242
    ds_read_b128 v[20:23], v196 offset:0
    ds_read_b128 v[24:27], v196 offset:2048
    ds_read_b64_tr_b16 v[36:37], v198 offset:0
    ds_read_b64_tr_b16 v[38:39], v198 offset:512
    ds_read_b64_tr_b16 v[44:45], v199 offset:0
    ds_read_b64_tr_b16 v[46:47], v199 offset:512
    ds_read_b64_tr_b16 v[52:53], v200 offset:0
    ds_read_b64_tr_b16 v[54:55], v200 offset:512
    s_setprio 0
    s_waitcnt lgkmcnt(0)
    s_mul_i32 s75, s75, 0x9E3779B1
    s_add_u32 s75, s75, 0x7F4A7C15
    s_waitcnt vmcnt(10)
    s_waitcnt lgkmcnt(0)
    s_barrier
    s_call_b64 s[90:91], L_iss
    s_setprio 2
    s_nop 0
    v_add_u32 v196, 36864, v60
    v_add_u32 v198, 36864, v240
    v_add_u32 v199, 36864, v241
    v_add_u32 v200, 36864, v242
    ds_read_b128 v[28:31], v196 offset:0
    ds_read_b128 v[32:35], v196 offset:2048
    ds_read_b64_tr_b16 v[40:41], v198 offset:0
    ds_read_b64_tr_b16 v[42:43], v198 offset:512
    ds_read_b64_tr_b16 v[48:49], v199 offset:0
    ds_read_b64_tr_b16 v[50:51], v199 offset:512
    ds_read_b64_tr_b16 v[56:57], v200 offset:0
    ds_read_b64_tr_b16 v[58:59], v200 offset:512
    s_setprio 0
    s_getreg_b32 s99, hwreg(HW_REG_XCC_ID, 0, 4)
    v_mov_b32 v10, s75
    v_mov_b32 v11, s99
    v_not_b32 v12, v10
    v_mov_b32 v13, 0
    v_and_b32 v8, 15, v2
    v_lshlrev_b32 v9, 4, v8
    v_add_u32 v9, s69, v9
    s_lshl_b32 s78, s70, 4
    s_xor_b32 s79, s78, 16
    v_mov_b32 v202, s78
    v_mov_b32 v203, s79
    v_cmp_gt_u32 vcc, 32, v2
    s_nop 1
    v_cndmask_b32 v202, v203, v202, vcc
    v_add_u32 v8, v202, v8
    v_cmp_gt_u32 vcc, 16, v2
    s_nop 1
    v_cndmask_b32 v8, v8, v9, vcc
    v_lshlrev_b32_e64 v8, 7, v8
    v_add_u32 v8, 4096, v8
    v_lshlrev_b32 v9, 3, v2
    s_lshl_b32 s82, s77, 7
    s_add_u32 s82, s82, 4096
    s_cmp_gt_u32 s76, 0
    s_cselect_b32 s82, 0x10000000, s82
    s_lshl_b32 s83, s77, 9
    s_add_u32 s83, s83, 8912896
    s_cmp_eq_u32 s76, 2
    s_cselect_b32 s83, s83, 0x10000000
    buffer_store_dwordx2 v[12:13], v9, s[36:39], s83 offen sc1
    s_waitcnt vmcnt(11)
    s_waitcnt lgkmcnt(0)
    s_barrier
    s_call_b64 s[90:91], L_iss
    s_waitcnt vmcnt(11)
    s_cmp_lg_u32 s3, 2
    s_cbranch_scc1 Lcs_2
    s_call_b64 s[90:91], L_cl0
Lcs_2:
    s_barrier
    s_setprio 2
    s_add_u32 m0, s64, 118784
    s_nop 0
    buffer_load_dwordx4 v4, s[28:31], s86 offen offset:0  lds
    v_mov_b32 v200, 0x3f803f80
    v_mov_b32 v201, 0x3f803f80
    v_mov_b32 v202, 0x3f803f80
    v_mov_b32 v203, 0x3f803f80
    s_add_u32 m0, s66, 141312
    s_nop 0
    s_nop 0
    buffer_load_dwordx4 v6, s[32:35], s87 offen offset:2048  lds
    v_mfma_f32_16x16x32_bf16 v[204:207], v[200:203], v[20:23], 0
    v_mfma_f32_16x16x32_bf16 v[212:215], v[20:23], v[20:23], 0
    v_mfma_f32_16x16x32_bf16 v[208:211], v[200:203], v[24:27], 0
    v_mfma_f32_16x16x32_bf16 v[216:219], v[24:27], v[24:27], 0
    s_add_u32 m0, s64, 120832
    s_add_u32 s101, s86, 32768
    buffer_load_dwordx4 v4, s[28:31], s101 offen offset:0  lds
    v_mfma_f32_16x16x32_bf16 v[220:223], v[200:203], v[36:39], 0
    v_mfma_f32_16x16x32_bf16 v[224:227], v[200:203], v[44:47], 0
    v_mfma_f32_16x16x32_bf16 v[228:231], v[200:203], v[52:55], 0
    v_mfma_f32_16x16x32_bf16 v[204:207], v[200:203], v[28:31], v[204:207]
    v_mfma_f32_16x16x32_bf16 v[212:215], v[28:31], v[28:31], v[212:215]
    s_add_u32 m0, s66, 151552
    s_add_u32 s101, s87, 4096
    buffer_load_dwordx4 v6, s[32:35], s101 offen offset:0  lds
    v_mfma_f32_16x16x32_bf16 v[208:211], v[200:203], v[32:35], v[208:211]
    v_mfma_f32_16x16x32_bf16 v[216:219], v[32:35], v[32:35], v[216:219]
    v_mfma_f32_16x16x32_bf16 v[220:223], v[200:203], v[40:43], v[220:223]
    v_mfma_f32_16x16x32_bf16 v[224:227], v[200:203], v[48:51], v[224:227]
    s_add_u32 m0, s66, 135168
    s_nop 0
    buffer_load_dwordx4 v6, s[32:35], s87 offen offset:0  lds
    v_mfma_f32_16x16x32_bf16 v[228:231], v[200:203], v[56:59], v[228:231]
    v_and_b32 v196, 3, v2
    v_cmp_eq_u32 s[90:91], 1, v196
    v_cmp_eq_u32 s[92:93], 2, v196
    v_cmp_eq_u32_e64 vcc, 3, v196
    s_add_u32 m0, s65, 118784
    s_nop 0
    buffer_load_dwordx4 v5, s[28:31], s86 offen offset:0  lds
    v_cndmask_b32 v212, v212, v213, s[90:91]
    v_cndmask_b32 v212, v212, v214, s[92:93]
    v_cndmask_b32 v205, v212, v215, vcc
    v_cndmask_b32 v216, v216, v217, s[90:91]
    s_add_u32 m0, s67, 141312
    s_nop 0
    buffer_load_dwordx4 v7, s[32:35], s87 offen offset:2048  lds
    v_cndmask_b32 v216, v216, v218, s[92:93]
    v_cndmask_b32 v209, v216, v219, vcc
    v_lshrrev_b32_e64 v196, 4, v2
    v_cmp_eq_u32 s[90:91], 1, v196
    v_cmp_eq_u32_e64 vcc, 2, v196
    s_add_u32 m0, s65, 120832
    s_add_u32 s101, s86, 32768
    buffer_load_dwordx4 v5, s[28:31], s101 offen offset:0  lds
    v_cndmask_b32 v220, v220, v224, s[90:91]
    v_cndmask_b32_e64 v220, v220, v228, vcc
    s_mul_i32 s78, s77, 768
    s_mul_i32 s79, s76, 192
    s_add_u32 m0, s67, 151552
    s_add_u32 s101, s87, 4096
    buffer_load_dwordx4 v7, s[32:35], s101 offen offset:0  lds
    s_add_u32 s78, s78, s79
    s_add_u32 s78, s78, 327680
    v_lshlrev_b32 v197, 2, v2
    s_mov_b32 exec_hi, 0xffff
    buffer_store_dword v220, v197, s[36:39], s78 offen sc1
    s_mov_b32 exec_hi, -1
    s_lshl_b32 s78, s69, 4
    s_add_u32 m0, s67, 135168
    s_nop 0
    buffer_load_dwordx4 v7, s[32:35], s87 offen offset:0  lds
    s_add_u32 s86, s86, 128
    s_add_u32 s87, s87, 393216
    s_and_b32 s86, s86, 2047
    s_cselect_b32 s87, s87, 0
    s_mov_b32 s101, 40960
    s_cmp_ge_i32 s64, 0
    s_cselect_b32 s101, 0xfffec000, s101
    s_add_u32 s64, s64, s101
    s_add_u32 s65, s65, s101
    s_add_u32 s66, s66, s101
    s_add_u32 s67, s67, s101
    s_add_u32 s78, s78, s70
    s_lshl_b32 s78, s78, 10
    s_lshl_b32 s79, s76, 8
    s_add_u32 s78, s78, s79
    buffer_store_dwordx4 v[16:19], v14, s[36:39], s96 offen offset:0 sc1
    s_add_u32 s78, s78, 65536
    v_and_b32 v198, 15, v2
    v_lshlrev_b32_e64 v198, 3, v198
    s_mov_b32 exec_lo, 0x00f0000f
    s_mov_b32 exec_hi, 0xf0000f00
    buffer_store_dwordx2 v[204:205], v198, s[36:39], s78 offen offset:0 sc1
    s_mov_b64 exec, -1
    s_mov_b32 exec_lo, 0x00f0000f
    s_mov_b32 exec_hi, 0xf0000f00
    buffer_store_dwordx2 v[208:209], v198, s[36:39], s78 offen offset:128 sc1
    s_mov_b64 exec, -1
    s_setprio 0
    s_waitcnt vmcnt(14)
    s_cmp_lg_u32 s3, 3
    s_cbranch_scc1 Lcs_3
    s_call_b64 s[90:91], L_cl0
Lcs_3:
    s_barrier
    s_call_b64 s[90:91], L_iss
    s_waitcnt vmcnt(10)
    s_cmp_lg_u32 s3, 4
    s_cbranch_scc1 Lcs_4
    s_call_b64 s[90:91], L_cl0
Lcs_4:
    s_barrier
    s_mov_b64 exec, 0xffff
    buffer_store_dwordx2 v[10:11], v9, s[36:39], s82 offen sc1
    s_mov_b64 exec, -1
    s_call_b64 s[90:91], L_iss
    s_waitcnt vmcnt(11)
    s_cmp_lg_u32 s3, 5
    s_cbranch_scc1 Lcs_5
    s_call_b64 s[90:91], L_cl0
Lcs_5:
    s_barrier
    s_call_b64 s[90:91], L_iss
    s_waitcnt vmcnt(10)
    s_cmp_lg_u32 s3, 6
    s_cbranch_scc1 Lcs_6
    s_call_b64 s[90:91], L_cl0
Lcs_6:
    s_barrier
    s_call_b64 s[90:91], L_iss
    s_waitcnt vmcnt(10)
    s_cmp_lg_u32 s97, 7
    s_cbranch_scc1 Lcs_7
    s_call_b64 s[90:91], L_cl1
Lcs_7:
    s_barrier
    s_call_b64 s[90:91], L_iss
    s_waitcnt vmcnt(10)
    s_cmp_lg_u32 s97, 8
    s_cbranch_scc1 Lcs_8
    s_call_b64 s[90:91], L_cl1
Lcs_8:
    s_barrier
    s_call_b64 s[90:91], L_iss
    s_waitcnt vmcnt(10)
    s_cmp_lg_u32 s97, 9
    s_cbranch_scc1 Lcs_9
    s_call_b64 s[90:91], L_cl1
Lcs_9:
    s_barrier
    s_call_b64 s[90:91], L_iss
    s_waitcnt vmcnt(10)
    s_cmp_lg_u32 s97, 10
    s_cbranch_scc1 Lcs_10
    s_call_b64 s[90:91], L_cl1
Lcs_10:
    s_barrier
    s_call_b64 s[90:91], L_iss
    s_waitcnt vmcnt(10)
    s_cmp_lg_u32 s97, 11
    s_cbranch_scc1 Lcs_11
    s_call_b64 s[90:91], L_cl1
Lcs_11:
    s_barrier
    s_cmp_lg_u32 s76, 0
    s_cbranch_scc1 Lpl_12
    s_mov_b32 exec_hi, 0xffff
    buffer_load_dwordx2 v[10:11], v8, s[36:39], 0 offen sc1
    s_mov_b64 exec, -1
Lpl_12:
    s_call_b64 s[90:91], L_iss
    s_cmp_lg_u32 s76, 1
    s_cbranch_scc1 Lpf_13
    s_getpc_b64 s[90:91]
Lpc_14:
    s_add_u32 s90, s90, L_phend-Lpc_14
    s_addc_u32 s91, s91, 0
    s_lshr_b32 s100, s2, 3
    s_lshl_b32 s100, s100, 10
    s_min_u32 s100, s100, (L_end-L_phend-768)
    v_add_u32 v236, s100, v14
    global_load_dword v236, v236, s[90:91]
Lpf_13:
    s_waitcnt vmcnt(10)
    s_barrier
    s_cmp_lg_u32 s76, 2
    s_cbranch_scc1 Lc4_15
    s_mov_b32 exec_hi, -1
    buffer_load_dword v238, v63, s[40:43], 0 offen
    s_mov_b64 exec, -1
Lc4_15:
    s_call_b64 s[90:91], L_iss
    s_waitcnt vmcnt(10)
    s_cmp_lg_u32 s76, 0
    s_cbranch_scc1 Lpc_16
    s_setprio 2
    s_mov_b32 exec_hi, 0xffff
    s_mov_b32 s85, 0
Lpk_17:
    v_cmp_ne_u32 vcc, s75, v10
    s_cbranch_vccnz Lspin_18
    v_cmp_ne_u32 vcc, s99, v11
    s_mov_b64 exec, -1
    s_lshr_b32 s78, vcc_lo, 16
    s_cselect_b32 s78, 0, 3
    s_cmp_eq_u32 vcc_hi, 0
    s_cselect_b32 s79, 3, 1
    s_and_b32 s78, s78, s79
    s_and_b32 s78, s78, 3
    v_mov_b32_e64 v10, s78
    v_mov_b32 v11, 163584
    ds_write_b32 v11, v10
    s_setprio 0
Lpc_16:
    s_barrier
    v_lshrrev_b32 v196, 4, v2
    v_and_b32 v197, 15, v2
    v_lshlrev_b32_e64 v197, 4, v197
    v_lshl_add_u32 v198, v196, 10, v197
    s_lshl_b32 s78, s69, 14
    s_lshl_b32 s79, s76, 8
    s_add_u32 s78, s78, s79
    s_nop 0
    s_add_u32 s78, s78, 65536
    buffer_load_dwordx4 v[20:23], v198, s[36:39], s78 offen sc1
    s_add_u32 s78, s78, 4096
    buffer_load_dwordx4 v[24:27], v198, s[36:39], s78 offen sc1
    s_add_u32 s78, s78, 4096
    buffer_load_dwordx4 v[28:31], v198, s[36:39], s78 offen sc1
    s_add_u32 s78, s78, 4096
    buffer_load_dwordx4 v[32:35], v198, s[36:39], s78 offen sc1
    v_mul_u32_u24 v198, 768, v196
    v_add_u32_e64 v198, v198, v197
    s_mul_i32 s78, s70, 12288
    s_lshl_b32 s79, s76, 8
    s_add_u32 s78, s78, s79
    s_add_u32 s78, s78, 327680
    s_cmp_eq_u32 s76, 3
    s_nop 0
    s_cselect_b32 s78, 0x10000000, s78
    buffer_load_dwordx4 v[36:39], v198, s[36:39], s78 offen sc1
    s_add_u32 s78, s78, 3072
    buffer_load_dwordx4 v[40:43], v198, s[36:39], s78 offen sc1
    s_add_u32 s78, s78, 3072
    buffer_load_dwordx4 v[44:47], v198, s[36:39], s78 offen sc1
    s_add_u32 s78, s78, 3072
    buffer_load_dwordx4 v[48:51], v198, s[36:39], s78 offen sc1
    s_add_u32 m0, s84, 0
    s_mov_b32 s100, 0
    buffer_load_dwordx4 v246, s[40:43], s100 offen  lds
    s_add_u32 m0, s84, 4096
    s_mov_b32 s100, 65536
    buffer_load_dwordx4 v246, s[40:43], s100 offen  lds
    s_add_u32 m0, s84, 8192
    s_mov_b32 s100, 131072
    buffer_load_dwordx4 v246, s[40:43], s100 offen  lds
    s_add_u32 m0, s84, 12288
    s_mov_b32 s100, 196608
    buffer_load_dwordx4 v246, s[40:43], s100 offen  lds
    s_waitcnt vmcnt(12)
    s_barrier
    s_setprio 2
    s_add_u32 m0, s84, 16384
    s_mov_b32 s100, 262144
    buffer_load_dwordx4 v246, s[40:43], s100 offen  lds
    s_waitcnt vmcnt(9)
    v_add_f32 v20, v20, v24
    v_add_f32 v21, v21, v25
    v_add_f32 v22, v22, v26
    v_add_f32 v23, v23, v27
    v_add_f32 v20, v20, v28
    v_add_f32 v21, v21, v29
    s_add_u32 m0, s84, 20480
    s_mov_b32 s100, 327680
    buffer_load_dwordx4 v246, s[40:43], s100 offen  lds
    v_add_f32 v22, v22, v30
    v_add_f32 v23, v23, v31
    v_add_f32 v20, v20, v32
    v_add_f32 v21, v21, v33
    v_add_f32 v22, v22, v34
    v_add_f32 v23, v23, v35
    s_nop 0
    v_permlane32_swap_b32 v20, v22
    s_add_u32 m0, s84, 24576
    s_mov_b32 s100, 393216
    buffer_load_dwordx4 v246, s[40:43], s100 offen  lds
L_pad0:
    s_cbranch_execz L_pad4
    v_permlane32_swap_b32 v21, v23
    v_add_f32 v20, v20, v22
    v_add_f32 v21, v21, v23
    v_mov_b32 v22, v20
    v_mov_b32 v23, v21
    s_nop 0
    v_permlane16_swap_b32 v20, v22
    v_permlane16_swap_b32 v21, v23
    v_add_f32 v20, v20, v22
    s_add_u32 m0, s84, 28672
    s_mov_b32 s100, 458752
    buffer_load_dwordx4 v246, s[40:43], s100 offen  lds
    v_add_f32_e64 v21, v21, v23
    v_mul_f32 v24, 0x3a800000, v20
    v_mul_f32 v26, 0x3a800000, v21
    v_fma_f32 v26, -v24, v24, v26
    v_max_f32_e64 v26, 0, v26
    v_cvt_pk_bf16_f32 v24, v24, v24
    v_and_b32 v24, 0xffff0000, v24
    s_add_u32 m0, s84, 32768
    s_mov_b32 s100, 524288
    buffer_load_dwordx4 v246, s[40:43], s100 offen  lds
    v_cvt_pk_bf16_f32 v26, v26, v26
    v_and_b32 v26, 0xffff0000, v26
    v_add_f32 v26, 0x3727c5ac, v26
    v_cvt_pk_bf16_f32 v26, v26, v26
    v_and_b32 v26, 0xffff0000, v26
    v_sqrt_f32 v26, v26
    s_nop 0
    v_cvt_pk_bf16_f32 v26, v26, v26
    v_and_b32 v26, 0xffff0000, v26
    s_add_u32 m0, s84, 36864
    s_mov_b32 s100, 589824
    buffer_load_dwordx4 v246, s[40:43], s100 offen  lds
    v_rcp_f32_e64 v25, v26
    v_xor_b32 v26, 0x80000000, v24
    v_lshrrev_b32 v27, 16, v26
    v_or_b32 v26, v26, v27
    v_mov_b32 v27, 0
    v_and_b32 v196, 15, v2
    v_lshrrev_b32_e64 v197, 5, v2
    s_add_u32 m0, s84, 40960
    s_mov_b32 s100, 655360
    buffer_load_dwordx4 v246, s[40:43], s100 offen  lds
    v_lshl_add_u32 v196, v196, 1, v197
    s_lshl_b32 s78, s76, 5
    v_add_u32 v196, s78, v196
    v_lshlrev_b32_e64 v197, 3, v196
    v_add_u32 v197, 159744, v197
    v_lshlrev_b32_e64 v196, 2, v196
    v_add_u32 v196, 162304, v196
    s_add_u32 m0, s84, 45056
    s_mov_b32 s100, 720896
    buffer_load_dwordx4 v246, s[40:43], s100 offen  lds
    ds_write_b64 v197, v[26:27]
    ds_write_b32 v196, v25
    s_waitcnt vmcnt(12)
    v_add_f32 v36, v36, v40
    v_add_f32 v37, v37, v41
    v_add_f32 v38, v38, v42
    v_add_f32 v39, v39, v43
    v_add_f32 v36, v36, v44
    s_add_u32 m0, s84, 49152
    s_mov_b32 s100, 786432
    buffer_load_dwordx4 v246, s[40:43], s100 offen  lds
    v_add_f32 v37, v37, v45
    v_add_f32 v38, v38, v46
    v_add_f32 v39, v39, v47
    v_add_f32 v36, v36, v48
    v_add_f32 v37, v37, v49
    v_add_f32 v38, v38, v50
    v_add_f32_e64 v39, v39, v51
    s_add_u32 m0, s84, 53248
    s_mov_b32 s100, 851968
    buffer_load_dwordx4 v246, s[40:43], s100 offen  lds
    v_permlane32_swap_b32 v36, v38
    v_permlane32_swap_b32 v37, v39
    v_add_f32 v36, v36, v38
    v_add_f32 v37, v37, v39
    s_nop 1
    v_permlane16_swap_b32 v36, v37
    v_add_f32_e64 v36, v36, v37
    v_cvt_pk_bf16_f32 v37, v36, v36
    v_and_b32 v37, 0xffff0000, v37
    s_add_u32 m0, s84, 57344
    s_mov_b32 s100, 917504
    buffer_load_dwordx4 v246, s[40:43], s100 offen  lds
    v_sub_f32_e64 v38, v36, v37
    v_cvt_pk_bf16_f32 v38, v37, v38
    v_mov_b32 v39, 0
    v_and_b32 v196, 15, v2
    v_lshrrev_b32_e64 v197, 4, v2
    v_lshl_add_u32 v196, v196, 2, v197
    s_lshl_b32 s78, s76, 9
    s_add_u32 m0, s84, 61440
    s_mov_b32 s100, 983040
    buffer_load_dwordx4 v246, s[40:43], s100 offen  lds
    s_add_u32 s78, s78, 160768
    v_lshl_add_u32 v196, v196, 3, s78
    v_and_b32 v197, 15, v2
    v_lshlrev_b32_e64 v197, 3, v197
    v_add_u32 v197, 162816, v197
    v_mov_b32 v198, 0x3f803f80
    s_cmp_eq_u32 s76, 3
    s_cselect_b64 vcc, -1, 0
    v_cndmask_b32 v196, v196, v197, vcc
    v_cndmask_b32 v38, v38, v198, vcc
    v_cndmask_b32_e64 v39, v39, v198, vcc
    ds_write_b64 v196, v[38:39]
    s_setprio 0
    s_waitcnt lgkmcnt(0)
    s_barrier
L_phend:
    s_mov_b32 s66, s96
    s_add_u32 m0, s84, 65536
    s_mov_b32 s100, 1048576
    buffer_load_dwordx4 v246, s[40:43], s100 offen  lds
    v_lshrrev_b32 v52, 2, v2
    v_and_b32 v53, 7, v52
    v_and_b32_e64 v55, 3, v2
    s_add_u32 m0, s84, 69632
    s_mov_b32 s100, 1114112
    buffer_load_dwordx4 v246, s[40:43], s100 offen  lds
    v_xor_b32 v53, v53, v55
    v_lshlrev_b32 v52, 7, v52
    v_lshrrev_b32_e64 v55, 1, v55
    s_add_u32 m0, s84, 73728
    s_mov_b32 s100, 1179648
    buffer_load_dwordx4 v246, s[40:43], s100 offen  lds
    v_lshl_add_u32 v52, v55, 3, v52
    s_lshr_b32 s78, s76, 1
    s_and_b32 s79, s76, 1
    s_lshl_b32 s80, s79, 2
    s_add_u32 m0, s84, 77824
    s_mov_b32 s100, 1245184
    buffer_load_dwordx4 v246, s[40:43], s100 offen  lds
    s_lshl_b32 s81, s78, 2
    v_xor_b32 v55, s80, v53
    v_xor_b32 v53, s81, v53
    s_add_u32 m0, s84, 81920
    s_mov_b32 s100, 1310720
    buffer_load_dwordx4 v246, s[40:43], s100 offen  lds
    s_lshl_b32 s80, s78, 14
    s_add_u32 s80, s80, 110592
    v_lshl_add_u32 v196, v55, 4, v52
    v_add_u32 v196, s80, v196
    s_add_u32 m0, s84, 86016
    s_mov_b32 s100, 1376256
    buffer_load_dwordx4 v246, s[40:43], s100 offen  lds
    v_lshl_add_u32 v198, v53, 4, v52
    v_add_u32 v198, 143360, v198
    v_xor_b32_e64 v197, 8, v196
    s_add_u32 m0, s84, 90112
    s_mov_b32 s100, 1441792
    buffer_load_dwordx4 v246, s[40:43], s100 offen  lds
    v_xor_b32_e64 v199, 8, v198
    v_mov_b32 v200, 0x3f803f80
    v_mov_b32 v201, 0x3f803f80
    v_mov_b32 v202, 0x3f803f80
    s_add_u32 m0, s84, 94208
    s_mov_b32 s100, 1507328
    buffer_load_dwordx4 v246, s[40:43], s100 offen  lds
    v_mov_b32 v203, 0x3f803f80
    v_lshrrev_b32 v62, 4, v2
    v_and_b32 v52, 15, v2
    s_add_u32 m0, s84, 98304
    s_mov_b32 s100, 1572864
    buffer_load_dwordx4 v246, s[40:43], s100 offen  lds
    v_lshlrev_b32_e64 v53, 4, v52
    v_lshl_add_u32 v62, v62, 13, v53
    v_lshrrev_b32_e64 v52, 3, v52
    v_lshl_add_u32 v62, v52, 8, v62
    s_add_u32 m0, s84, 102400
    s_mov_b32 s100, 1638400
    buffer_load_dwordx4 v246, s[40:43], s100 offen  lds
    v_xor_b32 v63, 256, v62
    s_lshl_b32 s78, s70, 2
    s_add_u32 s78, s78, s76
    s_add_u32 m0, s84, 106496
    s_mov_b32 s100, 1703936
    buffer_load_dwordx4 v246, s[40:43], s100 offen  lds
    s_lshl_b32 s78, s78, 15
    s_lshl_b32 s79, s69, 9
    s_add_u32 s78, s78, s79
    s_add_u32 s78, s78, 2097152
    s_mov_b32 s100, 2031616
    buffer_load_dwordx4 v[160:163], v246, s[40:43], s100 offen
    s_lshl_b32 s79, s77, 10
    s_lshl_b32 s80, s76, 6
    s_add_u32 s79, s79, s80
    s_mov_b32 s100, 1966080
    buffer_load_dwordx4 v[164:167], v246, s[40:43], s100 offen
    s_add_u32 s79, s79, 8389120
    v_lshrrev_b32 v52, 3, v2
    v_and_b32 v53, 7, v2
    v_lshlrev_b32_e64 v53, 4, v53
    s_mov_b32 s100, 1900544
    buffer_load_dwordx4 v[168:171], v246, s[40:43], s100 offen
    v_lshl_add_u32 v56, v52, 9, v53
    v_lshl_add_u32 v57, v52, 1, v53
    s_lshl_b32 s82, s70, 14
    s_mov_b32 s100, 1835008
    buffer_load_dwordx4 v[172:175], v246, s[40:43], s100 offen
    s_add_u32 s82, s82, s80
    s_add_u32 s82, s82, 8389120
    s_add_u32 s80, s80, 162944
    v_lshrrev_b32_e64 v58, 2, v2
    s_mov_b32 s100, 1769472
    buffer_load_dwordx4 v[176:179], v246, s[40:43], s100 offen
    v_and_b32 v53, 3, v2
    v_lshlrev_b32 v53, 4, v53
    v_lshl_add_u32 v58, v58, 10, v53
    s_mov_b32 s100, 0
    buffer_load_dwordx4 v[180:183], v247, s[28:31], s100 offen
    v_lshl_add_u32 v59, v52, 1, v53
    v_add_u32 v59, s80, v59
    s_lshl_b32 s64, s77, 13
    s_lshl_b32 s80, s76, 7
    s_mov_b32 s100, 16384
    buffer_load_dwordx4 v[184:187], v248, s[28:31], s100 offen
    s_add_u32 s64, s64, s80
    s_add_u32 s64, s64, 2097152
    s_add_u32 s65, s64, 4096
    s_mov_b32 s100, 32768
    buffer_load_dwordx4 v[188:191], v247, s[28:31], s100 offen
    s_lshl_b32 s81, s77, 10
    s_add_u32 s81, s81, s80
    s_add_u32 s81, s81, 8388608
    s_lshl_b32 s80, s71, 9
    s_mov_b32 s100, 49152
    buffer_load_dwordx4 v[192:195], v248, s[28:31], s100 offen
    s_add_u32 s80, s80, 8912896
    v_lshl_add_u32 v61, v2, 13, s80
    v_mov_b32 v52, 163584
    s_lshl_b32 s100, s77, 13
    s_add_u32 s100, s100, s89
    s_add_u32 s100, s100, 2097152
    buffer_load_dwordx4 v[252:255], v14, s[36:39], s100 offen offset:0 sc1
    ds_read_b32 v52, v52
    s_waitcnt lgkmcnt(0)
    v_readfirstlane_b32 s99, v52
    s_and_b32 s94, s69, 1
    s_lshl_b32 s100, s77, 13
    s_add_u32 s100, s100, s89
    s_nop 0
    s_add_u32 s100, s100, 2097152
    buffer_load_dwordx4 v[252:255], v14, s[36:39], s100 offen offset:1024 sc1
    s_mul_i32 s94, s94, 0x00010001
    s_mov_b32 s95, 0xfffefffe
    s_and_b32 s96, s75, 0x00010001
    buffer_load_dwordx4 v[252:255], v14, s[36:39], s66 offen sc1
    v_mov_b32_e64 v54, s96
    s_and_b32 s83, s75, 1
    s_lshl_b32 s83, s83, 16
    s_sub_u32 s83, 0, s83
    s_barrier
    ds_read_b64_tr_b16 v[4:5], v196 offset:0
    ds_read_b64_tr_b16 v[6:7], v196 offset:2048
    ds_read_b64_tr_b16 v[12:13], v198 offset:0
    ds_read_b64_tr_b16 v[14:15], v198 offset:2048
    ds_read_b64_tr_b16 v[8:9], v197 offset:0
    ds_read_b64_tr_b16 v[10:11], v197 offset:2048
    ds_read_b64_tr_b16 v[16:17], v199 offset:0
    ds_read_b64_tr_b16 v[18:19], v199 offset:2048
    ds_read_b64_tr_b16 v[20:21], v196 offset:4096
    ds_read_b64_tr_b16 v[22:23], v196 offset:6144
    ds_read_b64_tr_b16 v[28:29], v198 offset:4096
    ds_read_b64_tr_b16 v[30:31], v198 offset:6144
    ds_read_b64_tr_b16 v[24:25], v197 offset:4096
    ds_read_b64_tr_b16 v[26:27], v197 offset:6144
    s_waitcnt lgkmcnt(10)
    v_mfma_f32_16x16x32_bf16 v[204:207], v[4:7], v[12:15], 0
    ds_read_b64_tr_b16 v[32:33], v199 offset:4096
    ds_read_b64_tr_b16 v[34:35], v199 offset:6144
    s_waitcnt lgkmcnt(10)
    v_mfma_f32_16x16x32_bf16 v[208:211], v[8:11], v[12:15], 0
    ds_read_b64_tr_b16 v[36:37], v196 offset:8192
    ds_read_b64_tr_b16 v[38:39], v196 offset:10240
    s_waitcnt lgkmcnt(10)
    s_nop 0
    v_mfma_f32_16x16x32_bf16 v[216:219], v[8:11], v[16:19], 0
    ds_read_b64_tr_b16 v[44:45], v198 offset:8192
    ds_read_b64_tr_b16 v[46:47], v198 offset:10240
    v_mfma_f32_16x16x32_bf16 v[212:215], v[4:7], v[16:19], 0
    ds_read_b64_tr_b16 v[40:41], v197 offset:8192
    ds_read_b64_tr_b16 v[42:43], v197 offset:10240
    s_waitcnt lgkmcnt(10)
    v_mfma_f32_16x16x32_bf16 v[204:207], v[20:23], v[28:31], v[204:207]
    ds_read_b64_tr_b16 v[48:49], v199 offset:8192
    ds_read_b64_tr_b16 v[50:51], v199 offset:10240
    s_waitcnt lgkmcnt(10)
    v_mfma_f32_16x16x32_bf16 v[208:211], v[24:27], v[28:31], v[208:211]
    ds_read_b64_tr_b16 v[228:229], v196 offset:12288
    ds_read_b64_tr_b16 v[230:231], v196 offset:14336
    s_waitcnt lgkmcnt(10)
    s_nop 0
    v_mfma_f32_16x16x32_bf16 v[216:219], v[24:27], v[32:35], v[216:219]
    ds_read_b64_tr_b16 v[236:237], v198 offset:12288
    ds_read_b64_tr_b16 v[238:239], v198 offset:14336
    v_mfma_f32_16x16x32_bf16 v[212:215], v[20:23], v[32:35], v[212:215]
    ds_read_b64_tr_b16 v[232:233], v197 offset:12288
    ds_read_b64_tr_b16 v[234:235], v197 offset:14336
    s_waitcnt lgkmcnt(10)
    v_mfma_f32_16x16x32_bf16 v[204:207], v[36:39], v[44:47], v[204:207]
    ds_read_b64_tr_b16 v[240:241], v199 offset:12288
    ds_read_b64_tr_b16 v[242:243], v199 offset:14336
    s_waitcnt lgkmcnt(10)
    v_mfma_f32_16x16x32_bf16 v[208:211], v[40:43], v[44:47], v[208:211]
    s_waitcnt lgkmcnt(8)
    v_mfma_f32_16x16x32_bf16 v[216:219], v[40:43], v[48:51], v[216:219]
L_pad1:
    s_cbranch_execz L_pad5
    v_mfma_f32_16x16x32_bf16 v[212:215], v[36:39], v[48:51], v[212:215]
    s_waitcnt lgkmcnt(4)
    v_mfma_f32_16x16x32_bf16 v[204:207], v[228:231], v[236:239], v[204:207]
    s_waitcnt lgkmcnt(2)
    v_mfma_f32_16x16x32_bf16 v[208:211], v[232:235], v[236:239], v[208:211]
    s_waitcnt lgkmcnt(0)
    s_nop 0
    v_mfma_f32_16x16x32_bf16 v[216:219], v[232:235], v[240:243], v[216:219]
    v_mfma_f32_16x16x32_bf16 v[212:215], v[228:231], v[240:243], v[212:215]
    v_mfma_f32_16x16x32_bf16 v[220:223], v[4:7], v[200:203], 0
    v_mfma_f32_16x16x32_bf16 v[224:227], v[8:11], v[200:203], 0
    v_mfma_f32_16x16x32_bf16 v[220:223], v[20:23], v[200:203], v[220:223]
    v_mfma_f32_16x16x32_bf16 v[224:227], v[24:27], v[200:203], v[224:227]
    v_cvt_pk_bf16_f32 v12, v204, v205
    v_cvt_pk_bf16_f32 v13, v206, v207
    v_cvt_pk_bf16_f32 v14, v208, v209
    v_cvt_pk_bf16_f32 v15, v210, v211
    v_mfma_f32_16x16x32_bf16 v[220:223], v[36:39], v[200:203], v[220:223]
    v_add_u32_e64 v12, s94, v12
    v_and_or_b32 v12, v12, s95, v54
    v_mfma_f32_16x16x32_bf16 v[224:227], v[40:43], v[200:203], v[224:227]
    v_add_u32_e64 v13, s94, v13
    v_and_or_b32 v13, v13, s95, v54
    v_mfma_f32_16x16x32_bf16 v[220:223], v[228:231], v[200:203], v[220:223]
    v_add_u32_e64 v14, s94, v14
    v_and_or_b32 v14, v14, s95, v54
    v_mfma_f32_16x16x32_bf16 v[224:227], v[232:235], v[200:203], v[224:227]
    v_add_u32_e64 v15, s94, v15
    v_and_or_b32 v15, v15, s95, v54
    s_bitcmp1_b32 s99, 0
    s_cbranch_scc0 Lls_19
    buffer_store_dwordx4 v[12:15], v62, s[36:39], s78 offen
Lle_20:
    v_cvt_pk_bf16_f32 v28, v212, v213
    v_cvt_pk_bf16_f32 v29, v214, v215
    v_cvt_pk_bf16_f32 v30, v216, v217
    v_cvt_pk_bf16_f32 v31, v218, v219
    v_add_u32_e64 v28, s94, v28
    v_and_or_b32 v28, v28, s95, v54
    v_add_u32_e64 v29, s94, v29
    v_and_or_b32 v29, v29, s95, v54
    v_add_u32_e64 v30, s94, v30
    v_and_or_b32 v30, v30, s95, v54
    v_add_u32_e64 v31, s94, v31
    v_and_or_b32 v31, v31, s95, v54
    s_bitcmp1_b32 s99, 0
    s_cbranch_scc0 Lls_21
    buffer_store_dwordx4 v[28:31], v63, s[36:39], s78 offen
Lle_22:
    v_cvt_pk_bf16_f32 v44, v220, v221
    v_cvt_pk_bf16_f32 v45, v222, v223
    v_cvt_pk_bf16_f32 v46, v224, v225
    v_cvt_pk_bf16_f32 v47, v226, v227
    s_mov_b32 exec_lo, 0x00010001
    s_mov_b32 exec_hi, 0x00010001
    s_bitcmp1_b32 s99, 0
    s_cbranch_scc0 Lls_23
    buffer_store_dwordx4 v[44:47], v2, s[36:39], s79 offen
Lle_24:
    s_mov_b64 exec, -1
    s_mov_b32 s85, 0
Lspin_25:
    buffer_load_dwordx4 v[20:23], v56, s[36:39], s64 offen sc1
    buffer_load_dwordx4 v[24:27], v56, s[36:39], s65 offen sc1
    buffer_load_dwordx4 v[16:19], v58, s[36:39], s82 offen sc1
    s_add_u32 s85, s85, 1
    s_cmp_gt_u32 s85, 400000
    s_cbranch_scc1 L_end
    s_waitcnt vmcnt(0)
    s_nop 0
    v_bitop3_b32 v28, v20, v24, v54 bitop3:0x7e
    v_bitop3_b32 v29, v21, v25, v54 bitop3:0x7e
    v_bitop3_b32 v30, v22, v26, v54 bitop3:0x7e
    v_bitop3_b32 v31, v23, v27, v54 bitop3:0x7e
    v_or3_b32 v28, v28, v29, v30
    v_cmp_eq_u32 s[90:91], -1, v16
    v_or_b32_e64 v28, v28, v31
    v_and_b32 v28, 0x00010001, v28
    v_cmp_ne_u32_e64 vcc, 0, v28
    s_or_b64 vcc, vcc, s[90:91]
    s_cbranch_vccnz Lspin_25
    v_lshl_add_u32 v28, v20, 16, s83
    v_and_b32 v29, 0xfffe0000, v20
    v_lshl_add_u32 v36, v24, 16, s83
    v_and_b32 v37, 0xfffe0000, v24
    v_pk_add_f32 v[28:29], v[28:29], v[36:37]
    v_lshl_add_u32 v30, v21, 16, s83
    v_and_b32 v31, 0xfffe0000, v21
    v_lshl_add_u32 v38, v25, 16, s83
    v_and_b32 v39, 0xfffe0000, v25
    v_pk_add_f32 v[30:31], v[30:31], v[38:39]
    v_lshl_add_u32 v32, v22, 16, s83
    v_and_b32 v33, 0xfffe0000, v22
    v_lshl_add_u32 v40, v26, 16, s83
    v_and_b32 v41, 0xfffe0000, v26
    v_pk_add_f32 v[32:33], v[32:33], v[40:41]
    v_lshl_add_u32 v34, v23, 16, s83
    v_and_b32 v35, 0xfffe0000, v23
    v_lshl_add_u32 v42, v27, 16, s83
    v_and_b32 v43, 0xfffe0000, v27
    v_pk_add_f32 v[34:35], v[34:35], v[42:43]
    v_permlane32_swap_b32 v28, v32
    v_permlane32_swap_b32 v29, v33
    v_permlane32_swap_b32 v30, v34
    v_permlane32_swap_b32 v31, v35
    v_pk_add_f32 v[28:29], v[28:29], v[32:33]
    v_pk_add_f32 v[30:31], v[30:31], v[34:35]
    s_nop 1
    v_permlane16_swap_b32 v28, v30
    v_permlane16_swap_b32_e64 v29, v31
    v_pk_add_f32 v[28:29], v[28:29], v[30:31]
    s_nop 1
    v_add_f32_dpp v28, v28, v28 row_ror:8 row_mask:0xf bank_mask:0xf
    v_add_f32_dpp v29, v29, v29 row_ror:8 row_mask:0xf bank_mask:0xf
    v_cvt_pk_bf16_f32 v36, v28, v29
    s_mov_b32 exec_lo, 0x00ff00ff
    s_mov_b32 exec_hi, 0x00ff00ff
    s_bitcmp1_b32 s99, 0
    s_cbranch_scc0 Lls_26
    buffer_store_dword v36, v57, s[36:39], s81 offen
Lle_27:
    s_mov_b64 exec, -1
    v_lshlrev_b32_e64 v28, 16, v16
    v_and_b32 v29, 0xffff0000, v16
    v_lshlrev_b32_e64 v30, 16, v17
    v_and_b32 v31, 0xffff0000, v17
    v_lshlrev_b32_e64 v32, 16, v18
    v_and_b32 v33, 0xffff0000, v18
    v_lshlrev_b32_e64 v34, 16, v19
    v_and_b32 v35, 0xffff0000, v19
    v_permlane32_swap_b32 v28, v32
    v_permlane32_swap_b32 v29, v33
    v_permlane32_swap_b32 v30, v34
    v_permlane32_swap_b32 v31, v35
    v_pk_add_f32 v[28:29], v[28:29], v[32:33]
    v_pk_add_f32 v[30:31], v[30:31], v[34:35]
    s_nop 1
    v_permlane16_swap_b32 v28, v30
    v_permlane16_swap_b32_e64 v29, v31
    v_pk_add_f32 v[28:29], v[28:29], v[30:31]
    s_nop 1
    v_add_f32_dpp v38, v28, v28 row_ror:8 row_mask:0xf bank_mask:0x3
    s_nop 1
    v_add_f32_dpp v38, v29, v29 row_ror:8 row_mask:0xf bank_mask:0xc
    s_nop 1
    v_add_f32_dpp v37, v38, v38 row_shr:4 row_mask:0xf bank_mask:0xf
    v_cvt_pk_bf16_f32 v37, v37, v37
    s_mov_b32 exec_lo, 0xf0f0f0f0
    s_mov_b32 exec_hi, 0xf0f0f0f0
    ds_write_b16 v59, v37
    s_mov_b64 exec, -1
    s_waitcnt lgkmcnt(0)
    s_barrier
    v_lshlrev_b32 v4, 4, v2
    s_lshl_b32 s78, s76, 10
    s_add_u32 s78, s78, 110592
    v_add_u32 v5, s78, v4
    s_lshl_b32 s78, s76, 12
    s_add_u32 s78, s78, 131072
    v_add_u32 v6, s78, v4
    s_lshl_b32 s100, s77, 9
    s_add_u32 s100, s100, 8912896
    v_mov_b32 v48, s75
    v_mov_b32 v49, s75
    v_lshl_add_u32 v50, v2, 3, s100
    s_lshl_b32 s83, s71, 4
    s_add_u32 s83, s83, s72
    s_lshl_b32 s78, s77, 13
    s_and_b32 s79, s76, 1
    s_lshl_b32 s79, s79, 10
    s_add_u32 s78, s78, s79
    s_add_u32 s78, s78, 2099200
    s_mul_i32 s79, s74, 56
    s_add_u32 s79, s79, s73
    s_lshl_b32 s79, s79, 10
    s_add_u32 s79, s79, 1114112
    s_cmp_eq_u32 s76, 1
    s_cselect_b32 s78, s79, s78
    s_cmp_ge_u32 s73, 56
    s_cselect_b32 s78, 0x10000000, s78
    s_lshl_b32 s79, s83, 11
    s_add_u32 s79, s79, s84
    s_add_u32 s79, s79, 1572864
    s_cmp_lt_u32 s76, 2
    s_cselect_b32 s94, s79, s78
    s_lshl_b32 s79, s83, 9
    s_add_u32 s79, s79, 524288
    s_cmp_eq_u32 s76, 0
    s_cselect_b32 s78, s79, s78
    s_cselect_b32 s79, 0, -1
    v_mov_b32 v56, -1
    v_mov_b32 v57, -1
    v_mov_b32 v58, -1
    v_mov_b32_e64 v59, -1
    s_barrier
    s_mov_b32 s100, 43008
    buffer_load_dwordx4 v[88:91], v244, s[48:51], s100 offen nt
    s_mov_b32 s100, 43008
    buffer_load_dwordx4 v[120:123], v244, s[52:55], s100 offen nt
    s_mov_b32 s100, 50176
    buffer_load_dwordx4 v[92:95], v244, s[48:51], s100 offen nt
    s_mov_b32 s100, 50176
    buffer_load_dwordx4 v[124:127], v244, s[52:55], s100 offen nt
    ds_write_b128 v6, v[180:183] offset:0
    ds_write_b128 v6, v[184:187] offset:1024
    ds_write_b128 v6, v[188:191] offset:2048
    ds_write_b128 v6, v[192:195] offset:3072
    ds_write_b128 v5, v[160:163] offset:16384
    ds_write_b128 v5, v[164:167] offset:12288
    ds_write_b128 v5, v[168:171] offset:8192
    ds_write_b128 v5, v[172:175] offset:4096
    ds_write_b128 v5, v[176:179] offset:0
    s_waitcnt lgkmcnt(0)
    s_barrier
    s_cmp_lg_u32 s76, 0
    s_cbranch_scc1 Lfs_28
    buffer_store_dwordx2 v[48:49], v50, s[36:39], 0 offen sc1
Lfs_28:
    s_and_b32 s100, s76, 2
    s_and_b32 s101, s99, 1
    s_lshl_b32 s100, s100, s101
    s_and_b32 s100, s100, 4
    s_or_b32 s99, s99, s100
    s_mov_b32 exec_hi, s79
    s_bitcmp1_b32 s99, 2
    s_cbranch_scc0 Lls_29
    buffer_store_dwordx4 v[56:59], v4, s[36:39], s78 offen
Lle_30:
    s_mov_b32 exec_hi, -1
    s_mov_b32 s100, 0x05040100
    s_mov_b32 s101, 0x07060302
    v_perm_b32 v7, v68, v64, s100
    v_perm_b32 v68, v68, v64, s101
    v_mov_b32 v64, v7
    v_perm_b32 v7, v69, v65, s100
    v_perm_b32 v69, v69, v65, s101
    v_mov_b32_e64 v65, v7
    v_perm_b32 v7, v70, v66, s100
    v_perm_b32 v70, v70, v66, s101
    v_mov_b32_e64 v66, v7
    v_perm_b32 v7, v71, v67, s100
    v_perm_b32 v71, v71, v67, s101
    v_mov_b32_e64 v67, v7
    v_perm_b32 v7, v100, v96, s100
    v_perm_b32 v100, v100, v96, s101
    v_mov_b32_e64 v96, v7
    v_perm_b32 v7, v101, v97, s100
    v_perm_b32 v101, v101, v97, s101
    v_mov_b32_e64 v97, v7
    v_perm_b32 v7, v102, v98, s100
    v_perm_b32 v102, v102, v98, s101
    v_mov_b32_e64 v98, v7
    v_perm_b32 v7, v103, v99, s100
    v_perm_b32 v103, v103, v99, s101
    v_mov_b32_e64 v99, v7
    v_perm_b32 v7, v76, v72, s100
    v_perm_b32 v76, v76, v72, s101
    v_mov_b32_e64 v72, v7
    v_perm_b32 v7, v77, v73, s100
    v_perm_b32 v77, v77, v73, s101
    v_mov_b32_e64 v73, v7
    v_perm_b32 v7, v78, v74, s100
    v_perm_b32 v78, v78, v74, s101
    v_mov_b32_e64 v74, v7
    v_perm_b32 v7, v79, v75, s100
    v_perm_b32 v79, v79, v75, s101
    v_mov_b32_e64 v75, v7
    v_perm_b32 v7, v108, v104, s100
    v_perm_b32 v108, v108, v104, s101
    v_mov_b32_e64 v104, v7
    v_perm_b32 v7, v109, v105, s100
    v_perm_b32 v109, v109, v105, s101
    v_mov_b32_e64 v105, v7
    v_perm_b32 v7, v110, v106, s100
    v_perm_b32 v110, v110, v106, s101
    v_mov_b32_e64 v106, v7
    v_perm_b32 v7, v111, v107, s100
    v_perm_b32 v111, v111, v107, s101
    v_mov_b32_e64 v107, v7
    v_perm_b32 v7, v84, v80, s100
    v_perm_b32 v84, v84, v80, s101
    v_mov_b32_e64 v80, v7
    v_perm_b32 v7, v85, v81, s100
    v_perm_b32 v85, v85, v81, s101
    v_mov_b32_e64 v81, v7
    v_perm_b32 v7, v86, v82, s100
    v_perm_b32 v86, v86, v82, s101
    v_mov_b32_e64 v82, v7
    v_perm_b32 v7, v87, v83, s100
    v_perm_b32 v87, v87, v83, s101
    v_mov_b32_e64 v83, v7
    v_perm_b32 v7, v116, v112, s100
    v_perm_b32 v116, v116, v112, s101
    v_mov_b32_e64 v112, v7
    v_perm_b32 v7, v117, v113, s100
    v_perm_b32 v117, v117, v113, s101
    v_mov_b32_e64 v113, v7
    v_perm_b32 v7, v118, v114, s100
    v_perm_b32 v118, v118, v114, s101
    v_mov_b32_e64 v114, v7
    v_perm_b32 v7, v119, v115, s100
    v_perm_b32 v119, v119, v115, s101
    v_mov_b32_e64 v115, v7
    s_cmp_lg_u32 s76, 2
    s_cbranch_scc1 Lf2_31
    s_mov_b64 exec, 0xffff
L_pad2:
    s_cbranch_execz L_pad6
    s_mov_b32 s101, 0
    s_mov_b32 s85, 0
Lspin_32:
    buffer_load_dword v52, v61, s[36:39], s101 offen sc1
    s_add_u32 s101, s101, 128
    s_min_u32 s101, s101, 384
    s_add_u32 s85, s85, 1
    s_cmp_gt_u32 s85, 400000
    s_cbranch_scc1 L_end
    s_waitcnt vmcnt(0)
    v_cmp_ne_u32_e64 vcc, s75, v52
    s_cbranch_vccnz Lspin_32
    s_mov_b64 exec, -1
Lf2_31:
    s_barrier
    s_waitcnt vmcnt(0)
    s_mov_b32 s100, 0x05040100
    s_mov_b32 s101, 0x07060302
    v_perm_b32 v7, v92, v88, s100
    v_perm_b32 v92, v92, v88, s101
    v_mov_b32_e64 v88, v7
    v_perm_b32 v7, v93, v89, s100
    v_perm_b32 v93, v93, v89, s101
    v_mov_b32_e64 v89, v7
    v_perm_b32 v7, v94, v90, s100
    v_perm_b32 v94, v94, v90, s101
    v_mov_b32_e64 v90, v7
    v_perm_b32 v7, v95, v91, s100
    v_perm_b32 v95, v95, v91, s101
    v_mov_b32_e64 v91, v7
    v_perm_b32 v7, v124, v120, s100
    v_perm_b32 v124, v124, v120, s101
    v_mov_b32_e64 v120, v7
    v_perm_b32 v7, v125, v121, s100
    v_perm_b32 v125, v125, v121, s101
    v_mov_b32_e64 v121, v7
    v_perm_b32 v7, v126, v122, s100
    v_perm_b32 v126, v126, v122, s101
    v_mov_b32_e64 v122, v7
    v_perm_b32 v7, v127, v123, s100
    v_perm_b32 v127, v127, v123, s101
    v_mov_b32 v123, v7
    v_lshrrev_b32 v8, 3, v2
    v_and_b32 v9, 7, v2
    v_lshlrev_b32 v10, 4, v9
    v_lshl_add_u32 v11, v8, 13, v10
    v_and_b32 v12, 15, v2
    v_lshlrev_b32 v12, 13, v12
    v_and_b32_e64 v13, 3, v8
    v_lshl_add_u32 v13, v13, 9, v10
    v_lshrrev_b32_e64 v15, 2, v8
    v_lshl_add_u32 v13, v15, 13, v13
    v_lshl_add_u32 v14, v9, 3, v8
    s_lshl_b32 s80, s74, 2
    s_add_u32 s80, s80, s76
    s_lshl_b32 s78, s80, 9
    s_add_u32 s78, s78, 524288
    s_add_u32 s79, s78, 65536
    s_add_u32 s81, s73, s76
    s_and_b32 s81, s81, 3
    s_andn2_b32 s100, s73, 3
    s_or_b32 s81, s81, s100
    s_and_b32 s81, s81, 3
    s_lshl_b32 s81, s81, 2
    s_add_u32 s81, s81, s74
    s_lshl_b32 s81, s81, 13
    s_lshl_b32 s80, s76, 9
    s_add_u32 s80, s80, s81
    s_lshl_b32 s81, s70, 17
    s_add_u32 s81, s81, 2099200
    s_add_u32 s80, s80, s81
    s_and_b32 s100, s73, 3
    s_lshl_b32 s100, s100, 15
    s_add_u32 s81, s81, s100
    v_add_u32 v47, 0x10000, v11
    v_and_b32_e64 v53, 1, v54
    s_lshl_b32 s64, s76, 7
    s_add_u32 s64, s64, s81
    s_add_u32 s65, s64, 16384
    v_lshrrev_b32_e64 v50, 5, v2
    v_lshl_add_u32 v50, v9, 1, v50
    s_lshl_b32 s82, s76, 5
    s_add_u32 s82, s82, 163456
    v_lshl_add_u32 v50, v50, 1, s82
    v_lshlrev_b32 v27, 4, v8
    v_add_u32 v51, 163456, v27
    v_lshlrev_b32 v49, 2, v14
    v_lshlrev_b32 v15, 3, v14
    v_mov_b32 v26, 163360
    s_mul_i32 s66, s74, 56
    s_add_u32 s66, s66, s73
    s_lshl_b32 s66, s66, 10
    s_lshl_b32 s82, s76, 8
    s_add_u32 s66, s66, s82
    s_add_u32 s66, s66, 1114112
    s_barrier
    s_mov_b32 s100, 0
    s_nop 0
    buffer_load_dwordx4 v[128:131], v245, s[56:59], s100 offen nt
    s_mov_b32 s100, 2048
    buffer_load_dwordx4 v[132:135], v245, s[56:59], s100 offen nt
    s_mov_b32 s100, 4096
    buffer_load_dwordx4 v[136:139], v245, s[56:59], s100 offen nt
    s_mov_b32 s100, 6144
    buffer_load_dwordx4 v[140:143], v245, s[56:59], s100 offen nt
    s_mov_b32 s100, 8192
    buffer_load_dwordx4 v[144:147], v245, s[56:59], s100 offen nt
    s_barrier
    s_waitcnt vmcnt(0)
    s_mov_b32 s100, 0x05040100
    s_mov_b32 s101, 0x07060302
    v_perm_b32 v7, v132, v128, s100
    v_perm_b32 v132, v132, v128, s101
    v_mov_b32_e64 v128, v7
    v_perm_b32 v7, v133, v129, s100
    v_perm_b32 v133, v133, v129, s101
    v_mov_b32_e64 v129, v7
    v_perm_b32 v7, v134, v130, s100
    v_perm_b32 v134, v134, v130, s101
    v_mov_b32_e64 v130, v7
    v_perm_b32 v7, v135, v131, s100
    v_perm_b32 v135, v135, v131, s101
    v_mov_b32_e64 v131, v7
    v_perm_b32 v7, v140, v136, s100
    v_perm_b32 v140, v140, v136, s101
    v_mov_b32_e64 v136, v7
    v_perm_b32 v7, v141, v137, s100
    v_perm_b32 v141, v141, v137, s101
    v_mov_b32_e64 v137, v7
    v_perm_b32 v7, v142, v138, s100
    v_perm_b32 v142, v142, v138, s101
    v_mov_b32_e64 v138, v7
    v_perm_b32 v7, v143, v139, s100
    v_perm_b32 v143, v143, v139, s101
    v_mov_b32 v139, v7
    s_barrier
    s_mov_b32 s100, 10240
    buffer_load_dwordx4 v[148:151], v245, s[56:59], s100 offen nt
    s_mov_b32 s100, 12288
    buffer_load_dwordx4 v[152:155], v245, s[56:59], s100 offen nt
    s_mov_b32 s100, 14336
    buffer_load_dwordx4 v[156:159], v245, s[56:59], s100 offen nt
    s_and_b32 s79, s2, 7
    s_lshl_b32 s79, s79, 9
    s_add_u32 s79, s79, 524288
    s_mov_b64 exec, 0xffff
    s_sleep 20
    s_mov_b32 s85, 0
Lspin_33:
    buffer_load_dwordx2 v[24:25], v12, s[36:39], s79 offen offset:128 sc1
    s_or_b32 s79, s79, 4096
    s_add_u32 s85, s85, 1
    s_cmp_gt_u32 s85, 400000
    s_cbranch_scc1 L_end
    s_waitcnt vmcnt(0)
    v_cmp_ne_u32_e64 vcc, s75, v25
    s_cbranch_vccnz Lspin_33
    v_max_f32_dpp v24, v24, v24 row_ror:8 row_mask:0xf bank_mask:0xf
    s_nop 1
    v_max_f32_dpp v24, v24, v24 row_ror:4 row_mask:0xf bank_mask:0xf
    s_nop 1
    v_max_f32_dpp v24, v24, v24 row_ror:2 row_mask:0xf bank_mask:0xf
    s_nop 1
    v_max_f32_dpp v24, v24, v24 row_ror:1 row_mask:0xf bank_mask:0xf
    s_nop 0
    v_readfirstlane_b32 s97, v24
    s_mov_b64 exec, -1
    s_nop 0
    v_mov_b32 v24, s97
    s_cmp_ge_u32 s73, 56
    s_cbranch_scc1 L_red
    s_bfe_u32 s79, s97, 0x40007
    s_lshl_b32 s79, s79, 13
    s_add_u32 s78, s78, s79
    buffer_load_dwordx4 v[20:23], v27, s[36:39], s78 offen sc1
    ds_write_b32 v26, v24
    s_mov_b32 s85, 1
    s_mov_b32 s100, 0x05040100
    s_mov_b32 s101, 0x07060302
    v_perm_b32 v7, v148, v144, s100
    v_perm_b32 v148, v148, v144, s101
    v_mov_b32 v144, v7
    v_perm_b32 v7, v149, v145, s100
    v_perm_b32 v149, v149, v145, s101
    v_mov_b32_e64 v145, v7
    v_perm_b32 v7, v150, v146, s100
    v_perm_b32 v150, v150, v146, s101
    v_mov_b32_e64 v146, v7
    v_perm_b32 v7, v151, v147, s100
    v_perm_b32 v151, v151, v147, s101
    v_mov_b32_e64 v147, v7
    v_perm_b32 v7, v156, v152, s100
    v_perm_b32 v156, v156, v152, s101
    v_mov_b32_e64 v152, v7
    v_perm_b32 v7, v157, v153, s100
    v_perm_b32 v157, v157, v153, s101
    v_mov_b32_e64 v153, v7
    v_perm_b32 v7, v158, v154, s100
    v_perm_b32 v158, v158, v154, s101
    v_mov_b32_e64 v154, v7
    v_perm_b32 v7, v159, v155, s100
    v_perm_b32 v159, v159, v155, s101
    v_mov_b32 v155, v7
Lb_35:
    s_waitcnt vmcnt(0) lgkmcnt(0)
    v_max3_u32 v16, v20, v21, v22
    v_max_u32 v16, v16, v23
    v_cmp_eq_u32_e64 vcc, -1, v16
    s_cbranch_vccnz Lspin_34
    v_dot2_f32_bf16 v28, v64, v20, 0
    v_dot2_f32_bf16 v29, v68, v20, 0
    v_dot2_f32_bf16 v30, v65, v20, 0
    v_dot2_f32_bf16 v31, v69, v20, 0
    v_dot2_f32_bf16 v32, v66, v20, 0
    v_dot2_f32_bf16 v33, v70, v20, 0
    v_dot2_f32_bf16 v34, v67, v20, 0
    v_dot2_f32_bf16 v35, v71, v20, 0
    v_dot2_f32_bf16 v28, v72, v21, v28
    v_dot2_f32_bf16 v29, v76, v21, v29
    v_dot2_f32_bf16 v30, v73, v21, v30
    v_dot2_f32_bf16 v31, v77, v21, v31
    v_dot2_f32_bf16 v32, v74, v21, v32
    v_dot2_f32_bf16 v33, v78, v21, v33
    v_dot2_f32_bf16 v34, v75, v21, v34
    v_dot2_f32_bf16 v35, v79, v21, v35
    v_dot2_f32_bf16 v28, v80, v22, v28
    v_dot2_f32_bf16 v29, v84, v22, v29
    v_dot2_f32_bf16 v30, v81, v22, v30
    v_dot2_f32_bf16 v31, v85, v22, v31
    v_dot2_f32_bf16 v32, v82, v22, v32
    v_dot2_f32_bf16 v33, v86, v22, v33
    v_dot2_f32_bf16 v34, v83, v22, v34
    v_dot2_f32_bf16 v35, v87, v22, v35
    v_dot2_f32_bf16 v28, v88, v23, v28
    v_dot2_f32_bf16 v29, v92, v23, v29
    v_dot2_f32_bf16 v30, v89, v23, v30
    v_dot2_f32_bf16 v31, v93, v23, v31
    v_dot2_f32_bf16 v32, v90, v23, v32
    v_dot2_f32_bf16 v33, v94, v23, v33
    v_dot2_f32_bf16 v34, v91, v23, v34
    v_dot2_f32_bf16 v35, v95, v23, v35
    v_dot2_f32_bf16 v36, v96, v20, 0
    v_dot2_f32_bf16 v37, v100, v20, 0
    v_dot2_f32_bf16 v38, v97, v20, 0
    v_dot2_f32_bf16 v39, v101, v20, 0
    v_dot2_f32_bf16 v40, v98, v20, 0
    v_dot2_f32_bf16 v41, v102, v20, 0
    v_dot2_f32_bf16 v42, v99, v20, 0
    v_dot2_f32_bf16 v43, v103, v20, 0
    v_dot2_f32_bf16 v36, v104, v21, v36
    v_dot2_f32_bf16 v37, v108, v21, v37
    v_dot2_f32_bf16 v38, v105, v21, v38
    v_dot2_f32_bf16 v39, v109, v21, v39
    v_dot2_f32_bf16 v40, v106, v21, v40
    v_dot2_f32_bf16 v41, v110, v21, v41
    v_dot2_f32_bf16 v42, v107, v21, v42
    v_dot2_f32_bf16 v43, v111, v21, v43
    v_dot2_f32_bf16 v36, v112, v22, v36
    v_dot2_f32_bf16 v37, v116, v22, v37
    v_dot2_f32_bf16 v38, v113, v22, v38
    v_dot2_f32_bf16 v39, v117, v22, v39
    v_dot2_f32_bf16 v40, v114, v22, v40
    v_dot2_f32_bf16 v41, v118, v22, v41
    v_dot2_f32_bf16 v42, v115, v22, v42
    v_dot2_f32_bf16 v43, v119, v22, v43
    v_dot2_f32_bf16 v36, v120, v23, v36
    v_dot2_f32_bf16 v37, v124, v23, v37
    v_dot2_f32_bf16 v38, v121, v23, v38
    v_dot2_f32_bf16 v39, v125, v23, v39
    v_dot2_f32_bf16 v40, v122, v23, v40
    v_dot2_f32_bf16 v41, v126, v23, v41
    v_dot2_f32_bf16 v42, v123, v23, v42
    v_dot2_f32_bf16 v43, v127, v23, v43
    v_permlane32_swap_b32 v28, v32
    v_permlane32_swap_b32 v29, v33
    v_permlane32_swap_b32 v30, v34
    v_permlane32_swap_b32 v31, v35
    v_permlane32_swap_b32 v36, v40
    v_permlane32_swap_b32 v37, v41
    v_permlane32_swap_b32 v38, v42
    v_permlane32_swap_b32 v39, v43
    v_pk_add_f32 v[28:29], v[28:29], v[32:33]
    v_pk_add_f32 v[30:31], v[30:31], v[34:35]
    v_pk_add_f32 v[36:37], v[36:37], v[40:41]
    v_pk_add_f32 v[38:39], v[38:39], v[42:43]
    v_permlane16_swap_b32 v28, v30
    v_permlane16_swap_b32 v29, v31
    v_permlane16_swap_b32 v36, v38
    v_permlane16_swap_b32 v37, v39
    v_pk_add_f32 v[28:29], v[28:29], v[30:31]
    v_pk_add_f32 v[36:37], v[36:37], v[38:39]
    s_nop 0
    v_add_f32_dpp v44, v28, v28 row_ror:8 row_mask:0xf bank_mask:0x3
    v_add_f32_dpp v45, v36, v36 row_ror:8 row_mask:0xf bank_mask:0x3
    s_nop 0
    v_add_f32_dpp v44, v29, v29 row_ror:8 row_mask:0xf bank_mask:0xc
    v_add_f32_dpp v45, v37, v37 row_ror:8 row_mask:0xf bank_mask:0xc
    v_and_or_b32 v44, v44, -2, v53
    s_bitcmp1_b32 s99, 0
    s_cbranch_scc0 Lls_36
    buffer_store_dwordx2 v[44:45], v15, s[36:39], s80 offen
Lle_37:
    s_mov_b32 s95, s80
    s_barrier
    s_mov_b32 s85, 0
Lspin_38:
    buffer_load_dwordx4 v[16:19], v13, s[36:39], s64 offen sc1
    buffer_load_dwordx4 v[20:23], v13, s[36:39], s65 offen sc1
    s_add_u32 s85, s85, 1
    s_cmp_gt_u32 s85, 400000
L_pad3:
    s_cbranch_execz L_pad7
    s_cbranch_scc1 L_end
    s_waitcnt vmcnt(0)
    v_max3_u32 v25, v16, v18, v20
    v_max_u32 v25, v25, v22
    v_cmp_eq_u32 vcc, -1, v25
    s_cbranch_vccnz Lspin_38
    v_and_b32 v16, -2, v16
    v_and_b32 v18, -2, v18
    v_and_b32 v20, -2, v20
    v_and_b32 v22, -2, v22
    v_pk_add_f32 v[16:17], v[16:17], v[20:21]
    v_pk_add_f32 v[18:19], v[18:19], v[22:23]
    s_nop 1
    v_permlane32_swap_b32 v16, v18
    v_permlane32_swap_b32_e64 v17, v19
    v_pk_add_f32 v[16:17], v[16:17], v[18:19]
    v_mov_b32 v18, v16
    v_mov_b32 v19, v17
    s_nop 0
    v_permlane16_swap_b32 v16, v18
    v_permlane16_swap_b32_e64 v17, v19
    v_pk_add_f32 v[16:17], v[16:17], v[18:19]
    s_nop 1
    v_add_f32_dpp v16, v16, v16 row_ror:8 row_mask:0xf bank_mask:0xf
    v_add_f32_dpp v17, v17, v17 row_ror:8 row_mask:0xf bank_mask:0xf
    v_cvt_pk_bf16_f32 v17, v16, v17
    v_lshlrev_b32 v16, 16, v17
    v_mul_f32 v18, 0xbfb8aa3b, v16
    v_exp_f32_e64 v18, v18
    v_and_b32 v17, 0xffff0000, v17
    v_add_f32 v18, 1.0, v18
    v_rcp_f32 v18, v18
    s_nop 0
    v_mul_f32 v16, v16, v18
    v_cvt_pk_bf16_f32 v16, v16, v16
    v_and_b32 v16, 0xffff0000, v16
    v_mul_f32_e64 v16, v16, v17
    v_cvt_pk_bf16_f32 v16, v16, v16
    ds_write_b16 v50, v16
    s_waitcnt lgkmcnt(0)
    s_barrier
    ds_read_b128 v[20:23], v51
    s_waitcnt lgkmcnt(0)
    s_nop 0
    v_dot2_f32_bf16 v28, v128, v20, 0
    v_dot2_f32_bf16 v29, v132, v20, 0
    v_dot2_f32_bf16 v30, v129, v20, 0
    v_dot2_f32_bf16 v31, v133, v20, 0
    v_dot2_f32_bf16 v32, v130, v20, 0
    v_dot2_f32_bf16 v33, v134, v20, 0
    v_dot2_f32_bf16 v34, v131, v20, 0
    v_dot2_f32_bf16 v35, v135, v20, 0
    v_dot2_f32_bf16 v28, v136, v21, v28
    v_dot2_f32_bf16 v29, v140, v21, v29
    v_dot2_f32_bf16 v30, v137, v21, v30
    v_dot2_f32_bf16 v31, v141, v21, v31
    v_dot2_f32_bf16 v32, v138, v21, v32
    v_dot2_f32_bf16 v33, v142, v21, v33
    v_dot2_f32_bf16 v34, v139, v21, v34
    v_dot2_f32_bf16 v35, v143, v21, v35
    v_dot2_f32_bf16 v28, v144, v22, v28
    v_dot2_f32_bf16 v29, v148, v22, v29
    v_dot2_f32_bf16 v30, v145, v22, v30
    v_dot2_f32_bf16 v31, v149, v22, v31
    v_dot2_f32_bf16 v32, v146, v22, v32
    v_dot2_f32_bf16 v33, v150, v22, v33
    v_dot2_f32_bf16 v34, v147, v22, v34
    v_dot2_f32_bf16 v35, v151, v22, v35
    v_dot2_f32_bf16 v28, v152, v23, v28
    v_dot2_f32_bf16 v29, v156, v23, v29
    v_dot2_f32_bf16 v30, v153, v23, v30
    v_dot2_f32_bf16 v31, v157, v23, v31
    v_dot2_f32_bf16 v32, v154, v23, v32
    v_dot2_f32_bf16 v33, v158, v23, v33
    v_dot2_f32_bf16 v34, v155, v23, v34
    v_dot2_f32_bf16 v35, v159, v23, v35
    v_permlane32_swap_b32 v28, v32
    v_permlane32_swap_b32 v29, v33
    v_permlane32_swap_b32 v30, v34
    v_permlane32_swap_b32 v31, v35
    v_pk_add_f32 v[28:29], v[28:29], v[32:33]
    v_pk_add_f32 v[30:31], v[30:31], v[34:35]
    s_nop 1
    v_permlane16_swap_b32 v28, v30
    v_permlane16_swap_b32_e64 v29, v31
    v_pk_add_f32 v[28:29], v[28:29], v[30:31]
    s_nop 1
    v_add_f32_dpp v46, v28, v28 row_ror:8 row_mask:0xf bank_mask:0x3
    s_nop 1
    v_add_f32_dpp v46, v29, v29 row_ror:8 row_mask:0xf bank_mask:0xc
    buffer_store_dword v46, v49, s[36:39], s66 offen sc1
    s_barrier
    s_branch L_fin
L_red:
    v_mov_b32 v26, 163360
    ds_write_b32 v26, v24
    s_waitcnt lgkmcnt(0)
    s_barrier
    s_barrier
    s_barrier
    s_cmp_lg_u32 s76, 0
    s_cbranch_scc1 L_fin
    s_sub_u32 s83, s0, 224
    v_lshrrev_b32_e64 v14, 4, v2
    v_lshl_add_u32 v14, v9, 2, v14
    v_lshlrev_b32 v15, 2, v14
    v_lshlrev_b32 v14, 1, v14
    s_bfe_u32 s78, s97, 0x40007
    s_lshl_b32 s78, s78, 13
    s_lshr_b32 s79, s83, 1
    s_lshl_b32 s79, s79, 9
    s_add_u32 s78, s78, s79
    s_and_b32 s79, s83, 1
    s_lshl_b32 s79, s79, 7
    s_add_u32 s78, s78, s79
    s_add_u32 s78, s78, 524544
    s_mov_b32 s85, 0
Lspin_39:
    buffer_load_dword v46, v15, s[36:39], s78 offen sc1
    s_add_u32 s85, s85, 1
    s_cmp_gt_u32 s85, 400000
    s_cbranch_scc1 L_end
    s_waitcnt vmcnt(0)
    v_cmp_eq_u32_e64 vcc, -1, v46
    s_cbranch_vccnz Lspin_39
    v_cvt_pk_bf16_f32 v47, v24, v24
    v_and_b32 v47, 0xffff0000, v47
    v_mul_f32 v47, 0xbfb8aa3b, v47
    v_exp_f32 v47, v47
    s_nop 0
    v_add_f32 v47, 1.0, v47
    v_rcp_f32_e64 v47, v47
    s_nop 0
    v_cvt_pk_bf16_f32 v47, v47, v47
    v_and_b32 v47, 0xffff0000, v47
    v_lshl_add_u32 v13, v8, 10, v10
    s_lshr_b32 s78, s83, 3
    s_mul_i32 s78, s78, 57344
    s_and_b32 s79, s83, 7
    s_lshl_b32 s79, s79, 7
    s_add_u32 s78, s78, s79
    s_add_u32 s78, s78, 1114112
    s_and_b32 s80, s97, 0x7ff
    s_lshl_b32 s80, s80, 11
    s_lshl_b32 s79, s83, 6
    s_add_u32 s80, s80, s79
    s_sleep 30
    s_mov_b32 s85, 0
Lspin_40:
    s_add_u32 s79, s78, 0
    buffer_load_dwordx4 v[16:19], v13, s[36:39], s79 offen sc1
    s_add_u32 s79, s78, 8192
    buffer_load_dwordx4 v[20:23], v13, s[36:39], s79 offen sc1
    s_add_u32 s79, s78, 16384
    buffer_load_dwordx4 v[24:27], v13, s[36:39], s79 offen sc1
    s_add_u32 s79, s78, 24576
    buffer_load_dwordx4 v[28:31], v13, s[36:39], s79 offen sc1
    s_add_u32 s79, s78, 32768
    buffer_load_dwordx4 v[32:35], v13, s[36:39], s79 offen sc1
    s_add_u32 s79, s78, 40960
    buffer_load_dwordx4 v[36:39], v13, s[36:39], s79 offen sc1
    s_add_u32 s79, s78, 49152
    buffer_load_dwordx4 v[40:43], v13, s[36:39], s79 offen sc1
    s_add_u32 s85, s85, 1
    s_cmp_gt_u32 s85, 400000
    s_cbranch_scc1 L_end
    s_waitcnt vmcnt(0)
    v_max_u32 v48, v16, v17
    v_max_u32_e64 v49, v18, v19
    v_max3_u32 v48, v48, v20, v21
    v_max3_u32 v49, v49, v22, v23
    v_max3_u32 v48, v48, v24, v25
    v_max3_u32 v49, v49, v26, v27
    v_max3_u32 v48, v48, v28, v29
    v_max3_u32 v49, v49, v30, v31
    v_max3_u32 v48, v48, v32, v33
    v_max3_u32 v49, v49, v34, v35
    v_max3_u32 v48, v48, v36, v37
    v_max3_u32 v49, v49, v38, v39
    v_max3_u32 v48, v48, v40, v41
    v_max3_u32 v49, v49, v42, v43
    v_max_u32 v48, v48, v49
    v_cmp_eq_u32_e64 vcc, -1, v48
    s_cbranch_vccnz Lspin_40
    v_pk_add_f32 v[16:17], v[16:17], v[20:21]
    v_pk_add_f32 v[24:25], v[24:25], v[28:29]
    v_pk_add_f32 v[32:33], v[32:33], v[36:37]
    v_pk_add_f32 v[16:17], v[16:17], v[24:25]
    v_pk_add_f32 v[32:33], v[32:33], v[40:41]
    v_pk_add_f32 v[16:17], v[16:17], v[32:33]
    v_pk_add_f32 v[18:19], v[18:19], v[22:23]
    v_pk_add_f32 v[26:27], v[26:27], v[30:31]
    v_pk_add_f32 v[34:35], v[34:35], v[38:39]
    v_pk_add_f32 v[18:19], v[18:19], v[26:27]
    v_pk_add_f32 v[34:35], v[34:35], v[42:43]
    v_pk_add_f32 v[18:19], v[18:19], v[34:35]
    s_nop 1
    v_permlane32_swap_b32 v16, v18
    v_permlane32_swap_b32_e64 v17, v19
    v_pk_add_f32 v[16:17], v[16:17], v[18:19]
    s_nop 1
    v_permlane16_swap_b32 v16, v17
    v_add_f32 v16, v16, v17
    s_nop 1
    v_add_f32_dpp v16, v16, v16 row_ror:8 row_mask:0xf bank_mask:0xf
    v_cvt_pk_bf16_f32 v16, v16, v16
    v_and_b32 v16, 0xffff0000, v16
    v_mul_f32_e64 v16, v16, v47
    v_cvt_pk_bf16_f32 v16, v16, v16
    v_and_b32 v16, 0xffff0000, v16
    v_add_f32_e64 v16, v16, v46
    v_cvt_pk_bf16_f32 v16, v16, v16
    s_mov_b32 exec_lo, 0x00ff00ff
    s_mov_b32 exec_hi, 0x00ff00ff
    buffer_store_short v16, v14, s[44:47], s80 offen
    s_mov_b64 exec, -1
    s_cmp_lg_u32 s0, 224
    s_cbranch_scc1 Lep_41
    s_cmp_lg_u32 s76, 0
    s_cbranch_scc1 Lep_41
    v_mov_b32 v196, s75
    v_mov_b32_e64 v197, 0
    s_mov_b64 exec, 1
    buffer_store_dword v196, v197, s[36:39], 0 offen sc1
    s_mov_b64 exec, -1
Lep_41:
    s_branch L_fin
L_pad4:
    s_cbranch_execz L_pad8
    s_endpgm
Lspin_18:
    buffer_load_dwordx2 v[10:11], v8, s[36:39], 0 offen sc1
    s_add_u32 s85, s85, 1
    s_cmp_gt_u32 s85, 400000
    s_cbranch_scc1 L_end
    s_waitcnt vmcnt(0)
    s_branch Lpk_17
Lls_19:
    buffer_store_dwordx4 v[12:15], v62, s[36:39], s78 offen sc1
    s_nop 1
    s_branch Lle_20
Lls_21:
    buffer_store_dwordx4 v[28:31], v63, s[36:39], s78 offen sc1
    s_nop 1
    s_branch Lle_22
Lls_23:
    buffer_store_dwordx4 v[44:47], v2, s[36:39], s79 offen sc1
    s_nop 1
    s_branch Lle_24
Lls_26:
    buffer_store_dword v36, v57, s[36:39], s81 offen sc1
    s_nop 1
    s_branch Lle_27
Lls_29:
    buffer_store_dwordx4 v[56:59], v4, s[36:39], s78 offen sc1
    s_nop 1
    s_branch Lle_30
Lspin_34:
    buffer_load_dwordx4 v[20:23], v27, s[36:39], s78 offen sc1
    s_add_u32 s85, s85, 1
    s_cmp_gt_u32 s85, 400000
    s_cbranch_scc1 L_end
    s_branch Lb_35
Lls_36:
    buffer_store_dwordx2 v[44:45], v15, s[36:39], s80 offen sc1
    s_nop 1
    s_branch Lle_37
L_padret:
    s_setpc_b64 s[12:13]
    .p2align 3
L_M:
    s_getpc_b64 s[90:91]
L_mpc:
    s_sub_u32 s90, s90, L_mpc-L_sube
    s_subb_u32 s91, s91, 0
    s_lshr_b32 s78, s2, 3
    s_lshl_b32 s78, s78, 10
    s_lshl_b32 s79, s76, 8
    s_add_u32 s78, s78, s79
    s_min_u32 s78, s78, (L_end-L_sube)
    v_lshl_add_u32 v119, v2, 2, s78
    global_load_dword v119, v119, s[90:91]
    s_setprio 1
    s_and_b32 s78, s2, 7
    s_lshr_b32 s79, s2, 3
    s_lshl_b32 s71, s78, 1
    s_and_b32 s72, s79, 1
    s_add_u32 s71, s71, s72
    s_lshr_b32 s72, s79, 1
    s_cmp_gt_u32 s70, 3
    s_cselect_b32 s78, 1, 0
    s_cmp_gt_u32 s70, 11
    s_cselect_b32 s78, 2, s78
    s_sub_u32 s78, s70, s78
    s_cmp_eq_u32 s70, 3
    s_cselect_b32 s78, 14, s78
    s_cmp_eq_u32 s70, 11
    s_cselect_b32 s78, 15, s78
    s_lshl_b32 s0, s78, 4
    s_add_u32 s0, s0, s69
    s_lshr_b32 s73, s0, 2
    s_and_b32 s74, s0, 3
    s_lshl_b32 s77, s70, 4
    s_add_u32 s77, s77, s69
    s_and_b32 s80, s76, 1
    s_lshr_b32 s81, s76, 1
    v_and_b32 v8, 15, v2
    v_lshrrev_b32 v9, 4, v2
    v_lshrrev_b32 v10, 1, v8
    s_lshl_b32 s78, s80, 13
    s_add_u32 s78, s78, 118784
    v_lshlrev_b32 v11, 7, v8
    v_add_u32 v11, s78, v11
    v_add_u32 v12, 0, v9
    v_xor_b32 v12, v12, v10
    v_lshl_add_u32 v4, v12, 4, v11
    v_add_u32 v12, 4, v9
    v_xor_b32 v12, v12, v10
    v_lshl_add_u32 v5, v12, 4, v11
    v_bfe_u32 v10, v2, 2, 2
    v_and_b32_e64 v11, 3, v2
    v_lshl_add_u32 v12, v9, 3, v10
    v_lshlrev_b32_e64 v12, 7, v12
    v_lshl_add_u32 v12, v11, 3, v12
    v_add_u32 v12, 135168, v12
    v_lshrrev_b32 v13, 1, v10
    v_and_b32 v14, 1, v9
    v_lshl_add_u32 v13, v14, 1, v13
    s_lshl_b32 s78, s81, 1
    s_add_u32 s79, s78, 0
    v_xor_b32_e64 v14, s79, v13
    v_lshl_add_u32 v6, v14, 5, v12
    s_add_u32 s79, s78, 1
    v_xor_b32 v14, s79, v13
    v_lshl_add_u32 v7, v14, 5, v12
    v_lshrrev_b32_e64 v13, 5, v2
    v_lshl_add_u32 v13, v13, 3, v10
    v_lshlrev_b32 v13, 6, v13
    v_and_b32 v14, 1, v9
    v_lshl_add_u32 v13, v14, 5, v13
    v_lshl_add_u32 v13, v11, 3, v13
    s_lshl_b32 s78, s81, 11
    s_add_u32 s78, s78, 159744
    v_add_u32 v15, s78, v13
    v_mov_b64 v[128:129], 0
    v_mov_b64 v[130:131], 0
    v_mov_b64 v[132:133], 0
    v_mov_b64 v[134:135], 0
    v_mov_b64 v[136:137], 0
    v_mov_b64 v[138:139], 0
    v_mov_b64 v[140:141], 0
    v_mov_b64 v[142:143], 0
    v_mov_b64 v[144:145], 0
    v_mov_b64 v[146:147], 0
    v_mov_b64 v[148:149], 0
    v_mov_b64 v[150:151], 0
    v_mov_b64 v[152:153], 0
    v_mov_b64 v[154:155], 0
    v_mov_b64 v[156:157], 0
    v_mov_b64 v[158:159], 0
    v_mov_b64 v[160:161], 0
    v_mov_b64 v[162:163], 0
L_pad5:
    s_cbranch_execz L_pad9
    v_mov_b64 v[164:165], 0
    v_mov_b64 v[166:167], 0
    v_mov_b64 v[168:169], 0
    v_mov_b64 v[170:171], 0
    v_mov_b64 v[172:173], 0
    v_mov_b64 v[174:175], 0
    v_mov_b64 v[176:177], 0
    v_mov_b64 v[178:179], 0
    v_mov_b64 v[180:181], 0
    v_mov_b64 v[182:183], 0
    v_mov_b64 v[184:185], 0
    v_mov_b64 v[186:187], 0
    v_mov_b64 v[188:189], 0
    v_mov_b64 v[190:191], 0
    v_mov_b64 v[192:193], 0
    v_mov_b64 v[194:195], 0
    v_mov_b64 v[196:197], 0
    v_mov_b64 v[198:199], 0
    v_mov_b64 v[200:201], 0
    v_mov_b64 v[202:203], 0
    v_mov_b64 v[204:205], 0
    v_mov_b64 v[206:207], 0
    v_mov_b64 v[208:209], 0
    v_mov_b64 v[210:211], 0
    v_mov_b64 v[212:213], 0
    v_mov_b64 v[214:215], 0
    v_mov_b64 v[216:217], 0
    v_mov_b64 v[218:219], 0
    v_mov_b64 v[220:221], 0
    v_mov_b64 v[222:223], 0
    v_mov_b64 v[104:105], 0
    v_mov_b64 v[106:107], 0
    v_mov_b64 v[108:109], 0
    v_mov_b64 v[110:111], 0
    v_and_b32 v14, 31, v2
    v_lshrrev_b32 v13, 5, v2
    s_lshl_b32 s78, s81, 14
    s_lshl_b32 s79, s80, 13
    s_add_u32 s78, s78, s79
    s_add_u32 s78, s78, 110592
    v_lshl_add_u32 v12, v14, 7, s78
    v_and_b32 v14, 7, v14
    v_xor_b32 v14, v14, v13
    v_xor_b32_e64 v13, 0, v14
    v_lshl_add_u32 v112, v13, 4, v12
    v_xor_b32_e64 v13, 2, v14
    v_lshl_add_u32 v113, v13, 4, v12
    v_xor_b32_e64 v13, 4, v14
    v_lshl_add_u32 v114, v13, 4, v12
    v_xor_b32_e64 v13, 6, v14
    v_lshl_add_u32 v115, v13, 4, v12
    s_add_u32 s79, s79, 143360
    v_lshl_add_u32 v12, v8, 7, s79
    s_lshl_b32 s78, s81, 2
    v_add_u32 v14, s78, v9
    v_and_b32 v13, 7, v8
    v_xor_b32 v14, v14, v13
    v_lshl_add_u32 v116, v14, 4, v12
    s_lshl_b32 s78, s80, 6
    v_add_u32 v10, s78, v8
    v_lshlrev_b32_e64 v11, 3, v10
    v_add_u32 v11, 159744, v11
    s_lshl_b32 s79, s81, 5
    v_add_u32 v12, s79, v8
    v_lshlrev_b32_e64 v12, 3, v12
    v_add_u32 v12, 160768, v12
    v_lshlrev_b32_e64 v13, 2, v10
    v_add_u32 v13, 162304, v13
    v_and_b32 v14, 31, v2
    v_add_u32 v14, s78, v14
    v_lshlrev_b32_e64 v14, 2, v14
    v_add_u32 v14, 162304, v14
    s_waitcnt lgkmcnt(0)
    s_load_dword s75, s[26:27], 0
    s_getpc_b64 s[12:13]
Lpr_42:
    s_add_u32 s12, s12, L_end-Lpr_42
    s_addc_u32 s13, s13, 0
    s_mov_b32 s36, s26
    s_and_b32 s37, s27, 0xffff
    s_mov_b32 s38, 0x10000000
    s_mov_b32 s39, 0x20000
    s_mov_b32 s64, s14
    s_and_b32 s65, s15, 0xffff
    s_mov_b32 s66, 0x800
    s_mov_b32 s67, 0x20000
    s_mov_b32 s44, s22
    s_and_b32 s45, s23, 0xffff
    s_mov_b32 s46, 0x400000
    s_mov_b32 s47, 0x20000
    s_lshl_b32 s78, s72, 7
    buffer_load_dword v118, off, s[64:67], s78
    s_waitcnt lgkmcnt(0)
    s_mul_i32 s75, s75, 0x9E3779B1
    s_add_u32 s75, s75, 0x7F4A7C15
    s_mov_b32 s84, 0
    s_mov_b32 s82, 2
    s_mov_b32 s83, 0xfffec000
    s_barrier
    s_nop 0
    ds_read_b128 v[16:19], v4 offset:0
    ds_read_b64_tr_b16 v[40:41], v6 offset:8192
    ds_read_b64_tr_b16 v[42:43], v6 offset:8704
    ds_read_b128 v[20:23], v4 offset:2048
    ds_read_b128 v[24:27], v4 offset:4096
    ds_read_b128 v[28:31], v4 offset:6144
    ds_read_b64_tr_b16 v[44:45], v7 offset:8192
    ds_read_b64_tr_b16 v[46:47], v7 offset:8704
    ds_read_b64_tr_b16 v[48:49], v6 offset:16384
    ds_read_b64_tr_b16 v[50:51], v6 offset:16896
    ds_read_b64_tr_b16 v[52:53], v7 offset:16384
    ds_read_b64_tr_b16 v[54:55], v7 offset:16896
    ds_read_b64_tr_b16 v[32:33], v6 offset:0
    ds_read_b64_tr_b16 v[34:35], v6 offset:512
    ds_read_b64_tr_b16 v[36:37], v7 offset:0
    ds_read_b64_tr_b16 v[38:39], v7 offset:512
    ds_read_b64_tr_b16 v[96:97], v15 offset:0
    ds_read_b64_tr_b16 v[98:99], v15 offset:1024
    ds_read_b64_tr_b16 v[100:101], v15 offset:256
    ds_read_b64_tr_b16 v[102:103], v15 offset:1280
    s_waitcnt lgkmcnt(0)
    s_nop 0
    v_mfma_f32_16x16x32_bf16 v[160:163], v[40:43], v[16:19], v[160:163]
    v_mfma_f32_16x16x32_bf16 v[176:179], v[44:47], v[16:19], v[176:179]
    v_mfma_f32_16x16x32_bf16 v[180:183], v[44:47], v[20:23], v[180:183]
    v_mfma_f32_16x16x32_bf16 v[164:167], v[40:43], v[20:23], v[164:167]
    v_mfma_f32_16x16x32_bf16 v[168:171], v[40:43], v[24:27], v[168:171]
    v_mfma_f32_16x16x32_bf16 v[184:187], v[44:47], v[24:27], v[184:187]
    v_mfma_f32_16x16x32_bf16 v[188:191], v[44:47], v[28:31], v[188:191]
    v_mfma_f32_16x16x32_bf16 v[172:175], v[40:43], v[28:31], v[172:175]
    v_mfma_f32_16x16x32_bf16 v[204:207], v[48:51], v[28:31], v[204:207]
    v_mfma_f32_16x16x32_bf16 v[220:223], v[52:55], v[28:31], v[220:223]
    v_mfma_f32_16x16x32_bf16 v[216:219], v[52:55], v[24:27], v[216:219]
    v_mfma_f32_16x16x32_bf16 v[200:203], v[48:51], v[24:27], v[200:203]
    v_mfma_f32_16x16x32_bf16 v[196:199], v[48:51], v[20:23], v[196:199]
    v_mfma_f32_16x16x32_bf16 v[212:215], v[52:55], v[20:23], v[212:215]
    v_mfma_f32_16x16x32_bf16 v[208:211], v[52:55], v[16:19], v[208:211]
    v_mfma_f32_16x16x32_bf16 v[192:195], v[48:51], v[16:19], v[192:195]
    v_mfma_f32_16x16x32_bf16 v[128:131], v[32:35], v[16:19], v[128:131]
    v_mfma_f32_16x16x32_bf16 v[144:147], v[36:39], v[16:19], v[144:147]
    v_mfma_f32_16x16x32_bf16 v[148:151], v[36:39], v[20:23], v[148:151]
    v_mfma_f32_16x16x32_bf16 v[132:135], v[32:35], v[20:23], v[132:135]
    v_mfma_f32_16x16x32_bf16 v[136:139], v[32:35], v[24:27], v[136:139]
    v_mfma_f32_16x16x32_bf16 v[152:155], v[36:39], v[24:27], v[152:155]
    v_mfma_f32_16x16x32_bf16 v[156:159], v[36:39], v[28:31], v[156:159]
    v_mfma_f32_16x16x32_bf16 v[140:143], v[32:35], v[28:31], v[140:143]
    ds_read_b128 v[56:59], v5 offset:0
    ds_read_b64_tr_b16 v[80:81], v6 offset:12288
    ds_read_b64_tr_b16 v[82:83], v6 offset:12800
    ds_read_b128 v[60:63], v5 offset:2048
    ds_read_b128 v[64:67], v5 offset:4096
    ds_read_b128 v[68:71], v5 offset:6144
    ds_read_b64_tr_b16 v[84:85], v7 offset:12288
    ds_read_b64_tr_b16 v[86:87], v7 offset:12800
    ds_read_b64_tr_b16 v[88:89], v6 offset:20480
    ds_read_b64_tr_b16 v[90:91], v6 offset:20992
    ds_read_b64_tr_b16 v[92:93], v7 offset:20480
    ds_read_b64_tr_b16 v[94:95], v7 offset:20992
    ds_read_b64_tr_b16 v[72:73], v6 offset:4096
    ds_read_b64_tr_b16 v[74:75], v6 offset:4608
    ds_read_b64_tr_b16 v[76:77], v7 offset:4096
    ds_read_b64_tr_b16 v[78:79], v7 offset:4608
    s_add_u32 s84, s84, 1
    s_cmp_eq_u32 s82, 2
    s_cselect_b32 s78, s83, 40960
    s_cselect_b32 s82, -1, s82
    s_add_u32 s82, s82, 1
    v_add_u32 v4, s78, v4
    v_add_u32 v5, s78, v5
    v_add_u32 v6, s78, v6
    v_add_u32_e64 v7, s78, v7
    s_waitcnt vmcnt(0) lgkmcnt(0)
    v_mfma_f32_16x16x32_bf16 v[160:163], v[80:83], v[56:59], v[160:163]
    v_mfma_f32_16x16x32_bf16 v[176:179], v[84:87], v[56:59], v[176:179]
    v_mfma_f32_16x16x32_bf16 v[180:183], v[84:87], v[60:63], v[180:183]
    v_mfma_f32_16x16x32_bf16 v[164:167], v[80:83], v[60:63], v[164:167]
    v_mfma_f32_16x16x32_bf16 v[168:171], v[80:83], v[64:67], v[168:171]
    v_mfma_f32_16x16x32_bf16 v[184:187], v[84:87], v[64:67], v[184:187]
    v_mfma_f32_16x16x32_bf16 v[188:191], v[84:87], v[68:71], v[188:191]
    v_mfma_f32_16x16x32_bf16 v[172:175], v[80:83], v[68:71], v[172:175]
    v_mfma_f32_16x16x32_bf16 v[204:207], v[88:91], v[68:71], v[204:207]
    v_mfma_f32_16x16x32_bf16 v[220:223], v[92:95], v[68:71], v[220:223]
    v_mfma_f32_16x16x32_bf16 v[216:219], v[92:95], v[64:67], v[216:219]
    v_mfma_f32_16x16x32_bf16 v[200:203], v[88:91], v[64:67], v[200:203]
    v_mfma_f32_16x16x32_bf16 v[196:199], v[88:91], v[60:63], v[196:199]
    v_mfma_f32_16x16x32_bf16 v[212:215], v[92:95], v[60:63], v[212:215]
    v_mfma_f32_16x16x32_bf16 v[208:211], v[92:95], v[56:59], v[208:211]
    v_mfma_f32_16x16x32_bf16 v[192:195], v[88:91], v[56:59], v[192:195]
    v_mfma_f32_16x16x32_bf16 v[128:131], v[72:75], v[56:59], v[128:131]
    v_mfma_f32_16x16x32_bf16 v[144:147], v[76:79], v[56:59], v[144:147]
    v_mfma_f32_16x16x32_bf16 v[148:151], v[76:79], v[60:63], v[148:151]
    v_mfma_f32_16x16x32_bf16 v[132:135], v[72:75], v[60:63], v[132:135]
    v_mfma_f32_16x16x32_bf16 v[136:139], v[72:75], v[64:67], v[136:139]
    v_mfma_f32_16x16x32_bf16 v[152:155], v[76:79], v[64:67], v[152:155]
    v_mfma_f32_16x16x32_bf16 v[156:159], v[76:79], v[68:71], v[156:159]
    v_mfma_f32_16x16x32_bf16 v[140:143], v[72:75], v[68:71], v[140:143]
    s_barrier
    s_nop 0
    ds_read_b128 v[16:19], v4 offset:0
    ds_read_b64_tr_b16 v[40:41], v6 offset:8192
    ds_read_b64_tr_b16 v[42:43], v6 offset:8704
    ds_read_b128 v[20:23], v4 offset:2048
    ds_read_b128 v[24:27], v4 offset:4096
    ds_read_b128 v[28:31], v4 offset:6144
    ds_read_b64_tr_b16 v[44:45], v7 offset:8192
    ds_read_b64_tr_b16 v[46:47], v7 offset:8704
    ds_read_b64_tr_b16 v[48:49], v6 offset:16384
    ds_read_b64_tr_b16 v[50:51], v6 offset:16896
    ds_read_b64_tr_b16 v[52:53], v7 offset:16384
    ds_read_b64_tr_b16 v[54:55], v7 offset:16896
    ds_read_b64_tr_b16 v[32:33], v6 offset:0
    ds_read_b64_tr_b16 v[34:35], v6 offset:512
    ds_read_b64_tr_b16 v[36:37], v7 offset:0
    ds_read_b64_tr_b16 v[38:39], v7 offset:512
    s_waitcnt lgkmcnt(0)
    s_nop 0
    v_mfma_f32_16x16x32_bf16 v[160:163], v[40:43], v[16:19], v[160:163]
    v_mfma_f32_16x16x32_bf16 v[176:179], v[44:47], v[16:19], v[176:179]
    v_mfma_f32_16x16x32_bf16 v[180:183], v[44:47], v[20:23], v[180:183]
    v_mfma_f32_16x16x32_bf16 v[164:167], v[40:43], v[20:23], v[164:167]
    v_mfma_f32_16x16x32_bf16 v[168:171], v[40:43], v[24:27], v[168:171]
    v_mfma_f32_16x16x32_bf16 v[184:187], v[44:47], v[24:27], v[184:187]
    v_mfma_f32_16x16x32_bf16 v[188:191], v[44:47], v[28:31], v[188:191]
    v_mfma_f32_16x16x32_bf16 v[172:175], v[40:43], v[28:31], v[172:175]
    v_mfma_f32_16x16x32_bf16 v[204:207], v[48:51], v[28:31], v[204:207]
    v_mfma_f32_16x16x32_bf16 v[220:223], v[52:55], v[28:31], v[220:223]
    v_mfma_f32_16x16x32_bf16 v[216:219], v[52:55], v[24:27], v[216:219]
    v_mfma_f32_16x16x32_bf16 v[200:203], v[48:51], v[24:27], v[200:203]
    v_mfma_f32_16x16x32_bf16 v[196:199], v[48:51], v[20:23], v[196:199]
    v_mfma_f32_16x16x32_bf16 v[212:215], v[52:55], v[20:23], v[212:215]
    v_mfma_f32_16x16x32_bf16 v[208:211], v[52:55], v[16:19], v[208:211]
    v_mfma_f32_16x16x32_bf16 v[192:195], v[48:51], v[16:19], v[192:195]
    v_mfma_f32_16x16x32_bf16 v[128:131], v[32:35], v[16:19], v[128:131]
    v_mfma_f32_16x16x32_bf16 v[144:147], v[36:39], v[16:19], v[144:147]
    v_mfma_f32_16x16x32_bf16 v[148:151], v[36:39], v[20:23], v[148:151]
    v_mfma_f32_16x16x32_bf16 v[132:135], v[32:35], v[20:23], v[132:135]
    v_mfma_f32_16x16x32_bf16 v[136:139], v[32:35], v[24:27], v[136:139]
    v_mfma_f32_16x16x32_bf16 v[152:155], v[36:39], v[24:27], v[152:155]
    v_mfma_f32_16x16x32_bf16 v[156:159], v[36:39], v[28:31], v[156:159]
    v_mfma_f32_16x16x32_bf16 v[140:143], v[32:35], v[28:31], v[140:143]
    ds_read_b128 v[56:59], v5 offset:0
    ds_read_b64_tr_b16 v[80:81], v6 offset:12288
    ds_read_b64_tr_b16 v[82:83], v6 offset:12800
    ds_read_b128 v[60:63], v5 offset:2048
    ds_read_b128 v[64:67], v5 offset:4096
    ds_read_b128 v[68:71], v5 offset:6144
    ds_read_b64_tr_b16 v[84:85], v7 offset:12288
    ds_read_b64_tr_b16 v[86:87], v7 offset:12800
    ds_read_b64_tr_b16 v[88:89], v6 offset:20480
    ds_read_b64_tr_b16 v[90:91], v6 offset:20992
    ds_read_b64_tr_b16 v[92:93], v7 offset:20480
    ds_read_b64_tr_b16 v[94:95], v7 offset:20992
    ds_read_b64_tr_b16 v[72:73], v6 offset:4096
    ds_read_b64_tr_b16 v[74:75], v6 offset:4608
    ds_read_b64_tr_b16 v[76:77], v7 offset:4096
    ds_read_b64_tr_b16 v[78:79], v7 offset:4608
    s_add_u32 s84, s84, 1
    s_cmp_eq_u32 s82, 2
    s_cselect_b32 s78, s83, 40960
    s_cselect_b32 s82, -1, s82
    s_add_u32 s82, s82, 1
    v_add_u32 v4, s78, v4
    v_add_u32 v5, s78, v5
    v_add_u32 v6, s78, v6
    v_add_u32_e64 v7, s78, v7
    s_waitcnt vmcnt(0) lgkmcnt(0)
    v_mfma_f32_16x16x32_bf16 v[160:163], v[80:83], v[56:59], v[160:163]
    v_mfma_f32_16x16x32_bf16 v[176:179], v[84:87], v[56:59], v[176:179]
    v_mfma_f32_16x16x32_bf16 v[180:183], v[84:87], v[60:63], v[180:183]
    v_mfma_f32_16x16x32_bf16 v[164:167], v[80:83], v[60:63], v[164:167]
    v_mfma_f32_16x16x32_bf16 v[168:171], v[80:83], v[64:67], v[168:171]
    v_mfma_f32_16x16x32_bf16 v[184:187], v[84:87], v[64:67], v[184:187]
    v_mfma_f32_16x16x32_bf16 v[188:191], v[84:87], v[68:71], v[188:191]
    v_mfma_f32_16x16x32_bf16 v[172:175], v[80:83], v[68:71], v[172:175]
    v_mfma_f32_16x16x32_bf16 v[204:207], v[88:91], v[68:71], v[204:207]
    v_mfma_f32_16x16x32_bf16 v[220:223], v[92:95], v[68:71], v[220:223]
    v_mfma_f32_16x16x32_bf16 v[216:219], v[92:95], v[64:67], v[216:219]
    v_mfma_f32_16x16x32_bf16 v[200:203], v[88:91], v[64:67], v[200:203]
    v_mfma_f32_16x16x32_bf16 v[196:199], v[88:91], v[60:63], v[196:199]
    v_mfma_f32_16x16x32_bf16 v[212:215], v[92:95], v[60:63], v[212:215]
    v_mfma_f32_16x16x32_bf16 v[208:211], v[92:95], v[56:59], v[208:211]
    v_mfma_f32_16x16x32_bf16 v[192:195], v[88:91], v[56:59], v[192:195]
    v_mfma_f32_16x16x32_bf16 v[128:131], v[72:75], v[56:59], v[128:131]
    v_mfma_f32_16x16x32_bf16 v[144:147], v[76:79], v[56:59], v[144:147]
    v_mfma_f32_16x16x32_bf16 v[148:151], v[76:79], v[60:63], v[148:151]
    v_mfma_f32_16x16x32_bf16 v[132:135], v[72:75], v[60:63], v[132:135]
    v_mfma_f32_16x16x32_bf16 v[136:139], v[72:75], v[64:67], v[136:139]
    v_mfma_f32_16x16x32_bf16 v[152:155], v[76:79], v[64:67], v[152:155]
    v_mfma_f32_16x16x32_bf16 v[156:159], v[76:79], v[68:71], v[156:159]
    v_mfma_f32_16x16x32_bf16 v[140:143], v[72:75], v[68:71], v[140:143]
    s_mov_b64 exec, 0
    s_cmp_lg_u32 s76, 0
    s_cbranch_scc1 Lt_43
    s_call_b64 s[12:13], L_pad0
Lt_43:
    s_cmp_lg_u32 s76, 1
    s_cbranch_scc1 Lt_44
    s_call_b64 s[12:13], L_pad1
Lt_44:
    s_cmp_lg_u32 s76, 2
    s_cbranch_scc1 Lt_45
    s_call_b64 s[12:13], L_pad2
Lt_45:
    s_cmp_lg_u32 s76, 3
    s_cbranch_scc1 Lt_46
    s_call_b64 s[12:13], L_pad3
Lt_46:
    s_mov_b64 exec, -1
    s_barrier
    s_nop 0
    ds_read_b128 v[16:19], v4 offset:0
L_pad6:
    s_cbranch_execz L_pad10
    s_nop 0
    ds_read_b64_tr_b16 v[40:41], v6 offset:8192
    ds_read_b64_tr_b16 v[42:43], v6 offset:8704
    ds_read_b128 v[20:23], v4 offset:2048
    ds_read_b128 v[24:27], v4 offset:4096
    ds_read_b128 v[28:31], v4 offset:6144
    ds_read_b64_tr_b16 v[44:45], v7 offset:8192
    ds_read_b64_tr_b16 v[46:47], v7 offset:8704
    ds_read_b64_tr_b16 v[48:49], v6 offset:16384
    ds_read_b64_tr_b16 v[50:51], v6 offset:16896
    ds_read_b64_tr_b16 v[52:53], v7 offset:16384
    ds_read_b64_tr_b16 v[54:55], v7 offset:16896
    ds_read_b64_tr_b16 v[32:33], v6 offset:0
    ds_read_b64_tr_b16 v[34:35], v6 offset:512
    ds_read_b64_tr_b16 v[36:37], v7 offset:0
    ds_read_b64_tr_b16 v[38:39], v7 offset:512
    s_waitcnt lgkmcnt(0)
    s_nop 0
    v_mfma_f32_16x16x32_bf16 v[160:163], v[40:43], v[16:19], v[160:163]
    v_mfma_f32_16x16x32_bf16 v[176:179], v[44:47], v[16:19], v[176:179]
    v_mfma_f32_16x16x32_bf16 v[180:183], v[44:47], v[20:23], v[180:183]
    v_mfma_f32_16x16x32_bf16 v[164:167], v[40:43], v[20:23], v[164:167]
    v_mfma_f32_16x16x32_bf16 v[168:171], v[40:43], v[24:27], v[168:171]
    v_mfma_f32_16x16x32_bf16 v[184:187], v[44:47], v[24:27], v[184:187]
    v_mfma_f32_16x16x32_bf16 v[188:191], v[44:47], v[28:31], v[188:191]
    v_mfma_f32_16x16x32_bf16 v[172:175], v[40:43], v[28:31], v[172:175]
    v_mfma_f32_16x16x32_bf16 v[204:207], v[48:51], v[28:31], v[204:207]
    v_mfma_f32_16x16x32_bf16 v[220:223], v[52:55], v[28:31], v[220:223]
    v_mfma_f32_16x16x32_bf16 v[216:219], v[52:55], v[24:27], v[216:219]
    v_mfma_f32_16x16x32_bf16 v[200:203], v[48:51], v[24:27], v[200:203]
    v_mfma_f32_16x16x32_bf16 v[196:199], v[48:51], v[20:23], v[196:199]
    v_mfma_f32_16x16x32_bf16 v[212:215], v[52:55], v[20:23], v[212:215]
    v_mfma_f32_16x16x32_bf16 v[208:211], v[52:55], v[16:19], v[208:211]
    v_mfma_f32_16x16x32_bf16 v[192:195], v[48:51], v[16:19], v[192:195]
    v_mfma_f32_16x16x32_bf16 v[128:131], v[32:35], v[16:19], v[128:131]
    v_mfma_f32_16x16x32_bf16 v[144:147], v[36:39], v[16:19], v[144:147]
    v_mfma_f32_16x16x32_bf16 v[148:151], v[36:39], v[20:23], v[148:151]
    v_mfma_f32_16x16x32_bf16 v[132:135], v[32:35], v[20:23], v[132:135]
    v_mfma_f32_16x16x32_bf16 v[136:139], v[32:35], v[24:27], v[136:139]
    v_mfma_f32_16x16x32_bf16 v[152:155], v[36:39], v[24:27], v[152:155]
    v_mfma_f32_16x16x32_bf16 v[156:159], v[36:39], v[28:31], v[156:159]
    v_mfma_f32_16x16x32_bf16 v[140:143], v[32:35], v[28:31], v[140:143]
    ds_read_b128 v[56:59], v5 offset:0
    ds_read_b64_tr_b16 v[80:81], v6 offset:12288
    ds_read_b64_tr_b16 v[82:83], v6 offset:12800
    ds_read_b128 v[60:63], v5 offset:2048
    ds_read_b128 v[64:67], v5 offset:4096
    ds_read_b128 v[68:71], v5 offset:6144
    ds_read_b64_tr_b16 v[84:85], v7 offset:12288
    ds_read_b64_tr_b16 v[86:87], v7 offset:12800
    ds_read_b64_tr_b16 v[88:89], v6 offset:20480
    ds_read_b64_tr_b16 v[90:91], v6 offset:20992
    ds_read_b64_tr_b16 v[92:93], v7 offset:20480
    ds_read_b64_tr_b16 v[94:95], v7 offset:20992
    ds_read_b64_tr_b16 v[72:73], v6 offset:4096
    ds_read_b64_tr_b16 v[74:75], v6 offset:4608
    ds_read_b64_tr_b16 v[76:77], v7 offset:4096
    ds_read_b64_tr_b16 v[78:79], v7 offset:4608
    s_add_u32 s84, s84, 1
    s_cmp_eq_u32 s82, 2
    s_cselect_b32 s78, s83, 40960
    s_cselect_b32 s82, -1, s82
    s_add_u32 s82, s82, 1
    v_add_u32 v4, s78, v4
    v_add_u32 v5, s78, v5
    v_add_u32 v6, s78, v6
    v_add_u32_e64 v7, s78, v7
    s_waitcnt vmcnt(0) lgkmcnt(0)
    v_mfma_f32_16x16x32_bf16 v[160:163], v[80:83], v[56:59], v[160:163]
    v_mfma_f32_16x16x32_bf16 v[176:179], v[84:87], v[56:59], v[176:179]
    v_mfma_f32_16x16x32_bf16 v[180:183], v[84:87], v[60:63], v[180:183]
    v_mfma_f32_16x16x32_bf16 v[164:167], v[80:83], v[60:63], v[164:167]
    v_mfma_f32_16x16x32_bf16 v[168:171], v[80:83], v[64:67], v[168:171]
    v_mfma_f32_16x16x32_bf16 v[184:187], v[84:87], v[64:67], v[184:187]
    v_mfma_f32_16x16x32_bf16 v[188:191], v[84:87], v[68:71], v[188:191]
    v_mfma_f32_16x16x32_bf16 v[172:175], v[80:83], v[68:71], v[172:175]
    v_mfma_f32_16x16x32_bf16 v[204:207], v[88:91], v[68:71], v[204:207]
    v_mfma_f32_16x16x32_bf16 v[220:223], v[92:95], v[68:71], v[220:223]
    v_mfma_f32_16x16x32_bf16 v[216:219], v[92:95], v[64:67], v[216:219]
    v_mfma_f32_16x16x32_bf16 v[200:203], v[88:91], v[64:67], v[200:203]
    v_mfma_f32_16x16x32_bf16 v[196:199], v[88:91], v[60:63], v[196:199]
    v_mfma_f32_16x16x32_bf16 v[212:215], v[92:95], v[60:63], v[212:215]
    v_mfma_f32_16x16x32_bf16 v[208:211], v[92:95], v[56:59], v[208:211]
    v_mfma_f32_16x16x32_bf16 v[192:195], v[88:91], v[56:59], v[192:195]
    v_mfma_f32_16x16x32_bf16 v[128:131], v[72:75], v[56:59], v[128:131]
    v_mfma_f32_16x16x32_bf16 v[144:147], v[76:79], v[56:59], v[144:147]
    v_mfma_f32_16x16x32_bf16 v[148:151], v[76:79], v[60:63], v[148:151]
    v_mfma_f32_16x16x32_bf16 v[132:135], v[72:75], v[60:63], v[132:135]
    v_mfma_f32_16x16x32_bf16 v[136:139], v[72:75], v[64:67], v[136:139]
    v_mfma_f32_16x16x32_bf16 v[152:155], v[76:79], v[64:67], v[152:155]
    v_mfma_f32_16x16x32_bf16 v[156:159], v[76:79], v[68:71], v[156:159]
    v_mfma_f32_16x16x32_bf16 v[140:143], v[72:75], v[68:71], v[140:143]
    s_barrier
    s_nop 0
    ds_read_b128 v[16:19], v4 offset:0
    ds_read_b64_tr_b16 v[40:41], v6 offset:8192
    ds_read_b64_tr_b16 v[42:43], v6 offset:8704
    ds_read_b128 v[20:23], v4 offset:2048
    ds_read_b128 v[24:27], v4 offset:4096
    ds_read_b128 v[28:31], v4 offset:6144
    ds_read_b64_tr_b16 v[44:45], v7 offset:8192
    ds_read_b64_tr_b16 v[46:47], v7 offset:8704
    ds_read_b64_tr_b16 v[48:49], v6 offset:16384
    ds_read_b64_tr_b16 v[50:51], v6 offset:16896
    ds_read_b64_tr_b16 v[52:53], v7 offset:16384
    ds_read_b64_tr_b16 v[54:55], v7 offset:16896
    ds_read_b64_tr_b16 v[32:33], v6 offset:0
    ds_read_b64_tr_b16 v[34:35], v6 offset:512
    ds_read_b64_tr_b16 v[36:37], v7 offset:0
    ds_read_b64_tr_b16 v[38:39], v7 offset:512
    .p2align 3
L_Mloop:
    s_waitcnt lgkmcnt(0)
    s_nop 0
    v_mfma_f32_16x16x32_bf16 v[160:163], v[40:43], v[16:19], v[160:163]
    ds_read_b128 v[56:59], v5 offset:0
    v_mfma_f32_16x16x32_bf16 v[176:179], v[44:47], v[16:19], v[176:179]
    ds_read_b64_tr_b16 v[80:81], v6 offset:12288
    v_mfma_f32_16x16x32_bf16 v[180:183], v[44:47], v[20:23], v[180:183]
    ds_read_b64_tr_b16 v[82:83], v6 offset:12800
    v_mfma_f32_16x16x32_bf16 v[164:167], v[40:43], v[20:23], v[164:167]
    ds_read_b128 v[60:63], v5 offset:2048
    v_mfma_f32_16x16x32_bf16 v[168:171], v[40:43], v[24:27], v[168:171]
    ds_read_b128 v[64:67], v5 offset:4096
    v_mfma_f32_16x16x32_bf16 v[184:187], v[44:47], v[24:27], v[184:187]
    ds_read_b128 v[68:71], v5 offset:6144
    v_mfma_f32_16x16x32_bf16 v[188:191], v[44:47], v[28:31], v[188:191]
    ds_read_b64_tr_b16 v[84:85], v7 offset:12288
    v_mfma_f32_16x16x32_bf16 v[172:175], v[40:43], v[28:31], v[172:175]
    ds_read_b64_tr_b16 v[86:87], v7 offset:12800
    v_mfma_f32_16x16x32_bf16 v[204:207], v[48:51], v[28:31], v[204:207]
    ds_read_b64_tr_b16 v[88:89], v6 offset:20480
    v_mfma_f32_16x16x32_bf16 v[220:223], v[52:55], v[28:31], v[220:223]
    ds_read_b64_tr_b16 v[90:91], v6 offset:20992
    v_mfma_f32_16x16x32_bf16 v[216:219], v[52:55], v[24:27], v[216:219]
    ds_read_b64_tr_b16 v[92:93], v7 offset:20480
    v_mfma_f32_16x16x32_bf16 v[200:203], v[48:51], v[24:27], v[200:203]
    ds_read_b64_tr_b16 v[94:95], v7 offset:20992
    v_mfma_f32_16x16x32_bf16 v[196:199], v[48:51], v[20:23], v[196:199]
    ds_read_b64_tr_b16 v[72:73], v6 offset:4096
    v_mfma_f32_16x16x32_bf16 v[212:215], v[52:55], v[20:23], v[212:215]
    ds_read_b64_tr_b16 v[74:75], v6 offset:4608
    v_mfma_f32_16x16x32_bf16 v[208:211], v[52:55], v[16:19], v[208:211]
    ds_read_b64_tr_b16 v[76:77], v7 offset:4096
    v_mfma_f32_16x16x32_bf16 v[192:195], v[48:51], v[16:19], v[192:195]
    ds_read_b64_tr_b16 v[78:79], v7 offset:4608
    v_mfma_f32_16x16x32_bf16 v[128:131], v[32:35], v[16:19], v[128:131]
    s_add_u32 s84, s84, 1
    s_cmp_eq_u32 s82, 2
    s_cselect_b32 s78, s83, 40960
    s_cselect_b32 s82, -1, s82
    s_add_u32 s82, s82, 1
    v_mfma_f32_16x16x32_bf16 v[144:147], v[36:39], v[16:19], v[144:147]
    v_add_u32 v4, s78, v4
    v_add_u32 v5, s78, v5
    v_mfma_f32_16x16x32_bf16 v[148:151], v[36:39], v[20:23], v[148:151]
    v_add_u32 v6, s78, v6
    v_add_u32 v7, s78, v7
    v_mfma_f32_16x16x32_bf16 v[132:135], v[32:35], v[20:23], v[132:135]
    v_mfma_f32_16x16x32_bf16 v[136:139], v[32:35], v[24:27], v[136:139]
    v_mfma_f32_16x16x32_bf16 v[152:155], v[36:39], v[24:27], v[152:155]
    v_mfma_f32_16x16x32_bf16 v[156:159], v[36:39], v[28:31], v[156:159]
    v_mfma_f32_16x16x32_bf16 v[140:143], v[32:35], v[28:31], v[140:143]
    s_waitcnt vmcnt(0) lgkmcnt(0)
    v_mfma_f32_16x16x32_bf16 v[160:163], v[80:83], v[56:59], v[160:163]
    v_mfma_f32_16x16x32_bf16 v[176:179], v[84:87], v[56:59], v[176:179]
    s_barrier
    s_cmp_eq_u32 s84, 16
    s_cbranch_scc1 L_Mtail
    v_mfma_f32_16x16x32_bf16 v[180:183], v[84:87], v[60:63], v[180:183]
    ds_read_b128 v[16:19], v4 offset:0
    v_mfma_f32_16x16x32_bf16 v[164:167], v[80:83], v[60:63], v[164:167]
    ds_read_b64_tr_b16 v[40:41], v6 offset:8192
    v_mfma_f32_16x16x32_bf16 v[168:171], v[80:83], v[64:67], v[168:171]
    ds_read_b64_tr_b16 v[42:43], v6 offset:8704
    v_mfma_f32_16x16x32_bf16 v[184:187], v[84:87], v[64:67], v[184:187]
    ds_read_b128 v[20:23], v4 offset:2048
    v_mfma_f32_16x16x32_bf16 v[188:191], v[84:87], v[68:71], v[188:191]
    ds_read_b128 v[24:27], v4 offset:4096
    v_mfma_f32_16x16x32_bf16 v[172:175], v[80:83], v[68:71], v[172:175]
    ds_read_b128 v[28:31], v4 offset:6144
    v_mfma_f32_16x16x32_bf16 v[204:207], v[88:91], v[68:71], v[204:207]
    ds_read_b64_tr_b16 v[44:45], v7 offset:8192
    v_mfma_f32_16x16x32_bf16 v[220:223], v[92:95], v[68:71], v[220:223]
    ds_read_b64_tr_b16 v[46:47], v7 offset:8704
    v_mfma_f32_16x16x32_bf16 v[216:219], v[92:95], v[64:67], v[216:219]
    ds_read_b64_tr_b16 v[48:49], v6 offset:16384
    v_mfma_f32_16x16x32_bf16 v[200:203], v[88:91], v[64:67], v[200:203]
    ds_read_b64_tr_b16 v[50:51], v6 offset:16896
    v_mfma_f32_16x16x32_bf16 v[196:199], v[88:91], v[60:63], v[196:199]
    ds_read_b64_tr_b16 v[52:53], v7 offset:16384
    v_mfma_f32_16x16x32_bf16 v[212:215], v[92:95], v[60:63], v[212:215]
    ds_read_b64_tr_b16 v[54:55], v7 offset:16896
    v_mfma_f32_16x16x32_bf16 v[208:211], v[92:95], v[56:59], v[208:211]
    ds_read_b64_tr_b16 v[32:33], v6 offset:0
    v_mfma_f32_16x16x32_bf16 v[192:195], v[88:91], v[56:59], v[192:195]
    ds_read_b64_tr_b16 v[34:35], v6 offset:512
    v_mfma_f32_16x16x32_bf16 v[128:131], v[72:75], v[56:59], v[128:131]
    ds_read_b64_tr_b16 v[36:37], v7 offset:0
    v_mfma_f32_16x16x32_bf16 v[144:147], v[76:79], v[56:59], v[144:147]
    ds_read_b64_tr_b16 v[38:39], v7 offset:512
    v_mfma_f32_16x16x32_bf16 v[148:151], v[76:79], v[60:63], v[148:151]
    v_mfma_f32_16x16x32_bf16 v[132:135], v[72:75], v[60:63], v[132:135]
    v_mfma_f32_16x16x32_bf16 v[136:139], v[72:75], v[64:67], v[136:139]
    v_mfma_f32_16x16x32_bf16 v[152:155], v[76:79], v[64:67], v[152:155]
    v_mfma_f32_16x16x32_bf16 v[156:159], v[76:79], v[68:71], v[156:159]
    v_mfma_f32_16x16x32_bf16 v[140:143], v[72:75], v[68:71], v[140:143]
    s_branch L_Mloop
    .p2align 3
L_Mtail:
    s_mov_b64 exec, 0xffff
    ds_read_b64 v[104:105], v11 offset:0
    ds_read_b64 v[106:107], v11 offset:128
    ds_read_b64 v[108:109], v11 offset:256
    ds_read_b64 v[110:111], v11 offset:384
    s_mov_b64 exec, -1
    s_nop 0
    v_mfma_f32_16x16x32_bf16 v[180:183], v[84:87], v[60:63], v[180:183]
    ds_read_b64 v[20:21], v12 offset:512
    v_mfma_f32_16x16x32_bf16 v[164:167], v[80:83], v[60:63], v[164:167]
    ds_read_b64 v[22:23], v12 offset:640
    v_mfma_f32_16x16x32_bf16 v[168:171], v[80:83], v[64:67], v[168:171]
    ds_read_b64 v[24:25], v12 offset:1024
    v_mfma_f32_16x16x32_bf16 v[184:187], v[84:87], v[64:67], v[184:187]
    ds_read_b64 v[26:27], v12 offset:1152
    v_mfma_f32_16x16x32_bf16 v[188:191], v[84:87], v[68:71], v[188:191]
    ds_read_b64 v[16:17], v12 offset:0
    v_mfma_f32_16x16x32_bf16 v[172:175], v[80:83], v[68:71], v[172:175]
    ds_read_b64 v[18:19], v12 offset:128
    v_mfma_f32_16x16x32_bf16 v[204:207], v[88:91], v[68:71], v[204:207]
    ds_read2_b32 v[32:33], v14 offset0:0 offset1:32
    v_mfma_f32_16x16x32_bf16 v[220:223], v[92:95], v[68:71], v[220:223]
    ds_read_b32 v28, v13 offset:0
    v_mfma_f32_16x16x32_bf16 v[216:219], v[92:95], v[64:67], v[216:219]
    ds_read_b32 v30, v13 offset:64
    v_mfma_f32_16x16x32_bf16 v[200:203], v[88:91], v[64:67], v[200:203]
    ds_read_b32 v44, v13 offset:128
    v_mfma_f32_16x16x32_bf16 v[196:199], v[88:91], v[60:63], v[196:199]
    ds_read_b32 v46, v13 offset:192
    v_mfma_f32_16x16x32_bf16 v[212:215], v[92:95], v[60:63], v[212:215]
    v_mfma_f32_16x16x32_bf16 v[208:211], v[92:95], v[56:59], v[208:211]
    v_mfma_f32_16x16x32_bf16 v[192:195], v[88:91], v[56:59], v[192:195]
    s_waitcnt lgkmcnt(0)
    s_nop 0
    v_mfma_f32_16x16x16_bf16 v[160:163], v[20:21], v[104:105], v[160:163]
    v_mfma_f32_16x16x16_bf16 v[176:179], v[22:23], v[104:105], v[176:179]
    v_mfma_f32_16x16x16_bf16 v[164:167], v[20:21], v[106:107], v[164:167]
    v_mfma_f32_16x16x16_bf16 v[180:183], v[22:23], v[106:107], v[180:183]
    v_mfma_f32_16x16x16_bf16 v[168:171], v[20:21], v[108:109], v[168:171]
    v_mfma_f32_16x16x16_bf16 v[184:187], v[22:23], v[108:109], v[184:187]
    v_mfma_f32_16x16x16_bf16 v[172:175], v[20:21], v[110:111], v[172:175]
    v_mfma_f32_16x16x16_bf16 v[188:191], v[22:23], v[110:111], v[188:191]
    v_mul_f32 v34, 0x3fb8aa3b, v32
    v_mul_f32 v48, 0x3fb8aa3b, v33
    v_mfma_f32_16x16x16_bf16 v[192:195], v[24:25], v[104:105], v[192:195]
    v_mfma_f32_16x16x16_bf16 v[208:211], v[26:27], v[104:105], v[208:211]
    v_mfma_f32_16x16x16_bf16 v[196:199], v[24:25], v[106:107], v[196:199]
    v_cvt_pk_bf16_f32 v160, v160, v161
    v_cvt_pk_bf16_f32 v161, v162, v163
    v_cvt_pk_bf16_f32 v162, v176, v177
    v_cvt_pk_bf16_f32 v163, v178, v179
    v_mfma_f32_16x16x16_bf16 v[212:215], v[26:27], v[106:107], v[212:215]
    v_cvt_pk_bf16_f32 v164, v164, v165
    v_cvt_pk_bf16_f32 v165, v166, v167
    v_cvt_pk_bf16_f32 v166, v180, v181
    v_cvt_pk_bf16_f32 v167, v182, v183
    v_mfma_f32_16x16x16_bf16 v[200:203], v[24:25], v[108:109], v[200:203]
    v_cvt_pk_bf16_f32 v168, v168, v169
    v_cvt_pk_bf16_f32 v169, v170, v171
    v_cvt_pk_bf16_f32 v170, v184, v185
    v_cvt_pk_bf16_f32 v171, v186, v187
    v_mfma_f32_16x16x16_bf16 v[216:219], v[26:27], v[108:109], v[216:219]
    v_cvt_pk_bf16_f32 v172, v172, v173
    v_cvt_pk_bf16_f32 v173, v174, v175
    v_cvt_pk_bf16_f32 v174, v188, v189
L_pad7:
    s_cbranch_execz L_pad11
    v_cvt_pk_bf16_f32 v175, v190, v191
    v_mfma_f32_16x16x16_bf16 v[204:207], v[24:25], v[110:111], v[204:207]
    v_permlane16_swap_b32 v160, v164
    v_permlane16_swap_b32 v161, v165
    v_permlane16_swap_b32 v162, v166
    v_permlane16_swap_b32_e64 v163, v167
    v_mfma_f32_16x16x16_bf16 v[220:223], v[26:27], v[110:111], v[220:223]
    v_permlane16_swap_b32 v168, v172
    v_permlane16_swap_b32 v169, v173
    v_permlane16_swap_b32 v170, v174
    v_permlane16_swap_b32 v171, v175
    v_mfma_f32_32x32x16_bf16 v[224:239], v[96:99], v[160:163], 0
    v_mfma_f32_32x32x16_bf16 v[224:239], v[100:103], v[164:167], v[224:239]
    v_mfma_f32_32x32x16_bf16 v[240:255], v[96:99], v[168:171], 0
    v_mfma_f32_32x32x16_bf16 v[240:255], v[100:103], v[172:175], v[240:255]
    v_pk_mul_f32 v[192:193], v[192:193], v[28:29] op_sel_hi:[1,0]
    v_pk_mul_f32 v[194:195], v[194:195], v[28:29] op_sel_hi:[1,0]
    v_pk_mul_f32 v[208:209], v[208:209], v[28:29] op_sel_hi:[1,0]
    v_pk_mul_f32 v[210:211], v[210:211], v[28:29] op_sel_hi:[1,0]
    v_cvt_pk_bf16_f32 v192, v192, v193
    v_cvt_pk_bf16_f32 v193, v194, v195
    v_cvt_pk_bf16_f32 v194, v208, v209
    v_cvt_pk_bf16_f32 v195, v210, v211
    v_pk_mul_f32 v[196:197], v[196:197], v[30:31] op_sel_hi:[1,0]
    v_pk_mul_f32 v[198:199], v[198:199], v[30:31] op_sel_hi:[1,0]
    v_pk_mul_f32 v[212:213], v[212:213], v[30:31] op_sel_hi:[1,0]
    v_pk_mul_f32 v[214:215], v[214:215], v[30:31] op_sel_hi:[1,0]
    v_cvt_pk_bf16_f32 v196, v196, v197
    v_cvt_pk_bf16_f32 v197, v198, v199
    v_cvt_pk_bf16_f32 v198, v212, v213
    v_cvt_pk_bf16_f32 v199, v214, v215
    v_pk_mul_f32 v[200:201], v[200:201], v[44:45] op_sel_hi:[1,0]
    v_pk_mul_f32 v[202:203], v[202:203], v[44:45] op_sel_hi:[1,0]
    v_pk_mul_f32 v[216:217], v[216:217], v[44:45] op_sel_hi:[1,0]
    v_pk_mul_f32 v[218:219], v[218:219], v[44:45] op_sel_hi:[1,0]
    v_cvt_pk_bf16_f32 v200, v200, v201
    v_cvt_pk_bf16_f32 v201, v202, v203
    v_cvt_pk_bf16_f32 v202, v216, v217
    v_cvt_pk_bf16_f32 v203, v218, v219
    v_pk_mul_f32 v[204:205], v[204:205], v[46:47] op_sel_hi:[1,0]
    v_pk_mul_f32 v[206:207], v[206:207], v[46:47] op_sel_hi:[1,0]
    v_pk_mul_f32 v[220:221], v[220:221], v[46:47] op_sel_hi:[1,0]
    v_pk_mul_f32 v[222:223], v[222:223], v[46:47] op_sel_hi:[1,0]
    v_cvt_pk_bf16_f32 v204, v204, v205
    v_cvt_pk_bf16_f32 v205, v206, v207
    v_cvt_pk_bf16_f32 v206, v220, v221
    v_cvt_pk_bf16_f32 v207, v222, v223
    v_mfma_f32_16x16x32_bf16 v[128:131], v[72:75], v[56:59], v[128:131]
    v_max3_f32 v36, v224, v225, v226
    v_max3_f32 v38, -v224, -v225, -v226
    v_max3_f32 v36, v36, v227, v228
    v_max3_f32 v38, v38, -v227, -v228
    v_mfma_f32_16x16x32_bf16 v[144:147], v[76:79], v[56:59], v[144:147]
    v_max3_f32 v36, v36, v229, v230
    v_max3_f32 v38, v38, -v229, -v230
    v_max3_f32 v36, v36, v231, v232
    v_max3_f32 v38, v38, -v231, -v232
    v_mfma_f32_16x16x32_bf16 v[148:151], v[76:79], v[60:63], v[148:151]
    v_max3_f32 v36, v36, v233, v234
    v_max3_f32 v38, v38, -v233, -v234
    v_max3_f32 v36, v36, v235, v236
    v_max3_f32 v38, v38, -v235, -v236
    v_mfma_f32_16x16x32_bf16 v[132:135], v[72:75], v[60:63], v[132:135]
    v_max3_f32 v36, v36, v237, v238
    v_max3_f32 v38, v38, -v237, -v238
    v_max_f32_e64 v36, v36, v239
    v_max_f32 v38, v38, -v239
    v_mfma_f32_16x16x32_bf16 v[136:139], v[72:75], v[64:67], v[136:139]
    v_max3_f32 v37, v240, v241, v242
    v_max3_f32 v39, -v240, -v241, -v242
    v_max3_f32 v37, v37, v243, v244
    v_max3_f32 v39, v39, -v243, -v244
    v_mfma_f32_16x16x32_bf16 v[152:155], v[76:79], v[64:67], v[152:155]
    v_max3_f32 v37, v37, v245, v246
    v_max3_f32 v39, v39, -v245, -v246
    v_max3_f32 v37, v37, v247, v248
    v_max3_f32 v39, v39, -v247, -v248
    v_mfma_f32_16x16x32_bf16 v[156:159], v[76:79], v[68:71], v[156:159]
    v_max3_f32 v37, v37, v249, v250
    v_max3_f32 v39, v39, -v249, -v250
    v_max3_f32 v37, v37, v251, v252
    v_max3_f32 v39, v39, -v251, -v252
    v_mfma_f32_16x16x32_bf16 v[140:143], v[72:75], v[68:71], v[140:143]
    v_max3_f32 v37, v37, v253, v254
    v_max3_f32 v39, v39, -v253, -v254
    v_max_f32_e64 v37, v37, v255
    v_max_f32 v39, v39, -v255
    v_permlane32_swap_b32 v36, v38
    s_nop 0
    v_permlane32_swap_b32 v37, v39
    v_max_f32 v36, v36, v38
    v_max_f32_e64 v37, v37, v39
    v_mul_f32 v36, -v36, v34
    v_mul_f32 v37, -v37, v48
    v_mov_b32 v38, v36
    v_mov_b32 v39, v37
    s_nop 0
    v_permlane32_swap_b32 v36, v38
    v_permlane32_swap_b32_e64 v37, v39
    v_pk_fma_f32 v[60:61], v[224:225], v[34:35], v[36:37] op_sel_hi:[1,0,0]
    v_pk_fma_f32 v[62:63], v[226:227], v[34:35], v[36:37] op_sel_hi:[1,0,0]
    v_pk_fma_f32 v[64:65], v[228:229], v[34:35], v[36:37] op_sel_hi:[1,0,0]
    v_pk_fma_f32 v[66:67], v[230:231], v[34:35], v[36:37] op_sel_hi:[1,0,0]
    v_pk_fma_f32 v[68:69], v[232:233], v[34:35], v[36:37] op_sel_hi:[1,0,0]
    v_pk_fma_f32 v[70:71], v[234:235], v[34:35], v[36:37] op_sel_hi:[1,0,0]
    v_pk_fma_f32 v[72:73], v[236:237], v[34:35], v[36:37] op_sel_hi:[1,0,0]
    v_pk_fma_f32 v[74:75], v[238:239], v[34:35], v[36:37] op_sel_hi:[1,0,0]
    v_pk_fma_f32 v[76:77], v[224:225], v[34:35], v[38:39] op_sel_hi:[1,0,0] neg_lo:[1,0,0] neg_hi:[1,0,0]
    v_pk_fma_f32 v[78:79], v[226:227], v[34:35], v[38:39] op_sel_hi:[1,0,0] neg_lo:[1,0,0] neg_hi:[1,0,0]
    v_pk_fma_f32 v[80:81], v[228:229], v[34:35], v[38:39] op_sel_hi:[1,0,0] neg_lo:[1,0,0] neg_hi:[1,0,0]
    v_pk_fma_f32 v[82:83], v[230:231], v[34:35], v[38:39] op_sel_hi:[1,0,0] neg_lo:[1,0,0] neg_hi:[1,0,0]
    v_pk_fma_f32 v[84:85], v[232:233], v[34:35], v[38:39] op_sel_hi:[1,0,0] neg_lo:[1,0,0] neg_hi:[1,0,0]
    v_pk_fma_f32 v[86:87], v[234:235], v[34:35], v[38:39] op_sel_hi:[1,0,0] neg_lo:[1,0,0] neg_hi:[1,0,0]
    v_pk_fma_f32 v[88:89], v[236:237], v[34:35], v[38:39] op_sel_hi:[1,0,0] neg_lo:[1,0,0] neg_hi:[1,0,0]
    v_pk_fma_f32 v[90:91], v[238:239], v[34:35], v[38:39] op_sel_hi:[1,0,0] neg_lo:[1,0,0] neg_hi:[1,0,0]
    v_exp_f32 v60, v60
    v_exp_f32 v61, v61
    v_exp_f32 v62, v62
    v_exp_f32 v63, v63
    v_exp_f32 v64, v64
    v_exp_f32 v65, v65
    v_exp_f32 v66, v66
    v_exp_f32 v67, v67
    v_exp_f32 v68, v68
    v_exp_f32 v69, v69
    v_exp_f32 v70, v70
    v_exp_f32 v71, v71
    v_exp_f32 v72, v72
    v_exp_f32 v73, v73
    v_exp_f32 v74, v74
    v_exp_f32 v75, v75
    v_exp_f32 v76, v76
    v_exp_f32 v77, v77
    v_exp_f32 v78, v78
    v_exp_f32 v79, v79
    v_exp_f32 v80, v80
    v_exp_f32 v81, v81
    v_exp_f32 v82, v82
    v_exp_f32 v83, v83
    v_exp_f32 v84, v84
    v_exp_f32 v85, v85
    v_exp_f32 v86, v86
    v_exp_f32 v87, v87
    v_exp_f32 v88, v88
    v_exp_f32 v89, v89
    v_exp_f32 v90, v90
    v_exp_f32 v91, v91
    v_pk_add_f32 v[40:41], v[60:61], v[62:63]
    v_pk_add_f32 v[42:43], v[76:77], v[78:79]
    v_pk_add_f32 v[40:41], v[40:41], v[64:65]
    v_pk_add_f32 v[42:43], v[42:43], v[80:81]
    v_pk_add_f32 v[40:41], v[40:41], v[66:67]
    v_pk_add_f32 v[42:43], v[42:43], v[82:83]
    v_pk_add_f32 v[40:41], v[40:41], v[68:69]
    v_pk_add_f32 v[42:43], v[42:43], v[84:85]
    v_pk_add_f32 v[40:41], v[40:41], v[70:71]
    v_pk_add_f32 v[42:43], v[42:43], v[86:87]
    v_pk_add_f32 v[40:41], v[40:41], v[72:73]
    v_pk_add_f32 v[42:43], v[42:43], v[88:89]
    v_pk_add_f32 v[40:41], v[40:41], v[74:75]
    v_pk_add_f32 v[42:43], v[42:43], v[90:91]
    v_add_f32 v40, v40, v41
    v_add_f32 v42, v42, v43
    s_nop 1
    v_permlane32_swap_b32 v40, v42
    v_add_f32 v40, v40, v42
    v_rcp_f32 v40, v40
    s_nop 0
    v_mov_b32 v42, v40
    s_nop 1
    v_permlane32_swap_b32 v40, v42
    v_pk_mul_f32 v[60:61], v[60:61], v[40:41] op_sel_hi:[1,0]
    v_pk_mul_f32 v[62:63], v[62:63], v[40:41] op_sel_hi:[1,0]
    v_pk_mul_f32 v[64:65], v[64:65], v[40:41] op_sel_hi:[1,0]
    v_pk_mul_f32 v[66:67], v[66:67], v[40:41] op_sel_hi:[1,0]
    v_cvt_pk_bf16_f32 v160, v60, v61
    v_cvt_pk_bf16_f32 v161, v62, v63
    v_cvt_pk_bf16_f32 v162, v64, v65
    v_cvt_pk_bf16_f32 v163, v66, v67
    v_pk_mul_f32 v[68:69], v[68:69], v[40:41] op_sel_hi:[1,0]
    v_pk_mul_f32 v[70:71], v[70:71], v[40:41] op_sel_hi:[1,0]
    v_pk_mul_f32 v[72:73], v[72:73], v[40:41] op_sel_hi:[1,0]
    v_pk_mul_f32 v[74:75], v[74:75], v[40:41] op_sel_hi:[1,0]
    v_cvt_pk_bf16_f32 v166, v68, v69
    v_cvt_pk_bf16_f32 v167, v70, v71
    v_cvt_pk_bf16_f32 v164, v72, v73
    v_cvt_pk_bf16_f32 v165, v74, v75
    v_pk_mul_f32 v[76:77], v[76:77], v[42:43] op_sel_hi:[1,0]
    v_pk_mul_f32 v[78:79], v[78:79], v[42:43] op_sel_hi:[1,0]
    v_pk_mul_f32 v[80:81], v[80:81], v[42:43] op_sel_hi:[1,0]
    v_pk_mul_f32 v[82:83], v[82:83], v[42:43] op_sel_hi:[1,0]
    v_cvt_pk_bf16_f32 v168, v76, v77
    v_cvt_pk_bf16_f32 v169, v78, v79
    v_cvt_pk_bf16_f32 v170, v80, v81
    v_cvt_pk_bf16_f32 v171, v82, v83
    v_pk_mul_f32 v[84:85], v[84:85], v[42:43] op_sel_hi:[1,0]
    v_pk_mul_f32 v[86:87], v[86:87], v[42:43] op_sel_hi:[1,0]
    v_pk_mul_f32 v[88:89], v[88:89], v[42:43] op_sel_hi:[1,0]
    v_pk_mul_f32 v[90:91], v[90:91], v[42:43] op_sel_hi:[1,0]
    v_cvt_pk_bf16_f32 v174, v84, v85
    v_cvt_pk_bf16_f32 v175, v86, v87
    v_cvt_pk_bf16_f32 v172, v88, v89
    v_cvt_pk_bf16_f32 v173, v90, v91
    v_pk_fma_f32 v[60:61], v[240:241], v[48:49], v[36:37] op_sel:[0,0,1] op_sel_hi:[1,0,1]
    v_pk_fma_f32 v[62:63], v[242:243], v[48:49], v[36:37] op_sel:[0,0,1] op_sel_hi:[1,0,1]
    v_pk_fma_f32 v[64:65], v[244:245], v[48:49], v[36:37] op_sel:[0,0,1] op_sel_hi:[1,0,1]
    v_pk_fma_f32 v[66:67], v[246:247], v[48:49], v[36:37] op_sel:[0,0,1] op_sel_hi:[1,0,1]
    v_pk_fma_f32 v[68:69], v[248:249], v[48:49], v[36:37] op_sel:[0,0,1] op_sel_hi:[1,0,1]
    v_pk_fma_f32 v[70:71], v[250:251], v[48:49], v[36:37] op_sel:[0,0,1] op_sel_hi:[1,0,1]
    v_pk_fma_f32 v[72:73], v[252:253], v[48:49], v[36:37] op_sel:[0,0,1] op_sel_hi:[1,0,1]
    v_pk_fma_f32 v[74:75], v[254:255], v[48:49], v[36:37] op_sel:[0,0,1] op_sel_hi:[1,0,1]
    v_pk_fma_f32 v[76:77], v[240:241], v[48:49], v[38:39] op_sel:[0,0,1] op_sel_hi:[1,0,1] neg_lo:[1,0,0] neg_hi:[1,0,0]
    v_pk_fma_f32 v[78:79], v[242:243], v[48:49], v[38:39] op_sel:[0,0,1] op_sel_hi:[1,0,1] neg_lo:[1,0,0] neg_hi:[1,0,0]
    v_pk_fma_f32 v[80:81], v[244:245], v[48:49], v[38:39] op_sel:[0,0,1] op_sel_hi:[1,0,1] neg_lo:[1,0,0] neg_hi:[1,0,0]
    v_pk_fma_f32 v[82:83], v[246:247], v[48:49], v[38:39] op_sel:[0,0,1] op_sel_hi:[1,0,1] neg_lo:[1,0,0] neg_hi:[1,0,0]
    v_pk_fma_f32 v[84:85], v[248:249], v[48:49], v[38:39] op_sel:[0,0,1] op_sel_hi:[1,0,1] neg_lo:[1,0,0] neg_hi:[1,0,0]
    v_pk_fma_f32 v[86:87], v[250:251], v[48:49], v[38:39] op_sel:[0,0,1] op_sel_hi:[1,0,1] neg_lo:[1,0,0] neg_hi:[1,0,0]
    v_pk_fma_f32 v[88:89], v[252:253], v[48:49], v[38:39] op_sel:[0,0,1] op_sel_hi:[1,0,1] neg_lo:[1,0,0] neg_hi:[1,0,0]
    v_pk_fma_f32 v[90:91], v[254:255], v[48:49], v[38:39] op_sel:[0,0,1] op_sel_hi:[1,0,1] neg_lo:[1,0,0] neg_hi:[1,0,0]
    v_exp_f32 v60, v60
    v_exp_f32 v61, v61
    v_exp_f32 v62, v62
    v_exp_f32 v63, v63
    ds_write_b128 v116, v[192:195] offset:0
    v_exp_f32 v64, v64
    v_exp_f32 v65, v65
    v_exp_f32 v66, v66
    v_exp_f32 v67, v67
    ds_write_b128 v116, v[196:199] offset:2048
    v_exp_f32 v68, v68
    v_exp_f32 v69, v69
    v_exp_f32 v70, v70
    v_exp_f32 v71, v71
    ds_write_b128 v116, v[200:203] offset:4096
    v_exp_f32 v72, v72
    v_exp_f32 v73, v73
    v_exp_f32 v74, v74
    v_exp_f32 v75, v75
    ds_write_b128 v116, v[204:207] offset:6144
    v_exp_f32 v76, v76
    v_exp_f32 v77, v77
    v_exp_f32 v78, v78
    v_exp_f32 v79, v79
    ds_write_b128 v112, v[160:163] offset:0
    v_exp_f32 v80, v80
    v_exp_f32 v81, v81
    v_exp_f32 v82, v82
    v_exp_f32 v83, v83
    ds_write_b128 v113, v[164:167] offset:0
    v_exp_f32 v84, v84
    v_exp_f32 v85, v85
    v_exp_f32 v86, v86
    v_exp_f32 v87, v87
    ds_write_b128 v114, v[168:171] offset:0
    v_exp_f32 v88, v88
    v_exp_f32 v89, v89
    v_exp_f32 v90, v90
    v_exp_f32 v91, v91
    ds_write_b128 v115, v[172:175] offset:0
    v_pk_add_f32 v[40:41], v[60:61], v[62:63]
    v_pk_add_f32 v[42:43], v[76:77], v[78:79]
    v_pk_add_f32 v[40:41], v[40:41], v[64:65]
    v_pk_add_f32 v[42:43], v[42:43], v[80:81]
    v_pk_add_f32 v[40:41], v[40:41], v[66:67]
    v_pk_add_f32 v[42:43], v[42:43], v[82:83]
    v_pk_add_f32 v[40:41], v[40:41], v[68:69]
    v_pk_add_f32 v[42:43], v[42:43], v[84:85]
    v_pk_add_f32 v[40:41], v[40:41], v[70:71]
    v_pk_add_f32 v[42:43], v[42:43], v[86:87]
    v_pk_add_f32 v[40:41], v[40:41], v[72:73]
    v_pk_add_f32 v[42:43], v[42:43], v[88:89]
    v_pk_add_f32 v[40:41], v[40:41], v[74:75]
    v_pk_add_f32 v[42:43], v[42:43], v[90:91]
    v_add_f32 v40, v40, v41
    v_add_f32 v42, v42, v43
    s_nop 1
    v_permlane32_swap_b32 v40, v42
    v_add_f32 v40, v40, v42
    v_rcp_f32 v40, v40
    s_nop 0
    v_mov_b32 v42, v40
    s_nop 1
    v_permlane32_swap_b32 v40, v42
    v_pk_mul_f32 v[60:61], v[60:61], v[40:41] op_sel_hi:[1,0]
    v_pk_mul_f32 v[62:63], v[62:63], v[40:41] op_sel_hi:[1,0]
    v_pk_mul_f32 v[64:65], v[64:65], v[40:41] op_sel_hi:[1,0]
    v_pk_mul_f32 v[66:67], v[66:67], v[40:41] op_sel_hi:[1,0]
    v_cvt_pk_bf16_f32 v176, v60, v61
    v_cvt_pk_bf16_f32 v177, v62, v63
    v_cvt_pk_bf16_f32 v178, v64, v65
    v_cvt_pk_bf16_f32 v179, v66, v67
    ds_write_b128 v112, v[176:179] offset:4096
    v_pk_mul_f32 v[68:69], v[68:69], v[40:41] op_sel_hi:[1,0]
    v_pk_mul_f32 v[70:71], v[70:71], v[40:41] op_sel_hi:[1,0]
    v_pk_mul_f32 v[72:73], v[72:73], v[40:41] op_sel_hi:[1,0]
    v_pk_mul_f32 v[74:75], v[74:75], v[40:41] op_sel_hi:[1,0]
    v_cvt_pk_bf16_f32 v182, v68, v69
    v_cvt_pk_bf16_f32 v183, v70, v71
    v_cvt_pk_bf16_f32 v180, v72, v73
    v_cvt_pk_bf16_f32 v181, v74, v75
    ds_write_b128 v113, v[180:183] offset:4096
    v_pk_mul_f32 v[76:77], v[76:77], v[42:43] op_sel_hi:[1,0]
    v_pk_mul_f32 v[78:79], v[78:79], v[42:43] op_sel_hi:[1,0]
    v_pk_mul_f32 v[80:81], v[80:81], v[42:43] op_sel_hi:[1,0]
    v_pk_mul_f32 v[82:83], v[82:83], v[42:43] op_sel_hi:[1,0]
L_pad8:
    s_cbranch_execz L_pad12
    s_nop 0
    v_cvt_pk_bf16_f32 v184, v76, v77
    v_cvt_pk_bf16_f32 v185, v78, v79
    v_cvt_pk_bf16_f32 v186, v80, v81
    v_cvt_pk_bf16_f32 v187, v82, v83
    ds_write_b128 v114, v[184:187] offset:4096
    v_pk_mul_f32 v[84:85], v[84:85], v[42:43] op_sel_hi:[1,0]
    v_pk_mul_f32 v[86:87], v[86:87], v[42:43] op_sel_hi:[1,0]
    v_pk_mul_f32 v[88:89], v[88:89], v[42:43] op_sel_hi:[1,0]
    v_pk_mul_f32 v[90:91], v[90:91], v[42:43] op_sel_hi:[1,0]
    v_cvt_pk_bf16_f32 v190, v84, v85
    v_cvt_pk_bf16_f32 v191, v86, v87
    v_cvt_pk_bf16_f32 v188, v88, v89
    v_cvt_pk_bf16_f32 v189, v90, v91
    ds_write_b128 v115, v[188:191] offset:4096
    s_waitcnt lgkmcnt(0)
    s_barrier
    s_setprio 0
    s_nop 0
    v_mfma_f32_16x16x16_bf16 v[128:131], v[16:17], v[104:105], v[128:131]
    v_mfma_f32_16x16x16_bf16 v[144:147], v[18:19], v[104:105], v[144:147]
    v_mfma_f32_16x16x16_bf16 v[132:135], v[16:17], v[106:107], v[132:135]
    v_mfma_f32_16x16x16_bf16 v[148:151], v[18:19], v[106:107], v[148:151]
    v_mfma_f32_16x16x16_bf16 v[136:139], v[16:17], v[108:109], v[136:139]
    v_mfma_f32_16x16x16_bf16 v[152:155], v[18:19], v[108:109], v[152:155]
    v_mfma_f32_16x16x16_bf16 v[140:143], v[16:17], v[110:111], v[140:143]
    v_mfma_f32_16x16x16_bf16 v[156:159], v[18:19], v[110:111], v[156:159]
    v_lshrrev_b32 v11, 5, v2
    s_lshl_b32 s78, s81, 7
    s_add_u32 s78, s78, 162944
    v_lshl_add_u32 v10, v11, 4, s78
    v_and_b32 v13, 1, v2
    v_cmp_eq_u32 vcc, 1, v13
    v_mov_b32 v13, 162816
    v_and_b32 v12, 31, v2
    v_cndmask_b32 v10, v10, v13, vcc
    v_lshlrev_b32_e64 v12, 4, v12
    v_lshl_add_u32 v11, v11, 10, v12
    v_lshlrev_b32_e64 v14, 4, v2
    v_cvt_pk_bf16_f32 v128, v128, v129
    v_cvt_pk_bf16_f32 v129, v130, v131
    v_cvt_pk_bf16_f32 v130, v144, v145
    v_cvt_pk_bf16_f32 v131, v146, v147
    v_cvt_pk_bf16_f32 v132, v132, v133
    v_cvt_pk_bf16_f32 v133, v134, v135
    v_cvt_pk_bf16_f32 v134, v148, v149
    v_cvt_pk_bf16_f32 v135, v150, v151
    v_cvt_pk_bf16_f32 v136, v136, v137
    v_cvt_pk_bf16_f32 v137, v138, v139
    v_cvt_pk_bf16_f32 v138, v152, v153
    v_cvt_pk_bf16_f32 v139, v154, v155
    v_cvt_pk_bf16_f32 v140, v140, v141
    v_cvt_pk_bf16_f32 v141, v142, v143
    v_cvt_pk_bf16_f32 v142, v156, v157
    v_cvt_pk_bf16_f32 v143, v158, v159
    v_permlane16_swap_b32 v128, v132
    v_permlane16_swap_b32 v129, v133
    v_permlane16_swap_b32 v130, v134
    v_permlane16_swap_b32 v131, v135
    v_permlane16_swap_b32 v136, v140
    v_permlane16_swap_b32 v137, v141
    v_permlane16_swap_b32 v138, v142
    v_permlane16_swap_b32 v139, v143
    v_mfma_f32_32x32x16_bf16 v[224:239], v[96:99], v[128:131], 0
    v_mfma_f32_32x32x16_bf16 v[224:239], v[100:103], v[132:135], v[224:239]
    v_mfma_f32_32x32x16_bf16 v[240:255], v[96:99], v[136:139], 0
    v_mfma_f32_32x32x16_bf16 v[240:255], v[100:103], v[140:143], v[240:255]
    s_lshl_b32 s94, s70, 14
    s_lshl_b32 s79, s81, 13
    s_add_u32 s94, s94, s79
    s_add_u32 s94, s94, 8388608
    s_add_u32 s95, s94, 4096
    s_lshl_b32 s78, s69, 1
    s_add_u32 s78, s78, s80
    s_lshl_b32 s78, s78, 6
    s_lshl_b32 s79, s70, 1
    s_add_u32 s78, s78, s79
    s_add_u32 s78, s78, s81
    s_lshl_b32 s78, s78, 11
    s_add_u32 s96, s78, 4194304
    s_add_u32 s97, s96, 65536
    v_max3_f32 v36, v224, v225, v226
    v_max3_f32 v38, -v224, -v225, -v226
    v_max3_f32 v36, v36, v227, v228
    v_max3_f32 v38, v38, -v227, -v228
    v_max3_f32 v36, v36, v229, v230
    v_max3_f32 v38, v38, -v229, -v230
    v_max3_f32 v36, v36, v231, v232
    v_max3_f32 v38, v38, -v231, -v232
    v_max3_f32 v36, v36, v233, v234
    v_max3_f32 v38, v38, -v233, -v234
    v_max3_f32 v36, v36, v235, v236
    v_max3_f32 v38, v38, -v235, -v236
    v_max3_f32 v36, v36, v237, v238
    v_max3_f32 v38, v38, -v237, -v238
    v_max_f32_e64 v36, v36, v239
    v_max_f32 v38, v38, -v239
    v_max3_f32 v37, v240, v241, v242
    v_max3_f32 v39, -v240, -v241, -v242
    v_max3_f32 v37, v37, v243, v244
    v_max3_f32 v39, v39, -v243, -v244
    v_max3_f32 v37, v37, v245, v246
    v_max3_f32 v39, v39, -v245, -v246
    v_max3_f32 v37, v37, v247, v248
    v_max3_f32 v39, v39, -v247, -v248
    v_max3_f32 v37, v37, v249, v250
    v_max3_f32 v39, v39, -v249, -v250
    v_max3_f32 v37, v37, v251, v252
    v_max3_f32 v39, v39, -v251, -v252
    v_max3_f32 v37, v37, v253, v254
    v_max3_f32 v39, v39, -v253, -v254
    v_max_f32_e64 v37, v37, v255
    v_max_f32 v39, v39, -v255
    v_permlane32_swap_b32 v36, v38
    s_nop 0
    v_permlane32_swap_b32 v37, v39
    v_max_f32 v36, v36, v38
    v_max_f32_e64 v37, v37, v39
    v_mul_f32 v36, -v36, v34
    v_mul_f32 v37, -v37, v48
    v_mov_b32 v38, v36
    v_mov_b32 v39, v37
    s_nop 0
    v_permlane32_swap_b32 v36, v38
    v_permlane32_swap_b32_e64 v37, v39
    v_pk_fma_f32 v[60:61], v[224:225], v[34:35], v[36:37] op_sel_hi:[1,0,0]
    v_pk_fma_f32 v[62:63], v[226:227], v[34:35], v[36:37] op_sel_hi:[1,0,0]
    v_pk_fma_f32 v[64:65], v[228:229], v[34:35], v[36:37] op_sel_hi:[1,0,0]
    v_pk_fma_f32 v[66:67], v[230:231], v[34:35], v[36:37] op_sel_hi:[1,0,0]
    v_pk_fma_f32 v[68:69], v[232:233], v[34:35], v[36:37] op_sel_hi:[1,0,0]
    v_pk_fma_f32 v[70:71], v[234:235], v[34:35], v[36:37] op_sel_hi:[1,0,0]
    v_pk_fma_f32 v[72:73], v[236:237], v[34:35], v[36:37] op_sel_hi:[1,0,0]
    v_pk_fma_f32 v[74:75], v[238:239], v[34:35], v[36:37] op_sel_hi:[1,0,0]
    v_pk_fma_f32 v[76:77], v[224:225], v[34:35], v[38:39] op_sel_hi:[1,0,0] neg_lo:[1,0,0] neg_hi:[1,0,0]
    v_pk_fma_f32 v[78:79], v[226:227], v[34:35], v[38:39] op_sel_hi:[1,0,0] neg_lo:[1,0,0] neg_hi:[1,0,0]
    v_pk_fma_f32 v[80:81], v[228:229], v[34:35], v[38:39] op_sel_hi:[1,0,0] neg_lo:[1,0,0] neg_hi:[1,0,0]
    v_pk_fma_f32 v[82:83], v[230:231], v[34:35], v[38:39] op_sel_hi:[1,0,0] neg_lo:[1,0,0] neg_hi:[1,0,0]
    v_pk_fma_f32 v[84:85], v[232:233], v[34:35], v[38:39] op_sel_hi:[1,0,0] neg_lo:[1,0,0] neg_hi:[1,0,0]
    v_pk_fma_f32 v[86:87], v[234:235], v[34:35], v[38:39] op_sel_hi:[1,0,0] neg_lo:[1,0,0] neg_hi:[1,0,0]
    v_pk_fma_f32 v[88:89], v[236:237], v[34:35], v[38:39] op_sel_hi:[1,0,0] neg_lo:[1,0,0] neg_hi:[1,0,0]
    v_pk_fma_f32 v[90:91], v[238:239], v[34:35], v[38:39] op_sel_hi:[1,0,0] neg_lo:[1,0,0] neg_hi:[1,0,0]
    v_exp_f32 v60, v60
    v_exp_f32 v61, v61
    v_exp_f32 v62, v62
    v_exp_f32 v63, v63
    v_exp_f32 v64, v64
    v_exp_f32 v65, v65
    v_exp_f32 v66, v66
    v_exp_f32 v67, v67
    v_exp_f32 v68, v68
    v_exp_f32 v69, v69
    v_exp_f32 v70, v70
    v_exp_f32 v71, v71
    v_exp_f32 v72, v72
    v_exp_f32 v73, v73
    v_exp_f32 v74, v74
    v_exp_f32 v75, v75
    v_exp_f32 v76, v76
    v_exp_f32 v77, v77
    v_exp_f32 v78, v78
    v_exp_f32 v79, v79
    v_exp_f32 v80, v80
    v_exp_f32 v81, v81
    v_exp_f32 v82, v82
    v_exp_f32 v83, v83
    v_exp_f32 v84, v84
    v_exp_f32 v85, v85
    v_exp_f32 v86, v86
    v_exp_f32 v87, v87
    v_exp_f32 v88, v88
    v_exp_f32 v89, v89
    v_exp_f32 v90, v90
    v_exp_f32 v91, v91
    v_cvt_pk_bf16_f32 v160, v60, v61
    v_cvt_pk_bf16_f32 v161, v62, v63
    v_cvt_pk_bf16_f32 v162, v64, v65
    v_cvt_pk_bf16_f32 v163, v66, v67
    v_cvt_pk_bf16_f32 v164, v68, v69
    v_cvt_pk_bf16_f32 v165, v70, v71
    v_cvt_pk_bf16_f32 v166, v72, v73
    v_cvt_pk_bf16_f32 v167, v74, v75
    v_cvt_pk_bf16_f32 v168, v76, v77
    v_cvt_pk_bf16_f32 v169, v78, v79
    v_cvt_pk_bf16_f32 v170, v80, v81
    v_cvt_pk_bf16_f32 v171, v82, v83
    v_cvt_pk_bf16_f32 v172, v84, v85
    v_cvt_pk_bf16_f32 v173, v86, v87
    v_cvt_pk_bf16_f32 v174, v88, v89
    v_cvt_pk_bf16_f32 v175, v90, v91
    v_pk_fma_f32 v[60:61], v[240:241], v[48:49], v[36:37] op_sel:[0,0,1] op_sel_hi:[1,0,1]
    v_pk_fma_f32 v[62:63], v[242:243], v[48:49], v[36:37] op_sel:[0,0,1] op_sel_hi:[1,0,1]
    v_pk_fma_f32 v[64:65], v[244:245], v[48:49], v[36:37] op_sel:[0,0,1] op_sel_hi:[1,0,1]
    v_pk_fma_f32 v[66:67], v[246:247], v[48:49], v[36:37] op_sel:[0,0,1] op_sel_hi:[1,0,1]
    v_pk_fma_f32 v[68:69], v[248:249], v[48:49], v[36:37] op_sel:[0,0,1] op_sel_hi:[1,0,1]
    v_pk_fma_f32 v[70:71], v[250:251], v[48:49], v[36:37] op_sel:[0,0,1] op_sel_hi:[1,0,1]
    v_pk_fma_f32 v[72:73], v[252:253], v[48:49], v[36:37] op_sel:[0,0,1] op_sel_hi:[1,0,1]
    v_pk_fma_f32 v[74:75], v[254:255], v[48:49], v[36:37] op_sel:[0,0,1] op_sel_hi:[1,0,1]
    v_pk_fma_f32 v[76:77], v[240:241], v[48:49], v[38:39] op_sel:[0,0,1] op_sel_hi:[1,0,1] neg_lo:[1,0,0] neg_hi:[1,0,0]
    v_pk_fma_f32 v[78:79], v[242:243], v[48:49], v[38:39] op_sel:[0,0,1] op_sel_hi:[1,0,1] neg_lo:[1,0,0] neg_hi:[1,0,0]
    v_pk_fma_f32 v[80:81], v[244:245], v[48:49], v[38:39] op_sel:[0,0,1] op_sel_hi:[1,0,1] neg_lo:[1,0,0] neg_hi:[1,0,0]
    v_pk_fma_f32 v[82:83], v[246:247], v[48:49], v[38:39] op_sel:[0,0,1] op_sel_hi:[1,0,1] neg_lo:[1,0,0] neg_hi:[1,0,0]
    v_pk_fma_f32 v[84:85], v[248:249], v[48:49], v[38:39] op_sel:[0,0,1] op_sel_hi:[1,0,1] neg_lo:[1,0,0] neg_hi:[1,0,0]
    v_pk_fma_f32 v[86:87], v[250:251], v[48:49], v[38:39] op_sel:[0,0,1] op_sel_hi:[1,0,1] neg_lo:[1,0,0] neg_hi:[1,0,0]
    v_pk_fma_f32 v[88:89], v[252:253], v[48:49], v[38:39] op_sel:[0,0,1] op_sel_hi:[1,0,1] neg_lo:[1,0,0] neg_hi:[1,0,0]
    v_pk_fma_f32 v[90:91], v[254:255], v[48:49], v[38:39] op_sel:[0,0,1] op_sel_hi:[1,0,1] neg_lo:[1,0,0] neg_hi:[1,0,0]
    v_exp_f32 v60, v60
    v_exp_f32 v61, v61
    v_exp_f32 v62, v62
    v_exp_f32 v63, v63
    v_exp_f32 v64, v64
    v_exp_f32 v65, v65
    v_exp_f32 v66, v66
    v_exp_f32 v67, v67
    v_exp_f32 v68, v68
    v_exp_f32 v69, v69
    v_exp_f32 v70, v70
    v_exp_f32 v71, v71
    v_exp_f32 v72, v72
    v_exp_f32 v73, v73
    v_exp_f32 v74, v74
    v_exp_f32 v75, v75
    v_exp_f32 v76, v76
    v_exp_f32 v77, v77
    v_exp_f32 v78, v78
    v_exp_f32 v79, v79
    v_exp_f32 v80, v80
    v_exp_f32 v81, v81
    v_exp_f32 v82, v82
    v_exp_f32 v83, v83
    v_exp_f32 v84, v84
    v_exp_f32 v85, v85
    v_exp_f32 v86, v86
    v_exp_f32 v87, v87
    v_exp_f32 v88, v88
    v_exp_f32 v89, v89
    v_exp_f32 v90, v90
    v_exp_f32 v91, v91
    v_cvt_pk_bf16_f32 v176, v60, v61
    v_cvt_pk_bf16_f32 v177, v62, v63
    v_cvt_pk_bf16_f32 v178, v64, v65
    v_cvt_pk_bf16_f32 v179, v66, v67
    v_cvt_pk_bf16_f32 v180, v68, v69
    v_cvt_pk_bf16_f32 v181, v70, v71
    v_cvt_pk_bf16_f32 v182, v72, v73
    v_cvt_pk_bf16_f32 v183, v74, v75
    v_cvt_pk_bf16_f32 v184, v76, v77
    v_cvt_pk_bf16_f32 v185, v78, v79
    v_cvt_pk_bf16_f32 v186, v80, v81
    v_cvt_pk_bf16_f32 v187, v82, v83
    v_cvt_pk_bf16_f32 v188, v84, v85
    v_cvt_pk_bf16_f32 v189, v86, v87
    v_cvt_pk_bf16_f32 v190, v88, v89
    v_cvt_pk_bf16_f32 v191, v90, v91
    s_barrier
    s_setprio 1
    ds_read_b128 v[16:19], v10 offset:0
    ds_read_b128 v[20:23], v10 offset:32
    ds_read_b128 v[24:27], v10 offset:64
    ds_read_b128 v[28:31], v10 offset:96
    s_waitcnt lgkmcnt(3)
    v_mfma_f32_32x32x16_bf16 v[224:239], v[16:19], v[160:163], 0
    s_waitcnt lgkmcnt(2)
    v_mfma_f32_32x32x16_bf16 v[224:239], v[20:23], v[164:167], v[224:239]
    buffer_load_dwordx4 v[96:99], v11, s[36:39], s94 offen offset:0 sc1
    buffer_load_dwordx4 v[100:103], v11, s[36:39], s94 offen offset:2048 sc1
    buffer_load_dwordx4 v[104:107], v11, s[36:39], s95 offen offset:0 sc1
    buffer_load_dwordx4 v[108:111], v11, s[36:39], s95 offen offset:2048 sc1
    s_waitcnt lgkmcnt(1)
    v_mfma_f32_32x32x16_bf16 v[240:255], v[24:27], v[168:171], 0
    s_waitcnt lgkmcnt(0)
    v_mfma_f32_32x32x16_bf16 v[240:255], v[28:31], v[172:175], v[240:255]
    v_mfma_f32_32x32x16_bf16 v[192:207], v[16:19], v[176:179], 0
    v_mfma_f32_32x32x16_bf16 v[192:207], v[20:23], v[180:183], v[192:207]
    v_mfma_f32_32x32x16_bf16 v[208:223], v[24:27], v[184:187], 0
    v_mfma_f32_32x32x16_bf16 v[208:223], v[28:31], v[188:191], v[208:223]
    s_mov_b32 s85, 0
L_kvchk:
    s_waitcnt vmcnt(0)
    v_mfma_f32_32x32x16_bf16 v[60:75], v[96:99], v[160:163], 0
    v_max3_u32 v13, v96, v97, v98
    v_max3_u32 v10, v99, v100, v101
    v_max3_u32 v13, v13, v102, v103
    v_max3_u32 v10, v10, v104, v105
    v_max3_u32 v13, v13, v106, v107
    v_mfma_f32_32x32x16_bf16 v[60:75], v[100:103], v[164:167], v[60:75]
    v_max3_u32 v10, v10, v108, v109
    v_max3_u32 v13, v13, v110, v111
    v_max_u32 v13, v13, v10
    v_cmp_eq_u32_e64 vcc, -1, v13
    s_cbranch_vccnz L_kvspin
    v_mfma_f32_32x32x16_bf16 v[76:91], v[104:107], v[168:171], 0
    v_rcp_f32 v36, v225
    v_rcp_f32 v40, v193
    v_rcp_f32 v38, v241
    v_rcp_f32 v42, v209
    v_mfma_f32_32x32x16_bf16 v[76:91], v[108:111], v[172:175], v[76:91]
    v_mov_b32 v44, 0x358637bd
    v_mov_b32 v45, 0x358637bd
    v_fmac_f32 v44, v224, v36
    v_fmac_f32 v45, v192, v40
    v_fmac_f32 v44, v240, v38
    v_fmac_f32 v45, v208, v42
    v_mfma_f32_32x32x16_bf16 v[128:143], v[96:99], v[176:179], 0
    v_rcp_f32 v44, v44
    v_rcp_f32 v45, v45
    v_mul_f32 v36, v36, v44
    v_mul_f32 v40, v40, v45
    v_mfma_f32_32x32x16_bf16 v[128:143], v[100:103], v[180:183], v[128:143]
    v_mul_f32 v38, v38, v44
    v_mul_f32 v42, v42, v45
    v_mul_f32 v60, v60, v36
    v_mul_f32 v61, v61, v36
    v_mul_f32 v62, v62, v36
    v_mul_f32 v63, v63, v36
    v_mfma_f32_32x32x16_bf16 v[144:159], v[104:107], v[184:187], 0
    v_mul_f32 v64, v64, v36
    v_mul_f32 v65, v65, v36
    v_mul_f32 v66, v66, v36
    v_mul_f32 v67, v67, v36
    v_mul_f32 v68, v68, v36
    v_mul_f32 v69, v69, v36
    v_mfma_f32_32x32x16_bf16 v[144:159], v[108:111], v[188:191], v[144:159]
    v_mul_f32 v70, v70, v36
    v_mul_f32 v71, v71, v36
    v_mul_f32 v72, v72, v36
    v_mul_f32 v73, v73, v36
L_pad9:
    s_cbranch_execz L_padret
    v_mul_f32 v74, v74, v36
    v_mul_f32_e64 v75, v75, v36
    v_pk_fma_f32 v[60:61], v[76:77], v[38:39], v[60:61] op_sel_hi:[1,0,1]
    v_pk_fma_f32 v[62:63], v[78:79], v[38:39], v[62:63] op_sel_hi:[1,0,1]
    v_pk_fma_f32 v[64:65], v[80:81], v[38:39], v[64:65] op_sel_hi:[1,0,1]
    v_pk_fma_f32 v[66:67], v[82:83], v[38:39], v[66:67] op_sel_hi:[1,0,1]
    v_cvt_pk_bf16_f32 v16, v60, v61
    v_cvt_pk_bf16_f32 v17, v62, v63
    v_cvt_pk_bf16_f32 v18, v64, v65
    v_cvt_pk_bf16_f32 v19, v66, v67
    buffer_store_dwordx4 v[16:19], v14, s[36:39], s96 offen offset:0 sc1
    v_pk_fma_f32 v[68:69], v[84:85], v[38:39], v[68:69] op_sel_hi:[1,0,1]
    v_pk_fma_f32 v[70:71], v[86:87], v[38:39], v[70:71] op_sel_hi:[1,0,1]
    v_pk_fma_f32 v[72:73], v[88:89], v[38:39], v[72:73] op_sel_hi:[1,0,1]
    v_pk_fma_f32 v[74:75], v[90:91], v[38:39], v[74:75] op_sel_hi:[1,0,1]
    v_cvt_pk_bf16_f32 v20, v68, v69
    v_cvt_pk_bf16_f32 v21, v70, v71
    v_cvt_pk_bf16_f32 v22, v72, v73
    v_cvt_pk_bf16_f32 v23, v74, v75
    buffer_store_dwordx4 v[20:23], v14, s[36:39], s96 offen offset:1024 sc1
    v_pk_mul_f32 v[128:129], v[128:129], v[40:41] op_sel_hi:[1,0]
    v_pk_mul_f32 v[130:131], v[130:131], v[40:41] op_sel_hi:[1,0]
    v_pk_mul_f32 v[132:133], v[132:133], v[40:41] op_sel_hi:[1,0]
    v_pk_mul_f32 v[134:135], v[134:135], v[40:41] op_sel_hi:[1,0]
    v_pk_fma_f32 v[128:129], v[144:145], v[42:43], v[128:129] op_sel_hi:[1,0,1]
    v_pk_fma_f32 v[130:131], v[146:147], v[42:43], v[130:131] op_sel_hi:[1,0,1]
    v_pk_fma_f32 v[132:133], v[148:149], v[42:43], v[132:133] op_sel_hi:[1,0,1]
    v_pk_fma_f32 v[134:135], v[150:151], v[42:43], v[134:135] op_sel_hi:[1,0,1]
    v_cvt_pk_bf16_f32 v24, v128, v129
    v_cvt_pk_bf16_f32 v25, v130, v131
    v_cvt_pk_bf16_f32 v26, v132, v133
    v_cvt_pk_bf16_f32 v27, v134, v135
    buffer_store_dwordx4 v[24:27], v14, s[36:39], s97 offen offset:0 sc1
    v_pk_mul_f32 v[136:137], v[136:137], v[40:41] op_sel_hi:[1,0]
    v_pk_mul_f32 v[138:139], v[138:139], v[40:41] op_sel_hi:[1,0]
    v_pk_mul_f32 v[140:141], v[140:141], v[40:41] op_sel_hi:[1,0]
    v_pk_mul_f32 v[142:143], v[142:143], v[40:41] op_sel_hi:[1,0]
    v_pk_fma_f32 v[136:137], v[152:153], v[42:43], v[136:137] op_sel_hi:[1,0,1]
    v_pk_fma_f32 v[138:139], v[154:155], v[42:43], v[138:139] op_sel_hi:[1,0,1]
    v_pk_fma_f32 v[140:141], v[156:157], v[42:43], v[140:141] op_sel_hi:[1,0,1]
    v_pk_fma_f32 v[142:143], v[158:159], v[42:43], v[142:143] op_sel_hi:[1,0,1]
    v_cvt_pk_bf16_f32 v28, v136, v137
    v_cvt_pk_bf16_f32 v29, v138, v139
    v_cvt_pk_bf16_f32 v30, v140, v141
    v_cvt_pk_bf16_f32 v31, v142, v143
    buffer_store_dwordx4 v[28:31], v14, s[36:39], s97 offen offset:1024 sc1
    v_and_b32 v8, 31, v2
    v_lshrrev_b32 v9, 5, v2
    v_lshlrev_b32 v10, 3, v9
    s_lshl_b32 s78, s72, 7
    buffer_load_dwordx2 v[32:33], v10, s[64:67], s78 offen offset:0
    buffer_load_dwordx2 v[34:35], v10, s[64:67], s78 offen offset:16
    buffer_load_dwordx2 v[36:37], v10, s[64:67], s78 offen offset:32
    buffer_load_dwordx2 v[38:39], v10, s[64:67], s78 offen offset:48
    buffer_load_dwordx2 v[40:41], v10, s[64:67], s78 offen offset:64
    buffer_load_dwordx2 v[42:43], v10, s[64:67], s78 offen offset:80
    buffer_load_dwordx2 v[44:45], v10, s[64:67], s78 offen offset:96
    buffer_load_dwordx2 v[46:47], v10, s[64:67], s78 offen offset:112
    buffer_load_dwordx4 v[48:51], v14, s[64:67], 0 offen
    buffer_load_dwordx4 v[52:55], v14, s[64:67], 0 offen offset:1024
    s_barrier
    s_lshl_b32 s78, s76, 12
    s_add_u32 s78, s78, 131072
    v_lshl_add_u32 v6, v8, 7, s78
    v_add_u32_e64 v6, v6, v10
    v_bfe_u32 v11, v8, 1, 3
    v_lshl_add_u32 v6, v11, 4, v6
    v_xor_b32 v112, 0, v6
    v_xor_b32 v113, 16, v6
    v_xor_b32 v114, 32, v6
    v_xor_b32 v115, 48, v6
    v_xor_b32_e64 v116, 64, v6
    v_xor_b32 v117, 80, v6
    v_xor_b32 v118, 96, v6
    v_xor_b32 v119, 112, v6
    v_bfe_u32 v11, v2, 2, 2
    v_lshl_add_u32 v12, v9, 2, v11
    v_lshlrev_b32 v12, 7, v12
    v_lshrrev_b32 v11, 1, v11
    v_lshl_add_u32 v12, v11, 6, v12
    v_bfe_u32 v11, v2, 4, 1
    v_lshl_add_u32 v12, v11, 5, v12
    v_and_b32_e64 v11, 3, v2
    v_lshl_add_u32 v12, v11, 3, v12
    s_lshl_b32 s82, s72, 0
    s_and_b32 s82, s82, 15
    s_lshl_b32 s78, s82, 13
    v_add_u32 v4, s78, v12
    v_xor_b32 v5, 64, v4
    s_lshl_b32 s83, s71, 2
    s_add_u32 s83, s83, s76
    s_lshl_b32 s83, s83, 16
    s_add_u32 s83, s83, 4194304
    s_lshl_b32 s82, s82, 12
    s_add_u32 s88, s82, s83
    v_lshlrev_b32_e64 v12, 4, v8
    v_lshl_add_u32 v12, v9, 16, v12
    v_add_u32 v7, 8192, v12
    s_lshl_b32 s94, s71, 17
    s_lshl_b32 s79, s76, 9
    s_add_u32 s94, s94, s79
    s_add_u32 s94, s94, 2097152
    s_lshl_b32 s95, s72, 13
    s_add_u32 s95, s95, s94
    s_lshl_b32 s78, s76, 5
    v_add_u32 v11, s78, v8
    v_and_b32 v13, 7, v8
    v_xor_b32 v13, v13, v9
    v_lshlrev_b32 v13, 4, v13
    v_lshl_add_u32 v13, v11, 8, v13
    v_lshlrev_b32_e64 v10, 3, v11
    v_add_u32 v10, 159744, v10
    s_lshl_b32 s78, s71, 7
    v_add_u32 v11, s78, v11
    s_waitcnt vmcnt(0)
    s_barrier
    ds_read_b64 v[96:97], v112
    ds_read_b64 v[98:99], v113
    ds_read_b64 v[100:101], v114
    ds_read_b64 v[102:103], v115
    ds_read_b64 v[104:105], v116
    ds_read_b64 v[106:107], v117
    ds_read_b64 v[108:109], v118
    ds_read_b64 v[110:111], v119
    v_lshlrev_b32_e64 v60, 16, v32
    v_and_b32 v61, 0xffff0000, v32
    v_lshlrev_b32_e64 v62, 16, v33
    v_and_b32 v63, 0xffff0000, v33
    v_lshlrev_b32_e64 v64, 16, v34
    v_and_b32 v65, 0xffff0000, v34
    v_lshlrev_b32_e64 v66, 16, v35
    v_and_b32 v67, 0xffff0000, v35
    v_lshlrev_b32_e64 v68, 16, v36
    v_and_b32 v69, 0xffff0000, v36
    v_lshlrev_b32_e64 v70, 16, v37
    v_and_b32 v71, 0xffff0000, v37
    v_lshlrev_b32_e64 v72, 16, v38
    v_and_b32 v73, 0xffff0000, v38
    v_lshlrev_b32_e64 v74, 16, v39
    v_and_b32 v75, 0xffff0000, v39
    v_lshlrev_b32_e64 v76, 16, v40
    v_and_b32 v77, 0xffff0000, v40
    v_lshlrev_b32_e64 v78, 16, v41
    v_and_b32 v79, 0xffff0000, v41
    v_lshlrev_b32_e64 v80, 16, v42
    v_and_b32 v81, 0xffff0000, v42
    v_lshlrev_b32_e64 v82, 16, v43
    v_and_b32 v83, 0xffff0000, v43
    v_lshlrev_b32_e64 v84, 16, v44
    v_and_b32 v85, 0xffff0000, v44
    v_lshlrev_b32_e64 v86, 16, v45
    v_and_b32 v87, 0xffff0000, v45
    v_lshlrev_b32_e64 v88, 16, v46
    v_and_b32 v89, 0xffff0000, v46
    v_lshlrev_b32_e64 v90, 16, v47
    v_and_b32 v91, 0xffff0000, v47
    s_mov_b32 s78, 0x3f803f80
    v_dot2_f32_bf16 v126, v48, s78, 0
    v_dot2_f32_bf16 v126, v49, s78, v126
    v_dot2_f32_bf16 v126, v50, s78, v126
    v_dot2_f32_bf16 v126, v51, s78, v126
    v_dot2_f32_bf16 v126, v52, s78, v126
    v_dot2_f32_bf16 v126, v53, s78, v126
    v_dot2_f32_bf16 v126, v54, s78, v126
    v_dot2_f32_bf16 v126, v55, s78, v126
    s_nop 2
    v_add_f32_dpp v126, v126, v126 row_ror:8 row_mask:0xf bank_mask:0xf
    s_nop 1
    v_add_f32_dpp v126, v126, v126 row_ror:4 row_mask:0xf bank_mask:0xf
    s_nop 1
    v_add_f32_dpp v126, v126, v126 row_ror:2 row_mask:0xf bank_mask:0xf
    s_nop 1
    v_add_f32_dpp v126, v126, v126 row_ror:1 row_mask:0xf bank_mask:0xf
    v_mov_b32 v127, v126
    s_nop 1
    v_permlane32_swap_b32 v126, v127
    v_add_f32 v126, v126, v127
    v_mov_b32 v127, v126
    s_nop 1
    v_permlane16_swap_b32 v126, v127
    v_add_f32 v126, v126, v127
    v_mov_b32 v44, 163328
    v_mov_b32_e64 v45, 1
    v_mov_b32 v46, 0xff800000
    v_mov_b32_e64 v47, 0
    ds_write_b64 v44, v[46:47]
    s_lshl_b32 s96, s71, 4
    s_add_u32 s96, s96, s72
    s_lshl_b32 s96, s96, 9
    s_add_u32 s96, s96, 524288
    v_mov_b32 v15, 163584
    ds_read_b32 v15, v15
    s_waitcnt lgkmcnt(0)
    v_readfirstlane_b32 s99, v15
    v_lshlrev_b32 v224, 16, v96
    v_and_b32 v225, 0xffff0000, v96
    v_lshlrev_b32_e64 v226, 16, v97
    v_and_b32 v227, 0xffff0000, v97
    v_lshlrev_b32_e64 v228, 16, v98
    v_and_b32 v229, 0xffff0000, v98
    v_lshlrev_b32_e64 v230, 16, v99
    v_and_b32 v231, 0xffff0000, v99
    v_lshlrev_b32_e64 v232, 16, v100
    v_and_b32 v233, 0xffff0000, v100
    v_lshlrev_b32_e64 v234, 16, v101
    v_and_b32 v235, 0xffff0000, v101
    v_lshlrev_b32_e64 v236, 16, v102
    v_and_b32 v237, 0xffff0000, v102
    v_lshlrev_b32_e64 v238, 16, v103
    v_and_b32 v239, 0xffff0000, v103
    v_lshlrev_b32_e64 v240, 16, v104
    v_and_b32 v241, 0xffff0000, v104
    v_lshlrev_b32_e64 v242, 16, v105
    v_and_b32 v243, 0xffff0000, v105
    v_lshlrev_b32_e64 v244, 16, v106
    v_and_b32 v245, 0xffff0000, v106
    v_lshlrev_b32_e64 v246, 16, v107
    v_and_b32 v247, 0xffff0000, v107
    v_lshlrev_b32_e64 v248, 16, v108
    v_and_b32 v249, 0xffff0000, v108
    v_lshlrev_b32_e64 v250, 16, v109
    v_and_b32 v251, 0xffff0000, v109
    v_lshlrev_b32_e64 v252, 16, v110
    v_and_b32 v253, 0xffff0000, v110
    v_lshlrev_b32_e64 v254, 16, v111
    v_and_b32 v255, 0xffff0000, v111
    s_mov_b32 s84, 0
    s_barrier
    buffer_load_dwordx4 v[160:163], v14, s[36:39], s88 offen offset:0 sc1
    ds_read_b64_tr_b16 v[128:129], v4 offset:0
    buffer_load_dwordx4 v[164:167], v14, s[36:39], s88 offen offset:1024 sc1
    ds_read_b64_tr_b16 v[130:131], v4 offset:1024
    buffer_load_dwordx4 v[168:171], v14, s[36:39], s88 offen offset:2048 sc1
    ds_read_b64_tr_b16 v[132:133], v5 offset:0
    buffer_load_dwordx4 v[172:175], v14, s[36:39], s88 offen offset:3072 sc1
    s_add_u32 s82, s82, 4096
    s_and_b32 s82, s82, 0xffff
    s_add_u32 s88, s82, s83
    s_nop 0
    ds_read_b64_tr_b16 v[134:135], v5 offset:1024
    buffer_load_dwordx4 v[176:179], v14, s[36:39], s88 offen offset:0 sc1
    ds_read_b64_tr_b16 v[136:137], v4 offset:2048
    buffer_load_dwordx4 v[180:183], v14, s[36:39], s88 offen offset:1024 sc1
    ds_read_b64_tr_b16 v[138:139], v4 offset:3072
    buffer_load_dwordx4 v[184:187], v14, s[36:39], s88 offen offset:2048 sc1
    ds_read_b64_tr_b16 v[140:141], v5 offset:2048
    buffer_load_dwordx4 v[188:191], v14, s[36:39], s88 offen offset:3072 sc1
    s_add_u32 s82, s82, 4096
    s_and_b32 s82, s82, 0xffff
    s_add_u32 s88, s82, s83
    s_nop 0
    ds_read_b64_tr_b16 v[142:143], v5 offset:3072
    buffer_load_dwordx4 v[192:195], v14, s[36:39], s88 offen offset:0 sc1
    buffer_load_dwordx4 v[196:199], v14, s[36:39], s88 offen offset:1024 sc1
    buffer_load_dwordx4 v[200:203], v14, s[36:39], s88 offen offset:2048 sc1
    buffer_load_dwordx4 v[204:207], v14, s[36:39], s88 offen offset:3072 sc1
    s_add_u32 s82, s82, 4096
    s_and_b32 s82, s82, 0xffff
    s_add_u32 s88, s82, s83
    buffer_load_dwordx4 v[208:211], v14, s[36:39], s88 offen offset:0 sc1
    buffer_load_dwordx4 v[212:215], v14, s[36:39], s88 offen offset:1024 sc1
    .p2align 3
L_G2:
    s_add_u32 s84, s84, 1
    s_waitcnt vmcnt(12) lgkmcnt(6)
    v_mfma_f32_32x32x16_bf16 v[224:239], v[128:131], v[160:163], v[224:239]
    ds_read_b64_tr_b16 v[144:145], v4 offset:4096
    ds_read_b64_tr_b16 v[146:147], v4 offset:5120
    buffer_load_dwordx4 v[216:219], v14, s[36:39], s88 offen offset:2048 sc1
    s_waitcnt lgkmcnt(6)
    v_mfma_f32_32x32x16_bf16 v[240:255], v[132:135], v[160:163], v[240:255]
    ds_read_b64_tr_b16 v[148:149], v5 offset:4096
    ds_read_b64_tr_b16 v[150:151], v5 offset:5120
    s_waitcnt lgkmcnt(6)
    v_mfma_f32_32x32x16_bf16 v[224:239], v[136:139], v[164:167], v[224:239]
    ds_read_b64_tr_b16 v[152:153], v4 offset:6144
    ds_read_b64_tr_b16 v[154:155], v4 offset:7168
    buffer_load_dwordx4 v[220:223], v14, s[36:39], s88 offen offset:3072 sc1
    s_add_u32 s82, s82, 4096
    s_and_b32 s82, s82, 0xffff
    s_add_u32 s88, s82, s83
    s_waitcnt lgkmcnt(6)
    v_mfma_f32_32x32x16_bf16 v[240:255], v[140:143], v[164:167], v[240:255]
    ds_read_b64_tr_b16 v[156:157], v5 offset:6144
    ds_read_b64_tr_b16 v[158:159], v5 offset:7168
    v_add_u32 v4, 0x2000, v4
    v_and_b32 v4, 0x1ffff, v4
    v_xor_b32 v5, 64, v4
    s_waitcnt vmcnt(12) lgkmcnt(6)
    v_mfma_f32_32x32x16_bf16 v[224:239], v[144:147], v[168:171], v[224:239]
    ds_read_b64_tr_b16 v[128:129], v4 offset:0
    ds_read_b64_tr_b16 v[130:131], v4 offset:1024
L_pad10:
    s_cbranch_execz L_padret
    buffer_load_dwordx4 v[160:163], v14, s[36:39], s88 offen offset:0 sc1
    s_waitcnt lgkmcnt(6)
    v_mfma_f32_32x32x16_bf16 v[240:255], v[148:151], v[168:171], v[240:255]
    ds_read_b64_tr_b16 v[132:133], v5 offset:0
    ds_read_b64_tr_b16 v[134:135], v5 offset:1024
    s_waitcnt lgkmcnt(6)
    v_mfma_f32_32x32x16_bf16 v[224:239], v[152:155], v[172:175], v[224:239]
    ds_read_b64_tr_b16 v[136:137], v4 offset:2048
    ds_read_b64_tr_b16 v[138:139], v4 offset:3072
    buffer_load_dwordx4 v[164:167], v14, s[36:39], s88 offen offset:1024 sc1
    s_waitcnt lgkmcnt(6)
    v_mfma_f32_32x32x16_bf16 v[240:255], v[156:159], v[172:175], v[240:255]
    ds_read_b64_tr_b16 v[140:141], v5 offset:2048
    ds_read_b64_tr_b16 v[142:143], v5 offset:3072
    s_waitcnt vmcnt(12) lgkmcnt(6)
    v_mfma_f32_32x32x16_bf16 v[224:239], v[128:131], v[176:179], v[224:239]
    ds_read_b64_tr_b16 v[144:145], v4 offset:4096
    ds_read_b64_tr_b16 v[146:147], v4 offset:5120
    buffer_load_dwordx4 v[168:171], v14, s[36:39], s88 offen offset:2048 sc1
    s_waitcnt lgkmcnt(6)
    v_mfma_f32_32x32x16_bf16 v[240:255], v[132:135], v[176:179], v[240:255]
    ds_read_b64_tr_b16 v[148:149], v5 offset:4096
    ds_read_b64_tr_b16 v[150:151], v5 offset:5120
    s_waitcnt lgkmcnt(6)
    s_nop 0
    v_mfma_f32_32x32x16_bf16 v[224:239], v[136:139], v[180:183], v[224:239]
    ds_read_b64_tr_b16 v[152:153], v4 offset:6144
    ds_read_b64_tr_b16 v[154:155], v4 offset:7168
    buffer_load_dwordx4 v[172:175], v14, s[36:39], s88 offen offset:3072 sc1
    s_add_u32 s82, s82, 4096
    s_and_b32 s82, s82, 0xffff
    s_add_u32 s88, s82, s83
    s_waitcnt lgkmcnt(6)
    v_mfma_f32_32x32x16_bf16 v[240:255], v[140:143], v[180:183], v[240:255]
    ds_read_b64_tr_b16 v[156:157], v5 offset:6144
    ds_read_b64_tr_b16 v[158:159], v5 offset:7168
    v_add_u32 v4, 0x2000, v4
    v_and_b32 v4, 0x1ffff, v4
    v_xor_b32 v5, 64, v4
    s_waitcnt vmcnt(12) lgkmcnt(6)
    v_mfma_f32_32x32x16_bf16 v[224:239], v[144:147], v[184:187], v[224:239]
    ds_read_b64_tr_b16 v[128:129], v4 offset:0
    ds_read_b64_tr_b16 v[130:131], v4 offset:1024
    buffer_load_dwordx4 v[176:179], v14, s[36:39], s88 offen offset:0 sc1
    s_waitcnt lgkmcnt(6)
    v_mfma_f32_32x32x16_bf16 v[240:255], v[148:151], v[184:187], v[240:255]
    ds_read_b64_tr_b16 v[132:133], v5 offset:0
    ds_read_b64_tr_b16 v[134:135], v5 offset:1024
    s_waitcnt lgkmcnt(6)
    v_mfma_f32_32x32x16_bf16 v[224:239], v[152:155], v[188:191], v[224:239]
    ds_read_b64_tr_b16 v[136:137], v4 offset:2048
    ds_read_b64_tr_b16 v[138:139], v4 offset:3072
    buffer_load_dwordx4 v[180:183], v14, s[36:39], s88 offen offset:1024 sc1
    s_waitcnt lgkmcnt(6)
    v_mfma_f32_32x32x16_bf16 v[240:255], v[156:159], v[188:191], v[240:255]
    ds_read_b64_tr_b16 v[140:141], v5 offset:2048
    ds_read_b64_tr_b16 v[142:143], v5 offset:3072
    s_waitcnt vmcnt(12) lgkmcnt(6)
    v_mfma_f32_32x32x16_bf16 v[224:239], v[128:131], v[192:195], v[224:239]
    ds_read_b64_tr_b16 v[144:145], v4 offset:4096
    ds_read_b64_tr_b16 v[146:147], v4 offset:5120
    buffer_load_dwordx4 v[184:187], v14, s[36:39], s88 offen offset:2048 sc1
    s_waitcnt lgkmcnt(6)
    v_mfma_f32_32x32x16_bf16 v[240:255], v[132:135], v[192:195], v[240:255]
    ds_read_b64_tr_b16 v[148:149], v5 offset:4096
    ds_read_b64_tr_b16 v[150:151], v5 offset:5120
    s_waitcnt lgkmcnt(6)
    v_mfma_f32_32x32x16_bf16 v[224:239], v[136:139], v[196:199], v[224:239]
    ds_read_b64_tr_b16 v[152:153], v4 offset:6144
    ds_read_b64_tr_b16 v[154:155], v4 offset:7168
    buffer_load_dwordx4 v[188:191], v14, s[36:39], s88 offen offset:3072 sc1
    s_add_u32 s82, s82, 4096
    s_and_b32 s82, s82, 0xffff
    s_add_u32 s88, s82, s83
    s_waitcnt lgkmcnt(6)
    v_mfma_f32_32x32x16_bf16 v[240:255], v[140:143], v[196:199], v[240:255]
    ds_read_b64_tr_b16 v[156:157], v5 offset:6144
    ds_read_b64_tr_b16 v[158:159], v5 offset:7168
    v_add_u32 v4, 0x2000, v4
    v_and_b32 v4, 0x1ffff, v4
    v_xor_b32 v5, 64, v4
    s_waitcnt vmcnt(12) lgkmcnt(6)
    v_mfma_f32_32x32x16_bf16 v[224:239], v[144:147], v[200:203], v[224:239]
    ds_read_b64_tr_b16 v[128:129], v4 offset:0
    ds_read_b64_tr_b16 v[130:131], v4 offset:1024
    buffer_load_dwordx4 v[192:195], v14, s[36:39], s88 offen offset:0 sc1
    s_waitcnt lgkmcnt(6)
    v_mfma_f32_32x32x16_bf16 v[240:255], v[148:151], v[200:203], v[240:255]
    ds_read_b64_tr_b16 v[132:133], v5 offset:0
    ds_read_b64_tr_b16 v[134:135], v5 offset:1024
    s_waitcnt lgkmcnt(6)
    v_mfma_f32_32x32x16_bf16 v[224:239], v[152:155], v[204:207], v[224:239]
    ds_read_b64_tr_b16 v[136:137], v4 offset:2048
    ds_read_b64_tr_b16 v[138:139], v4 offset:3072
    buffer_load_dwordx4 v[196:199], v14, s[36:39], s88 offen offset:1024 sc1
    s_waitcnt lgkmcnt(6)
    v_mfma_f32_32x32x16_bf16 v[240:255], v[156:159], v[204:207], v[240:255]
    ds_read_b64_tr_b16 v[140:141], v5 offset:2048
    ds_read_b64_tr_b16 v[142:143], v5 offset:3072
    s_waitcnt vmcnt(12) lgkmcnt(6)
    v_mfma_f32_32x32x16_bf16 v[224:239], v[128:131], v[208:211], v[224:239]
    ds_read_b64_tr_b16 v[144:145], v4 offset:4096
    ds_read_b64_tr_b16 v[146:147], v4 offset:5120
    buffer_load_dwordx4 v[200:203], v14, s[36:39], s88 offen offset:2048 sc1
    s_waitcnt lgkmcnt(6)
    v_mfma_f32_32x32x16_bf16 v[240:255], v[132:135], v[208:211], v[240:255]
    ds_read_b64_tr_b16 v[148:149], v5 offset:4096
    ds_read_b64_tr_b16 v[150:151], v5 offset:5120
    s_waitcnt lgkmcnt(6)
    v_mfma_f32_32x32x16_bf16 v[224:239], v[136:139], v[212:215], v[224:239]
    ds_read_b64_tr_b16 v[152:153], v4 offset:6144
    ds_read_b64_tr_b16 v[154:155], v4 offset:7168
    buffer_load_dwordx4 v[204:207], v14, s[36:39], s88 offen offset:3072 sc1
    s_add_u32 s82, s82, 4096
    s_and_b32 s82, s82, 0xffff
    s_add_u32 s88, s82, s83
    s_waitcnt lgkmcnt(6)
    v_mfma_f32_32x32x16_bf16 v[240:255], v[140:143], v[212:215], v[240:255]
    ds_read_b64_tr_b16 v[156:157], v5 offset:6144
    ds_read_b64_tr_b16 v[158:159], v5 offset:7168
    v_add_u32 v4, 0x2000, v4
    v_and_b32 v4, 0x1ffff, v4
    v_xor_b32 v5, 64, v4
    s_waitcnt vmcnt(12) lgkmcnt(6)
    v_mfma_f32_32x32x16_bf16 v[224:239], v[144:147], v[216:219], v[224:239]
    ds_read_b64_tr_b16 v[128:129], v4 offset:0
    ds_read_b64_tr_b16 v[130:131], v4 offset:1024
    buffer_load_dwordx4 v[208:211], v14, s[36:39], s88 offen offset:0 sc1
    s_waitcnt lgkmcnt(6)
    v_mfma_f32_32x32x16_bf16 v[240:255], v[148:151], v[216:219], v[240:255]
    ds_read_b64_tr_b16 v[132:133], v5 offset:0
    ds_read_b64_tr_b16 v[134:135], v5 offset:1024
    s_waitcnt lgkmcnt(6)
    v_mfma_f32_32x32x16_bf16 v[224:239], v[152:155], v[220:223], v[224:239]
    ds_read_b64_tr_b16 v[136:137], v4 offset:2048
    ds_read_b64_tr_b16 v[138:139], v4 offset:3072
    buffer_load_dwordx4 v[212:215], v14, s[36:39], s88 offen offset:1024 sc1
    s_waitcnt lgkmcnt(6)
    v_mfma_f32_32x32x16_bf16 v[240:255], v[156:159], v[220:223], v[240:255]
    ds_read_b64_tr_b16 v[140:141], v5 offset:2048
    ds_read_b64_tr_b16 v[142:143], v5 offset:3072
    s_cmp_lt_u32 s84, 3
    s_cbranch_scc1 L_G2
    s_waitcnt vmcnt(12) lgkmcnt(6)
    v_mfma_f32_32x32x16_bf16 v[224:239], v[128:131], v[160:163], v[224:239]
    ds_read_b64_tr_b16 v[144:145], v4 offset:4096
    ds_read_b64_tr_b16 v[146:147], v4 offset:5120
    buffer_load_dwordx4 v[216:219], v14, s[36:39], s88 offen offset:2048 sc1
    s_waitcnt lgkmcnt(6)
    v_mfma_f32_32x32x16_bf16 v[240:255], v[132:135], v[160:163], v[240:255]
    ds_read_b64_tr_b16 v[148:149], v5 offset:4096
    ds_read_b64_tr_b16 v[150:151], v5 offset:5120
    s_waitcnt lgkmcnt(6)
    v_mfma_f32_32x32x16_bf16 v[224:239], v[136:139], v[164:167], v[224:239]
    ds_read_b64_tr_b16 v[152:153], v4 offset:6144
    ds_read_b64_tr_b16 v[154:155], v4 offset:7168
    buffer_load_dwordx4 v[220:223], v14, s[36:39], s88 offen offset:3072 sc1
    s_add_u32 s82, s82, 4096
    s_and_b32 s82, s82, 0xffff
    s_add_u32 s88, s82, s83
    s_waitcnt lgkmcnt(6)
    v_mfma_f32_32x32x16_bf16 v[240:255], v[140:143], v[164:167], v[240:255]
    ds_read_b64_tr_b16 v[156:157], v5 offset:6144
    ds_read_b64_tr_b16 v[158:159], v5 offset:7168
    s_barrier
    v_add_u32 v4, 0x2000, v4
    v_and_b32 v4, 0x1ffff, v4
    v_xor_b32_e64 v5, 64, v4
    s_waitcnt vmcnt(12) lgkmcnt(6)
    v_mfma_f32_32x32x16_bf16 v[224:239], v[144:147], v[168:171], v[224:239]
    ds_read_b64_tr_b16 v[128:129], v4 offset:0
    ds_read_b64_tr_b16 v[130:131], v4 offset:1024
    s_waitcnt lgkmcnt(6)
    v_mfma_f32_32x32x16_bf16 v[240:255], v[148:151], v[168:171], v[240:255]
    ds_read_b64_tr_b16 v[132:133], v5 offset:0
    ds_read_b64_tr_b16 v[134:135], v5 offset:1024
    s_waitcnt lgkmcnt(6)
    v_mfma_f32_32x32x16_bf16 v[224:239], v[152:155], v[172:175], v[224:239]
    ds_read_b64_tr_b16 v[136:137], v4 offset:2048
    ds_read_b64_tr_b16 v[138:139], v4 offset:3072
    s_waitcnt lgkmcnt(6)
    v_mfma_f32_32x32x16_bf16 v[240:255], v[156:159], v[172:175], v[240:255]
    ds_read_b64_tr_b16 v[140:141], v5 offset:2048
    ds_read_b64_tr_b16 v[142:143], v5 offset:3072
    s_waitcnt vmcnt(10) lgkmcnt(6)
    v_mfma_f32_32x32x16_bf16 v[224:239], v[128:131], v[176:179], v[224:239]
    ds_read_b64_tr_b16 v[144:145], v4 offset:4096
    ds_read_b64_tr_b16 v[146:147], v4 offset:5120
    s_waitcnt lgkmcnt(6)
    v_mfma_f32_32x32x16_bf16 v[240:255], v[132:135], v[176:179], v[240:255]
    ds_read_b64_tr_b16 v[148:149], v5 offset:4096
    ds_read_b64_tr_b16 v[150:151], v5 offset:5120
    s_waitcnt lgkmcnt(6)
    v_mfma_f32_32x32x16_bf16 v[224:239], v[136:139], v[180:183], v[224:239]
    ds_read_b64_tr_b16 v[152:153], v4 offset:6144
    ds_read_b64_tr_b16 v[154:155], v4 offset:7168
    s_waitcnt lgkmcnt(6)
    v_mfma_f32_32x32x16_bf16 v[240:255], v[140:143], v[180:183], v[240:255]
    ds_read_b64_tr_b16 v[156:157], v5 offset:6144
    ds_read_b64_tr_b16 v[158:159], v5 offset:7168
    v_add_u32 v4, 0x2000, v4
    v_and_b32 v4, 0x1ffff, v4
    v_xor_b32_e64 v5, 64, v4
    s_waitcnt vmcnt(8) lgkmcnt(6)
    v_mfma_f32_32x32x16_bf16 v[224:239], v[144:147], v[184:187], v[224:239]
    ds_read_b64_tr_b16 v[128:129], v4 offset:0
    ds_read_b64_tr_b16 v[130:131], v4 offset:1024
    s_waitcnt lgkmcnt(6)
    v_mfma_f32_32x32x16_bf16 v[240:255], v[148:151], v[184:187], v[240:255]
    ds_read_b64_tr_b16 v[132:133], v5 offset:0
    ds_read_b64_tr_b16 v[134:135], v5 offset:1024
    s_waitcnt lgkmcnt(6)
    v_mfma_f32_32x32x16_bf16 v[224:239], v[152:155], v[188:191], v[224:239]
    ds_read_b64_tr_b16 v[136:137], v4 offset:2048
    ds_read_b64_tr_b16 v[138:139], v4 offset:3072
    s_waitcnt lgkmcnt(6)
    v_mfma_f32_32x32x16_bf16 v[240:255], v[156:159], v[188:191], v[240:255]
    ds_read_b64_tr_b16 v[140:141], v5 offset:2048
    ds_read_b64_tr_b16 v[142:143], v5 offset:3072
    s_waitcnt vmcnt(6) lgkmcnt(6)
    v_mfma_f32_32x32x16_bf16 v[224:239], v[128:131], v[192:195], v[224:239]
    ds_read_b64_tr_b16 v[144:145], v4 offset:4096
    ds_read_b64_tr_b16 v[146:147], v4 offset:5120
    s_waitcnt lgkmcnt(6)
    v_mfma_f32_32x32x16_bf16 v[240:255], v[132:135], v[192:195], v[240:255]
    ds_read_b64_tr_b16 v[148:149], v5 offset:4096
    ds_read_b64_tr_b16 v[150:151], v5 offset:5120
    s_waitcnt lgkmcnt(6)
    v_mfma_f32_32x32x16_bf16 v[224:239], v[136:139], v[196:199], v[224:239]
    ds_read_b64_tr_b16 v[152:153], v4 offset:6144
    ds_read_b64_tr_b16 v[154:155], v4 offset:7168
    s_waitcnt lgkmcnt(6)
    v_mfma_f32_32x32x16_bf16 v[240:255], v[140:143], v[196:199], v[240:255]
    ds_read_b64_tr_b16 v[156:157], v5 offset:6144
    ds_read_b64_tr_b16 v[158:159], v5 offset:7168
    v_add_u32 v4, 0x2000, v4
    v_and_b32 v4, 0x1ffff, v4
    v_xor_b32_e64 v5, 64, v4
    s_waitcnt vmcnt(4) lgkmcnt(6)
    v_mfma_f32_32x32x16_bf16 v[224:239], v[144:147], v[200:203], v[224:239]
    ds_read_b64_tr_b16 v[128:129], v4 offset:0
    ds_read_b64_tr_b16 v[130:131], v4 offset:1024
    s_waitcnt lgkmcnt(6)
    v_mfma_f32_32x32x16_bf16 v[240:255], v[148:151], v[200:203], v[240:255]
    ds_read_b64_tr_b16 v[132:133], v5 offset:0
    ds_read_b64_tr_b16 v[134:135], v5 offset:1024
    s_waitcnt lgkmcnt(6)
    v_mfma_f32_32x32x16_bf16 v[224:239], v[152:155], v[204:207], v[224:239]
    ds_read_b64_tr_b16 v[136:137], v4 offset:2048
    ds_read_b64_tr_b16 v[138:139], v4 offset:3072
    s_waitcnt lgkmcnt(6)
    v_mfma_f32_32x32x16_bf16 v[240:255], v[156:159], v[204:207], v[240:255]
    ds_read_b64_tr_b16 v[140:141], v5 offset:2048
    ds_read_b64_tr_b16 v[142:143], v5 offset:3072
    s_waitcnt vmcnt(2) lgkmcnt(6)
    v_mfma_f32_32x32x16_bf16 v[224:239], v[128:131], v[208:211], v[224:239]
    ds_read_b64_tr_b16 v[144:145], v4 offset:4096
    ds_read_b64_tr_b16 v[146:147], v4 offset:5120
    s_waitcnt lgkmcnt(6)
    v_mfma_f32_32x32x16_bf16 v[240:255], v[132:135], v[208:211], v[240:255]
    ds_read_b64_tr_b16 v[148:149], v5 offset:4096
    ds_read_b64_tr_b16 v[150:151], v5 offset:5120
    s_waitcnt lgkmcnt(6)
    v_mfma_f32_32x32x16_bf16 v[224:239], v[136:139], v[212:215], v[224:239]
    ds_read_b64_tr_b16 v[152:153], v4 offset:6144
    ds_read_b64_tr_b16 v[154:155], v4 offset:7168
    s_waitcnt lgkmcnt(6)
    v_mfma_f32_32x32x16_bf16 v[240:255], v[140:143], v[212:215], v[240:255]
    ds_read_b64_tr_b16 v[156:157], v5 offset:6144
    ds_read_b64_tr_b16 v[158:159], v5 offset:7168
    s_waitcnt vmcnt(0) lgkmcnt(6)
    v_mfma_f32_32x32x16_bf16 v[224:239], v[144:147], v[216:219], v[224:239]
    s_waitcnt lgkmcnt(4)
    v_mfma_f32_32x32x16_bf16 v[240:255], v[148:151], v[216:219], v[240:255]
    s_waitcnt lgkmcnt(2)
    v_mfma_f32_32x32x16_bf16 v[224:239], v[152:155], v[220:223], v[224:239]
    s_waitcnt lgkmcnt(0)
    v_mfma_f32_32x32x16_bf16 v[240:255], v[156:159], v[220:223], v[240:255]
    s_nop 9
    v_pk_mul_f32 v[18:19], v[224:225], v[224:225]
    v_pk_mul_f32 v[20:21], v[224:225], v[60:61]
    v_pk_add_f32 v[16:17], v[224:225], v[226:227]
    v_pk_fma_f32 v[18:19], v[226:227], v[226:227], v[18:19]
    v_pk_fma_f32 v[20:21], v[226:227], v[62:63], v[20:21]
    v_pk_add_f32 v[16:17], v[16:17], v[228:229]
    v_pk_fma_f32 v[18:19], v[228:229], v[228:229], v[18:19]
    v_pk_fma_f32 v[20:21], v[228:229], v[64:65], v[20:21]
    v_pk_add_f32 v[16:17], v[16:17], v[230:231]
    v_pk_fma_f32 v[18:19], v[230:231], v[230:231], v[18:19]
    v_pk_fma_f32 v[20:21], v[230:231], v[66:67], v[20:21]
    v_pk_add_f32 v[16:17], v[16:17], v[232:233]
L_pad11:
    s_cbranch_execz L_padret
    s_nop 0
    v_pk_fma_f32 v[18:19], v[232:233], v[232:233], v[18:19]
    v_pk_fma_f32 v[20:21], v[232:233], v[68:69], v[20:21]
    v_pk_add_f32 v[16:17], v[16:17], v[234:235]
    v_pk_fma_f32 v[18:19], v[234:235], v[234:235], v[18:19]
    v_pk_fma_f32 v[20:21], v[234:235], v[70:71], v[20:21]
    v_pk_add_f32 v[16:17], v[16:17], v[236:237]
    v_pk_fma_f32 v[18:19], v[236:237], v[236:237], v[18:19]
    v_pk_fma_f32 v[20:21], v[236:237], v[72:73], v[20:21]
    v_pk_add_f32 v[16:17], v[16:17], v[238:239]
    v_pk_fma_f32 v[18:19], v[238:239], v[238:239], v[18:19]
    v_pk_fma_f32 v[20:21], v[238:239], v[74:75], v[20:21]
    v_pk_add_f32 v[16:17], v[16:17], v[240:241]
    v_pk_fma_f32 v[18:19], v[240:241], v[240:241], v[18:19]
    v_pk_fma_f32 v[20:21], v[240:241], v[76:77], v[20:21]
    v_pk_add_f32 v[16:17], v[16:17], v[242:243]
    v_pk_fma_f32 v[18:19], v[242:243], v[242:243], v[18:19]
    v_pk_fma_f32 v[20:21], v[242:243], v[78:79], v[20:21]
    v_pk_add_f32 v[16:17], v[16:17], v[244:245]
    v_pk_fma_f32 v[18:19], v[244:245], v[244:245], v[18:19]
    v_pk_fma_f32 v[20:21], v[244:245], v[80:81], v[20:21]
    v_pk_add_f32 v[16:17], v[16:17], v[246:247]
    v_pk_fma_f32 v[18:19], v[246:247], v[246:247], v[18:19]
    v_pk_fma_f32 v[20:21], v[246:247], v[82:83], v[20:21]
    v_pk_add_f32 v[16:17], v[16:17], v[248:249]
    v_pk_fma_f32 v[18:19], v[248:249], v[248:249], v[18:19]
    v_pk_fma_f32 v[20:21], v[248:249], v[84:85], v[20:21]
    v_pk_add_f32 v[16:17], v[16:17], v[250:251]
    v_pk_fma_f32 v[18:19], v[250:251], v[250:251], v[18:19]
    v_pk_fma_f32 v[20:21], v[250:251], v[86:87], v[20:21]
    v_pk_add_f32 v[16:17], v[16:17], v[252:253]
    v_pk_fma_f32 v[18:19], v[252:253], v[252:253], v[18:19]
    v_pk_fma_f32 v[20:21], v[252:253], v[88:89], v[20:21]
    v_pk_add_f32 v[16:17], v[16:17], v[254:255]
    v_pk_fma_f32 v[18:19], v[254:255], v[254:255], v[18:19]
    v_pk_fma_f32 v[20:21], v[254:255], v[90:91], v[20:21]
    v_mov_b32 v27, s75
    v_add_f32 v24, v16, v17
    v_add_f32 v25, v18, v19
    v_add_f32 v26, v20, v21
    v_mov_b32 v28, v24
    v_mov_b32 v29, v25
    v_mov_b32 v30, v26
    v_permlane32_swap_b32 v24, v28
    v_permlane32_swap_b32 v25, v29
    v_permlane32_swap_b32 v26, v30
    v_pk_add_f32 v[24:25], v[24:25], v[28:29]
    v_add_f32 v26, v26, v30
    s_mov_b32 exec_hi, 0
    s_bitcmp1_b32 s99, 0
    s_cbranch_scc0 Lls_47
    buffer_store_dwordx4 v[24:27], v14, s[36:39], s95 offen
Lle_48:
    s_mov_b32 exec_hi, -1
    s_add_u32 s79, s94, 16384
    s_add_u32 s80, s94, 32768
    s_add_u32 s81, s94, 49152
    s_barrier
    v_xor_b32_e64 v112, 0, v13
    ds_write_b128 v112, v[224:227]
    v_xor_b32_e64 v113, 32, v13
    ds_write_b128 v113, v[228:231]
    v_xor_b32_e64 v114, 64, v13
    ds_write_b128 v114, v[232:235]
    buffer_load_dwordx4 v[64:67], v12, s[36:39], s94 offen offset:0 sc1
    buffer_load_dwordx4 v[68:71], v7, s[36:39], s94 offen offset:0 sc1
    buffer_load_dwordx4 v[72:75], v12, s[36:39], s79 offen offset:0 sc1
    buffer_load_dwordx4 v[76:79], v7, s[36:39], s79 offen offset:0 sc1
    buffer_load_dwordx4 v[80:83], v12, s[36:39], s80 offen offset:0 sc1
    buffer_load_dwordx4 v[84:87], v7, s[36:39], s80 offen offset:0 sc1
    buffer_load_dwordx4 v[88:91], v12, s[36:39], s81 offen offset:0 sc1
    buffer_load_dwordx4 v[92:95], v7, s[36:39], s81 offen offset:0 sc1
    v_xor_b32 v115, 96, v13
    ds_write_b128 v115, v[236:239]
    v_xor_b32 v116, 128, v13
    ds_write_b128 v116, v[240:243]
    v_xor_b32 v117, 160, v13
    ds_write_b128 v117, v[244:247]
    v_xor_b32 v118, 192, v13
    ds_write_b128 v118, v[248:251]
    v_xor_b32 v119, 224, v13
    ds_write_b128 v119, v[252:255]
    s_mov_b32 s85, 1
L_gchk:
    s_waitcnt vmcnt(0)
    v_max3_u32 v16, v67, v71, v75
    v_max3_u32 v16, v16, v79, v83
    v_max3_u32 v16, v16, v87, v91
    v_max3_u32 v16, v16, v95, s75
    v_min3_u32 v17, v67, v71, v75
    v_min3_u32 v17, v17, v79, v83
    v_min3_u32 v17, v17, v87, v91
    v_min3_u32 v17, v17, v95, s75
    v_cmp_ne_u32_e64 vcc, v16, v17
    s_cbranch_vccnz Lspin_49
    s_barrier
    v_pk_add_f32 v[64:65], v[64:65], v[68:69]
    v_add_f32_e64 v66, v66, v70
    v_pk_add_f32 v[72:73], v[72:73], v[76:77]
    v_add_f32_e64 v74, v74, v78
    v_pk_add_f32 v[80:81], v[80:81], v[84:85]
    v_add_f32_e64 v82, v82, v86
    v_pk_add_f32 v[88:89], v[88:89], v[92:93]
    v_add_f32_e64 v90, v90, v94
    v_pk_add_f32 v[64:65], v[64:65], v[72:73]
    v_add_f32_e64 v66, v66, v74
    v_pk_add_f32 v[80:81], v[80:81], v[88:89]
    v_add_f32 v82, v82, v90
    v_add_f32 v24, v64, v80
    v_add_f32 v25, v65, v81
    v_add_f32 v26, v66, v82
    v_mov_b32 v28, v24
    v_mov_b32 v29, v25
    v_mov_b32 v30, v26
    v_permlane32_swap_b32 v24, v28
    v_permlane32_swap_b32 v25, v29
    v_permlane32_swap_b32 v26, v30
    v_pk_add_f32 v[24:25], v[24:25], v[28:29]
    v_add_f32_e64 v26, v26, v30
    v_mul_f32 v36, 0x3a800000, v24
    v_mul_f32 v40, 0x3a800000, v25
    v_fma_f32 v40, -v36, v36, v40
    v_max_f32_e64 v40, 0, v40
    v_cvt_pk_bf16_f32 v36, v36, v36
    v_and_b32 v36, 0xffff0000, v36
    v_cvt_pk_bf16_f32 v40, v40, v40
    v_and_b32 v40, 0xffff0000, v40
    v_add_f32 v40, 0x3727c5ac, v40
    v_cvt_pk_bf16_f32 v40, v40, v40
    v_and_b32 v40, 0xffff0000, v40
    v_sqrt_f32 v40, v40
    s_nop 0
    v_cvt_pk_bf16_f32 v40, v40, v40
    v_and_b32 v40, 0xffff0000, v40
    v_rcp_f32_e64 v38, v40
    v_fma_f32 v42, -v36, v126, v26
    s_mov_b32 s79, 0xfffff800
    v_mul_f32_e64 v42, v42, v38
    v_mul_f32 v39, -v36, v38
    v_and_or_b32 v42, v42, s79, v11
    s_mov_b32 exec_hi, 0
    ds_write_b64 v10, v[38:39]
    ds_max_f32 v44, v42
    s_mov_b32 exec_lo, 1
    ds_add_rtn_u32 v46, v44, v45 offset:4
    s_mov_b32 exec_lo, -1
    ds_read_b32 v20, v44
    v_lshlrev_b32 v17, 3, v2
    v_lshlrev_b32 v18, 2, v2
    v_mov_b32_e64 v21, s75
    s_mov_b32 s79, s96
    s_waitcnt lgkmcnt(0)
    v_readfirstlane_b32 s78, v46
    s_cmp_lg_u32 s78, 3
    s_cbranch_scc1 L_nocand
    s_mov_b32 exec_lo, 0xffff
    buffer_store_dwordx2 v[20:21], v17, s[36:39], s79 offen offset:128 sc1
    s_mov_b32 exec_lo, -1
    v_and_b32 v22, 127, v20
    v_and_b32 v23, 7, v20
    v_lshlrev_b32 v23, 4, v23
    v_xor_b32 v23, v23, v17
    v_lshl_add_u32 v23, v22, 8, v23
    v_lshlrev_b32_e64 v22, 3, v22
    ds_read_b64 v[24:25], v23
    v_add_u32 v22, 159744, v22
    ds_read_b64 v[26:27], v22
    s_waitcnt lgkmcnt(0)
    v_fma_f32 v28, v24, v26, v27
    v_fma_f32 v29, v25, v26, v27
    v_cvt_pk_bf16_f32 v30, v28, v29
    buffer_store_dword v30, v18, s[36:39], s79 offen sc1
    v_add_f32 v28, v28, v24
    v_add_f32_e64 v29, v29, v25
    buffer_store_dwordx2 v[28:29], v17, s[36:39], s79 offen offset:256 sc1
L_nocand:
    s_mov_b32 exec_hi, -1
    v_lshrrev_b32 v16, 3, v2
    v_and_b32 v17, 7, v2
    s_lshl_b32 s78, s76, 5
    v_add_u32 v18, s78, v16
    v_lshlrev_b32 v19, 1, v17
    v_xor_b32 v19, v19, v16
    v_lshlrev_b32 v19, 4, v19
    v_lshl_add_u32 v19, v18, 8, v19
    v_xor_b32 v32, 16, v19
    v_lshlrev_b32 v33, 3, v18
    v_add_u32 v33, 159744, v33
    ds_read_b128 v[64:67], v19 offset:0
    ds_read_b128 v[68:71], v32 offset:0
    ds_read_b64 v[96:97], v33 offset:0
    ds_read_b128 v[72:75], v19 offset:2048
    ds_read_b128 v[76:79], v32 offset:2048
    ds_read_b64 v[98:99], v33 offset:64
    ds_read_b128 v[80:83], v19 offset:4096
    ds_read_b128 v[84:87], v32 offset:4096
    ds_read_b64 v[100:101], v33 offset:128
    ds_read_b128 v[88:91], v19 offset:6144
    ds_read_b128 v[92:95], v32 offset:6144
    ds_read_b64 v[102:103], v33 offset:192
    s_lshl_b32 s78, s71, 7
    v_add_u32_e64 v18, s78, v18
    s_lshl_b32 s79, s72, 7
    v_lshl_add_u32 v19, v18, 11, s79
    v_lshl_add_u32 v19, v17, 4, v19
    v_mov_b32 v16, 163360
    s_waitcnt lgkmcnt(0)
    v_add_f32 v96, 1.0, v96
    v_pk_fma_f32 v[64:65], v[64:65], v[96:97], v[96:97] op_sel:[0,0,1] op_sel_hi:[1,0,1]
    v_pk_fma_f32 v[66:67], v[66:67], v[96:97], v[96:97] op_sel:[0,0,1] op_sel_hi:[1,0,1]
    v_pk_fma_f32 v[68:69], v[68:69], v[96:97], v[96:97] op_sel:[0,0,1] op_sel_hi:[1,0,1]
    v_pk_fma_f32 v[70:71], v[70:71], v[96:97], v[96:97] op_sel:[0,0,1] op_sel_hi:[1,0,1]
    v_cvt_pk_bf16_f32 v104, v64, v65
    v_cvt_pk_bf16_f32 v105, v66, v67
    v_cvt_pk_bf16_f32 v106, v68, v69
    v_cvt_pk_bf16_f32 v107, v70, v71
    v_add_f32_e64 v98, 1.0, v98
    v_pk_fma_f32 v[72:73], v[72:73], v[98:99], v[98:99] op_sel:[0,0,1] op_sel_hi:[1,0,1]
    v_pk_fma_f32 v[74:75], v[74:75], v[98:99], v[98:99] op_sel:[0,0,1] op_sel_hi:[1,0,1]
    v_pk_fma_f32 v[76:77], v[76:77], v[98:99], v[98:99] op_sel:[0,0,1] op_sel_hi:[1,0,1]
    v_pk_fma_f32 v[78:79], v[78:79], v[98:99], v[98:99] op_sel:[0,0,1] op_sel_hi:[1,0,1]
    v_cvt_pk_bf16_f32 v108, v72, v73
    v_cvt_pk_bf16_f32 v109, v74, v75
    v_cvt_pk_bf16_f32 v110, v76, v77
    v_cvt_pk_bf16_f32 v111, v78, v79
    v_add_f32_e64 v100, 1.0, v100
    v_pk_fma_f32 v[80:81], v[80:81], v[100:101], v[100:101] op_sel:[0,0,1] op_sel_hi:[1,0,1]
    v_pk_fma_f32 v[82:83], v[82:83], v[100:101], v[100:101] op_sel:[0,0,1] op_sel_hi:[1,0,1]
    v_pk_fma_f32 v[84:85], v[84:85], v[100:101], v[100:101] op_sel:[0,0,1] op_sel_hi:[1,0,1]
    v_pk_fma_f32 v[86:87], v[86:87], v[100:101], v[100:101] op_sel:[0,0,1] op_sel_hi:[1,0,1]
    v_cvt_pk_bf16_f32 v112, v80, v81
    v_cvt_pk_bf16_f32 v113, v82, v83
    v_cvt_pk_bf16_f32 v114, v84, v85
    v_cvt_pk_bf16_f32 v115, v86, v87
    v_add_f32_e64 v102, 1.0, v102
    v_pk_fma_f32 v[88:89], v[88:89], v[102:103], v[102:103] op_sel:[0,0,1] op_sel_hi:[1,0,1]
    v_pk_fma_f32 v[90:91], v[90:91], v[102:103], v[102:103] op_sel:[0,0,1] op_sel_hi:[1,0,1]
    v_pk_fma_f32 v[92:93], v[92:93], v[102:103], v[102:103] op_sel:[0,0,1] op_sel_hi:[1,0,1]
    v_pk_fma_f32 v[94:95], v[94:95], v[102:103], v[102:103] op_sel:[0,0,1] op_sel_hi:[1,0,1]
    v_cvt_pk_bf16_f32 v116, v88, v89
    v_cvt_pk_bf16_f32 v117, v90, v91
    v_cvt_pk_bf16_f32 v118, v92, v93
    v_cvt_pk_bf16_f32 v119, v94, v95
    s_barrier
    ds_read_b32 v17, v16
    s_waitcnt lgkmcnt(0)
    v_and_b32 v17, 0x7ff, v17
    v_sub_u32 v17, v17, v18
    s_barrier
    s_mov_b32 s78, 0
    v_cmp_ne_u32 vcc, 0, v17
    s_mov_b64 exec, vcc
    s_cbranch_execz Lo_50
    buffer_store_dwordx4 v[104:107], v19, s[44:47], s78 offen sc1
Lo_50:
    s_mov_b64 exec, -1
    s_mov_b32 s78, 16384
    v_cmp_ne_u32 vcc, 8, v17
    s_mov_b64 exec, vcc
    s_cbranch_execz Lo_51
    buffer_store_dwordx4 v[108:111], v19, s[44:47], s78 offen sc1
Lo_51:
    s_mov_b64 exec, -1
    s_barrier
    s_mov_b32 s78, 32768
    v_cmp_ne_u32_e64 vcc, 16, v17
    s_mov_b64 exec, vcc
    s_cbranch_execz Lo_52
    buffer_store_dwordx4 v[112:115], v19, s[44:47], s78 offen sc1
Lo_52:
    s_mov_b64 exec, -1
    s_mov_b32 s78, 49152
    v_cmp_ne_u32 vcc, 24, v17
    s_mov_b64 exec, vcc
    s_cbranch_execz Lo_53
    buffer_store_dwordx4 v[116:119], v19, s[44:47], s78 offen sc1
Lo_53:
    s_mov_b64 exec, -1
    s_branch L_fin
L_pad12:
    s_cbranch_execz L_padret
    s_endpgm
Lspin_49:
    buffer_load_dwordx4 v[64:67], v12, s[36:39], s94 offen offset:0 sc1
    buffer_load_dwordx4 v[68:71], v7, s[36:39], s94 offen offset:0 sc1
    buffer_load_dwordx4 v[72:75], v12, s[36:39], s79 offen offset:0 sc1
    buffer_load_dwordx4 v[76:79], v7, s[36:39], s79 offen offset:0 sc1
    buffer_load_dwordx4 v[80:83], v12, s[36:39], s80 offen offset:0 sc1
    buffer_load_dwordx4 v[84:87], v7, s[36:39], s80 offen offset:0 sc1
    buffer_load_dwordx4 v[88:91], v12, s[36:39], s81 offen offset:0 sc1
    buffer_load_dwordx4 v[92:95], v7, s[36:39], s81 offen offset:0 sc1
    s_add_u32 s85, s85, 1
    s_cmp_gt_u32 s85, 400000
    s_cbranch_scc1 L_end
    s_branch L_gchk
L_kvspin:
    buffer_load_dwordx4 v[96:99], v11, s[36:39], s94 offen offset:0 sc1
    buffer_load_dwordx4 v[100:103], v11, s[36:39], s94 offen offset:2048 sc1
    buffer_load_dwordx4 v[104:107], v11, s[36:39], s95 offen offset:0 sc1
    buffer_load_dwordx4 v[108:111], v11, s[36:39], s95 offen offset:2048 sc1
    s_add_u32 s85, s85, 1
    s_cmp_gt_u32 s85, 400000
    s_cbranch_scc1 L_end
    s_nop 3
    s_branch L_kvchk
Lls_47:
    buffer_store_dwordx4 v[24:27], v14, s[36:39], s95 offen sc1
    s_nop 1
    s_branch Lle_48
L_fin:
L_end:
    s_endpgm
.fill 64, 4, 0xbf800000
s_endpgm
.section .rodata,"a"
.p2align 6
.amdhsa_kernel sequential_preLN__linear_kernel_hedgehog__moe_arch_mod__prompt_kernel
  .amdhsa_next_free_vgpr 256
  .amdhsa_next_free_sgpr 102
  .amdhsa_accum_offset 256
  .amdhsa_group_segment_fixed_size 0
  .amdhsa_kernarg_size 96
  .amdhsa_user_sgpr_count 2
  .amdhsa_user_sgpr_kernarg_segment_ptr 1
  .amdhsa_system_sgpr_workgroup_id_x 1
  .amdhsa_float_denorm_mode_32 3
.end_amdhsa_kernel
```

```asm
; @launch grid=(256,1,1) block=(512,1,1) lds=163840
.amdgcn_target "amdgcn-amd-amdhsa--gfx950"
.text
.globl sequential_preLN__linear_kernel_hedgehog__moe_arch_mod__prompt_kernel
.p2align 8
.type sequential_preLN__linear_kernel_hedgehog__moe_arch_mod__prompt_kernel,@function
sequential_preLN__linear_kernel_hedgehog__moe_arch_mod__prompt_kernel:
    s_cmp_ge_u32 s2, 256
    s_cbranch_scc1 L_end
    s_load_dwordx16 s[4:19], s[0:1], 0
    s_load_dwordx8 s[20:27], s[0:1], 64
    v_lshrrev_b32 v1, 6, v0
    v_and_b32_e64 v2, 63, v0
    v_readfirstlane_b32 s68, v1
    s_lshr_b32 s69, s2, 4
    s_and_b32 s70, s2, 7
    s_lshl_b32 s70, s70, 1
    s_bfe_u32 s78, s2, 0x10003
    s_or_b32 s70, s70, s78
    s_and_b32 s76, s68, 3
    s_cmp_ge_u32 s68, 4
    s_cbranch_scc1 L_M
    v_lshrrev_b32 v196, 3, v2
    v_and_b32 v197, 7, v2
    v_lshrrev_b32_e64 v198, 4, v2
    s_and_b32 s80, s69, 0
    s_lshl_b32 s89, s76, 11
    s_lshl_b32 s66, s80, 10
    s_or_b32 s66, s66, s89
    s_xor_b32 s67, s66, 1024
    s_lshl_b32 s79, s70, 7
    s_movk_i32 s78, 6144
    v_mov_b32_e64 v199, s79
    v_mad_u32_u24 v199, v196, s78, v199
    s_lshl_b32 s80, s80, 2
    v_and_b32 v200, 2, v196
    v_xor_b32 v200, v200, v197
    v_xor_b32 v200, s80, v200
    v_lshl_add_u32 v199, v200, 4, v199
    s_mul_i32 s78, s66, 48
    s_mul_i32 s79, s67, 48
    v_add_u32 v6, s78, v199
    v_xor_b32 v199, 64, v199
    v_add_u32_e64 v7, s79, v199
    s_and_b32 s80, s70, 0
    s_lshl_b32 s88, s76, 12
    s_lshl_b32 s64, s80, 10
    s_or_b32 s64, s64, s88
    s_xor_b32 s65, s64, 1024
    s_lshl_b32 s80, s80, 2
    s_lshl_b32 s78, s69, 14
    s_add_u32 s78, s78, s64
    s_lshl_b32 s78, s78, 4
    v_lshl_add_u32 v199, v196, 11, s78
    v_xor_b32 v200, v198, v197
    v_xor_b32 v200, s80, v200
    v_lshl_add_u32 v4, v200, 4, v199
    v_xor_b32 v5, 16448, v4
    s_and_b32 s78, s70, 14
    s_and_b32 s79, s69, 14
    s_add_u32 s78, s78, s79
    s_sub_u32 s78, 32, s78
    s_and_b32 s78, s78, 15
    s_lshl_b32 s86, s78, 7
    s_mul_i32 s87, s78, 393216
    s_mov_b32 s30, 0x400000
    s_mov_b32 s31, 0x20000
    s_mov_b32 s34, 0x600000
    s_mov_b32 s35, 0x20000
    s_waitcnt lgkmcnt(0)
    s_mov_b32 s32, s6
    s_and_b32 s33, s7, 0xffff
    s_mov_b32 s28, s4
    s_and_b32 s29, s5, 0xffff
    s_add_u32 m0, s64, 118784
    s_nop 0
    buffer_load_dwordx4 v4, s[28:31], s86 offen offset:0  lds
    s_add_u32 m0, s66, 141312
    s_nop 0
    s_nop 0
    buffer_load_dwordx4 v6, s[32:35], s87 offen offset:2048  lds
    s_add_u32 m0, s64, 120832
    s_add_u32 s101, s86, 32768
    buffer_load_dwordx4 v4, s[28:31], s101 offen offset:0  lds
    s_add_u32 m0, s66, 151552
    s_add_u32 s101, s87, 4096
    buffer_load_dwordx4 v6, s[32:35], s101 offen offset:0  lds
    s_add_u32 m0, s66, 135168
    s_nop 0
    buffer_load_dwordx4 v6, s[32:35], s87 offen offset:0  lds
    s_add_u32 m0, s65, 118784
    s_nop 0
    buffer_load_dwordx4 v5, s[28:31], s86 offen offset:0  lds
    s_add_u32 m0, s67, 141312
    s_nop 0
    s_nop 0
    buffer_load_dwordx4 v7, s[32:35], s87 offen offset:2048  lds
    s_add_u32 m0, s65, 120832
    s_add_u32 s101, s86, 32768
    buffer_load_dwordx4 v5, s[28:31], s101 offen offset:0  lds
    s_add_u32 m0, s67, 151552
    s_add_u32 s101, s87, 4096
    buffer_load_dwordx4 v7, s[32:35], s101 offen offset:0  lds
    s_add_u32 m0, s67, 135168
    s_nop 0
    buffer_load_dwordx4 v7, s[32:35], s87 offen offset:0  lds
    s_add_u32 s86, s86, 128
    s_add_u32 s87, s87, 393216
    s_and_b32 s86, s86, 2047
    s_cselect_b32 s87, s87, 0
    s_mov_b32 s101, 40960
    s_cmp_ge_i32 s64, 0
    s_cselect_b32 s101, 0xfffec000, s101
    s_add_u32 s64, s64, s101
    s_add_u32 s65, s65, s101
    s_add_u32 s66, s66, s101
    s_add_u32 s67, s67, s101
    s_load_dword s75, s[26:27], 0
    s_mov_b32 s60, s8
    s_and_b32 s61, s9, 0xffff
    s_mov_b32 s62, 0x10000
    s_mov_b32 s63, 0x20000
    v_lshlrev_b32 v14, 4, v2
    s_lshl_b32 s78, s70, 12
    s_lshl_b32 s79, s76, 10
    s_add_u32 s78, s78, s79
    s_add_u32 m0, s79, 159744
    s_nop 0
    buffer_load_dwordx4 v14, s[60:63], s78 offen lds
    s_and_b32 s78, s2, 7
    s_lshr_b32 s79, s2, 3
    s_lshl_b32 s71, s78, 1
    s_and_b32 s72, s79, 1
    s_add_u32 s71, s71, s72
    s_lshr_b32 s72, s79, 1
    s_cmp_gt_u32 s70, 3
    s_cselect_b32 s78, 1, 0
    s_cmp_gt_u32 s70, 11
    s_cselect_b32 s78, 2, s78
    s_sub_u32 s78, s70, s78
    s_cmp_eq_u32 s70, 3
    s_cselect_b32 s78, 14, s78
    s_cmp_eq_u32 s70, 11
    s_cselect_b32 s78, 15, s78
    s_lshl_b32 s0, s78, 4
    s_add_u32 s0, s0, s69
    s_lshr_b32 s73, s0, 2
    s_and_b32 s74, s0, 3
    s_lshl_b32 s77, s70, 4
    s_add_u32 s77, s77, s69
    s_getpc_b64 s[12:13]
Lpr_1:
    s_add_u32 s12, s12, L_end-Lpr_1
    s_addc_u32 s13, s13, 0
    s_mov_b32 s36, s26
    s_and_b32 s37, s27, 0xffff
    s_mov_b32 s38, 0x10000000
    s_mov_b32 s39, 0x20000
    s_mov_b32 s40, s10
    s_and_b32 s41, s11, 0xffff
    s_mov_b32 s42, 0x200000
    s_mov_b32 s43, 0x20000
    s_mov_b32 s44, s22
    s_and_b32 s45, s23, 0xffff
    s_mov_b32 s46, 0x400000
    s_mov_b32 s47, 0x20000
    s_mov_b32 s48, s16
    s_and_b32 s49, s17, 0xffff
    s_mov_b32 s50, 0x700000
    s_mov_b32 s51, 0x20000
    s_mov_b32 s52, s18
    s_and_b32 s53, s19, 0xffff
    s_mov_b32 s54, 0x700000
    s_mov_b32 s55, 0x20000
    s_mov_b32 s56, s20
    s_and_b32 s57, s21, 0xffff
    s_mov_b32 s58, 0x700000
    s_mov_b32 s59, 0x20000
    v_mov_b32 v16, -1
    v_mov_b32 v17, -1
    v_mov_b32 v18, -1
    v_mov_b32_e64 v19, -1
    s_lshl_b32 s94, s77, 14
    s_lshl_b32 s78, s76, 12
    s_add_u32 s94, s94, s78
    s_add_u32 s94, s94, 4194304
    s_lshl_b32 s96, s77, 10
    s_add_u32 s96, s96, 8388608
    s_cmp_eq_u32 s76, 3
    s_cselect_b32 s96, s96, 0x10000000
    v_and_b32 v196, 15, v2
    v_lshrrev_b32 v197, 1, v196
    v_lshlrev_b32 v199, 7, v196
    v_add_u32 v199, s88, v199
    v_xor_b32_e64 v200, v198, v197
    v_lshl_add_u32 v60, v200, 4, v199
    v_bfe_u32 v196, v2, 2, 2
    v_and_b32_e64 v197, 3, v2
    v_lshl_add_u32 v199, v198, 3, v196
    v_lshlrev_b32_e64 v199, 7, v199
    v_lshl_add_u32 v199, v197, 3, v199
    v_lshrrev_b32 v196, 1, v196
    v_and_b32 v197, 1, v198
    v_lshl_add_u32 v196, v197, 1, v196
    s_mul_i32 s80, s76, 3
    s_add_u32 s78, s80, 0
    s_and_b32 s79, s78, 3
    s_lshr_b32 s78, s78, 2
    s_lshl_b32 s78, s78, 13
    s_add_u32 s78, s78, 16384
    v_xor_b32 v197, s79, v196
    v_lshl_add_u32 v197, v197, 5, v199
    v_add_u32_e64 v240, s78, v197
    s_add_u32 s78, s80, 1
    s_and_b32 s79, s78, 3
    s_lshr_b32 s78, s78, 2
    s_lshl_b32 s78, s78, 13
    s_add_u32 s78, s78, 16384
    v_xor_b32_e64 v197, s79, v196
    v_lshl_add_u32 v197, v197, 5, v199
    v_add_u32_e64 v241, s78, v197
    s_add_u32 s78, s80, 2
    s_and_b32 s79, s78, 3
    s_lshr_b32 s78, s78, 2
    s_lshl_b32 s78, s78, 13
    s_add_u32 s78, s78, 16384
    v_xor_b32_e64 v197, s79, v196
    v_lshl_add_u32 v197, v197, 5, v199
    v_add_u32 v242, s78, v197
    s_and_b32 s78, s70, 1
    s_lshl_b32 s78, s78, 6
    v_xor_b32 v60, s78, v60
    s_and_b32 s78, s69, 1
    s_lshl_b32 s78, s78, 12
    v_add_u32 v240, s78, v240
    v_add_u32 v241, s78, v241
    v_add_u32_e64 v242, s78, v242
    s_add_u32 m0, s64, 118784
    s_nop 0
    buffer_load_dwordx4 v4, s[28:31], s86 offen offset:0  lds
    v_lshrrev_b32 v196, 3, v2
    v_and_b32 v197, 7, v2
    v_lshlrev_b32 v199, 4, v197
    v_mul_u32_u24 v244, 57344, v196
    s_add_u32 m0, s66, 141312
    s_nop 0
    buffer_load_dwordx4 v6, s[32:35], s87 offen offset:2048  lds
    v_add_u32 v244, v244, v199
    v_lshl_add_u32 v245, v196, 14, v199
    s_lshl_b32 s78, s74, 2
    s_add_u32 s78, s78, s76
    s_add_u32 m0, s64, 120832
    s_add_u32 s101, s86, 32768
    buffer_load_dwordx4 v4, s[28:31], s101 offen offset:0  lds
    s_mul_i32 s79, s78, 458752
    s_add_u32 s80, s73, s76
    s_and_b32 s80, s80, 3
    s_andn2_b32 s100, s73, 3
    s_add_u32 m0, s66, 151552
    s_add_u32 s101, s87, 4096
    buffer_load_dwordx4 v6, s[32:35], s101 offen offset:0  lds
    s_or_b32 s80, s80, s100
    s_lshl_b32 s80, s80, 7
    s_add_u32 s79, s79, s80
    s_cmp_ge_u32 s73, 56
    s_cselect_b32 s79, 0x8000000, s79
    v_add_u32_e64 v244, s79, v244
    s_lshl_b32 s78, s78, 7
    s_add_u32 m0, s66, 135168
    s_nop 0
    buffer_load_dwordx4 v6, s[32:35], s87 offen offset:0  lds
    s_lshl_b32 s80, s73, 17
    s_add_u32 s78, s78, s80
    v_add_u32_e64 v245, s78, v245
    s_lshl_b32 s78, s72, 7
    s_add_u32 m0, s65, 118784
    s_nop 0
    buffer_load_dwordx4 v5, s[28:31], s86 offen offset:0  lds
    v_lshl_add_u32 v196, v196, 11, s78
    v_and_b32 v199, 1, v198
    v_lshlrev_b32 v199, 2, v199
    v_xor_b32 v199, v199, v197
    s_add_u32 m0, s67, 141312
    s_nop 0
    buffer_load_dwordx4 v7, s[32:35], s87 offen offset:2048  lds
    v_lshl_add_u32 v246, v199, 4, v196
    s_lshl_b32 s78, s71, 2
    s_add_u32 s78, s78, s76
    s_lshl_b32 s78, s78, 16
    v_add_u32_e64 v196, s78, v196
    s_add_u32 m0, s65, 120832
    s_add_u32 s101, s86, 32768
    buffer_load_dwordx4 v5, s[28:31], s101 offen offset:0  lds
    v_xor_b32_e64 v199, v198, v197
    v_lshl_add_u32 v247, v199, 4, v196
    v_xor_b32 v248, 64, v247
    s_lshl_b32 s78, s76, 14
    s_add_u32 m0, s67, 151552
    s_add_u32 s101, s87, 4096
    buffer_load_dwordx4 v7, s[32:35], s101 offen offset:0  lds
    v_add_u32 v246, s78, v246
    s_lshl_b32 s84, s76, 10
    s_bfe_u32 s78, s2, 0x40003
    s_lshl_b32 s78, s78, 17
    s_add_u32 m0, s67, 135168
    s_nop 0
    buffer_load_dwordx4 v7, s[32:35], s87 offen offset:0  lds
    s_add_u32 s86, s86, 128
    s_add_u32 s87, s87, 393216
    s_and_b32 s86, s86, 2047
    s_cselect_b32 s87, s87, 0
    s_mov_b32 s101, 40960
    s_cmp_ge_i32 s64, 0
    s_cselect_b32 s101, 0xfffec000, s101
    s_add_u32 s64, s64, s101
    s_add_u32 s65, s65, s101
    s_add_u32 s66, s66, s101
    s_add_u32 s67, s67, s101
    s_and_b32 s79, s72, 8
    s_add_u32 s79, s79, 3
    s_lshl_b32 s79, s79, 7
    s_add_u32 s78, s78, s79
    v_lshl_add_u32 v63, v2, 11, s78
    s_lshl_b32 s100, s69, 2
    s_mov_b32 s92, 0x24362543
    s_mov_b32 s93, 0x26542365
    s_lshr_b64 s[92:93], s[92:93], s100
    s_and_b32 s3, s92, 15
    s_mov_b32 s92, 0x798b7a98
    s_mov_b32 s93, 0x7ba978ba
    s_lshr_b64 s[92:93], s[92:93], s100
    s_and_b32 s97, s92, 15
    s_branch L_sube
    .p2align 6
L_iss:
    s_add_u32 m0, s64, 118784
    s_nop 0
    buffer_load_dwordx4 v4, s[28:31], s86 offen offset:0  lds
    s_add_u32 m0, s66, 141312
    s_nop 0
    buffer_load_dwordx4 v6, s[32:35], s87 offen offset:2048  lds
    s_add_u32 m0, s64, 120832
    s_add_u32 s101, s86, 32768
    buffer_load_dwordx4 v4, s[28:31], s101 offen offset:0  lds
    s_add_u32 m0, s66, 151552
    s_add_u32 s101, s87, 4096
    buffer_load_dwordx4 v6, s[32:35], s101 offen offset:0  lds
    s_add_u32 m0, s66, 135168
    s_nop 0
    buffer_load_dwordx4 v6, s[32:35], s87 offen offset:0  lds
    s_add_u32 m0, s65, 118784
    s_nop 0
    buffer_load_dwordx4 v5, s[28:31], s86 offen offset:0  lds
    s_add_u32 m0, s67, 141312
    s_nop 0
    s_nop 0
    buffer_load_dwordx4 v7, s[32:35], s87 offen offset:2048  lds
    s_add_u32 m0, s65, 120832
    s_add_u32 s101, s86, 32768
    buffer_load_dwordx4 v5, s[28:31], s101 offen offset:0  lds
    s_add_u32 m0, s67, 151552
    s_add_u32 s101, s87, 4096
    buffer_load_dwordx4 v7, s[32:35], s101 offen offset:0  lds
    s_add_u32 m0, s67, 135168
    s_nop 0
    buffer_load_dwordx4 v7, s[32:35], s87 offen offset:0  lds
    s_add_u32 s86, s86, 128
    s_add_u32 s87, s87, 393216
    s_and_b32 s86, s86, 2047
    s_cselect_b32 s87, s87, 0
    s_mov_b32 s101, 40960
    s_cmp_ge_i32 s64, 0
    s_cselect_b32 s101, 0xfffec000, s101
    s_add_u32 s64, s64, s101
    s_add_u32 s65, s65, s101
    s_add_u32 s66, s66, s101
    s_add_u32 s67, s67, s101
    s_setpc_b64 s[90:91]
    .p2align 6
L_cl0:
    s_mov_b32 s100, 0
    buffer_load_dwordx4 v[64:67], v244, s[48:51], s100 offen nt
    s_mov_b32 s100, 0
    buffer_load_dwordx4 v[96:99], v244, s[52:55], s100 offen nt
    s_mov_b32 s100, 7168
    buffer_load_dwordx4 v[68:71], v244, s[48:51], s100 offen nt
    s_mov_b32 s100, 7168
    buffer_load_dwordx4 v[100:103], v244, s[52:55], s100 offen nt
    s_mov_b32 s100, 14336
    buffer_load_dwordx4 v[72:75], v244, s[48:51], s100 offen nt
    s_mov_b32 s100, 14336
    buffer_load_dwordx4 v[104:107], v244, s[52:55], s100 offen nt
    s_setpc_b64 s[90:91]
    .p2align 6
L_cl1:
    s_mov_b32 s100, 21504
    buffer_load_dwordx4 v[76:79], v244, s[48:51], s100 offen nt
    s_mov_b32 s100, 21504
    buffer_load_dwordx4 v[108:111], v244, s[52:55], s100 offen nt
    s_mov_b32 s100, 28672
    buffer_load_dwordx4 v[80:83], v244, s[48:51], s100 offen nt
    s_mov_b32 s100, 28672
    buffer_load_dwordx4 v[112:115], v244, s[52:55], s100 offen nt
    s_mov_b32 s100, 35840
    buffer_load_dwordx4 v[84:87], v244, s[48:51], s100 offen nt
    s_mov_b32 s100, 35840
    buffer_load_dwordx4 v[116:119], v244, s[52:55], s100 offen nt
    s_setpc_b64 s[90:91]
    .p2align 12
L_sube:
    s_waitcnt vmcnt(10)
    s_barrier
    s_call_b64 s[90:91], L_iss
    s_setprio 2
    v_add_u32 v196, 118784, v60
    v_add_u32 v198, 118784, v240
    v_add_u32 v199, 118784, v241
    v_add_u32 v200, 118784, v242
    ds_read_b128 v[20:23], v196 offset:0
    ds_read_b128 v[24:27], v196 offset:2048
    ds_read_b64_tr_b16 v[36:37], v198 offset:0
    ds_read_b64_tr_b16 v[38:39], v198 offset:512
    ds_read_b64_tr_b16 v[44:45], v199 offset:0
    ds_read_b64_tr_b16 v[46:47], v199 offset:512
    ds_read_b64_tr_b16 v[52:53], v200 offset:0
    ds_read_b64_tr_b16 v[54:55], v200 offset:512
    s_setprio 0
    s_waitcnt lgkmcnt(0)
    s_mul_i32 s75, s75, 0x9E3779B1
    s_add_u32 s75, s75, 0x7F4A7C15
    s_waitcnt vmcnt(10)
    s_waitcnt lgkmcnt(0)
    s_barrier
    s_call_b64 s[90:91], L_iss
    s_setprio 2
    s_nop 0
    v_add_u32 v196, 36864, v60
    v_add_u32 v198, 36864, v240
    v_add_u32 v199, 36864, v241
    v_add_u32 v200, 36864, v242
    ds_read_b128 v[28:31], v196 offset:0
    ds_read_b128 v[32:35], v196 offset:2048
    ds_read_b64_tr_b16 v[40:41], v198 offset:0
    ds_read_b64_tr_b16 v[42:43], v198 offset:512
    ds_read_b64_tr_b16 v[48:49], v199 offset:0
    ds_read_b64_tr_b16 v[50:51], v199 offset:512
    ds_read_b64_tr_b16 v[56:57], v200 offset:0
    ds_read_b64_tr_b16 v[58:59], v200 offset:512
    s_setprio 0
    s_getreg_b32 s99, hwreg(HW_REG_XCC_ID, 0, 4)
    v_mov_b32 v10, s75
    v_mov_b32 v11, s99
    v_not_b32 v12, v10
    v_mov_b32 v13, 0
    v_and_b32 v8, 15, v2
    v_lshlrev_b32 v9, 4, v8
    v_add_u32 v9, s69, v9
    s_lshl_b32 s78, s70, 4
    s_xor_b32 s79, s78, 16
    v_mov_b32 v202, s78
    v_mov_b32 v203, s79
    v_cmp_gt_u32 vcc, 32, v2
    s_nop 1
    v_cndmask_b32 v202, v203, v202, vcc
    v_add_u32 v8, v202, v8
    v_cmp_gt_u32 vcc, 16, v2
    s_nop 1
    v_cndmask_b32 v8, v8, v9, vcc
    v_lshlrev_b32_e64 v8, 7, v8
    v_add_u32 v8, 4096, v8
    v_lshlrev_b32 v9, 3, v2
    s_lshl_b32 s82, s77, 7
    s_add_u32 s82, s82, 4096
    s_cmp_gt_u32 s76, 0
    s_cselect_b32 s82, 0x10000000, s82
    s_lshl_b32 s83, s77, 9
    s_add_u32 s83, s83, 8912896
    s_cmp_eq_u32 s76, 2
    s_cselect_b32 s83, s83, 0x10000000
    buffer_store_dwordx2 v[12:13], v9, s[36:39], s83 offen sc1
    s_waitcnt vmcnt(11)
    s_waitcnt lgkmcnt(0)
    s_barrier
    s_call_b64 s[90:91], L_iss
    s_waitcnt vmcnt(11)
    s_cmp_lg_u32 s3, 2
    s_cbranch_scc1 Lcs_2
    s_call_b64 s[90:91], L_cl0
Lcs_2:
    s_barrier
    s_setprio 2
    s_add_u32 m0, s64, 118784
    s_nop 0
    buffer_load_dwordx4 v4, s[28:31], s86 offen offset:0  lds
    v_mov_b32 v200, 0x3f803f80
    v_mov_b32 v201, 0x3f803f80
    v_mov_b32 v202, 0x3f803f80
    v_mov_b32 v203, 0x3f803f80
    s_add_u32 m0, s66, 141312
    s_nop 0
    s_nop 0
    buffer_load_dwordx4 v6, s[32:35], s87 offen offset:2048  lds
    v_mfma_f32_16x16x32_bf16 v[204:207], v[200:203], v[20:23], 0
    v_mfma_f32_16x16x32_bf16 v[212:215], v[20:23], v[20:23], 0
    v_mfma_f32_16x16x32_bf16 v[208:211], v[200:203], v[24:27], 0
    v_mfma_f32_16x16x32_bf16 v[216:219], v[24:27], v[24:27], 0
    s_add_u32 m0, s64, 120832
    s_add_u32 s101, s86, 32768
    buffer_load_dwordx4 v4, s[28:31], s101 offen offset:0  lds
    v_mfma_f32_16x16x32_bf16 v[220:223], v[200:203], v[36:39], 0
    v_mfma_f32_16x16x32_bf16 v[224:227], v[200:203], v[44:47], 0
    v_mfma_f32_16x16x32_bf16 v[228:231], v[200:203], v[52:55], 0
    v_mfma_f32_16x16x32_bf16 v[204:207], v[200:203], v[28:31], v[204:207]
    v_mfma_f32_16x16x32_bf16 v[212:215], v[28:31], v[28:31], v[212:215]
    s_add_u32 m0, s66, 151552
    s_add_u32 s101, s87, 4096
    buffer_load_dwordx4 v6, s[32:35], s101 offen offset:0  lds
    v_mfma_f32_16x16x32_bf16 v[208:211], v[200:203], v[32:35], v[208:211]
    v_mfma_f32_16x16x32_bf16 v[216:219], v[32:35], v[32:35], v[216:219]
    v_mfma_f32_16x16x32_bf16 v[220:223], v[200:203], v[40:43], v[220:223]
    v_mfma_f32_16x16x32_bf16 v[224:227], v[200:203], v[48:51], v[224:227]
    s_add_u32 m0, s66, 135168
    s_nop 0
    buffer_load_dwordx4 v6, s[32:35], s87 offen offset:0  lds
    v_mfma_f32_16x16x32_bf16 v[228:231], v[200:203], v[56:59], v[228:231]
    v_and_b32 v196, 3, v2
    v_cmp_eq_u32 s[90:91], 1, v196
    v_cmp_eq_u32 s[92:93], 2, v196
    v_cmp_eq_u32_e64 vcc, 3, v196
    s_add_u32 m0, s65, 118784
    s_nop 0
    buffer_load_dwordx4 v5, s[28:31], s86 offen offset:0  lds
    v_cndmask_b32 v212, v212, v213, s[90:91]
    v_cndmask_b32 v212, v212, v214, s[92:93]
    v_cndmask_b32 v205, v212, v215, vcc
    v_cndmask_b32 v216, v216, v217, s[90:91]
    s_add_u32 m0, s67, 141312
    s_nop 0
    buffer_load_dwordx4 v7, s[32:35], s87 offen offset:2048  lds
    v_cndmask_b32 v216, v216, v218, s[92:93]
    v_cndmask_b32 v209, v216, v219, vcc
    v_lshrrev_b32_e64 v196, 4, v2
    v_cmp_eq_u32 s[90:91], 1, v196
    v_cmp_eq_u32_e64 vcc, 2, v196
    s_add_u32 m0, s65, 120832
    s_add_u32 s101, s86, 32768
    buffer_load_dwordx4 v5, s[28:31], s101 offen offset:0  lds
    v_cndmask_b32 v220, v220, v224, s[90:91]
    v_cndmask_b32_e64 v220, v220, v228, vcc
    s_mul_i32 s78, s77, 768
    s_mul_i32 s79, s76, 192
    s_add_u32 m0, s67, 151552
    s_add_u32 s101, s87, 4096
    buffer_load_dwordx4 v7, s[32:35], s101 offen offset:0  lds
    s_add_u32 s78, s78, s79
    s_add_u32 s78, s78, 327680
    v_lshlrev_b32 v197, 2, v2
    s_mov_b32 exec_hi, 0xffff
    buffer_store_dword v220, v197, s[36:39], s78 offen sc1
    s_mov_b32 exec_hi, -1
    s_lshl_b32 s78, s69, 4
    s_add_u32 m0, s67, 135168
    s_nop 0
    buffer_load_dwordx4 v7, s[32:35], s87 offen offset:0  lds
    s_add_u32 s86, s86, 128
    s_add_u32 s87, s87, 393216
    s_and_b32 s86, s86, 2047
    s_cselect_b32 s87, s87, 0
    s_mov_b32 s101, 40960
    s_cmp_ge_i32 s64, 0
    s_cselect_b32 s101, 0xfffec000, s101
    s_add_u32 s64, s64, s101
    s_add_u32 s65, s65, s101
    s_add_u32 s66, s66, s101
    s_add_u32 s67, s67, s101
    s_add_u32 s78, s78, s70
    s_lshl_b32 s78, s78, 10
    s_lshl_b32 s79, s76, 8
    s_add_u32 s78, s78, s79
    buffer_store_dwordx4 v[16:19], v14, s[36:39], s96 offen offset:0 sc1
    s_add_u32 s78, s78, 65536
    v_and_b32 v198, 15, v2
    v_lshlrev_b32_e64 v198, 3, v198
    s_mov_b32 exec_lo, 0x00f0000f
    s_mov_b32 exec_hi, 0xf0000f00
    buffer_store_dwordx2 v[204:205], v198, s[36:39], s78 offen offset:0 sc1
    s_mov_b64 exec, -1
    s_mov_b32 exec_lo, 0x00f0000f
    s_mov_b32 exec_hi, 0xf0000f00
    buffer_store_dwordx2 v[208:209], v198, s[36:39], s78 offen offset:128 sc1
    s_mov_b64 exec, -1
    s_setprio 0
    s_waitcnt vmcnt(14)
    s_cmp_lg_u32 s3, 3
    s_cbranch_scc1 Lcs_3
    s_call_b64 s[90:91], L_cl0
Lcs_3:
    s_barrier
    s_call_b64 s[90:91], L_iss
    s_waitcnt vmcnt(10)
    s_cmp_lg_u32 s3, 4
    s_cbranch_scc1 Lcs_4
    s_call_b64 s[90:91], L_cl0
Lcs_4:
    s_barrier
    s_mov_b64 exec, 0xffff
    buffer_store_dwordx2 v[10:11], v9, s[36:39], s82 offen sc1
    s_mov_b64 exec, -1
    s_call_b64 s[90:91], L_iss
    s_waitcnt vmcnt(11)
    s_cmp_lg_u32 s3, 5
    s_cbranch_scc1 Lcs_5
    s_call_b64 s[90:91], L_cl0
Lcs_5:
    s_barrier
    s_call_b64 s[90:91], L_iss
    s_waitcnt vmcnt(10)
    s_cmp_lg_u32 s3, 6
    s_cbranch_scc1 Lcs_6
    s_call_b64 s[90:91], L_cl0
Lcs_6:
    s_barrier
    s_call_b64 s[90:91], L_iss
    s_waitcnt vmcnt(10)
    s_cmp_lg_u32 s97, 7
    s_cbranch_scc1 Lcs_7
    s_call_b64 s[90:91], L_cl1
Lcs_7:
    s_barrier
    s_call_b64 s[90:91], L_iss
    s_waitcnt vmcnt(10)
    s_cmp_lg_u32 s97, 8
    s_cbranch_scc1 Lcs_8
    s_call_b64 s[90:91], L_cl1
Lcs_8:
    s_barrier
    s_call_b64 s[90:91], L_iss
    s_waitcnt vmcnt(10)
    s_cmp_lg_u32 s97, 9
    s_cbranch_scc1 Lcs_9
    s_call_b64 s[90:91], L_cl1
Lcs_9:
    s_barrier
    s_call_b64 s[90:91], L_iss
    s_waitcnt vmcnt(10)
    s_cmp_lg_u32 s97, 10
    s_cbranch_scc1 Lcs_10
    s_call_b64 s[90:91], L_cl1
Lcs_10:
    s_barrier
    s_call_b64 s[90:91], L_iss
    s_waitcnt vmcnt(10)
    s_cmp_lg_u32 s97, 11
    s_cbranch_scc1 Lcs_11
    s_call_b64 s[90:91], L_cl1
Lcs_11:
    s_barrier
    s_cmp_lg_u32 s76, 0
    s_cbranch_scc1 Lpl_12
    s_mov_b32 exec_hi, 0xffff
    buffer_load_dwordx2 v[10:11], v8, s[36:39], 0 offen sc1
    s_mov_b64 exec, -1
Lpl_12:
    s_call_b64 s[90:91], L_iss
    s_cmp_lg_u32 s76, 1
    s_cbranch_scc1 Lpf_13
    s_getpc_b64 s[90:91]
Lpc_14:
    s_add_u32 s90, s90, L_phend-Lpc_14
    s_addc_u32 s91, s91, 0
    s_lshr_b32 s100, s2, 3
    s_lshl_b32 s100, s100, 10
    s_min_u32 s100, s100, (L_end-L_phend-768)
    v_add_u32 v236, s100, v14
    global_load_dword v236, v236, s[90:91]
Lpf_13:
    s_waitcnt vmcnt(10)
    s_barrier
    s_cmp_lg_u32 s76, 2
    s_cbranch_scc1 Lc4_15
    s_mov_b32 exec_hi, -1
    buffer_load_dword v238, v63, s[40:43], 0 offen
    s_mov_b64 exec, -1
Lc4_15:
    s_call_b64 s[90:91], L_iss
    s_waitcnt vmcnt(10)
    s_cmp_lg_u32 s76, 0
    s_cbranch_scc1 Lpc_16
    s_setprio 2
    s_mov_b32 exec_hi, 0xffff
    s_mov_b32 s85, 0
Lpk_17:
    v_cmp_ne_u32 vcc, s75, v10
    s_cbranch_vccnz Lspin_18
    v_cmp_ne_u32 vcc, s99, v11
    s_mov_b64 exec, -1
    s_lshr_b32 s78, vcc_lo, 16
    s_cselect_b32 s78, 0, 3
    s_cmp_eq_u32 vcc_hi, 0
    s_cselect_b32 s79, 3, 1
    s_and_b32 s78, s78, s79
    s_and_b32 s78, s78, 3
    v_mov_b32_e64 v10, s78
    v_mov_b32 v11, 163584
    ds_write_b32 v11, v10
    s_setprio 0
Lpc_16:
    s_barrier
    v_lshrrev_b32 v196, 4, v2
    v_and_b32 v197, 15, v2
    v_lshlrev_b32_e64 v197, 4, v197
    v_lshl_add_u32 v198, v196, 10, v197
    s_lshl_b32 s78, s69, 14
    s_lshl_b32 s79, s76, 8
    s_add_u32 s78, s78, s79
    s_nop 0
    s_add_u32 s78, s78, 65536
    buffer_load_dwordx4 v[20:23], v198, s[36:39], s78 offen sc1
    s_add_u32 s78, s78, 4096
    buffer_load_dwordx4 v[24:27], v198, s[36:39], s78 offen sc1
    s_add_u32 s78, s78, 4096
    buffer_load_dwordx4 v[28:31], v198, s[36:39], s78 offen sc1
    s_add_u32 s78, s78, 4096
    buffer_load_dwordx4 v[32:35], v198, s[36:39], s78 offen sc1
    v_mul_u32_u24 v198, 768, v196
    v_add_u32_e64 v198, v198, v197
    s_mul_i32 s78, s70, 12288
    s_lshl_b32 s79, s76, 8
    s_add_u32 s78, s78, s79
    s_add_u32 s78, s78, 327680
    s_cmp_eq_u32 s76, 3
    s_nop 0
    s_cselect_b32 s78, 0x10000000, s78
    buffer_load_dwordx4 v[36:39], v198, s[36:39], s78 offen sc1
    s_add_u32 s78, s78, 3072
    buffer_load_dwordx4 v[40:43], v198, s[36:39], s78 offen sc1
    s_add_u32 s78, s78, 3072
    buffer_load_dwordx4 v[44:47], v198, s[36:39], s78 offen sc1
    s_add_u32 s78, s78, 3072
    buffer_load_dwordx4 v[48:51], v198, s[36:39], s78 offen sc1
    s_add_u32 m0, s84, 0
    s_mov_b32 s100, 0
    buffer_load_dwordx4 v246, s[40:43], s100 offen  lds
    s_add_u32 m0, s84, 4096
    s_mov_b32 s100, 65536
    buffer_load_dwordx4 v246, s[40:43], s100 offen  lds
    s_add_u32 m0, s84, 8192
    s_mov_b32 s100, 131072
    buffer_load_dwordx4 v246, s[40:43], s100 offen  lds
    s_add_u32 m0, s84, 12288
    s_mov_b32 s100, 196608
    buffer_load_dwordx4 v246, s[40:43], s100 offen  lds
    s_waitcnt vmcnt(12)
    s_barrier
    s_setprio 2
    s_add_u32 m0, s84, 16384
    s_mov_b32 s100, 262144
    buffer_load_dwordx4 v246, s[40:43], s100 offen  lds
    s_waitcnt vmcnt(9)
    v_add_f32 v20, v20, v24
    v_add_f32 v21, v21, v25
    v_add_f32 v22, v22, v26
    v_add_f32 v23, v23, v27
    v_add_f32 v20, v20, v28
    v_add_f32 v21, v21, v29
    s_add_u32 m0, s84, 20480
    s_mov_b32 s100, 327680
    buffer_load_dwordx4 v246, s[40:43], s100 offen  lds
    v_add_f32 v22, v22, v30
    v_add_f32 v23, v23, v31
    v_add_f32 v20, v20, v32
    v_add_f32 v21, v21, v33
    v_add_f32 v22, v22, v34
    v_add_f32 v23, v23, v35
    s_nop 0
    v_permlane32_swap_b32 v20, v22
    s_add_u32 m0, s84, 24576
    s_mov_b32 s100, 393216
    buffer_load_dwordx4 v246, s[40:43], s100 offen  lds
L_pad0:
    s_cbranch_execz L_pad4
    v_permlane32_swap_b32 v21, v23
    v_add_f32 v20, v20, v22
    v_add_f32 v21, v21, v23
    v_mov_b32 v22, v20
    v_mov_b32 v23, v21
    s_nop 0
    v_permlane16_swap_b32 v20, v22
    v_permlane16_swap_b32 v21, v23
    v_add_f32 v20, v20, v22
    s_add_u32 m0, s84, 28672
    s_mov_b32 s100, 458752
    buffer_load_dwordx4 v246, s[40:43], s100 offen  lds
    v_add_f32_e64 v21, v21, v23
    v_mul_f32 v24, 0x3a800000, v20
    v_mul_f32 v26, 0x3a800000, v21
    v_fma_f32 v26, -v24, v24, v26
    v_max_f32_e64 v26, 0, v26
    v_cvt_pk_bf16_f32 v24, v24, v24
    v_and_b32 v24, 0xffff0000, v24
    s_add_u32 m0, s84, 32768
    s_mov_b32 s100, 524288
    buffer_load_dwordx4 v246, s[40:43], s100 offen  lds
    v_cvt_pk_bf16_f32 v26, v26, v26
    v_and_b32 v26, 0xffff0000, v26
    v_add_f32 v26, 0x3727c5ac, v26
    v_cvt_pk_bf16_f32 v26, v26, v26
    v_and_b32 v26, 0xffff0000, v26
    v_sqrt_f32 v26, v26
    s_nop 0
    v_cvt_pk_bf16_f32 v26, v26, v26
    v_and_b32 v26, 0xffff0000, v26
    s_add_u32 m0, s84, 36864
    s_mov_b32 s100, 589824
    buffer_load_dwordx4 v246, s[40:43], s100 offen  lds
    v_rcp_f32_e64 v25, v26
    v_xor_b32 v26, 0x80000000, v24
    v_lshrrev_b32 v27, 16, v26
    v_or_b32 v26, v26, v27
    v_mov_b32 v27, 0
    v_and_b32 v196, 15, v2
    v_lshrrev_b32_e64 v197, 5, v2
    s_add_u32 m0, s84, 40960
    s_mov_b32 s100, 655360
    buffer_load_dwordx4 v246, s[40:43], s100 offen  lds
    v_lshl_add_u32 v196, v196, 1, v197
    s_lshl_b32 s78, s76, 5
    v_add_u32 v196, s78, v196
    v_lshlrev_b32_e64 v197, 3, v196
    v_add_u32 v197, 159744, v197
    v_lshlrev_b32_e64 v196, 2, v196
    v_add_u32 v196, 162304, v196
    s_add_u32 m0, s84, 45056
    s_mov_b32 s100, 720896
    buffer_load_dwordx4 v246, s[40:43], s100 offen  lds
    ds_write_b64 v197, v[26:27]
    ds_write_b32 v196, v25
    s_waitcnt vmcnt(12)
    v_add_f32 v36, v36, v40
    v_add_f32 v37, v37, v41
    v_add_f32 v38, v38, v42
    v_add_f32 v39, v39, v43
    v_add_f32 v36, v36, v44
    s_add_u32 m0, s84, 49152
    s_mov_b32 s100, 786432
    buffer_load_dwordx4 v246, s[40:43], s100 offen  lds
    v_add_f32 v37, v37, v45
    v_add_f32 v38, v38, v46
    v_add_f32 v39, v39, v47
    v_add_f32 v36, v36, v48
    v_add_f32 v37, v37, v49
    v_add_f32 v38, v38, v50
    v_add_f32_e64 v39, v39, v51
    s_add_u32 m0, s84, 53248
    s_mov_b32 s100, 851968
    buffer_load_dwordx4 v246, s[40:43], s100 offen  lds
    v_permlane32_swap_b32 v36, v38
    v_permlane32_swap_b32 v37, v39
    v_add_f32 v36, v36, v38
    v_add_f32 v37, v37, v39
    s_nop 1
    v_permlane16_swap_b32 v36, v37
    v_add_f32_e64 v36, v36, v37
    v_cvt_pk_bf16_f32 v37, v36, v36
    v_and_b32 v37, 0xffff0000, v37
    s_add_u32 m0, s84, 57344
    s_mov_b32 s100, 917504
    buffer_load_dwordx4 v246, s[40:43], s100 offen  lds
    v_sub_f32_e64 v38, v36, v37
    v_cvt_pk_bf16_f32 v38, v37, v38
    v_mov_b32 v39, 0
    v_and_b32 v196, 15, v2
    v_lshrrev_b32_e64 v197, 4, v2
    v_lshl_add_u32 v196, v196, 2, v197
    s_lshl_b32 s78, s76, 9
    s_add_u32 m0, s84, 61440
    s_mov_b32 s100, 983040
    buffer_load_dwordx4 v246, s[40:43], s100 offen  lds
    s_add_u32 s78, s78, 160768
    v_lshl_add_u32 v196, v196, 3, s78
    v_and_b32 v197, 15, v2
    v_lshlrev_b32_e64 v197, 3, v197
    v_add_u32 v197, 162816, v197
    v_mov_b32 v198, 0x3f803f80
    s_cmp_eq_u32 s76, 3
    s_cselect_b64 vcc, -1, 0
    v_cndmask_b32 v196, v196, v197, vcc
    v_cndmask_b32 v38, v38, v198, vcc
    v_cndmask_b32_e64 v39, v39, v198, vcc
    ds_write_b64 v196, v[38:39]
    s_setprio 0
    s_waitcnt lgkmcnt(0)
    s_barrier
L_phend:
    s_mov_b32 s66, s96
    s_add_u32 m0, s84, 65536
    s_mov_b32 s100, 1048576
    buffer_load_dwordx4 v246, s[40:43], s100 offen  lds
    v_lshrrev_b32 v52, 2, v2
    v_and_b32 v53, 7, v52
    v_and_b32_e64 v55, 3, v2
    s_add_u32 m0, s84, 69632
    s_mov_b32 s100, 1114112
    buffer_load_dwordx4 v246, s[40:43], s100 offen  lds
    v_xor_b32 v53, v53, v55
    v_lshlrev_b32 v52, 7, v52
    v_lshrrev_b32_e64 v55, 1, v55
    s_add_u32 m0, s84, 73728
    s_mov_b32 s100, 1179648
    buffer_load_dwordx4 v246, s[40:43], s100 offen  lds
    v_lshl_add_u32 v52, v55, 3, v52
    s_lshr_b32 s78, s76, 1
    s_and_b32 s79, s76, 1
    s_lshl_b32 s80, s79, 2
    s_add_u32 m0, s84, 77824
    s_mov_b32 s100, 1245184
    buffer_load_dwordx4 v246, s[40:43], s100 offen  lds
    s_lshl_b32 s81, s78, 2
    v_xor_b32 v55, s80, v53
    v_xor_b32 v53, s81, v53
    s_add_u32 m0, s84, 81920
    s_mov_b32 s100, 1310720
    buffer_load_dwordx4 v246, s[40:43], s100 offen  lds
    s_lshl_b32 s80, s78, 14
    s_add_u32 s80, s80, 110592
    v_lshl_add_u32 v196, v55, 4, v52
    v_add_u32 v196, s80, v196
    s_add_u32 m0, s84, 86016
    s_mov_b32 s100, 1376256
    buffer_load_dwordx4 v246, s[40:43], s100 offen  lds
    v_lshl_add_u32 v198, v53, 4, v52
    v_add_u32 v198, 143360, v198
    v_xor_b32_e64 v197, 8, v196
    s_add_u32 m0, s84, 90112
    s_mov_b32 s100, 1441792
    buffer_load_dwordx4 v246, s[40:43], s100 offen  lds
    v_xor_b32_e64 v199, 8, v198
    v_mov_b32 v200, 0x3f803f80
    v_mov_b32 v201, 0x3f803f80
    v_mov_b32 v202, 0x3f803f80
    s_add_u32 m0, s84, 94208
    s_mov_b32 s100, 1507328
    buffer_load_dwordx4 v246, s[40:43], s100 offen  lds
    v_mov_b32 v203, 0x3f803f80
    v_lshrrev_b32 v62, 4, v2
    v_and_b32 v52, 15, v2
    s_add_u32 m0, s84, 98304
    s_mov_b32 s100, 1572864
    buffer_load_dwordx4 v246, s[40:43], s100 offen  lds
    v_lshlrev_b32_e64 v53, 4, v52
    v_lshl_add_u32 v62, v62, 13, v53
    v_lshrrev_b32_e64 v52, 3, v52
    v_lshl_add_u32 v62, v52, 8, v62
    s_add_u32 m0, s84, 102400
    s_mov_b32 s100, 1638400
    buffer_load_dwordx4 v246, s[40:43], s100 offen  lds
    v_xor_b32 v63, 256, v62
    s_lshl_b32 s78, s70, 2
    s_add_u32 s78, s78, s76
    s_add_u32 m0, s84, 106496
    s_mov_b32 s100, 1703936
    buffer_load_dwordx4 v246, s[40:43], s100 offen  lds
    s_lshl_b32 s78, s78, 15
    s_lshl_b32 s79, s69, 9
    s_add_u32 s78, s78, s79
    s_add_u32 s78, s78, 2097152
    s_mov_b32 s100, 2031616
    buffer_load_dwordx4 v[160:163], v246, s[40:43], s100 offen
    s_lshl_b32 s79, s77, 10
    s_lshl_b32 s80, s76, 6
    s_add_u32 s79, s79, s80
    s_mov_b32 s100, 1966080
    buffer_load_dwordx4 v[164:167], v246, s[40:43], s100 offen
    s_add_u32 s79, s79, 8389120
    v_lshrrev_b32 v52, 3, v2
    v_and_b32 v53, 7, v2
    v_lshlrev_b32_e64 v53, 4, v53
    s_mov_b32 s100, 1900544
    buffer_load_dwordx4 v[168:171], v246, s[40:43], s100 offen
    v_lshl_add_u32 v56, v52, 9, v53
    v_lshl_add_u32 v57, v52, 1, v53
    s_lshl_b32 s82, s70, 14
    s_mov_b32 s100, 1835008
    buffer_load_dwordx4 v[172:175], v246, s[40:43], s100 offen
    s_add_u32 s82, s82, s80
    s_add_u32 s82, s82, 8389120
    s_add_u32 s80, s80, 162944
    v_lshrrev_b32_e64 v58, 2, v2
    s_mov_b32 s100, 1769472
    buffer_load_dwordx4 v[176:179], v246, s[40:43], s100 offen
    v_and_b32 v53, 3, v2
    v_lshlrev_b32 v53, 4, v53
    v_lshl_add_u32 v58, v58, 10, v53
    s_mov_b32 s100, 0
    buffer_load_dwordx4 v[180:183], v247, s[28:31], s100 offen
    v_lshl_add_u32 v59, v52, 1, v53
    v_add_u32 v59, s80, v59
    s_lshl_b32 s64, s77, 13
    s_lshl_b32 s80, s76, 7
    s_mov_b32 s100, 16384
    buffer_load_dwordx4 v[184:187], v248, s[28:31], s100 offen
    s_add_u32 s64, s64, s80
    s_add_u32 s64, s64, 2097152
    s_add_u32 s65, s64, 4096
    s_mov_b32 s100, 32768
    buffer_load_dwordx4 v[188:191], v247, s[28:31], s100 offen
    s_lshl_b32 s81, s77, 10
    s_add_u32 s81, s81, s80
    s_add_u32 s81, s81, 8388608
    s_lshl_b32 s80, s71, 9
    s_mov_b32 s100, 49152
    buffer_load_dwordx4 v[192:195], v248, s[28:31], s100 offen
    s_add_u32 s80, s80, 8912896
    v_lshl_add_u32 v61, v2, 13, s80
    v_mov_b32 v52, 163584
    s_lshl_b32 s100, s77, 13
    s_add_u32 s100, s100, s89
    s_add_u32 s100, s100, 2097152
    buffer_load_dwordx4 v[252:255], v14, s[36:39], s100 offen offset:0 sc1
    ds_read_b32 v52, v52
    s_waitcnt lgkmcnt(0)
    v_readfirstlane_b32 s99, v52
    s_and_b32 s94, s69, 1
    s_lshl_b32 s100, s77, 13
    s_add_u32 s100, s100, s89
    s_nop 0
    s_add_u32 s100, s100, 2097152
    buffer_load_dwordx4 v[252:255], v14, s[36:39], s100 offen offset:1024 sc1
    s_mul_i32 s94, s94, 0x00010001
    s_mov_b32 s95, 0xfffefffe
    s_and_b32 s96, s75, 0x00010001
    buffer_load_dwordx4 v[252:255], v14, s[36:39], s66 offen sc1
    v_mov_b32_e64 v54, s96
    s_and_b32 s83, s75, 1
    s_lshl_b32 s83, s83, 16
    s_sub_u32 s83, 0, s83
    s_barrier
    ds_read_b64_tr_b16 v[4:5], v196 offset:0
    ds_read_b64_tr_b16 v[6:7], v196 offset:2048
    ds_read_b64_tr_b16 v[12:13], v198 offset:0
    ds_read_b64_tr_b16 v[14:15], v198 offset:2048
    ds_read_b64_tr_b16 v[8:9], v197 offset:0
    ds_read_b64_tr_b16 v[10:11], v197 offset:2048
    ds_read_b64_tr_b16 v[16:17], v199 offset:0
    ds_read_b64_tr_b16 v[18:19], v199 offset:2048
    ds_read_b64_tr_b16 v[20:21], v196 offset:4096
    ds_read_b64_tr_b16 v[22:23], v196 offset:6144
    ds_read_b64_tr_b16 v[28:29], v198 offset:4096
    ds_read_b64_tr_b16 v[30:31], v198 offset:6144
    ds_read_b64_tr_b16 v[24:25], v197 offset:4096
    ds_read_b64_tr_b16 v[26:27], v197 offset:6144
    s_waitcnt lgkmcnt(10)
    v_mfma_f32_16x16x32_bf16 v[204:207], v[4:7], v[12:15], 0
    ds_read_b64_tr_b16 v[32:33], v199 offset:4096
    ds_read_b64_tr_b16 v[34:35], v199 offset:6144
    s_waitcnt lgkmcnt(10)
    v_mfma_f32_16x16x32_bf16 v[208:211], v[8:11], v[12:15], 0
    ds_read_b64_tr_b16 v[36:37], v196 offset:8192
    ds_read_b64_tr_b16 v[38:39], v196 offset:10240
    s_waitcnt lgkmcnt(10)
    s_nop 0
    v_mfma_f32_16x16x32_bf16 v[216:219], v[8:11], v[16:19], 0
    ds_read_b64_tr_b16 v[44:45], v198 offset:8192
    ds_read_b64_tr_b16 v[46:47], v198 offset:10240
    v_mfma_f32_16x16x32_bf16 v[212:215], v[4:7], v[16:19], 0
    ds_read_b64_tr_b16 v[40:41], v197 offset:8192
    ds_read_b64_tr_b16 v[42:43], v197 offset:10240
    s_waitcnt lgkmcnt(10)
    v_mfma_f32_16x16x32_bf16 v[204:207], v[20:23], v[28:31], v[204:207]
    ds_read_b64_tr_b16 v[48:49], v199 offset:8192
    ds_read_b64_tr_b16 v[50:51], v199 offset:10240
    s_waitcnt lgkmcnt(10)
    v_mfma_f32_16x16x32_bf16 v[208:211], v[24:27], v[28:31], v[208:211]
    ds_read_b64_tr_b16 v[228:229], v196 offset:12288
    ds_read_b64_tr_b16 v[230:231], v196 offset:14336
    s_waitcnt lgkmcnt(10)
    s_nop 0
    v_mfma_f32_16x16x32_bf16 v[216:219], v[24:27], v[32:35], v[216:219]
    ds_read_b64_tr_b16 v[236:237], v198 offset:12288
    ds_read_b64_tr_b16 v[238:239], v198 offset:14336
    v_mfma_f32_16x16x32_bf16 v[212:215], v[20:23], v[32:35], v[212:215]
    ds_read_b64_tr_b16 v[232:233], v197 offset:12288
    ds_read_b64_tr_b16 v[234:235], v197 offset:14336
    s_waitcnt lgkmcnt(10)
    v_mfma_f32_16x16x32_bf16 v[204:207], v[36:39], v[44:47], v[204:207]
    ds_read_b64_tr_b16 v[240:241], v199 offset:12288
    ds_read_b64_tr_b16 v[242:243], v199 offset:14336
    s_waitcnt lgkmcnt(10)
    v_mfma_f32_16x16x32_bf16 v[208:211], v[40:43], v[44:47], v[208:211]
    s_waitcnt lgkmcnt(8)
    v_mfma_f32_16x16x32_bf16 v[216:219], v[40:43], v[48:51], v[216:219]
L_pad1:
    s_cbranch_execz L_pad5
    v_mfma_f32_16x16x32_bf16 v[212:215], v[36:39], v[48:51], v[212:215]
    s_waitcnt lgkmcnt(4)
    v_mfma_f32_16x16x32_bf16 v[204:207], v[228:231], v[236:239], v[204:207]
    s_waitcnt lgkmcnt(2)
    v_mfma_f32_16x16x32_bf16 v[208:211], v[232:235], v[236:239], v[208:211]
    s_waitcnt lgkmcnt(0)
    s_nop 0
    v_mfma_f32_16x16x32_bf16 v[216:219], v[232:235], v[240:243], v[216:219]
    v_mfma_f32_16x16x32_bf16 v[212:215], v[228:231], v[240:243], v[212:215]
    v_mfma_f32_16x16x32_bf16 v[220:223], v[4:7], v[200:203], 0
    v_mfma_f32_16x16x32_bf16 v[224:227], v[8:11], v[200:203], 0
    v_mfma_f32_16x16x32_bf16 v[220:223], v[20:23], v[200:203], v[220:223]
    v_mfma_f32_16x16x32_bf16 v[224:227], v[24:27], v[200:203], v[224:227]
    v_cvt_pk_bf16_f32 v12, v204, v205
    v_cvt_pk_bf16_f32 v13, v206, v207
    v_cvt_pk_bf16_f32 v14, v208, v209
    v_cvt_pk_bf16_f32 v15, v210, v211
    v_mfma_f32_16x16x32_bf16 v[220:223], v[36:39], v[200:203], v[220:223]
    v_add_u32_e64 v12, s94, v12
    v_and_or_b32 v12, v12, s95, v54
    v_mfma_f32_16x16x32_bf16 v[224:227], v[40:43], v[200:203], v[224:227]
    v_add_u32_e64 v13, s94, v13
    v_and_or_b32 v13, v13, s95, v54
    v_mfma_f32_16x16x32_bf16 v[220:223], v[228:231], v[200:203], v[220:223]
    v_add_u32_e64 v14, s94, v14
    v_and_or_b32 v14, v14, s95, v54
    v_mfma_f32_16x16x32_bf16 v[224:227], v[232:235], v[200:203], v[224:227]
    v_add_u32_e64 v15, s94, v15
    v_and_or_b32 v15, v15, s95, v54
    s_bitcmp1_b32 s99, 0
    s_cbranch_scc0 Lls_19
    buffer_store_dwordx4 v[12:15], v62, s[36:39], s78 offen
Lle_20:
    v_cvt_pk_bf16_f32 v28, v212, v213
    v_cvt_pk_bf16_f32 v29, v214, v215
    v_cvt_pk_bf16_f32 v30, v216, v217
    v_cvt_pk_bf16_f32 v31, v218, v219
    v_add_u32_e64 v28, s94, v28
    v_and_or_b32 v28, v28, s95, v54
    v_add_u32_e64 v29, s94, v29
    v_and_or_b32 v29, v29, s95, v54
    v_add_u32_e64 v30, s94, v30
    v_and_or_b32 v30, v30, s95, v54
    v_add_u32_e64 v31, s94, v31
    v_and_or_b32 v31, v31, s95, v54
    s_bitcmp1_b32 s99, 0
    s_cbranch_scc0 Lls_21
    buffer_store_dwordx4 v[28:31], v63, s[36:39], s78 offen
Lle_22:
    v_cvt_pk_bf16_f32 v44, v220, v221
    v_cvt_pk_bf16_f32 v45, v222, v223
    v_cvt_pk_bf16_f32 v46, v224, v225
    v_cvt_pk_bf16_f32 v47, v226, v227
    s_mov_b32 exec_lo, 0x00010001
    s_mov_b32 exec_hi, 0x00010001
    s_bitcmp1_b32 s99, 0
    s_cbranch_scc0 Lls_23
    buffer_store_dwordx4 v[44:47], v2, s[36:39], s79 offen
Lle_24:
    s_mov_b64 exec, -1
    s_mov_b32 s85, 0
Lspin_25:
    buffer_load_dwordx4 v[20:23], v56, s[36:39], s64 offen sc1
    buffer_load_dwordx4 v[24:27], v56, s[36:39], s65 offen sc1
    buffer_load_dwordx4 v[16:19], v58, s[36:39], s82 offen sc1
    s_add_u32 s85, s85, 1
    s_cmp_gt_u32 s85, 400000
    s_cbranch_scc1 L_end
    s_waitcnt vmcnt(0)
    s_nop 0
    v_bitop3_b32 v28, v20, v24, v54 bitop3:0x7e
    v_bitop3_b32 v29, v21, v25, v54 bitop3:0x7e
    v_bitop3_b32 v30, v22, v26, v54 bitop3:0x7e
    v_bitop3_b32 v31, v23, v27, v54 bitop3:0x7e
    v_or3_b32 v28, v28, v29, v30
    v_cmp_eq_u32 s[90:91], -1, v16
    v_or_b32_e64 v28, v28, v31
    v_and_b32 v28, 0x00010001, v28
    v_cmp_ne_u32_e64 vcc, 0, v28
    s_or_b64 vcc, vcc, s[90:91]
    s_cbranch_vccnz Lspin_25
    v_lshl_add_u32 v28, v20, 16, s83
    v_and_b32 v29, 0xfffe0000, v20
    v_lshl_add_u32 v36, v24, 16, s83
    v_and_b32 v37, 0xfffe0000, v24
    v_pk_add_f32 v[28:29], v[28:29], v[36:37]
    v_lshl_add_u32 v30, v21, 16, s83
    v_and_b32 v31, 0xfffe0000, v21
    v_lshl_add_u32 v38, v25, 16, s83
    v_and_b32 v39, 0xfffe0000, v25
    v_pk_add_f32 v[30:31], v[30:31], v[38:39]
    v_lshl_add_u32 v32, v22, 16, s83
    v_and_b32 v33, 0xfffe0000, v22
    v_lshl_add_u32 v40, v26, 16, s83
    v_and_b32 v41, 0xfffe0000, v26
    v_pk_add_f32 v[32:33], v[32:33], v[40:41]
    v_lshl_add_u32 v34, v23, 16, s83
    v_and_b32 v35, 0xfffe0000, v23
    v_lshl_add_u32 v42, v27, 16, s83
    v_and_b32 v43, 0xfffe0000, v27
    v_pk_add_f32 v[34:35], v[34:35], v[42:43]
    v_permlane32_swap_b32 v28, v32
    v_permlane32_swap_b32 v29, v33
    v_permlane32_swap_b32 v30, v34
    v_permlane32_swap_b32 v31, v35
    v_pk_add_f32 v[28:29], v[28:29], v[32:33]
    v_pk_add_f32 v[30:31], v[30:31], v[34:35]
    s_nop 1
    v_permlane16_swap_b32 v28, v30
    v_permlane16_swap_b32_e64 v29, v31
    v_pk_add_f32 v[28:29], v[28:29], v[30:31]
    s_nop 1
    v_add_f32_dpp v28, v28, v28 row_ror:8 row_mask:0xf bank_mask:0xf
    v_add_f32_dpp v29, v29, v29 row_ror:8 row_mask:0xf bank_mask:0xf
    v_cvt_pk_bf16_f32 v36, v28, v29
    s_mov_b32 exec_lo, 0x00ff00ff
    s_mov_b32 exec_hi, 0x00ff00ff
    s_bitcmp1_b32 s99, 0
    s_cbranch_scc0 Lls_26
    buffer_store_dword v36, v57, s[36:39], s81 offen
Lle_27:
    s_mov_b64 exec, -1
    v_lshlrev_b32_e64 v28, 16, v16
    v_and_b32 v29, 0xffff0000, v16
    v_lshlrev_b32_e64 v30, 16, v17
    v_and_b32 v31, 0xffff0000, v17
    v_lshlrev_b32_e64 v32, 16, v18
    v_and_b32 v33, 0xffff0000, v18
    v_lshlrev_b32_e64 v34, 16, v19
    v_and_b32 v35, 0xffff0000, v19
    v_permlane32_swap_b32 v28, v32
    v_permlane32_swap_b32 v29, v33
    v_permlane32_swap_b32 v30, v34
    v_permlane32_swap_b32 v31, v35
    v_pk_add_f32 v[28:29], v[28:29], v[32:33]
    v_pk_add_f32 v[30:31], v[30:31], v[34:35]
    s_nop 1
    v_permlane16_swap_b32 v28, v30
    v_permlane16_swap_b32_e64 v29, v31
    v_pk_add_f32 v[28:29], v[28:29], v[30:31]
    s_nop 1
    v_add_f32_dpp v38, v28, v28 row_ror:8 row_mask:0xf bank_mask:0x3
    s_nop 1
    v_add_f32_dpp v38, v29, v29 row_ror:8 row_mask:0xf bank_mask:0xc
    s_nop 1
    v_add_f32_dpp v37, v38, v38 row_shr:4 row_mask:0xf bank_mask:0xf
    v_cvt_pk_bf16_f32 v37, v37, v37
    s_mov_b32 exec_lo, 0xf0f0f0f0
    s_mov_b32 exec_hi, 0xf0f0f0f0
    ds_write_b16 v59, v37
    s_mov_b64 exec, -1
    s_waitcnt lgkmcnt(0)
    s_barrier
    v_lshlrev_b32 v4, 4, v2
    s_lshl_b32 s78, s76, 10
    s_add_u32 s78, s78, 110592
    v_add_u32 v5, s78, v4
    s_lshl_b32 s78, s76, 12
    s_add_u32 s78, s78, 131072
    v_add_u32 v6, s78, v4
    s_lshl_b32 s100, s77, 9
    s_add_u32 s100, s100, 8912896
    v_mov_b32 v48, s75
    v_mov_b32 v49, s75
    v_lshl_add_u32 v50, v2, 3, s100
    s_lshl_b32 s83, s71, 4
    s_add_u32 s83, s83, s72
    s_lshl_b32 s78, s77, 13
    s_and_b32 s79, s76, 1
    s_lshl_b32 s79, s79, 10
    s_add_u32 s78, s78, s79
    s_add_u32 s78, s78, 2099200
    s_mul_i32 s79, s74, 56
    s_add_u32 s79, s79, s73
    s_lshl_b32 s79, s79, 10
    s_add_u32 s79, s79, 1114112
    s_cmp_eq_u32 s76, 1
    s_cselect_b32 s78, s79, s78
    s_cmp_ge_u32 s73, 56
    s_cselect_b32 s78, 0x10000000, s78
    s_lshl_b32 s79, s83, 11
    s_add_u32 s79, s79, s84
    s_add_u32 s79, s79, 1572864
    s_cmp_lt_u32 s76, 2
    s_cselect_b32 s94, s79, s78
    s_lshl_b32 s79, s83, 9
    s_add_u32 s79, s79, 524288
    s_cmp_eq_u32 s76, 0
    s_cselect_b32 s78, s79, s78
    s_cselect_b32 s79, 0, -1
    v_mov_b32 v56, -1
    v_mov_b32 v57, -1
    v_mov_b32 v58, -1
    v_mov_b32_e64 v59, -1
    s_barrier
    s_mov_b32 s100, 43008
    buffer_load_dwordx4 v[88:91], v244, s[48:51], s100 offen nt
    s_mov_b32 s100, 43008
    buffer_load_dwordx4 v[120:123], v244, s[52:55], s100 offen nt
    s_mov_b32 s100, 50176
    buffer_load_dwordx4 v[92:95], v244, s[48:51], s100 offen nt
    s_mov_b32 s100, 50176
    buffer_load_dwordx4 v[124:127], v244, s[52:55], s100 offen nt
    ds_write_b128 v6, v[180:183] offset:0
    ds_write_b128 v6, v[184:187] offset:1024
    ds_write_b128 v6, v[188:191] offset:2048
    ds_write_b128 v6, v[192:195] offset:3072
    ds_write_b128 v5, v[160:163] offset:16384
    ds_write_b128 v5, v[164:167] offset:12288
    ds_write_b128 v5, v[168:171] offset:8192
    ds_write_b128 v5, v[172:175] offset:4096
    ds_write_b128 v5, v[176:179] offset:0
    s_waitcnt lgkmcnt(0)
    s_barrier
    s_cmp_lg_u32 s76, 0
    s_cbranch_scc1 Lfs_28
    buffer_store_dwordx2 v[48:49], v50, s[36:39], 0 offen sc1
Lfs_28:
    s_and_b32 s100, s76, 2
    s_and_b32 s101, s99, 1
    s_lshl_b32 s100, s100, s101
    s_and_b32 s100, s100, 4
    s_or_b32 s99, s99, s100
    s_mov_b32 exec_hi, s79
    s_bitcmp1_b32 s99, 2
    s_cbranch_scc0 Lls_29
    buffer_store_dwordx4 v[56:59], v4, s[36:39], s78 offen
Lle_30:
    s_mov_b32 exec_hi, -1
    s_mov_b32 s100, 0x05040100
    s_mov_b32 s101, 0x07060302
    v_perm_b32 v7, v68, v64, s100
    v_perm_b32 v68, v68, v64, s101
    v_mov_b32 v64, v7
    v_perm_b32 v7, v69, v65, s100
    v_perm_b32 v69, v69, v65, s101
    v_mov_b32_e64 v65, v7
    v_perm_b32 v7, v70, v66, s100
    v_perm_b32 v70, v70, v66, s101
    v_mov_b32_e64 v66, v7
    v_perm_b32 v7, v71, v67, s100
    v_perm_b32 v71, v71, v67, s101
    v_mov_b32_e64 v67, v7
    v_perm_b32 v7, v100, v96, s100
    v_perm_b32 v100, v100, v96, s101
    v_mov_b32_e64 v96, v7
    v_perm_b32 v7, v101, v97, s100
    v_perm_b32 v101, v101, v97, s101
    v_mov_b32_e64 v97, v7
    v_perm_b32 v7, v102, v98, s100
    v_perm_b32 v102, v102, v98, s101
    v_mov_b32_e64 v98, v7
    v_perm_b32 v7, v103, v99, s100
    v_perm_b32 v103, v103, v99, s101
    v_mov_b32_e64 v99, v7
    v_perm_b32 v7, v76, v72, s100
    v_perm_b32 v76, v76, v72, s101
    v_mov_b32_e64 v72, v7
    v_perm_b32 v7, v77, v73, s100
    v_perm_b32 v77, v77, v73, s101
    v_mov_b32_e64 v73, v7
    v_perm_b32 v7, v78, v74, s100
    v_perm_b32 v78, v78, v74, s101
    v_mov_b32_e64 v74, v7
    v_perm_b32 v7, v79, v75, s100
    v_perm_b32 v79, v79, v75, s101
    v_mov_b32_e64 v75, v7
    v_perm_b32 v7, v108, v104, s100
    v_perm_b32 v108, v108, v104, s101
    v_mov_b32_e64 v104, v7
    v_perm_b32 v7, v109, v105, s100
    v_perm_b32 v109, v109, v105, s101
    v_mov_b32_e64 v105, v7
    v_perm_b32 v7, v110, v106, s100
    v_perm_b32 v110, v110, v106, s101
    v_mov_b32_e64 v106, v7
    v_perm_b32 v7, v111, v107, s100
    v_perm_b32 v111, v111, v107, s101
    v_mov_b32_e64 v107, v7
    v_perm_b32 v7, v84, v80, s100
    v_perm_b32 v84, v84, v80, s101
    v_mov_b32_e64 v80, v7
    v_perm_b32 v7, v85, v81, s100
    v_perm_b32 v85, v85, v81, s101
    v_mov_b32_e64 v81, v7
    v_perm_b32 v7, v86, v82, s100
    v_perm_b32 v86, v86, v82, s101
    v_mov_b32_e64 v82, v7
    v_perm_b32 v7, v87, v83, s100
    v_perm_b32 v87, v87, v83, s101
    v_mov_b32_e64 v83, v7
    v_perm_b32 v7, v116, v112, s100
    v_perm_b32 v116, v116, v112, s101
    v_mov_b32_e64 v112, v7
    v_perm_b32 v7, v117, v113, s100
    v_perm_b32 v117, v117, v113, s101
    v_mov_b32_e64 v113, v7
    v_perm_b32 v7, v118, v114, s100
    v_perm_b32 v118, v118, v114, s101
    v_mov_b32_e64 v114, v7
    v_perm_b32 v7, v119, v115, s100
    v_perm_b32 v119, v119, v115, s101
    v_mov_b32_e64 v115, v7
    s_cmp_lg_u32 s76, 2
    s_cbranch_scc1 Lf2_31
    s_mov_b64 exec, 0xffff
L_pad2:
    s_cbranch_execz L_pad6
    s_mov_b32 s101, 0
    s_mov_b32 s85, 0
Lspin_32:
    buffer_load_dword v52, v61, s[36:39], s101 offen sc1
    s_add_u32 s101, s101, 128
    s_min_u32 s101, s101, 384
    s_add_u32 s85, s85, 1
    s_cmp_gt_u32 s85, 400000
    s_cbranch_scc1 L_end
    s_waitcnt vmcnt(0)
    v_cmp_ne_u32_e64 vcc, s75, v52
    s_cbranch_vccnz Lspin_32
    s_mov_b64 exec, -1
Lf2_31:
    s_barrier
    s_waitcnt vmcnt(0)
    s_mov_b32 s100, 0x05040100
    s_mov_b32 s101, 0x07060302
    v_perm_b32 v7, v92, v88, s100
    v_perm_b32 v92, v92, v88, s101
    v_mov_b32_e64 v88, v7
    v_perm_b32 v7, v93, v89, s100
    v_perm_b32 v93, v93, v89, s101
    v_mov_b32_e64 v89, v7
    v_perm_b32 v7, v94, v90, s100
    v_perm_b32 v94, v94, v90, s101
    v_mov_b32_e64 v90, v7
    v_perm_b32 v7, v95, v91, s100
    v_perm_b32 v95, v95, v91, s101
    v_mov_b32_e64 v91, v7
    v_perm_b32 v7, v124, v120, s100
    v_perm_b32 v124, v124, v120, s101
    v_mov_b32_e64 v120, v7
    v_perm_b32 v7, v125, v121, s100
    v_perm_b32 v125, v125, v121, s101
    v_mov_b32_e64 v121, v7
    v_perm_b32 v7, v126, v122, s100
    v_perm_b32 v126, v126, v122, s101
    v_mov_b32_e64 v122, v7
    v_perm_b32 v7, v127, v123, s100
    v_perm_b32 v127, v127, v123, s101
    v_mov_b32 v123, v7
    v_lshrrev_b32 v8, 3, v2
    v_and_b32 v9, 7, v2
    v_lshlrev_b32 v10, 4, v9
    v_lshl_add_u32 v11, v8, 13, v10
    v_and_b32 v12, 15, v2
    v_lshlrev_b32 v12, 13, v12
    v_and_b32_e64 v13, 3, v8
    v_lshl_add_u32 v13, v13, 9, v10
    v_lshrrev_b32_e64 v15, 2, v8
    v_lshl_add_u32 v13, v15, 13, v13
    v_lshl_add_u32 v14, v9, 3, v8
    s_lshl_b32 s80, s74, 2
    s_add_u32 s80, s80, s76
    s_lshl_b32 s78, s80, 9
    s_add_u32 s78, s78, 524288
    s_add_u32 s79, s78, 65536
    s_add_u32 s81, s73, s76
    s_and_b32 s81, s81, 3
    s_andn2_b32 s100, s73, 3
    s_or_b32 s81, s81, s100
    s_and_b32 s81, s81, 3
    s_lshl_b32 s81, s81, 2
    s_add_u32 s81, s81, s74
    s_lshl_b32 s81, s81, 13
    s_lshl_b32 s80, s76, 9
    s_add_u32 s80, s80, s81
    s_lshl_b32 s81, s70, 17
    s_add_u32 s81, s81, 2099200
    s_add_u32 s80, s80, s81
    s_and_b32 s100, s73, 3
    s_lshl_b32 s100, s100, 15
    s_add_u32 s81, s81, s100
    v_add_u32 v47, 0x10000, v11
    v_and_b32_e64 v53, 1, v54
    s_lshl_b32 s64, s76, 7
    s_add_u32 s64, s64, s81
    s_add_u32 s65, s64, 16384
    v_lshrrev_b32_e64 v50, 5, v2
    v_lshl_add_u32 v50, v9, 1, v50
    s_lshl_b32 s82, s76, 5
    s_add_u32 s82, s82, 163456
    v_lshl_add_u32 v50, v50, 1, s82
    v_lshlrev_b32 v27, 4, v8
    v_add_u32 v51, 163456, v27
    v_lshlrev_b32 v49, 2, v14
    v_lshlrev_b32 v15, 3, v14
    v_mov_b32 v26, 163360
    s_mul_i32 s66, s74, 56
    s_add_u32 s66, s66, s73
    s_lshl_b32 s66, s66, 10
    s_lshl_b32 s82, s76, 8
    s_add_u32 s66, s66, s82
    s_add_u32 s66, s66, 1114112
    s_barrier
    s_mov_b32 s100, 0
    s_nop 0
    buffer_load_dwordx4 v[128:131], v245, s[56:59], s100 offen nt
    s_mov_b32 s100, 2048
    buffer_load_dwordx4 v[132:135], v245, s[56:59], s100 offen nt
    s_mov_b32 s100, 4096
    buffer_load_dwordx4 v[136:139], v245, s[56:59], s100 offen nt
    s_mov_b32 s100, 6144
    buffer_load_dwordx4 v[140:143], v245, s[56:59], s100 offen nt
    s_mov_b32 s100, 8192
    buffer_load_dwordx4 v[144:147], v245, s[56:59], s100 offen nt
    s_barrier
    s_waitcnt vmcnt(0)
    s_mov_b32 s100, 0x05040100
    s_mov_b32 s101, 0x07060302
    v_perm_b32 v7, v132, v128, s100
    v_perm_b32 v132, v132, v128, s101
    v_mov_b32_e64 v128, v7
    v_perm_b32 v7, v133, v129, s100
    v_perm_b32 v133, v133, v129, s101
    v_mov_b32_e64 v129, v7
    v_perm_b32 v7, v134, v130, s100
    v_perm_b32 v134, v134, v130, s101
    v_mov_b32_e64 v130, v7
    v_perm_b32 v7, v135, v131, s100
    v_perm_b32 v135, v135, v131, s101
    v_mov_b32_e64 v131, v7
    v_perm_b32 v7, v140, v136, s100
    v_perm_b32 v140, v140, v136, s101
    v_mov_b32_e64 v136, v7
    v_perm_b32 v7, v141, v137, s100
    v_perm_b32 v141, v141, v137, s101
    v_mov_b32_e64 v137, v7
    v_perm_b32 v7, v142, v138, s100
    v_perm_b32 v142, v142, v138, s101
    v_mov_b32_e64 v138, v7
    v_perm_b32 v7, v143, v139, s100
    v_perm_b32 v143, v143, v139, s101
    v_mov_b32 v139, v7
    s_barrier
    s_mov_b32 s100, 10240
    buffer_load_dwordx4 v[148:151], v245, s[56:59], s100 offen nt
    s_mov_b32 s100, 12288
    buffer_load_dwordx4 v[152:155], v245, s[56:59], s100 offen nt
    s_mov_b32 s100, 14336
    buffer_load_dwordx4 v[156:159], v245, s[56:59], s100 offen nt
    s_and_b32 s79, s2, 7
    s_lshl_b32 s79, s79, 9
    s_add_u32 s79, s79, 524288
    s_mov_b64 exec, 0xffff
    s_sleep 20
    s_mov_b32 s85, 0
Lspin_33:
    buffer_load_dwordx2 v[24:25], v12, s[36:39], s79 offen offset:128 sc1
    s_or_b32 s79, s79, 4096
    s_add_u32 s85, s85, 1
    s_cmp_gt_u32 s85, 400000
    s_cbranch_scc1 L_end
    s_waitcnt vmcnt(0)
    v_cmp_ne_u32_e64 vcc, s75, v25
    s_cbranch_vccnz Lspin_33
    v_max_f32_dpp v24, v24, v24 row_ror:8 row_mask:0xf bank_mask:0xf
    s_nop 1
    v_max_f32_dpp v24, v24, v24 row_ror:4 row_mask:0xf bank_mask:0xf
    s_nop 1
    v_max_f32_dpp v24, v24, v24 row_ror:2 row_mask:0xf bank_mask:0xf
    s_nop 1
    v_max_f32_dpp v24, v24, v24 row_ror:1 row_mask:0xf bank_mask:0xf
    s_nop 0
    v_readfirstlane_b32 s97, v24
    s_mov_b64 exec, -1
    s_nop 0
    v_mov_b32 v24, s97
    s_cmp_ge_u32 s73, 56
    s_cbranch_scc1 L_red
    s_bfe_u32 s79, s97, 0x40007
    s_lshl_b32 s79, s79, 13
    s_add_u32 s78, s78, s79
    buffer_load_dwordx4 v[20:23], v27, s[36:39], s78 offen sc1
    ds_write_b32 v26, v24
    s_mov_b32 s85, 1
    s_mov_b32 s100, 0x05040100
    s_mov_b32 s101, 0x07060302
    v_perm_b32 v7, v148, v144, s100
    v_perm_b32 v148, v148, v144, s101
    v_mov_b32 v144, v7
    v_perm_b32 v7, v149, v145, s100
    v_perm_b32 v149, v149, v145, s101
    v_mov_b32_e64 v145, v7
    v_perm_b32 v7, v150, v146, s100
    v_perm_b32 v150, v150, v146, s101
    v_mov_b32_e64 v146, v7
    v_perm_b32 v7, v151, v147, s100
    v_perm_b32 v151, v151, v147, s101
    v_mov_b32_e64 v147, v7
    v_perm_b32 v7, v156, v152, s100
    v_perm_b32 v156, v156, v152, s101
    v_mov_b32_e64 v152, v7
    v_perm_b32 v7, v157, v153, s100
    v_perm_b32 v157, v157, v153, s101
    v_mov_b32_e64 v153, v7
    v_perm_b32 v7, v158, v154, s100
    v_perm_b32 v158, v158, v154, s101
    v_mov_b32_e64 v154, v7
    v_perm_b32 v7, v159, v155, s100
    v_perm_b32 v159, v159, v155, s101
    v_mov_b32 v155, v7
Lb_35:
    s_waitcnt vmcnt(0) lgkmcnt(0)
    v_max3_u32 v16, v20, v21, v22
    v_max_u32 v16, v16, v23
    v_cmp_eq_u32_e64 vcc, -1, v16
    s_cbranch_vccnz Lspin_34
    v_dot2_f32_bf16 v28, v64, v20, 0
    v_dot2_f32_bf16 v29, v68, v20, 0
    v_dot2_f32_bf16 v30, v65, v20, 0
    v_dot2_f32_bf16 v31, v69, v20, 0
    v_dot2_f32_bf16 v32, v66, v20, 0
    v_dot2_f32_bf16 v33, v70, v20, 0
    v_dot2_f32_bf16 v34, v67, v20, 0
    v_dot2_f32_bf16 v35, v71, v20, 0
    v_dot2_f32_bf16 v28, v72, v21, v28
    v_dot2_f32_bf16 v29, v76, v21, v29
    v_dot2_f32_bf16 v30, v73, v21, v30
    v_dot2_f32_bf16 v31, v77, v21, v31
    v_dot2_f32_bf16 v32, v74, v21, v32
    v_dot2_f32_bf16 v33, v78, v21, v33
    v_dot2_f32_bf16 v34, v75, v21, v34
    v_dot2_f32_bf16 v35, v79, v21, v35
    v_dot2_f32_bf16 v28, v80, v22, v28
    v_dot2_f32_bf16 v29, v84, v22, v29
    v_dot2_f32_bf16 v30, v81, v22, v30
    v_dot2_f32_bf16 v31, v85, v22, v31
    v_dot2_f32_bf16 v32, v82, v22, v32
    v_dot2_f32_bf16 v33, v86, v22, v33
    v_dot2_f32_bf16 v34, v83, v22, v34
    v_dot2_f32_bf16 v35, v87, v22, v35
    v_dot2_f32_bf16 v28, v88, v23, v28
    v_dot2_f32_bf16 v29, v92, v23, v29
    v_dot2_f32_bf16 v30, v89, v23, v30
    v_dot2_f32_bf16 v31, v93, v23, v31
    v_dot2_f32_bf16 v32, v90, v23, v32
    v_dot2_f32_bf16 v33, v94, v23, v33
    v_dot2_f32_bf16 v34, v91, v23, v34
    v_dot2_f32_bf16 v35, v95, v23, v35
    v_dot2_f32_bf16 v36, v96, v20, 0
    v_dot2_f32_bf16 v37, v100, v20, 0
    v_dot2_f32_bf16 v38, v97, v20, 0
    v_dot2_f32_bf16 v39, v101, v20, 0
    v_dot2_f32_bf16 v40, v98, v20, 0
    v_dot2_f32_bf16 v41, v102, v20, 0
    v_dot2_f32_bf16 v42, v99, v20, 0
    v_dot2_f32_bf16 v43, v103, v20, 0
    v_dot2_f32_bf16 v36, v104, v21, v36
    v_dot2_f32_bf16 v37, v108, v21, v37
    v_dot2_f32_bf16 v38, v105, v21, v38
    v_dot2_f32_bf16 v39, v109, v21, v39
    v_dot2_f32_bf16 v40, v106, v21, v40
    v_dot2_f32_bf16 v41, v110, v21, v41
    v_dot2_f32_bf16 v42, v107, v21, v42
    v_dot2_f32_bf16 v43, v111, v21, v43
    v_dot2_f32_bf16 v36, v112, v22, v36
    v_dot2_f32_bf16 v37, v116, v22, v37
    v_dot2_f32_bf16 v38, v113, v22, v38
    v_dot2_f32_bf16 v39, v117, v22, v39
    v_dot2_f32_bf16 v40, v114, v22, v40
    v_dot2_f32_bf16 v41, v118, v22, v41
    v_dot2_f32_bf16 v42, v115, v22, v42
    v_dot2_f32_bf16 v43, v119, v22, v43
    v_dot2_f32_bf16 v36, v120, v23, v36
    v_dot2_f32_bf16 v37, v124, v23, v37
    v_dot2_f32_bf16 v38, v121, v23, v38
    v_dot2_f32_bf16 v39, v125, v23, v39
    v_dot2_f32_bf16 v40, v122, v23, v40
    v_dot2_f32_bf16 v41, v126, v23, v41
    v_dot2_f32_bf16 v42, v123, v23, v42
    v_dot2_f32_bf16 v43, v127, v23, v43
    v_permlane32_swap_b32 v28, v32
    v_permlane32_swap_b32 v29, v33
    v_permlane32_swap_b32 v30, v34
    v_permlane32_swap_b32 v31, v35
    v_permlane32_swap_b32 v36, v40
    v_permlane32_swap_b32 v37, v41
    v_permlane32_swap_b32 v38, v42
    v_permlane32_swap_b32 v39, v43
    v_pk_add_f32 v[28:29], v[28:29], v[32:33]
    v_pk_add_f32 v[30:31], v[30:31], v[34:35]
    v_pk_add_f32 v[36:37], v[36:37], v[40:41]
    v_pk_add_f32 v[38:39], v[38:39], v[42:43]
    v_permlane16_swap_b32 v28, v30
    v_permlane16_swap_b32 v29, v31
    v_permlane16_swap_b32 v36, v38
    v_permlane16_swap_b32 v37, v39
    v_pk_add_f32 v[28:29], v[28:29], v[30:31]
    v_pk_add_f32 v[36:37], v[36:37], v[38:39]
    s_nop 0
    v_add_f32_dpp v44, v28, v28 row_ror:8 row_mask:0xf bank_mask:0x3
    v_add_f32_dpp v45, v36, v36 row_ror:8 row_mask:0xf bank_mask:0x3
    s_nop 0
    v_add_f32_dpp v44, v29, v29 row_ror:8 row_mask:0xf bank_mask:0xc
    v_add_f32_dpp v45, v37, v37 row_ror:8 row_mask:0xf bank_mask:0xc
    v_and_or_b32 v44, v44, -2, v53
    s_bitcmp1_b32 s99, 0
    s_cbranch_scc0 Lls_36
    buffer_store_dwordx2 v[44:45], v15, s[36:39], s80 offen
Lle_37:
    s_mov_b32 s95, s80
    s_barrier
    s_mov_b32 s85, 0
Lspin_38:
    buffer_load_dwordx4 v[16:19], v13, s[36:39], s64 offen sc1
    buffer_load_dwordx4 v[20:23], v13, s[36:39], s65 offen sc1
    s_add_u32 s85, s85, 1
    s_cmp_gt_u32 s85, 400000
L_pad3:
    s_cbranch_execz L_pad7
    s_cbranch_scc1 L_end
    s_waitcnt vmcnt(0)
    v_max3_u32 v25, v16, v18, v20
    v_max_u32 v25, v25, v22
    v_cmp_eq_u32 vcc, -1, v25
    s_cbranch_vccnz Lspin_38
    v_and_b32 v16, -2, v16
    v_and_b32 v18, -2, v18
    v_and_b32 v20, -2, v20
    v_and_b32 v22, -2, v22
    v_pk_add_f32 v[16:17], v[16:17], v[20:21]
    v_pk_add_f32 v[18:19], v[18:19], v[22:23]
    s_nop 1
    v_permlane32_swap_b32 v16, v18
    v_permlane32_swap_b32_e64 v17, v19
    v_pk_add_f32 v[16:17], v[16:17], v[18:19]
    v_mov_b32 v18, v16
    v_mov_b32 v19, v17
    s_nop 0
    v_permlane16_swap_b32 v16, v18
    v_permlane16_swap_b32_e64 v17, v19
    v_pk_add_f32 v[16:17], v[16:17], v[18:19]
    s_nop 1
    v_add_f32_dpp v16, v16, v16 row_ror:8 row_mask:0xf bank_mask:0xf
    v_add_f32_dpp v17, v17, v17 row_ror:8 row_mask:0xf bank_mask:0xf
    v_cvt_pk_bf16_f32 v17, v16, v17
    v_lshlrev_b32 v16, 16, v17
    v_mul_f32 v18, 0xbfb8aa3b, v16
    v_exp_f32_e64 v18, v18
    v_and_b32 v17, 0xffff0000, v17
    v_add_f32 v18, 1.0, v18
    v_rcp_f32 v18, v18
    s_nop 0
    v_mul_f32 v16, v16, v18
    v_cvt_pk_bf16_f32 v16, v16, v16
    v_and_b32 v16, 0xffff0000, v16
    v_mul_f32_e64 v16, v16, v17
    v_cvt_pk_bf16_f32 v16, v16, v16
    ds_write_b16 v50, v16
    s_waitcnt lgkmcnt(0)
    s_barrier
    ds_read_b128 v[20:23], v51
    s_waitcnt lgkmcnt(0)
    s_nop 0
    v_dot2_f32_bf16 v28, v128, v20, 0
    v_dot2_f32_bf16 v29, v132, v20, 0
    v_dot2_f32_bf16 v30, v129, v20, 0
    v_dot2_f32_bf16 v31, v133, v20, 0
    v_dot2_f32_bf16 v32, v130, v20, 0
    v_dot2_f32_bf16 v33, v134, v20, 0
    v_dot2_f32_bf16 v34, v131, v20, 0
    v_dot2_f32_bf16 v35, v135, v20, 0
    v_dot2_f32_bf16 v28, v136, v21, v28
    v_dot2_f32_bf16 v29, v140, v21, v29
    v_dot2_f32_bf16 v30, v137, v21, v30
    v_dot2_f32_bf16 v31, v141, v21, v31
    v_dot2_f32_bf16 v32, v138, v21, v32
    v_dot2_f32_bf16 v33, v142, v21, v33
    v_dot2_f32_bf16 v34, v139, v21, v34
    v_dot2_f32_bf16 v35, v143, v21, v35
    v_dot2_f32_bf16 v28, v144, v22, v28
    v_dot2_f32_bf16 v29, v148, v22, v29
    v_dot2_f32_bf16 v30, v145, v22, v30
    v_dot2_f32_bf16 v31, v149, v22, v31
    v_dot2_f32_bf16 v32, v146, v22, v32
    v_dot2_f32_bf16 v33, v150, v22, v33
    v_dot2_f32_bf16 v34, v147, v22, v34
    v_dot2_f32_bf16 v35, v151, v22, v35
    v_dot2_f32_bf16 v28, v152, v23, v28
    v_dot2_f32_bf16 v29, v156, v23, v29
    v_dot2_f32_bf16 v30, v153, v23, v30
    v_dot2_f32_bf16 v31, v157, v23, v31
    v_dot2_f32_bf16 v32, v154, v23, v32
    v_dot2_f32_bf16 v33, v158, v23, v33
    v_dot2_f32_bf16 v34, v155, v23, v34
    v_dot2_f32_bf16 v35, v159, v23, v35
    v_permlane32_swap_b32 v28, v32
    v_permlane32_swap_b32 v29, v33
    v_permlane32_swap_b32 v30, v34
    v_permlane32_swap_b32 v31, v35
    v_pk_add_f32 v[28:29], v[28:29], v[32:33]
    v_pk_add_f32 v[30:31], v[30:31], v[34:35]
    s_nop 1
    v_permlane16_swap_b32 v28, v30
    v_permlane16_swap_b32_e64 v29, v31
    v_pk_add_f32 v[28:29], v[28:29], v[30:31]
    s_nop 1
    v_add_f32_dpp v46, v28, v28 row_ror:8 row_mask:0xf bank_mask:0x3
    s_nop 1
    v_add_f32_dpp v46, v29, v29 row_ror:8 row_mask:0xf bank_mask:0xc
    buffer_store_dword v46, v49, s[36:39], s66 offen sc1
    s_barrier
    s_branch L_fin
L_red:
    v_mov_b32 v26, 163360
    ds_write_b32 v26, v24
    s_waitcnt lgkmcnt(0)
    s_barrier
    s_barrier
    s_barrier
    s_cmp_lg_u32 s76, 0
    s_cbranch_scc1 L_fin
    s_sub_u32 s83, s0, 224
    v_lshrrev_b32_e64 v14, 4, v2
    v_lshl_add_u32 v14, v9, 2, v14
    v_lshlrev_b32 v15, 2, v14
    v_lshlrev_b32 v14, 1, v14
    s_bfe_u32 s78, s97, 0x40007
    s_lshl_b32 s78, s78, 13
    s_lshr_b32 s79, s83, 1
    s_lshl_b32 s79, s79, 9
    s_add_u32 s78, s78, s79
    s_and_b32 s79, s83, 1
    s_lshl_b32 s79, s79, 7
    s_add_u32 s78, s78, s79
    s_add_u32 s78, s78, 524544
    s_mov_b32 s85, 0
Lspin_39:
    buffer_load_dword v46, v15, s[36:39], s78 offen sc1
    s_add_u32 s85, s85, 1
    s_cmp_gt_u32 s85, 400000
    s_cbranch_scc1 L_end
    s_waitcnt vmcnt(0)
    v_cmp_eq_u32_e64 vcc, -1, v46
    s_cbranch_vccnz Lspin_39
    v_cvt_pk_bf16_f32 v47, v24, v24
    v_and_b32 v47, 0xffff0000, v47
    v_mul_f32 v47, 0xbfb8aa3b, v47
    v_exp_f32 v47, v47
    s_nop 0
    v_add_f32 v47, 1.0, v47
    v_rcp_f32_e64 v47, v47
    s_nop 0
    v_cvt_pk_bf16_f32 v47, v47, v47
    v_and_b32 v47, 0xffff0000, v47
    v_lshl_add_u32 v13, v8, 10, v10
    s_lshr_b32 s78, s83, 3
    s_mul_i32 s78, s78, 57344
    s_and_b32 s79, s83, 7
    s_lshl_b32 s79, s79, 7
    s_add_u32 s78, s78, s79
    s_add_u32 s78, s78, 1114112
    s_and_b32 s80, s97, 0x7ff
    s_lshl_b32 s80, s80, 11
    s_lshl_b32 s79, s83, 6
    s_add_u32 s80, s80, s79
    s_sleep 30
    s_mov_b32 s85, 0
Lspin_40:
    s_add_u32 s79, s78, 0
    buffer_load_dwordx4 v[16:19], v13, s[36:39], s79 offen sc1
    s_add_u32 s79, s78, 8192
    buffer_load_dwordx4 v[20:23], v13, s[36:39], s79 offen sc1
    s_add_u32 s79, s78, 16384
    buffer_load_dwordx4 v[24:27], v13, s[36:39], s79 offen sc1
    s_add_u32 s79, s78, 24576
    buffer_load_dwordx4 v[28:31], v13, s[36:39], s79 offen sc1
    s_add_u32 s79, s78, 32768
    buffer_load_dwordx4 v[32:35], v13, s[36:39], s79 offen sc1
    s_add_u32 s79, s78, 40960
    buffer_load_dwordx4 v[36:39], v13, s[36:39], s79 offen sc1
    s_add_u32 s79, s78, 49152
    buffer_load_dwordx4 v[40:43], v13, s[36:39], s79 offen sc1
    s_add_u32 s85, s85, 1
    s_cmp_gt_u32 s85, 400000
    s_cbranch_scc1 L_end
    s_waitcnt vmcnt(0)
    v_max_u32 v48, v16, v17
    v_max_u32_e64 v49, v18, v19
    v_max3_u32 v48, v48, v20, v21
    v_max3_u32 v49, v49, v22, v23
    v_max3_u32 v48, v48, v24, v25
    v_max3_u32 v49, v49, v26, v27
    v_max3_u32 v48, v48, v28, v29
    v_max3_u32 v49, v49, v30, v31
    v_max3_u32 v48, v48, v32, v33
    v_max3_u32 v49, v49, v34, v35
    v_max3_u32 v48, v48, v36, v37
    v_max3_u32 v49, v49, v38, v39
    v_max3_u32 v48, v48, v40, v41
    v_max3_u32 v49, v49, v42, v43
    v_max_u32 v48, v48, v49
    v_cmp_eq_u32_e64 vcc, -1, v48
    s_cbranch_vccnz Lspin_40
    v_pk_add_f32 v[16:17], v[16:17], v[20:21]
    v_pk_add_f32 v[24:25], v[24:25], v[28:29]
    v_pk_add_f32 v[32:33], v[32:33], v[36:37]
    v_pk_add_f32 v[16:17], v[16:17], v[24:25]
    v_pk_add_f32 v[32:33], v[32:33], v[40:41]
    v_pk_add_f32 v[16:17], v[16:17], v[32:33]
    v_pk_add_f32 v[18:19], v[18:19], v[22:23]
    v_pk_add_f32 v[26:27], v[26:27], v[30:31]
    v_pk_add_f32 v[34:35], v[34:35], v[38:39]
    v_pk_add_f32 v[18:19], v[18:19], v[26:27]
    v_pk_add_f32 v[34:35], v[34:35], v[42:43]
    v_pk_add_f32 v[18:19], v[18:19], v[34:35]
    s_nop 1
    v_permlane32_swap_b32 v16, v18
    v_permlane32_swap_b32_e64 v17, v19
    v_pk_add_f32 v[16:17], v[16:17], v[18:19]
    s_nop 1
    v_permlane16_swap_b32 v16, v17
    v_add_f32 v16, v16, v17
    s_nop 1
    v_add_f32_dpp v16, v16, v16 row_ror:8 row_mask:0xf bank_mask:0xf
    v_cvt_pk_bf16_f32 v16, v16, v16
    v_and_b32 v16, 0xffff0000, v16
    v_mul_f32_e64 v16, v16, v47
    v_cvt_pk_bf16_f32 v16, v16, v16
    v_and_b32 v16, 0xffff0000, v16
    v_add_f32_e64 v16, v16, v46
    v_cvt_pk_bf16_f32 v16, v16, v16
    s_mov_b32 exec_lo, 0x00ff00ff
    s_mov_b32 exec_hi, 0x00ff00ff
    buffer_store_short v16, v14, s[44:47], s80 offen
    s_mov_b64 exec, -1
    s_cmp_lg_u32 s0, 224
    s_cbranch_scc1 Lep_41
    s_cmp_lg_u32 s76, 0
    s_cbranch_scc1 Lep_41
    v_mov_b32 v196, s75
    v_mov_b32_e64 v197, 0
    s_mov_b64 exec, 1
    buffer_store_dword v196, v197, s[36:39], 0 offen sc1
    s_mov_b64 exec, -1
Lep_41:
    s_branch L_fin
L_pad4:
    s_cbranch_execz L_pad8
    s_endpgm
Lspin_18:
    buffer_load_dwordx2 v[10:11], v8, s[36:39], 0 offen sc1
    s_add_u32 s85, s85, 1
    s_cmp_gt_u32 s85, 400000
    s_cbranch_scc1 L_end
    s_waitcnt vmcnt(0)
    s_branch Lpk_17
Lls_19:
    buffer_store_dwordx4 v[12:15], v62, s[36:39], s78 offen sc1
    s_nop 1
    s_branch Lle_20
Lls_21:
    buffer_store_dwordx4 v[28:31], v63, s[36:39], s78 offen sc1
    s_nop 1
    s_branch Lle_22
Lls_23:
    buffer_store_dwordx4 v[44:47], v2, s[36:39], s79 offen sc1
    s_nop 1
    s_branch Lle_24
Lls_26:
    buffer_store_dword v36, v57, s[36:39], s81 offen sc1
    s_nop 1
    s_branch Lle_27
Lls_29:
    buffer_store_dwordx4 v[56:59], v4, s[36:39], s78 offen sc1
    s_nop 1
    s_branch Lle_30
Lspin_34:
    buffer_load_dwordx4 v[20:23], v27, s[36:39], s78 offen sc1
    s_add_u32 s85, s85, 1
    s_cmp_gt_u32 s85, 400000
    s_cbranch_scc1 L_end
    s_branch Lb_35
Lls_36:
    buffer_store_dwordx2 v[44:45], v15, s[36:39], s80 offen sc1
    s_nop 1
    s_branch Lle_37
L_padret:
    s_setpc_b64 s[12:13]
    .p2align 3
L_M:
    s_getpc_b64 s[90:91]
L_mpc:
    s_sub_u32 s90, s90, L_mpc-L_sube
    s_subb_u32 s91, s91, 0
    s_lshr_b32 s78, s2, 3
    s_lshl_b32 s78, s78, 10
    s_lshl_b32 s79, s76, 8
    s_add_u32 s78, s78, s79
    s_min_u32 s78, s78, (L_end-L_sube)
    v_lshl_add_u32 v119, v2, 2, s78
    global_load_dword v119, v119, s[90:91]
    s_setprio 1
    s_and_b32 s78, s2, 7
    s_lshr_b32 s79, s2, 3
    s_lshl_b32 s71, s78, 1
    s_and_b32 s72, s79, 1
    s_add_u32 s71, s71, s72
    s_lshr_b32 s72, s79, 1
    s_cmp_gt_u32 s70, 3
    s_cselect_b32 s78, 1, 0
    s_cmp_gt_u32 s70, 11
    s_cselect_b32 s78, 2, s78
    s_sub_u32 s78, s70, s78
    s_cmp_eq_u32 s70, 3
    s_cselect_b32 s78, 14, s78
    s_cmp_eq_u32 s70, 11
    s_cselect_b32 s78, 15, s78
    s_lshl_b32 s0, s78, 4
    s_add_u32 s0, s0, s69
    s_lshr_b32 s73, s0, 2
    s_and_b32 s74, s0, 3
    s_lshl_b32 s77, s70, 4
    s_add_u32 s77, s77, s69
    s_and_b32 s80, s76, 1
    s_lshr_b32 s81, s76, 1
    v_and_b32 v8, 15, v2
    v_lshrrev_b32 v9, 4, v2
    v_lshrrev_b32 v10, 1, v8
    s_lshl_b32 s78, s80, 13
    s_add_u32 s78, s78, 118784
    v_lshlrev_b32 v11, 7, v8
    v_add_u32 v11, s78, v11
    v_add_u32 v12, 0, v9
    v_xor_b32 v12, v12, v10
    v_lshl_add_u32 v4, v12, 4, v11
    v_add_u32 v12, 4, v9
    v_xor_b32 v12, v12, v10
    v_lshl_add_u32 v5, v12, 4, v11
    v_bfe_u32 v10, v2, 2, 2
    v_and_b32_e64 v11, 3, v2
    v_lshl_add_u32 v12, v9, 3, v10
    v_lshlrev_b32_e64 v12, 7, v12
    v_lshl_add_u32 v12, v11, 3, v12
    v_add_u32 v12, 135168, v12
    v_lshrrev_b32 v13, 1, v10
    v_and_b32 v14, 1, v9
    v_lshl_add_u32 v13, v14, 1, v13
    s_lshl_b32 s78, s81, 1
    s_add_u32 s79, s78, 0
    v_xor_b32_e64 v14, s79, v13
    v_lshl_add_u32 v6, v14, 5, v12
    s_add_u32 s79, s78, 1
    v_xor_b32 v14, s79, v13
    v_lshl_add_u32 v7, v14, 5, v12
    v_lshrrev_b32_e64 v13, 5, v2
    v_lshl_add_u32 v13, v13, 3, v10
    v_lshlrev_b32 v13, 6, v13
    v_and_b32 v14, 1, v9
    v_lshl_add_u32 v13, v14, 5, v13
    v_lshl_add_u32 v13, v11, 3, v13
    s_lshl_b32 s78, s81, 11
    s_add_u32 s78, s78, 159744
    v_add_u32 v15, s78, v13
    v_mov_b64 v[128:129], 0
    v_mov_b64 v[130:131], 0
    v_mov_b64 v[132:133], 0
    v_mov_b64 v[134:135], 0
    v_mov_b64 v[136:137], 0
    v_mov_b64 v[138:139], 0
    v_mov_b64 v[140:141], 0
    v_mov_b64 v[142:143], 0
    v_mov_b64 v[144:145], 0
    v_mov_b64 v[146:147], 0
    v_mov_b64 v[148:149], 0
    v_mov_b64 v[150:151], 0
    v_mov_b64 v[152:153], 0
    v_mov_b64 v[154:155], 0
    v_mov_b64 v[156:157], 0
    v_mov_b64 v[158:159], 0
    v_mov_b64 v[160:161], 0
    v_mov_b64 v[162:163], 0
L_pad5:
    s_cbranch_execz L_pad9
    v_mov_b64 v[164:165], 0
    v_mov_b64 v[166:167], 0
    v_mov_b64 v[168:169], 0
    v_mov_b64 v[170:171], 0
    v_mov_b64 v[172:173], 0
    v_mov_b64 v[174:175], 0
    v_mov_b64 v[176:177], 0
    v_mov_b64 v[178:179], 0
    v_mov_b64 v[180:181], 0
    v_mov_b64 v[182:183], 0
    v_mov_b64 v[184:185], 0
    v_mov_b64 v[186:187], 0
    v_mov_b64 v[188:189], 0
    v_mov_b64 v[190:191], 0
    v_mov_b64 v[192:193], 0
    v_mov_b64 v[194:195], 0
    v_mov_b64 v[196:197], 0
    v_mov_b64 v[198:199], 0
    v_mov_b64 v[200:201], 0
    v_mov_b64 v[202:203], 0
    v_mov_b64 v[204:205], 0
    v_mov_b64 v[206:207], 0
    v_mov_b64 v[208:209], 0
    v_mov_b64 v[210:211], 0
    v_mov_b64 v[212:213], 0
    v_mov_b64 v[214:215], 0
    v_mov_b64 v[216:217], 0
    v_mov_b64 v[218:219], 0
    v_mov_b64 v[220:221], 0
    v_mov_b64 v[222:223], 0
    v_mov_b64 v[104:105], 0
    v_mov_b64 v[106:107], 0
    v_mov_b64 v[108:109], 0
    v_mov_b64 v[110:111], 0
    v_and_b32 v14, 31, v2
    v_lshrrev_b32 v13, 5, v2
    s_lshl_b32 s78, s81, 14
    s_lshl_b32 s79, s80, 13
    s_add_u32 s78, s78, s79
    s_add_u32 s78, s78, 110592
    v_lshl_add_u32 v12, v14, 7, s78
    v_and_b32 v14, 7, v14
    v_xor_b32 v14, v14, v13
    v_xor_b32_e64 v13, 0, v14
    v_lshl_add_u32 v112, v13, 4, v12
    v_xor_b32_e64 v13, 2, v14
    v_lshl_add_u32 v113, v13, 4, v12
    v_xor_b32_e64 v13, 4, v14
    v_lshl_add_u32 v114, v13, 4, v12
    v_xor_b32_e64 v13, 6, v14
    v_lshl_add_u32 v115, v13, 4, v12
    s_add_u32 s79, s79, 143360
    v_lshl_add_u32 v12, v8, 7, s79
    s_lshl_b32 s78, s81, 2
    v_add_u32 v14, s78, v9
    v_and_b32 v13, 7, v8
    v_xor_b32 v14, v14, v13
    v_lshl_add_u32 v116, v14, 4, v12
    s_lshl_b32 s78, s80, 6
    v_add_u32 v10, s78, v8
    v_lshlrev_b32_e64 v11, 3, v10
    v_add_u32 v11, 159744, v11
    s_lshl_b32 s79, s81, 5
    v_add_u32 v12, s79, v8
    v_lshlrev_b32_e64 v12, 3, v12
    v_add_u32 v12, 160768, v12
    v_lshlrev_b32_e64 v13, 2, v10
    v_add_u32 v13, 162304, v13
    v_and_b32 v14, 31, v2
    v_add_u32 v14, s78, v14
    v_lshlrev_b32_e64 v14, 2, v14
    v_add_u32 v14, 162304, v14
    s_waitcnt lgkmcnt(0)
    s_load_dword s75, s[26:27], 0
    s_getpc_b64 s[12:13]
Lpr_42:
    s_add_u32 s12, s12, L_end-Lpr_42
    s_addc_u32 s13, s13, 0
    s_mov_b32 s36, s26
    s_and_b32 s37, s27, 0xffff
    s_mov_b32 s38, 0x10000000
    s_mov_b32 s39, 0x20000
    s_mov_b32 s64, s14
    s_and_b32 s65, s15, 0xffff
    s_mov_b32 s66, 0x800
    s_mov_b32 s67, 0x20000
    s_mov_b32 s44, s22
    s_and_b32 s45, s23, 0xffff
    s_mov_b32 s46, 0x400000
    s_mov_b32 s47, 0x20000
    s_lshl_b32 s78, s72, 7
    buffer_load_dword v118, off, s[64:67], s78
    s_waitcnt lgkmcnt(0)
    s_mul_i32 s75, s75, 0x9E3779B1
    s_add_u32 s75, s75, 0x7F4A7C15
    s_mov_b32 s84, 0
    s_mov_b32 s82, 2
    s_mov_b32 s83, 0xfffec000
    s_barrier
    s_nop 0
    ds_read_b128 v[16:19], v4 offset:0
    ds_read_b128 v[20:23], v5 offset:0
    ds_read_b128 v[24:27], v4 offset:2048
    ds_read_b128 v[28:31], v5 offset:2048
    ds_read_b128 v[32:35], v4 offset:4096
    ds_read_b128 v[36:39], v5 offset:4096
    ds_read_b128 v[40:43], v4 offset:6144
    ds_read_b128 v[44:47], v5 offset:6144
    ds_read_b64_tr_b16 v[88:89], v6 offset:8192
    ds_read_b64_tr_b16 v[90:91], v6 offset:8704
    ds_read_b64_tr_b16 v[92:93], v6 offset:12288
    ds_read_b64_tr_b16 v[94:95], v6 offset:12800
    ds_read_b64_tr_b16 v[224:225], v7 offset:8192
    ds_read_b64_tr_b16 v[226:227], v7 offset:8704
    ds_read_b64_tr_b16 v[228:229], v7 offset:12288
    ds_read_b64_tr_b16 v[230:231], v7 offset:12800
    ds_read_b64_tr_b16 v[232:233], v6 offset:16384
    ds_read_b64_tr_b16 v[234:235], v6 offset:16896
    ds_read_b64_tr_b16 v[236:237], v6 offset:20480
    ds_read_b64_tr_b16 v[238:239], v6 offset:20992
    ds_read_b64_tr_b16 v[96:97], v15 offset:0
    ds_read_b64_tr_b16 v[98:99], v15 offset:1024
    ds_read_b64_tr_b16 v[100:101], v15 offset:256
    ds_read_b64_tr_b16 v[102:103], v15 offset:1280
    s_waitcnt lgkmcnt(0)
    s_nop 0
    v_mfma_f32_16x16x32_bf16 v[160:163], v[88:91], v[16:19], v[160:163]
    v_mfma_f32_16x16x32_bf16 v[160:163], v[92:95], v[20:23], v[160:163]
    v_mfma_f32_16x16x32_bf16 v[164:167], v[92:95], v[28:31], v[164:167]
    v_mfma_f32_16x16x32_bf16 v[164:167], v[88:91], v[24:27], v[164:167]
    v_mfma_f32_16x16x32_bf16 v[168:171], v[88:91], v[32:35], v[168:171]
    v_mfma_f32_16x16x32_bf16 v[168:171], v[92:95], v[36:39], v[168:171]
    v_mfma_f32_16x16x32_bf16 v[172:175], v[92:95], v[44:47], v[172:175]
    v_mfma_f32_16x16x32_bf16 v[172:175], v[88:91], v[40:43], v[172:175]
    v_mfma_f32_16x16x32_bf16 v[188:191], v[224:227], v[40:43], v[188:191]
    v_mfma_f32_16x16x32_bf16 v[188:191], v[228:231], v[44:47], v[188:191]
    v_mfma_f32_16x16x32_bf16 v[184:187], v[228:231], v[36:39], v[184:187]
    v_mfma_f32_16x16x32_bf16 v[184:187], v[224:227], v[32:35], v[184:187]
    v_mfma_f32_16x16x32_bf16 v[180:183], v[224:227], v[24:27], v[180:183]
    v_mfma_f32_16x16x32_bf16 v[180:183], v[228:231], v[28:31], v[180:183]
    v_mfma_f32_16x16x32_bf16 v[176:179], v[228:231], v[20:23], v[176:179]
    v_mfma_f32_16x16x32_bf16 v[176:179], v[224:227], v[16:19], v[176:179]
    v_mfma_f32_16x16x32_bf16 v[192:195], v[232:235], v[16:19], v[192:195]
    v_mfma_f32_16x16x32_bf16 v[192:195], v[236:239], v[20:23], v[192:195]
    v_mfma_f32_16x16x32_bf16 v[196:199], v[236:239], v[28:31], v[196:199]
    v_mfma_f32_16x16x32_bf16 v[196:199], v[232:235], v[24:27], v[196:199]
    v_mfma_f32_16x16x32_bf16 v[200:203], v[232:235], v[32:35], v[200:203]
    v_mfma_f32_16x16x32_bf16 v[200:203], v[236:239], v[36:39], v[200:203]
    v_mfma_f32_16x16x32_bf16 v[204:207], v[236:239], v[44:47], v[204:207]
    v_mfma_f32_16x16x32_bf16 v[204:207], v[232:235], v[40:43], v[204:207]
    ds_read_b64_tr_b16 v[80:81], v7 offset:16384
    ds_read_b64_tr_b16 v[82:83], v7 offset:16896
    ds_read_b64_tr_b16 v[84:85], v7 offset:20480
    ds_read_b64_tr_b16 v[86:87], v7 offset:20992
    ds_read_b64_tr_b16 v[88:89], v6 offset:0
    ds_read_b64_tr_b16 v[90:91], v6 offset:512
    ds_read_b64_tr_b16 v[92:93], v6 offset:4096
    ds_read_b64_tr_b16 v[94:95], v6 offset:4608
    ds_read_b64_tr_b16 v[224:225], v7 offset:0
    ds_read_b64_tr_b16 v[226:227], v7 offset:512
    ds_read_b64_tr_b16 v[228:229], v7 offset:4096
    ds_read_b64_tr_b16 v[230:231], v7 offset:4608
    s_add_u32 s84, s84, 1
    s_cmp_eq_u32 s82, 2
    s_cselect_b32 s78, s83, 40960
    s_cselect_b32 s82, -1, s82
    s_add_u32 s82, s82, 1
    v_add_u32 v4, s78, v4
    v_add_u32 v5, s78, v5
    v_add_u32 v6, s78, v6
    v_add_u32_e64 v7, s78, v7
    s_waitcnt vmcnt(0) lgkmcnt(0)
    v_mfma_f32_16x16x32_bf16 v[220:223], v[80:83], v[40:43], v[220:223]
    v_mfma_f32_16x16x32_bf16 v[220:223], v[84:87], v[44:47], v[220:223]
    v_mfma_f32_16x16x32_bf16 v[216:219], v[84:87], v[36:39], v[216:219]
    v_mfma_f32_16x16x32_bf16 v[216:219], v[80:83], v[32:35], v[216:219]
    v_mfma_f32_16x16x32_bf16 v[212:215], v[80:83], v[24:27], v[212:215]
    v_mfma_f32_16x16x32_bf16 v[212:215], v[84:87], v[28:31], v[212:215]
    v_mfma_f32_16x16x32_bf16 v[208:211], v[84:87], v[20:23], v[208:211]
    v_mfma_f32_16x16x32_bf16 v[208:211], v[80:83], v[16:19], v[208:211]
    v_mfma_f32_16x16x32_bf16 v[128:131], v[88:91], v[16:19], v[128:131]
    v_mfma_f32_16x16x32_bf16 v[128:131], v[92:95], v[20:23], v[128:131]
    v_mfma_f32_16x16x32_bf16 v[132:135], v[92:95], v[28:31], v[132:135]
    v_mfma_f32_16x16x32_bf16 v[132:135], v[88:91], v[24:27], v[132:135]
    v_mfma_f32_16x16x32_bf16 v[136:139], v[88:91], v[32:35], v[136:139]
    v_mfma_f32_16x16x32_bf16 v[136:139], v[92:95], v[36:39], v[136:139]
    v_mfma_f32_16x16x32_bf16 v[140:143], v[92:95], v[44:47], v[140:143]
    v_mfma_f32_16x16x32_bf16 v[140:143], v[88:91], v[40:43], v[140:143]
    v_mfma_f32_16x16x32_bf16 v[156:159], v[224:227], v[40:43], v[156:159]
    v_mfma_f32_16x16x32_bf16 v[156:159], v[228:231], v[44:47], v[156:159]
    v_mfma_f32_16x16x32_bf16 v[152:155], v[228:231], v[36:39], v[152:155]
    v_mfma_f32_16x16x32_bf16 v[152:155], v[224:227], v[32:35], v[152:155]
    v_mfma_f32_16x16x32_bf16 v[148:151], v[224:227], v[24:27], v[148:151]
    v_mfma_f32_16x16x32_bf16 v[148:151], v[228:231], v[28:31], v[148:151]
    v_mfma_f32_16x16x32_bf16 v[144:147], v[228:231], v[20:23], v[144:147]
    v_mfma_f32_16x16x32_bf16 v[144:147], v[224:227], v[16:19], v[144:147]
    s_barrier
    s_nop 0
    ds_read_b128 v[48:51], v4 offset:0
    ds_read_b128 v[52:55], v5 offset:0
    ds_read_b128 v[56:59], v4 offset:2048
    ds_read_b128 v[60:63], v5 offset:2048
    ds_read_b128 v[64:67], v4 offset:4096
    ds_read_b128 v[68:71], v5 offset:4096
    ds_read_b128 v[72:75], v4 offset:6144
    ds_read_b128 v[76:79], v5 offset:6144
    ds_read_b64_tr_b16 v[232:233], v6 offset:8192
    ds_read_b64_tr_b16 v[234:235], v6 offset:8704
    ds_read_b64_tr_b16 v[236:237], v6 offset:12288
    ds_read_b64_tr_b16 v[238:239], v6 offset:12800
    ds_read_b64_tr_b16 v[80:81], v7 offset:8192
    ds_read_b64_tr_b16 v[82:83], v7 offset:8704
    ds_read_b64_tr_b16 v[84:85], v7 offset:12288
    ds_read_b64_tr_b16 v[86:87], v7 offset:12800
    ds_read_b64_tr_b16 v[88:89], v6 offset:16384
    ds_read_b64_tr_b16 v[90:91], v6 offset:16896
    ds_read_b64_tr_b16 v[92:93], v6 offset:20480
    ds_read_b64_tr_b16 v[94:95], v6 offset:20992
    s_waitcnt lgkmcnt(0)
    s_nop 0
    v_mfma_f32_16x16x32_bf16 v[160:163], v[232:235], v[48:51], v[160:163]
    v_mfma_f32_16x16x32_bf16 v[160:163], v[236:239], v[52:55], v[160:163]
    v_mfma_f32_16x16x32_bf16 v[164:167], v[236:239], v[60:63], v[164:167]
    v_mfma_f32_16x16x32_bf16 v[164:167], v[232:235], v[56:59], v[164:167]
    v_mfma_f32_16x16x32_bf16 v[168:171], v[232:235], v[64:67], v[168:171]
    v_mfma_f32_16x16x32_bf16 v[168:171], v[236:239], v[68:71], v[168:171]
    v_mfma_f32_16x16x32_bf16 v[172:175], v[236:239], v[76:79], v[172:175]
    v_mfma_f32_16x16x32_bf16 v[172:175], v[232:235], v[72:75], v[172:175]
    v_mfma_f32_16x16x32_bf16 v[188:191], v[80:83], v[72:75], v[188:191]
    v_mfma_f32_16x16x32_bf16 v[188:191], v[84:87], v[76:79], v[188:191]
    v_mfma_f32_16x16x32_bf16 v[184:187], v[84:87], v[68:71], v[184:187]
    v_mfma_f32_16x16x32_bf16 v[184:187], v[80:83], v[64:67], v[184:187]
    v_mfma_f32_16x16x32_bf16 v[180:183], v[80:83], v[56:59], v[180:183]
    v_mfma_f32_16x16x32_bf16 v[180:183], v[84:87], v[60:63], v[180:183]
    v_mfma_f32_16x16x32_bf16 v[176:179], v[84:87], v[52:55], v[176:179]
    v_mfma_f32_16x16x32_bf16 v[176:179], v[80:83], v[48:51], v[176:179]
    v_mfma_f32_16x16x32_bf16 v[192:195], v[88:91], v[48:51], v[192:195]
    v_mfma_f32_16x16x32_bf16 v[192:195], v[92:95], v[52:55], v[192:195]
    v_mfma_f32_16x16x32_bf16 v[196:199], v[92:95], v[60:63], v[196:199]
    v_mfma_f32_16x16x32_bf16 v[196:199], v[88:91], v[56:59], v[196:199]
    v_mfma_f32_16x16x32_bf16 v[200:203], v[88:91], v[64:67], v[200:203]
    v_mfma_f32_16x16x32_bf16 v[200:203], v[92:95], v[68:71], v[200:203]
    v_mfma_f32_16x16x32_bf16 v[204:207], v[92:95], v[76:79], v[204:207]
    v_mfma_f32_16x16x32_bf16 v[204:207], v[88:91], v[72:75], v[204:207]
    ds_read_b64_tr_b16 v[224:225], v7 offset:16384
    ds_read_b64_tr_b16 v[226:227], v7 offset:16896
    ds_read_b64_tr_b16 v[228:229], v7 offset:20480
    ds_read_b64_tr_b16 v[230:231], v7 offset:20992
    ds_read_b64_tr_b16 v[232:233], v6 offset:0
    ds_read_b64_tr_b16 v[234:235], v6 offset:512
    ds_read_b64_tr_b16 v[236:237], v6 offset:4096
    ds_read_b64_tr_b16 v[238:239], v6 offset:4608
    ds_read_b64_tr_b16 v[80:81], v7 offset:0
    ds_read_b64_tr_b16 v[82:83], v7 offset:512
    ds_read_b64_tr_b16 v[84:85], v7 offset:4096
    ds_read_b64_tr_b16 v[86:87], v7 offset:4608
    s_add_u32 s84, s84, 1
    s_cmp_eq_u32 s82, 2
    s_cselect_b32 s78, s83, 40960
    s_cselect_b32 s82, -1, s82
    s_add_u32 s82, s82, 1
    v_add_u32 v4, s78, v4
    v_add_u32 v5, s78, v5
    v_add_u32 v6, s78, v6
    v_add_u32_e64 v7, s78, v7
    s_waitcnt vmcnt(0) lgkmcnt(0)
    v_mfma_f32_16x16x32_bf16 v[220:223], v[224:227], v[72:75], v[220:223]
    v_mfma_f32_16x16x32_bf16 v[220:223], v[228:231], v[76:79], v[220:223]
    v_mfma_f32_16x16x32_bf16 v[216:219], v[228:231], v[68:71], v[216:219]
    v_mfma_f32_16x16x32_bf16 v[216:219], v[224:227], v[64:67], v[216:219]
    v_mfma_f32_16x16x32_bf16 v[212:215], v[224:227], v[56:59], v[212:215]
    v_mfma_f32_16x16x32_bf16 v[212:215], v[228:231], v[60:63], v[212:215]
    v_mfma_f32_16x16x32_bf16 v[208:211], v[228:231], v[52:55], v[208:211]
    v_mfma_f32_16x16x32_bf16 v[208:211], v[224:227], v[48:51], v[208:211]
    v_mfma_f32_16x16x32_bf16 v[128:131], v[232:235], v[48:51], v[128:131]
    v_mfma_f32_16x16x32_bf16 v[128:131], v[236:239], v[52:55], v[128:131]
    v_mfma_f32_16x16x32_bf16 v[132:135], v[236:239], v[60:63], v[132:135]
    v_mfma_f32_16x16x32_bf16 v[132:135], v[232:235], v[56:59], v[132:135]
    v_mfma_f32_16x16x32_bf16 v[136:139], v[232:235], v[64:67], v[136:139]
    v_mfma_f32_16x16x32_bf16 v[136:139], v[236:239], v[68:71], v[136:139]
    v_mfma_f32_16x16x32_bf16 v[140:143], v[236:239], v[76:79], v[140:143]
    v_mfma_f32_16x16x32_bf16 v[140:143], v[232:235], v[72:75], v[140:143]
    v_mfma_f32_16x16x32_bf16 v[156:159], v[80:83], v[72:75], v[156:159]
    v_mfma_f32_16x16x32_bf16 v[156:159], v[84:87], v[76:79], v[156:159]
    v_mfma_f32_16x16x32_bf16 v[152:155], v[84:87], v[68:71], v[152:155]
    v_mfma_f32_16x16x32_bf16 v[152:155], v[80:83], v[64:67], v[152:155]
    v_mfma_f32_16x16x32_bf16 v[148:151], v[80:83], v[56:59], v[148:151]
    v_mfma_f32_16x16x32_bf16 v[148:151], v[84:87], v[60:63], v[148:151]
    v_mfma_f32_16x16x32_bf16 v[144:147], v[84:87], v[52:55], v[144:147]
    v_mfma_f32_16x16x32_bf16 v[144:147], v[80:83], v[48:51], v[144:147]
    s_mov_b64 exec, 0
    s_cmp_lg_u32 s76, 0
    s_cbranch_scc1 Lt_43
    s_call_b64 s[12:13], L_pad0
Lt_43:
    s_cmp_lg_u32 s76, 1
    s_cbranch_scc1 Lt_44
    s_call_b64 s[12:13], L_pad1
Lt_44:
    s_cmp_lg_u32 s76, 2
    s_cbranch_scc1 Lt_45
    s_call_b64 s[12:13], L_pad2
Lt_45:
    s_cmp_lg_u32 s76, 3
    s_cbranch_scc1 Lt_46
    s_call_b64 s[12:13], L_pad3
Lt_46:
    s_mov_b64 exec, -1
    s_barrier
    s_nop 0
    ds_read_b128 v[16:19], v4 offset:0
L_pad6:
    s_cbranch_execz L_pad10
    s_nop 0
    ds_read_b128 v[20:23], v5 offset:0
    ds_read_b128 v[24:27], v4 offset:2048
    ds_read_b128 v[28:31], v5 offset:2048
    ds_read_b128 v[32:35], v4 offset:4096
    ds_read_b128 v[36:39], v5 offset:4096
    ds_read_b128 v[40:43], v4 offset:6144
    ds_read_b128 v[44:47], v5 offset:6144
    ds_read_b64_tr_b16 v[88:89], v6 offset:8192
    ds_read_b64_tr_b16 v[90:91], v6 offset:8704
    ds_read_b64_tr_b16 v[92:93], v6 offset:12288
    ds_read_b64_tr_b16 v[94:95], v6 offset:12800
    ds_read_b64_tr_b16 v[224:225], v7 offset:8192
    ds_read_b64_tr_b16 v[226:227], v7 offset:8704
    ds_read_b64_tr_b16 v[228:229], v7 offset:12288
    ds_read_b64_tr_b16 v[230:231], v7 offset:12800
    ds_read_b64_tr_b16 v[232:233], v6 offset:16384
    ds_read_b64_tr_b16 v[234:235], v6 offset:16896
    ds_read_b64_tr_b16 v[236:237], v6 offset:20480
    ds_read_b64_tr_b16 v[238:239], v6 offset:20992
    s_waitcnt lgkmcnt(0)
    s_nop 0
    v_mfma_f32_16x16x32_bf16 v[160:163], v[88:91], v[16:19], v[160:163]
    v_mfma_f32_16x16x32_bf16 v[160:163], v[92:95], v[20:23], v[160:163]
    v_mfma_f32_16x16x32_bf16 v[164:167], v[92:95], v[28:31], v[164:167]
    v_mfma_f32_16x16x32_bf16 v[164:167], v[88:91], v[24:27], v[164:167]
    v_mfma_f32_16x16x32_bf16 v[168:171], v[88:91], v[32:35], v[168:171]
    v_mfma_f32_16x16x32_bf16 v[168:171], v[92:95], v[36:39], v[168:171]
    v_mfma_f32_16x16x32_bf16 v[172:175], v[92:95], v[44:47], v[172:175]
    v_mfma_f32_16x16x32_bf16 v[172:175], v[88:91], v[40:43], v[172:175]
    v_mfma_f32_16x16x32_bf16 v[188:191], v[224:227], v[40:43], v[188:191]
    v_mfma_f32_16x16x32_bf16 v[188:191], v[228:231], v[44:47], v[188:191]
    v_mfma_f32_16x16x32_bf16 v[184:187], v[228:231], v[36:39], v[184:187]
    v_mfma_f32_16x16x32_bf16 v[184:187], v[224:227], v[32:35], v[184:187]
    v_mfma_f32_16x16x32_bf16 v[180:183], v[224:227], v[24:27], v[180:183]
    v_mfma_f32_16x16x32_bf16 v[180:183], v[228:231], v[28:31], v[180:183]
    v_mfma_f32_16x16x32_bf16 v[176:179], v[228:231], v[20:23], v[176:179]
    v_mfma_f32_16x16x32_bf16 v[176:179], v[224:227], v[16:19], v[176:179]
    v_mfma_f32_16x16x32_bf16 v[192:195], v[232:235], v[16:19], v[192:195]
    v_mfma_f32_16x16x32_bf16 v[192:195], v[236:239], v[20:23], v[192:195]
    v_mfma_f32_16x16x32_bf16 v[196:199], v[236:239], v[28:31], v[196:199]
    v_mfma_f32_16x16x32_bf16 v[196:199], v[232:235], v[24:27], v[196:199]
    v_mfma_f32_16x16x32_bf16 v[200:203], v[232:235], v[32:35], v[200:203]
    v_mfma_f32_16x16x32_bf16 v[200:203], v[236:239], v[36:39], v[200:203]
    v_mfma_f32_16x16x32_bf16 v[204:207], v[236:239], v[44:47], v[204:207]
    v_mfma_f32_16x16x32_bf16 v[204:207], v[232:235], v[40:43], v[204:207]
    ds_read_b64_tr_b16 v[80:81], v7 offset:16384
    ds_read_b64_tr_b16 v[82:83], v7 offset:16896
    ds_read_b64_tr_b16 v[84:85], v7 offset:20480
    ds_read_b64_tr_b16 v[86:87], v7 offset:20992
    ds_read_b64_tr_b16 v[88:89], v6 offset:0
    ds_read_b64_tr_b16 v[90:91], v6 offset:512
    ds_read_b64_tr_b16 v[92:93], v6 offset:4096
    ds_read_b64_tr_b16 v[94:95], v6 offset:4608
    ds_read_b64_tr_b16 v[224:225], v7 offset:0
    ds_read_b64_tr_b16 v[226:227], v7 offset:512
    ds_read_b64_tr_b16 v[228:229], v7 offset:4096
    ds_read_b64_tr_b16 v[230:231], v7 offset:4608
    s_add_u32 s84, s84, 1
    s_cmp_eq_u32 s82, 2
    s_cselect_b32 s78, s83, 40960
    s_cselect_b32 s82, -1, s82
    s_add_u32 s82, s82, 1
    v_add_u32 v4, s78, v4
    v_add_u32 v5, s78, v5
    v_add_u32 v6, s78, v6
    v_add_u32_e64 v7, s78, v7
    s_waitcnt vmcnt(0) lgkmcnt(0)
    v_mfma_f32_16x16x32_bf16 v[220:223], v[80:83], v[40:43], v[220:223]
    v_mfma_f32_16x16x32_bf16 v[220:223], v[84:87], v[44:47], v[220:223]
    v_mfma_f32_16x16x32_bf16 v[216:219], v[84:87], v[36:39], v[216:219]
    v_mfma_f32_16x16x32_bf16 v[216:219], v[80:83], v[32:35], v[216:219]
    v_mfma_f32_16x16x32_bf16 v[212:215], v[80:83], v[24:27], v[212:215]
    v_mfma_f32_16x16x32_bf16 v[212:215], v[84:87], v[28:31], v[212:215]
    v_mfma_f32_16x16x32_bf16 v[208:211], v[84:87], v[20:23], v[208:211]
    v_mfma_f32_16x16x32_bf16 v[208:211], v[80:83], v[16:19], v[208:211]
    v_mfma_f32_16x16x32_bf16 v[128:131], v[88:91], v[16:19], v[128:131]
    v_mfma_f32_16x16x32_bf16 v[128:131], v[92:95], v[20:23], v[128:131]
    v_mfma_f32_16x16x32_bf16 v[132:135], v[92:95], v[28:31], v[132:135]
    v_mfma_f32_16x16x32_bf16 v[132:135], v[88:91], v[24:27], v[132:135]
    v_mfma_f32_16x16x32_bf16 v[136:139], v[88:91], v[32:35], v[136:139]
    v_mfma_f32_16x16x32_bf16 v[136:139], v[92:95], v[36:39], v[136:139]
    v_mfma_f32_16x16x32_bf16 v[140:143], v[92:95], v[44:47], v[140:143]
    v_mfma_f32_16x16x32_bf16 v[140:143], v[88:91], v[40:43], v[140:143]
    v_mfma_f32_16x16x32_bf16 v[156:159], v[224:227], v[40:43], v[156:159]
    v_mfma_f32_16x16x32_bf16 v[156:159], v[228:231], v[44:47], v[156:159]
    v_mfma_f32_16x16x32_bf16 v[152:155], v[228:231], v[36:39], v[152:155]
    v_mfma_f32_16x16x32_bf16 v[152:155], v[224:227], v[32:35], v[152:155]
    v_mfma_f32_16x16x32_bf16 v[148:151], v[224:227], v[24:27], v[148:151]
    v_mfma_f32_16x16x32_bf16 v[148:151], v[228:231], v[28:31], v[148:151]
    v_mfma_f32_16x16x32_bf16 v[144:147], v[228:231], v[20:23], v[144:147]
    v_mfma_f32_16x16x32_bf16 v[144:147], v[224:227], v[16:19], v[144:147]
    s_barrier
    s_nop 0
    ds_read_b128 v[48:51], v4 offset:0
    ds_read_b128 v[52:55], v5 offset:0
    ds_read_b128 v[56:59], v4 offset:2048
    ds_read_b128 v[60:63], v5 offset:2048
    ds_read_b128 v[64:67], v4 offset:4096
    ds_read_b128 v[68:71], v5 offset:4096
    ds_read_b128 v[72:75], v4 offset:6144
    ds_read_b128 v[76:79], v5 offset:6144
    ds_read_b64_tr_b16 v[232:233], v6 offset:8192
    ds_read_b64_tr_b16 v[234:235], v6 offset:8704
    ds_read_b64_tr_b16 v[236:237], v6 offset:12288
    ds_read_b64_tr_b16 v[238:239], v6 offset:12800
    ds_read_b64_tr_b16 v[80:81], v7 offset:8192
    ds_read_b64_tr_b16 v[82:83], v7 offset:8704
    ds_read_b64_tr_b16 v[84:85], v7 offset:12288
    ds_read_b64_tr_b16 v[86:87], v7 offset:12800
    .p2align 3
L_Mloop:
    s_waitcnt lgkmcnt(0)
    s_nop 0
    v_mfma_f32_16x16x32_bf16 v[160:163], v[232:235], v[48:51], v[160:163]
    ds_read_b64_tr_b16 v[88:89], v6 offset:16384
    v_mfma_f32_16x16x32_bf16 v[160:163], v[236:239], v[52:55], v[160:163]
    ds_read_b64_tr_b16 v[90:91], v6 offset:16896
    v_mfma_f32_16x16x32_bf16 v[164:167], v[236:239], v[60:63], v[164:167]
    ds_read_b64_tr_b16 v[92:93], v6 offset:20480
    v_mfma_f32_16x16x32_bf16 v[164:167], v[232:235], v[56:59], v[164:167]
    ds_read_b64_tr_b16 v[94:95], v6 offset:20992
    v_mfma_f32_16x16x32_bf16 v[168:171], v[232:235], v[64:67], v[168:171]
    ds_read_b64_tr_b16 v[224:225], v7 offset:16384
    v_mfma_f32_16x16x32_bf16 v[168:171], v[236:239], v[68:71], v[168:171]
    ds_read_b64_tr_b16 v[226:227], v7 offset:16896
    v_mfma_f32_16x16x32_bf16 v[172:175], v[236:239], v[76:79], v[172:175]
    ds_read_b64_tr_b16 v[228:229], v7 offset:20480
    v_mfma_f32_16x16x32_bf16 v[172:175], v[232:235], v[72:75], v[172:175]
    ds_read_b64_tr_b16 v[230:231], v7 offset:20992
    v_mfma_f32_16x16x32_bf16 v[188:191], v[80:83], v[72:75], v[188:191]
    ds_read_b64_tr_b16 v[232:233], v6 offset:0
    v_mfma_f32_16x16x32_bf16 v[188:191], v[84:87], v[76:79], v[188:191]
    ds_read_b64_tr_b16 v[234:235], v6 offset:512
    v_mfma_f32_16x16x32_bf16 v[184:187], v[84:87], v[68:71], v[184:187]
    ds_read_b64_tr_b16 v[236:237], v6 offset:4096
    v_mfma_f32_16x16x32_bf16 v[184:187], v[80:83], v[64:67], v[184:187]
    ds_read_b64_tr_b16 v[238:239], v6 offset:4608
    v_mfma_f32_16x16x32_bf16 v[180:183], v[80:83], v[56:59], v[180:183]
    v_mfma_f32_16x16x32_bf16 v[180:183], v[84:87], v[60:63], v[180:183]
    v_mfma_f32_16x16x32_bf16 v[176:179], v[84:87], v[52:55], v[176:179]
    v_mfma_f32_16x16x32_bf16 v[176:179], v[80:83], v[48:51], v[176:179]
    s_waitcnt lgkmcnt(4)
    s_nop 0
    v_mfma_f32_16x16x32_bf16 v[192:195], v[88:91], v[48:51], v[192:195]
    ds_read_b64_tr_b16 v[80:81], v7 offset:0
    v_mfma_f32_16x16x32_bf16 v[192:195], v[92:95], v[52:55], v[192:195]
    ds_read_b64_tr_b16 v[82:83], v7 offset:512
    v_mfma_f32_16x16x32_bf16 v[196:199], v[92:95], v[60:63], v[196:199]
    ds_read_b64_tr_b16 v[84:85], v7 offset:4096
    v_mfma_f32_16x16x32_bf16 v[196:199], v[88:91], v[56:59], v[196:199]
    ds_read_b64_tr_b16 v[86:87], v7 offset:4608
    v_mfma_f32_16x16x32_bf16 v[200:203], v[88:91], v[64:67], v[200:203]
    s_add_u32 s84, s84, 1
    s_cmp_eq_u32 s82, 2
    s_cselect_b32 s78, s83, 40960
    s_cselect_b32 s82, -1, s82
    s_add_u32 s82, s82, 1
    v_mfma_f32_16x16x32_bf16 v[200:203], v[92:95], v[68:71], v[200:203]
    v_add_u32 v4, s78, v4
    v_add_u32 v5, s78, v5
    v_mfma_f32_16x16x32_bf16 v[204:207], v[92:95], v[76:79], v[204:207]
    v_add_u32 v6, s78, v6
    v_add_u32 v7, s78, v7
    v_mfma_f32_16x16x32_bf16 v[204:207], v[88:91], v[72:75], v[204:207]
    v_mfma_f32_16x16x32_bf16 v[220:223], v[224:227], v[72:75], v[220:223]
    v_mfma_f32_16x16x32_bf16 v[220:223], v[228:231], v[76:79], v[220:223]
    s_waitcnt lgkmcnt(0)
    v_mfma_f32_16x16x32_bf16 v[216:219], v[228:231], v[68:71], v[216:219]
    v_mfma_f32_16x16x32_bf16 v[216:219], v[224:227], v[64:67], v[216:219]
    s_barrier
    s_cmp_eq_u32 s84, 16
    s_cbranch_scc1 L_Mtail
    v_mfma_f32_16x16x32_bf16 v[212:215], v[224:227], v[56:59], v[212:215]
    ds_read_b128 v[16:19], v4 offset:0
    v_mfma_f32_16x16x32_bf16 v[212:215], v[228:231], v[60:63], v[212:215]
    ds_read_b128 v[20:23], v5 offset:0
    v_mfma_f32_16x16x32_bf16 v[208:211], v[228:231], v[52:55], v[208:211]
    ds_read_b128 v[24:27], v4 offset:2048
    v_mfma_f32_16x16x32_bf16 v[208:211], v[224:227], v[48:51], v[208:211]
    ds_read_b128 v[28:31], v5 offset:2048
    v_mfma_f32_16x16x32_bf16 v[128:131], v[232:235], v[48:51], v[128:131]
    ds_read_b128 v[32:35], v4 offset:4096
    v_mfma_f32_16x16x32_bf16 v[128:131], v[236:239], v[52:55], v[128:131]
    ds_read_b128 v[36:39], v5 offset:4096
    v_mfma_f32_16x16x32_bf16 v[132:135], v[236:239], v[60:63], v[132:135]
    ds_read_b128 v[40:43], v4 offset:6144
    v_mfma_f32_16x16x32_bf16 v[132:135], v[232:235], v[56:59], v[132:135]
    ds_read_b128 v[44:47], v5 offset:6144
    v_mfma_f32_16x16x32_bf16 v[136:139], v[232:235], v[64:67], v[136:139]
    ds_read_b64_tr_b16 v[88:89], v6 offset:8192
    v_mfma_f32_16x16x32_bf16 v[136:139], v[236:239], v[68:71], v[136:139]
    ds_read_b64_tr_b16 v[90:91], v6 offset:8704
    v_mfma_f32_16x16x32_bf16 v[140:143], v[236:239], v[76:79], v[140:143]
    ds_read_b64_tr_b16 v[92:93], v6 offset:12288
    v_mfma_f32_16x16x32_bf16 v[140:143], v[232:235], v[72:75], v[140:143]
    ds_read_b64_tr_b16 v[94:95], v6 offset:12800
    v_mfma_f32_16x16x32_bf16 v[156:159], v[80:83], v[72:75], v[156:159]
    ds_read_b64_tr_b16 v[224:225], v7 offset:8192
    v_mfma_f32_16x16x32_bf16 v[156:159], v[84:87], v[76:79], v[156:159]
    ds_read_b64_tr_b16 v[226:227], v7 offset:8704
    v_mfma_f32_16x16x32_bf16 v[152:155], v[84:87], v[68:71], v[152:155]
    ds_read_b64_tr_b16 v[228:229], v7 offset:12288
    v_mfma_f32_16x16x32_bf16 v[152:155], v[80:83], v[64:67], v[152:155]
    ds_read_b64_tr_b16 v[230:231], v7 offset:12800
    v_mfma_f32_16x16x32_bf16 v[148:151], v[80:83], v[56:59], v[148:151]
    v_mfma_f32_16x16x32_bf16 v[148:151], v[84:87], v[60:63], v[148:151]
    v_mfma_f32_16x16x32_bf16 v[144:147], v[84:87], v[52:55], v[144:147]
    v_mfma_f32_16x16x32_bf16 v[144:147], v[80:83], v[48:51], v[144:147]
    s_waitcnt lgkmcnt(0)
    s_nop 0
    v_mfma_f32_16x16x32_bf16 v[160:163], v[88:91], v[16:19], v[160:163]
    ds_read_b64_tr_b16 v[232:233], v6 offset:16384
    v_mfma_f32_16x16x32_bf16 v[160:163], v[92:95], v[20:23], v[160:163]
    ds_read_b64_tr_b16 v[234:235], v6 offset:16896
    v_mfma_f32_16x16x32_bf16 v[164:167], v[92:95], v[28:31], v[164:167]
    ds_read_b64_tr_b16 v[236:237], v6 offset:20480
    v_mfma_f32_16x16x32_bf16 v[164:167], v[88:91], v[24:27], v[164:167]
    ds_read_b64_tr_b16 v[238:239], v6 offset:20992
    v_mfma_f32_16x16x32_bf16 v[168:171], v[88:91], v[32:35], v[168:171]
    ds_read_b64_tr_b16 v[80:81], v7 offset:16384
    v_mfma_f32_16x16x32_bf16 v[168:171], v[92:95], v[36:39], v[168:171]
    ds_read_b64_tr_b16 v[82:83], v7 offset:16896
    v_mfma_f32_16x16x32_bf16 v[172:175], v[92:95], v[44:47], v[172:175]
    ds_read_b64_tr_b16 v[84:85], v7 offset:20480
    v_mfma_f32_16x16x32_bf16 v[172:175], v[88:91], v[40:43], v[172:175]
    ds_read_b64_tr_b16 v[86:87], v7 offset:20992
    v_mfma_f32_16x16x32_bf16 v[188:191], v[224:227], v[40:43], v[188:191]
    ds_read_b64_tr_b16 v[88:89], v6 offset:0
    v_mfma_f32_16x16x32_bf16 v[188:191], v[228:231], v[44:47], v[188:191]
    ds_read_b64_tr_b16 v[90:91], v6 offset:512
    v_mfma_f32_16x16x32_bf16 v[184:187], v[228:231], v[36:39], v[184:187]
    ds_read_b64_tr_b16 v[92:93], v6 offset:4096
    v_mfma_f32_16x16x32_bf16 v[184:187], v[224:227], v[32:35], v[184:187]
    ds_read_b64_tr_b16 v[94:95], v6 offset:4608
    v_mfma_f32_16x16x32_bf16 v[180:183], v[224:227], v[24:27], v[180:183]
    v_mfma_f32_16x16x32_bf16 v[180:183], v[228:231], v[28:31], v[180:183]
    v_mfma_f32_16x16x32_bf16 v[176:179], v[228:231], v[20:23], v[176:179]
    v_mfma_f32_16x16x32_bf16 v[176:179], v[224:227], v[16:19], v[176:179]
    s_waitcnt lgkmcnt(4)
    s_nop 0
    v_mfma_f32_16x16x32_bf16 v[192:195], v[232:235], v[16:19], v[192:195]
    ds_read_b64_tr_b16 v[224:225], v7 offset:0
    v_mfma_f32_16x16x32_bf16 v[192:195], v[236:239], v[20:23], v[192:195]
    ds_read_b64_tr_b16 v[226:227], v7 offset:512
    v_mfma_f32_16x16x32_bf16 v[196:199], v[236:239], v[28:31], v[196:199]
    ds_read_b64_tr_b16 v[228:229], v7 offset:4096
    v_mfma_f32_16x16x32_bf16 v[196:199], v[232:235], v[24:27], v[196:199]
    ds_read_b64_tr_b16 v[230:231], v7 offset:4608
    v_mfma_f32_16x16x32_bf16 v[200:203], v[232:235], v[32:35], v[200:203]
    s_add_u32 s84, s84, 1
    s_cmp_eq_u32 s82, 2
    s_cselect_b32 s78, s83, 40960
    s_cselect_b32 s82, -1, s82
    s_add_u32 s82, s82, 1
    v_mfma_f32_16x16x32_bf16 v[200:203], v[236:239], v[36:39], v[200:203]
    v_add_u32 v4, s78, v4
    v_add_u32 v5, s78, v5
    v_mfma_f32_16x16x32_bf16 v[204:207], v[236:239], v[44:47], v[204:207]
    v_add_u32 v6, s78, v6
    v_add_u32 v7, s78, v7
    v_mfma_f32_16x16x32_bf16 v[204:207], v[232:235], v[40:43], v[204:207]
    v_mfma_f32_16x16x32_bf16 v[220:223], v[80:83], v[40:43], v[220:223]
    v_mfma_f32_16x16x32_bf16 v[220:223], v[84:87], v[44:47], v[220:223]
    s_waitcnt lgkmcnt(0)
    v_mfma_f32_16x16x32_bf16 v[216:219], v[84:87], v[36:39], v[216:219]
    v_mfma_f32_16x16x32_bf16 v[216:219], v[80:83], v[32:35], v[216:219]
    s_barrier
    v_mfma_f32_16x16x32_bf16 v[212:215], v[80:83], v[24:27], v[212:215]
    ds_read_b128 v[48:51], v4 offset:0
    v_mfma_f32_16x16x32_bf16 v[212:215], v[84:87], v[28:31], v[212:215]
    ds_read_b128 v[52:55], v5 offset:0
    v_mfma_f32_16x16x32_bf16 v[208:211], v[84:87], v[20:23], v[208:211]
    ds_read_b128 v[56:59], v4 offset:2048
    v_mfma_f32_16x16x32_bf16 v[208:211], v[80:83], v[16:19], v[208:211]
    ds_read_b128 v[60:63], v5 offset:2048
    v_mfma_f32_16x16x32_bf16 v[128:131], v[88:91], v[16:19], v[128:131]
    ds_read_b128 v[64:67], v4 offset:4096
    v_mfma_f32_16x16x32_bf16 v[128:131], v[92:95], v[20:23], v[128:131]
    ds_read_b128 v[68:71], v5 offset:4096
    v_mfma_f32_16x16x32_bf16 v[132:135], v[92:95], v[28:31], v[132:135]
    ds_read_b128 v[72:75], v4 offset:6144
    v_mfma_f32_16x16x32_bf16 v[132:135], v[88:91], v[24:27], v[132:135]
    ds_read_b128 v[76:79], v5 offset:6144
    v_mfma_f32_16x16x32_bf16 v[136:139], v[88:91], v[32:35], v[136:139]
    ds_read_b64_tr_b16 v[232:233], v6 offset:8192
    v_mfma_f32_16x16x32_bf16 v[136:139], v[92:95], v[36:39], v[136:139]
    ds_read_b64_tr_b16 v[234:235], v6 offset:8704
    v_mfma_f32_16x16x32_bf16 v[140:143], v[92:95], v[44:47], v[140:143]
    ds_read_b64_tr_b16 v[236:237], v6 offset:12288
    v_mfma_f32_16x16x32_bf16 v[140:143], v[88:91], v[40:43], v[140:143]
    ds_read_b64_tr_b16 v[238:239], v6 offset:12800
    v_mfma_f32_16x16x32_bf16 v[156:159], v[224:227], v[40:43], v[156:159]
    ds_read_b64_tr_b16 v[80:81], v7 offset:8192
    v_mfma_f32_16x16x32_bf16 v[156:159], v[228:231], v[44:47], v[156:159]
    ds_read_b64_tr_b16 v[82:83], v7 offset:8704
    v_mfma_f32_16x16x32_bf16 v[152:155], v[228:231], v[36:39], v[152:155]
    ds_read_b64_tr_b16 v[84:85], v7 offset:12288
    v_mfma_f32_16x16x32_bf16 v[152:155], v[224:227], v[32:35], v[152:155]
    ds_read_b64_tr_b16 v[86:87], v7 offset:12800
    v_mfma_f32_16x16x32_bf16 v[148:151], v[224:227], v[24:27], v[148:151]
    v_mfma_f32_16x16x32_bf16 v[148:151], v[228:231], v[28:31], v[148:151]
    v_mfma_f32_16x16x32_bf16 v[144:147], v[228:231], v[20:23], v[144:147]
    v_mfma_f32_16x16x32_bf16 v[144:147], v[224:227], v[16:19], v[144:147]
    s_branch L_Mloop
    .p2align 3
L_Mtail:
L_pad7:
    s_cbranch_execz L_pad11
    s_mov_b64 exec, 0xffff
    ds_read_b64 v[104:105], v11 offset:0
    ds_read_b64 v[106:107], v11 offset:128
    ds_read_b64 v[108:109], v11 offset:256
    ds_read_b64 v[110:111], v11 offset:384
    s_mov_b64 exec, -1
    v_mfma_f32_16x16x32_bf16 v[212:215], v[224:227], v[56:59], v[212:215]
    ds_read_b64 v[20:21], v12 offset:512
    v_mfma_f32_16x16x32_bf16 v[212:215], v[228:231], v[60:63], v[212:215]
    ds_read_b64 v[22:23], v12 offset:640
    v_mfma_f32_16x16x32_bf16 v[208:211], v[228:231], v[52:55], v[208:211]
    ds_read_b64 v[24:25], v12 offset:1024
    v_mfma_f32_16x16x32_bf16 v[208:211], v[224:227], v[48:51], v[208:211]
    ds_read_b64 v[26:27], v12 offset:1152
    v_mfma_f32_16x16x32_bf16 v[128:131], v[232:235], v[48:51], v[128:131]
    ds_read_b64 v[16:17], v12 offset:0
    v_mfma_f32_16x16x32_bf16 v[128:131], v[236:239], v[52:55], v[128:131]
    ds_read_b64 v[18:19], v12 offset:128
    v_mfma_f32_16x16x32_bf16 v[132:135], v[236:239], v[60:63], v[132:135]
    ds_read2_b32 v[32:33], v14 offset0:0 offset1:32
    v_mfma_f32_16x16x32_bf16 v[132:135], v[232:235], v[56:59], v[132:135]
    ds_read_b32 v28, v13 offset:0
    v_mfma_f32_16x16x32_bf16 v[136:139], v[232:235], v[64:67], v[136:139]
    ds_read_b32 v30, v13 offset:64
    v_mfma_f32_16x16x32_bf16 v[136:139], v[236:239], v[68:71], v[136:139]
    ds_read_b32 v44, v13 offset:128
    v_mfma_f32_16x16x32_bf16 v[140:143], v[236:239], v[76:79], v[140:143]
    ds_read_b32 v46, v13 offset:192
    v_mfma_f32_16x16x32_bf16 v[140:143], v[232:235], v[72:75], v[140:143]
    s_waitcnt lgkmcnt(0)
    s_nop 0
    v_mfma_f32_16x16x16_bf16 v[160:163], v[20:21], v[104:105], v[160:163]
    v_mfma_f32_16x16x16_bf16 v[176:179], v[22:23], v[104:105], v[176:179]
    v_mfma_f32_16x16x16_bf16 v[164:167], v[20:21], v[106:107], v[164:167]
    v_mfma_f32_16x16x16_bf16 v[180:183], v[22:23], v[106:107], v[180:183]
    v_mfma_f32_16x16x16_bf16 v[168:171], v[20:21], v[108:109], v[168:171]
    v_mfma_f32_16x16x16_bf16 v[184:187], v[22:23], v[108:109], v[184:187]
    v_mfma_f32_16x16x16_bf16 v[172:175], v[20:21], v[110:111], v[172:175]
    v_mfma_f32_16x16x16_bf16 v[188:191], v[22:23], v[110:111], v[188:191]
    v_mul_f32 v34, 0x3fb8aa3b, v32
    v_mul_f32 v120, 0x3fb8aa3b, v33
    v_mfma_f32_16x16x16_bf16 v[192:195], v[24:25], v[104:105], v[192:195]
    v_mfma_f32_16x16x16_bf16 v[208:211], v[26:27], v[104:105], v[208:211]
    v_mfma_f32_16x16x16_bf16 v[196:199], v[24:25], v[106:107], v[196:199]
    v_cvt_pk_bf16_f32 v160, v160, v161
    v_cvt_pk_bf16_f32 v161, v162, v163
    v_cvt_pk_bf16_f32 v162, v176, v177
    v_cvt_pk_bf16_f32 v163, v178, v179
    v_mfma_f32_16x16x16_bf16 v[212:215], v[26:27], v[106:107], v[212:215]
    v_cvt_pk_bf16_f32 v164, v164, v165
    v_cvt_pk_bf16_f32 v165, v166, v167
    v_cvt_pk_bf16_f32 v166, v180, v181
    v_cvt_pk_bf16_f32 v167, v182, v183
    v_mfma_f32_16x16x16_bf16 v[200:203], v[24:25], v[108:109], v[200:203]
    v_cvt_pk_bf16_f32 v168, v168, v169
    v_cvt_pk_bf16_f32 v169, v170, v171
    v_cvt_pk_bf16_f32 v170, v184, v185
    v_cvt_pk_bf16_f32 v171, v186, v187
    v_mfma_f32_16x16x16_bf16 v[216:219], v[26:27], v[108:109], v[216:219]
    v_cvt_pk_bf16_f32 v172, v172, v173
    v_cvt_pk_bf16_f32 v173, v174, v175
    v_cvt_pk_bf16_f32 v174, v188, v189
    v_cvt_pk_bf16_f32 v175, v190, v191
    v_mfma_f32_16x16x16_bf16 v[204:207], v[24:25], v[110:111], v[204:207]
    v_permlane16_swap_b32 v160, v164
    v_permlane16_swap_b32 v161, v165
    v_permlane16_swap_b32 v162, v166
    v_permlane16_swap_b32 v163, v167
    v_mfma_f32_16x16x16_bf16 v[220:223], v[26:27], v[110:111], v[220:223]
    v_permlane16_swap_b32 v168, v172
    v_permlane16_swap_b32 v169, v173
    v_permlane16_swap_b32 v170, v174
    v_permlane16_swap_b32 v171, v175
    v_mfma_f32_32x32x16_bf16 v[224:239], v[96:99], v[160:163], 0
    v_mfma_f32_32x32x16_bf16 v[224:239], v[100:103], v[164:167], v[224:239]
    v_mfma_f32_32x32x16_bf16 v[240:255], v[96:99], v[168:171], 0
    v_mfma_f32_32x32x16_bf16 v[240:255], v[100:103], v[172:175], v[240:255]
    v_pk_mul_f32 v[192:193], v[192:193], v[28:29] op_sel_hi:[1,0]
    v_pk_mul_f32 v[194:195], v[194:195], v[28:29] op_sel_hi:[1,0]
    v_pk_mul_f32 v[208:209], v[208:209], v[28:29] op_sel_hi:[1,0]
    v_pk_mul_f32 v[210:211], v[210:211], v[28:29] op_sel_hi:[1,0]
    v_cvt_pk_bf16_f32 v192, v192, v193
    v_cvt_pk_bf16_f32 v193, v194, v195
    v_cvt_pk_bf16_f32 v194, v208, v209
    v_cvt_pk_bf16_f32 v195, v210, v211
    v_pk_mul_f32 v[196:197], v[196:197], v[30:31] op_sel_hi:[1,0]
    v_pk_mul_f32 v[198:199], v[198:199], v[30:31] op_sel_hi:[1,0]
    v_pk_mul_f32 v[212:213], v[212:213], v[30:31] op_sel_hi:[1,0]
    v_pk_mul_f32 v[214:215], v[214:215], v[30:31] op_sel_hi:[1,0]
    v_cvt_pk_bf16_f32 v196, v196, v197
    v_cvt_pk_bf16_f32 v197, v198, v199
    v_cvt_pk_bf16_f32 v198, v212, v213
    v_cvt_pk_bf16_f32 v199, v214, v215
    v_pk_mul_f32 v[200:201], v[200:201], v[44:45] op_sel_hi:[1,0]
    v_pk_mul_f32 v[202:203], v[202:203], v[44:45] op_sel_hi:[1,0]
    v_pk_mul_f32 v[216:217], v[216:217], v[44:45] op_sel_hi:[1,0]
    v_pk_mul_f32 v[218:219], v[218:219], v[44:45] op_sel_hi:[1,0]
    v_cvt_pk_bf16_f32 v200, v200, v201
    v_cvt_pk_bf16_f32 v201, v202, v203
    v_cvt_pk_bf16_f32 v202, v216, v217
    v_cvt_pk_bf16_f32 v203, v218, v219
    v_pk_mul_f32 v[204:205], v[204:205], v[46:47] op_sel_hi:[1,0]
    v_pk_mul_f32 v[206:207], v[206:207], v[46:47] op_sel_hi:[1,0]
    v_pk_mul_f32 v[220:221], v[220:221], v[46:47] op_sel_hi:[1,0]
    v_pk_mul_f32 v[222:223], v[222:223], v[46:47] op_sel_hi:[1,0]
    v_cvt_pk_bf16_f32 v204, v204, v205
    v_cvt_pk_bf16_f32 v205, v206, v207
    v_cvt_pk_bf16_f32 v206, v220, v221
    v_cvt_pk_bf16_f32 v207, v222, v223
    v_mfma_f32_16x16x32_bf16 v[156:159], v[80:83], v[72:75], v[156:159]
    v_max3_f32 v36, v224, v225, v226
    v_max3_f32 v38, -v224, -v225, -v226
    v_max3_f32 v36, v36, v227, v228
    v_max3_f32 v38, v38, -v227, -v228
    v_mfma_f32_16x16x32_bf16 v[156:159], v[84:87], v[76:79], v[156:159]
    v_max3_f32 v36, v36, v229, v230
    v_max3_f32 v38, v38, -v229, -v230
    v_max3_f32 v36, v36, v231, v232
    v_max3_f32 v38, v38, -v231, -v232
    v_mfma_f32_16x16x32_bf16 v[152:155], v[84:87], v[68:71], v[152:155]
    v_max3_f32 v36, v36, v233, v234
    v_max3_f32 v38, v38, -v233, -v234
    v_max3_f32 v36, v36, v235, v236
    v_max3_f32 v38, v38, -v235, -v236
    v_mfma_f32_16x16x32_bf16 v[152:155], v[80:83], v[64:67], v[152:155]
    v_max3_f32 v36, v36, v237, v238
    v_max3_f32 v38, v38, -v237, -v238
    v_max_f32_e64 v36, v36, v239
    v_max_f32 v38, v38, -v239
    v_mfma_f32_16x16x32_bf16 v[148:151], v[80:83], v[56:59], v[148:151]
    v_max3_f32 v37, v240, v241, v242
    v_max3_f32 v39, -v240, -v241, -v242
    v_max3_f32 v37, v37, v243, v244
    v_max3_f32 v39, v39, -v243, -v244
    v_mfma_f32_16x16x32_bf16 v[148:151], v[84:87], v[60:63], v[148:151]
    v_max3_f32 v37, v37, v245, v246
    v_max3_f32 v39, v39, -v245, -v246
    v_max3_f32 v37, v37, v247, v248
    v_max3_f32 v39, v39, -v247, -v248
    v_mfma_f32_16x16x32_bf16 v[144:147], v[84:87], v[52:55], v[144:147]
    v_max3_f32 v37, v37, v249, v250
    v_max3_f32 v39, v39, -v249, -v250
    v_max3_f32 v37, v37, v251, v252
    v_max3_f32 v39, v39, -v251, -v252
    v_mfma_f32_16x16x32_bf16 v[144:147], v[80:83], v[48:51], v[144:147]
    v_max3_f32 v37, v37, v253, v254
    v_max3_f32 v39, v39, -v253, -v254
    v_max_f32_e64 v37, v37, v255
    v_max_f32 v39, v39, -v255
    v_permlane32_swap_b32 v36, v38
    s_nop 0
    v_permlane32_swap_b32 v37, v39
    v_max_f32 v36, v36, v38
    v_max_f32_e64 v37, v37, v39
    v_mul_f32 v36, -v36, v34
    v_mul_f32 v37, -v37, v120
    v_mov_b32 v38, v36
    v_mov_b32 v39, v37
    s_nop 0
    v_permlane32_swap_b32 v36, v38
    v_permlane32_swap_b32_e64 v37, v39
    v_pk_fma_f32 v[60:61], v[224:225], v[34:35], v[36:37] op_sel_hi:[1,0,0]
    v_pk_fma_f32 v[62:63], v[226:227], v[34:35], v[36:37] op_sel_hi:[1,0,0]
    v_pk_fma_f32 v[64:65], v[228:229], v[34:35], v[36:37] op_sel_hi:[1,0,0]
    v_pk_fma_f32 v[66:67], v[230:231], v[34:35], v[36:37] op_sel_hi:[1,0,0]
    v_pk_fma_f32 v[68:69], v[232:233], v[34:35], v[36:37] op_sel_hi:[1,0,0]
    v_pk_fma_f32 v[70:71], v[234:235], v[34:35], v[36:37] op_sel_hi:[1,0,0]
    v_pk_fma_f32 v[72:73], v[236:237], v[34:35], v[36:37] op_sel_hi:[1,0,0]
    v_pk_fma_f32 v[74:75], v[238:239], v[34:35], v[36:37] op_sel_hi:[1,0,0]
    v_pk_fma_f32 v[76:77], v[224:225], v[34:35], v[38:39] op_sel_hi:[1,0,0] neg_lo:[1,0,0] neg_hi:[1,0,0]
    v_pk_fma_f32 v[78:79], v[226:227], v[34:35], v[38:39] op_sel_hi:[1,0,0] neg_lo:[1,0,0] neg_hi:[1,0,0]
    v_pk_fma_f32 v[80:81], v[228:229], v[34:35], v[38:39] op_sel_hi:[1,0,0] neg_lo:[1,0,0] neg_hi:[1,0,0]
    v_pk_fma_f32 v[82:83], v[230:231], v[34:35], v[38:39] op_sel_hi:[1,0,0] neg_lo:[1,0,0] neg_hi:[1,0,0]
    v_pk_fma_f32 v[84:85], v[232:233], v[34:35], v[38:39] op_sel_hi:[1,0,0] neg_lo:[1,0,0] neg_hi:[1,0,0]
    v_pk_fma_f32 v[86:87], v[234:235], v[34:35], v[38:39] op_sel_hi:[1,0,0] neg_lo:[1,0,0] neg_hi:[1,0,0]
    v_pk_fma_f32 v[88:89], v[236:237], v[34:35], v[38:39] op_sel_hi:[1,0,0] neg_lo:[1,0,0] neg_hi:[1,0,0]
    v_pk_fma_f32 v[90:91], v[238:239], v[34:35], v[38:39] op_sel_hi:[1,0,0] neg_lo:[1,0,0] neg_hi:[1,0,0]
    v_exp_f32 v60, v60
    v_exp_f32 v61, v61
    v_exp_f32 v62, v62
    v_exp_f32 v63, v63
    v_exp_f32 v64, v64
    v_exp_f32 v65, v65
    v_exp_f32 v66, v66
    v_exp_f32 v67, v67
    v_exp_f32 v68, v68
    v_exp_f32 v69, v69
    v_exp_f32 v70, v70
    v_exp_f32 v71, v71
    v_exp_f32 v72, v72
    v_exp_f32 v73, v73
    v_exp_f32 v74, v74
    v_exp_f32 v75, v75
    v_exp_f32 v76, v76
    v_exp_f32 v77, v77
    v_exp_f32 v78, v78
    v_exp_f32 v79, v79
    v_exp_f32 v80, v80
    v_exp_f32 v81, v81
    v_exp_f32 v82, v82
    v_exp_f32 v83, v83
    v_exp_f32 v84, v84
    v_exp_f32 v85, v85
    v_exp_f32 v86, v86
    v_exp_f32 v87, v87
    v_exp_f32 v88, v88
    v_exp_f32 v89, v89
    v_exp_f32 v90, v90
    v_exp_f32 v91, v91
    v_pk_add_f32 v[40:41], v[60:61], v[62:63]
    v_pk_add_f32 v[42:43], v[76:77], v[78:79]
    v_pk_add_f32 v[40:41], v[40:41], v[64:65]
    v_pk_add_f32 v[42:43], v[42:43], v[80:81]
    v_pk_add_f32 v[40:41], v[40:41], v[66:67]
    v_pk_add_f32 v[42:43], v[42:43], v[82:83]
    v_pk_add_f32 v[40:41], v[40:41], v[68:69]
    v_pk_add_f32 v[42:43], v[42:43], v[84:85]
    v_pk_add_f32 v[40:41], v[40:41], v[70:71]
    v_pk_add_f32 v[42:43], v[42:43], v[86:87]
    v_pk_add_f32 v[40:41], v[40:41], v[72:73]
    v_pk_add_f32 v[42:43], v[42:43], v[88:89]
    v_pk_add_f32 v[40:41], v[40:41], v[74:75]
    v_pk_add_f32 v[42:43], v[42:43], v[90:91]
    v_add_f32 v40, v40, v41
    v_add_f32 v42, v42, v43
    s_nop 1
    v_permlane32_swap_b32 v40, v42
    v_add_f32 v40, v40, v42
    v_rcp_f32 v40, v40
    s_nop 0
    v_mov_b32 v42, v40
    s_nop 1
    v_permlane32_swap_b32 v40, v42
    v_pk_mul_f32 v[60:61], v[60:61], v[40:41] op_sel_hi:[1,0]
    v_pk_mul_f32 v[62:63], v[62:63], v[40:41] op_sel_hi:[1,0]
    v_pk_mul_f32 v[64:65], v[64:65], v[40:41] op_sel_hi:[1,0]
    v_pk_mul_f32 v[66:67], v[66:67], v[40:41] op_sel_hi:[1,0]
    v_cvt_pk_bf16_f32 v160, v60, v61
    v_cvt_pk_bf16_f32 v161, v62, v63
    v_cvt_pk_bf16_f32 v162, v64, v65
    v_cvt_pk_bf16_f32 v163, v66, v67
    v_pk_mul_f32 v[68:69], v[68:69], v[40:41] op_sel_hi:[1,0]
    v_pk_mul_f32 v[70:71], v[70:71], v[40:41] op_sel_hi:[1,0]
    v_pk_mul_f32 v[72:73], v[72:73], v[40:41] op_sel_hi:[1,0]
    v_pk_mul_f32 v[74:75], v[74:75], v[40:41] op_sel_hi:[1,0]
    v_cvt_pk_bf16_f32 v166, v68, v69
    v_cvt_pk_bf16_f32 v167, v70, v71
    v_cvt_pk_bf16_f32 v164, v72, v73
    v_cvt_pk_bf16_f32 v165, v74, v75
    v_pk_mul_f32 v[76:77], v[76:77], v[42:43] op_sel_hi:[1,0]
    v_pk_mul_f32 v[78:79], v[78:79], v[42:43] op_sel_hi:[1,0]
    v_pk_mul_f32 v[80:81], v[80:81], v[42:43] op_sel_hi:[1,0]
    v_pk_mul_f32 v[82:83], v[82:83], v[42:43] op_sel_hi:[1,0]
    v_cvt_pk_bf16_f32 v168, v76, v77
    v_cvt_pk_bf16_f32 v169, v78, v79
    v_cvt_pk_bf16_f32 v170, v80, v81
    v_cvt_pk_bf16_f32 v171, v82, v83
    v_pk_mul_f32 v[84:85], v[84:85], v[42:43] op_sel_hi:[1,0]
    v_pk_mul_f32 v[86:87], v[86:87], v[42:43] op_sel_hi:[1,0]
    v_pk_mul_f32 v[88:89], v[88:89], v[42:43] op_sel_hi:[1,0]
L_pad8:
    s_cbranch_execz L_pad12
    s_nop 0
    v_pk_mul_f32 v[90:91], v[90:91], v[42:43] op_sel_hi:[1,0]
    v_cvt_pk_bf16_f32 v174, v84, v85
    v_cvt_pk_bf16_f32 v175, v86, v87
    v_cvt_pk_bf16_f32 v172, v88, v89
    v_cvt_pk_bf16_f32 v173, v90, v91
    v_pk_fma_f32 v[60:61], v[240:241], v[120:121], v[36:37] op_sel:[0,0,1] op_sel_hi:[1,0,1]
    v_pk_fma_f32 v[62:63], v[242:243], v[120:121], v[36:37] op_sel:[0,0,1] op_sel_hi:[1,0,1]
    v_pk_fma_f32 v[64:65], v[244:245], v[120:121], v[36:37] op_sel:[0,0,1] op_sel_hi:[1,0,1]
    v_pk_fma_f32 v[66:67], v[246:247], v[120:121], v[36:37] op_sel:[0,0,1] op_sel_hi:[1,0,1]
    v_pk_fma_f32 v[68:69], v[248:249], v[120:121], v[36:37] op_sel:[0,0,1] op_sel_hi:[1,0,1]
    v_pk_fma_f32 v[70:71], v[250:251], v[120:121], v[36:37] op_sel:[0,0,1] op_sel_hi:[1,0,1]
    v_pk_fma_f32 v[72:73], v[252:253], v[120:121], v[36:37] op_sel:[0,0,1] op_sel_hi:[1,0,1]
    v_pk_fma_f32 v[74:75], v[254:255], v[120:121], v[36:37] op_sel:[0,0,1] op_sel_hi:[1,0,1]
    v_pk_fma_f32 v[76:77], v[240:241], v[120:121], v[38:39] op_sel:[0,0,1] op_sel_hi:[1,0,1] neg_lo:[1,0,0] neg_hi:[1,0,0]
    v_pk_fma_f32 v[78:79], v[242:243], v[120:121], v[38:39] op_sel:[0,0,1] op_sel_hi:[1,0,1] neg_lo:[1,0,0] neg_hi:[1,0,0]
    v_pk_fma_f32 v[80:81], v[244:245], v[120:121], v[38:39] op_sel:[0,0,1] op_sel_hi:[1,0,1] neg_lo:[1,0,0] neg_hi:[1,0,0]
    v_pk_fma_f32 v[82:83], v[246:247], v[120:121], v[38:39] op_sel:[0,0,1] op_sel_hi:[1,0,1] neg_lo:[1,0,0] neg_hi:[1,0,0]
    v_pk_fma_f32 v[84:85], v[248:249], v[120:121], v[38:39] op_sel:[0,0,1] op_sel_hi:[1,0,1] neg_lo:[1,0,0] neg_hi:[1,0,0]
    v_pk_fma_f32 v[86:87], v[250:251], v[120:121], v[38:39] op_sel:[0,0,1] op_sel_hi:[1,0,1] neg_lo:[1,0,0] neg_hi:[1,0,0]
    v_pk_fma_f32 v[88:89], v[252:253], v[120:121], v[38:39] op_sel:[0,0,1] op_sel_hi:[1,0,1] neg_lo:[1,0,0] neg_hi:[1,0,0]
    v_pk_fma_f32 v[90:91], v[254:255], v[120:121], v[38:39] op_sel:[0,0,1] op_sel_hi:[1,0,1] neg_lo:[1,0,0] neg_hi:[1,0,0]
    v_exp_f32 v60, v60
    v_exp_f32 v61, v61
    v_exp_f32 v62, v62
    v_exp_f32 v63, v63
    ds_write_b128 v116, v[192:195] offset:0
    v_exp_f32 v64, v64
    v_exp_f32 v65, v65
    v_exp_f32 v66, v66
    v_exp_f32 v67, v67
    ds_write_b128 v116, v[196:199] offset:2048
    v_exp_f32 v68, v68
    v_exp_f32 v69, v69
    v_exp_f32 v70, v70
    v_exp_f32 v71, v71
    ds_write_b128 v116, v[200:203] offset:4096
    v_exp_f32 v72, v72
    v_exp_f32 v73, v73
    v_exp_f32 v74, v74
    v_exp_f32 v75, v75
    ds_write_b128 v116, v[204:207] offset:6144
    v_exp_f32 v76, v76
    v_exp_f32 v77, v77
    v_exp_f32 v78, v78
    v_exp_f32 v79, v79
    ds_write_b128 v112, v[160:163] offset:0
    v_exp_f32 v80, v80
    v_exp_f32 v81, v81
    v_exp_f32 v82, v82
    v_exp_f32 v83, v83
    ds_write_b128 v113, v[164:167] offset:0
    v_exp_f32 v84, v84
    v_exp_f32 v85, v85
    v_exp_f32 v86, v86
    v_exp_f32 v87, v87
    ds_write_b128 v114, v[168:171] offset:0
    v_exp_f32 v88, v88
    v_exp_f32 v89, v89
    v_exp_f32 v90, v90
    v_exp_f32 v91, v91
    ds_write_b128 v115, v[172:175] offset:0
    v_pk_add_f32 v[40:41], v[60:61], v[62:63]
    v_pk_add_f32 v[42:43], v[76:77], v[78:79]
    v_pk_add_f32 v[40:41], v[40:41], v[64:65]
    v_pk_add_f32 v[42:43], v[42:43], v[80:81]
    v_pk_add_f32 v[40:41], v[40:41], v[66:67]
    v_pk_add_f32 v[42:43], v[42:43], v[82:83]
    v_pk_add_f32 v[40:41], v[40:41], v[68:69]
    v_pk_add_f32 v[42:43], v[42:43], v[84:85]
    v_pk_add_f32 v[40:41], v[40:41], v[70:71]
    v_pk_add_f32 v[42:43], v[42:43], v[86:87]
    v_pk_add_f32 v[40:41], v[40:41], v[72:73]
    v_pk_add_f32 v[42:43], v[42:43], v[88:89]
    v_pk_add_f32 v[40:41], v[40:41], v[74:75]
    v_pk_add_f32 v[42:43], v[42:43], v[90:91]
    v_add_f32 v40, v40, v41
    v_add_f32 v42, v42, v43
    s_nop 1
    v_permlane32_swap_b32 v40, v42
    v_add_f32 v40, v40, v42
    v_rcp_f32 v40, v40
    s_nop 0
    v_mov_b32 v42, v40
    s_nop 1
    v_permlane32_swap_b32 v40, v42
    v_pk_mul_f32 v[60:61], v[60:61], v[40:41] op_sel_hi:[1,0]
    v_pk_mul_f32 v[62:63], v[62:63], v[40:41] op_sel_hi:[1,0]
    v_pk_mul_f32 v[64:65], v[64:65], v[40:41] op_sel_hi:[1,0]
    v_pk_mul_f32 v[66:67], v[66:67], v[40:41] op_sel_hi:[1,0]
    v_cvt_pk_bf16_f32 v176, v60, v61
    v_cvt_pk_bf16_f32 v177, v62, v63
    v_cvt_pk_bf16_f32 v178, v64, v65
    v_cvt_pk_bf16_f32 v179, v66, v67
    ds_write_b128 v112, v[176:179] offset:4096
    v_pk_mul_f32 v[68:69], v[68:69], v[40:41] op_sel_hi:[1,0]
    v_pk_mul_f32 v[70:71], v[70:71], v[40:41] op_sel_hi:[1,0]
    v_pk_mul_f32 v[72:73], v[72:73], v[40:41] op_sel_hi:[1,0]
    v_pk_mul_f32 v[74:75], v[74:75], v[40:41] op_sel_hi:[1,0]
    v_cvt_pk_bf16_f32 v182, v68, v69
    v_cvt_pk_bf16_f32 v183, v70, v71
    v_cvt_pk_bf16_f32 v180, v72, v73
    v_cvt_pk_bf16_f32 v181, v74, v75
    ds_write_b128 v113, v[180:183] offset:4096
    v_pk_mul_f32 v[76:77], v[76:77], v[42:43] op_sel_hi:[1,0]
    v_pk_mul_f32 v[78:79], v[78:79], v[42:43] op_sel_hi:[1,0]
    v_pk_mul_f32 v[80:81], v[80:81], v[42:43] op_sel_hi:[1,0]
    v_pk_mul_f32 v[82:83], v[82:83], v[42:43] op_sel_hi:[1,0]
    v_cvt_pk_bf16_f32 v184, v76, v77
    v_cvt_pk_bf16_f32 v185, v78, v79
    v_cvt_pk_bf16_f32 v186, v80, v81
    v_cvt_pk_bf16_f32 v187, v82, v83
    ds_write_b128 v114, v[184:187] offset:4096
    v_pk_mul_f32 v[84:85], v[84:85], v[42:43] op_sel_hi:[1,0]
    v_pk_mul_f32 v[86:87], v[86:87], v[42:43] op_sel_hi:[1,0]
    v_pk_mul_f32 v[88:89], v[88:89], v[42:43] op_sel_hi:[1,0]
    v_pk_mul_f32 v[90:91], v[90:91], v[42:43] op_sel_hi:[1,0]
    v_cvt_pk_bf16_f32 v190, v84, v85
    v_cvt_pk_bf16_f32 v191, v86, v87
    v_cvt_pk_bf16_f32 v188, v88, v89
    v_cvt_pk_bf16_f32 v189, v90, v91
    ds_write_b128 v115, v[188:191] offset:4096
    s_waitcnt lgkmcnt(0)
    s_barrier
    s_setprio 0
    s_nop 0
    v_mfma_f32_16x16x16_bf16 v[128:131], v[16:17], v[104:105], v[128:131]
    v_mfma_f32_16x16x16_bf16 v[144:147], v[18:19], v[104:105], v[144:147]
    v_mfma_f32_16x16x16_bf16 v[132:135], v[16:17], v[106:107], v[132:135]
    v_mfma_f32_16x16x16_bf16 v[148:151], v[18:19], v[106:107], v[148:151]
    v_mfma_f32_16x16x16_bf16 v[136:139], v[16:17], v[108:109], v[136:139]
    v_mfma_f32_16x16x16_bf16 v[152:155], v[18:19], v[108:109], v[152:155]
    v_mfma_f32_16x16x16_bf16 v[140:143], v[16:17], v[110:111], v[140:143]
    v_mfma_f32_16x16x16_bf16 v[156:159], v[18:19], v[110:111], v[156:159]
    v_lshrrev_b32 v11, 5, v2
    s_lshl_b32 s78, s81, 7
    s_add_u32 s78, s78, 162944
    v_lshl_add_u32 v10, v11, 4, s78
    v_and_b32 v13, 1, v2
    v_cmp_eq_u32 vcc, 1, v13
    v_mov_b32 v13, 162816
    v_and_b32 v12, 31, v2
    v_cndmask_b32 v10, v10, v13, vcc
    v_lshlrev_b32_e64 v12, 4, v12
    v_lshl_add_u32 v11, v11, 10, v12
    v_lshlrev_b32_e64 v14, 4, v2
    v_cvt_pk_bf16_f32 v128, v128, v129
    v_cvt_pk_bf16_f32 v129, v130, v131
    v_cvt_pk_bf16_f32 v130, v144, v145
    v_cvt_pk_bf16_f32 v131, v146, v147
    v_cvt_pk_bf16_f32 v132, v132, v133
    v_cvt_pk_bf16_f32 v133, v134, v135
    v_cvt_pk_bf16_f32 v134, v148, v149
    v_cvt_pk_bf16_f32 v135, v150, v151
    v_cvt_pk_bf16_f32 v136, v136, v137
    v_cvt_pk_bf16_f32 v137, v138, v139
    v_cvt_pk_bf16_f32 v138, v152, v153
    v_cvt_pk_bf16_f32 v139, v154, v155
    v_cvt_pk_bf16_f32 v140, v140, v141
    v_cvt_pk_bf16_f32 v141, v142, v143
    v_cvt_pk_bf16_f32 v142, v156, v157
    v_cvt_pk_bf16_f32 v143, v158, v159
    v_permlane16_swap_b32 v128, v132
    v_permlane16_swap_b32 v129, v133
    v_permlane16_swap_b32 v130, v134
    v_permlane16_swap_b32 v131, v135
    v_permlane16_swap_b32 v136, v140
    v_permlane16_swap_b32 v137, v141
    v_permlane16_swap_b32 v138, v142
    v_permlane16_swap_b32 v139, v143
    v_mfma_f32_32x32x16_bf16 v[224:239], v[96:99], v[128:131], 0
    v_mfma_f32_32x32x16_bf16 v[224:239], v[100:103], v[132:135], v[224:239]
    v_mfma_f32_32x32x16_bf16 v[240:255], v[96:99], v[136:139], 0
    v_mfma_f32_32x32x16_bf16 v[240:255], v[100:103], v[140:143], v[240:255]
    s_lshl_b32 s94, s70, 14
    s_lshl_b32 s79, s81, 13
    s_add_u32 s94, s94, s79
    s_add_u32 s94, s94, 8388608
    s_add_u32 s95, s94, 4096
    s_lshl_b32 s78, s69, 1
    s_add_u32 s78, s78, s80
    s_lshl_b32 s78, s78, 6
    s_lshl_b32 s79, s70, 1
    s_add_u32 s78, s78, s79
    s_add_u32 s78, s78, s81
    s_lshl_b32 s78, s78, 11
    s_add_u32 s96, s78, 4194304
    s_add_u32 s97, s96, 65536
    v_max3_f32 v36, v224, v225, v226
    v_max3_f32 v38, -v224, -v225, -v226
    v_max3_f32 v36, v36, v227, v228
    v_max3_f32 v38, v38, -v227, -v228
    v_max3_f32 v36, v36, v229, v230
    v_max3_f32 v38, v38, -v229, -v230
    v_max3_f32 v36, v36, v231, v232
    v_max3_f32 v38, v38, -v231, -v232
    v_max3_f32 v36, v36, v233, v234
    v_max3_f32 v38, v38, -v233, -v234
    v_max3_f32 v36, v36, v235, v236
    v_max3_f32 v38, v38, -v235, -v236
    v_max3_f32 v36, v36, v237, v238
    v_max3_f32 v38, v38, -v237, -v238
    v_max_f32_e64 v36, v36, v239
    v_max_f32 v38, v38, -v239
    v_max3_f32 v37, v240, v241, v242
    v_max3_f32 v39, -v240, -v241, -v242
    v_max3_f32 v37, v37, v243, v244
    v_max3_f32 v39, v39, -v243, -v244
    v_max3_f32 v37, v37, v245, v246
    v_max3_f32 v39, v39, -v245, -v246
    v_max3_f32 v37, v37, v247, v248
    v_max3_f32 v39, v39, -v247, -v248
    v_max3_f32 v37, v37, v249, v250
    v_max3_f32 v39, v39, -v249, -v250
    v_max3_f32 v37, v37, v251, v252
    v_max3_f32 v39, v39, -v251, -v252
    v_max3_f32 v37, v37, v253, v254
    v_max3_f32 v39, v39, -v253, -v254
    v_max_f32_e64 v37, v37, v255
    v_max_f32 v39, v39, -v255
    v_permlane32_swap_b32 v36, v38
    s_nop 0
    v_permlane32_swap_b32 v37, v39
    v_max_f32 v36, v36, v38
    v_max_f32_e64 v37, v37, v39
    v_mul_f32 v36, -v36, v34
    v_mul_f32 v37, -v37, v120
    v_mov_b32 v38, v36
    v_mov_b32 v39, v37
    s_nop 0
    v_permlane32_swap_b32 v36, v38
    v_permlane32_swap_b32_e64 v37, v39
    v_pk_fma_f32 v[60:61], v[224:225], v[34:35], v[36:37] op_sel_hi:[1,0,0]
    v_pk_fma_f32 v[62:63], v[226:227], v[34:35], v[36:37] op_sel_hi:[1,0,0]
    v_pk_fma_f32 v[64:65], v[228:229], v[34:35], v[36:37] op_sel_hi:[1,0,0]
    v_pk_fma_f32 v[66:67], v[230:231], v[34:35], v[36:37] op_sel_hi:[1,0,0]
    v_pk_fma_f32 v[68:69], v[232:233], v[34:35], v[36:37] op_sel_hi:[1,0,0]
    v_pk_fma_f32 v[70:71], v[234:235], v[34:35], v[36:37] op_sel_hi:[1,0,0]
    v_pk_fma_f32 v[72:73], v[236:237], v[34:35], v[36:37] op_sel_hi:[1,0,0]
    v_pk_fma_f32 v[74:75], v[238:239], v[34:35], v[36:37] op_sel_hi:[1,0,0]
    v_pk_fma_f32 v[76:77], v[224:225], v[34:35], v[38:39] op_sel_hi:[1,0,0] neg_lo:[1,0,0] neg_hi:[1,0,0]
    v_pk_fma_f32 v[78:79], v[226:227], v[34:35], v[38:39] op_sel_hi:[1,0,0] neg_lo:[1,0,0] neg_hi:[1,0,0]
    v_pk_fma_f32 v[80:81], v[228:229], v[34:35], v[38:39] op_sel_hi:[1,0,0] neg_lo:[1,0,0] neg_hi:[1,0,0]
    v_pk_fma_f32 v[82:83], v[230:231], v[34:35], v[38:39] op_sel_hi:[1,0,0] neg_lo:[1,0,0] neg_hi:[1,0,0]
    v_pk_fma_f32 v[84:85], v[232:233], v[34:35], v[38:39] op_sel_hi:[1,0,0] neg_lo:[1,0,0] neg_hi:[1,0,0]
    v_pk_fma_f32 v[86:87], v[234:235], v[34:35], v[38:39] op_sel_hi:[1,0,0] neg_lo:[1,0,0] neg_hi:[1,0,0]
    v_pk_fma_f32 v[88:89], v[236:237], v[34:35], v[38:39] op_sel_hi:[1,0,0] neg_lo:[1,0,0] neg_hi:[1,0,0]
    v_pk_fma_f32 v[90:91], v[238:239], v[34:35], v[38:39] op_sel_hi:[1,0,0] neg_lo:[1,0,0] neg_hi:[1,0,0]
    v_exp_f32 v60, v60
    v_exp_f32 v61, v61
    v_exp_f32 v62, v62
    v_exp_f32 v63, v63
    v_exp_f32 v64, v64
    v_exp_f32 v65, v65
    v_exp_f32 v66, v66
    v_exp_f32 v67, v67
    v_exp_f32 v68, v68
    v_exp_f32 v69, v69
    v_exp_f32 v70, v70
    v_exp_f32 v71, v71
    v_exp_f32 v72, v72
    v_exp_f32 v73, v73
    v_exp_f32 v74, v74
    v_exp_f32 v75, v75
    v_exp_f32 v76, v76
    v_exp_f32 v77, v77
    v_exp_f32 v78, v78
    v_exp_f32 v79, v79
    v_exp_f32 v80, v80
    v_exp_f32 v81, v81
    v_exp_f32 v82, v82
    v_exp_f32 v83, v83
    v_exp_f32 v84, v84
    v_exp_f32 v85, v85
    v_exp_f32 v86, v86
    v_exp_f32 v87, v87
    v_exp_f32 v88, v88
    v_exp_f32 v89, v89
    v_exp_f32 v90, v90
    v_exp_f32 v91, v91
    v_cvt_pk_bf16_f32 v160, v60, v61
    v_cvt_pk_bf16_f32 v161, v62, v63
    v_cvt_pk_bf16_f32 v162, v64, v65
    v_cvt_pk_bf16_f32 v163, v66, v67
    v_cvt_pk_bf16_f32 v164, v68, v69
    v_cvt_pk_bf16_f32 v165, v70, v71
    v_cvt_pk_bf16_f32 v166, v72, v73
    v_cvt_pk_bf16_f32 v167, v74, v75
    v_cvt_pk_bf16_f32 v168, v76, v77
    v_cvt_pk_bf16_f32 v169, v78, v79
    v_cvt_pk_bf16_f32 v170, v80, v81
    v_cvt_pk_bf16_f32 v171, v82, v83
    v_cvt_pk_bf16_f32 v172, v84, v85
    v_cvt_pk_bf16_f32 v173, v86, v87
    v_cvt_pk_bf16_f32 v174, v88, v89
    v_cvt_pk_bf16_f32 v175, v90, v91
    v_pk_fma_f32 v[60:61], v[240:241], v[120:121], v[36:37] op_sel:[0,0,1] op_sel_hi:[1,0,1]
    v_pk_fma_f32 v[62:63], v[242:243], v[120:121], v[36:37] op_sel:[0,0,1] op_sel_hi:[1,0,1]
    v_pk_fma_f32 v[64:65], v[244:245], v[120:121], v[36:37] op_sel:[0,0,1] op_sel_hi:[1,0,1]
    v_pk_fma_f32 v[66:67], v[246:247], v[120:121], v[36:37] op_sel:[0,0,1] op_sel_hi:[1,0,1]
    v_pk_fma_f32 v[68:69], v[248:249], v[120:121], v[36:37] op_sel:[0,0,1] op_sel_hi:[1,0,1]
    v_pk_fma_f32 v[70:71], v[250:251], v[120:121], v[36:37] op_sel:[0,0,1] op_sel_hi:[1,0,1]
    v_pk_fma_f32 v[72:73], v[252:253], v[120:121], v[36:37] op_sel:[0,0,1] op_sel_hi:[1,0,1]
    v_pk_fma_f32 v[74:75], v[254:255], v[120:121], v[36:37] op_sel:[0,0,1] op_sel_hi:[1,0,1]
    v_pk_fma_f32 v[76:77], v[240:241], v[120:121], v[38:39] op_sel:[0,0,1] op_sel_hi:[1,0,1] neg_lo:[1,0,0] neg_hi:[1,0,0]
    v_pk_fma_f32 v[78:79], v[242:243], v[120:121], v[38:39] op_sel:[0,0,1] op_sel_hi:[1,0,1] neg_lo:[1,0,0] neg_hi:[1,0,0]
    v_pk_fma_f32 v[80:81], v[244:245], v[120:121], v[38:39] op_sel:[0,0,1] op_sel_hi:[1,0,1] neg_lo:[1,0,0] neg_hi:[1,0,0]
    v_pk_fma_f32 v[82:83], v[246:247], v[120:121], v[38:39] op_sel:[0,0,1] op_sel_hi:[1,0,1] neg_lo:[1,0,0] neg_hi:[1,0,0]
    v_pk_fma_f32 v[84:85], v[248:249], v[120:121], v[38:39] op_sel:[0,0,1] op_sel_hi:[1,0,1] neg_lo:[1,0,0] neg_hi:[1,0,0]
    v_pk_fma_f32 v[86:87], v[250:251], v[120:121], v[38:39] op_sel:[0,0,1] op_sel_hi:[1,0,1] neg_lo:[1,0,0] neg_hi:[1,0,0]
    v_pk_fma_f32 v[88:89], v[252:253], v[120:121], v[38:39] op_sel:[0,0,1] op_sel_hi:[1,0,1] neg_lo:[1,0,0] neg_hi:[1,0,0]
L_pad9:
    s_cbranch_execz L_pad13
    v_pk_fma_f32 v[90:91], v[254:255], v[120:121], v[38:39] op_sel:[0,0,1] op_sel_hi:[1,0,1] neg_lo:[1,0,0] neg_hi:[1,0,0]
    v_exp_f32 v60, v60
    v_exp_f32 v61, v61
    v_exp_f32 v62, v62
    v_exp_f32 v63, v63
    v_exp_f32 v64, v64
    v_exp_f32 v65, v65
    v_exp_f32 v66, v66
    v_exp_f32 v67, v67
    v_exp_f32 v68, v68
    v_exp_f32 v69, v69
    v_exp_f32 v70, v70
    v_exp_f32 v71, v71
    v_exp_f32 v72, v72
    v_exp_f32 v73, v73
    v_exp_f32 v74, v74
    v_exp_f32 v75, v75
    v_exp_f32 v76, v76
    v_exp_f32 v77, v77
    v_exp_f32 v78, v78
    v_exp_f32 v79, v79
    v_exp_f32 v80, v80
    v_exp_f32 v81, v81
    v_exp_f32 v82, v82
    v_exp_f32 v83, v83
    v_exp_f32 v84, v84
    v_exp_f32 v85, v85
    v_exp_f32 v86, v86
    v_exp_f32 v87, v87
    v_exp_f32 v88, v88
    v_exp_f32 v89, v89
    v_exp_f32 v90, v90
    v_exp_f32_e64 v91, v91
    v_cvt_pk_bf16_f32 v176, v60, v61
    v_cvt_pk_bf16_f32 v177, v62, v63
    v_cvt_pk_bf16_f32 v178, v64, v65
    v_cvt_pk_bf16_f32 v179, v66, v67
    v_cvt_pk_bf16_f32 v180, v68, v69
    v_cvt_pk_bf16_f32 v181, v70, v71
    v_cvt_pk_bf16_f32 v182, v72, v73
    v_cvt_pk_bf16_f32 v183, v74, v75
    v_cvt_pk_bf16_f32 v184, v76, v77
    v_cvt_pk_bf16_f32 v185, v78, v79
    v_cvt_pk_bf16_f32 v186, v80, v81
    v_cvt_pk_bf16_f32 v187, v82, v83
    v_cvt_pk_bf16_f32 v188, v84, v85
    v_cvt_pk_bf16_f32 v189, v86, v87
    v_cvt_pk_bf16_f32 v190, v88, v89
    v_cvt_pk_bf16_f32 v191, v90, v91
    s_barrier
    s_setprio 1
    ds_read_b128 v[16:19], v10 offset:0
    ds_read_b128 v[20:23], v10 offset:32
    ds_read_b128 v[24:27], v10 offset:64
    ds_read_b128 v[28:31], v10 offset:96
    s_waitcnt lgkmcnt(3)
    v_mfma_f32_32x32x16_bf16 v[224:239], v[16:19], v[160:163], 0
    s_waitcnt lgkmcnt(2)
    v_mfma_f32_32x32x16_bf16 v[224:239], v[20:23], v[164:167], v[224:239]
    buffer_load_dwordx4 v[96:99], v11, s[36:39], s94 offen offset:0 sc1
    buffer_load_dwordx4 v[100:103], v11, s[36:39], s94 offen offset:2048 sc1
    buffer_load_dwordx4 v[104:107], v11, s[36:39], s95 offen offset:0 sc1
    buffer_load_dwordx4 v[108:111], v11, s[36:39], s95 offen offset:2048 sc1
    s_waitcnt lgkmcnt(1)
    v_mfma_f32_32x32x16_bf16 v[240:255], v[24:27], v[168:171], 0
    s_waitcnt lgkmcnt(0)
    v_mfma_f32_32x32x16_bf16 v[240:255], v[28:31], v[172:175], v[240:255]
    v_mfma_f32_32x32x16_bf16 v[192:207], v[16:19], v[176:179], 0
    v_mfma_f32_32x32x16_bf16 v[192:207], v[20:23], v[180:183], v[192:207]
    v_mfma_f32_32x32x16_bf16 v[208:223], v[24:27], v[184:187], 0
    v_mfma_f32_32x32x16_bf16 v[208:223], v[28:31], v[188:191], v[208:223]
    s_mov_b32 s85, 0
L_kvchk:
    s_waitcnt vmcnt(0)
    v_mfma_f32_32x32x16_bf16 v[60:75], v[96:99], v[160:163], 0
    v_max3_u32 v13, v96, v97, v98
    v_max3_u32 v10, v99, v100, v101
    v_max3_u32 v13, v13, v102, v103
    v_max3_u32 v10, v10, v104, v105
    v_max3_u32 v13, v13, v106, v107
    v_mfma_f32_32x32x16_bf16 v[60:75], v[100:103], v[164:167], v[60:75]
    v_max3_u32 v10, v10, v108, v109
    v_max3_u32 v13, v13, v110, v111
    v_max_u32 v13, v13, v10
    v_cmp_eq_u32_e64 vcc, -1, v13
    s_cbranch_vccnz L_kvspin
    v_mfma_f32_32x32x16_bf16 v[76:91], v[104:107], v[168:171], 0
    v_rcp_f32 v36, v225
    v_rcp_f32 v40, v193
    v_rcp_f32 v38, v241
    v_rcp_f32 v42, v209
    v_mfma_f32_32x32x16_bf16 v[76:91], v[108:111], v[172:175], v[76:91]
    v_mov_b32 v44, 0x358637bd
    v_mov_b32 v45, 0x358637bd
    v_fmac_f32 v44, v224, v36
    v_fmac_f32 v45, v192, v40
    v_fmac_f32 v44, v240, v38
    v_fmac_f32 v45, v208, v42
    v_mfma_f32_32x32x16_bf16 v[128:143], v[96:99], v[176:179], 0
    v_rcp_f32 v44, v44
    v_rcp_f32 v45, v45
    v_mul_f32 v36, v36, v44
    v_mul_f32 v40, v40, v45
    v_mfma_f32_32x32x16_bf16 v[128:143], v[100:103], v[180:183], v[128:143]
    v_mul_f32 v38, v38, v44
    v_mul_f32 v42, v42, v45
    v_mul_f32 v60, v60, v36
    v_mul_f32 v61, v61, v36
    v_mul_f32 v62, v62, v36
    v_mul_f32 v63, v63, v36
    v_mfma_f32_32x32x16_bf16 v[144:159], v[104:107], v[184:187], 0
    v_mul_f32 v64, v64, v36
    v_mul_f32 v65, v65, v36
    v_mul_f32 v66, v66, v36
    v_mul_f32 v67, v67, v36
    v_mul_f32 v68, v68, v36
    v_mul_f32 v69, v69, v36
    v_mfma_f32_32x32x16_bf16 v[144:159], v[108:111], v[188:191], v[144:159]
    v_mul_f32 v70, v70, v36
    v_mul_f32 v71, v71, v36
    v_mul_f32 v72, v72, v36
    v_mul_f32 v73, v73, v36
    v_mul_f32 v74, v74, v36
    v_mul_f32 v75, v75, v36
    v_pk_fma_f32 v[60:61], v[76:77], v[38:39], v[60:61] op_sel_hi:[1,0,1]
    v_pk_fma_f32 v[62:63], v[78:79], v[38:39], v[62:63] op_sel_hi:[1,0,1]
    v_pk_fma_f32 v[64:65], v[80:81], v[38:39], v[64:65] op_sel_hi:[1,0,1]
    v_pk_fma_f32 v[66:67], v[82:83], v[38:39], v[66:67] op_sel_hi:[1,0,1]
    v_cvt_pk_bf16_f32 v16, v60, v61
    v_cvt_pk_bf16_f32 v17, v62, v63
    v_cvt_pk_bf16_f32 v18, v64, v65
    v_cvt_pk_bf16_f32 v19, v66, v67
    buffer_store_dwordx4 v[16:19], v14, s[36:39], s96 offen offset:0 sc1
    v_pk_fma_f32 v[68:69], v[84:85], v[38:39], v[68:69] op_sel_hi:[1,0,1]
    v_pk_fma_f32 v[70:71], v[86:87], v[38:39], v[70:71] op_sel_hi:[1,0,1]
    v_pk_fma_f32 v[72:73], v[88:89], v[38:39], v[72:73] op_sel_hi:[1,0,1]
    v_pk_fma_f32 v[74:75], v[90:91], v[38:39], v[74:75] op_sel_hi:[1,0,1]
    v_cvt_pk_bf16_f32 v20, v68, v69
    v_cvt_pk_bf16_f32 v21, v70, v71
    v_cvt_pk_bf16_f32 v22, v72, v73
    v_cvt_pk_bf16_f32 v23, v74, v75
    buffer_store_dwordx4 v[20:23], v14, s[36:39], s96 offen offset:1024 sc1
    v_pk_mul_f32 v[128:129], v[128:129], v[40:41] op_sel_hi:[1,0]
    v_pk_mul_f32 v[130:131], v[130:131], v[40:41] op_sel_hi:[1,0]
    v_pk_mul_f32 v[132:133], v[132:133], v[40:41] op_sel_hi:[1,0]
    v_pk_mul_f32 v[134:135], v[134:135], v[40:41] op_sel_hi:[1,0]
    v_pk_fma_f32 v[128:129], v[144:145], v[42:43], v[128:129] op_sel_hi:[1,0,1]
    v_pk_fma_f32 v[130:131], v[146:147], v[42:43], v[130:131] op_sel_hi:[1,0,1]
    v_pk_fma_f32 v[132:133], v[148:149], v[42:43], v[132:133] op_sel_hi:[1,0,1]
    v_pk_fma_f32 v[134:135], v[150:151], v[42:43], v[134:135] op_sel_hi:[1,0,1]
    v_cvt_pk_bf16_f32 v24, v128, v129
    v_cvt_pk_bf16_f32 v25, v130, v131
    v_cvt_pk_bf16_f32 v26, v132, v133
    v_cvt_pk_bf16_f32 v27, v134, v135
    buffer_store_dwordx4 v[24:27], v14, s[36:39], s97 offen offset:0 sc1
    v_pk_mul_f32 v[136:137], v[136:137], v[40:41] op_sel_hi:[1,0]
    v_pk_mul_f32 v[138:139], v[138:139], v[40:41] op_sel_hi:[1,0]
    v_pk_mul_f32 v[140:141], v[140:141], v[40:41] op_sel_hi:[1,0]
    v_pk_mul_f32 v[142:143], v[142:143], v[40:41] op_sel_hi:[1,0]
    v_pk_fma_f32 v[136:137], v[152:153], v[42:43], v[136:137] op_sel_hi:[1,0,1]
    v_pk_fma_f32 v[138:139], v[154:155], v[42:43], v[138:139] op_sel_hi:[1,0,1]
    v_pk_fma_f32 v[140:141], v[156:157], v[42:43], v[140:141] op_sel_hi:[1,0,1]
    v_pk_fma_f32 v[142:143], v[158:159], v[42:43], v[142:143] op_sel_hi:[1,0,1]
    v_cvt_pk_bf16_f32 v28, v136, v137
    v_cvt_pk_bf16_f32 v29, v138, v139
    v_cvt_pk_bf16_f32 v30, v140, v141
    v_cvt_pk_bf16_f32 v31, v142, v143
    buffer_store_dwordx4 v[28:31], v14, s[36:39], s97 offen offset:1024 sc1
    v_and_b32 v8, 31, v2
    v_lshrrev_b32 v9, 5, v2
    v_lshlrev_b32 v10, 3, v9
    s_lshl_b32 s78, s72, 7
    buffer_load_dwordx2 v[32:33], v10, s[64:67], s78 offen offset:0
    buffer_load_dwordx2 v[34:35], v10, s[64:67], s78 offen offset:16
    buffer_load_dwordx2 v[36:37], v10, s[64:67], s78 offen offset:32
    buffer_load_dwordx2 v[38:39], v10, s[64:67], s78 offen offset:48
    buffer_load_dwordx2 v[40:41], v10, s[64:67], s78 offen offset:64
    buffer_load_dwordx2 v[42:43], v10, s[64:67], s78 offen offset:80
    buffer_load_dwordx2 v[44:45], v10, s[64:67], s78 offen offset:96
    buffer_load_dwordx2 v[46:47], v10, s[64:67], s78 offen offset:112
    buffer_load_dwordx4 v[48:51], v14, s[64:67], 0 offen
    buffer_load_dwordx4 v[52:55], v14, s[64:67], 0 offen offset:1024
    s_barrier
    s_lshl_b32 s78, s76, 12
    s_add_u32 s78, s78, 131072
    v_lshl_add_u32 v6, v8, 7, s78
    v_add_u32_e64 v6, v6, v10
    v_bfe_u32 v11, v8, 1, 3
    v_lshl_add_u32 v6, v11, 4, v6
    v_xor_b32 v112, 0, v6
    v_xor_b32 v113, 16, v6
    v_xor_b32 v114, 32, v6
    v_xor_b32 v115, 48, v6
    v_xor_b32_e64 v116, 64, v6
    v_xor_b32 v117, 80, v6
    v_xor_b32 v118, 96, v6
    v_xor_b32 v119, 112, v6
    v_bfe_u32 v11, v2, 2, 2
    v_lshl_add_u32 v12, v9, 2, v11
    v_lshlrev_b32 v12, 7, v12
    v_lshrrev_b32 v11, 1, v11
    v_lshl_add_u32 v12, v11, 6, v12
    v_bfe_u32 v11, v2, 4, 1
    v_lshl_add_u32 v12, v11, 5, v12
    v_and_b32_e64 v11, 3, v2
    v_lshl_add_u32 v12, v11, 3, v12
    s_lshl_b32 s82, s72, 0
    s_and_b32 s82, s82, 12
    s_lshl_b32 s78, s82, 13
    v_add_u32 v4, s78, v12
    v_xor_b32 v5, 64, v4
    s_lshl_b32 s83, s71, 2
    s_add_u32 s83, s83, s76
    s_lshl_b32 s83, s83, 16
    s_add_u32 s83, s83, 4194304
    s_lshl_b32 s82, s82, 12
    s_add_u32 s88, s82, s83
    v_lshlrev_b32_e64 v12, 4, v8
    v_lshl_add_u32 v12, v9, 16, v12
    v_add_u32 v7, 8192, v12
    s_lshl_b32 s94, s71, 17
    s_lshl_b32 s79, s76, 9
    s_add_u32 s94, s94, s79
    s_add_u32 s94, s94, 2097152
    s_lshl_b32 s95, s72, 13
    s_add_u32 s95, s95, s94
    s_lshl_b32 s78, s76, 5
    v_add_u32 v11, s78, v8
    v_and_b32 v13, 7, v8
    v_xor_b32 v13, v13, v9
    v_lshlrev_b32 v13, 4, v13
    v_lshl_add_u32 v13, v11, 8, v13
    v_lshlrev_b32_e64 v10, 3, v11
    v_add_u32 v10, 159744, v10
    s_lshl_b32 s78, s71, 7
    v_add_u32 v11, s78, v11
    s_waitcnt vmcnt(0)
    s_barrier
    ds_read_b64 v[96:97], v112
    ds_read_b64 v[98:99], v113
    ds_read_b64 v[100:101], v114
    ds_read_b64 v[102:103], v115
    ds_read_b64 v[104:105], v116
    ds_read_b64 v[106:107], v117
    ds_read_b64 v[108:109], v118
    ds_read_b64 v[110:111], v119
    v_lshlrev_b32_e64 v60, 16, v32
    v_and_b32 v61, 0xffff0000, v32
    v_lshlrev_b32_e64 v62, 16, v33
    v_and_b32 v63, 0xffff0000, v33
    v_lshlrev_b32_e64 v64, 16, v34
    v_and_b32 v65, 0xffff0000, v34
    v_lshlrev_b32_e64 v66, 16, v35
    v_and_b32 v67, 0xffff0000, v35
    v_lshlrev_b32_e64 v68, 16, v36
    v_and_b32 v69, 0xffff0000, v36
    v_lshlrev_b32_e64 v70, 16, v37
    v_and_b32 v71, 0xffff0000, v37
    v_lshlrev_b32_e64 v72, 16, v38
    v_and_b32 v73, 0xffff0000, v38
    v_lshlrev_b32_e64 v74, 16, v39
    v_and_b32 v75, 0xffff0000, v39
    v_lshlrev_b32_e64 v76, 16, v40
    v_and_b32 v77, 0xffff0000, v40
    v_lshlrev_b32_e64 v78, 16, v41
    v_and_b32 v79, 0xffff0000, v41
    v_lshlrev_b32_e64 v80, 16, v42
    v_and_b32 v81, 0xffff0000, v42
    v_lshlrev_b32_e64 v82, 16, v43
    v_and_b32 v83, 0xffff0000, v43
    v_lshlrev_b32_e64 v84, 16, v44
    v_and_b32 v85, 0xffff0000, v44
    v_lshlrev_b32_e64 v86, 16, v45
    v_and_b32 v87, 0xffff0000, v45
    v_lshlrev_b32_e64 v88, 16, v46
    v_and_b32 v89, 0xffff0000, v46
    v_lshlrev_b32_e64 v90, 16, v47
    v_and_b32 v91, 0xffff0000, v47
    s_mov_b32 s78, 0x3f803f80
    v_dot2_f32_bf16 v126, v48, s78, 0
    v_dot2_f32_bf16 v126, v49, s78, v126
    v_dot2_f32_bf16 v126, v50, s78, v126
    v_dot2_f32_bf16 v126, v51, s78, v126
    v_dot2_f32_bf16 v126, v52, s78, v126
    v_dot2_f32_bf16 v126, v53, s78, v126
    v_dot2_f32_bf16 v126, v54, s78, v126
    v_dot2_f32_bf16 v126, v55, s78, v126
    s_nop 2
    v_add_f32_dpp v126, v126, v126 row_ror:8 row_mask:0xf bank_mask:0xf
    s_nop 1
    v_add_f32_dpp v126, v126, v126 row_ror:4 row_mask:0xf bank_mask:0xf
    s_nop 1
    v_add_f32_dpp v126, v126, v126 row_ror:2 row_mask:0xf bank_mask:0xf
    s_nop 1
    v_add_f32_dpp v126, v126, v126 row_ror:1 row_mask:0xf bank_mask:0xf
    v_mov_b32 v127, v126
    s_nop 1
    v_permlane32_swap_b32 v126, v127
    v_add_f32 v126, v126, v127
    v_mov_b32 v127, v126
    s_nop 1
    v_permlane16_swap_b32 v126, v127
    v_add_f32 v126, v126, v127
    v_mov_b32 v44, 163328
    v_mov_b32_e64 v45, 1
    v_mov_b32 v46, 0xff800000
    v_mov_b32_e64 v47, 0
    ds_write_b64 v44, v[46:47]
    s_lshl_b32 s96, s71, 4
    s_add_u32 s96, s96, s72
    s_lshl_b32 s96, s96, 9
    s_add_u32 s96, s96, 524288
    v_mov_b32 v15, 163584
    ds_read_b32 v15, v15
    s_waitcnt lgkmcnt(0)
    v_readfirstlane_b32 s99, v15
    v_lshlrev_b32 v224, 16, v96
    v_and_b32 v225, 0xffff0000, v96
    v_lshlrev_b32_e64 v226, 16, v97
    v_and_b32 v227, 0xffff0000, v97
L_pad10:
    s_cbranch_execz L_padret
    v_lshlrev_b32 v228, 16, v98
    v_and_b32 v229, 0xffff0000, v98
    v_lshlrev_b32_e64 v230, 16, v99
    v_and_b32 v231, 0xffff0000, v99
    v_lshlrev_b32_e64 v232, 16, v100
    v_and_b32 v233, 0xffff0000, v100
    v_lshlrev_b32_e64 v234, 16, v101
    v_and_b32 v235, 0xffff0000, v101
    v_lshlrev_b32_e64 v236, 16, v102
    v_and_b32 v237, 0xffff0000, v102
    v_lshlrev_b32_e64 v238, 16, v103
    v_and_b32 v239, 0xffff0000, v103
    v_lshlrev_b32_e64 v240, 16, v104
    v_and_b32 v241, 0xffff0000, v104
    v_lshlrev_b32_e64 v242, 16, v105
    v_and_b32 v243, 0xffff0000, v105
    v_lshlrev_b32_e64 v244, 16, v106
    v_and_b32 v245, 0xffff0000, v106
    v_lshlrev_b32_e64 v246, 16, v107
    v_and_b32 v247, 0xffff0000, v107
    v_lshlrev_b32_e64 v248, 16, v108
    v_and_b32 v249, 0xffff0000, v108
    v_lshlrev_b32_e64 v250, 16, v109
    v_and_b32 v251, 0xffff0000, v109
    v_lshlrev_b32_e64 v252, 16, v110
    v_and_b32 v253, 0xffff0000, v110
    v_lshlrev_b32_e64 v254, 16, v111
    v_and_b32 v255, 0xffff0000, v111
    s_mov_b32 s84, 0
    s_barrier
    buffer_load_dwordx4 v[160:163], v14, s[36:39], s88 offen offset:0 sc1
    ds_read_b64_tr_b16 v[128:129], v4 offset:0
    buffer_load_dwordx4 v[164:167], v14, s[36:39], s88 offen offset:1024 sc1
    ds_read_b64_tr_b16 v[130:131], v4 offset:1024
    buffer_load_dwordx4 v[168:171], v14, s[36:39], s88 offen offset:2048 sc1
    ds_read_b64_tr_b16 v[132:133], v5 offset:0
    buffer_load_dwordx4 v[172:175], v14, s[36:39], s88 offen offset:3072 sc1
    s_add_u32 s82, s82, 4096
    s_and_b32 s82, s82, 0xffff
    s_add_u32 s88, s82, s83
    s_nop 0
    ds_read_b64_tr_b16 v[134:135], v5 offset:1024
    buffer_load_dwordx4 v[176:179], v14, s[36:39], s88 offen offset:0 sc1
    ds_read_b64_tr_b16 v[136:137], v4 offset:2048
    buffer_load_dwordx4 v[180:183], v14, s[36:39], s88 offen offset:1024 sc1
    ds_read_b64_tr_b16 v[138:139], v4 offset:3072
    buffer_load_dwordx4 v[184:187], v14, s[36:39], s88 offen offset:2048 sc1
    ds_read_b64_tr_b16 v[140:141], v5 offset:2048
    buffer_load_dwordx4 v[188:191], v14, s[36:39], s88 offen offset:3072 sc1
    s_add_u32 s82, s82, 4096
    s_and_b32 s82, s82, 0xffff
    s_add_u32 s88, s82, s83
    s_nop 0
    ds_read_b64_tr_b16 v[142:143], v5 offset:3072
    buffer_load_dwordx4 v[192:195], v14, s[36:39], s88 offen offset:0 sc1
    buffer_load_dwordx4 v[196:199], v14, s[36:39], s88 offen offset:1024 sc1
    buffer_load_dwordx4 v[200:203], v14, s[36:39], s88 offen offset:2048 sc1
    buffer_load_dwordx4 v[204:207], v14, s[36:39], s88 offen offset:3072 sc1
    s_add_u32 s82, s82, 4096
    s_and_b32 s82, s82, 0xffff
    s_add_u32 s88, s82, s83
    buffer_load_dwordx4 v[208:211], v14, s[36:39], s88 offen offset:0 sc1
    buffer_load_dwordx4 v[212:215], v14, s[36:39], s88 offen offset:1024 sc1
    .p2align 3
L_G2:
    s_add_u32 s84, s84, 1
    s_waitcnt vmcnt(12) lgkmcnt(6)
    v_mfma_f32_32x32x16_bf16 v[224:239], v[128:131], v[160:163], v[224:239]
    ds_read_b64_tr_b16 v[144:145], v4 offset:4096
    ds_read_b64_tr_b16 v[146:147], v4 offset:5120
    buffer_load_dwordx4 v[216:219], v14, s[36:39], s88 offen offset:2048 sc1
    s_waitcnt lgkmcnt(6)
    v_mfma_f32_32x32x16_bf16 v[240:255], v[132:135], v[160:163], v[240:255]
    ds_read_b64_tr_b16 v[148:149], v5 offset:4096
    ds_read_b64_tr_b16 v[150:151], v5 offset:5120
    s_waitcnt lgkmcnt(6)
    v_mfma_f32_32x32x16_bf16 v[224:239], v[136:139], v[164:167], v[224:239]
    ds_read_b64_tr_b16 v[152:153], v4 offset:6144
    ds_read_b64_tr_b16 v[154:155], v4 offset:7168
    buffer_load_dwordx4 v[220:223], v14, s[36:39], s88 offen offset:3072 sc1
    s_add_u32 s82, s82, 4096
    s_and_b32 s82, s82, 0xffff
    s_add_u32 s88, s82, s83
    s_waitcnt lgkmcnt(6)
    v_mfma_f32_32x32x16_bf16 v[240:255], v[140:143], v[164:167], v[240:255]
    ds_read_b64_tr_b16 v[156:157], v5 offset:6144
    ds_read_b64_tr_b16 v[158:159], v5 offset:7168
    v_add_u32 v4, 0x2000, v4
    v_and_b32 v4, 0x1ffff, v4
    v_xor_b32 v5, 64, v4
    s_waitcnt vmcnt(12) lgkmcnt(6)
    v_mfma_f32_32x32x16_bf16 v[224:239], v[144:147], v[168:171], v[224:239]
    ds_read_b64_tr_b16 v[128:129], v4 offset:0
    ds_read_b64_tr_b16 v[130:131], v4 offset:1024
    buffer_load_dwordx4 v[160:163], v14, s[36:39], s88 offen offset:0 sc1
    s_waitcnt lgkmcnt(6)
    v_mfma_f32_32x32x16_bf16 v[240:255], v[148:151], v[168:171], v[240:255]
    ds_read_b64_tr_b16 v[132:133], v5 offset:0
    ds_read_b64_tr_b16 v[134:135], v5 offset:1024
    s_waitcnt lgkmcnt(6)
    v_mfma_f32_32x32x16_bf16 v[224:239], v[152:155], v[172:175], v[224:239]
    ds_read_b64_tr_b16 v[136:137], v4 offset:2048
    ds_read_b64_tr_b16 v[138:139], v4 offset:3072
    buffer_load_dwordx4 v[164:167], v14, s[36:39], s88 offen offset:1024 sc1
    s_waitcnt lgkmcnt(6)
    v_mfma_f32_32x32x16_bf16 v[240:255], v[156:159], v[172:175], v[240:255]
    ds_read_b64_tr_b16 v[140:141], v5 offset:2048
    ds_read_b64_tr_b16 v[142:143], v5 offset:3072
    s_waitcnt vmcnt(12) lgkmcnt(6)
    v_mfma_f32_32x32x16_bf16 v[224:239], v[128:131], v[176:179], v[224:239]
    ds_read_b64_tr_b16 v[144:145], v4 offset:4096
    ds_read_b64_tr_b16 v[146:147], v4 offset:5120
    buffer_load_dwordx4 v[168:171], v14, s[36:39], s88 offen offset:2048 sc1
    s_waitcnt lgkmcnt(6)
    v_mfma_f32_32x32x16_bf16 v[240:255], v[132:135], v[176:179], v[240:255]
    ds_read_b64_tr_b16 v[148:149], v5 offset:4096
    ds_read_b64_tr_b16 v[150:151], v5 offset:5120
    s_waitcnt lgkmcnt(6)
    v_mfma_f32_32x32x16_bf16 v[224:239], v[136:139], v[180:183], v[224:239]
    ds_read_b64_tr_b16 v[152:153], v4 offset:6144
    ds_read_b64_tr_b16 v[154:155], v4 offset:7168
    buffer_load_dwordx4 v[172:175], v14, s[36:39], s88 offen offset:3072 sc1
    s_add_u32 s82, s82, 4096
    s_and_b32 s82, s82, 0xffff
    s_add_u32 s88, s82, s83
    s_waitcnt lgkmcnt(6)
    v_mfma_f32_32x32x16_bf16 v[240:255], v[140:143], v[180:183], v[240:255]
    ds_read_b64_tr_b16 v[156:157], v5 offset:6144
    ds_read_b64_tr_b16 v[158:159], v5 offset:7168
    v_add_u32 v4, 0x2000, v4
    v_and_b32 v4, 0x1ffff, v4
    v_xor_b32 v5, 64, v4
    s_waitcnt vmcnt(12) lgkmcnt(6)
    v_mfma_f32_32x32x16_bf16 v[224:239], v[144:147], v[184:187], v[224:239]
    ds_read_b64_tr_b16 v[128:129], v4 offset:0
    ds_read_b64_tr_b16 v[130:131], v4 offset:1024
    buffer_load_dwordx4 v[176:179], v14, s[36:39], s88 offen offset:0 sc1
    s_waitcnt lgkmcnt(6)
    v_mfma_f32_32x32x16_bf16 v[240:255], v[148:151], v[184:187], v[240:255]
    ds_read_b64_tr_b16 v[132:133], v5 offset:0
    ds_read_b64_tr_b16 v[134:135], v5 offset:1024
    s_waitcnt lgkmcnt(6)
    v_mfma_f32_32x32x16_bf16 v[224:239], v[152:155], v[188:191], v[224:239]
    ds_read_b64_tr_b16 v[136:137], v4 offset:2048
    ds_read_b64_tr_b16 v[138:139], v4 offset:3072
    buffer_load_dwordx4 v[180:183], v14, s[36:39], s88 offen offset:1024 sc1
    s_waitcnt lgkmcnt(6)
    v_mfma_f32_32x32x16_bf16 v[240:255], v[156:159], v[188:191], v[240:255]
    ds_read_b64_tr_b16 v[140:141], v5 offset:2048
    ds_read_b64_tr_b16 v[142:143], v5 offset:3072
    s_waitcnt vmcnt(12) lgkmcnt(6)
    v_mfma_f32_32x32x16_bf16 v[224:239], v[128:131], v[192:195], v[224:239]
    ds_read_b64_tr_b16 v[144:145], v4 offset:4096
    ds_read_b64_tr_b16 v[146:147], v4 offset:5120
    buffer_load_dwordx4 v[184:187], v14, s[36:39], s88 offen offset:2048 sc1
    s_waitcnt lgkmcnt(6)
    v_mfma_f32_32x32x16_bf16 v[240:255], v[132:135], v[192:195], v[240:255]
    ds_read_b64_tr_b16 v[148:149], v5 offset:4096
    ds_read_b64_tr_b16 v[150:151], v5 offset:5120
    s_waitcnt lgkmcnt(6)
    v_mfma_f32_32x32x16_bf16 v[224:239], v[136:139], v[196:199], v[224:239]
    ds_read_b64_tr_b16 v[152:153], v4 offset:6144
    ds_read_b64_tr_b16 v[154:155], v4 offset:7168
    buffer_load_dwordx4 v[188:191], v14, s[36:39], s88 offen offset:3072 sc1
    s_add_u32 s82, s82, 4096
    s_and_b32 s82, s82, 0xffff
    s_add_u32 s88, s82, s83
    s_waitcnt lgkmcnt(6)
    v_mfma_f32_32x32x16_bf16 v[240:255], v[140:143], v[196:199], v[240:255]
    ds_read_b64_tr_b16 v[156:157], v5 offset:6144
    ds_read_b64_tr_b16 v[158:159], v5 offset:7168
    v_add_u32 v4, 0x2000, v4
    v_and_b32 v4, 0x1ffff, v4
    v_xor_b32 v5, 64, v4
    s_waitcnt vmcnt(12) lgkmcnt(6)
    v_mfma_f32_32x32x16_bf16 v[224:239], v[144:147], v[200:203], v[224:239]
    ds_read_b64_tr_b16 v[128:129], v4 offset:0
    ds_read_b64_tr_b16 v[130:131], v4 offset:1024
    buffer_load_dwordx4 v[192:195], v14, s[36:39], s88 offen offset:0 sc1
    s_waitcnt lgkmcnt(6)
    v_mfma_f32_32x32x16_bf16 v[240:255], v[148:151], v[200:203], v[240:255]
    ds_read_b64_tr_b16 v[132:133], v5 offset:0
    ds_read_b64_tr_b16 v[134:135], v5 offset:1024
    s_waitcnt lgkmcnt(6)
    v_mfma_f32_32x32x16_bf16 v[224:239], v[152:155], v[204:207], v[224:239]
    ds_read_b64_tr_b16 v[136:137], v4 offset:2048
    ds_read_b64_tr_b16 v[138:139], v4 offset:3072
    buffer_load_dwordx4 v[196:199], v14, s[36:39], s88 offen offset:1024 sc1
    s_waitcnt lgkmcnt(6)
    v_mfma_f32_32x32x16_bf16 v[240:255], v[156:159], v[204:207], v[240:255]
    ds_read_b64_tr_b16 v[140:141], v5 offset:2048
    ds_read_b64_tr_b16 v[142:143], v5 offset:3072
    s_waitcnt vmcnt(12) lgkmcnt(6)
    v_mfma_f32_32x32x16_bf16 v[224:239], v[128:131], v[208:211], v[224:239]
    ds_read_b64_tr_b16 v[144:145], v4 offset:4096
    ds_read_b64_tr_b16 v[146:147], v4 offset:5120
    buffer_load_dwordx4 v[200:203], v14, s[36:39], s88 offen offset:2048 sc1
    s_waitcnt lgkmcnt(6)
    v_mfma_f32_32x32x16_bf16 v[240:255], v[132:135], v[208:211], v[240:255]
    ds_read_b64_tr_b16 v[148:149], v5 offset:4096
    ds_read_b64_tr_b16 v[150:151], v5 offset:5120
    s_waitcnt lgkmcnt(6)
    v_mfma_f32_32x32x16_bf16 v[224:239], v[136:139], v[212:215], v[224:239]
    ds_read_b64_tr_b16 v[152:153], v4 offset:6144
    ds_read_b64_tr_b16 v[154:155], v4 offset:7168
    buffer_load_dwordx4 v[204:207], v14, s[36:39], s88 offen offset:3072 sc1
    s_add_u32 s82, s82, 4096
    s_and_b32 s82, s82, 0xffff
    s_add_u32 s88, s82, s83
    s_waitcnt lgkmcnt(6)
    v_mfma_f32_32x32x16_bf16 v[240:255], v[140:143], v[212:215], v[240:255]
    ds_read_b64_tr_b16 v[156:157], v5 offset:6144
    ds_read_b64_tr_b16 v[158:159], v5 offset:7168
    v_add_u32 v4, 0x2000, v4
    v_and_b32 v4, 0x1ffff, v4
    v_xor_b32 v5, 64, v4
    s_waitcnt vmcnt(12) lgkmcnt(6)
    v_mfma_f32_32x32x16_bf16 v[224:239], v[144:147], v[216:219], v[224:239]
    ds_read_b64_tr_b16 v[128:129], v4 offset:0
    ds_read_b64_tr_b16 v[130:131], v4 offset:1024
    buffer_load_dwordx4 v[208:211], v14, s[36:39], s88 offen offset:0 sc1
    s_waitcnt lgkmcnt(6)
    v_mfma_f32_32x32x16_bf16 v[240:255], v[148:151], v[216:219], v[240:255]
    ds_read_b64_tr_b16 v[132:133], v5 offset:0
    ds_read_b64_tr_b16 v[134:135], v5 offset:1024
    s_waitcnt lgkmcnt(6)
    v_mfma_f32_32x32x16_bf16 v[224:239], v[152:155], v[220:223], v[224:239]
    ds_read_b64_tr_b16 v[136:137], v4 offset:2048
    ds_read_b64_tr_b16 v[138:139], v4 offset:3072
    buffer_load_dwordx4 v[212:215], v14, s[36:39], s88 offen offset:1024 sc1
    s_waitcnt lgkmcnt(6)
    v_mfma_f32_32x32x16_bf16 v[240:255], v[156:159], v[220:223], v[240:255]
    ds_read_b64_tr_b16 v[140:141], v5 offset:2048
    ds_read_b64_tr_b16 v[142:143], v5 offset:3072
    s_cmp_lt_u32 s84, 3
    s_cbranch_scc1 L_G2
    s_waitcnt vmcnt(12) lgkmcnt(6)
    v_mfma_f32_32x32x16_bf16 v[224:239], v[128:131], v[160:163], v[224:239]
    ds_read_b64_tr_b16 v[144:145], v4 offset:4096
    ds_read_b64_tr_b16 v[146:147], v4 offset:5120
    buffer_load_dwordx4 v[216:219], v14, s[36:39], s88 offen offset:2048 sc1
    s_waitcnt lgkmcnt(6)
    v_mfma_f32_32x32x16_bf16 v[240:255], v[132:135], v[160:163], v[240:255]
    ds_read_b64_tr_b16 v[148:149], v5 offset:4096
    ds_read_b64_tr_b16 v[150:151], v5 offset:5120
    s_waitcnt lgkmcnt(6)
    v_mfma_f32_32x32x16_bf16 v[224:239], v[136:139], v[164:167], v[224:239]
    ds_read_b64_tr_b16 v[152:153], v4 offset:6144
    ds_read_b64_tr_b16 v[154:155], v4 offset:7168
    buffer_load_dwordx4 v[220:223], v14, s[36:39], s88 offen offset:3072 sc1
    s_add_u32 s82, s82, 4096
    s_and_b32 s82, s82, 0xffff
    s_add_u32 s88, s82, s83
    s_waitcnt lgkmcnt(6)
    v_mfma_f32_32x32x16_bf16 v[240:255], v[140:143], v[164:167], v[240:255]
    ds_read_b64_tr_b16 v[156:157], v5 offset:6144
    ds_read_b64_tr_b16 v[158:159], v5 offset:7168
    s_barrier
    v_add_u32 v4, 0x2000, v4
    v_and_b32 v4, 0x1ffff, v4
    v_xor_b32_e64 v5, 64, v4
    s_waitcnt vmcnt(12) lgkmcnt(6)
    v_mfma_f32_32x32x16_bf16 v[224:239], v[144:147], v[168:171], v[224:239]
    ds_read_b64_tr_b16 v[128:129], v4 offset:0
    ds_read_b64_tr_b16 v[130:131], v4 offset:1024
    s_waitcnt lgkmcnt(6)
    v_mfma_f32_32x32x16_bf16 v[240:255], v[148:151], v[168:171], v[240:255]
    ds_read_b64_tr_b16 v[132:133], v5 offset:0
    ds_read_b64_tr_b16 v[134:135], v5 offset:1024
    s_waitcnt lgkmcnt(6)
    v_mfma_f32_32x32x16_bf16 v[224:239], v[152:155], v[172:175], v[224:239]
    ds_read_b64_tr_b16 v[136:137], v4 offset:2048
    ds_read_b64_tr_b16 v[138:139], v4 offset:3072
    s_waitcnt lgkmcnt(6)
    v_mfma_f32_32x32x16_bf16 v[240:255], v[156:159], v[172:175], v[240:255]
    ds_read_b64_tr_b16 v[140:141], v5 offset:2048
    ds_read_b64_tr_b16 v[142:143], v5 offset:3072
    s_waitcnt vmcnt(10) lgkmcnt(6)
    v_mfma_f32_32x32x16_bf16 v[224:239], v[128:131], v[176:179], v[224:239]
    ds_read_b64_tr_b16 v[144:145], v4 offset:4096
    ds_read_b64_tr_b16 v[146:147], v4 offset:5120
    s_waitcnt lgkmcnt(6)
    v_mfma_f32_32x32x16_bf16 v[240:255], v[132:135], v[176:179], v[240:255]
    ds_read_b64_tr_b16 v[148:149], v5 offset:4096
    ds_read_b64_tr_b16 v[150:151], v5 offset:5120
    s_waitcnt lgkmcnt(6)
    v_mfma_f32_32x32x16_bf16 v[224:239], v[136:139], v[180:183], v[224:239]
    ds_read_b64_tr_b16 v[152:153], v4 offset:6144
L_pad11:
    s_cbranch_execz L_padret
    ds_read_b64_tr_b16 v[154:155], v4 offset:7168
    s_waitcnt lgkmcnt(6)
    v_mfma_f32_32x32x16_bf16 v[240:255], v[140:143], v[180:183], v[240:255]
    ds_read_b64_tr_b16 v[156:157], v5 offset:6144
    ds_read_b64_tr_b16 v[158:159], v5 offset:7168
    v_add_u32 v4, 0x2000, v4
    v_and_b32 v4, 0x1ffff, v4
    v_xor_b32 v5, 64, v4
    s_waitcnt vmcnt(8) lgkmcnt(6)
    v_mfma_f32_32x32x16_bf16 v[224:239], v[144:147], v[184:187], v[224:239]
    ds_read_b64_tr_b16 v[128:129], v4 offset:0
    ds_read_b64_tr_b16 v[130:131], v4 offset:1024
    s_waitcnt lgkmcnt(6)
    v_mfma_f32_32x32x16_bf16 v[240:255], v[148:151], v[184:187], v[240:255]
    ds_read_b64_tr_b16 v[132:133], v5 offset:0
    ds_read_b64_tr_b16 v[134:135], v5 offset:1024
    s_waitcnt lgkmcnt(6)
    v_mfma_f32_32x32x16_bf16 v[224:239], v[152:155], v[188:191], v[224:239]
    ds_read_b64_tr_b16 v[136:137], v4 offset:2048
    ds_read_b64_tr_b16 v[138:139], v4 offset:3072
    s_waitcnt lgkmcnt(6)
    v_mfma_f32_32x32x16_bf16 v[240:255], v[156:159], v[188:191], v[240:255]
    ds_read_b64_tr_b16 v[140:141], v5 offset:2048
    ds_read_b64_tr_b16 v[142:143], v5 offset:3072
    s_waitcnt vmcnt(6) lgkmcnt(6)
    v_mfma_f32_32x32x16_bf16 v[224:239], v[128:131], v[192:195], v[224:239]
    ds_read_b64_tr_b16 v[144:145], v4 offset:4096
    ds_read_b64_tr_b16 v[146:147], v4 offset:5120
    s_waitcnt lgkmcnt(6)
    v_mfma_f32_32x32x16_bf16 v[240:255], v[132:135], v[192:195], v[240:255]
    ds_read_b64_tr_b16 v[148:149], v5 offset:4096
    ds_read_b64_tr_b16 v[150:151], v5 offset:5120
    s_waitcnt lgkmcnt(6)
    v_mfma_f32_32x32x16_bf16 v[224:239], v[136:139], v[196:199], v[224:239]
    ds_read_b64_tr_b16 v[152:153], v4 offset:6144
    ds_read_b64_tr_b16 v[154:155], v4 offset:7168
    s_waitcnt lgkmcnt(6)
    v_mfma_f32_32x32x16_bf16 v[240:255], v[140:143], v[196:199], v[240:255]
    ds_read_b64_tr_b16 v[156:157], v5 offset:6144
    ds_read_b64_tr_b16 v[158:159], v5 offset:7168
    v_add_u32 v4, 0x2000, v4
    v_and_b32 v4, 0x1ffff, v4
    v_xor_b32_e64 v5, 64, v4
    s_waitcnt vmcnt(4) lgkmcnt(6)
    v_mfma_f32_32x32x16_bf16 v[224:239], v[144:147], v[200:203], v[224:239]
    ds_read_b64_tr_b16 v[128:129], v4 offset:0
    ds_read_b64_tr_b16 v[130:131], v4 offset:1024
    s_waitcnt lgkmcnt(6)
    v_mfma_f32_32x32x16_bf16 v[240:255], v[148:151], v[200:203], v[240:255]
    ds_read_b64_tr_b16 v[132:133], v5 offset:0
    ds_read_b64_tr_b16 v[134:135], v5 offset:1024
    s_waitcnt lgkmcnt(6)
    v_mfma_f32_32x32x16_bf16 v[224:239], v[152:155], v[204:207], v[224:239]
    ds_read_b64_tr_b16 v[136:137], v4 offset:2048
    ds_read_b64_tr_b16 v[138:139], v4 offset:3072
    s_waitcnt lgkmcnt(6)
    v_mfma_f32_32x32x16_bf16 v[240:255], v[156:159], v[204:207], v[240:255]
    ds_read_b64_tr_b16 v[140:141], v5 offset:2048
    ds_read_b64_tr_b16 v[142:143], v5 offset:3072
    s_waitcnt vmcnt(2) lgkmcnt(6)
    v_mfma_f32_32x32x16_bf16 v[224:239], v[128:131], v[208:211], v[224:239]
    ds_read_b64_tr_b16 v[144:145], v4 offset:4096
    ds_read_b64_tr_b16 v[146:147], v4 offset:5120
    s_waitcnt lgkmcnt(6)
    v_mfma_f32_32x32x16_bf16 v[240:255], v[132:135], v[208:211], v[240:255]
    ds_read_b64_tr_b16 v[148:149], v5 offset:4096
    ds_read_b64_tr_b16 v[150:151], v5 offset:5120
    s_waitcnt lgkmcnt(6)
    v_mfma_f32_32x32x16_bf16 v[224:239], v[136:139], v[212:215], v[224:239]
    ds_read_b64_tr_b16 v[152:153], v4 offset:6144
    ds_read_b64_tr_b16 v[154:155], v4 offset:7168
    s_waitcnt lgkmcnt(6)
    v_mfma_f32_32x32x16_bf16 v[240:255], v[140:143], v[212:215], v[240:255]
    ds_read_b64_tr_b16 v[156:157], v5 offset:6144
    ds_read_b64_tr_b16 v[158:159], v5 offset:7168
    s_waitcnt vmcnt(0) lgkmcnt(6)
    v_mfma_f32_32x32x16_bf16 v[224:239], v[144:147], v[216:219], v[224:239]
    s_waitcnt lgkmcnt(4)
    v_mfma_f32_32x32x16_bf16 v[240:255], v[148:151], v[216:219], v[240:255]
    s_waitcnt lgkmcnt(2)
    v_mfma_f32_32x32x16_bf16 v[224:239], v[152:155], v[220:223], v[224:239]
    s_waitcnt lgkmcnt(0)
    v_mfma_f32_32x32x16_bf16 v[240:255], v[156:159], v[220:223], v[240:255]
    s_nop 9
    v_pk_mul_f32 v[18:19], v[224:225], v[224:225]
    v_pk_mul_f32 v[20:21], v[224:225], v[60:61]
    v_pk_add_f32 v[16:17], v[224:225], v[226:227]
    v_pk_fma_f32 v[18:19], v[226:227], v[226:227], v[18:19]
    v_pk_fma_f32 v[20:21], v[226:227], v[62:63], v[20:21]
    v_pk_add_f32 v[16:17], v[16:17], v[228:229]
    v_pk_fma_f32 v[18:19], v[228:229], v[228:229], v[18:19]
    v_pk_fma_f32 v[20:21], v[228:229], v[64:65], v[20:21]
    v_pk_add_f32 v[16:17], v[16:17], v[230:231]
    v_pk_fma_f32 v[18:19], v[230:231], v[230:231], v[18:19]
    v_pk_fma_f32 v[20:21], v[230:231], v[66:67], v[20:21]
    v_pk_add_f32 v[16:17], v[16:17], v[232:233]
    v_pk_fma_f32 v[18:19], v[232:233], v[232:233], v[18:19]
    v_pk_fma_f32 v[20:21], v[232:233], v[68:69], v[20:21]
    v_pk_add_f32 v[16:17], v[16:17], v[234:235]
    v_pk_fma_f32 v[18:19], v[234:235], v[234:235], v[18:19]
    v_pk_fma_f32 v[20:21], v[234:235], v[70:71], v[20:21]
    v_pk_add_f32 v[16:17], v[16:17], v[236:237]
    v_pk_fma_f32 v[18:19], v[236:237], v[236:237], v[18:19]
    v_pk_fma_f32 v[20:21], v[236:237], v[72:73], v[20:21]
    v_pk_add_f32 v[16:17], v[16:17], v[238:239]
    v_pk_fma_f32 v[18:19], v[238:239], v[238:239], v[18:19]
    v_pk_fma_f32 v[20:21], v[238:239], v[74:75], v[20:21]
    v_pk_add_f32 v[16:17], v[16:17], v[240:241]
    v_pk_fma_f32 v[18:19], v[240:241], v[240:241], v[18:19]
    v_pk_fma_f32 v[20:21], v[240:241], v[76:77], v[20:21]
    v_pk_add_f32 v[16:17], v[16:17], v[242:243]
    v_pk_fma_f32 v[18:19], v[242:243], v[242:243], v[18:19]
    v_pk_fma_f32 v[20:21], v[242:243], v[78:79], v[20:21]
    v_pk_add_f32 v[16:17], v[16:17], v[244:245]
    v_pk_fma_f32 v[18:19], v[244:245], v[244:245], v[18:19]
    v_pk_fma_f32 v[20:21], v[244:245], v[80:81], v[20:21]
    v_pk_add_f32 v[16:17], v[16:17], v[246:247]
    v_pk_fma_f32 v[18:19], v[246:247], v[246:247], v[18:19]
    v_pk_fma_f32 v[20:21], v[246:247], v[82:83], v[20:21]
    v_pk_add_f32 v[16:17], v[16:17], v[248:249]
    v_pk_fma_f32 v[18:19], v[248:249], v[248:249], v[18:19]
    v_pk_fma_f32 v[20:21], v[248:249], v[84:85], v[20:21]
    v_pk_add_f32 v[16:17], v[16:17], v[250:251]
    v_pk_fma_f32 v[18:19], v[250:251], v[250:251], v[18:19]
    v_pk_fma_f32 v[20:21], v[250:251], v[86:87], v[20:21]
    v_pk_add_f32 v[16:17], v[16:17], v[252:253]
    v_pk_fma_f32 v[18:19], v[252:253], v[252:253], v[18:19]
    v_pk_fma_f32 v[20:21], v[252:253], v[88:89], v[20:21]
    v_pk_add_f32 v[16:17], v[16:17], v[254:255]
    v_pk_fma_f32 v[18:19], v[254:255], v[254:255], v[18:19]
    v_pk_fma_f32 v[20:21], v[254:255], v[90:91], v[20:21]
    v_mov_b32 v27, s75
    v_add_f32 v24, v16, v17
    v_add_f32 v25, v18, v19
    v_add_f32 v26, v20, v21
    v_mov_b32 v28, v24
    v_mov_b32 v29, v25
    v_mov_b32 v30, v26
    v_permlane32_swap_b32 v24, v28
    v_permlane32_swap_b32 v25, v29
    v_permlane32_swap_b32 v26, v30
    v_pk_add_f32 v[24:25], v[24:25], v[28:29]
    v_add_f32 v26, v26, v30
    s_mov_b32 exec_hi, 0
    s_bitcmp1_b32 s99, 0
    s_cbranch_scc0 Lls_47
    buffer_store_dwordx4 v[24:27], v14, s[36:39], s95 offen
Lle_48:
    s_mov_b32 exec_hi, -1
    s_add_u32 s79, s94, 16384
    s_add_u32 s80, s94, 32768
    s_add_u32 s81, s94, 49152
    s_barrier
    v_xor_b32_e64 v112, 0, v13
    ds_write_b128 v112, v[224:227]
    v_xor_b32_e64 v113, 32, v13
    ds_write_b128 v113, v[228:231]
    v_xor_b32_e64 v114, 64, v13
    ds_write_b128 v114, v[232:235]
    buffer_load_dwordx4 v[64:67], v12, s[36:39], s94 offen offset:0 sc1
    buffer_load_dwordx4 v[68:71], v7, s[36:39], s94 offen offset:0 sc1
    buffer_load_dwordx4 v[72:75], v12, s[36:39], s79 offen offset:0 sc1
    buffer_load_dwordx4 v[76:79], v7, s[36:39], s79 offen offset:0 sc1
    buffer_load_dwordx4 v[80:83], v12, s[36:39], s80 offen offset:0 sc1
    buffer_load_dwordx4 v[84:87], v7, s[36:39], s80 offen offset:0 sc1
    buffer_load_dwordx4 v[88:91], v12, s[36:39], s81 offen offset:0 sc1
    buffer_load_dwordx4 v[92:95], v7, s[36:39], s81 offen offset:0 sc1
    v_xor_b32 v115, 96, v13
    ds_write_b128 v115, v[236:239]
    v_xor_b32 v116, 128, v13
    ds_write_b128 v116, v[240:243]
    v_xor_b32 v117, 160, v13
    ds_write_b128 v117, v[244:247]
    v_xor_b32 v118, 192, v13
    ds_write_b128 v118, v[248:251]
    v_xor_b32 v119, 224, v13
    ds_write_b128 v119, v[252:255]
    s_mov_b32 s85, 1
L_gchk:
    s_waitcnt vmcnt(0)
    v_max3_u32 v16, v67, v71, v75
    v_max3_u32 v16, v16, v79, v83
    v_max3_u32 v16, v16, v87, v91
    v_max3_u32 v16, v16, v95, s75
    v_min3_u32 v17, v67, v71, v75
    v_min3_u32 v17, v17, v79, v83
    v_min3_u32 v17, v17, v87, v91
    v_min3_u32 v17, v17, v95, s75
    v_cmp_ne_u32_e64 vcc, v16, v17
    s_cbranch_vccnz Lspin_49
    s_barrier
    v_pk_add_f32 v[64:65], v[64:65], v[68:69]
    v_add_f32_e64 v66, v66, v70
    v_pk_add_f32 v[72:73], v[72:73], v[76:77]
    v_add_f32_e64 v74, v74, v78
    v_pk_add_f32 v[80:81], v[80:81], v[84:85]
    v_add_f32_e64 v82, v82, v86
    v_pk_add_f32 v[88:89], v[88:89], v[92:93]
    v_add_f32_e64 v90, v90, v94
    v_pk_add_f32 v[64:65], v[64:65], v[72:73]
    v_add_f32_e64 v66, v66, v74
    v_pk_add_f32 v[80:81], v[80:81], v[88:89]
    v_add_f32 v82, v82, v90
    v_add_f32 v24, v64, v80
    v_add_f32 v25, v65, v81
    v_add_f32 v26, v66, v82
    v_mov_b32 v28, v24
    v_mov_b32 v29, v25
    v_mov_b32 v30, v26
    v_permlane32_swap_b32 v24, v28
    v_permlane32_swap_b32 v25, v29
    v_permlane32_swap_b32 v26, v30
    v_pk_add_f32 v[24:25], v[24:25], v[28:29]
    v_add_f32_e64 v26, v26, v30
    v_mul_f32 v36, 0x3a800000, v24
    v_mul_f32 v40, 0x3a800000, v25
    v_fma_f32 v40, -v36, v36, v40
    v_max_f32_e64 v40, 0, v40
    v_cvt_pk_bf16_f32 v36, v36, v36
    v_and_b32 v36, 0xffff0000, v36
    v_cvt_pk_bf16_f32 v40, v40, v40
    v_and_b32 v40, 0xffff0000, v40
    v_add_f32 v40, 0x3727c5ac, v40
    v_cvt_pk_bf16_f32 v40, v40, v40
    v_and_b32 v40, 0xffff0000, v40
    v_sqrt_f32 v40, v40
    s_nop 0
    v_cvt_pk_bf16_f32 v40, v40, v40
    v_and_b32 v40, 0xffff0000, v40
    v_rcp_f32_e64 v38, v40
    v_fma_f32 v42, -v36, v126, v26
    s_mov_b32 s79, 0xfffff800
    v_mul_f32_e64 v42, v42, v38
    v_mul_f32 v39, -v36, v38
    v_and_or_b32 v42, v42, s79, v11
    s_mov_b32 exec_hi, 0
    ds_write_b64 v10, v[38:39]
    ds_max_f32 v44, v42
    s_mov_b32 exec_lo, 1
    ds_add_rtn_u32 v46, v44, v45 offset:4
    s_mov_b32 exec_lo, -1
    ds_read_b32 v20, v44
    v_lshlrev_b32 v17, 3, v2
    v_lshlrev_b32 v18, 2, v2
    v_mov_b32_e64 v21, s75
    s_mov_b32 s79, s96
    s_waitcnt lgkmcnt(0)
    v_readfirstlane_b32 s78, v46
    s_cmp_lg_u32 s78, 3
    s_cbranch_scc1 L_nocand
    s_mov_b32 exec_lo, 0xffff
    buffer_store_dwordx2 v[20:21], v17, s[36:39], s79 offen offset:128 sc1
    s_mov_b32 exec_lo, -1
    v_and_b32 v22, 127, v20
    v_and_b32 v23, 7, v20
    v_lshlrev_b32 v23, 4, v23
    v_xor_b32 v23, v23, v17
    v_lshl_add_u32 v23, v22, 8, v23
    v_lshlrev_b32_e64 v22, 3, v22
    ds_read_b64 v[24:25], v23
    v_add_u32 v22, 159744, v22
    ds_read_b64 v[26:27], v22
    s_waitcnt lgkmcnt(0)
    v_fma_f32 v28, v24, v26, v27
    v_fma_f32 v29, v25, v26, v27
    v_cvt_pk_bf16_f32 v30, v28, v29
    buffer_store_dword v30, v18, s[36:39], s79 offen sc1
    v_add_f32 v28, v28, v24
    v_add_f32_e64 v29, v29, v25
    buffer_store_dwordx2 v[28:29], v17, s[36:39], s79 offen offset:256 sc1
L_nocand:
    s_mov_b32 exec_hi, -1
    v_lshrrev_b32 v16, 3, v2
    v_and_b32 v17, 7, v2
    s_lshl_b32 s78, s76, 5
    v_add_u32 v18, s78, v16
    v_lshlrev_b32 v19, 1, v17
    v_xor_b32 v19, v19, v16
    v_lshlrev_b32 v19, 4, v19
    v_lshl_add_u32 v19, v18, 8, v19
    v_xor_b32 v32, 16, v19
    v_lshlrev_b32 v33, 3, v18
    v_add_u32 v33, 159744, v33
    ds_read_b128 v[64:67], v19 offset:0
    ds_read_b128 v[68:71], v32 offset:0
    ds_read_b64 v[96:97], v33 offset:0
    ds_read_b128 v[72:75], v19 offset:2048
    ds_read_b128 v[76:79], v32 offset:2048
    ds_read_b64 v[98:99], v33 offset:64
    ds_read_b128 v[80:83], v19 offset:4096
    ds_read_b128 v[84:87], v32 offset:4096
    ds_read_b64 v[100:101], v33 offset:128
    ds_read_b128 v[88:91], v19 offset:6144
    ds_read_b128 v[92:95], v32 offset:6144
    ds_read_b64 v[102:103], v33 offset:192
    s_lshl_b32 s78, s71, 7
    v_add_u32_e64 v18, s78, v18
    s_lshl_b32 s79, s72, 7
    v_lshl_add_u32 v19, v18, 11, s79
    v_lshl_add_u32 v19, v17, 4, v19
L_pad12:
    s_cbranch_execz L_padret
    v_mov_b32 v16, 163360
    s_waitcnt lgkmcnt(0)
    v_add_f32_e64 v96, 1.0, v96
    v_pk_fma_f32 v[64:65], v[64:65], v[96:97], v[96:97] op_sel:[0,0,1] op_sel_hi:[1,0,1]
    v_pk_fma_f32 v[66:67], v[66:67], v[96:97], v[96:97] op_sel:[0,0,1] op_sel_hi:[1,0,1]
    v_pk_fma_f32 v[68:69], v[68:69], v[96:97], v[96:97] op_sel:[0,0,1] op_sel_hi:[1,0,1]
    v_pk_fma_f32 v[70:71], v[70:71], v[96:97], v[96:97] op_sel:[0,0,1] op_sel_hi:[1,0,1]
    v_cvt_pk_bf16_f32 v104, v64, v65
    v_cvt_pk_bf16_f32 v105, v66, v67
    v_cvt_pk_bf16_f32 v106, v68, v69
    v_cvt_pk_bf16_f32 v107, v70, v71
    v_add_f32_e64 v98, 1.0, v98
    v_pk_fma_f32 v[72:73], v[72:73], v[98:99], v[98:99] op_sel:[0,0,1] op_sel_hi:[1,0,1]
    v_pk_fma_f32 v[74:75], v[74:75], v[98:99], v[98:99] op_sel:[0,0,1] op_sel_hi:[1,0,1]
    v_pk_fma_f32 v[76:77], v[76:77], v[98:99], v[98:99] op_sel:[0,0,1] op_sel_hi:[1,0,1]
    v_pk_fma_f32 v[78:79], v[78:79], v[98:99], v[98:99] op_sel:[0,0,1] op_sel_hi:[1,0,1]
    v_cvt_pk_bf16_f32 v108, v72, v73
    v_cvt_pk_bf16_f32 v109, v74, v75
    v_cvt_pk_bf16_f32 v110, v76, v77
    v_cvt_pk_bf16_f32 v111, v78, v79
    v_add_f32_e64 v100, 1.0, v100
    v_pk_fma_f32 v[80:81], v[80:81], v[100:101], v[100:101] op_sel:[0,0,1] op_sel_hi:[1,0,1]
    v_pk_fma_f32 v[82:83], v[82:83], v[100:101], v[100:101] op_sel:[0,0,1] op_sel_hi:[1,0,1]
    v_pk_fma_f32 v[84:85], v[84:85], v[100:101], v[100:101] op_sel:[0,0,1] op_sel_hi:[1,0,1]
    v_pk_fma_f32 v[86:87], v[86:87], v[100:101], v[100:101] op_sel:[0,0,1] op_sel_hi:[1,0,1]
    v_cvt_pk_bf16_f32 v112, v80, v81
    v_cvt_pk_bf16_f32 v113, v82, v83
    v_cvt_pk_bf16_f32 v114, v84, v85
    v_cvt_pk_bf16_f32 v115, v86, v87
    v_add_f32_e64 v102, 1.0, v102
    v_pk_fma_f32 v[88:89], v[88:89], v[102:103], v[102:103] op_sel:[0,0,1] op_sel_hi:[1,0,1]
    v_pk_fma_f32 v[90:91], v[90:91], v[102:103], v[102:103] op_sel:[0,0,1] op_sel_hi:[1,0,1]
    v_pk_fma_f32 v[92:93], v[92:93], v[102:103], v[102:103] op_sel:[0,0,1] op_sel_hi:[1,0,1]
    v_pk_fma_f32 v[94:95], v[94:95], v[102:103], v[102:103] op_sel:[0,0,1] op_sel_hi:[1,0,1]
    v_cvt_pk_bf16_f32 v116, v88, v89
    v_cvt_pk_bf16_f32 v117, v90, v91
    v_cvt_pk_bf16_f32 v118, v92, v93
    v_cvt_pk_bf16_f32 v119, v94, v95
    s_barrier
    ds_read_b32 v17, v16
    s_waitcnt lgkmcnt(0)
    v_and_b32 v17, 0x7ff, v17
    v_sub_u32 v17, v17, v18
    s_barrier
    s_mov_b32 s78, 0
    v_cmp_ne_u32 vcc, 0, v17
    s_mov_b64 exec, vcc
    s_cbranch_execz Lo_50
    buffer_store_dwordx4 v[104:107], v19, s[44:47], s78 offen sc1
Lo_50:
    s_mov_b64 exec, -1
    s_mov_b32 s78, 16384
    v_cmp_ne_u32 vcc, 8, v17
    s_mov_b64 exec, vcc
    s_cbranch_execz Lo_51
    buffer_store_dwordx4 v[108:111], v19, s[44:47], s78 offen sc1
Lo_51:
    s_mov_b64 exec, -1
    s_barrier
    s_mov_b32 s78, 32768
    v_cmp_ne_u32_e64 vcc, 16, v17
    s_mov_b64 exec, vcc
    s_cbranch_execz Lo_52
    buffer_store_dwordx4 v[112:115], v19, s[44:47], s78 offen sc1
Lo_52:
    s_mov_b64 exec, -1
    s_mov_b32 s78, 49152
    v_cmp_ne_u32 vcc, 24, v17
    s_mov_b64 exec, vcc
    s_cbranch_execz Lo_53
    buffer_store_dwordx4 v[116:119], v19, s[44:47], s78 offen sc1
Lo_53:
    s_mov_b64 exec, -1
    s_branch L_fin
L_pad13:
    s_cbranch_execz L_padret
    s_endpgm
Lspin_49:
    buffer_load_dwordx4 v[64:67], v12, s[36:39], s94 offen offset:0 sc1
    buffer_load_dwordx4 v[68:71], v7, s[36:39], s94 offen offset:0 sc1
    buffer_load_dwordx4 v[72:75], v12, s[36:39], s79 offen offset:0 sc1
    buffer_load_dwordx4 v[76:79], v7, s[36:39], s79 offen offset:0 sc1
    buffer_load_dwordx4 v[80:83], v12, s[36:39], s80 offen offset:0 sc1
    buffer_load_dwordx4 v[84:87], v7, s[36:39], s80 offen offset:0 sc1
    buffer_load_dwordx4 v[88:91], v12, s[36:39], s81 offen offset:0 sc1
    buffer_load_dwordx4 v[92:95], v7, s[36:39], s81 offen offset:0 sc1
    s_add_u32 s85, s85, 1
    s_cmp_gt_u32 s85, 400000
    s_cbranch_scc1 L_end
    s_branch L_gchk
L_kvspin:
    buffer_load_dwordx4 v[96:99], v11, s[36:39], s94 offen offset:0 sc1
    buffer_load_dwordx4 v[100:103], v11, s[36:39], s94 offen offset:2048 sc1
    buffer_load_dwordx4 v[104:107], v11, s[36:39], s95 offen offset:0 sc1
    buffer_load_dwordx4 v[108:111], v11, s[36:39], s95 offen offset:2048 sc1
    s_add_u32 s85, s85, 1
    s_cmp_gt_u32 s85, 400000
    s_cbranch_scc1 L_end
    s_nop 3
    s_branch L_kvchk
Lls_47:
    buffer_store_dwordx4 v[24:27], v14, s[36:39], s95 offen sc1
    s_nop 1
    s_branch Lle_48
L_fin:
L_end:
    s_endpgm
.fill 64, 4, 0xbf800000
s_endpgm
.section .rodata,"a"
.p2align 6
.amdhsa_kernel sequential_preLN__linear_kernel_hedgehog__moe_arch_mod__prompt_kernel
  .amdhsa_next_free_vgpr 256
  .amdhsa_next_free_sgpr 102
  .amdhsa_accum_offset 256
  .amdhsa_group_segment_fixed_size 0
  .amdhsa_kernarg_size 96
  .amdhsa_user_sgpr_count 2
  .amdhsa_user_sgpr_kernarg_segment_ptr 1
  .amdhsa_system_sgpr_workgroup_id_x 1
  .amdhsa_float_denorm_mode_32 3
.end_amdhsa_kernel
```
